```python
import torch

def _softmax(x, axis=-1):
    return torch.softmax(x, dim=axis)

def _gelu(x):
    return torch.nn.functional.gelu(x, approximate='tanh')

def _silu(x):
    return torch.nn.functional.silu(x)

def _sigmoid(x):
    return torch.sigmoid(x)

def _layernorm(x, axis=-1, eps=1e-05):
    m = x.mean(dim=axis, keepdim=True)
    v = x.var(dim=axis, keepdim=True, unbiased=False)
    return (x - m) / torch.sqrt(v + eps)

def _scatter_add(tgt, idx, src, axis=0):
    return tgt.clone().index_add_(axis, idx, src)

def _segment_sum(src, seg, n):
    out = torch.zeros((n,) + src.shape[1:], dtype=src.dtype)
    return out.index_add_(0, seg, src)

def _pad(x, pw):
    flat = tuple((v for pair in reversed(pw) for v in pair))
    return torch.nn.functional.pad(x, flat)
kernel_name = 'recurrent_scan__ssm_conv_h3__mixer_gmlp__prompt'

def setup_inputs():

    _w = lambda a: (lambda t: t.to(torch.bfloat16) if t.is_floating_point() else t)(torch.as_tensor(a))

    def _A_setup():
        B, S, D = (1, 2048, 640)
        ks = 4
        return {'q': _w((lambda *s: torch.randn(*s, dtype=torch.bfloat16) * 0.05)(B, S, D)), 'k': _w((lambda *s: torch.randn(*s, dtype=torch.bfloat16) * 0.2)(B, S, D)), 'v': _w((lambda *s: torch.randn(*s, dtype=torch.bfloat16) * 0.2)(B, S, D)), 'shift_k': _w((lambda *s: torch.randn(*s, dtype=torch.bfloat16) * 0.2)(D, ks) * 0.5), 'ssm_k': _w((lambda *s: torch.randn(*s, dtype=torch.bfloat16) * 0.2)(D, S) * (1.0 / S ** 0.5)), 'ssm_D': _w((lambda *s: torch.randn(*s, dtype=torch.bfloat16) * 0.2)(D))}
    _A_in = _A_setup()

    def _B_setup():
        B, S, D, F = (1, 2048, 640, 1536)
        Fh = F // 2
        return {'x': _w((lambda *s: torch.randn(*s, dtype=torch.bfloat16) * 0.05)(B, S, D)), 'w_in': _w((lambda *s: torch.randn(*s, dtype=torch.bfloat16) * 0.8)(D, 2 * Fh)), 'w_sp': _w(0.01 * (lambda *s: torch.randn(*s, dtype=torch.bfloat16) * 0.8)(S, S)), 'b_sp': _w(1.0 + 0.01 * (lambda *s: torch.randn(*s, dtype=torch.bfloat16) * 0.1)(S)), 'w_out': _w((lambda *s: torch.randn(*s, dtype=torch.bfloat16) * 0.1)(Fh, D))}
    _B_in = _B_setup()
    return {'A_q': _A_in['q'], 'A_k': _A_in['k'], 'A_v': _A_in['v'], 'A_shift_k': _A_in['shift_k'], 'A_ssm_k': _A_in['ssm_k'], 'A_ssm_D': _A_in['ssm_D'], 'B_x': _B_in['x'], 'B_w_in': _B_in['w_in'], 'B_w_sp': _B_in['w_sp'], 'B_b_sp': _B_in['b_sp'], 'B_w_out': _B_in['w_out']}

def reference(A_q, A_k, A_v, A_shift_k, A_ssm_k, A_ssm_D, B_x, B_w_in, B_w_sp, B_b_sp, B_w_out):

    def _A_ref(q, k, v, shift_k, ssm_k, ssm_D):
        B, S, D = q.shape
        ks = shift_k.shape[-1]
        k_pad = _pad(k, ((0, 0), (ks - 1, 0), (0, 0)))
        k_shift = torch.zeros_like(k)
        for t in range(ks):
            k_shift = k_shift + k_pad[:, t:t + S, :] * shift_k[:, ks - 1 - t][None, None, :]
        kv = k_shift * v
        L = 2 * S
        kv_pad = _pad(kv, ((0, 0), (0, S), (0, 0)))
        kf_pad = _pad(ssm_k, ((0, 0), (0, S)))
        kv_f = (lambda x, axes=(-2, -1): torch.fft.rfft2(x.float(), dim=axes))(kv_pad[:, None, :, :], axes=(1, 2))
        kf_f = (lambda x, axes=(-2, -1): torch.fft.rfft2(x.float(), dim=axes))(kf_pad[:, None, :], axes=(1, 2))
        kf_f = (lambda x, *d: x.permute(*d))(kf_f, 1, 2, 0)
        y_f = kv_f * kf_f[None, :, :, :]
        y = (lambda x, s, axes=(-2, -1): torch.fft.irfft2(x, s=s, dim=axes).to(torch.bfloat16))(y_f, (1, L), axes=(1, 2))[:, 0, :S, :]
        y = y + kv * ssm_D[None, None, :]
        return q * y

    def _B_ref(x, w_in, w_sp, b_sp, w_out):
        B, S, D = x.shape
        F = w_in.shape[-1]
        Fh = F // 2
        z = _gelu(torch.einsum('bsd,df->bsf', x, w_in))
        z1 = z[..., :Fh].clone()
        z2 = _layernorm(z[..., Fh:], axis=-1)
        g = torch.einsum('ts,bsf->btf', w_sp, z2) + b_sp[None, :, None]
        return torch.einsum('bsf,fd->bsd', z1 * g, w_out)
    x = A_q
    xn = _layernorm(x, axis=-1)
    s = _A_ref(xn, A_k, A_v, A_shift_k, A_ssm_k, A_ssm_D)
    g = _silu(_B_ref(xn, B_w_in, B_w_sp, B_b_sp, B_w_out))
    return x + s * g
```

```asm
; @launch kernel=k1_kernel grid=(256,1,1) block=(512,1,1) lds=163840
; @launch kernel=k2_kernel grid=(512,1,1) block=(256,1,1) lds=81920
; @launch kernel=k3_kernel grid=(256,1,1) block=(256,1,1) lds=153600
.amdgcn_target "amdgcn-amd-amdhsa--gfx950"
.text
.globl k1_kernel
.p2align 8
.type k1_kernel,@function
k1_kernel:
    s_cmp_ge_u32 s2, 256
    s_cbranch_scc1 k1_kernel_end
    s_load_dwordx2 s[4:5], s[0:1], 0
    s_load_dwordx2 s[8:9], s[0:1], 56
    s_load_dwordx2 s[12:13], s[0:1], 8
    s_load_dwordx2 s[16:17], s[0:1], 16
    s_load_dwordx2 s[20:21], s[0:1], 24
    s_load_dwordx2 s[24:25], s[0:1], 104
    s_load_dwordx2 s[28:29], s[0:1], 96
    s_mov_b32 s6, 2621440
    s_mov_b32 s7, 0x20000
    s_mov_b32 s10, 1966080
    s_mov_b32 s11, 0x20000
    s_mov_b32 s14, 2621440
    s_mov_b32 s15, 0x20000
    s_mov_b32 s18, 2621440
    s_mov_b32 s19, 0x20000
    s_mov_b32 s22, 5120
    s_mov_b32 s23, 0x20000
    s_mov_b32 s26, 15007744
    s_mov_b32 s27, 0x20000
    s_mov_b32 s30, 256
    s_mov_b32 s31, 0x20000
    v_lshrrev_b32 v2, 6, v0
    v_and_b32 v1, 63, v0
    v_readfirstlane_b32 s34, v2
    v_lshrrev_b32 v2, 4, v1
    v_and_b32 v3, 15, v1
    s_and_b32 s40, s2, 7
    s_lshr_b32 s41, s2, 3
    s_lshr_b32 s32, s41, 3
    s_lshl_b32 s40, s40, 2
    s_add_u32 s32, s32, s40
    s_and_b32 s33, s41, 7
    s_and_b32 s35, s34, 1
    s_lshr_b32 s36, s34, 1
    s_and_b32 s36, s36, 1
    s_lshr_b32 s37, s34, 2
    s_xor_b32 s38, s35, s37
    s_lshl_b32 s39, s36, 1
    s_add_u32 s39, s39, s38
    s_mul_i32 s44, s32, 81920
    s_mul_i32 s46, s33, 192
    s_add_u32 s45, s46, 1536
    s_mov_b32 s47, 0x3727c5ac
    s_mov_b32 s48, 0x3f803f80
    s_mov_b32 s50, 0xc0135761
    s_mov_b32 s51, 0xc0135761
    s_mov_b32 s52, 0xbdd2d3e8
    s_mov_b32 s53, 0xbdd2d3e8
    s_lshl_b32 s56, s34, 11
    s_mul_i32 s57, s34, 3072
    s_lshl_b32 s40, s34, 3
    v_add_u32 v6, s40, v2
    v_and_b32 v7, 15, v6
    v_xor_b32 v7, v7, v3
    v_lshlrev_b32 v7, 4, v7
    v_mul_u32_u24 v6, 1280, v6
    v_add_u32 v4, v6, v7
    v_add_u32 v6, s40, v2
    v_add_u32 v6, 4, v6
    v_and_b32 v7, 15, v6
    v_xor_b32 v7, v7, v3
    v_lshlrev_b32 v7, 4, v7
    v_mul_u32_u24 v6, 1280, v6
    v_add_u32 v5, v6, v7
    s_mul_i32 s40, s34, 192
    v_add_u32 v6, s40, v1
    v_mul_u32_u24 v7, 43691, v6
    v_lshrrev_b32 v7, 19, v7
    v_mul_u32_u24 v8, 12, v7
    v_sub_u32 v6, v6, v8
    v_lshrrev_b32 v8, 2, v7
    v_and_b32 v8, 2, v8
    v_xor_b32 v6, v6, v8
    v_lshlrev_b32 v6, 4, v6
    v_mul_u32_u24 v7, 3072, v7
    v_add_u32 v9, v6, v7
    v_add_u32 v6, s40, v1
    v_add_u32 v6, 64, v6
    v_mul_u32_u24 v7, 43691, v6
    v_lshrrev_b32 v7, 19, v7
    v_mul_u32_u24 v8, 12, v7
    v_sub_u32 v6, v6, v8
    v_lshrrev_b32 v8, 2, v7
    v_and_b32 v8, 2, v8
    v_xor_b32 v6, v6, v8
    v_lshlrev_b32 v6, 4, v6
    v_mul_u32_u24 v7, 3072, v7
    v_add_u32 v10, v6, v7
    v_add_u32 v6, s40, v1
    v_add_u32 v6, 128, v6
    v_mul_u32_u24 v7, 43691, v6
    v_lshrrev_b32 v7, 19, v7
    v_mul_u32_u24 v8, 12, v7
    v_sub_u32 v6, v6, v8
    v_lshrrev_b32 v8, 2, v7
    v_and_b32 v8, 2, v8
    v_xor_b32 v6, v6, v8
    v_lshlrev_b32 v6, 4, v6
    v_mul_u32_u24 v7, 3072, v7
    v_add_u32 v11, v6, v7
    s_waitcnt lgkmcnt(0)
    s_add_u32 s41, s44, 0
    s_add_u32 m0, s56, 0
    s_nop 0
    buffer_load_dwordx4 v4, s[4:7], s41 offen lds
    s_add_u32 m0, s56, 1024
    s_nop 0
    buffer_load_dwordx4 v5, s[4:7], s41 offen lds
    s_add_u32 s41, s45, 0
    s_add_u32 m0, s57, 81920
    s_nop 0
    buffer_load_dwordx4 v9, s[8:11], s41 offen lds
    s_add_u32 m0, s57, 82944
    s_nop 0
    buffer_load_dwordx4 v10, s[8:11], s41 offen lds
    s_add_u32 m0, s57, 83968
    s_nop 0
    buffer_load_dwordx4 v11, s[8:11], s41 offen lds
    s_add_u32 s41, s44, 256
    s_add_u32 m0, s56, 16384
    s_nop 0
    buffer_load_dwordx4 v4, s[4:7], s41 offen lds
    s_add_u32 m0, s56, 17408
    s_nop 0
    buffer_load_dwordx4 v5, s[4:7], s41 offen lds
    s_add_u32 s41, s45, 393216
    s_add_u32 m0, s57, 106496
    s_nop 0
    buffer_load_dwordx4 v9, s[8:11], s41 offen lds
    s_add_u32 m0, s57, 107520
    s_nop 0
    buffer_load_dwordx4 v10, s[8:11], s41 offen lds
    s_add_u32 m0, s57, 108544
    s_nop 0
    buffer_load_dwordx4 v11, s[8:11], s41 offen lds
    v_mul_u32_u24 v172, 205, v1
    v_lshrrev_b32 v172, 11, v172
    v_mul_u32_u24 v6, 10, v172
    v_sub_u32 v173, v1, v6
    v_lshlrev_b32 v6, 1, v172
    s_lshl_b32 s40, s34, 3
    v_add_u32 v6, s40, v6
    v_mul_u32_u24 v6, 1280, v6
    v_lshlrev_b32 v7, 4, v173
    v_add_u32 v6, v6, v7
    s_mul_i32 s40, s33, 160
    s_add_u32 s40, s40, s44
    v_add_u32 v168, s40, v6
    v_subrev_u32 v169, 3840, v168
    v_subrev_u32 v170, 2560, v168
    v_subrev_u32 v171, 1280, v168
    s_mul_i32 s40, s33, 640
    v_lshlrev_b32 v7, 6, v173
    v_add_u32 v7, s40, v7
    s_mov_b64 s[54:55], exec
    s_mov_b32 exec_lo, -1
    s_mov_b32 exec_hi, 0xff
    buffer_load_dwordx4 v[60:63], v169, s[12:15], 0 offen
    buffer_load_dwordx4 v[64:67], v170, s[12:15], 0 offen
    buffer_load_dwordx4 v[68:71], v171, s[12:15], 0 offen
    buffer_load_dwordx4 v[72:75], v168, s[12:15], 0 offen
    buffer_load_dwordx4 v[76:79], v168, s[12:15], 0 offen offset:1280
    buffer_load_dwordx4 v[80:83], v168, s[16:19], 0 offen
    buffer_load_dwordx4 v[84:87], v168, s[16:19], 0 offen offset:1280
    buffer_load_dwordx4 v[152:155], v7, s[20:23], 0 offen offset:0
    buffer_load_dwordx4 v[156:159], v7, s[20:23], 0 offen offset:16
    buffer_load_dwordx4 v[160:163], v7, s[20:23], 0 offen offset:32
    buffer_load_dwordx4 v[164:167], v7, s[20:23], 0 offen offset:48
    s_mov_b64 exec, s[54:55]
    s_add_u32 s41, s44, 512
    s_add_u32 m0, s56, 32768
    s_nop 0
    buffer_load_dwordx4 v4, s[4:7], s41 offen lds
    s_add_u32 m0, s56, 33792
    s_nop 0
    buffer_load_dwordx4 v5, s[4:7], s41 offen lds
    s_add_u32 s41, s45, 786432
    s_add_u32 m0, s57, 131072
    s_nop 0
    buffer_load_dwordx4 v9, s[8:11], s41 offen lds
    s_add_u32 m0, s57, 132096
    s_nop 0
    buffer_load_dwordx4 v10, s[8:11], s41 offen lds
    s_add_u32 m0, s57, 133120
    s_nop 0
    buffer_load_dwordx4 v11, s[8:11], s41 offen lds
    s_add_u32 s41, s44, 768
    s_add_u32 m0, s56, 49152
    s_nop 0
    buffer_load_dwordx4 v4, s[4:7], s41 offen lds
    s_add_u32 m0, s56, 50176
    s_nop 0
    buffer_load_dwordx4 v5, s[4:7], s41 offen lds
    s_add_u32 s41, s44, 1024
    s_add_u32 m0, s56, 65536
    s_nop 0
    buffer_load_dwordx4 v4, s[4:7], s41 offen lds
    s_add_u32 m0, s56, 66560
    s_nop 0
    buffer_load_dwordx4 v5, s[4:7], s41 offen lds
    s_lshl_b32 s40, s37, 1
    s_add_u32 s59, s40, s36
    s_xor_b32 s60, s59, 1
    v_xor_b32 v6, v2, v3
    s_lshl_b32 s40, s59, 2
    v_xor_b32 v7, s40, v6
    v_lshlrev_b32 v7, 4, v7
    v_lshlrev_b32 v8, 8, v3
    v_add_u32 v7, v7, v8
    s_lshl_b32 s40, s36, 13
    s_lshl_b32 s41, s38, 12
    s_add_u32 s42, s40, s41
    v_add_u32 v174, s42, v7
    s_xor_b32 s41, s41, 4096
    s_add_u32 s42, s40, s41
    v_add_u32 v175, s42, v7
    s_lshl_b32 s40, s60, 2
    v_xor_b32 v7, s40, v6
    v_lshlrev_b32 v7, 4, v7
    v_lshlrev_b32 v8, 8, v3
    v_add_u32 v7, v7, v8
    s_lshl_b32 s40, s36, 13
    s_lshl_b32 s41, s38, 12
    s_add_u32 s42, s40, s41
    v_add_u32 v176, s42, v7
    s_xor_b32 s41, s41, 4096
    s_add_u32 s42, s40, s41
    v_add_u32 v177, s42, v7
    v_lshlrev_b32 v6, 3, v2
    v_lshrrev_b32 v7, 2, v3
    v_add_u32 v6, v6, v7
    v_mul_u32_u24 v6, 192, v6
    v_and_b32 v7, 3, v3
    v_lshlrev_b32 v7, 3, v7
    v_add_u32 v6, v6, v7
    v_and_b32 v7, 1, v2
    s_mul_i32 s43, s35, 3
    s_add_u32 s40, s43, 0
    v_xor_b32 v8, s40, v7
    v_lshlrev_b32 v8, 5, v8
    v_add_u32 v8, v8, v6
    s_mul_i32 s41, s59, 6144
    s_add_u32 s41, s41, 81920
    v_add_u32 v178, s41, v8
    s_mul_i32 s41, s60, 6144
    s_add_u32 s41, s41, 81920
    v_add_u32 v181, s41, v8
    s_add_u32 s40, s43, 1
    v_xor_b32 v8, s40, v7
    v_lshlrev_b32 v8, 5, v8
    v_add_u32 v8, v8, v6
    s_mul_i32 s41, s59, 6144
    s_add_u32 s41, s41, 81920
    v_add_u32 v179, s41, v8
    s_mul_i32 s41, s60, 6144
    s_add_u32 s41, s41, 81920
    v_add_u32 v182, s41, v8
    s_add_u32 s40, s43, 2
    v_xor_b32 v8, s40, v7
    v_lshlrev_b32 v8, 5, v8
    v_add_u32 v8, v8, v6
    s_mul_i32 s41, s59, 6144
    s_add_u32 s41, s41, 81920
    v_add_u32 v180, s41, v8
    s_mul_i32 s41, s60, 6144
    s_add_u32 s41, s41, 81920
    v_add_u32 v183, s41, v8
    v_mov_b32 v184, 0
    v_mov_b32 v185, 0
    v_mov_b32 v186, 0
    v_mov_b32 v187, 0
    v_mov_b32 v188, 0
    v_mov_b32 v222, s50
    v_mov_b32 v223, s50
    v_mov_b32 v224, 1.0
    v_mov_b32 v225, 1.0
    s_waitcnt vmcnt(25)
    s_waitcnt lgkmcnt(0)
    s_barrier
    ds_read_b128 v[12:15], v174 offset:0
    ds_read_b128 v[16:19], v175 offset:0
    ds_read_b128 v[20:23], v176 offset:0
    ds_read_b128 v[24:27], v177 offset:0
    ds_read_b64_tr_b16 v[92:93], v178
    ds_read_b64_tr_b16 v[94:95], v178 offset:768
    ds_read_b64_tr_b16 v[96:97], v179
    ds_read_b64_tr_b16 v[98:99], v179 offset:768
    ds_read_b64_tr_b16 v[100:101], v180
    ds_read_b64_tr_b16 v[102:103], v180 offset:768
    ds_read_b64_tr_b16 v[104:105], v181
    ds_read_b64_tr_b16 v[106:107], v181 offset:768
    ds_read_b64_tr_b16 v[108:109], v182
    ds_read_b64_tr_b16 v[110:111], v182 offset:768
    ds_read_b64_tr_b16 v[112:113], v183
    ds_read_b64_tr_b16 v[114:115], v183 offset:768
    s_waitcnt lgkmcnt(10)
    v_mfma_f32_16x16x32_bf16 v[116:119], v[92:95], v[12:15], 0
    v_mfma_f32_16x16x32_bf16 v[120:123], v[92:95], v[16:19], 0
    v_dot2_f32_bf16 v184, v92, s48, v184
    v_dot2_f32_bf16 v184, v93, s48, v184
    v_dot2_f32_bf16 v184, v94, s48, v184
    v_dot2_f32_bf16 v184, v95, s48, v184
    s_waitcnt lgkmcnt(8)
    v_mfma_f32_16x16x32_bf16 v[124:127], v[96:99], v[12:15], 0
    v_mfma_f32_16x16x32_bf16 v[128:131], v[96:99], v[16:19], 0
    v_dot2_f32_bf16 v185, v96, s48, v185
    v_dot2_f32_bf16 v185, v97, s48, v185
    v_dot2_f32_bf16 v185, v98, s48, v185
    v_dot2_f32_bf16 v185, v99, s48, v185
    s_waitcnt lgkmcnt(6)
    v_mfma_f32_16x16x32_bf16 v[132:135], v[100:103], v[12:15], 0
    v_mfma_f32_16x16x32_bf16 v[136:139], v[100:103], v[16:19], 0
    v_dot2_f32_bf16 v186, v100, s48, v186
    v_dot2_f32_bf16 v186, v101, s48, v186
    v_dot2_f32_bf16 v186, v102, s48, v186
    v_dot2_f32_bf16 v186, v103, s48, v186
    v_dot2_f32_bf16 v187, v12, s48, v187
    v_dot2_f32_bf16 v188, v12, v12, v188
    v_dot2_f32_bf16 v187, v13, s48, v187
    v_dot2_f32_bf16 v188, v13, v13, v188
    v_dot2_f32_bf16 v187, v14, s48, v187
    v_dot2_f32_bf16 v188, v14, v14, v188
    v_dot2_f32_bf16 v187, v15, s48, v187
    v_dot2_f32_bf16 v188, v15, v15, v188
    s_waitcnt lgkmcnt(4)
    v_mfma_f32_16x16x32_bf16 v[116:119], v[104:107], v[20:23], v[116:119]
    v_mfma_f32_16x16x32_bf16 v[120:123], v[104:107], v[24:27], v[120:123]
    s_waitcnt lgkmcnt(2)
    v_mfma_f32_16x16x32_bf16 v[124:127], v[108:111], v[20:23], v[124:127]
    v_mfma_f32_16x16x32_bf16 v[128:131], v[108:111], v[24:27], v[128:131]
    s_waitcnt lgkmcnt(0)
    v_mfma_f32_16x16x32_bf16 v[132:135], v[112:115], v[20:23], v[132:135]
    v_mfma_f32_16x16x32_bf16 v[136:139], v[112:115], v[24:27], v[136:139]
    v_dot2_f32_bf16 v187, v20, s48, v187
    v_dot2_f32_bf16 v188, v20, v20, v188
    v_dot2_f32_bf16 v187, v21, s48, v187
    v_dot2_f32_bf16 v188, v21, v21, v188
    v_dot2_f32_bf16 v187, v22, s48, v187
    v_dot2_f32_bf16 v188, v22, v22, v188
    v_dot2_f32_bf16 v187, v23, s48, v187
    v_dot2_f32_bf16 v188, v23, v23, v188
    s_waitcnt vmcnt(20)
    s_waitcnt lgkmcnt(0)
    s_barrier
    s_add_u32 s41, s45, 1179648
    s_add_u32 m0, s57, 81920
    s_nop 0
    buffer_load_dwordx4 v9, s[8:11], s41 offen lds
    s_add_u32 m0, s57, 82944
    s_nop 0
    buffer_load_dwordx4 v10, s[8:11], s41 offen lds
    s_add_u32 m0, s57, 83968
    s_nop 0
    buffer_load_dwordx4 v11, s[8:11], s41 offen lds
    v_add_u32 v178, 24576, v178
    v_add_u32 v179, 24576, v179
    v_add_u32 v180, 24576, v180
    v_add_u32 v181, 24576, v181
    v_add_u32 v182, 24576, v182
    v_add_u32 v183, 24576, v183
    ds_read_b128 v[28:31], v174 offset:16384
    ds_read_b128 v[32:35], v175 offset:16384
    ds_read_b128 v[36:39], v176 offset:16384
    ds_read_b128 v[40:43], v177 offset:16384
    ds_read_b64_tr_b16 v[92:93], v178
    ds_read_b64_tr_b16 v[94:95], v178 offset:768
    ds_read_b64_tr_b16 v[96:97], v179
    ds_read_b64_tr_b16 v[98:99], v179 offset:768
    ds_read_b64_tr_b16 v[100:101], v180
    ds_read_b64_tr_b16 v[102:103], v180 offset:768
    ds_read_b64_tr_b16 v[104:105], v181
    ds_read_b64_tr_b16 v[106:107], v181 offset:768
    ds_read_b64_tr_b16 v[108:109], v182
    ds_read_b64_tr_b16 v[110:111], v182 offset:768
    ds_read_b64_tr_b16 v[112:113], v183
    ds_read_b64_tr_b16 v[114:115], v183 offset:768
    s_waitcnt vmcnt(12)
    s_mov_b32 exec_lo, -1
    s_mov_b32 exec_hi, 0xff
    v_mul_u32_u24 v8, 1152, v173
    v_lshlrev_b32 v6, 2, v172
    v_sub_u32 v8, v8, v6
    s_lshl_b32 s40, s34, 4
    s_add_u32 s40, s40, 12
    v_add_u32 v8, s40, v8
    v_lshlrev_b32 v192, 16, v60
    v_and_b32 v193, 0xffff0000, v60
    v_lshlrev_b32 v194, 16, v64
    v_and_b32 v195, 0xffff0000, v64
    v_lshlrev_b32 v196, 16, v68
    v_and_b32 v197, 0xffff0000, v68
    v_lshlrev_b32 v198, 16, v72
    v_and_b32 v199, 0xffff0000, v72
    v_lshlrev_b32 v200, 16, v76
    v_and_b32 v201, 0xffff0000, v76
    v_lshlrev_b32 v202, 16, v152
    v_lshlrev_b32 v203, 16, v154
    v_and_b32 v204, 0xffff0000, v152
    v_and_b32 v205, 0xffff0000, v154
    v_lshlrev_b32 v206, 16, v153
    v_lshlrev_b32 v207, 16, v155
    v_and_b32 v208, 0xffff0000, v153
    v_and_b32 v209, 0xffff0000, v155
    v_pk_mul_f32 v[210:211], v[198:199], v[202:203]
    v_pk_fma_f32 v[210:211], v[196:197], v[204:205], v[210:211]
    v_pk_fma_f32 v[210:211], v[194:195], v[206:207], v[210:211]
    v_pk_fma_f32 v[210:211], v[192:193], v[208:209], v[210:211]
    v_pk_mul_f32 v[212:213], v[200:201], v[202:203]
    v_pk_fma_f32 v[212:213], v[198:199], v[204:205], v[212:213]
    v_pk_fma_f32 v[212:213], v[196:197], v[206:207], v[212:213]
    v_pk_fma_f32 v[212:213], v[194:195], v[208:209], v[212:213]
    v_lshlrev_b32 v214, 16, v80
    v_and_b32 v215, 0xffff0000, v80
    v_lshlrev_b32 v216, 16, v84
    v_and_b32 v217, 0xffff0000, v84
    v_pk_mul_f32 v[210:211], v[210:211], v[214:215]
    v_pk_mul_f32 v[212:213], v[212:213], v[216:217]
    v_cvt_pk_bf16_f32 v218, v212, v210
    v_cvt_pk_bf16_f32 v219, v213, v211
    ds_write_b32 v8, v218 offset:0
    ds_write_b32 v8, v219 offset:144
    v_lshlrev_b32 v192, 16, v61
    v_and_b32 v193, 0xffff0000, v61
    v_lshlrev_b32 v194, 16, v65
    v_and_b32 v195, 0xffff0000, v65
    v_lshlrev_b32 v196, 16, v69
    v_and_b32 v197, 0xffff0000, v69
    v_lshlrev_b32 v198, 16, v73
    v_and_b32 v199, 0xffff0000, v73
    v_lshlrev_b32 v200, 16, v77
    v_and_b32 v201, 0xffff0000, v77
    v_lshlrev_b32 v202, 16, v156
    v_lshlrev_b32 v203, 16, v158
    v_and_b32 v204, 0xffff0000, v156
    v_and_b32 v205, 0xffff0000, v158
    v_lshlrev_b32 v206, 16, v157
    v_lshlrev_b32 v207, 16, v159
    v_and_b32 v208, 0xffff0000, v157
    v_and_b32 v209, 0xffff0000, v159
    v_pk_mul_f32 v[210:211], v[198:199], v[202:203]
    v_pk_fma_f32 v[210:211], v[196:197], v[204:205], v[210:211]
    v_pk_fma_f32 v[210:211], v[194:195], v[206:207], v[210:211]
    v_pk_fma_f32 v[210:211], v[192:193], v[208:209], v[210:211]
    v_pk_mul_f32 v[212:213], v[200:201], v[202:203]
    v_pk_fma_f32 v[212:213], v[198:199], v[204:205], v[212:213]
    v_pk_fma_f32 v[212:213], v[196:197], v[206:207], v[212:213]
    v_pk_fma_f32 v[212:213], v[194:195], v[208:209], v[212:213]
    v_lshlrev_b32 v214, 16, v81
    v_and_b32 v215, 0xffff0000, v81
    v_lshlrev_b32 v216, 16, v85
    v_and_b32 v217, 0xffff0000, v85
    v_pk_mul_f32 v[210:211], v[210:211], v[214:215]
    v_pk_mul_f32 v[212:213], v[212:213], v[216:217]
    v_cvt_pk_bf16_f32 v218, v212, v210
    v_cvt_pk_bf16_f32 v219, v213, v211
    ds_write_b32 v8, v218 offset:288
    ds_write_b32 v8, v219 offset:432
    v_lshlrev_b32 v192, 16, v62
    v_and_b32 v193, 0xffff0000, v62
    v_lshlrev_b32 v194, 16, v66
    v_and_b32 v195, 0xffff0000, v66
    v_lshlrev_b32 v196, 16, v70
    v_and_b32 v197, 0xffff0000, v70
    v_lshlrev_b32 v198, 16, v74
    v_and_b32 v199, 0xffff0000, v74
    v_lshlrev_b32 v200, 16, v78
    v_and_b32 v201, 0xffff0000, v78
    v_lshlrev_b32 v202, 16, v160
    v_lshlrev_b32 v203, 16, v162
    v_and_b32 v204, 0xffff0000, v160
    v_and_b32 v205, 0xffff0000, v162
    v_lshlrev_b32 v206, 16, v161
    v_lshlrev_b32 v207, 16, v163
    v_and_b32 v208, 0xffff0000, v161
    v_and_b32 v209, 0xffff0000, v163
    v_pk_mul_f32 v[210:211], v[198:199], v[202:203]
    v_pk_fma_f32 v[210:211], v[196:197], v[204:205], v[210:211]
    v_pk_fma_f32 v[210:211], v[194:195], v[206:207], v[210:211]
    v_pk_fma_f32 v[210:211], v[192:193], v[208:209], v[210:211]
    v_pk_mul_f32 v[212:213], v[200:201], v[202:203]
    v_pk_fma_f32 v[212:213], v[198:199], v[204:205], v[212:213]
    v_pk_fma_f32 v[212:213], v[196:197], v[206:207], v[212:213]
    v_pk_fma_f32 v[212:213], v[194:195], v[208:209], v[212:213]
    v_lshlrev_b32 v214, 16, v82
    v_and_b32 v215, 0xffff0000, v82
    v_lshlrev_b32 v216, 16, v86
    v_and_b32 v217, 0xffff0000, v86
    v_pk_mul_f32 v[210:211], v[210:211], v[214:215]
    v_pk_mul_f32 v[212:213], v[212:213], v[216:217]
    v_cvt_pk_bf16_f32 v218, v212, v210
    v_cvt_pk_bf16_f32 v219, v213, v211
    ds_write_b32 v8, v218 offset:576
    ds_write_b32 v8, v219 offset:720
    v_lshlrev_b32 v192, 16, v63
    v_and_b32 v193, 0xffff0000, v63
    v_lshlrev_b32 v194, 16, v67
    v_and_b32 v195, 0xffff0000, v67
    v_lshlrev_b32 v196, 16, v71
    v_and_b32 v197, 0xffff0000, v71
    v_lshlrev_b32 v198, 16, v75
    v_and_b32 v199, 0xffff0000, v75
    v_lshlrev_b32 v200, 16, v79
    v_and_b32 v201, 0xffff0000, v79
    v_lshlrev_b32 v202, 16, v164
    v_lshlrev_b32 v203, 16, v166
    v_and_b32 v204, 0xffff0000, v164
    v_and_b32 v205, 0xffff0000, v166
    v_lshlrev_b32 v206, 16, v165
    v_lshlrev_b32 v207, 16, v167
    v_and_b32 v208, 0xffff0000, v165
    v_and_b32 v209, 0xffff0000, v167
    v_pk_mul_f32 v[210:211], v[198:199], v[202:203]
    v_pk_fma_f32 v[210:211], v[196:197], v[204:205], v[210:211]
    v_pk_fma_f32 v[210:211], v[194:195], v[206:207], v[210:211]
    v_pk_fma_f32 v[210:211], v[192:193], v[208:209], v[210:211]
    v_pk_mul_f32 v[212:213], v[200:201], v[202:203]
    v_pk_fma_f32 v[212:213], v[198:199], v[204:205], v[212:213]
    v_pk_fma_f32 v[212:213], v[196:197], v[206:207], v[212:213]
    v_pk_fma_f32 v[212:213], v[194:195], v[208:209], v[212:213]
    v_lshlrev_b32 v214, 16, v83
    v_and_b32 v215, 0xffff0000, v83
    v_lshlrev_b32 v216, 16, v87
    v_and_b32 v217, 0xffff0000, v87
    v_pk_mul_f32 v[210:211], v[210:211], v[214:215]
    v_pk_mul_f32 v[212:213], v[212:213], v[216:217]
    v_cvt_pk_bf16_f32 v218, v212, v210
    v_cvt_pk_bf16_f32 v219, v213, v211
    ds_write_b32 v8, v218 offset:864
    ds_write_b32 v8, v219 offset:1008
    s_mov_b64 exec, s[54:55]
    s_waitcnt lgkmcnt(15)
    v_mfma_f32_16x16x32_bf16 v[116:119], v[92:95], v[28:31], v[116:119]
    v_mfma_f32_16x16x32_bf16 v[120:123], v[92:95], v[32:35], v[120:123]
    v_dot2_f32_bf16 v184, v92, s48, v184
    v_dot2_f32_bf16 v184, v93, s48, v184
    v_dot2_f32_bf16 v184, v94, s48, v184
    v_dot2_f32_bf16 v184, v95, s48, v184
    s_waitcnt lgkmcnt(15)
    v_mfma_f32_16x16x32_bf16 v[124:127], v[96:99], v[28:31], v[124:127]
    v_mfma_f32_16x16x32_bf16 v[128:131], v[96:99], v[32:35], v[128:131]
    v_dot2_f32_bf16 v185, v96, s48, v185
    v_dot2_f32_bf16 v185, v97, s48, v185
    v_dot2_f32_bf16 v185, v98, s48, v185
    v_dot2_f32_bf16 v185, v99, s48, v185
    s_waitcnt lgkmcnt(14)
    v_mfma_f32_16x16x32_bf16 v[132:135], v[100:103], v[28:31], v[132:135]
    v_mfma_f32_16x16x32_bf16 v[136:139], v[100:103], v[32:35], v[136:139]
    v_dot2_f32_bf16 v186, v100, s48, v186
    v_dot2_f32_bf16 v186, v101, s48, v186
    v_dot2_f32_bf16 v186, v102, s48, v186
    v_dot2_f32_bf16 v186, v103, s48, v186
    v_dot2_f32_bf16 v187, v28, s48, v187
    v_dot2_f32_bf16 v188, v28, v28, v188
    v_dot2_f32_bf16 v187, v29, s48, v187
    v_dot2_f32_bf16 v188, v29, v29, v188
    v_dot2_f32_bf16 v187, v30, s48, v187
    v_dot2_f32_bf16 v188, v30, v30, v188
    v_dot2_f32_bf16 v187, v31, s48, v187
    v_dot2_f32_bf16 v188, v31, v31, v188
    s_waitcnt lgkmcnt(12)
    v_mfma_f32_16x16x32_bf16 v[116:119], v[104:107], v[36:39], v[116:119]
    v_mfma_f32_16x16x32_bf16 v[120:123], v[104:107], v[40:43], v[120:123]
    s_waitcnt lgkmcnt(10)
    v_mfma_f32_16x16x32_bf16 v[124:127], v[108:111], v[36:39], v[124:127]
    v_mfma_f32_16x16x32_bf16 v[128:131], v[108:111], v[40:43], v[128:131]
    s_waitcnt lgkmcnt(8)
    v_mfma_f32_16x16x32_bf16 v[132:135], v[112:115], v[36:39], v[132:135]
    v_mfma_f32_16x16x32_bf16 v[136:139], v[112:115], v[40:43], v[136:139]
    v_dot2_f32_bf16 v187, v36, s48, v187
    v_dot2_f32_bf16 v188, v36, v36, v188
    v_dot2_f32_bf16 v187, v37, s48, v187
    v_dot2_f32_bf16 v188, v37, v37, v188
    v_dot2_f32_bf16 v187, v38, s48, v187
    v_dot2_f32_bf16 v188, v38, v38, v188
    v_dot2_f32_bf16 v187, v39, s48, v187
    v_dot2_f32_bf16 v188, v39, v39, v188
    s_waitcnt vmcnt(7)
    s_waitcnt lgkmcnt(0)
    s_barrier
    s_add_u32 s41, s45, 1572864
    s_add_u32 m0, s57, 106496
    s_nop 0
    buffer_load_dwordx4 v9, s[8:11], s41 offen lds
    s_add_u32 m0, s57, 107520
    s_nop 0
    buffer_load_dwordx4 v10, s[8:11], s41 offen lds
    s_add_u32 m0, s57, 108544
    s_nop 0
    buffer_load_dwordx4 v11, s[8:11], s41 offen lds
    v_add_u32 v178, 24576, v178
    v_add_u32 v179, 24576, v179
    v_add_u32 v180, 24576, v180
    v_add_u32 v181, 24576, v181
    v_add_u32 v182, 24576, v182
    v_add_u32 v183, 24576, v183
    ds_read_b128 v[44:47], v174 offset:32768
    ds_read_b128 v[48:51], v175 offset:32768
    ds_read_b128 v[52:55], v176 offset:32768
    ds_read_b128 v[56:59], v177 offset:32768
    ds_read_b64_tr_b16 v[92:93], v178
    ds_read_b64_tr_b16 v[94:95], v178 offset:768
    ds_read_b64_tr_b16 v[96:97], v179
    ds_read_b64_tr_b16 v[98:99], v179 offset:768
    ds_read_b64_tr_b16 v[100:101], v180
    ds_read_b64_tr_b16 v[102:103], v180 offset:768
    ds_read_b64_tr_b16 v[104:105], v181
    ds_read_b64_tr_b16 v[106:107], v181 offset:768
    ds_read_b64_tr_b16 v[108:109], v182
    ds_read_b64_tr_b16 v[110:111], v182 offset:768
    ds_read_b64_tr_b16 v[112:113], v183
    ds_read_b64_tr_b16 v[114:115], v183 offset:768
    s_lshl_b32 s40, s34, 3
    v_lshrrev_b32 v6, 3, v1
    v_add_u32 v6, s40, v6
    v_and_b32 v7, 7, v1
    v_lshlrev_b32 v7, 4, v7
    v_mul_u32_u24 v8, 144, v6
    v_add_u32 v8, v8, v7
    ds_read_b128 v[192:195], v8 offset:0
    v_lshlrev_b32 v6, 12, v6
    v_add_u32 v6, v6, v7
    s_mul_i32 s40, s33, 327680
    s_lshl_b32 s41, s32, 7
    s_add_u32 s40, s40, s41
    s_add_u32 s40, s40, 6291456
    s_waitcnt lgkmcnt(0)
    buffer_store_dwordx4 v[192:195], v6, s[24:27], s40 offen
    s_cmp_ge_u32 s34, 2
    s_cbranch_scc1 k1_kvskip_1
    s_lshl_b32 s40, s34, 3
    s_add_u32 s40, s40, 64
    v_lshrrev_b32 v6, 3, v1
    v_add_u32 v6, s40, v6
    v_and_b32 v7, 7, v1
    v_lshlrev_b32 v7, 4, v7
    v_mul_u32_u24 v8, 144, v6
    v_add_u32 v8, v8, v7
    ds_read_b128 v[192:195], v8 offset:0
    v_lshlrev_b32 v6, 12, v6
    v_add_u32 v6, v6, v7
    s_mul_i32 s40, s33, 327680
    s_lshl_b32 s41, s32, 7
    s_add_u32 s40, s40, s41
    s_add_u32 s40, s40, 6291456
    s_waitcnt lgkmcnt(0)
    buffer_store_dwordx4 v[192:195], v6, s[24:27], s40 offen
k1_kvskip_1:
    s_nop 1
    s_waitcnt lgkmcnt(12)
    v_mfma_f32_16x16x32_bf16 v[116:119], v[92:95], v[44:47], v[116:119]
    v_mfma_f32_16x16x32_bf16 v[120:123], v[92:95], v[48:51], v[120:123]
    v_dot2_f32_bf16 v184, v92, s48, v184
    v_dot2_f32_bf16 v184, v93, s48, v184
    v_dot2_f32_bf16 v184, v94, s48, v184
    v_dot2_f32_bf16 v184, v95, s48, v184
    s_waitcnt lgkmcnt(10)
    v_mfma_f32_16x16x32_bf16 v[124:127], v[96:99], v[44:47], v[124:127]
    v_mfma_f32_16x16x32_bf16 v[128:131], v[96:99], v[48:51], v[128:131]
    v_dot2_f32_bf16 v185, v96, s48, v185
    v_dot2_f32_bf16 v185, v97, s48, v185
    v_dot2_f32_bf16 v185, v98, s48, v185
    v_dot2_f32_bf16 v185, v99, s48, v185
    s_waitcnt lgkmcnt(8)
    v_mfma_f32_16x16x32_bf16 v[132:135], v[100:103], v[44:47], v[132:135]
    v_mfma_f32_16x16x32_bf16 v[136:139], v[100:103], v[48:51], v[136:139]
    v_dot2_f32_bf16 v186, v100, s48, v186
    v_dot2_f32_bf16 v186, v101, s48, v186
    v_dot2_f32_bf16 v186, v102, s48, v186
    v_dot2_f32_bf16 v186, v103, s48, v186
    v_dot2_f32_bf16 v187, v44, s48, v187
    v_dot2_f32_bf16 v188, v44, v44, v188
    v_dot2_f32_bf16 v187, v45, s48, v187
    v_dot2_f32_bf16 v188, v45, v45, v188
    v_dot2_f32_bf16 v187, v46, s48, v187
    v_dot2_f32_bf16 v188, v46, v46, v188
    v_dot2_f32_bf16 v187, v47, s48, v187
    v_dot2_f32_bf16 v188, v47, v47, v188
    s_waitcnt lgkmcnt(6)
    v_mfma_f32_16x16x32_bf16 v[116:119], v[104:107], v[52:55], v[116:119]
    v_mfma_f32_16x16x32_bf16 v[120:123], v[104:107], v[56:59], v[120:123]
    s_waitcnt lgkmcnt(4)
    v_mfma_f32_16x16x32_bf16 v[124:127], v[108:111], v[52:55], v[124:127]
    v_mfma_f32_16x16x32_bf16 v[128:131], v[108:111], v[56:59], v[128:131]
    s_waitcnt lgkmcnt(2)
    v_mfma_f32_16x16x32_bf16 v[132:135], v[112:115], v[52:55], v[132:135]
    v_mfma_f32_16x16x32_bf16 v[136:139], v[112:115], v[56:59], v[136:139]
    v_dot2_f32_bf16 v187, v52, s48, v187
    v_dot2_f32_bf16 v188, v52, v52, v188
    v_dot2_f32_bf16 v187, v53, s48, v187
    v_dot2_f32_bf16 v188, v53, v53, v188
    v_dot2_f32_bf16 v187, v54, s48, v187
    v_dot2_f32_bf16 v188, v54, v54, v188
    v_dot2_f32_bf16 v187, v55, s48, v187
    v_dot2_f32_bf16 v188, v55, v55, v188
    s_waitcnt vmcnt(4)
    s_waitcnt lgkmcnt(0)
    s_barrier
    s_add_u32 s41, s46, 0
    s_add_u32 m0, s57, 131072
    s_nop 0
    buffer_load_dwordx4 v9, s[8:11], s41 offen lds
    s_add_u32 m0, s57, 132096
    s_nop 0
    buffer_load_dwordx4 v10, s[8:11], s41 offen lds
    s_add_u32 m0, s57, 133120
    s_nop 0
    buffer_load_dwordx4 v11, s[8:11], s41 offen lds
    v_subrev_u32 v178, 49152, v178
    v_subrev_u32 v179, 49152, v179
    v_subrev_u32 v180, 49152, v180
    v_subrev_u32 v181, 49152, v181
    v_subrev_u32 v182, 49152, v182
    v_subrev_u32 v183, 49152, v183
    ds_read_b128 v[60:63], v174 offset:49152
    ds_read_b128 v[64:67], v175 offset:49152
    ds_read_b128 v[68:71], v176 offset:49152
    ds_read_b128 v[72:75], v177 offset:49152
    ds_read_b64_tr_b16 v[92:93], v178
    ds_read_b64_tr_b16 v[94:95], v178 offset:768
    ds_read_b64_tr_b16 v[96:97], v179
    ds_read_b64_tr_b16 v[98:99], v179 offset:768
    ds_read_b64_tr_b16 v[100:101], v180
    ds_read_b64_tr_b16 v[102:103], v180 offset:768
    ds_read_b64_tr_b16 v[104:105], v181
    ds_read_b64_tr_b16 v[106:107], v181 offset:768
    ds_read_b64_tr_b16 v[108:109], v182
    ds_read_b64_tr_b16 v[110:111], v182 offset:768
    ds_read_b64_tr_b16 v[112:113], v183
    ds_read_b64_tr_b16 v[114:115], v183 offset:768
    s_waitcnt lgkmcnt(10)
    v_mfma_f32_16x16x32_bf16 v[116:119], v[92:95], v[60:63], v[116:119]
    v_mfma_f32_16x16x32_bf16 v[120:123], v[92:95], v[64:67], v[120:123]
    v_dot2_f32_bf16 v184, v92, s48, v184
    v_dot2_f32_bf16 v184, v93, s48, v184
    v_dot2_f32_bf16 v184, v94, s48, v184
    v_dot2_f32_bf16 v184, v95, s48, v184
    s_waitcnt lgkmcnt(8)
    v_mfma_f32_16x16x32_bf16 v[124:127], v[96:99], v[60:63], v[124:127]
    v_mfma_f32_16x16x32_bf16 v[128:131], v[96:99], v[64:67], v[128:131]
    v_dot2_f32_bf16 v185, v96, s48, v185
    v_dot2_f32_bf16 v185, v97, s48, v185
    v_dot2_f32_bf16 v185, v98, s48, v185
    v_dot2_f32_bf16 v185, v99, s48, v185
    s_waitcnt lgkmcnt(6)
    v_mfma_f32_16x16x32_bf16 v[132:135], v[100:103], v[60:63], v[132:135]
    v_mfma_f32_16x16x32_bf16 v[136:139], v[100:103], v[64:67], v[136:139]
    v_dot2_f32_bf16 v186, v100, s48, v186
    v_dot2_f32_bf16 v186, v101, s48, v186
    v_dot2_f32_bf16 v186, v102, s48, v186
    v_dot2_f32_bf16 v186, v103, s48, v186
    v_dot2_f32_bf16 v187, v60, s48, v187
    v_dot2_f32_bf16 v188, v60, v60, v188
    v_dot2_f32_bf16 v187, v61, s48, v187
    v_dot2_f32_bf16 v188, v61, v61, v188
    v_dot2_f32_bf16 v187, v62, s48, v187
    v_dot2_f32_bf16 v188, v62, v62, v188
    v_dot2_f32_bf16 v187, v63, s48, v187
    v_dot2_f32_bf16 v188, v63, v63, v188
    s_waitcnt lgkmcnt(4)
    v_mfma_f32_16x16x32_bf16 v[116:119], v[104:107], v[68:71], v[116:119]
    v_mfma_f32_16x16x32_bf16 v[120:123], v[104:107], v[72:75], v[120:123]
    s_waitcnt lgkmcnt(2)
    v_mfma_f32_16x16x32_bf16 v[124:127], v[108:111], v[68:71], v[124:127]
    v_mfma_f32_16x16x32_bf16 v[128:131], v[108:111], v[72:75], v[128:131]
    s_waitcnt lgkmcnt(0)
    v_mfma_f32_16x16x32_bf16 v[132:135], v[112:115], v[68:71], v[132:135]
    v_mfma_f32_16x16x32_bf16 v[136:139], v[112:115], v[72:75], v[136:139]
    v_dot2_f32_bf16 v187, v68, s48, v187
    v_dot2_f32_bf16 v188, v68, v68, v188
    v_dot2_f32_bf16 v187, v69, s48, v187
    v_dot2_f32_bf16 v188, v69, v69, v188
    v_dot2_f32_bf16 v187, v70, s48, v187
    v_dot2_f32_bf16 v188, v70, v70, v188
    v_dot2_f32_bf16 v187, v71, s48, v187
    v_dot2_f32_bf16 v188, v71, v71, v188
    s_waitcnt vmcnt(4)
    s_waitcnt lgkmcnt(0)
    s_barrier
    s_add_u32 s41, s46, 393216
    s_add_u32 m0, s57, 81920
    s_nop 0
    buffer_load_dwordx4 v9, s[8:11], s41 offen lds
    s_add_u32 m0, s57, 82944
    s_nop 0
    buffer_load_dwordx4 v10, s[8:11], s41 offen lds
    s_add_u32 m0, s57, 83968
    s_nop 0
    buffer_load_dwordx4 v11, s[8:11], s41 offen lds
    v_add_u32 v178, 24576, v178
    v_add_u32 v179, 24576, v179
    v_add_u32 v180, 24576, v180
    v_add_u32 v181, 24576, v181
    v_add_u32 v182, 24576, v182
    v_add_u32 v183, 24576, v183
    v_add_u32 v174, 0x10000, v174
    v_add_u32 v175, 0x10000, v175
    v_add_u32 v176, 0x10000, v176
    v_add_u32 v177, 0x10000, v177
    ds_read_b128 v[76:79], v174 offset:0
    ds_read_b128 v[80:83], v175 offset:0
    ds_read_b128 v[84:87], v176 offset:0
    ds_read_b128 v[88:91], v177 offset:0
    ds_read_b64_tr_b16 v[92:93], v178
    ds_read_b64_tr_b16 v[94:95], v178 offset:768
    ds_read_b64_tr_b16 v[96:97], v179
    ds_read_b64_tr_b16 v[98:99], v179 offset:768
    ds_read_b64_tr_b16 v[100:101], v180
    ds_read_b64_tr_b16 v[102:103], v180 offset:768
    ds_read_b64_tr_b16 v[104:105], v181
    ds_read_b64_tr_b16 v[106:107], v181 offset:768
    ds_read_b64_tr_b16 v[108:109], v182
    ds_read_b64_tr_b16 v[110:111], v182 offset:768
    ds_read_b64_tr_b16 v[112:113], v183
    ds_read_b64_tr_b16 v[114:115], v183 offset:768
    s_waitcnt lgkmcnt(10)
    v_mfma_f32_16x16x32_bf16 v[116:119], v[92:95], v[76:79], v[116:119]
    v_mfma_f32_16x16x32_bf16 v[120:123], v[92:95], v[80:83], v[120:123]
    v_dot2_f32_bf16 v184, v92, s48, v184
    v_dot2_f32_bf16 v184, v93, s48, v184
    v_dot2_f32_bf16 v184, v94, s48, v184
    v_dot2_f32_bf16 v184, v95, s48, v184
    s_waitcnt lgkmcnt(8)
    v_mfma_f32_16x16x32_bf16 v[124:127], v[96:99], v[76:79], v[124:127]
    v_mfma_f32_16x16x32_bf16 v[128:131], v[96:99], v[80:83], v[128:131]
    v_dot2_f32_bf16 v185, v96, s48, v185
    v_dot2_f32_bf16 v185, v97, s48, v185
    v_dot2_f32_bf16 v185, v98, s48, v185
    v_dot2_f32_bf16 v185, v99, s48, v185
    s_waitcnt lgkmcnt(6)
    v_mfma_f32_16x16x32_bf16 v[132:135], v[100:103], v[76:79], v[132:135]
    v_mfma_f32_16x16x32_bf16 v[136:139], v[100:103], v[80:83], v[136:139]
    v_dot2_f32_bf16 v186, v100, s48, v186
    v_dot2_f32_bf16 v186, v101, s48, v186
    v_dot2_f32_bf16 v186, v102, s48, v186
    v_dot2_f32_bf16 v186, v103, s48, v186
    v_dot2_f32_bf16 v187, v76, s48, v187
    v_dot2_f32_bf16 v188, v76, v76, v188
    v_dot2_f32_bf16 v187, v77, s48, v187
    v_dot2_f32_bf16 v188, v77, v77, v188
    v_dot2_f32_bf16 v187, v78, s48, v187
    v_dot2_f32_bf16 v188, v78, v78, v188
    v_dot2_f32_bf16 v187, v79, s48, v187
    v_dot2_f32_bf16 v188, v79, v79, v188
    s_waitcnt lgkmcnt(4)
    v_mfma_f32_16x16x32_bf16 v[116:119], v[104:107], v[84:87], v[116:119]
    v_mfma_f32_16x16x32_bf16 v[120:123], v[104:107], v[88:91], v[120:123]
    s_waitcnt lgkmcnt(2)
    v_mfma_f32_16x16x32_bf16 v[124:127], v[108:111], v[84:87], v[124:127]
    v_mfma_f32_16x16x32_bf16 v[128:131], v[108:111], v[88:91], v[128:131]
    s_waitcnt lgkmcnt(0)
    v_mfma_f32_16x16x32_bf16 v[132:135], v[112:115], v[84:87], v[132:135]
    v_mfma_f32_16x16x32_bf16 v[136:139], v[112:115], v[88:91], v[136:139]
    v_dot2_f32_bf16 v187, v84, s48, v187
    v_dot2_f32_bf16 v188, v84, v84, v188
    v_dot2_f32_bf16 v187, v85, s48, v187
    v_dot2_f32_bf16 v188, v85, v85, v188
    v_dot2_f32_bf16 v187, v86, s48, v187
    v_dot2_f32_bf16 v188, v86, v86, v188
    v_dot2_f32_bf16 v187, v87, s48, v187
    v_dot2_f32_bf16 v188, v87, v87, v188
    s_mul_i32 s40, s34, 3072
    s_add_u32 s40, s40, 16384
    v_lshlrev_b32 v6, 4, v1
    v_add_u32 v6, s40, v6
    ds_write_b128 v6, v[120:123] offset:0
    ds_write_b128 v6, v[128:131] offset:1024
    ds_write_b128 v6, v[136:139] offset:2048
    v_mov_b32 v7, v184
    s_nop 1
    v_permlane16_swap_b32 v184, v7
    v_add_f32 v184, v184, v7
    v_mov_b32 v7, v184
    s_nop 1
    v_permlane32_swap_b32 v184, v7
    v_add_f32 v184, v184, v7
    v_mov_b32 v7, v185
    s_nop 1
    v_permlane16_swap_b32 v185, v7
    v_add_f32 v185, v185, v7
    v_mov_b32 v7, v185
    s_nop 1
    v_permlane32_swap_b32 v185, v7
    v_add_f32 v185, v185, v7
    v_mov_b32 v7, v186
    s_nop 1
    v_permlane16_swap_b32 v186, v7
    v_add_f32 v186, v186, v7
    v_mov_b32 v7, v186
    s_nop 1
    v_permlane32_swap_b32 v186, v7
    v_add_f32 v186, v186, v7
    v_mov_b32 v7, v187
    s_nop 1
    v_permlane16_swap_b32 v187, v7
    v_add_f32 v187, v187, v7
    v_mov_b32 v7, v187
    s_nop 1
    v_permlane32_swap_b32 v187, v7
    v_add_f32 v187, v187, v7
    v_mov_b32 v7, v188
    s_nop 1
    v_permlane16_swap_b32 v188, v7
    v_add_f32 v188, v188, v7
    v_mov_b32 v7, v188
    s_nop 1
    v_permlane32_swap_b32 v188, v7
    v_add_f32 v188, v188, v7
    s_lshl_b32 s40, s35, 2
    s_lshl_b32 s41, s36, 1
    s_add_u32 s40, s40, s41
    s_add_u32 s40, s40, s37
    s_mul_i32 s40, s40, 192
    s_add_u32 s40, s40, 40960
    v_lshlrev_b32 v6, 2, v3
    v_add_u32 v6, s40, v6
    s_mov_b64 exec, 0xffff
    ds_write_b32 v6, v184 offset:0
    ds_write_b32 v6, v185 offset:64
    ds_write_b32 v6, v186 offset:128
    s_lshl_b32 s40, s39, 1
    s_add_u32 s40, s40, s37
    s_lshl_b32 s40, s40, 7
    s_add_u32 s40, s40, 43008
    v_lshlrev_b32 v6, 3, v3
    v_add_u32 v6, s40, v6
    v_mov_b32 v192, v187
    v_mov_b32 v193, v188
    ds_write_b64 v6, v[192:193]
    s_mov_b64 exec, -1
    v_mov_b32 v184, 0
    v_mov_b32 v185, 0
    v_mov_b32 v186, 0
    s_waitcnt vmcnt(3)
    s_waitcnt lgkmcnt(0)
    s_barrier
    s_add_u32 s41, s46, 786432
    s_add_u32 m0, s57, 106496
    s_nop 0
    buffer_load_dwordx4 v9, s[8:11], s41 offen lds
    s_add_u32 m0, s57, 107520
    s_nop 0
    buffer_load_dwordx4 v10, s[8:11], s41 offen lds
    s_add_u32 m0, s57, 108544
    s_nop 0
    buffer_load_dwordx4 v11, s[8:11], s41 offen lds
    v_add_u32 v178, 24576, v178
    v_add_u32 v179, 24576, v179
    v_add_u32 v180, 24576, v180
    v_add_u32 v181, 24576, v181
    v_add_u32 v182, 24576, v182
    v_add_u32 v183, 24576, v183
    s_xor_b32 s40, s34, 4
    s_mul_i32 s40, s40, 3072
    s_add_u32 s40, s40, 16384
    v_lshlrev_b32 v6, 4, v1
    v_add_u32 v6, s40, v6
    ds_read_b128 v[192:195], v6 offset:0
    ds_read_b128 v[196:199], v6 offset:1024
    ds_read_b128 v[200:203], v6 offset:2048
    s_lshl_b32 s40, s39, 8
    s_add_u32 s40, s40, 43008
    v_lshlrev_b32 v7, 3, v3
    v_add_u32 v7, s40, v7
    ds_read_b64 v[204:205], v7
    ds_read_b64 v[206:207], v7 offset:128
    s_waitcnt lgkmcnt(0)
    v_pk_add_f32 v[140:141], v[116:117], v[192:193]
    v_pk_add_f32 v[142:143], v[118:119], v[194:195]
    v_pk_add_f32 v[144:145], v[124:125], v[196:197]
    v_pk_add_f32 v[146:147], v[126:127], v[198:199]
    v_pk_add_f32 v[148:149], v[132:133], v[200:201]
    v_pk_add_f32 v[150:151], v[134:135], v[202:203]
    v_pk_add_f32 v[204:205], v[204:205], v[206:207]
    v_mul_f32 v220, 0x3acccccd, v204
    v_mul_f32 v221, 0x3acccccd, v205
    v_fma_f32 v221, -v220, v220, v221
    v_max_f32 v221, 0, v221
    v_cvt_pk_bf16_f32 v221, v221, v221
    v_and_b32 v221, 0xffff0000, v221
    v_add_f32 v221, s47, v221
    v_cvt_pk_bf16_f32 v221, v221, v221
    v_and_b32 v221, 0xffff0000, v221
    v_sqrt_f32 v221, v221
    s_nop 0
    v_cvt_pk_bf16_f32 v221, v221, v221
    v_and_b32 v221, 0xffff0000, v221
    v_rcp_f32 v221, v221
    v_cvt_pk_bf16_f32 v220, v220, v220
    v_and_b32 v220, 0xffff0000, v220
    s_mul_i32 s40, s35, 768
    s_add_u32 s40, s40, 40960
    v_lshlrev_b32 v6, 4, v2
    v_add_u32 v6, s40, v6
    ds_read_b128 v[192:195], v6 offset:0
    ds_read_b128 v[196:199], v6 offset:192
    ds_read_b128 v[200:203], v6 offset:384
    ds_read_b128 v[204:207], v6 offset:576
    s_waitcnt lgkmcnt(0)
    v_pk_add_f32 v[192:193], v[192:193], v[196:197]
    v_pk_add_f32 v[200:201], v[200:201], v[204:205]
    v_pk_add_f32 v[192:193], v[192:193], v[200:201]
    v_pk_add_f32 v[194:195], v[194:195], v[198:199]
    v_pk_add_f32 v[202:203], v[202:203], v[206:207]
    v_pk_add_f32 v[194:195], v[194:195], v[202:203]
    v_fma_f32 v140, -v220, v192, v140
    v_mul_f32 v140, v221, v140
    v_fma_f32 v141, -v220, v193, v141
    v_mul_f32 v141, v221, v141
    v_fma_f32 v142, -v220, v194, v142
    v_mul_f32 v142, v221, v142
    v_fma_f32 v143, -v220, v195, v143
    v_mul_f32 v143, v221, v143
    ds_read_b128 v[192:195], v6 offset:64
    ds_read_b128 v[196:199], v6 offset:256
    ds_read_b128 v[200:203], v6 offset:448
    ds_read_b128 v[204:207], v6 offset:640
    s_waitcnt lgkmcnt(0)
    v_pk_add_f32 v[192:193], v[192:193], v[196:197]
    v_pk_add_f32 v[200:201], v[200:201], v[204:205]
    v_pk_add_f32 v[192:193], v[192:193], v[200:201]
    v_pk_add_f32 v[194:195], v[194:195], v[198:199]
    v_pk_add_f32 v[202:203], v[202:203], v[206:207]
    v_pk_add_f32 v[194:195], v[194:195], v[202:203]
    v_fma_f32 v144, -v220, v192, v144
    v_mul_f32 v144, v221, v144
    v_fma_f32 v145, -v220, v193, v145
    v_mul_f32 v145, v221, v145
    v_fma_f32 v146, -v220, v194, v146
    v_mul_f32 v146, v221, v146
    v_fma_f32 v147, -v220, v195, v147
    v_mul_f32 v147, v221, v147
    ds_read_b128 v[192:195], v6 offset:128
    ds_read_b128 v[196:199], v6 offset:320
    ds_read_b128 v[200:203], v6 offset:512
    ds_read_b128 v[204:207], v6 offset:704
    s_waitcnt lgkmcnt(0)
    v_pk_add_f32 v[192:193], v[192:193], v[196:197]
    v_pk_add_f32 v[200:201], v[200:201], v[204:205]
    v_pk_add_f32 v[192:193], v[192:193], v[200:201]
    v_pk_add_f32 v[194:195], v[194:195], v[198:199]
    v_pk_add_f32 v[202:203], v[202:203], v[206:207]
    v_pk_add_f32 v[194:195], v[194:195], v[202:203]
    v_fma_f32 v148, -v220, v192, v148
    v_mul_f32 v148, v221, v148
    v_fma_f32 v149, -v220, v193, v149
    v_mul_f32 v149, v221, v149
    v_fma_f32 v150, -v220, v194, v150
    v_mul_f32 v150, v221, v150
    v_fma_f32 v151, -v220, v195, v151
    v_mul_f32 v151, v221, v151
    ds_read_b64_tr_b16 v[92:93], v178
    ds_read_b64_tr_b16 v[94:95], v178 offset:768
    ds_read_b64_tr_b16 v[96:97], v179
    ds_read_b64_tr_b16 v[98:99], v179 offset:768
    ds_read_b64_tr_b16 v[100:101], v180
    ds_read_b64_tr_b16 v[102:103], v180 offset:768
    ds_read_b64_tr_b16 v[104:105], v181
    ds_read_b64_tr_b16 v[106:107], v181 offset:768
    ds_read_b64_tr_b16 v[108:109], v182
    ds_read_b64_tr_b16 v[110:111], v182 offset:768
    ds_read_b64_tr_b16 v[112:113], v183
    ds_read_b64_tr_b16 v[114:115], v183 offset:768
    s_waitcnt lgkmcnt(10)
    v_mfma_f32_16x16x32_bf16 v[116:119], v[92:95], v[12:15], 0
    v_mfma_f32_16x16x32_bf16 v[120:123], v[92:95], v[16:19], 0
    v_dot2_f32_bf16 v184, v92, s48, v184
    v_dot2_f32_bf16 v184, v93, s48, v184
    v_dot2_f32_bf16 v184, v94, s48, v184
    v_dot2_f32_bf16 v184, v95, s48, v184
    s_waitcnt lgkmcnt(8)
    v_mfma_f32_16x16x32_bf16 v[124:127], v[96:99], v[12:15], 0
    v_mfma_f32_16x16x32_bf16 v[128:131], v[96:99], v[16:19], 0
    v_dot2_f32_bf16 v185, v96, s48, v185
    v_dot2_f32_bf16 v185, v97, s48, v185
    v_dot2_f32_bf16 v185, v98, s48, v185
    v_dot2_f32_bf16 v185, v99, s48, v185
    s_waitcnt lgkmcnt(6)
    v_mfma_f32_16x16x32_bf16 v[132:135], v[100:103], v[12:15], 0
    v_mfma_f32_16x16x32_bf16 v[136:139], v[100:103], v[16:19], 0
    v_dot2_f32_bf16 v186, v100, s48, v186
    v_dot2_f32_bf16 v186, v101, s48, v186
    v_dot2_f32_bf16 v186, v102, s48, v186
    v_dot2_f32_bf16 v186, v103, s48, v186
    s_waitcnt lgkmcnt(4)
    v_mfma_f32_16x16x32_bf16 v[116:119], v[104:107], v[20:23], v[116:119]
    v_mfma_f32_16x16x32_bf16 v[120:123], v[104:107], v[24:27], v[120:123]
    s_waitcnt lgkmcnt(2)
    v_mfma_f32_16x16x32_bf16 v[124:127], v[108:111], v[20:23], v[124:127]
    v_mfma_f32_16x16x32_bf16 v[128:131], v[108:111], v[24:27], v[128:131]
    s_waitcnt lgkmcnt(0)
    v_mfma_f32_16x16x32_bf16 v[132:135], v[112:115], v[20:23], v[132:135]
    v_mfma_f32_16x16x32_bf16 v[136:139], v[112:115], v[24:27], v[136:139]
    v_pk_mul_f32 v[192:193], v[140:141], v[140:141]
    v_pk_mul_f32 v[194:195], v[142:143], v[142:143]
    v_pk_mul_f32 v[196:197], v[144:145], v[144:145]
    v_pk_mul_f32 v[198:199], v[146:147], v[146:147]
    v_pk_mul_f32 v[200:201], v[148:149], v[148:149]
    v_pk_mul_f32 v[202:203], v[150:151], v[150:151]
    v_pk_fma_f32 v[192:193], v[192:193], s[52:53], v[222:223]
    v_pk_fma_f32 v[194:195], v[194:195], s[52:53], v[222:223]
    v_pk_fma_f32 v[196:197], v[196:197], s[52:53], v[222:223]
    v_pk_fma_f32 v[198:199], v[198:199], s[52:53], v[222:223]
    v_pk_fma_f32 v[200:201], v[200:201], s[52:53], v[222:223]
    v_pk_fma_f32 v[202:203], v[202:203], s[52:53], v[222:223]
    v_pk_mul_f32 v[192:193], v[192:193], v[140:141]
    v_pk_mul_f32 v[194:195], v[194:195], v[142:143]
    v_pk_mul_f32 v[196:197], v[196:197], v[144:145]
    v_pk_mul_f32 v[198:199], v[198:199], v[146:147]
    v_pk_mul_f32 v[200:201], v[200:201], v[148:149]
    v_pk_mul_f32 v[202:203], v[202:203], v[150:151]
    v_exp_f32 v192, v192
    v_exp_f32 v193, v193
    v_exp_f32 v194, v194
    v_exp_f32 v195, v195
    v_exp_f32 v196, v196
    v_exp_f32 v197, v197
    v_exp_f32 v198, v198
    v_exp_f32 v199, v199
    v_exp_f32 v200, v200
    v_exp_f32 v201, v201
    v_exp_f32 v202, v202
    v_exp_f32 v203, v203
    v_pk_add_f32 v[192:193], v[192:193], v[224:225]
    v_pk_add_f32 v[194:195], v[194:195], v[224:225]
    v_pk_add_f32 v[196:197], v[196:197], v[224:225]
    v_pk_add_f32 v[198:199], v[198:199], v[224:225]
    v_pk_add_f32 v[200:201], v[200:201], v[224:225]
    v_pk_add_f32 v[202:203], v[202:203], v[224:225]
    v_rcp_f32 v192, v192
    v_rcp_f32 v193, v193
    v_rcp_f32 v194, v194
    v_rcp_f32 v195, v195
    v_rcp_f32 v196, v196
    v_rcp_f32 v197, v197
    v_rcp_f32 v198, v198
    v_rcp_f32 v199, v199
    v_rcp_f32 v200, v200
    v_rcp_f32 v201, v201
    v_rcp_f32 v202, v202
    v_rcp_f32 v203, v203
    v_pk_mul_f32 v[140:141], v[140:141], v[192:193]
    v_pk_mul_f32 v[142:143], v[142:143], v[194:195]
    v_pk_mul_f32 v[144:145], v[144:145], v[196:197]
    v_pk_mul_f32 v[146:147], v[146:147], v[198:199]
    v_pk_mul_f32 v[148:149], v[148:149], v[200:201]
    v_pk_mul_f32 v[150:151], v[150:151], v[202:203]
    v_add_f32 v192, v140, v141
    v_add_f32 v192, v192, v142
    v_add_f32 v192, v192, v143
    v_add_f32 v192, v192, v144
    v_add_f32 v192, v192, v145
    v_add_f32 v192, v192, v146
    v_add_f32 v192, v192, v147
    v_add_f32 v192, v192, v148
    v_add_f32 v192, v192, v149
    v_add_f32 v192, v192, v150
    v_add_f32 v192, v192, v151
    v_mov_b32 v194, v192
    s_nop 1
    v_permlane16_swap_b32 v192, v194
    v_add_f32 v192, v192, v194
    v_mov_b32 v194, v192
    s_nop 1
    v_permlane32_swap_b32 v192, v194
    v_add_f32 v192, v192, v194
    v_mul_f32 v192, 0x3caaaaab, v192
    v_sub_f32 v194, v140, v192
    v_mul_f32 v193, v194, v194
    v_sub_f32 v194, v141, v192
    v_fmac_f32 v193, v194, v194
    v_sub_f32 v194, v142, v192
    v_fmac_f32 v193, v194, v194
    v_sub_f32 v194, v143, v192
    v_fmac_f32 v193, v194, v194
    v_sub_f32 v194, v144, v192
    v_fmac_f32 v193, v194, v194
    v_sub_f32 v194, v145, v192
    v_fmac_f32 v193, v194, v194
    v_sub_f32 v194, v146, v192
    v_fmac_f32 v193, v194, v194
    v_sub_f32 v194, v147, v192
    v_fmac_f32 v193, v194, v194
    v_sub_f32 v194, v148, v192
    v_fmac_f32 v193, v194, v194
    v_sub_f32 v194, v149, v192
    v_fmac_f32 v193, v194, v194
    v_sub_f32 v194, v150, v192
    v_fmac_f32 v193, v194, v194
    v_sub_f32 v194, v151, v192
    v_fmac_f32 v193, v194, v194
    v_mov_b32 v194, v193
    s_nop 1
    v_permlane16_swap_b32 v193, v194
    v_add_f32 v193, v193, v194
    v_mov_b32 v194, v193
    s_nop 1
    v_permlane32_swap_b32 v193, v194
    v_add_f32 v193, v193, v194
    s_lshl_b32 s40, s32, 4
    s_lshl_b32 s41, s33, 1
    s_add_u32 s40, s40, s41
    s_add_u32 s40, s40, s35
    s_lshl_b32 s40, s40, 9
    s_lshl_b32 s41, s39, 7
    s_add_u32 s40, s40, s41
    s_add_u32 s40, s40, 14745600
    v_lshlrev_b32 v6, 3, v3
    s_mov_b64 exec, 0xffff
    buffer_store_dwordx2 v[192:193], v6, s[24:27], s40 offen sc1
    s_mov_b64 exec, -1
    s_or_b32 s40, s33, s35
    s_cmp_lg_u32 s40, 0
    s_cbranch_scc1 k1_xst_2
    s_lshl_b32 s40, s32, 9
    s_lshl_b32 s41, s39, 7
    s_add_u32 s40, s40, s41
    s_add_u32 s40, s40, 14680064
    v_mov_b32 v196, v220
    v_mov_b32 v197, v221
    s_mov_b64 exec, 0xffff
    buffer_store_dwordx2 v[196:197], v6, s[24:27], s40 offen
    s_mov_b64 exec, -1
k1_xst_2:
    s_waitcnt vmcnt(0)
    s_waitcnt lgkmcnt(0)
    s_barrier
    s_cmp_lg_u32 s34, 0
    s_cbranch_scc1 k1_sig_3
    s_lshl_b32 s40, s32, 2
    v_mov_b32 v6, s40
    v_mov_b32 v7, 1
    s_mov_b64 exec, 1
    buffer_atomic_add v7, v6, s[28:31], 0 offen
    s_mov_b64 exec, -1
k1_sig_3:
    s_add_u32 s41, s46, 1179648
    s_add_u32 m0, s57, 131072
    s_nop 0
    buffer_load_dwordx4 v9, s[8:11], s41 offen lds
    s_add_u32 m0, s57, 132096
    s_nop 0
    buffer_load_dwordx4 v10, s[8:11], s41 offen lds
    s_add_u32 m0, s57, 133120
    s_nop 0
    buffer_load_dwordx4 v11, s[8:11], s41 offen lds
    v_subrev_u32 v178, 49152, v178
    v_subrev_u32 v179, 49152, v179
    v_subrev_u32 v180, 49152, v180
    v_subrev_u32 v181, 49152, v181
    v_subrev_u32 v182, 49152, v182
    v_subrev_u32 v183, 49152, v183
    ds_read_b64_tr_b16 v[92:93], v178
    ds_read_b64_tr_b16 v[94:95], v178 offset:768
    ds_read_b64_tr_b16 v[96:97], v179
    ds_read_b64_tr_b16 v[98:99], v179 offset:768
    ds_read_b64_tr_b16 v[100:101], v180
    ds_read_b64_tr_b16 v[102:103], v180 offset:768
    ds_read_b64_tr_b16 v[104:105], v181
    ds_read_b64_tr_b16 v[106:107], v181 offset:768
    ds_read_b64_tr_b16 v[108:109], v182
    ds_read_b64_tr_b16 v[110:111], v182 offset:768
    ds_read_b64_tr_b16 v[112:113], v183
    ds_read_b64_tr_b16 v[114:115], v183 offset:768
    s_waitcnt lgkmcnt(10)
    v_mfma_f32_16x16x32_bf16 v[116:119], v[92:95], v[28:31], v[116:119]
    v_mfma_f32_16x16x32_bf16 v[120:123], v[92:95], v[32:35], v[120:123]
    v_dot2_f32_bf16 v184, v92, s48, v184
    v_dot2_f32_bf16 v184, v93, s48, v184
    v_dot2_f32_bf16 v184, v94, s48, v184
    v_dot2_f32_bf16 v184, v95, s48, v184
    s_waitcnt lgkmcnt(8)
    v_mfma_f32_16x16x32_bf16 v[124:127], v[96:99], v[28:31], v[124:127]
    v_mfma_f32_16x16x32_bf16 v[128:131], v[96:99], v[32:35], v[128:131]
    v_dot2_f32_bf16 v185, v96, s48, v185
    v_dot2_f32_bf16 v185, v97, s48, v185
    v_dot2_f32_bf16 v185, v98, s48, v185
    v_dot2_f32_bf16 v185, v99, s48, v185
    s_waitcnt lgkmcnt(6)
    v_mfma_f32_16x16x32_bf16 v[132:135], v[100:103], v[28:31], v[132:135]
    v_mfma_f32_16x16x32_bf16 v[136:139], v[100:103], v[32:35], v[136:139]
    v_dot2_f32_bf16 v186, v100, s48, v186
    v_dot2_f32_bf16 v186, v101, s48, v186
    v_dot2_f32_bf16 v186, v102, s48, v186
    v_dot2_f32_bf16 v186, v103, s48, v186
    s_waitcnt lgkmcnt(4)
    v_mfma_f32_16x16x32_bf16 v[116:119], v[104:107], v[36:39], v[116:119]
    v_mfma_f32_16x16x32_bf16 v[120:123], v[104:107], v[40:43], v[120:123]
    s_waitcnt lgkmcnt(2)
    v_mfma_f32_16x16x32_bf16 v[124:127], v[108:111], v[36:39], v[124:127]
    v_mfma_f32_16x16x32_bf16 v[128:131], v[108:111], v[40:43], v[128:131]
    s_waitcnt lgkmcnt(0)
    v_mfma_f32_16x16x32_bf16 v[132:135], v[112:115], v[36:39], v[132:135]
    v_mfma_f32_16x16x32_bf16 v[136:139], v[112:115], v[40:43], v[136:139]
    s_waitcnt vmcnt(4)
    s_waitcnt lgkmcnt(0)
    s_barrier
    s_add_u32 s41, s46, 1572864
    s_add_u32 m0, s57, 81920
    s_nop 0
    buffer_load_dwordx4 v9, s[8:11], s41 offen lds
    s_add_u32 m0, s57, 82944
    s_nop 0
    buffer_load_dwordx4 v10, s[8:11], s41 offen lds
    s_add_u32 m0, s57, 83968
    s_nop 0
    buffer_load_dwordx4 v11, s[8:11], s41 offen lds
    v_add_u32 v178, 24576, v178
    v_add_u32 v179, 24576, v179
    v_add_u32 v180, 24576, v180
    v_add_u32 v181, 24576, v181
    v_add_u32 v182, 24576, v182
    v_add_u32 v183, 24576, v183
    ds_read_b64_tr_b16 v[92:93], v178
    ds_read_b64_tr_b16 v[94:95], v178 offset:768
    ds_read_b64_tr_b16 v[96:97], v179
    ds_read_b64_tr_b16 v[98:99], v179 offset:768
    ds_read_b64_tr_b16 v[100:101], v180
    ds_read_b64_tr_b16 v[102:103], v180 offset:768
    ds_read_b64_tr_b16 v[104:105], v181
    ds_read_b64_tr_b16 v[106:107], v181 offset:768
    ds_read_b64_tr_b16 v[108:109], v182
    ds_read_b64_tr_b16 v[110:111], v182 offset:768
    ds_read_b64_tr_b16 v[112:113], v183
    ds_read_b64_tr_b16 v[114:115], v183 offset:768
    s_waitcnt lgkmcnt(10)
    v_mfma_f32_16x16x32_bf16 v[116:119], v[92:95], v[44:47], v[116:119]
    v_mfma_f32_16x16x32_bf16 v[120:123], v[92:95], v[48:51], v[120:123]
    v_dot2_f32_bf16 v184, v92, s48, v184
    v_dot2_f32_bf16 v184, v93, s48, v184
    v_dot2_f32_bf16 v184, v94, s48, v184
    v_dot2_f32_bf16 v184, v95, s48, v184
    s_waitcnt lgkmcnt(8)
    v_mfma_f32_16x16x32_bf16 v[124:127], v[96:99], v[44:47], v[124:127]
    v_mfma_f32_16x16x32_bf16 v[128:131], v[96:99], v[48:51], v[128:131]
    v_dot2_f32_bf16 v185, v96, s48, v185
    v_dot2_f32_bf16 v185, v97, s48, v185
    v_dot2_f32_bf16 v185, v98, s48, v185
    v_dot2_f32_bf16 v185, v99, s48, v185
    s_waitcnt lgkmcnt(6)
    v_mfma_f32_16x16x32_bf16 v[132:135], v[100:103], v[44:47], v[132:135]
    v_mfma_f32_16x16x32_bf16 v[136:139], v[100:103], v[48:51], v[136:139]
    v_dot2_f32_bf16 v186, v100, s48, v186
    v_dot2_f32_bf16 v186, v101, s48, v186
    v_dot2_f32_bf16 v186, v102, s48, v186
    v_dot2_f32_bf16 v186, v103, s48, v186
    s_waitcnt lgkmcnt(4)
    v_mfma_f32_16x16x32_bf16 v[116:119], v[104:107], v[52:55], v[116:119]
    v_mfma_f32_16x16x32_bf16 v[120:123], v[104:107], v[56:59], v[120:123]
    s_waitcnt lgkmcnt(2)
    v_mfma_f32_16x16x32_bf16 v[124:127], v[108:111], v[52:55], v[124:127]
    v_mfma_f32_16x16x32_bf16 v[128:131], v[108:111], v[56:59], v[128:131]
    s_waitcnt lgkmcnt(0)
    v_mfma_f32_16x16x32_bf16 v[132:135], v[112:115], v[52:55], v[132:135]
    v_mfma_f32_16x16x32_bf16 v[136:139], v[112:115], v[56:59], v[136:139]
    s_waitcnt vmcnt(3)
    s_waitcnt lgkmcnt(0)
    s_barrier
    v_add_u32 v178, 24576, v178
    v_add_u32 v179, 24576, v179
    v_add_u32 v180, 24576, v180
    v_add_u32 v181, 24576, v181
    v_add_u32 v182, 24576, v182
    v_add_u32 v183, 24576, v183
    ds_read_b64_tr_b16 v[92:93], v178
    ds_read_b64_tr_b16 v[94:95], v178 offset:768
    ds_read_b64_tr_b16 v[96:97], v179
    ds_read_b64_tr_b16 v[98:99], v179 offset:768
    ds_read_b64_tr_b16 v[100:101], v180
    ds_read_b64_tr_b16 v[102:103], v180 offset:768
    ds_read_b64_tr_b16 v[104:105], v181
    ds_read_b64_tr_b16 v[106:107], v181 offset:768
    ds_read_b64_tr_b16 v[108:109], v182
    ds_read_b64_tr_b16 v[110:111], v182 offset:768
    ds_read_b64_tr_b16 v[112:113], v183
    ds_read_b64_tr_b16 v[114:115], v183 offset:768
    s_waitcnt lgkmcnt(10)
    v_mfma_f32_16x16x32_bf16 v[116:119], v[92:95], v[60:63], v[116:119]
    v_mfma_f32_16x16x32_bf16 v[120:123], v[92:95], v[64:67], v[120:123]
    v_dot2_f32_bf16 v184, v92, s48, v184
    v_dot2_f32_bf16 v184, v93, s48, v184
    v_dot2_f32_bf16 v184, v94, s48, v184
    v_dot2_f32_bf16 v184, v95, s48, v184
    s_waitcnt lgkmcnt(8)
    v_mfma_f32_16x16x32_bf16 v[124:127], v[96:99], v[60:63], v[124:127]
    v_mfma_f32_16x16x32_bf16 v[128:131], v[96:99], v[64:67], v[128:131]
    v_dot2_f32_bf16 v185, v96, s48, v185
    v_dot2_f32_bf16 v185, v97, s48, v185
    v_dot2_f32_bf16 v185, v98, s48, v185
    v_dot2_f32_bf16 v185, v99, s48, v185
    s_waitcnt lgkmcnt(6)
    v_mfma_f32_16x16x32_bf16 v[132:135], v[100:103], v[60:63], v[132:135]
    v_mfma_f32_16x16x32_bf16 v[136:139], v[100:103], v[64:67], v[136:139]
    v_dot2_f32_bf16 v186, v100, s48, v186
    v_dot2_f32_bf16 v186, v101, s48, v186
    v_dot2_f32_bf16 v186, v102, s48, v186
    v_dot2_f32_bf16 v186, v103, s48, v186
    s_waitcnt lgkmcnt(4)
    v_mfma_f32_16x16x32_bf16 v[116:119], v[104:107], v[68:71], v[116:119]
    v_mfma_f32_16x16x32_bf16 v[120:123], v[104:107], v[72:75], v[120:123]
    s_waitcnt lgkmcnt(2)
    v_mfma_f32_16x16x32_bf16 v[124:127], v[108:111], v[68:71], v[124:127]
    v_mfma_f32_16x16x32_bf16 v[128:131], v[108:111], v[72:75], v[128:131]
    s_waitcnt lgkmcnt(0)
    v_mfma_f32_16x16x32_bf16 v[132:135], v[112:115], v[68:71], v[132:135]
    v_mfma_f32_16x16x32_bf16 v[136:139], v[112:115], v[72:75], v[136:139]
    s_waitcnt vmcnt(0)
    s_waitcnt lgkmcnt(0)
    s_barrier
    v_subrev_u32 v178, 49152, v178
    v_subrev_u32 v179, 49152, v179
    v_subrev_u32 v180, 49152, v180
    v_subrev_u32 v181, 49152, v181
    v_subrev_u32 v182, 49152, v182
    v_subrev_u32 v183, 49152, v183
    ds_read_b64_tr_b16 v[92:93], v178
    ds_read_b64_tr_b16 v[94:95], v178 offset:768
    ds_read_b64_tr_b16 v[96:97], v179
    ds_read_b64_tr_b16 v[98:99], v179 offset:768
    ds_read_b64_tr_b16 v[100:101], v180
    ds_read_b64_tr_b16 v[102:103], v180 offset:768
    ds_read_b64_tr_b16 v[104:105], v181
    ds_read_b64_tr_b16 v[106:107], v181 offset:768
    ds_read_b64_tr_b16 v[108:109], v182
    ds_read_b64_tr_b16 v[110:111], v182 offset:768
    ds_read_b64_tr_b16 v[112:113], v183
    ds_read_b64_tr_b16 v[114:115], v183 offset:768
    s_waitcnt lgkmcnt(10)
    v_mfma_f32_16x16x32_bf16 v[116:119], v[92:95], v[76:79], v[116:119]
    v_mfma_f32_16x16x32_bf16 v[120:123], v[92:95], v[80:83], v[120:123]
    v_dot2_f32_bf16 v184, v92, s48, v184
    v_dot2_f32_bf16 v184, v93, s48, v184
    v_dot2_f32_bf16 v184, v94, s48, v184
    v_dot2_f32_bf16 v184, v95, s48, v184
    s_waitcnt lgkmcnt(8)
    v_mfma_f32_16x16x32_bf16 v[124:127], v[96:99], v[76:79], v[124:127]
    v_mfma_f32_16x16x32_bf16 v[128:131], v[96:99], v[80:83], v[128:131]
    v_dot2_f32_bf16 v185, v96, s48, v185
    v_dot2_f32_bf16 v185, v97, s48, v185
    v_dot2_f32_bf16 v185, v98, s48, v185
    v_dot2_f32_bf16 v185, v99, s48, v185
    s_waitcnt lgkmcnt(6)
    v_mfma_f32_16x16x32_bf16 v[132:135], v[100:103], v[76:79], v[132:135]
    v_mfma_f32_16x16x32_bf16 v[136:139], v[100:103], v[80:83], v[136:139]
    v_dot2_f32_bf16 v186, v100, s48, v186
    v_dot2_f32_bf16 v186, v101, s48, v186
    v_dot2_f32_bf16 v186, v102, s48, v186
    v_dot2_f32_bf16 v186, v103, s48, v186
    s_waitcnt lgkmcnt(4)
    v_mfma_f32_16x16x32_bf16 v[116:119], v[104:107], v[84:87], v[116:119]
    v_mfma_f32_16x16x32_bf16 v[120:123], v[104:107], v[88:91], v[120:123]
    s_waitcnt lgkmcnt(2)
    v_mfma_f32_16x16x32_bf16 v[124:127], v[108:111], v[84:87], v[124:127]
    v_mfma_f32_16x16x32_bf16 v[128:131], v[108:111], v[88:91], v[128:131]
    s_waitcnt lgkmcnt(0)
    v_mfma_f32_16x16x32_bf16 v[132:135], v[112:115], v[84:87], v[132:135]
    v_mfma_f32_16x16x32_bf16 v[136:139], v[112:115], v[88:91], v[136:139]
    s_mul_i32 s40, s34, 3072
    s_add_u32 s40, s40, 16384
    v_lshlrev_b32 v6, 4, v1
    v_add_u32 v6, s40, v6
    ds_write_b128 v6, v[120:123] offset:0
    ds_write_b128 v6, v[128:131] offset:1024
    s_nop 1
    ds_write_b128 v6, v[136:139] offset:2048
    v_mov_b32 v7, v184
    s_nop 1
    v_permlane16_swap_b32 v184, v7
    v_add_f32 v184, v184, v7
    v_mov_b32 v7, v184
    s_nop 1
    v_permlane32_swap_b32 v184, v7
    v_add_f32 v184, v184, v7
    v_mov_b32 v7, v185
    s_nop 1
    v_permlane16_swap_b32 v185, v7
    v_add_f32 v185, v185, v7
    v_mov_b32 v7, v185
    s_nop 1
    v_permlane32_swap_b32 v185, v7
    v_add_f32 v185, v185, v7
    v_mov_b32 v7, v186
    s_nop 1
    v_permlane16_swap_b32 v186, v7
    v_add_f32 v186, v186, v7
    v_mov_b32 v7, v186
    s_nop 1
    v_permlane32_swap_b32 v186, v7
    v_add_f32 v186, v186, v7
    s_lshl_b32 s40, s35, 2
    s_lshl_b32 s41, s36, 1
    s_add_u32 s40, s40, s41
    s_add_u32 s40, s40, s37
    s_mul_i32 s40, s40, 192
    s_add_u32 s40, s40, 40960
    v_lshlrev_b32 v6, 2, v3
    v_add_u32 v6, s40, v6
    s_mov_b64 exec, 0xffff
    ds_write_b32 v6, v184 offset:0
    ds_write_b32 v6, v185 offset:64
    ds_write_b32 v6, v186 offset:128
    s_mov_b64 exec, -1
    v_mov_b32 v184, 0
    v_mov_b32 v185, 0
    v_mov_b32 v186, 0
    s_waitcnt lgkmcnt(0)
    s_barrier
    s_xor_b32 s40, s34, 4
    s_mul_i32 s40, s40, 3072
    s_add_u32 s40, s40, 16384
    v_lshlrev_b32 v6, 4, v1
    v_add_u32 v6, s40, v6
    ds_read_b128 v[192:195], v6 offset:0
    ds_read_b128 v[196:199], v6 offset:1024
    ds_read_b128 v[200:203], v6 offset:2048
    s_waitcnt lgkmcnt(0)
    v_pk_add_f32 v[92:93], v[116:117], v[192:193]
    v_pk_add_f32 v[94:95], v[118:119], v[194:195]
    v_pk_add_f32 v[96:97], v[124:125], v[196:197]
    v_pk_add_f32 v[98:99], v[126:127], v[198:199]
    v_pk_add_f32 v[100:101], v[132:133], v[200:201]
    v_pk_add_f32 v[102:103], v[134:135], v[202:203]
    s_mul_i32 s40, s35, 768
    s_add_u32 s40, s40, 40960
    v_lshlrev_b32 v6, 4, v2
    v_add_u32 v6, s40, v6
    ds_read_b128 v[192:195], v6 offset:0
    ds_read_b128 v[196:199], v6 offset:192
    ds_read_b128 v[200:203], v6 offset:384
    ds_read_b128 v[204:207], v6 offset:576
    s_waitcnt lgkmcnt(0)
    v_pk_add_f32 v[192:193], v[192:193], v[196:197]
    v_pk_add_f32 v[200:201], v[200:201], v[204:205]
    v_pk_add_f32 v[192:193], v[192:193], v[200:201]
    v_pk_add_f32 v[194:195], v[194:195], v[198:199]
    v_pk_add_f32 v[202:203], v[202:203], v[206:207]
    v_pk_add_f32 v[194:195], v[194:195], v[202:203]
    v_fma_f32 v92, -v220, v192, v92
    v_mul_f32 v92, v221, v92
    v_fma_f32 v93, -v220, v193, v93
    v_mul_f32 v93, v221, v93
    v_fma_f32 v94, -v220, v194, v94
    v_mul_f32 v94, v221, v94
    v_fma_f32 v95, -v220, v195, v95
    v_mul_f32 v95, v221, v95
    ds_read_b128 v[192:195], v6 offset:64
    ds_read_b128 v[196:199], v6 offset:256
    ds_read_b128 v[200:203], v6 offset:448
    ds_read_b128 v[204:207], v6 offset:640
    s_waitcnt lgkmcnt(0)
    v_pk_add_f32 v[192:193], v[192:193], v[196:197]
    v_pk_add_f32 v[200:201], v[200:201], v[204:205]
    v_pk_add_f32 v[192:193], v[192:193], v[200:201]
    v_pk_add_f32 v[194:195], v[194:195], v[198:199]
    v_pk_add_f32 v[202:203], v[202:203], v[206:207]
    v_pk_add_f32 v[194:195], v[194:195], v[202:203]
    v_fma_f32 v96, -v220, v192, v96
    v_mul_f32 v96, v221, v96
    v_fma_f32 v97, -v220, v193, v97
    v_mul_f32 v97, v221, v97
    v_fma_f32 v98, -v220, v194, v98
    v_mul_f32 v98, v221, v98
    v_fma_f32 v99, -v220, v195, v99
    v_mul_f32 v99, v221, v99
    ds_read_b128 v[192:195], v6 offset:128
    ds_read_b128 v[196:199], v6 offset:320
    ds_read_b128 v[200:203], v6 offset:512
    ds_read_b128 v[204:207], v6 offset:704
    s_waitcnt lgkmcnt(0)
    v_pk_add_f32 v[192:193], v[192:193], v[196:197]
    v_pk_add_f32 v[200:201], v[200:201], v[204:205]
    v_pk_add_f32 v[192:193], v[192:193], v[200:201]
    v_pk_add_f32 v[194:195], v[194:195], v[198:199]
    v_pk_add_f32 v[202:203], v[202:203], v[206:207]
    v_pk_add_f32 v[194:195], v[194:195], v[202:203]
    v_fma_f32 v100, -v220, v192, v100
    v_mul_f32 v100, v221, v100
    v_fma_f32 v101, -v220, v193, v101
    v_mul_f32 v101, v221, v101
    v_fma_f32 v102, -v220, v194, v102
    v_mul_f32 v102, v221, v102
    v_fma_f32 v103, -v220, v195, v103
    v_mul_f32 v103, v221, v103
    v_pk_mul_f32 v[192:193], v[92:93], v[92:93]
    v_pk_mul_f32 v[194:195], v[94:95], v[94:95]
    v_pk_mul_f32 v[196:197], v[96:97], v[96:97]
    v_pk_mul_f32 v[198:199], v[98:99], v[98:99]
    v_pk_mul_f32 v[200:201], v[100:101], v[100:101]
    v_pk_mul_f32 v[202:203], v[102:103], v[102:103]
    v_pk_fma_f32 v[192:193], v[192:193], s[52:53], v[222:223]
    v_pk_fma_f32 v[194:195], v[194:195], s[52:53], v[222:223]
    v_pk_fma_f32 v[196:197], v[196:197], s[52:53], v[222:223]
    v_pk_fma_f32 v[198:199], v[198:199], s[52:53], v[222:223]
    v_pk_fma_f32 v[200:201], v[200:201], s[52:53], v[222:223]
    v_pk_fma_f32 v[202:203], v[202:203], s[52:53], v[222:223]
    v_pk_mul_f32 v[192:193], v[192:193], v[92:93]
    v_pk_mul_f32 v[194:195], v[194:195], v[94:95]
    v_pk_mul_f32 v[196:197], v[196:197], v[96:97]
    v_pk_mul_f32 v[198:199], v[198:199], v[98:99]
    v_pk_mul_f32 v[200:201], v[200:201], v[100:101]
    v_pk_mul_f32 v[202:203], v[202:203], v[102:103]
    v_exp_f32 v192, v192
    v_exp_f32 v193, v193
    v_exp_f32 v194, v194
    v_exp_f32 v195, v195
    v_exp_f32 v196, v196
    v_exp_f32 v197, v197
    v_exp_f32 v198, v198
    v_exp_f32 v199, v199
    v_exp_f32 v200, v200
    v_exp_f32 v201, v201
    v_exp_f32 v202, v202
    v_exp_f32 v203, v203
    v_pk_add_f32 v[192:193], v[192:193], v[224:225]
    v_pk_add_f32 v[194:195], v[194:195], v[224:225]
    v_pk_add_f32 v[196:197], v[196:197], v[224:225]
    v_pk_add_f32 v[198:199], v[198:199], v[224:225]
    v_pk_add_f32 v[200:201], v[200:201], v[224:225]
    v_pk_add_f32 v[202:203], v[202:203], v[224:225]
    v_rcp_f32 v192, v192
    v_rcp_f32 v193, v193
    v_rcp_f32 v194, v194
    v_rcp_f32 v195, v195
    v_rcp_f32 v196, v196
    v_rcp_f32 v197, v197
    v_rcp_f32 v198, v198
    v_rcp_f32 v199, v199
    v_rcp_f32 v200, v200
    v_rcp_f32 v201, v201
    v_rcp_f32 v202, v202
    v_rcp_f32 v203, v203
    v_pk_mul_f32 v[92:93], v[92:93], v[192:193]
    v_pk_mul_f32 v[94:95], v[94:95], v[194:195]
    v_pk_mul_f32 v[96:97], v[96:97], v[196:197]
    v_pk_mul_f32 v[98:99], v[98:99], v[198:199]
    v_pk_mul_f32 v[100:101], v[100:101], v[200:201]
    v_pk_mul_f32 v[102:103], v[102:103], v[202:203]
    v_lshrrev_b32 v6, 1, v2
    v_mul_u32_u24 v6, 3072, v6
    v_and_b32 v7, 1, v2
    v_lshlrev_b32 v7, 5, v7
    v_add_u32 v7, v7, v3
    v_lshlrev_b32 v7, 4, v7
    v_add_u32 v6, v6, v7
    s_lshl_b32 s40, s32, 3
    s_add_u32 s40, s40, s33
    s_mul_i32 s58, s40, 12288
    s_lshr_b32 s40, s39, 1
    s_mul_i32 s40, s40, 6144
    s_add_u32 s58, s58, s40
    s_and_b32 s40, s39, 1
    s_lshl_b32 s40, s40, 8
    s_add_u32 s58, s58, s40
    s_add_u32 s58, s58, 3145728
    s_mul_i32 s43, s35, 3
    v_cvt_pk_bf16_f32 v192, v92, v93
    v_cvt_pk_bf16_f32 v193, v94, v95
    s_add_u32 s40, s43, 0
    s_lshr_b32 s41, s40, 1
    s_lshl_b32 s41, s41, 10
    s_and_b32 s40, s40, 1
    s_lshl_b32 s40, s40, 3
    s_add_u32 s40, s40, s41
    s_add_u32 s40, s40, s58
    buffer_store_dwordx2 v[192:193], v6, s[24:27], s40 offen
    v_cvt_pk_bf16_f32 v194, v96, v97
    v_cvt_pk_bf16_f32 v195, v98, v99
    s_add_u32 s40, s43, 1
    s_lshr_b32 s41, s40, 1
    s_lshl_b32 s41, s41, 10
    s_and_b32 s40, s40, 1
    s_lshl_b32 s40, s40, 3
    s_add_u32 s40, s40, s41
    s_add_u32 s40, s40, s58
    buffer_store_dwordx2 v[194:195], v6, s[24:27], s40 offen
    v_cvt_pk_bf16_f32 v196, v100, v101
    v_cvt_pk_bf16_f32 v197, v102, v103
    s_add_u32 s40, s43, 2
    s_lshr_b32 s41, s40, 1
    s_lshl_b32 s41, s41, 10
    s_and_b32 s40, s40, 1
    s_lshl_b32 s40, s40, 3
    s_add_u32 s40, s40, s41
    s_add_u32 s40, s40, s58
    buffer_store_dwordx2 v[196:197], v6, s[24:27], s40 offen
    s_lshl_b32 s40, s32, 2
    v_mov_b32 v7, s40
k1_poll_4:
    buffer_load_dword v8, v7, s[28:31], 0 offen sc1
    s_waitcnt vmcnt(0)
    v_readfirstlane_b32 s41, v8
    s_nop 0
    s_cmp_ge_u32 s41, 8
    s_cbranch_scc1 k1_polled_5
    s_sleep 1
    s_branch k1_poll_4
k1_polled_5:
    s_lshl_b32 s40, s32, 13
    s_lshl_b32 s41, s39, 7
    s_add_u32 s40, s40, s41
    s_add_u32 s40, s40, 14745600
    v_lshlrev_b32 v6, 11, v2
    v_lshlrev_b32 v7, 3, v3
    v_add_u32 v6, v6, v7
    buffer_load_dwordx2 v[200:201], v6, s[24:27], s40 offen offset:0 sc1
    buffer_load_dwordx2 v[202:203], v6, s[24:27], s40 offen offset:512 sc1
    buffer_load_dwordx2 v[204:205], v6, s[24:27], s40 offen offset:1024 sc1
    buffer_load_dwordx2 v[206:207], v6, s[24:27], s40 offen offset:1536 sc1
    s_waitcnt vmcnt(0)
    v_add_f32 v192, v200, v202
    v_add_f32 v192, v192, v204
    v_add_f32 v192, v192, v206
    v_mov_b32 v194, v192
    s_nop 1
    v_permlane16_swap_b32 v192, v194
    v_add_f32 v192, v192, v194
    v_mov_b32 v194, v192
    s_nop 1
    v_permlane32_swap_b32 v192, v194
    v_add_f32 v192, v192, v194
    v_mul_f32 v192, 0x3d800000, v192
    v_mov_b32 v193, 0
    v_mov_b32 v195, 0x42400000
    v_sub_f32 v194, v200, v192
    v_mul_f32 v194, v194, v194
    v_fma_f32 v194, v194, v195, v201
    v_add_f32 v193, v193, v194
    v_sub_f32 v194, v202, v192
    v_mul_f32 v194, v194, v194
    v_fma_f32 v194, v194, v195, v203
    v_add_f32 v193, v193, v194
    v_sub_f32 v194, v204, v192
    v_mul_f32 v194, v194, v194
    v_fma_f32 v194, v194, v195, v205
    v_add_f32 v193, v193, v194
    v_sub_f32 v194, v206, v192
    v_mul_f32 v194, v194, v194
    v_fma_f32 v194, v194, v195, v207
    v_add_f32 v193, v193, v194
    v_mov_b32 v194, v193
    s_nop 1
    v_permlane16_swap_b32 v193, v194
    v_add_f32 v193, v193, v194
    v_mov_b32 v194, v193
    s_nop 1
    v_permlane32_swap_b32 v193, v194
    v_add_f32 v193, v193, v194
    v_mul_f32 v193, 0x3aaaaaab, v193
    v_max_f32 v193, 0, v193
    v_cvt_pk_bf16_f32 v193, v193, v193
    v_and_b32 v193, 0xffff0000, v193
    v_add_f32 v193, s47, v193
    v_cvt_pk_bf16_f32 v193, v193, v193
    v_and_b32 v193, 0xffff0000, v193
    v_sqrt_f32 v193, v193
    s_nop 0
    v_cvt_pk_bf16_f32 v193, v193, v193
    v_and_b32 v193, 0xffff0000, v193
    v_rcp_f32 v193, v193
    v_cvt_pk_bf16_f32 v192, v192, v192
    v_and_b32 v192, 0xffff0000, v192
    v_sub_f32 v140, v140, v192
    v_mul_f32 v140, v140, v193
    v_sub_f32 v141, v141, v192
    v_mul_f32 v141, v141, v193
    v_sub_f32 v142, v142, v192
    v_mul_f32 v142, v142, v193
    v_sub_f32 v143, v143, v192
    v_mul_f32 v143, v143, v193
    v_sub_f32 v144, v144, v192
    v_mul_f32 v144, v144, v193
    v_sub_f32 v145, v145, v192
    v_mul_f32 v145, v145, v193
    v_sub_f32 v146, v146, v192
    v_mul_f32 v146, v146, v193
    v_sub_f32 v147, v147, v192
    v_mul_f32 v147, v147, v193
    v_sub_f32 v148, v148, v192
    v_mul_f32 v148, v148, v193
    v_sub_f32 v149, v149, v192
    v_mul_f32 v149, v149, v193
    v_sub_f32 v150, v150, v192
    v_mul_f32 v150, v150, v193
    v_sub_f32 v151, v151, v192
    v_mul_f32 v151, v151, v193
    s_lshl_b32 s40, s39, 4
    v_add_u32 v6, s40, v3
    v_mul_u32_u24 v6, 200, v6
    v_lshlrev_b32 v7, 3, v2
    v_add_u32 v6, v6, v7
    s_mul_i32 s40, s35, 96
    s_add_u32 s40, s40, 0
    v_add_u32 v6, s40, v6
    v_cvt_pk_bf16_f32 v192, v140, v141
    v_cvt_pk_bf16_f32 v193, v142, v143
    ds_write_b64 v6, v[192:193] offset:0
    v_cvt_pk_bf16_f32 v194, v144, v145
    v_cvt_pk_bf16_f32 v195, v146, v147
    ds_write_b64 v6, v[194:195] offset:32
    v_cvt_pk_bf16_f32 v196, v148, v149
    v_cvt_pk_bf16_f32 v197, v150, v151
    ds_write_b64 v6, v[196:197] offset:64
    s_waitcnt lgkmcnt(0)
    s_barrier
    v_lshrrev_b32 v6, 1, v2
    v_lshlrev_b32 v6, 3, v6
    v_lshrrev_b32 v7, 2, v3
    v_add_u32 v6, v6, v7
    v_mul_u32_u24 v6, 200, v6
    v_and_b32 v7, 1, v2
    v_lshlrev_b32 v7, 5, v7
    v_add_u32 v6, v6, v7
    v_and_b32 v7, 3, v3
    v_lshlrev_b32 v7, 3, v7
    v_add_u32 v6, v6, v7
    v_lshlrev_b32 v8, 4, v1
    s_add_u32 s40, s34, 0
    s_mul_i32 s41, s40, 43
    s_lshr_b32 s41, s41, 7
    s_mul_i32 s42, s41, 3
    s_sub_u32 s42, s40, s42
    s_mul_i32 s41, s41, 3200
    s_lshl_b32 s42, s42, 6
    s_add_u32 s41, s41, s42
    s_add_u32 s41, s41, 0
    v_add_u32 v7, s41, v6
    ds_read_b64_tr_b16 v[192:193], v7
    ds_read_b64_tr_b16 v[194:195], v7 offset:800
    s_lshl_b32 s41, s33, 7
    s_lshl_b32 s42, s32, 2
    s_add_u32 s41, s41, s42
    s_mul_i32 s41, s41, 3
    s_add_u32 s41, s41, s40
    s_lshl_b32 s41, s41, 10
    s_add_u32 s41, s41, 0
    s_waitcnt lgkmcnt(0)
    buffer_store_dwordx4 v[192:195], v8, s[24:27], s41 offen
    s_cmp_ge_u32 s34, 4
    s_cbranch_scc1 k1_fr_6
    s_add_u32 s40, s34, 8
    s_mul_i32 s41, s40, 43
    s_lshr_b32 s41, s41, 7
    s_mul_i32 s42, s41, 3
    s_sub_u32 s42, s40, s42
    s_mul_i32 s41, s41, 3200
    s_lshl_b32 s42, s42, 6
    s_add_u32 s41, s41, s42
    s_add_u32 s41, s41, 0
    v_add_u32 v7, s41, v6
    ds_read_b64_tr_b16 v[192:193], v7
    ds_read_b64_tr_b16 v[194:195], v7 offset:800
    s_lshl_b32 s41, s33, 7
    s_lshl_b32 s42, s32, 2
    s_add_u32 s41, s41, s42
    s_mul_i32 s41, s41, 3
    s_add_u32 s41, s41, s40
    s_lshl_b32 s41, s41, 10
    s_add_u32 s41, s41, 0
    s_waitcnt lgkmcnt(0)
    buffer_store_dwordx4 v[192:195], v8, s[24:27], s41 offen
k1_fr_6:
k1_kernel_end:
    s_endpgm

.globl k2_kernel
.p2align 8
.type k2_kernel,@function
k2_kernel:
    s_cmp_ge_u32 s2, 512
    s_cbranch_scc1 k2_kernel_end
    s_cmp_ge_u32 s2, 256
    s_cbranch_scc1 k2_kernel_conv
    s_load_dwordx2 s[4:5], s[0:1], 64
    s_load_dwordx2 s[8:9], s[0:1], 104
    s_load_dwordx2 s[12:13], s[0:1], 72
    s_mov_b32 s6, 8388608
    s_mov_b32 s7, 0x20000
    s_mov_b32 s10, 15007744
    s_mov_b32 s11, 0x20000
    s_mov_b32 s14, 4096
    s_mov_b32 s15, 0x20000
    v_lshrrev_b32 v2, 6, v0
    v_and_b32 v1, 63, v0
    v_readfirstlane_b32 s34, v2
    s_and_b32 s40, s2, 7
    s_lshr_b32 s41, s2, 3
    s_lshr_b32 s32, s40, 1
    s_lshl_b32 s32, s32, 3
    s_and_b32 s42, s41, 7
    s_add_u32 s32, s32, s42
    s_and_b32 s33, s40, 1
    s_lshl_b32 s33, s33, 2
    s_lshr_b32 s42, s41, 3
    s_add_u32 s33, s33, s42
    s_lshl_b32 s44, s33, 7
    s_lshl_b32 s40, s34, 5
    s_add_u32 s44, s44, s40
    s_mul_i32 s44, s44, 3072
    s_add_u32 s44, s44, 0
    s_lshl_b32 s45, s32, 18
    s_lshl_b32 s40, s34, 10
    s_add_u32 s45, s45, s40
    s_lshl_b32 s46, s34, 14
    v_lshlrev_b32 v5, 4, v1
    v_lshrrev_b32 v2, 3, v1
    v_lshlrev_b32 v2, 12, v2
    v_and_b32 v3, 7, v1
    v_lshrrev_b32 v4, 4, v1
    v_xor_b32 v3, v3, v4
    v_lshlrev_b32 v4, 4, v3
    v_add_u32 v6, v2, v4
    v_xor_b32 v3, 4, v3
    v_lshlrev_b32 v4, 4, v3
    v_add_u32 v7, v2, v4
    v_and_b32 v2, 31, v1
    v_lshrrev_b32 v3, 1, v2
    v_and_b32 v3, 7, v3
    v_lshrrev_b32 v4, 5, v1
    v_xor_b32 v3, v3, v4
    v_lshlrev_b32 v2, 7, v2
    v_add_u32 v2, s46, v2
    v_xor_b32 v4, 0, v3
    v_lshlrev_b32 v4, 4, v4
    v_add_u32 v8, v2, v4
    v_xor_b32 v4, 2, v3
    v_lshlrev_b32 v4, 4, v4
    v_add_u32 v9, v2, v4
    v_xor_b32 v4, 4, v3
    v_lshlrev_b32 v4, 4, v4
    v_add_u32 v10, v2, v4
    v_xor_b32 v4, 6, v3
    v_lshlrev_b32 v4, 4, v4
    v_add_u32 v11, v2, v4
    s_waitcnt lgkmcnt(0)
    s_add_u32 s41, s45, 0
    s_add_u32 m0, s46, 0
    s_nop 0
    buffer_load_dwordx4 v6, s[4:7], s41 offen lds
    s_add_u32 s41, s45, 32768
    s_add_u32 m0, s46, 1024
    s_nop 0
    buffer_load_dwordx4 v7, s[4:7], s41 offen lds
    s_add_u32 s41, s45, 65536
    s_add_u32 m0, s46, 2048
    s_nop 0
    buffer_load_dwordx4 v6, s[4:7], s41 offen lds
    s_add_u32 s41, s45, 98304
    s_add_u32 m0, s46, 3072
    s_nop 0
    buffer_load_dwordx4 v7, s[4:7], s41 offen lds
    s_add_u32 s41, s45, 131072
    s_add_u32 m0, s46, 4096
    s_nop 0
    buffer_load_dwordx4 v6, s[4:7], s41 offen lds
    s_add_u32 s41, s45, 163840
    s_add_u32 m0, s46, 5120
    s_nop 0
    buffer_load_dwordx4 v7, s[4:7], s41 offen lds
    s_add_u32 s41, s45, 196608
    s_add_u32 m0, s46, 6144
    s_nop 0
    buffer_load_dwordx4 v6, s[4:7], s41 offen lds
    s_add_u32 s41, s45, 229376
    s_add_u32 m0, s46, 7168
    s_nop 0
    buffer_load_dwordx4 v7, s[4:7], s41 offen lds
    s_add_u32 s41, s44, 0
    buffer_load_dwordx4 v[108:111], v5, s[8:11], s41 offen offset:0
    buffer_load_dwordx4 v[112:115], v5, s[8:11], s41 offen offset:1024
    buffer_load_dwordx4 v[116:119], v5, s[8:11], s41 offen offset:2048
    s_add_u32 s41, s44, 3072
    buffer_load_dwordx4 v[120:123], v5, s[8:11], s41 offen offset:0
    buffer_load_dwordx4 v[124:127], v5, s[8:11], s41 offen offset:1024
    buffer_load_dwordx4 v[128:131], v5, s[8:11], s41 offen offset:2048
    s_add_u32 s41, s44, 6144
    buffer_load_dwordx4 v[132:135], v5, s[8:11], s41 offen offset:0
    buffer_load_dwordx4 v[136:139], v5, s[8:11], s41 offen offset:1024
    buffer_load_dwordx4 v[140:143], v5, s[8:11], s41 offen offset:2048
    s_add_u32 s41, s44, 9216
    buffer_load_dwordx4 v[144:147], v5, s[8:11], s41 offen offset:0
    buffer_load_dwordx4 v[148:151], v5, s[8:11], s41 offen offset:1024
    buffer_load_dwordx4 v[152:155], v5, s[8:11], s41 offen offset:2048
    s_add_u32 s41, s45, 128
    s_add_u32 m0, s46, 8192
    s_nop 0
    buffer_load_dwordx4 v6, s[4:7], s41 offen lds
    s_add_u32 s41, s45, 32896
    s_add_u32 m0, s46, 9216
    s_nop 0
    buffer_load_dwordx4 v7, s[4:7], s41 offen lds
    s_add_u32 s41, s45, 65664
    s_add_u32 m0, s46, 10240
    s_nop 0
    buffer_load_dwordx4 v6, s[4:7], s41 offen lds
    s_add_u32 s41, s45, 98432
    s_add_u32 m0, s46, 11264
    s_nop 0
    buffer_load_dwordx4 v7, s[4:7], s41 offen lds
    s_add_u32 s41, s45, 131200
    s_add_u32 m0, s46, 12288
    s_nop 0
    buffer_load_dwordx4 v6, s[4:7], s41 offen lds
    s_add_u32 s41, s45, 163968
    s_add_u32 m0, s46, 13312
    s_nop 0
    buffer_load_dwordx4 v7, s[4:7], s41 offen lds
    s_add_u32 s41, s45, 196736
    s_add_u32 m0, s46, 14336
    s_nop 0
    buffer_load_dwordx4 v6, s[4:7], s41 offen lds
    s_add_u32 s41, s45, 229504
    s_add_u32 m0, s46, 15360
    s_nop 0
    buffer_load_dwordx4 v7, s[4:7], s41 offen lds
    s_add_u32 s41, s44, 12288
    buffer_load_dwordx4 v[156:159], v5, s[8:11], s41 offen offset:0
    buffer_load_dwordx4 v[160:163], v5, s[8:11], s41 offen offset:1024
    buffer_load_dwordx4 v[164:167], v5, s[8:11], s41 offen offset:2048
    s_add_u32 s41, s44, 15360
    buffer_load_dwordx4 v[168:171], v5, s[8:11], s41 offen offset:0
    buffer_load_dwordx4 v[172:175], v5, s[8:11], s41 offen offset:1024
    buffer_load_dwordx4 v[176:179], v5, s[8:11], s41 offen offset:2048
    s_add_u32 s41, s44, 18432
    buffer_load_dwordx4 v[180:183], v5, s[8:11], s41 offen offset:0
    buffer_load_dwordx4 v[184:187], v5, s[8:11], s41 offen offset:1024
    buffer_load_dwordx4 v[188:191], v5, s[8:11], s41 offen offset:2048
    s_add_u32 s41, s44, 21504
    buffer_load_dwordx4 v[192:195], v5, s[8:11], s41 offen offset:0
    buffer_load_dwordx4 v[196:199], v5, s[8:11], s41 offen offset:1024
    buffer_load_dwordx4 v[200:203], v5, s[8:11], s41 offen offset:2048
    s_lshl_b32 s40, s32, 3
    s_add_u32 s40, s40, s33
    s_lshl_b32 s40, s40, 2
    s_add_u32 s40, s40, s34
    s_mul_i32 s40, s40, 3072
    s_add_u32 s40, s40, 3145728
    buffer_load_dwordx4 v[220:223], v5, s[8:11], s40 offen offset:0
    buffer_load_dwordx4 v[224:227], v5, s[8:11], s40 offen offset:1024
    buffer_load_dwordx4 v[228:231], v5, s[8:11], s40 offen offset:2048
    v_and_b32 v2, 31, v1
    v_lshlrev_b32 v2, 1, v2
    s_lshr_b32 s40, s34, 1
    s_lshl_b32 s40, s40, 6
    s_lshl_b32 s41, s32, 7
    s_add_u32 s40, s40, s41
    buffer_load_ushort v232, v2, s[12:15], s40 offen
    s_waitcnt vmcnt(36)
    ds_read_b128 v[204:207], v8 offset:0
    ds_read_b128 v[208:211], v8 offset:4096
    ds_read_b128 v[212:215], v9 offset:0
    ds_read_b128 v[216:219], v9 offset:4096
    s_waitcnt vmcnt(33)
    s_waitcnt lgkmcnt(2)
    v_mfma_f32_32x32x16_bf16 v[12:27], v[108:111], v[204:207], 0
    v_mfma_f32_32x32x16_bf16 v[28:43], v[108:111], v[208:211], 0
    v_mfma_f32_32x32x16_bf16 v[44:59], v[112:115], v[204:207], 0
    v_mfma_f32_32x32x16_bf16 v[60:75], v[112:115], v[208:211], 0
    v_mfma_f32_32x32x16_bf16 v[76:91], v[116:119], v[204:207], 0
    v_mfma_f32_32x32x16_bf16 v[92:107], v[116:119], v[208:211], 0
    s_add_u32 s41, s44, 24576
    buffer_load_dwordx4 v[108:111], v5, s[8:11], s41 offen offset:0
    buffer_load_dwordx4 v[112:115], v5, s[8:11], s41 offen offset:1024
    buffer_load_dwordx4 v[116:119], v5, s[8:11], s41 offen offset:2048
    ds_read_b128 v[204:207], v10 offset:0
    ds_read_b128 v[208:211], v10 offset:4096
    s_waitcnt vmcnt(33)
    s_waitcnt lgkmcnt(2)
    v_mfma_f32_32x32x16_bf16 v[12:27], v[120:123], v[212:215], v[12:27]
    v_mfma_f32_32x32x16_bf16 v[28:43], v[120:123], v[216:219], v[28:43]
    v_mfma_f32_32x32x16_bf16 v[44:59], v[124:127], v[212:215], v[44:59]
    v_mfma_f32_32x32x16_bf16 v[60:75], v[124:127], v[216:219], v[60:75]
    v_mfma_f32_32x32x16_bf16 v[76:91], v[128:131], v[212:215], v[76:91]
    v_mfma_f32_32x32x16_bf16 v[92:107], v[128:131], v[216:219], v[92:107]
    s_add_u32 s41, s44, 27648
    buffer_load_dwordx4 v[120:123], v5, s[8:11], s41 offen offset:0
    buffer_load_dwordx4 v[124:127], v5, s[8:11], s41 offen offset:1024
    buffer_load_dwordx4 v[128:131], v5, s[8:11], s41 offen offset:2048
    ds_read_b128 v[212:215], v11 offset:0
    ds_read_b128 v[216:219], v11 offset:4096
    s_waitcnt vmcnt(33)
    s_waitcnt lgkmcnt(2)
    v_mfma_f32_32x32x16_bf16 v[12:27], v[132:135], v[204:207], v[12:27]
    v_mfma_f32_32x32x16_bf16 v[28:43], v[132:135], v[208:211], v[28:43]
    v_mfma_f32_32x32x16_bf16 v[44:59], v[136:139], v[204:207], v[44:59]
    v_mfma_f32_32x32x16_bf16 v[60:75], v[136:139], v[208:211], v[60:75]
    v_mfma_f32_32x32x16_bf16 v[76:91], v[140:143], v[204:207], v[76:91]
    v_mfma_f32_32x32x16_bf16 v[92:107], v[140:143], v[208:211], v[92:107]
    s_add_u32 s41, s44, 30720
    buffer_load_dwordx4 v[132:135], v5, s[8:11], s41 offen offset:0
    buffer_load_dwordx4 v[136:139], v5, s[8:11], s41 offen offset:1024
    buffer_load_dwordx4 v[140:143], v5, s[8:11], s41 offen offset:2048
    s_waitcnt vmcnt(25)
    ds_read_b128 v[204:207], v8 offset:8192
    ds_read_b128 v[208:211], v8 offset:12288
    s_waitcnt vmcnt(33)
    s_waitcnt lgkmcnt(2)
    v_mfma_f32_32x32x16_bf16 v[12:27], v[144:147], v[212:215], v[12:27]
    v_mfma_f32_32x32x16_bf16 v[28:43], v[144:147], v[216:219], v[28:43]
    v_mfma_f32_32x32x16_bf16 v[44:59], v[148:151], v[212:215], v[44:59]
    v_mfma_f32_32x32x16_bf16 v[60:75], v[148:151], v[216:219], v[60:75]
    v_mfma_f32_32x32x16_bf16 v[76:91], v[152:155], v[212:215], v[76:91]
    v_mfma_f32_32x32x16_bf16 v[92:107], v[152:155], v[216:219], v[92:107]
    s_add_u32 s41, s44, 33792
    buffer_load_dwordx4 v[144:147], v5, s[8:11], s41 offen offset:0
    buffer_load_dwordx4 v[148:151], v5, s[8:11], s41 offen offset:1024
    buffer_load_dwordx4 v[152:155], v5, s[8:11], s41 offen offset:2048
    s_add_u32 s41, s45, 256
    s_add_u32 m0, s46, 0
    s_nop 0
    buffer_load_dwordx4 v6, s[4:7], s41 offen lds
    s_add_u32 s41, s45, 33024
    s_add_u32 m0, s46, 1024
    s_nop 0
    buffer_load_dwordx4 v7, s[4:7], s41 offen lds
    s_add_u32 s41, s45, 65792
    s_add_u32 m0, s46, 2048
    s_nop 0
    buffer_load_dwordx4 v6, s[4:7], s41 offen lds
    s_add_u32 s41, s45, 98560
    s_add_u32 m0, s46, 3072
    s_nop 0
    buffer_load_dwordx4 v7, s[4:7], s41 offen lds
    s_add_u32 s41, s45, 131328
    s_add_u32 m0, s46, 4096
    s_nop 0
    buffer_load_dwordx4 v6, s[4:7], s41 offen lds
    s_add_u32 s41, s45, 164096
    s_add_u32 m0, s46, 5120
    s_nop 0
    buffer_load_dwordx4 v7, s[4:7], s41 offen lds
    s_add_u32 s41, s45, 196864
    s_add_u32 m0, s46, 6144
    s_nop 0
    buffer_load_dwordx4 v6, s[4:7], s41 offen lds
    s_add_u32 s41, s45, 229632
    s_add_u32 m0, s46, 7168
    s_nop 0
    buffer_load_dwordx4 v7, s[4:7], s41 offen lds
    ds_read_b128 v[212:215], v9 offset:8192
    ds_read_b128 v[216:219], v9 offset:12288
    s_waitcnt vmcnt(33)
    s_waitcnt lgkmcnt(2)
    v_mfma_f32_32x32x16_bf16 v[12:27], v[156:159], v[204:207], v[12:27]
    v_mfma_f32_32x32x16_bf16 v[28:43], v[156:159], v[208:211], v[28:43]
    v_mfma_f32_32x32x16_bf16 v[44:59], v[160:163], v[204:207], v[44:59]
    v_mfma_f32_32x32x16_bf16 v[60:75], v[160:163], v[208:211], v[60:75]
    v_mfma_f32_32x32x16_bf16 v[76:91], v[164:167], v[204:207], v[76:91]
    v_mfma_f32_32x32x16_bf16 v[92:107], v[164:167], v[208:211], v[92:107]
    s_add_u32 s41, s44, 36864
    buffer_load_dwordx4 v[156:159], v5, s[8:11], s41 offen offset:0
    buffer_load_dwordx4 v[160:163], v5, s[8:11], s41 offen offset:1024
    buffer_load_dwordx4 v[164:167], v5, s[8:11], s41 offen offset:2048
    ds_read_b128 v[204:207], v10 offset:8192
    ds_read_b128 v[208:211], v10 offset:12288
    s_waitcnt vmcnt(33)
    s_waitcnt lgkmcnt(2)
    v_mfma_f32_32x32x16_bf16 v[12:27], v[168:171], v[212:215], v[12:27]
    v_mfma_f32_32x32x16_bf16 v[28:43], v[168:171], v[216:219], v[28:43]
    v_mfma_f32_32x32x16_bf16 v[44:59], v[172:175], v[212:215], v[44:59]
    v_mfma_f32_32x32x16_bf16 v[60:75], v[172:175], v[216:219], v[60:75]
    v_mfma_f32_32x32x16_bf16 v[76:91], v[176:179], v[212:215], v[76:91]
    v_mfma_f32_32x32x16_bf16 v[92:107], v[176:179], v[216:219], v[92:107]
    s_add_u32 s41, s44, 39936
    buffer_load_dwordx4 v[168:171], v5, s[8:11], s41 offen offset:0
    buffer_load_dwordx4 v[172:175], v5, s[8:11], s41 offen offset:1024
    buffer_load_dwordx4 v[176:179], v5, s[8:11], s41 offen offset:2048
    ds_read_b128 v[212:215], v11 offset:8192
    ds_read_b128 v[216:219], v11 offset:12288
    s_waitcnt vmcnt(33)
    s_waitcnt lgkmcnt(2)
    v_mfma_f32_32x32x16_bf16 v[12:27], v[180:183], v[204:207], v[12:27]
    v_mfma_f32_32x32x16_bf16 v[28:43], v[180:183], v[208:211], v[28:43]
    v_mfma_f32_32x32x16_bf16 v[44:59], v[184:187], v[204:207], v[44:59]
    v_mfma_f32_32x32x16_bf16 v[60:75], v[184:187], v[208:211], v[60:75]
    v_mfma_f32_32x32x16_bf16 v[76:91], v[188:191], v[204:207], v[76:91]
    v_mfma_f32_32x32x16_bf16 v[92:107], v[188:191], v[208:211], v[92:107]
    s_add_u32 s41, s44, 43008
    buffer_load_dwordx4 v[180:183], v5, s[8:11], s41 offen offset:0
    buffer_load_dwordx4 v[184:187], v5, s[8:11], s41 offen offset:1024
    buffer_load_dwordx4 v[188:191], v5, s[8:11], s41 offen offset:2048
    s_waitcnt vmcnt(9)
    ds_read_b128 v[204:207], v8 offset:0
    ds_read_b128 v[208:211], v8 offset:4096
    s_waitcnt vmcnt(33)
    s_waitcnt lgkmcnt(2)
    v_mfma_f32_32x32x16_bf16 v[12:27], v[192:195], v[212:215], v[12:27]
    v_mfma_f32_32x32x16_bf16 v[28:43], v[192:195], v[216:219], v[28:43]
    v_mfma_f32_32x32x16_bf16 v[44:59], v[196:199], v[212:215], v[44:59]
    v_mfma_f32_32x32x16_bf16 v[60:75], v[196:199], v[216:219], v[60:75]
    v_mfma_f32_32x32x16_bf16 v[76:91], v[200:203], v[212:215], v[76:91]
    v_mfma_f32_32x32x16_bf16 v[92:107], v[200:203], v[216:219], v[92:107]
    s_add_u32 s41, s44, 46080
    buffer_load_dwordx4 v[192:195], v5, s[8:11], s41 offen offset:0
    buffer_load_dwordx4 v[196:199], v5, s[8:11], s41 offen offset:1024
    buffer_load_dwordx4 v[200:203], v5, s[8:11], s41 offen offset:2048
    s_add_u32 s41, s45, 384
    s_add_u32 m0, s46, 8192
    s_nop 0
    buffer_load_dwordx4 v6, s[4:7], s41 offen lds
    s_add_u32 s41, s45, 33152
    s_add_u32 m0, s46, 9216
    s_nop 0
    buffer_load_dwordx4 v7, s[4:7], s41 offen lds
    s_add_u32 s41, s45, 65920
    s_add_u32 m0, s46, 10240
    s_nop 0
    buffer_load_dwordx4 v6, s[4:7], s41 offen lds
    s_add_u32 s41, s45, 98688
    s_add_u32 m0, s46, 11264
    s_nop 0
    buffer_load_dwordx4 v7, s[4:7], s41 offen lds
    s_add_u32 s41, s45, 131456
    s_add_u32 m0, s46, 12288
    s_nop 0
    buffer_load_dwordx4 v6, s[4:7], s41 offen lds
    s_add_u32 s41, s45, 164224
    s_add_u32 m0, s46, 13312
    s_nop 0
    buffer_load_dwordx4 v7, s[4:7], s41 offen lds
    s_add_u32 s41, s45, 196992
    s_add_u32 m0, s46, 14336
    s_nop 0
    buffer_load_dwordx4 v6, s[4:7], s41 offen lds
    s_add_u32 s41, s45, 229760
    s_add_u32 m0, s46, 15360
    s_nop 0
    buffer_load_dwordx4 v7, s[4:7], s41 offen lds
    ds_read_b128 v[212:215], v9 offset:0
    ds_read_b128 v[216:219], v9 offset:4096
    s_waitcnt vmcnt(37)
    s_waitcnt lgkmcnt(2)
    v_mfma_f32_32x32x16_bf16 v[12:27], v[108:111], v[204:207], v[12:27]
    v_mfma_f32_32x32x16_bf16 v[28:43], v[108:111], v[208:211], v[28:43]
    v_mfma_f32_32x32x16_bf16 v[44:59], v[112:115], v[204:207], v[44:59]
    v_mfma_f32_32x32x16_bf16 v[60:75], v[112:115], v[208:211], v[60:75]
    v_mfma_f32_32x32x16_bf16 v[76:91], v[116:119], v[204:207], v[76:91]
    v_mfma_f32_32x32x16_bf16 v[92:107], v[116:119], v[208:211], v[92:107]
    s_add_u32 s41, s44, 49152
    buffer_load_dwordx4 v[108:111], v5, s[8:11], s41 offen offset:0
    buffer_load_dwordx4 v[112:115], v5, s[8:11], s41 offen offset:1024
    buffer_load_dwordx4 v[116:119], v5, s[8:11], s41 offen offset:2048
    ds_read_b128 v[204:207], v10 offset:0
    ds_read_b128 v[208:211], v10 offset:4096
    s_waitcnt vmcnt(37)
    s_waitcnt lgkmcnt(2)
    v_mfma_f32_32x32x16_bf16 v[12:27], v[120:123], v[212:215], v[12:27]
    v_mfma_f32_32x32x16_bf16 v[28:43], v[120:123], v[216:219], v[28:43]
    v_mfma_f32_32x32x16_bf16 v[44:59], v[124:127], v[212:215], v[44:59]
    v_mfma_f32_32x32x16_bf16 v[60:75], v[124:127], v[216:219], v[60:75]
    v_mfma_f32_32x32x16_bf16 v[76:91], v[128:131], v[212:215], v[76:91]
    v_mfma_f32_32x32x16_bf16 v[92:107], v[128:131], v[216:219], v[92:107]
    s_add_u32 s41, s44, 52224
    buffer_load_dwordx4 v[120:123], v5, s[8:11], s41 offen offset:0
    buffer_load_dwordx4 v[124:127], v5, s[8:11], s41 offen offset:1024
    buffer_load_dwordx4 v[128:131], v5, s[8:11], s41 offen offset:2048
    ds_read_b128 v[212:215], v11 offset:0
    ds_read_b128 v[216:219], v11 offset:4096
    s_waitcnt vmcnt(37)
    s_waitcnt lgkmcnt(2)
    v_mfma_f32_32x32x16_bf16 v[12:27], v[132:135], v[204:207], v[12:27]
    v_mfma_f32_32x32x16_bf16 v[28:43], v[132:135], v[208:211], v[28:43]
    v_mfma_f32_32x32x16_bf16 v[44:59], v[136:139], v[204:207], v[44:59]
    v_mfma_f32_32x32x16_bf16 v[60:75], v[136:139], v[208:211], v[60:75]
    v_mfma_f32_32x32x16_bf16 v[76:91], v[140:143], v[204:207], v[76:91]
    v_mfma_f32_32x32x16_bf16 v[92:107], v[140:143], v[208:211], v[92:107]
    s_add_u32 s41, s44, 55296
    buffer_load_dwordx4 v[132:135], v5, s[8:11], s41 offen offset:0
    buffer_load_dwordx4 v[136:139], v5, s[8:11], s41 offen offset:1024
    buffer_load_dwordx4 v[140:143], v5, s[8:11], s41 offen offset:2048
    s_waitcnt vmcnt(9)
    ds_read_b128 v[204:207], v8 offset:8192
    ds_read_b128 v[208:211], v8 offset:12288
    s_waitcnt vmcnt(37)
    s_waitcnt lgkmcnt(2)
    v_mfma_f32_32x32x16_bf16 v[12:27], v[144:147], v[212:215], v[12:27]
    v_mfma_f32_32x32x16_bf16 v[28:43], v[144:147], v[216:219], v[28:43]
    v_mfma_f32_32x32x16_bf16 v[44:59], v[148:151], v[212:215], v[44:59]
    v_mfma_f32_32x32x16_bf16 v[60:75], v[148:151], v[216:219], v[60:75]
    v_mfma_f32_32x32x16_bf16 v[76:91], v[152:155], v[212:215], v[76:91]
    v_mfma_f32_32x32x16_bf16 v[92:107], v[152:155], v[216:219], v[92:107]
    s_add_u32 s41, s44, 58368
    buffer_load_dwordx4 v[144:147], v5, s[8:11], s41 offen offset:0
    buffer_load_dwordx4 v[148:151], v5, s[8:11], s41 offen offset:1024
    buffer_load_dwordx4 v[152:155], v5, s[8:11], s41 offen offset:2048
    s_add_u32 s41, s45, 512
    s_add_u32 m0, s46, 0
    s_nop 0
    buffer_load_dwordx4 v6, s[4:7], s41 offen lds
    s_add_u32 s41, s45, 33280
    s_add_u32 m0, s46, 1024
    s_nop 0
    buffer_load_dwordx4 v7, s[4:7], s41 offen lds
    s_add_u32 s41, s45, 66048
    s_add_u32 m0, s46, 2048
    s_nop 0
    buffer_load_dwordx4 v6, s[4:7], s41 offen lds
    s_add_u32 s41, s45, 98816
    s_add_u32 m0, s46, 3072
    s_nop 0
    buffer_load_dwordx4 v7, s[4:7], s41 offen lds
    s_add_u32 s41, s45, 131584
    s_add_u32 m0, s46, 4096
    s_nop 0
    buffer_load_dwordx4 v6, s[4:7], s41 offen lds
    s_add_u32 s41, s45, 164352
    s_add_u32 m0, s46, 5120
    s_nop 0
    buffer_load_dwordx4 v7, s[4:7], s41 offen lds
    s_add_u32 s41, s45, 197120
    s_add_u32 m0, s46, 6144
    s_nop 0
    buffer_load_dwordx4 v6, s[4:7], s41 offen lds
    s_add_u32 s41, s45, 229888
    s_add_u32 m0, s46, 7168
    s_nop 0
    buffer_load_dwordx4 v7, s[4:7], s41 offen lds
    ds_read_b128 v[212:215], v9 offset:8192
    ds_read_b128 v[216:219], v9 offset:12288
    s_waitcnt vmcnt(37)
    s_waitcnt lgkmcnt(2)
    v_mfma_f32_32x32x16_bf16 v[12:27], v[156:159], v[204:207], v[12:27]
    v_mfma_f32_32x32x16_bf16 v[28:43], v[156:159], v[208:211], v[28:43]
    v_mfma_f32_32x32x16_bf16 v[44:59], v[160:163], v[204:207], v[44:59]
    v_mfma_f32_32x32x16_bf16 v[60:75], v[160:163], v[208:211], v[60:75]
    v_mfma_f32_32x32x16_bf16 v[76:91], v[164:167], v[204:207], v[76:91]
    v_mfma_f32_32x32x16_bf16 v[92:107], v[164:167], v[208:211], v[92:107]
    s_add_u32 s41, s44, 61440
    buffer_load_dwordx4 v[156:159], v5, s[8:11], s41 offen offset:0
    buffer_load_dwordx4 v[160:163], v5, s[8:11], s41 offen offset:1024
    buffer_load_dwordx4 v[164:167], v5, s[8:11], s41 offen offset:2048
    ds_read_b128 v[204:207], v10 offset:8192
    ds_read_b128 v[208:211], v10 offset:12288
    s_waitcnt vmcnt(37)
    s_waitcnt lgkmcnt(2)
    v_mfma_f32_32x32x16_bf16 v[12:27], v[168:171], v[212:215], v[12:27]
    v_mfma_f32_32x32x16_bf16 v[28:43], v[168:171], v[216:219], v[28:43]
    v_mfma_f32_32x32x16_bf16 v[44:59], v[172:175], v[212:215], v[44:59]
    v_mfma_f32_32x32x16_bf16 v[60:75], v[172:175], v[216:219], v[60:75]
    v_mfma_f32_32x32x16_bf16 v[76:91], v[176:179], v[212:215], v[76:91]
    v_mfma_f32_32x32x16_bf16 v[92:107], v[176:179], v[216:219], v[92:107]
    s_add_u32 s41, s44, 64512
    buffer_load_dwordx4 v[168:171], v5, s[8:11], s41 offen offset:0
    buffer_load_dwordx4 v[172:175], v5, s[8:11], s41 offen offset:1024
    buffer_load_dwordx4 v[176:179], v5, s[8:11], s41 offen offset:2048
    ds_read_b128 v[212:215], v11 offset:8192
    ds_read_b128 v[216:219], v11 offset:12288
    s_waitcnt vmcnt(37)
    s_waitcnt lgkmcnt(2)
    v_mfma_f32_32x32x16_bf16 v[12:27], v[180:183], v[204:207], v[12:27]
    v_mfma_f32_32x32x16_bf16 v[28:43], v[180:183], v[208:211], v[28:43]
    v_mfma_f32_32x32x16_bf16 v[44:59], v[184:187], v[204:207], v[44:59]
    v_mfma_f32_32x32x16_bf16 v[60:75], v[184:187], v[208:211], v[60:75]
    v_mfma_f32_32x32x16_bf16 v[76:91], v[188:191], v[204:207], v[76:91]
    v_mfma_f32_32x32x16_bf16 v[92:107], v[188:191], v[208:211], v[92:107]
    s_add_u32 s41, s44, 67584
    buffer_load_dwordx4 v[180:183], v5, s[8:11], s41 offen offset:0
    buffer_load_dwordx4 v[184:187], v5, s[8:11], s41 offen offset:1024
    buffer_load_dwordx4 v[188:191], v5, s[8:11], s41 offen offset:2048
    s_waitcnt vmcnt(9)
    ds_read_b128 v[204:207], v8 offset:0
    ds_read_b128 v[208:211], v8 offset:4096
    s_waitcnt vmcnt(37)
    s_waitcnt lgkmcnt(2)
    v_mfma_f32_32x32x16_bf16 v[12:27], v[192:195], v[212:215], v[12:27]
    v_mfma_f32_32x32x16_bf16 v[28:43], v[192:195], v[216:219], v[28:43]
    v_mfma_f32_32x32x16_bf16 v[44:59], v[196:199], v[212:215], v[44:59]
    v_mfma_f32_32x32x16_bf16 v[60:75], v[196:199], v[216:219], v[60:75]
    v_mfma_f32_32x32x16_bf16 v[76:91], v[200:203], v[212:215], v[76:91]
    v_mfma_f32_32x32x16_bf16 v[92:107], v[200:203], v[216:219], v[92:107]
    s_add_u32 s41, s44, 70656
    buffer_load_dwordx4 v[192:195], v5, s[8:11], s41 offen offset:0
    buffer_load_dwordx4 v[196:199], v5, s[8:11], s41 offen offset:1024
    buffer_load_dwordx4 v[200:203], v5, s[8:11], s41 offen offset:2048
    s_add_u32 s41, s45, 640
    s_add_u32 m0, s46, 8192
    s_nop 0
    buffer_load_dwordx4 v6, s[4:7], s41 offen lds
    s_add_u32 s41, s45, 33408
    s_add_u32 m0, s46, 9216
    s_nop 0
    buffer_load_dwordx4 v7, s[4:7], s41 offen lds
    s_add_u32 s41, s45, 66176
    s_add_u32 m0, s46, 10240
    s_nop 0
    buffer_load_dwordx4 v6, s[4:7], s41 offen lds
    s_add_u32 s41, s45, 98944
    s_add_u32 m0, s46, 11264
    s_nop 0
    buffer_load_dwordx4 v7, s[4:7], s41 offen lds
    s_add_u32 s41, s45, 131712
    s_add_u32 m0, s46, 12288
    s_nop 0
    buffer_load_dwordx4 v6, s[4:7], s41 offen lds
    s_add_u32 s41, s45, 164480
    s_add_u32 m0, s46, 13312
    s_nop 0
    buffer_load_dwordx4 v7, s[4:7], s41 offen lds
    s_add_u32 s41, s45, 197248
    s_add_u32 m0, s46, 14336
    s_nop 0
    buffer_load_dwordx4 v6, s[4:7], s41 offen lds
    s_add_u32 s41, s45, 230016
    s_add_u32 m0, s46, 15360
    s_nop 0
    buffer_load_dwordx4 v7, s[4:7], s41 offen lds
    ds_read_b128 v[212:215], v9 offset:0
    ds_read_b128 v[216:219], v9 offset:4096
    s_waitcnt vmcnt(37)
    s_waitcnt lgkmcnt(2)
    v_mfma_f32_32x32x16_bf16 v[12:27], v[108:111], v[204:207], v[12:27]
    v_mfma_f32_32x32x16_bf16 v[28:43], v[108:111], v[208:211], v[28:43]
    v_mfma_f32_32x32x16_bf16 v[44:59], v[112:115], v[204:207], v[44:59]
    v_mfma_f32_32x32x16_bf16 v[60:75], v[112:115], v[208:211], v[60:75]
    v_mfma_f32_32x32x16_bf16 v[76:91], v[116:119], v[204:207], v[76:91]
    v_mfma_f32_32x32x16_bf16 v[92:107], v[116:119], v[208:211], v[92:107]
    s_add_u32 s41, s44, 73728
    buffer_load_dwordx4 v[108:111], v5, s[8:11], s41 offen offset:0
    buffer_load_dwordx4 v[112:115], v5, s[8:11], s41 offen offset:1024
    buffer_load_dwordx4 v[116:119], v5, s[8:11], s41 offen offset:2048
    ds_read_b128 v[204:207], v10 offset:0
    ds_read_b128 v[208:211], v10 offset:4096
    s_waitcnt vmcnt(37)
    s_waitcnt lgkmcnt(2)
    v_mfma_f32_32x32x16_bf16 v[12:27], v[120:123], v[212:215], v[12:27]
    v_mfma_f32_32x32x16_bf16 v[28:43], v[120:123], v[216:219], v[28:43]
    v_mfma_f32_32x32x16_bf16 v[44:59], v[124:127], v[212:215], v[44:59]
    v_mfma_f32_32x32x16_bf16 v[60:75], v[124:127], v[216:219], v[60:75]
    v_mfma_f32_32x32x16_bf16 v[76:91], v[128:131], v[212:215], v[76:91]
    v_mfma_f32_32x32x16_bf16 v[92:107], v[128:131], v[216:219], v[92:107]
    s_add_u32 s41, s44, 76800
    buffer_load_dwordx4 v[120:123], v5, s[8:11], s41 offen offset:0
    buffer_load_dwordx4 v[124:127], v5, s[8:11], s41 offen offset:1024
    buffer_load_dwordx4 v[128:131], v5, s[8:11], s41 offen offset:2048
    ds_read_b128 v[212:215], v11 offset:0
    ds_read_b128 v[216:219], v11 offset:4096
    s_waitcnt vmcnt(37)
    s_waitcnt lgkmcnt(2)
    v_mfma_f32_32x32x16_bf16 v[12:27], v[132:135], v[204:207], v[12:27]
    v_mfma_f32_32x32x16_bf16 v[28:43], v[132:135], v[208:211], v[28:43]
    v_mfma_f32_32x32x16_bf16 v[44:59], v[136:139], v[204:207], v[44:59]
    v_mfma_f32_32x32x16_bf16 v[60:75], v[136:139], v[208:211], v[60:75]
    v_mfma_f32_32x32x16_bf16 v[76:91], v[140:143], v[204:207], v[76:91]
    v_mfma_f32_32x32x16_bf16 v[92:107], v[140:143], v[208:211], v[92:107]
    s_add_u32 s41, s44, 79872
    buffer_load_dwordx4 v[132:135], v5, s[8:11], s41 offen offset:0
    buffer_load_dwordx4 v[136:139], v5, s[8:11], s41 offen offset:1024
    buffer_load_dwordx4 v[140:143], v5, s[8:11], s41 offen offset:2048
    s_waitcnt vmcnt(9)
    ds_read_b128 v[204:207], v8 offset:8192
    ds_read_b128 v[208:211], v8 offset:12288
    s_waitcnt vmcnt(37)
    s_waitcnt lgkmcnt(2)
    v_mfma_f32_32x32x16_bf16 v[12:27], v[144:147], v[212:215], v[12:27]
    v_mfma_f32_32x32x16_bf16 v[28:43], v[144:147], v[216:219], v[28:43]
    v_mfma_f32_32x32x16_bf16 v[44:59], v[148:151], v[212:215], v[44:59]
    v_mfma_f32_32x32x16_bf16 v[60:75], v[148:151], v[216:219], v[60:75]
    v_mfma_f32_32x32x16_bf16 v[76:91], v[152:155], v[212:215], v[76:91]
    v_mfma_f32_32x32x16_bf16 v[92:107], v[152:155], v[216:219], v[92:107]
    s_add_u32 s41, s44, 82944
    buffer_load_dwordx4 v[144:147], v5, s[8:11], s41 offen offset:0
    buffer_load_dwordx4 v[148:151], v5, s[8:11], s41 offen offset:1024
    buffer_load_dwordx4 v[152:155], v5, s[8:11], s41 offen offset:2048
    s_add_u32 s41, s45, 768
    s_add_u32 m0, s46, 0
    s_nop 0
    buffer_load_dwordx4 v6, s[4:7], s41 offen lds
    s_add_u32 s41, s45, 33536
    s_add_u32 m0, s46, 1024
    s_nop 0
    buffer_load_dwordx4 v7, s[4:7], s41 offen lds
    s_add_u32 s41, s45, 66304
    s_add_u32 m0, s46, 2048
    s_nop 0
    buffer_load_dwordx4 v6, s[4:7], s41 offen lds
    s_add_u32 s41, s45, 99072
    s_add_u32 m0, s46, 3072
    s_nop 0
    buffer_load_dwordx4 v7, s[4:7], s41 offen lds
    s_add_u32 s41, s45, 131840
    s_add_u32 m0, s46, 4096
    s_nop 0
    buffer_load_dwordx4 v6, s[4:7], s41 offen lds
    s_add_u32 s41, s45, 164608
    s_add_u32 m0, s46, 5120
    s_nop 0
    buffer_load_dwordx4 v7, s[4:7], s41 offen lds
    s_add_u32 s41, s45, 197376
    s_add_u32 m0, s46, 6144
    s_nop 0
    buffer_load_dwordx4 v6, s[4:7], s41 offen lds
    s_add_u32 s41, s45, 230144
    s_add_u32 m0, s46, 7168
    s_nop 0
    buffer_load_dwordx4 v7, s[4:7], s41 offen lds
    ds_read_b128 v[212:215], v9 offset:8192
    ds_read_b128 v[216:219], v9 offset:12288
    s_waitcnt vmcnt(37)
    s_waitcnt lgkmcnt(2)
    v_mfma_f32_32x32x16_bf16 v[12:27], v[156:159], v[204:207], v[12:27]
    v_mfma_f32_32x32x16_bf16 v[28:43], v[156:159], v[208:211], v[28:43]
    v_mfma_f32_32x32x16_bf16 v[44:59], v[160:163], v[204:207], v[44:59]
    v_mfma_f32_32x32x16_bf16 v[60:75], v[160:163], v[208:211], v[60:75]
    v_mfma_f32_32x32x16_bf16 v[76:91], v[164:167], v[204:207], v[76:91]
    v_mfma_f32_32x32x16_bf16 v[92:107], v[164:167], v[208:211], v[92:107]
    s_add_u32 s41, s44, 86016
    buffer_load_dwordx4 v[156:159], v5, s[8:11], s41 offen offset:0
    buffer_load_dwordx4 v[160:163], v5, s[8:11], s41 offen offset:1024
    buffer_load_dwordx4 v[164:167], v5, s[8:11], s41 offen offset:2048
    ds_read_b128 v[204:207], v10 offset:8192
    ds_read_b128 v[208:211], v10 offset:12288
    s_waitcnt vmcnt(37)
    s_waitcnt lgkmcnt(2)
    v_mfma_f32_32x32x16_bf16 v[12:27], v[168:171], v[212:215], v[12:27]
    v_mfma_f32_32x32x16_bf16 v[28:43], v[168:171], v[216:219], v[28:43]
    v_mfma_f32_32x32x16_bf16 v[44:59], v[172:175], v[212:215], v[44:59]
    v_mfma_f32_32x32x16_bf16 v[60:75], v[172:175], v[216:219], v[60:75]
    v_mfma_f32_32x32x16_bf16 v[76:91], v[176:179], v[212:215], v[76:91]
    v_mfma_f32_32x32x16_bf16 v[92:107], v[176:179], v[216:219], v[92:107]
    s_add_u32 s41, s44, 89088
    buffer_load_dwordx4 v[168:171], v5, s[8:11], s41 offen offset:0
    buffer_load_dwordx4 v[172:175], v5, s[8:11], s41 offen offset:1024
    buffer_load_dwordx4 v[176:179], v5, s[8:11], s41 offen offset:2048
    ds_read_b128 v[212:215], v11 offset:8192
    ds_read_b128 v[216:219], v11 offset:12288
    s_waitcnt vmcnt(37)
    s_waitcnt lgkmcnt(2)
    v_mfma_f32_32x32x16_bf16 v[12:27], v[180:183], v[204:207], v[12:27]
    v_mfma_f32_32x32x16_bf16 v[28:43], v[180:183], v[208:211], v[28:43]
    v_mfma_f32_32x32x16_bf16 v[44:59], v[184:187], v[204:207], v[44:59]
    v_mfma_f32_32x32x16_bf16 v[60:75], v[184:187], v[208:211], v[60:75]
    v_mfma_f32_32x32x16_bf16 v[76:91], v[188:191], v[204:207], v[76:91]
    v_mfma_f32_32x32x16_bf16 v[92:107], v[188:191], v[208:211], v[92:107]
    s_add_u32 s41, s44, 92160
    buffer_load_dwordx4 v[180:183], v5, s[8:11], s41 offen offset:0
    buffer_load_dwordx4 v[184:187], v5, s[8:11], s41 offen offset:1024
    buffer_load_dwordx4 v[188:191], v5, s[8:11], s41 offen offset:2048
    s_waitcnt vmcnt(9)
    ds_read_b128 v[204:207], v8 offset:0
    ds_read_b128 v[208:211], v8 offset:4096
    s_waitcnt vmcnt(37)
    s_waitcnt lgkmcnt(2)
    v_mfma_f32_32x32x16_bf16 v[12:27], v[192:195], v[212:215], v[12:27]
    v_mfma_f32_32x32x16_bf16 v[28:43], v[192:195], v[216:219], v[28:43]
    v_mfma_f32_32x32x16_bf16 v[44:59], v[196:199], v[212:215], v[44:59]
    v_mfma_f32_32x32x16_bf16 v[60:75], v[196:199], v[216:219], v[60:75]
    v_mfma_f32_32x32x16_bf16 v[76:91], v[200:203], v[212:215], v[76:91]
    v_mfma_f32_32x32x16_bf16 v[92:107], v[200:203], v[216:219], v[92:107]
    s_add_u32 s41, s44, 95232
    buffer_load_dwordx4 v[192:195], v5, s[8:11], s41 offen offset:0
    buffer_load_dwordx4 v[196:199], v5, s[8:11], s41 offen offset:1024
    buffer_load_dwordx4 v[200:203], v5, s[8:11], s41 offen offset:2048
    s_add_u32 s41, s45, 896
    s_add_u32 m0, s46, 8192
    s_nop 0
    buffer_load_dwordx4 v6, s[4:7], s41 offen lds
    s_add_u32 s41, s45, 33664
    s_add_u32 m0, s46, 9216
    s_nop 0
    buffer_load_dwordx4 v7, s[4:7], s41 offen lds
    s_add_u32 s41, s45, 66432
    s_add_u32 m0, s46, 10240
    s_nop 0
    buffer_load_dwordx4 v6, s[4:7], s41 offen lds
    s_add_u32 s41, s45, 99200
    s_add_u32 m0, s46, 11264
    s_nop 0
    buffer_load_dwordx4 v7, s[4:7], s41 offen lds
    s_add_u32 s41, s45, 131968
    s_add_u32 m0, s46, 12288
    s_nop 0
    buffer_load_dwordx4 v6, s[4:7], s41 offen lds
    s_add_u32 s41, s45, 164736
    s_add_u32 m0, s46, 13312
    s_nop 0
    buffer_load_dwordx4 v7, s[4:7], s41 offen lds
    s_add_u32 s41, s45, 197504
    s_add_u32 m0, s46, 14336
    s_nop 0
    buffer_load_dwordx4 v6, s[4:7], s41 offen lds
    s_add_u32 s41, s45, 230272
    s_add_u32 m0, s46, 15360
    s_nop 0
    buffer_load_dwordx4 v7, s[4:7], s41 offen lds
    ds_read_b128 v[212:215], v9 offset:0
    ds_read_b128 v[216:219], v9 offset:4096
    s_waitcnt vmcnt(37)
    s_waitcnt lgkmcnt(2)
    v_mfma_f32_32x32x16_bf16 v[12:27], v[108:111], v[204:207], v[12:27]
    v_mfma_f32_32x32x16_bf16 v[28:43], v[108:111], v[208:211], v[28:43]
    v_mfma_f32_32x32x16_bf16 v[44:59], v[112:115], v[204:207], v[44:59]
    v_mfma_f32_32x32x16_bf16 v[60:75], v[112:115], v[208:211], v[60:75]
    v_mfma_f32_32x32x16_bf16 v[76:91], v[116:119], v[204:207], v[76:91]
    v_mfma_f32_32x32x16_bf16 v[92:107], v[116:119], v[208:211], v[92:107]
    ds_read_b128 v[204:207], v10 offset:0
    ds_read_b128 v[208:211], v10 offset:4096
    s_waitcnt vmcnt(34)
    s_waitcnt lgkmcnt(2)
    v_mfma_f32_32x32x16_bf16 v[12:27], v[120:123], v[212:215], v[12:27]
    v_mfma_f32_32x32x16_bf16 v[28:43], v[120:123], v[216:219], v[28:43]
    v_mfma_f32_32x32x16_bf16 v[44:59], v[124:127], v[212:215], v[44:59]
    v_mfma_f32_32x32x16_bf16 v[60:75], v[124:127], v[216:219], v[60:75]
    v_mfma_f32_32x32x16_bf16 v[76:91], v[128:131], v[212:215], v[76:91]
    v_mfma_f32_32x32x16_bf16 v[92:107], v[128:131], v[216:219], v[92:107]
    ds_read_b128 v[212:215], v11 offset:0
    ds_read_b128 v[216:219], v11 offset:4096
    s_waitcnt vmcnt(31)
    s_waitcnt lgkmcnt(2)
    v_mfma_f32_32x32x16_bf16 v[12:27], v[132:135], v[204:207], v[12:27]
    v_mfma_f32_32x32x16_bf16 v[28:43], v[132:135], v[208:211], v[28:43]
    v_mfma_f32_32x32x16_bf16 v[44:59], v[136:139], v[204:207], v[44:59]
    v_mfma_f32_32x32x16_bf16 v[60:75], v[136:139], v[208:211], v[60:75]
    v_mfma_f32_32x32x16_bf16 v[76:91], v[140:143], v[204:207], v[76:91]
    v_mfma_f32_32x32x16_bf16 v[92:107], v[140:143], v[208:211], v[92:107]
    s_waitcnt vmcnt(0)
    ds_read_b128 v[204:207], v8 offset:8192
    ds_read_b128 v[208:211], v8 offset:12288
    s_waitcnt vmcnt(28)
    s_waitcnt lgkmcnt(2)
    v_mfma_f32_32x32x16_bf16 v[12:27], v[144:147], v[212:215], v[12:27]
    v_mfma_f32_32x32x16_bf16 v[28:43], v[144:147], v[216:219], v[28:43]
    v_mfma_f32_32x32x16_bf16 v[44:59], v[148:151], v[212:215], v[44:59]
    v_mfma_f32_32x32x16_bf16 v[60:75], v[148:151], v[216:219], v[60:75]
    v_mfma_f32_32x32x16_bf16 v[76:91], v[152:155], v[212:215], v[76:91]
    v_mfma_f32_32x32x16_bf16 v[92:107], v[152:155], v[216:219], v[92:107]
    ds_read_b128 v[212:215], v9 offset:8192
    ds_read_b128 v[216:219], v9 offset:12288
    s_waitcnt vmcnt(17)
    s_waitcnt lgkmcnt(2)
    v_mfma_f32_32x32x16_bf16 v[12:27], v[156:159], v[204:207], v[12:27]
    v_mfma_f32_32x32x16_bf16 v[28:43], v[156:159], v[208:211], v[28:43]
    v_mfma_f32_32x32x16_bf16 v[44:59], v[160:163], v[204:207], v[44:59]
    v_mfma_f32_32x32x16_bf16 v[60:75], v[160:163], v[208:211], v[60:75]
    v_mfma_f32_32x32x16_bf16 v[76:91], v[164:167], v[204:207], v[76:91]
    v_mfma_f32_32x32x16_bf16 v[92:107], v[164:167], v[208:211], v[92:107]
    ds_read_b128 v[204:207], v10 offset:8192
    ds_read_b128 v[208:211], v10 offset:12288
    s_waitcnt vmcnt(14)
    s_waitcnt lgkmcnt(2)
    v_mfma_f32_32x32x16_bf16 v[12:27], v[168:171], v[212:215], v[12:27]
    v_mfma_f32_32x32x16_bf16 v[28:43], v[168:171], v[216:219], v[28:43]
    v_mfma_f32_32x32x16_bf16 v[44:59], v[172:175], v[212:215], v[44:59]
    v_mfma_f32_32x32x16_bf16 v[60:75], v[172:175], v[216:219], v[60:75]
    v_mfma_f32_32x32x16_bf16 v[76:91], v[176:179], v[212:215], v[76:91]
    v_mfma_f32_32x32x16_bf16 v[92:107], v[176:179], v[216:219], v[92:107]
    ds_read_b128 v[212:215], v11 offset:8192
    ds_read_b128 v[216:219], v11 offset:12288
    s_waitcnt vmcnt(11)
    s_waitcnt lgkmcnt(2)
    v_mfma_f32_32x32x16_bf16 v[12:27], v[180:183], v[204:207], v[12:27]
    v_mfma_f32_32x32x16_bf16 v[28:43], v[180:183], v[208:211], v[28:43]
    v_mfma_f32_32x32x16_bf16 v[44:59], v[184:187], v[204:207], v[44:59]
    v_mfma_f32_32x32x16_bf16 v[60:75], v[184:187], v[208:211], v[60:75]
    v_mfma_f32_32x32x16_bf16 v[76:91], v[188:191], v[204:207], v[76:91]
    v_mfma_f32_32x32x16_bf16 v[92:107], v[188:191], v[208:211], v[92:107]
    s_waitcnt vmcnt(8)
    s_waitcnt lgkmcnt(0)
    v_mfma_f32_32x32x16_bf16 v[12:27], v[192:195], v[212:215], v[12:27]
    v_mfma_f32_32x32x16_bf16 v[28:43], v[192:195], v[216:219], v[28:43]
    v_mfma_f32_32x32x16_bf16 v[44:59], v[196:199], v[212:215], v[44:59]
    v_mfma_f32_32x32x16_bf16 v[60:75], v[196:199], v[216:219], v[60:75]
    v_mfma_f32_32x32x16_bf16 v[76:91], v[200:203], v[212:215], v[76:91]
    v_mfma_f32_32x32x16_bf16 v[92:107], v[200:203], v[216:219], v[92:107]
    s_barrier
    s_mul_i32 s40, s34, 18432
    v_add_u32 v2, s40, v5
    s_sub_u32 s41, 3, s34
    s_and_b32 s41, s41, 3
    s_mul_i32 s42, s41, 6144
    s_add_u32 s42, s42, s40
    s_cmp_eq_u32 s41, 3
    s_cselect_b32 s42, 73728, s42
    v_add_u32 v233, s42, v5
    s_sub_u32 s41, 4, s34
    s_and_b32 s41, s41, 3
    s_mul_i32 s42, s41, 6144
    s_add_u32 s42, s42, s40
    s_cmp_eq_u32 s41, 3
    s_cselect_b32 s42, 73728, s42
    v_add_u32 v234, s42, v5
    s_sub_u32 s41, 5, s34
    s_and_b32 s41, s41, 3
    s_mul_i32 s42, s41, 6144
    s_add_u32 s42, s42, s40
    s_cmp_eq_u32 s41, 3
    s_cselect_b32 s42, 73728, s42
    v_add_u32 v235, s42, v5
    s_sub_u32 s41, 6, s34
    s_and_b32 s41, s41, 3
    s_mul_i32 s42, s41, 6144
    s_add_u32 s42, s42, s40
    s_cmp_eq_u32 s41, 3
    s_cselect_b32 s42, 73728, s42
    v_add_u32 v236, s42, v5
    ds_write_b128 v233, v[12:15] offset:0
    ds_write_b128 v233, v[20:23] offset:1024
    ds_write_b128 v233, v[44:47] offset:2048
    ds_write_b128 v233, v[52:55] offset:3072
    ds_write_b128 v233, v[76:79] offset:4096
    ds_write_b128 v233, v[84:87] offset:5120
    ds_write_b128 v234, v[16:19] offset:0
    ds_write_b128 v234, v[24:27] offset:1024
    ds_write_b128 v234, v[48:51] offset:2048
    ds_write_b128 v234, v[56:59] offset:3072
    ds_write_b128 v234, v[80:83] offset:4096
    ds_write_b128 v234, v[88:91] offset:5120
    ds_write_b128 v235, v[28:31] offset:0
    ds_write_b128 v235, v[36:39] offset:1024
    ds_write_b128 v235, v[60:63] offset:2048
    ds_write_b128 v235, v[68:71] offset:3072
    ds_write_b128 v235, v[92:95] offset:4096
    ds_write_b128 v235, v[100:103] offset:5120
    ds_write_b128 v236, v[32:35] offset:0
    ds_write_b128 v236, v[40:43] offset:1024
    ds_write_b128 v236, v[64:67] offset:2048
    ds_write_b128 v236, v[72:75] offset:3072
    ds_write_b128 v236, v[96:99] offset:4096
    ds_write_b128 v236, v[104:107] offset:5120
    s_waitcnt lgkmcnt(0)
    s_barrier
    s_cmp_lg_u32 s34, 0
    s_cbranch_scc1 g_own_1
    v_mov_b32 v108, v12
    v_mov_b32 v109, v13
    v_mov_b32 v110, v14
    v_mov_b32 v111, v15
    v_mov_b32 v112, v20
    v_mov_b32 v113, v21
    v_mov_b32 v114, v22
    v_mov_b32 v115, v23
    v_mov_b32 v116, v44
    v_mov_b32 v117, v45
    v_mov_b32 v118, v46
    v_mov_b32 v119, v47
    v_mov_b32 v120, v52
    v_mov_b32 v121, v53
    v_mov_b32 v122, v54
    v_mov_b32 v123, v55
    v_mov_b32 v124, v76
    v_mov_b32 v125, v77
    v_mov_b32 v126, v78
    v_mov_b32 v127, v79
    v_mov_b32 v128, v84
    v_mov_b32 v129, v85
    v_mov_b32 v130, v86
    v_mov_b32 v131, v87
    s_branch g_ownend_5
g_own_1:
    s_cmp_lg_u32 s34, 1
    s_cbranch_scc1 g_own_2
    v_mov_b32 v108, v16
    v_mov_b32 v109, v17
    v_mov_b32 v110, v18
    v_mov_b32 v111, v19
    v_mov_b32 v112, v24
    v_mov_b32 v113, v25
    v_mov_b32 v114, v26
    v_mov_b32 v115, v27
    v_mov_b32 v116, v48
    v_mov_b32 v117, v49
    v_mov_b32 v118, v50
    v_mov_b32 v119, v51
    v_mov_b32 v120, v56
    v_mov_b32 v121, v57
    v_mov_b32 v122, v58
    v_mov_b32 v123, v59
    v_mov_b32 v124, v80
    v_mov_b32 v125, v81
    v_mov_b32 v126, v82
    v_mov_b32 v127, v83
    v_mov_b32 v128, v88
    v_mov_b32 v129, v89
    v_mov_b32 v130, v90
    v_mov_b32 v131, v91
    s_branch g_ownend_5
g_own_2:
    s_cmp_lg_u32 s34, 2
    s_cbranch_scc1 g_own_3
    v_mov_b32 v108, v28
    v_mov_b32 v109, v29
    v_mov_b32 v110, v30
    v_mov_b32 v111, v31
    v_mov_b32 v112, v36
    v_mov_b32 v113, v37
    v_mov_b32 v114, v38
    v_mov_b32 v115, v39
    v_mov_b32 v116, v60
    v_mov_b32 v117, v61
    v_mov_b32 v118, v62
    v_mov_b32 v119, v63
    v_mov_b32 v120, v68
    v_mov_b32 v121, v69
    v_mov_b32 v122, v70
    v_mov_b32 v123, v71
    v_mov_b32 v124, v92
    v_mov_b32 v125, v93
    v_mov_b32 v126, v94
    v_mov_b32 v127, v95
    v_mov_b32 v128, v100
    v_mov_b32 v129, v101
    v_mov_b32 v130, v102
    v_mov_b32 v131, v103
    s_branch g_ownend_5
g_own_3:
    v_mov_b32 v108, v32
    v_mov_b32 v109, v33
    v_mov_b32 v110, v34
    v_mov_b32 v111, v35
    v_mov_b32 v112, v40
    v_mov_b32 v113, v41
    v_mov_b32 v114, v42
    v_mov_b32 v115, v43
    v_mov_b32 v116, v64
    v_mov_b32 v117, v65
    v_mov_b32 v118, v66
    v_mov_b32 v119, v67
    v_mov_b32 v120, v72
    v_mov_b32 v121, v73
    v_mov_b32 v122, v74
    v_mov_b32 v123, v75
    v_mov_b32 v124, v96
    v_mov_b32 v125, v97
    v_mov_b32 v126, v98
    v_mov_b32 v127, v99
    v_mov_b32 v128, v104
    v_mov_b32 v129, v105
    v_mov_b32 v130, v106
    v_mov_b32 v131, v107
g_ownend_5:
    s_add_u32 s41, s34, 1
    s_and_b32 s41, s41, 3
    s_mul_i32 s42, s41, 18432
    s_add_u32 s42, s42, 12288
    v_add_u32 v2, s42, v5
    ds_read_b128 v[12:15], v2 offset:0
    ds_read_b128 v[16:19], v2 offset:1024
    ds_read_b128 v[20:23], v2 offset:2048
    ds_read_b128 v[24:27], v2 offset:3072
    ds_read_b128 v[28:31], v2 offset:4096
    ds_read_b128 v[32:35], v2 offset:5120
    s_add_u32 s41, s34, 2
    s_and_b32 s41, s41, 3
    s_mul_i32 s42, s41, 18432
    s_add_u32 s42, s42, 6144
    v_add_u32 v2, s42, v5
    ds_read_b128 v[36:39], v2 offset:0
    ds_read_b128 v[40:43], v2 offset:1024
    ds_read_b128 v[44:47], v2 offset:2048
    ds_read_b128 v[48:51], v2 offset:3072
    ds_read_b128 v[52:55], v2 offset:4096
    ds_read_b128 v[56:59], v2 offset:5120
    s_add_u32 s41, s34, 3
    s_and_b32 s41, s41, 3
    s_mul_i32 s42, s41, 18432
    s_add_u32 s42, s42, 0
    v_add_u32 v2, s42, v5
    ds_read_b128 v[60:63], v2 offset:0
    ds_read_b128 v[64:67], v2 offset:1024
    ds_read_b128 v[68:71], v2 offset:2048
    ds_read_b128 v[72:75], v2 offset:3072
    ds_read_b128 v[76:79], v2 offset:4096
    ds_read_b128 v[80:83], v2 offset:5120
    s_waitcnt vmcnt(63)
    v_lshlrev_b32 v232, 16, v232
    s_waitcnt lgkmcnt(0)
    v_pk_add_f32 v[108:109], v[108:109], v[12:13]
    v_pk_add_f32 v[110:111], v[110:111], v[14:15]
    v_pk_add_f32 v[112:113], v[112:113], v[16:17]
    v_pk_add_f32 v[114:115], v[114:115], v[18:19]
    v_pk_add_f32 v[116:117], v[116:117], v[20:21]
    v_pk_add_f32 v[118:119], v[118:119], v[22:23]
    v_pk_add_f32 v[120:121], v[120:121], v[24:25]
    v_pk_add_f32 v[122:123], v[122:123], v[26:27]
    v_pk_add_f32 v[124:125], v[124:125], v[28:29]
    v_pk_add_f32 v[126:127], v[126:127], v[30:31]
    v_pk_add_f32 v[128:129], v[128:129], v[32:33]
    v_pk_add_f32 v[130:131], v[130:131], v[34:35]
    v_pk_add_f32 v[108:109], v[108:109], v[36:37]
    v_pk_add_f32 v[110:111], v[110:111], v[38:39]
    v_pk_add_f32 v[112:113], v[112:113], v[40:41]
    v_pk_add_f32 v[114:115], v[114:115], v[42:43]
    v_pk_add_f32 v[116:117], v[116:117], v[44:45]
    v_pk_add_f32 v[118:119], v[118:119], v[46:47]
    v_pk_add_f32 v[120:121], v[120:121], v[48:49]
    v_pk_add_f32 v[122:123], v[122:123], v[50:51]
    v_pk_add_f32 v[124:125], v[124:125], v[52:53]
    v_pk_add_f32 v[126:127], v[126:127], v[54:55]
    v_pk_add_f32 v[128:129], v[128:129], v[56:57]
    v_pk_add_f32 v[130:131], v[130:131], v[58:59]
    v_pk_add_f32 v[108:109], v[108:109], v[60:61]
    v_pk_add_f32 v[110:111], v[110:111], v[62:63]
    v_pk_add_f32 v[112:113], v[112:113], v[64:65]
    v_pk_add_f32 v[114:115], v[114:115], v[66:67]
    v_pk_add_f32 v[116:117], v[116:117], v[68:69]
    v_pk_add_f32 v[118:119], v[118:119], v[70:71]
    v_pk_add_f32 v[120:121], v[120:121], v[72:73]
    v_pk_add_f32 v[122:123], v[122:123], v[74:75]
    v_pk_add_f32 v[124:125], v[124:125], v[76:77]
    v_pk_add_f32 v[126:127], v[126:127], v[78:79]
    v_pk_add_f32 v[128:129], v[128:129], v[80:81]
    v_pk_add_f32 v[130:131], v[130:131], v[82:83]
    v_add_f32 v108, v108, v232
    v_add_f32 v109, v109, v232
    v_lshlrev_b32 v3, 16, v220
    v_and_b32 v4, 0xffff0000, v220
    v_mul_f32 v108, v108, v3
    v_mul_f32 v109, v109, v4
    v_cvt_pk_bf16_f32 v12, v108, v109
    v_add_f32 v110, v110, v232
    v_add_f32 v111, v111, v232
    v_lshlrev_b32 v3, 16, v221
    v_and_b32 v4, 0xffff0000, v221
    v_mul_f32 v110, v110, v3
    v_mul_f32 v111, v111, v4
    v_cvt_pk_bf16_f32 v13, v110, v111
    v_add_f32 v112, v112, v232
    v_add_f32 v113, v113, v232
    v_lshlrev_b32 v3, 16, v222
    v_and_b32 v4, 0xffff0000, v222
    v_mul_f32 v112, v112, v3
    v_mul_f32 v113, v113, v4
    v_cvt_pk_bf16_f32 v14, v112, v113
    v_add_f32 v114, v114, v232
    v_add_f32 v115, v115, v232
    v_lshlrev_b32 v3, 16, v223
    v_and_b32 v4, 0xffff0000, v223
    v_mul_f32 v114, v114, v3
    v_mul_f32 v115, v115, v4
    v_cvt_pk_bf16_f32 v15, v114, v115
    v_add_f32 v116, v116, v232
    v_add_f32 v117, v117, v232
    v_lshlrev_b32 v3, 16, v224
    v_and_b32 v4, 0xffff0000, v224
    v_mul_f32 v116, v116, v3
    v_mul_f32 v117, v117, v4
    v_cvt_pk_bf16_f32 v16, v116, v117
    v_add_f32 v118, v118, v232
    v_add_f32 v119, v119, v232
    v_lshlrev_b32 v3, 16, v225
    v_and_b32 v4, 0xffff0000, v225
    v_mul_f32 v118, v118, v3
    v_mul_f32 v119, v119, v4
    v_cvt_pk_bf16_f32 v17, v118, v119
    v_add_f32 v120, v120, v232
    v_add_f32 v121, v121, v232
    v_lshlrev_b32 v3, 16, v226
    v_and_b32 v4, 0xffff0000, v226
    v_mul_f32 v120, v120, v3
    v_mul_f32 v121, v121, v4
    v_cvt_pk_bf16_f32 v18, v120, v121
    v_add_f32 v122, v122, v232
    v_add_f32 v123, v123, v232
    v_lshlrev_b32 v3, 16, v227
    v_and_b32 v4, 0xffff0000, v227
    v_mul_f32 v122, v122, v3
    v_mul_f32 v123, v123, v4
    v_cvt_pk_bf16_f32 v19, v122, v123
    v_add_f32 v124, v124, v232
    v_add_f32 v125, v125, v232
    v_lshlrev_b32 v3, 16, v228
    v_and_b32 v4, 0xffff0000, v228
    v_mul_f32 v124, v124, v3
    v_mul_f32 v125, v125, v4
    v_cvt_pk_bf16_f32 v20, v124, v125
    v_add_f32 v126, v126, v232
    v_add_f32 v127, v127, v232
    v_lshlrev_b32 v3, 16, v229
    v_and_b32 v4, 0xffff0000, v229
    v_mul_f32 v126, v126, v3
    v_mul_f32 v127, v127, v4
    v_cvt_pk_bf16_f32 v21, v126, v127
    v_add_f32 v128, v128, v232
    v_add_f32 v129, v129, v232
    v_lshlrev_b32 v3, 16, v230
    v_and_b32 v4, 0xffff0000, v230
    v_mul_f32 v128, v128, v3
    v_mul_f32 v129, v129, v4
    v_cvt_pk_bf16_f32 v22, v128, v129
    v_add_f32 v130, v130, v232
    v_add_f32 v131, v131, v232
    v_lshlrev_b32 v3, 16, v231
    v_and_b32 v4, 0xffff0000, v231
    v_mul_f32 v130, v130, v3
    v_mul_f32 v131, v131, v4
    v_cvt_pk_bf16_f32 v23, v130, v131
    v_lshrrev_b32 v2, 4, v1
    v_and_b32 v2, 1, v2
    v_mul_u32_u24 v2, 24576, v2
    v_and_b32 v3, 15, v1
    v_lshrrev_b32 v4, 5, v1
    v_lshlrev_b32 v4, 4, v4
    v_add_u32 v3, v3, v4
    v_lshlrev_b32 v3, 4, v3
    v_add_u32 v2, v2, v3
    s_mul_i32 s40, s32, 98304
    s_lshr_b32 s41, s34, 1
    s_mul_i32 s41, s41, 49152
    s_add_u32 s40, s40, s41
    s_mul_i32 s41, s33, 3072
    s_add_u32 s40, s40, s41
    s_and_b32 s41, s34, 1
    s_lshl_b32 s41, s41, 9
    s_add_u32 s40, s40, s41
    s_add_u32 s40, s40, 11534336
    buffer_store_dwordx4 v[12:15], v2, s[8:11], s40 offen offset:0
    buffer_store_dwordx4 v[16:19], v2, s[8:11], s40 offen offset:1024
    buffer_store_dwordx4 v[20:23], v2, s[8:11], s40 offen offset:2048
    s_endpgm
k2_kernel_conv:
    s_load_dwordx2 s[4:5], s[0:1], 32
    s_load_dwordx2 s[8:9], s[0:1], 104
    s_load_dwordx2 s[12:13], s[0:1], 40
    s_mov_b32 s6, 2621440
    s_mov_b32 s7, 0x20000
    s_mov_b32 s10, 15007744
    s_mov_b32 s11, 0x20000
    s_mov_b32 s14, 1280
    s_mov_b32 s15, 0x20000
    v_lshrrev_b32 v3, 6, v0
    v_and_b32 v1, 63, v0
    v_readfirstlane_b32 s34, v3
    s_sub_u32 s32, s2, 256
    v_lshlrev_b32 v2, 4, v0
    v_subrev_u32 v47, 16, v2
    s_waitcnt lgkmcnt(0)
    s_add_u32 s35, s32, 0
    s_min_u32 s35, s35, 639
    s_lshl_b32 s40, s35, 12
    buffer_load_dwordx4 v[12:15], v2, s[4:7], s40 offen
    buffer_load_dwordx4 v[8:11], v47, s[4:7], s40 offen
    s_add_u32 s40, s40, 6291456
    buffer_load_dwordx4 v[32:35], v2, s[8:11], s40 offen
    s_lshl_b32 s40, s35, 1
    v_mov_b32 v3, 0
    buffer_load_ushort v44, v3, s[12:15], s40 offen
    s_add_u32 s35, s32, 256
    s_min_u32 s35, s35, 639
    s_lshl_b32 s40, s35, 12
    buffer_load_dwordx4 v[20:23], v2, s[4:7], s40 offen
    buffer_load_dwordx4 v[16:19], v47, s[4:7], s40 offen
    s_add_u32 s40, s40, 6291456
    buffer_load_dwordx4 v[36:39], v2, s[8:11], s40 offen
    s_lshl_b32 s40, s35, 1
    v_mov_b32 v3, 0
    buffer_load_ushort v45, v3, s[12:15], s40 offen
    s_add_u32 s35, s32, 512
    s_min_u32 s35, s35, 639
    s_lshl_b32 s40, s35, 12
    buffer_load_dwordx4 v[28:31], v2, s[4:7], s40 offen
    buffer_load_dwordx4 v[24:27], v47, s[4:7], s40 offen
    s_add_u32 s40, s40, 6291456
    buffer_load_dwordx4 v[40:43], v2, s[8:11], s40 offen
    s_lshl_b32 s40, s35, 1
    v_mov_b32 v3, 0
    buffer_load_ushort v46, v3, s[12:15], s40 offen
    v_mov_b32 v48, 0
    v_mov_b32 v49, 0
    v_mov_b32 v50, 0
    v_mov_b32 v51, 0
    v_lshrrev_b32 v3, 3, v0
    v_mul_u32_u24 v3, 4416, v3
    v_and_b32 v4, 7, v0
    v_lshlrev_b32 v4, 4, v4
    v_add_u32 v3, v3, v4
    v_cmp_gt_u32 vcc, 64, v0
    s_nop 0
    s_and_saveexec_b64 s[50:51], vcc
    s_cbranch_execz c_z_6
    ds_write_b128 v3, v[48:51] offset:0
    v_cmp_gt_u32 vcc, 8, v0
    s_nop 0
    s_and_b64 exec, exec, vcc
    ds_write_b128 v2, v[48:51] offset:35328
c_z_6:
    s_mov_b64 exec, s[50:51]
    s_waitcnt lgkmcnt(0)
    s_barrier
    v_add_u32 v52, 112, v2
    v_lshrrev_b32 v3, 3, v0
    v_mul_u32_u24 v3, 144, v3
    v_and_b32 v4, 7, v0
    v_lshlrev_b32 v4, 4, v4
    v_add_u32 v53, v3, v4
    v_add_u32 v53, 35472, v53
    v_and_b32 v3, 7, v1
    v_mul_u32_u24 v3, 4416, v3
    v_and_b32 v4, 31, v1
    v_lshrrev_b32 v4, 3, v4
    v_lshrrev_b32 v5, 5, v1
    v_sub_u32 v4, v4, v5
    v_lshlrev_b32 v4, 4, v4
    v_add_u32 v3, v3, v4
    s_lshl_b32 s40, s34, 10
    s_add_u32 s40, s40, 16
    v_add_u32 v54, s40, v3
    v_and_b32 v3, 31, v1
    s_lshl_b32 s40, s34, 3
    v_subrev_u32 v3, s40, v3
    v_max_i32 v3, -1, v3
    v_add_u32 v3, 1, v3
    v_mul_u32_u24 v3, 144, v3
    v_lshrrev_b32 v4, 5, v1
    v_lshlrev_b32 v4, 4, v4
    v_add_u32 v55, v3, v4
    v_and_b32 v3, 31, v1
    v_cmp_ne_u32 vcc, 0, v3
    s_nop 1
    v_cndmask_b32 v56, 0, -1, vcc
    v_and_b32 v3, 31, v1
    v_lshrrev_b32 v4, 5, v1
    v_lshlrev_b32 v4, 3, v4
    v_add_u32 v4, 7, v4
    v_sub_u32 v4, v4, v3
    v_cmp_eq_u32 vcc, 0, v4
    v_mov_b32 v5, 0xffff
    s_nop 0
    v_cndmask_b32 v60, 0, v5, vcc
    v_cmp_eq_u32 vcc, 1, v4
    v_mov_b32 v5, 0xffff0000
    s_nop 0
    v_cndmask_b32 v5, 0, v5, vcc
    v_or_b32 v60, v60, v5
    v_cmp_eq_u32 vcc, 2, v4
    v_mov_b32 v5, 0xffff
    s_nop 0
    v_cndmask_b32 v61, 0, v5, vcc
    v_cmp_eq_u32 vcc, 3, v4
    v_mov_b32 v5, 0xffff0000
    s_nop 0
    v_cndmask_b32 v5, 0, v5, vcc
    v_or_b32 v61, v61, v5
    v_cmp_eq_u32 vcc, 4, v4
    v_mov_b32 v5, 0xffff
    s_nop 0
    v_cndmask_b32 v62, 0, v5, vcc
    v_cmp_eq_u32 vcc, 5, v4
    v_mov_b32 v5, 0xffff0000
    s_nop 0
    v_cndmask_b32 v5, 0, v5, vcc
    v_or_b32 v62, v62, v5
    v_cmp_eq_u32 vcc, 6, v4
    v_mov_b32 v5, 0xffff
    s_nop 0
    v_cndmask_b32 v63, 0, v5, vcc
    v_cmp_eq_u32 vcc, 7, v4
    v_mov_b32 v5, 0xffff0000
    s_nop 0
    v_cndmask_b32 v5, 0, v5, vcc
    v_or_b32 v63, v63, v5
    v_cmp_eq_u32 vcc, -16, v4
    v_mov_b32 v5, 0xffff
    s_nop 0
    v_cndmask_b32 v64, 0, v5, vcc
    v_cmp_eq_u32 vcc, -15, v4
    v_mov_b32 v5, 0xffff0000
    s_nop 0
    v_cndmask_b32 v5, 0, v5, vcc
    v_or_b32 v64, v64, v5
    v_cmp_eq_u32 vcc, -14, v4
    v_mov_b32 v5, 0xffff
    s_nop 0
    v_cndmask_b32 v65, 0, v5, vcc
    v_cmp_eq_u32 vcc, -13, v4
    v_mov_b32 v5, 0xffff0000
    s_nop 0
    v_cndmask_b32 v5, 0, v5, vcc
    v_or_b32 v65, v65, v5
    v_cmp_eq_u32 vcc, -12, v4
    v_mov_b32 v5, 0xffff
    s_nop 0
    v_cndmask_b32 v66, 0, v5, vcc
    v_cmp_eq_u32 vcc, -11, v4
    v_mov_b32 v5, 0xffff0000
    s_nop 0
    v_cndmask_b32 v5, 0, v5, vcc
    v_or_b32 v66, v66, v5
    v_cmp_eq_u32 vcc, -10, v4
    v_mov_b32 v5, 0xffff
    s_nop 0
    v_cndmask_b32 v67, 0, v5, vcc
    v_cmp_eq_u32 vcc, -9, v4
    v_mov_b32 v5, 0xffff0000
    s_nop 0
    v_cndmask_b32 v5, 0, v5, vcc
    v_or_b32 v67, v67, v5
    v_and_b32 v3, 31, v1
    v_mul_u32_u24 v3, 272, v3
    v_lshrrev_b32 v4, 5, v1
    v_lshlrev_b32 v4, 4, v4
    v_add_u32 v3, v3, v4
    s_mul_i32 s40, s34, 8704
    s_add_u32 s40, s40, 40128
    v_add_u32 v68, s40, v3
    v_lshrrev_b32 v3, 3, v0
    v_mul_u32_u24 v3, 272, v3
    v_and_b32 v4, 7, v0
    v_lshlrev_b32 v4, 5, v4
    v_add_u32 v69, v3, v4
    v_add_u32 v69, 40128, v69
    s_add_u32 s35, s32, 0
    s_waitcnt vmcnt(8)
    v_cmp_ne_u32 vcc, 0, v0
    s_nop 1
    v_cndmask_b32 v8, 0, v8, vcc
    v_cndmask_b32 v9, 0, v9, vcc
    v_cndmask_b32 v10, 0, v10, vcc
    v_cndmask_b32 v11, 0, v11, vcc
    v_alignbit_b32 v160, v9, v8, 16
    v_alignbit_b32 v161, v10, v9, 16
    v_alignbit_b32 v162, v11, v10, 16
    v_alignbit_b32 v163, v12, v11, 16
    v_alignbit_b32 v164, v13, v12, 16
    v_alignbit_b32 v165, v14, v13, 16
    v_alignbit_b32 v166, v15, v14, 16
    ds_write_b128 v52, v[160:163] offset:0
    v_mov_b32 v168, v9
    v_mov_b32 v169, v10
    v_mov_b32 v170, v11
    v_mov_b32 v171, v12
    ds_write_b128 v52, v[168:171] offset:4416
    s_nop 1
    v_mov_b32 v168, v161
    v_mov_b32 v169, v162
    v_mov_b32 v170, v163
    v_mov_b32 v171, v164
    ds_write_b128 v52, v[168:171] offset:8832
    s_nop 1
    ds_write_b128 v52, v[10:13] offset:13248
    ds_write_b128 v52, v[162:165] offset:17664
    v_mov_b32 v168, v11
    v_mov_b32 v169, v12
    v_mov_b32 v170, v13
    v_mov_b32 v171, v14
    ds_write_b128 v52, v[168:171] offset:22080
    s_nop 1
    v_mov_b32 v168, v163
    v_mov_b32 v169, v164
    v_mov_b32 v170, v165
    v_mov_b32 v171, v166
    ds_write_b128 v52, v[168:171] offset:26496
    s_nop 1
    ds_write_b128 v52, v[12:15] offset:30912
    ds_write_b128 v53, v[32:35]
    v_lshlrev_b32 v3, 16, v44
    v_or_b32 v3, v3, v44
    v_and_b32 v172, v60, v3
    v_and_b32 v173, v61, v3
    v_and_b32 v174, v62, v3
    v_and_b32 v175, v63, v3
    v_and_b32 v176, v64, v3
    v_and_b32 v177, v65, v3
    v_and_b32 v178, v66, v3
    v_and_b32 v179, v67, v3
    s_waitcnt lgkmcnt(0)
    s_barrier
    ds_read_b128 v[104:107], v55 offset:35328
    ds_read_b128 v[108:111], v55 offset:35360
    ds_read_b128 v[112:115], v55 offset:35392
    ds_read_b128 v[116:119], v55 offset:35424
    ds_read_b128 v[120:123], v54 offset:0
    ds_read_b128 v[124:127], v54 offset:32
    ds_read_b128 v[128:131], v54 offset:64
    ds_read_b128 v[132:135], v54 offset:96
    ds_read_b128 v[136:139], v54 offset:128
    ds_read_b128 v[140:143], v54 offset:160
    ds_read_b128 v[144:147], v54 offset:192
    ds_read_b128 v[148:151], v54 offset:224
    ds_read_b128 v[152:155], v54 offset:256
    ds_read_b128 v[156:159], v54 offset:288
    s_waitcnt lgkmcnt(4)
    v_mfma_f32_32x32x16_bf16 v[72:87], v[132:135], v[104:107], 0
    v_mfma_f32_32x32x16_bf16 v[88:103], v[140:143], v[104:107], 0
    s_cmp_lg_u32 s34, 0
    s_cbranch_scc1 c_dg_7
    v_mfma_f32_32x32x16_bf16 v[72:87], v[172:175], v[104:107], v[72:87]
c_dg_7:
    v_and_b32_dpp v104, v104, v56 wave_shr:1 row_mask:0xf bank_mask:0xf bound_ctrl:0
    v_and_b32_dpp v105, v105, v56 wave_shr:1 row_mask:0xf bank_mask:0xf bound_ctrl:0
    v_and_b32_dpp v106, v106, v56 wave_shr:1 row_mask:0xf bank_mask:0xf bound_ctrl:0
    v_and_b32_dpp v107, v107, v56 wave_shr:1 row_mask:0xf bank_mask:0xf bound_ctrl:0
    v_mfma_f32_32x32x16_bf16 v[72:87], v[128:131], v[108:111], v[72:87]
    v_mfma_f32_32x32x16_bf16 v[88:103], v[136:139], v[108:111], v[88:103]
    s_cmp_lg_u32 s34, 0
    s_cbranch_scc1 c_dg_8
    v_mfma_f32_32x32x16_bf16 v[72:87], v[176:179], v[108:111], v[72:87]
c_dg_8:
    v_and_b32_dpp v108, v108, v56 wave_shr:1 row_mask:0xf bank_mask:0xf bound_ctrl:0
    v_and_b32_dpp v109, v109, v56 wave_shr:1 row_mask:0xf bank_mask:0xf bound_ctrl:0
    v_and_b32_dpp v110, v110, v56 wave_shr:1 row_mask:0xf bank_mask:0xf bound_ctrl:0
    v_and_b32_dpp v111, v111, v56 wave_shr:1 row_mask:0xf bank_mask:0xf bound_ctrl:0
    v_mfma_f32_32x32x16_bf16 v[72:87], v[124:127], v[112:115], v[72:87]
    v_mfma_f32_32x32x16_bf16 v[88:103], v[132:135], v[112:115], v[88:103]
    s_cmp_lg_u32 s34, 0
    s_cbranch_scc1 c_dg_9
    v_mfma_f32_32x32x16_bf16 v[88:103], v[172:175], v[112:115], v[88:103]
c_dg_9:
    v_and_b32_dpp v112, v112, v56 wave_shr:1 row_mask:0xf bank_mask:0xf bound_ctrl:0
    v_and_b32_dpp v113, v113, v56 wave_shr:1 row_mask:0xf bank_mask:0xf bound_ctrl:0
    v_and_b32_dpp v114, v114, v56 wave_shr:1 row_mask:0xf bank_mask:0xf bound_ctrl:0
    v_and_b32_dpp v115, v115, v56 wave_shr:1 row_mask:0xf bank_mask:0xf bound_ctrl:0
    v_mfma_f32_32x32x16_bf16 v[72:87], v[120:123], v[116:119], v[72:87]
    v_mfma_f32_32x32x16_bf16 v[88:103], v[128:131], v[116:119], v[88:103]
    s_cmp_lg_u32 s34, 0
    s_cbranch_scc1 c_dg_10
    v_mfma_f32_32x32x16_bf16 v[88:103], v[176:179], v[116:119], v[88:103]
c_dg_10:
    v_and_b32_dpp v116, v116, v56 wave_shr:1 row_mask:0xf bank_mask:0xf bound_ctrl:0
    v_and_b32_dpp v117, v117, v56 wave_shr:1 row_mask:0xf bank_mask:0xf bound_ctrl:0
    v_and_b32_dpp v118, v118, v56 wave_shr:1 row_mask:0xf bank_mask:0xf bound_ctrl:0
    v_and_b32_dpp v119, v119, v56 wave_shr:1 row_mask:0xf bank_mask:0xf bound_ctrl:0
    ds_read_b128 v[120:123], v54 offset:320
    ds_read_b128 v[124:127], v54 offset:352
    ds_read_b128 v[128:131], v54 offset:384
    ds_read_b128 v[132:135], v54 offset:416
    s_waitcnt lgkmcnt(4)
    v_mfma_f32_32x32x16_bf16 v[72:87], v[148:151], v[104:107], v[72:87]
    v_mfma_f32_32x32x16_bf16 v[88:103], v[156:159], v[104:107], v[88:103]
    v_and_b32_dpp v104, v104, v56 wave_shr:1 row_mask:0xf bank_mask:0xf bound_ctrl:0
    v_and_b32_dpp v105, v105, v56 wave_shr:1 row_mask:0xf bank_mask:0xf bound_ctrl:0
    v_and_b32_dpp v106, v106, v56 wave_shr:1 row_mask:0xf bank_mask:0xf bound_ctrl:0
    v_and_b32_dpp v107, v107, v56 wave_shr:1 row_mask:0xf bank_mask:0xf bound_ctrl:0
    v_mfma_f32_32x32x16_bf16 v[72:87], v[144:147], v[108:111], v[72:87]
    v_mfma_f32_32x32x16_bf16 v[88:103], v[152:155], v[108:111], v[88:103]
    v_and_b32_dpp v108, v108, v56 wave_shr:1 row_mask:0xf bank_mask:0xf bound_ctrl:0
    v_and_b32_dpp v109, v109, v56 wave_shr:1 row_mask:0xf bank_mask:0xf bound_ctrl:0
    v_and_b32_dpp v110, v110, v56 wave_shr:1 row_mask:0xf bank_mask:0xf bound_ctrl:0
    v_and_b32_dpp v111, v111, v56 wave_shr:1 row_mask:0xf bank_mask:0xf bound_ctrl:0
    v_mfma_f32_32x32x16_bf16 v[72:87], v[140:143], v[112:115], v[72:87]
    v_mfma_f32_32x32x16_bf16 v[88:103], v[148:151], v[112:115], v[88:103]
    v_and_b32_dpp v112, v112, v56 wave_shr:1 row_mask:0xf bank_mask:0xf bound_ctrl:0
    v_and_b32_dpp v113, v113, v56 wave_shr:1 row_mask:0xf bank_mask:0xf bound_ctrl:0
    v_and_b32_dpp v114, v114, v56 wave_shr:1 row_mask:0xf bank_mask:0xf bound_ctrl:0
    v_and_b32_dpp v115, v115, v56 wave_shr:1 row_mask:0xf bank_mask:0xf bound_ctrl:0
    v_mfma_f32_32x32x16_bf16 v[72:87], v[136:139], v[116:119], v[72:87]
    v_mfma_f32_32x32x16_bf16 v[88:103], v[144:147], v[116:119], v[88:103]
    v_and_b32_dpp v116, v116, v56 wave_shr:1 row_mask:0xf bank_mask:0xf bound_ctrl:0
    v_and_b32_dpp v117, v117, v56 wave_shr:1 row_mask:0xf bank_mask:0xf bound_ctrl:0
    v_and_b32_dpp v118, v118, v56 wave_shr:1 row_mask:0xf bank_mask:0xf bound_ctrl:0
    v_and_b32_dpp v119, v119, v56 wave_shr:1 row_mask:0xf bank_mask:0xf bound_ctrl:0
    ds_read_b128 v[136:139], v54 offset:448
    ds_read_b128 v[140:143], v54 offset:480
    ds_read_b128 v[144:147], v54 offset:512
    ds_read_b128 v[148:151], v54 offset:544
    s_waitcnt lgkmcnt(4)
    v_mfma_f32_32x32x16_bf16 v[72:87], v[124:127], v[104:107], v[72:87]
    v_mfma_f32_32x32x16_bf16 v[88:103], v[132:135], v[104:107], v[88:103]
    v_and_b32_dpp v104, v104, v56 wave_shr:1 row_mask:0xf bank_mask:0xf bound_ctrl:0
    v_and_b32_dpp v105, v105, v56 wave_shr:1 row_mask:0xf bank_mask:0xf bound_ctrl:0
    v_and_b32_dpp v106, v106, v56 wave_shr:1 row_mask:0xf bank_mask:0xf bound_ctrl:0
    v_and_b32_dpp v107, v107, v56 wave_shr:1 row_mask:0xf bank_mask:0xf bound_ctrl:0
    v_mfma_f32_32x32x16_bf16 v[72:87], v[120:123], v[108:111], v[72:87]
    v_mfma_f32_32x32x16_bf16 v[88:103], v[128:131], v[108:111], v[88:103]
    v_and_b32_dpp v108, v108, v56 wave_shr:1 row_mask:0xf bank_mask:0xf bound_ctrl:0
    v_and_b32_dpp v109, v109, v56 wave_shr:1 row_mask:0xf bank_mask:0xf bound_ctrl:0
    v_and_b32_dpp v110, v110, v56 wave_shr:1 row_mask:0xf bank_mask:0xf bound_ctrl:0
    v_and_b32_dpp v111, v111, v56 wave_shr:1 row_mask:0xf bank_mask:0xf bound_ctrl:0
    v_mfma_f32_32x32x16_bf16 v[72:87], v[156:159], v[112:115], v[72:87]
    v_mfma_f32_32x32x16_bf16 v[88:103], v[124:127], v[112:115], v[88:103]
    v_and_b32_dpp v112, v112, v56 wave_shr:1 row_mask:0xf bank_mask:0xf bound_ctrl:0
    v_and_b32_dpp v113, v113, v56 wave_shr:1 row_mask:0xf bank_mask:0xf bound_ctrl:0
    v_and_b32_dpp v114, v114, v56 wave_shr:1 row_mask:0xf bank_mask:0xf bound_ctrl:0
    v_and_b32_dpp v115, v115, v56 wave_shr:1 row_mask:0xf bank_mask:0xf bound_ctrl:0
    v_mfma_f32_32x32x16_bf16 v[72:87], v[152:155], v[116:119], v[72:87]
    v_mfma_f32_32x32x16_bf16 v[88:103], v[120:123], v[116:119], v[88:103]
    v_and_b32_dpp v116, v116, v56 wave_shr:1 row_mask:0xf bank_mask:0xf bound_ctrl:0
    v_and_b32_dpp v117, v117, v56 wave_shr:1 row_mask:0xf bank_mask:0xf bound_ctrl:0
    v_and_b32_dpp v118, v118, v56 wave_shr:1 row_mask:0xf bank_mask:0xf bound_ctrl:0
    v_and_b32_dpp v119, v119, v56 wave_shr:1 row_mask:0xf bank_mask:0xf bound_ctrl:0
    ds_read_b128 v[152:155], v54 offset:576
    ds_read_b128 v[156:159], v54 offset:608
    ds_read_b128 v[120:123], v54 offset:640
    ds_read_b128 v[124:127], v54 offset:672
    s_waitcnt lgkmcnt(4)
    v_mfma_f32_32x32x16_bf16 v[72:87], v[140:143], v[104:107], v[72:87]
    v_mfma_f32_32x32x16_bf16 v[88:103], v[148:151], v[104:107], v[88:103]
    v_and_b32_dpp v104, v104, v56 wave_shr:1 row_mask:0xf bank_mask:0xf bound_ctrl:0
    v_and_b32_dpp v105, v105, v56 wave_shr:1 row_mask:0xf bank_mask:0xf bound_ctrl:0
    v_and_b32_dpp v106, v106, v56 wave_shr:1 row_mask:0xf bank_mask:0xf bound_ctrl:0
    v_and_b32_dpp v107, v107, v56 wave_shr:1 row_mask:0xf bank_mask:0xf bound_ctrl:0
    v_mfma_f32_32x32x16_bf16 v[72:87], v[136:139], v[108:111], v[72:87]
    v_mfma_f32_32x32x16_bf16 v[88:103], v[144:147], v[108:111], v[88:103]
    v_and_b32_dpp v108, v108, v56 wave_shr:1 row_mask:0xf bank_mask:0xf bound_ctrl:0
    v_and_b32_dpp v109, v109, v56 wave_shr:1 row_mask:0xf bank_mask:0xf bound_ctrl:0
    v_and_b32_dpp v110, v110, v56 wave_shr:1 row_mask:0xf bank_mask:0xf bound_ctrl:0
    v_and_b32_dpp v111, v111, v56 wave_shr:1 row_mask:0xf bank_mask:0xf bound_ctrl:0
    v_mfma_f32_32x32x16_bf16 v[72:87], v[132:135], v[112:115], v[72:87]
    v_mfma_f32_32x32x16_bf16 v[88:103], v[140:143], v[112:115], v[88:103]
    v_and_b32_dpp v112, v112, v56 wave_shr:1 row_mask:0xf bank_mask:0xf bound_ctrl:0
    v_and_b32_dpp v113, v113, v56 wave_shr:1 row_mask:0xf bank_mask:0xf bound_ctrl:0
    v_and_b32_dpp v114, v114, v56 wave_shr:1 row_mask:0xf bank_mask:0xf bound_ctrl:0
    v_and_b32_dpp v115, v115, v56 wave_shr:1 row_mask:0xf bank_mask:0xf bound_ctrl:0
    v_mfma_f32_32x32x16_bf16 v[72:87], v[128:131], v[116:119], v[72:87]
    v_mfma_f32_32x32x16_bf16 v[88:103], v[136:139], v[116:119], v[88:103]
    v_and_b32_dpp v116, v116, v56 wave_shr:1 row_mask:0xf bank_mask:0xf bound_ctrl:0
    v_and_b32_dpp v117, v117, v56 wave_shr:1 row_mask:0xf bank_mask:0xf bound_ctrl:0
    v_and_b32_dpp v118, v118, v56 wave_shr:1 row_mask:0xf bank_mask:0xf bound_ctrl:0
    v_and_b32_dpp v119, v119, v56 wave_shr:1 row_mask:0xf bank_mask:0xf bound_ctrl:0
    ds_read_b128 v[128:131], v54 offset:704
    ds_read_b128 v[132:135], v54 offset:736
    ds_read_b128 v[136:139], v54 offset:768
    ds_read_b128 v[140:143], v54 offset:800
    s_waitcnt lgkmcnt(4)
    v_mfma_f32_32x32x16_bf16 v[72:87], v[156:159], v[104:107], v[72:87]
    v_mfma_f32_32x32x16_bf16 v[88:103], v[124:127], v[104:107], v[88:103]
    v_and_b32_dpp v104, v104, v56 wave_shr:1 row_mask:0xf bank_mask:0xf bound_ctrl:0
    v_and_b32_dpp v105, v105, v56 wave_shr:1 row_mask:0xf bank_mask:0xf bound_ctrl:0
    v_and_b32_dpp v106, v106, v56 wave_shr:1 row_mask:0xf bank_mask:0xf bound_ctrl:0
    v_and_b32_dpp v107, v107, v56 wave_shr:1 row_mask:0xf bank_mask:0xf bound_ctrl:0
    v_mfma_f32_32x32x16_bf16 v[72:87], v[152:155], v[108:111], v[72:87]
    v_mfma_f32_32x32x16_bf16 v[88:103], v[120:123], v[108:111], v[88:103]
    v_and_b32_dpp v108, v108, v56 wave_shr:1 row_mask:0xf bank_mask:0xf bound_ctrl:0
    v_and_b32_dpp v109, v109, v56 wave_shr:1 row_mask:0xf bank_mask:0xf bound_ctrl:0
    v_and_b32_dpp v110, v110, v56 wave_shr:1 row_mask:0xf bank_mask:0xf bound_ctrl:0
    v_and_b32_dpp v111, v111, v56 wave_shr:1 row_mask:0xf bank_mask:0xf bound_ctrl:0
    v_mfma_f32_32x32x16_bf16 v[72:87], v[148:151], v[112:115], v[72:87]
    v_mfma_f32_32x32x16_bf16 v[88:103], v[156:159], v[112:115], v[88:103]
    v_and_b32_dpp v112, v112, v56 wave_shr:1 row_mask:0xf bank_mask:0xf bound_ctrl:0
    v_and_b32_dpp v113, v113, v56 wave_shr:1 row_mask:0xf bank_mask:0xf bound_ctrl:0
    v_and_b32_dpp v114, v114, v56 wave_shr:1 row_mask:0xf bank_mask:0xf bound_ctrl:0
    v_and_b32_dpp v115, v115, v56 wave_shr:1 row_mask:0xf bank_mask:0xf bound_ctrl:0
    v_mfma_f32_32x32x16_bf16 v[72:87], v[144:147], v[116:119], v[72:87]
    v_mfma_f32_32x32x16_bf16 v[88:103], v[152:155], v[116:119], v[88:103]
    v_and_b32_dpp v116, v116, v56 wave_shr:1 row_mask:0xf bank_mask:0xf bound_ctrl:0
    v_and_b32_dpp v117, v117, v56 wave_shr:1 row_mask:0xf bank_mask:0xf bound_ctrl:0
    v_and_b32_dpp v118, v118, v56 wave_shr:1 row_mask:0xf bank_mask:0xf bound_ctrl:0
    v_and_b32_dpp v119, v119, v56 wave_shr:1 row_mask:0xf bank_mask:0xf bound_ctrl:0
    ds_read_b128 v[144:147], v54 offset:832
    ds_read_b128 v[148:151], v54 offset:864
    ds_read_b128 v[152:155], v54 offset:896
    ds_read_b128 v[156:159], v54 offset:928
    s_waitcnt lgkmcnt(4)
    v_mfma_f32_32x32x16_bf16 v[72:87], v[132:135], v[104:107], v[72:87]
    v_mfma_f32_32x32x16_bf16 v[88:103], v[140:143], v[104:107], v[88:103]
    v_and_b32_dpp v104, v104, v56 wave_shr:1 row_mask:0xf bank_mask:0xf bound_ctrl:0
    v_and_b32_dpp v105, v105, v56 wave_shr:1 row_mask:0xf bank_mask:0xf bound_ctrl:0
    v_and_b32_dpp v106, v106, v56 wave_shr:1 row_mask:0xf bank_mask:0xf bound_ctrl:0
    v_and_b32_dpp v107, v107, v56 wave_shr:1 row_mask:0xf bank_mask:0xf bound_ctrl:0
    v_mfma_f32_32x32x16_bf16 v[72:87], v[128:131], v[108:111], v[72:87]
    v_mfma_f32_32x32x16_bf16 v[88:103], v[136:139], v[108:111], v[88:103]
    v_and_b32_dpp v108, v108, v56 wave_shr:1 row_mask:0xf bank_mask:0xf bound_ctrl:0
    v_and_b32_dpp v109, v109, v56 wave_shr:1 row_mask:0xf bank_mask:0xf bound_ctrl:0
    v_and_b32_dpp v110, v110, v56 wave_shr:1 row_mask:0xf bank_mask:0xf bound_ctrl:0
    v_and_b32_dpp v111, v111, v56 wave_shr:1 row_mask:0xf bank_mask:0xf bound_ctrl:0
    v_mfma_f32_32x32x16_bf16 v[72:87], v[124:127], v[112:115], v[72:87]
    v_mfma_f32_32x32x16_bf16 v[88:103], v[132:135], v[112:115], v[88:103]
    v_and_b32_dpp v112, v112, v56 wave_shr:1 row_mask:0xf bank_mask:0xf bound_ctrl:0
    v_and_b32_dpp v113, v113, v56 wave_shr:1 row_mask:0xf bank_mask:0xf bound_ctrl:0
    v_and_b32_dpp v114, v114, v56 wave_shr:1 row_mask:0xf bank_mask:0xf bound_ctrl:0
    v_and_b32_dpp v115, v115, v56 wave_shr:1 row_mask:0xf bank_mask:0xf bound_ctrl:0
    v_mfma_f32_32x32x16_bf16 v[72:87], v[120:123], v[116:119], v[72:87]
    v_mfma_f32_32x32x16_bf16 v[88:103], v[128:131], v[116:119], v[88:103]
    v_and_b32_dpp v116, v116, v56 wave_shr:1 row_mask:0xf bank_mask:0xf bound_ctrl:0
    v_and_b32_dpp v117, v117, v56 wave_shr:1 row_mask:0xf bank_mask:0xf bound_ctrl:0
    v_and_b32_dpp v118, v118, v56 wave_shr:1 row_mask:0xf bank_mask:0xf bound_ctrl:0
    v_and_b32_dpp v119, v119, v56 wave_shr:1 row_mask:0xf bank_mask:0xf bound_ctrl:0
    ds_read_b128 v[120:123], v54 offset:960
    ds_read_b128 v[124:127], v54 offset:992
    ds_read_b128 v[128:131], v54 offset:1024
    ds_read_b128 v[132:135], v54 offset:1056
    s_waitcnt lgkmcnt(4)
    v_mfma_f32_32x32x16_bf16 v[72:87], v[148:151], v[104:107], v[72:87]
    v_mfma_f32_32x32x16_bf16 v[88:103], v[156:159], v[104:107], v[88:103]
    v_and_b32_dpp v104, v104, v56 wave_shr:1 row_mask:0xf bank_mask:0xf bound_ctrl:0
    v_and_b32_dpp v105, v105, v56 wave_shr:1 row_mask:0xf bank_mask:0xf bound_ctrl:0
    v_and_b32_dpp v106, v106, v56 wave_shr:1 row_mask:0xf bank_mask:0xf bound_ctrl:0
    v_and_b32_dpp v107, v107, v56 wave_shr:1 row_mask:0xf bank_mask:0xf bound_ctrl:0
    v_mfma_f32_32x32x16_bf16 v[72:87], v[144:147], v[108:111], v[72:87]
    v_mfma_f32_32x32x16_bf16 v[88:103], v[152:155], v[108:111], v[88:103]
    v_and_b32_dpp v108, v108, v56 wave_shr:1 row_mask:0xf bank_mask:0xf bound_ctrl:0
    v_and_b32_dpp v109, v109, v56 wave_shr:1 row_mask:0xf bank_mask:0xf bound_ctrl:0
    v_and_b32_dpp v110, v110, v56 wave_shr:1 row_mask:0xf bank_mask:0xf bound_ctrl:0
    v_and_b32_dpp v111, v111, v56 wave_shr:1 row_mask:0xf bank_mask:0xf bound_ctrl:0
    v_mfma_f32_32x32x16_bf16 v[72:87], v[140:143], v[112:115], v[72:87]
    v_mfma_f32_32x32x16_bf16 v[88:103], v[148:151], v[112:115], v[88:103]
    v_and_b32_dpp v112, v112, v56 wave_shr:1 row_mask:0xf bank_mask:0xf bound_ctrl:0
    v_and_b32_dpp v113, v113, v56 wave_shr:1 row_mask:0xf bank_mask:0xf bound_ctrl:0
    v_and_b32_dpp v114, v114, v56 wave_shr:1 row_mask:0xf bank_mask:0xf bound_ctrl:0
    v_and_b32_dpp v115, v115, v56 wave_shr:1 row_mask:0xf bank_mask:0xf bound_ctrl:0
    v_mfma_f32_32x32x16_bf16 v[72:87], v[136:139], v[116:119], v[72:87]
    v_mfma_f32_32x32x16_bf16 v[88:103], v[144:147], v[116:119], v[88:103]
    v_and_b32_dpp v116, v116, v56 wave_shr:1 row_mask:0xf bank_mask:0xf bound_ctrl:0
    v_and_b32_dpp v117, v117, v56 wave_shr:1 row_mask:0xf bank_mask:0xf bound_ctrl:0
    v_and_b32_dpp v118, v118, v56 wave_shr:1 row_mask:0xf bank_mask:0xf bound_ctrl:0
    v_and_b32_dpp v119, v119, v56 wave_shr:1 row_mask:0xf bank_mask:0xf bound_ctrl:0
    s_waitcnt lgkmcnt(0)
    v_mfma_f32_32x32x16_bf16 v[72:87], v[124:127], v[104:107], v[72:87]
    v_mfma_f32_32x32x16_bf16 v[88:103], v[132:135], v[104:107], v[88:103]
    v_mfma_f32_32x32x16_bf16 v[72:87], v[120:123], v[108:111], v[72:87]
    v_mfma_f32_32x32x16_bf16 v[88:103], v[128:131], v[108:111], v[88:103]
    v_mfma_f32_32x32x16_bf16 v[72:87], v[156:159], v[112:115], v[72:87]
    v_mfma_f32_32x32x16_bf16 v[88:103], v[124:127], v[112:115], v[88:103]
    v_mfma_f32_32x32x16_bf16 v[72:87], v[152:155], v[116:119], v[72:87]
    v_mfma_f32_32x32x16_bf16 v[88:103], v[120:123], v[116:119], v[88:103]
    s_nop 10
    ds_write_b128 v68, v[72:75] offset:0
    ds_write_b128 v68, v[76:79] offset:32
    ds_write_b128 v68, v[80:83] offset:64
    ds_write_b128 v68, v[84:87] offset:96
    ds_write_b128 v68, v[88:91] offset:128
    ds_write_b128 v68, v[92:95] offset:160
    ds_write_b128 v68, v[96:99] offset:192
    ds_write_b128 v68, v[100:103] offset:224
    s_waitcnt lgkmcnt(0)
    s_barrier
    ds_read_b128 v[120:123], v69 offset:0
    ds_read_b128 v[124:127], v69 offset:16
    ds_read_b128 v[128:131], v69 offset:8704
    ds_read_b128 v[132:135], v69 offset:8720
    ds_read_b128 v[136:139], v69 offset:17408
    ds_read_b128 v[140:143], v69 offset:17424
    ds_read_b128 v[144:147], v69 offset:26112
    ds_read_b128 v[148:151], v69 offset:26128
    s_waitcnt lgkmcnt(0)
    v_pk_add_f32 v[120:121], v[120:121], v[128:129]
    v_pk_add_f32 v[122:123], v[122:123], v[130:131]
    v_pk_add_f32 v[124:125], v[124:125], v[132:133]
    v_pk_add_f32 v[126:127], v[126:127], v[134:135]
    v_pk_add_f32 v[120:121], v[120:121], v[136:137]
    v_pk_add_f32 v[122:123], v[122:123], v[138:139]
    v_pk_add_f32 v[124:125], v[124:125], v[140:141]
    v_pk_add_f32 v[126:127], v[126:127], v[142:143]
    v_pk_add_f32 v[120:121], v[120:121], v[144:145]
    v_pk_add_f32 v[122:123], v[122:123], v[146:147]
    v_pk_add_f32 v[124:125], v[124:125], v[148:149]
    v_pk_add_f32 v[126:127], v[126:127], v[150:151]
    v_cvt_pk_bf16_f32 v168, v120, v121
    v_cvt_pk_bf16_f32 v169, v122, v123
    v_cvt_pk_bf16_f32 v170, v124, v125
    v_cvt_pk_bf16_f32 v171, v126, v127
    s_lshl_b32 s40, s35, 12
    s_add_u32 s40, s40, 8912896
    buffer_store_dwordx4 v[168:171], v2, s[8:11], s40 offen
    s_nop 1
    s_add_u32 s35, s32, 256
    s_waitcnt vmcnt(5)
    v_cmp_ne_u32 vcc, 0, v0
    s_nop 1
    v_cndmask_b32 v16, 0, v16, vcc
    v_cndmask_b32 v17, 0, v17, vcc
    v_cndmask_b32 v18, 0, v18, vcc
    v_cndmask_b32 v19, 0, v19, vcc
    v_alignbit_b32 v160, v17, v16, 16
    v_alignbit_b32 v161, v18, v17, 16
    v_alignbit_b32 v162, v19, v18, 16
    v_alignbit_b32 v163, v20, v19, 16
    v_alignbit_b32 v164, v21, v20, 16
    v_alignbit_b32 v165, v22, v21, 16
    v_alignbit_b32 v166, v23, v22, 16
    ds_write_b128 v52, v[160:163] offset:0
    v_mov_b32 v168, v17
    v_mov_b32 v169, v18
    v_mov_b32 v170, v19
    v_mov_b32 v171, v20
    ds_write_b128 v52, v[168:171] offset:4416
    s_nop 1
    v_mov_b32 v168, v161
    v_mov_b32 v169, v162
    v_mov_b32 v170, v163
    v_mov_b32 v171, v164
    ds_write_b128 v52, v[168:171] offset:8832
    s_nop 1
    ds_write_b128 v52, v[18:21] offset:13248
    ds_write_b128 v52, v[162:165] offset:17664
    v_mov_b32 v168, v19
    v_mov_b32 v169, v20
    v_mov_b32 v170, v21
    v_mov_b32 v171, v22
    ds_write_b128 v52, v[168:171] offset:22080
    s_nop 1
    v_mov_b32 v168, v163
    v_mov_b32 v169, v164
    v_mov_b32 v170, v165
    v_mov_b32 v171, v166
    ds_write_b128 v52, v[168:171] offset:26496
    s_nop 1
    ds_write_b128 v52, v[20:23] offset:30912
    ds_write_b128 v53, v[36:39]
    v_lshlrev_b32 v3, 16, v45
    v_or_b32 v3, v3, v45
    v_and_b32 v172, v60, v3
    v_and_b32 v173, v61, v3
    v_and_b32 v174, v62, v3
    v_and_b32 v175, v63, v3
    v_and_b32 v176, v64, v3
    v_and_b32 v177, v65, v3
    v_and_b32 v178, v66, v3
    v_and_b32 v179, v67, v3
    s_waitcnt lgkmcnt(0)
    s_barrier
    ds_read_b128 v[104:107], v55 offset:35328
    ds_read_b128 v[108:111], v55 offset:35360
    ds_read_b128 v[112:115], v55 offset:35392
    ds_read_b128 v[116:119], v55 offset:35424
    ds_read_b128 v[120:123], v54 offset:0
    ds_read_b128 v[124:127], v54 offset:32
    ds_read_b128 v[128:131], v54 offset:64
    ds_read_b128 v[132:135], v54 offset:96
    ds_read_b128 v[136:139], v54 offset:128
    ds_read_b128 v[140:143], v54 offset:160
    ds_read_b128 v[144:147], v54 offset:192
    ds_read_b128 v[148:151], v54 offset:224
    ds_read_b128 v[152:155], v54 offset:256
    ds_read_b128 v[156:159], v54 offset:288
    s_waitcnt lgkmcnt(4)
    v_mfma_f32_32x32x16_bf16 v[72:87], v[132:135], v[104:107], 0
    v_mfma_f32_32x32x16_bf16 v[88:103], v[140:143], v[104:107], 0
    s_cmp_lg_u32 s34, 0
    s_cbranch_scc1 c_dg_11
    v_mfma_f32_32x32x16_bf16 v[72:87], v[172:175], v[104:107], v[72:87]
c_dg_11:
    v_and_b32_dpp v104, v104, v56 wave_shr:1 row_mask:0xf bank_mask:0xf bound_ctrl:0
    v_and_b32_dpp v105, v105, v56 wave_shr:1 row_mask:0xf bank_mask:0xf bound_ctrl:0
    v_and_b32_dpp v106, v106, v56 wave_shr:1 row_mask:0xf bank_mask:0xf bound_ctrl:0
    v_and_b32_dpp v107, v107, v56 wave_shr:1 row_mask:0xf bank_mask:0xf bound_ctrl:0
    v_mfma_f32_32x32x16_bf16 v[72:87], v[128:131], v[108:111], v[72:87]
    v_mfma_f32_32x32x16_bf16 v[88:103], v[136:139], v[108:111], v[88:103]
    s_cmp_lg_u32 s34, 0
    s_cbranch_scc1 c_dg_12
    v_mfma_f32_32x32x16_bf16 v[72:87], v[176:179], v[108:111], v[72:87]
c_dg_12:
    v_and_b32_dpp v108, v108, v56 wave_shr:1 row_mask:0xf bank_mask:0xf bound_ctrl:0
    v_and_b32_dpp v109, v109, v56 wave_shr:1 row_mask:0xf bank_mask:0xf bound_ctrl:0
    v_and_b32_dpp v110, v110, v56 wave_shr:1 row_mask:0xf bank_mask:0xf bound_ctrl:0
    v_and_b32_dpp v111, v111, v56 wave_shr:1 row_mask:0xf bank_mask:0xf bound_ctrl:0
    v_mfma_f32_32x32x16_bf16 v[72:87], v[124:127], v[112:115], v[72:87]
    v_mfma_f32_32x32x16_bf16 v[88:103], v[132:135], v[112:115], v[88:103]
    s_cmp_lg_u32 s34, 0
    s_cbranch_scc1 c_dg_13
    v_mfma_f32_32x32x16_bf16 v[88:103], v[172:175], v[112:115], v[88:103]
c_dg_13:
    v_and_b32_dpp v112, v112, v56 wave_shr:1 row_mask:0xf bank_mask:0xf bound_ctrl:0
    v_and_b32_dpp v113, v113, v56 wave_shr:1 row_mask:0xf bank_mask:0xf bound_ctrl:0
    v_and_b32_dpp v114, v114, v56 wave_shr:1 row_mask:0xf bank_mask:0xf bound_ctrl:0
    v_and_b32_dpp v115, v115, v56 wave_shr:1 row_mask:0xf bank_mask:0xf bound_ctrl:0
    v_mfma_f32_32x32x16_bf16 v[72:87], v[120:123], v[116:119], v[72:87]
    v_mfma_f32_32x32x16_bf16 v[88:103], v[128:131], v[116:119], v[88:103]
    s_cmp_lg_u32 s34, 0
    s_cbranch_scc1 c_dg_14
    v_mfma_f32_32x32x16_bf16 v[88:103], v[176:179], v[116:119], v[88:103]
c_dg_14:
    v_and_b32_dpp v116, v116, v56 wave_shr:1 row_mask:0xf bank_mask:0xf bound_ctrl:0
    v_and_b32_dpp v117, v117, v56 wave_shr:1 row_mask:0xf bank_mask:0xf bound_ctrl:0
    v_and_b32_dpp v118, v118, v56 wave_shr:1 row_mask:0xf bank_mask:0xf bound_ctrl:0
    v_and_b32_dpp v119, v119, v56 wave_shr:1 row_mask:0xf bank_mask:0xf bound_ctrl:0
    ds_read_b128 v[120:123], v54 offset:320
    ds_read_b128 v[124:127], v54 offset:352
    ds_read_b128 v[128:131], v54 offset:384
    ds_read_b128 v[132:135], v54 offset:416
    s_waitcnt lgkmcnt(4)
    v_mfma_f32_32x32x16_bf16 v[72:87], v[148:151], v[104:107], v[72:87]
    v_mfma_f32_32x32x16_bf16 v[88:103], v[156:159], v[104:107], v[88:103]
    v_and_b32_dpp v104, v104, v56 wave_shr:1 row_mask:0xf bank_mask:0xf bound_ctrl:0
    v_and_b32_dpp v105, v105, v56 wave_shr:1 row_mask:0xf bank_mask:0xf bound_ctrl:0
    v_and_b32_dpp v106, v106, v56 wave_shr:1 row_mask:0xf bank_mask:0xf bound_ctrl:0
    v_and_b32_dpp v107, v107, v56 wave_shr:1 row_mask:0xf bank_mask:0xf bound_ctrl:0
    v_mfma_f32_32x32x16_bf16 v[72:87], v[144:147], v[108:111], v[72:87]
    v_mfma_f32_32x32x16_bf16 v[88:103], v[152:155], v[108:111], v[88:103]
    v_and_b32_dpp v108, v108, v56 wave_shr:1 row_mask:0xf bank_mask:0xf bound_ctrl:0
    v_and_b32_dpp v109, v109, v56 wave_shr:1 row_mask:0xf bank_mask:0xf bound_ctrl:0
    v_and_b32_dpp v110, v110, v56 wave_shr:1 row_mask:0xf bank_mask:0xf bound_ctrl:0
    v_and_b32_dpp v111, v111, v56 wave_shr:1 row_mask:0xf bank_mask:0xf bound_ctrl:0
    v_mfma_f32_32x32x16_bf16 v[72:87], v[140:143], v[112:115], v[72:87]
    v_mfma_f32_32x32x16_bf16 v[88:103], v[148:151], v[112:115], v[88:103]
    v_and_b32_dpp v112, v112, v56 wave_shr:1 row_mask:0xf bank_mask:0xf bound_ctrl:0
    v_and_b32_dpp v113, v113, v56 wave_shr:1 row_mask:0xf bank_mask:0xf bound_ctrl:0
    v_and_b32_dpp v114, v114, v56 wave_shr:1 row_mask:0xf bank_mask:0xf bound_ctrl:0
    v_and_b32_dpp v115, v115, v56 wave_shr:1 row_mask:0xf bank_mask:0xf bound_ctrl:0
    v_mfma_f32_32x32x16_bf16 v[72:87], v[136:139], v[116:119], v[72:87]
    v_mfma_f32_32x32x16_bf16 v[88:103], v[144:147], v[116:119], v[88:103]
    v_and_b32_dpp v116, v116, v56 wave_shr:1 row_mask:0xf bank_mask:0xf bound_ctrl:0
    v_and_b32_dpp v117, v117, v56 wave_shr:1 row_mask:0xf bank_mask:0xf bound_ctrl:0
    v_and_b32_dpp v118, v118, v56 wave_shr:1 row_mask:0xf bank_mask:0xf bound_ctrl:0
    v_and_b32_dpp v119, v119, v56 wave_shr:1 row_mask:0xf bank_mask:0xf bound_ctrl:0
    ds_read_b128 v[136:139], v54 offset:448
    ds_read_b128 v[140:143], v54 offset:480
    ds_read_b128 v[144:147], v54 offset:512
    ds_read_b128 v[148:151], v54 offset:544
    s_waitcnt lgkmcnt(4)
    v_mfma_f32_32x32x16_bf16 v[72:87], v[124:127], v[104:107], v[72:87]
    v_mfma_f32_32x32x16_bf16 v[88:103], v[132:135], v[104:107], v[88:103]
    v_and_b32_dpp v104, v104, v56 wave_shr:1 row_mask:0xf bank_mask:0xf bound_ctrl:0
    v_and_b32_dpp v105, v105, v56 wave_shr:1 row_mask:0xf bank_mask:0xf bound_ctrl:0
    v_and_b32_dpp v106, v106, v56 wave_shr:1 row_mask:0xf bank_mask:0xf bound_ctrl:0
    v_and_b32_dpp v107, v107, v56 wave_shr:1 row_mask:0xf bank_mask:0xf bound_ctrl:0
    v_mfma_f32_32x32x16_bf16 v[72:87], v[120:123], v[108:111], v[72:87]
    v_mfma_f32_32x32x16_bf16 v[88:103], v[128:131], v[108:111], v[88:103]
    v_and_b32_dpp v108, v108, v56 wave_shr:1 row_mask:0xf bank_mask:0xf bound_ctrl:0
    v_and_b32_dpp v109, v109, v56 wave_shr:1 row_mask:0xf bank_mask:0xf bound_ctrl:0
    v_and_b32_dpp v110, v110, v56 wave_shr:1 row_mask:0xf bank_mask:0xf bound_ctrl:0
    v_and_b32_dpp v111, v111, v56 wave_shr:1 row_mask:0xf bank_mask:0xf bound_ctrl:0
    v_mfma_f32_32x32x16_bf16 v[72:87], v[156:159], v[112:115], v[72:87]
    v_mfma_f32_32x32x16_bf16 v[88:103], v[124:127], v[112:115], v[88:103]
    v_and_b32_dpp v112, v112, v56 wave_shr:1 row_mask:0xf bank_mask:0xf bound_ctrl:0
    v_and_b32_dpp v113, v113, v56 wave_shr:1 row_mask:0xf bank_mask:0xf bound_ctrl:0
    v_and_b32_dpp v114, v114, v56 wave_shr:1 row_mask:0xf bank_mask:0xf bound_ctrl:0
    v_and_b32_dpp v115, v115, v56 wave_shr:1 row_mask:0xf bank_mask:0xf bound_ctrl:0
    v_mfma_f32_32x32x16_bf16 v[72:87], v[152:155], v[116:119], v[72:87]
    v_mfma_f32_32x32x16_bf16 v[88:103], v[120:123], v[116:119], v[88:103]
    v_and_b32_dpp v116, v116, v56 wave_shr:1 row_mask:0xf bank_mask:0xf bound_ctrl:0
    v_and_b32_dpp v117, v117, v56 wave_shr:1 row_mask:0xf bank_mask:0xf bound_ctrl:0
    v_and_b32_dpp v118, v118, v56 wave_shr:1 row_mask:0xf bank_mask:0xf bound_ctrl:0
    v_and_b32_dpp v119, v119, v56 wave_shr:1 row_mask:0xf bank_mask:0xf bound_ctrl:0
    ds_read_b128 v[152:155], v54 offset:576
    ds_read_b128 v[156:159], v54 offset:608
    ds_read_b128 v[120:123], v54 offset:640
    ds_read_b128 v[124:127], v54 offset:672
    s_waitcnt lgkmcnt(4)
    v_mfma_f32_32x32x16_bf16 v[72:87], v[140:143], v[104:107], v[72:87]
    v_mfma_f32_32x32x16_bf16 v[88:103], v[148:151], v[104:107], v[88:103]
    v_and_b32_dpp v104, v104, v56 wave_shr:1 row_mask:0xf bank_mask:0xf bound_ctrl:0
    v_and_b32_dpp v105, v105, v56 wave_shr:1 row_mask:0xf bank_mask:0xf bound_ctrl:0
    v_and_b32_dpp v106, v106, v56 wave_shr:1 row_mask:0xf bank_mask:0xf bound_ctrl:0
    v_and_b32_dpp v107, v107, v56 wave_shr:1 row_mask:0xf bank_mask:0xf bound_ctrl:0
    v_mfma_f32_32x32x16_bf16 v[72:87], v[136:139], v[108:111], v[72:87]
    v_mfma_f32_32x32x16_bf16 v[88:103], v[144:147], v[108:111], v[88:103]
    v_and_b32_dpp v108, v108, v56 wave_shr:1 row_mask:0xf bank_mask:0xf bound_ctrl:0
    v_and_b32_dpp v109, v109, v56 wave_shr:1 row_mask:0xf bank_mask:0xf bound_ctrl:0
    v_and_b32_dpp v110, v110, v56 wave_shr:1 row_mask:0xf bank_mask:0xf bound_ctrl:0
    v_and_b32_dpp v111, v111, v56 wave_shr:1 row_mask:0xf bank_mask:0xf bound_ctrl:0
    v_mfma_f32_32x32x16_bf16 v[72:87], v[132:135], v[112:115], v[72:87]
    v_mfma_f32_32x32x16_bf16 v[88:103], v[140:143], v[112:115], v[88:103]
    v_and_b32_dpp v112, v112, v56 wave_shr:1 row_mask:0xf bank_mask:0xf bound_ctrl:0
    v_and_b32_dpp v113, v113, v56 wave_shr:1 row_mask:0xf bank_mask:0xf bound_ctrl:0
    v_and_b32_dpp v114, v114, v56 wave_shr:1 row_mask:0xf bank_mask:0xf bound_ctrl:0
    v_and_b32_dpp v115, v115, v56 wave_shr:1 row_mask:0xf bank_mask:0xf bound_ctrl:0
    v_mfma_f32_32x32x16_bf16 v[72:87], v[128:131], v[116:119], v[72:87]
    v_mfma_f32_32x32x16_bf16 v[88:103], v[136:139], v[116:119], v[88:103]
    v_and_b32_dpp v116, v116, v56 wave_shr:1 row_mask:0xf bank_mask:0xf bound_ctrl:0
    v_and_b32_dpp v117, v117, v56 wave_shr:1 row_mask:0xf bank_mask:0xf bound_ctrl:0
    v_and_b32_dpp v118, v118, v56 wave_shr:1 row_mask:0xf bank_mask:0xf bound_ctrl:0
    v_and_b32_dpp v119, v119, v56 wave_shr:1 row_mask:0xf bank_mask:0xf bound_ctrl:0
    ds_read_b128 v[128:131], v54 offset:704
    ds_read_b128 v[132:135], v54 offset:736
    ds_read_b128 v[136:139], v54 offset:768
    ds_read_b128 v[140:143], v54 offset:800
    s_waitcnt lgkmcnt(4)
    v_mfma_f32_32x32x16_bf16 v[72:87], v[156:159], v[104:107], v[72:87]
    v_mfma_f32_32x32x16_bf16 v[88:103], v[124:127], v[104:107], v[88:103]
    v_and_b32_dpp v104, v104, v56 wave_shr:1 row_mask:0xf bank_mask:0xf bound_ctrl:0
    v_and_b32_dpp v105, v105, v56 wave_shr:1 row_mask:0xf bank_mask:0xf bound_ctrl:0
    v_and_b32_dpp v106, v106, v56 wave_shr:1 row_mask:0xf bank_mask:0xf bound_ctrl:0
    v_and_b32_dpp v107, v107, v56 wave_shr:1 row_mask:0xf bank_mask:0xf bound_ctrl:0
    v_mfma_f32_32x32x16_bf16 v[72:87], v[152:155], v[108:111], v[72:87]
    v_mfma_f32_32x32x16_bf16 v[88:103], v[120:123], v[108:111], v[88:103]
    v_and_b32_dpp v108, v108, v56 wave_shr:1 row_mask:0xf bank_mask:0xf bound_ctrl:0
    v_and_b32_dpp v109, v109, v56 wave_shr:1 row_mask:0xf bank_mask:0xf bound_ctrl:0
    v_and_b32_dpp v110, v110, v56 wave_shr:1 row_mask:0xf bank_mask:0xf bound_ctrl:0
    v_and_b32_dpp v111, v111, v56 wave_shr:1 row_mask:0xf bank_mask:0xf bound_ctrl:0
    v_mfma_f32_32x32x16_bf16 v[72:87], v[148:151], v[112:115], v[72:87]
    v_mfma_f32_32x32x16_bf16 v[88:103], v[156:159], v[112:115], v[88:103]
    v_and_b32_dpp v112, v112, v56 wave_shr:1 row_mask:0xf bank_mask:0xf bound_ctrl:0
    v_and_b32_dpp v113, v113, v56 wave_shr:1 row_mask:0xf bank_mask:0xf bound_ctrl:0
    v_and_b32_dpp v114, v114, v56 wave_shr:1 row_mask:0xf bank_mask:0xf bound_ctrl:0
    v_and_b32_dpp v115, v115, v56 wave_shr:1 row_mask:0xf bank_mask:0xf bound_ctrl:0
    v_mfma_f32_32x32x16_bf16 v[72:87], v[144:147], v[116:119], v[72:87]
    v_mfma_f32_32x32x16_bf16 v[88:103], v[152:155], v[116:119], v[88:103]
    v_and_b32_dpp v116, v116, v56 wave_shr:1 row_mask:0xf bank_mask:0xf bound_ctrl:0
    v_and_b32_dpp v117, v117, v56 wave_shr:1 row_mask:0xf bank_mask:0xf bound_ctrl:0
    v_and_b32_dpp v118, v118, v56 wave_shr:1 row_mask:0xf bank_mask:0xf bound_ctrl:0
    v_and_b32_dpp v119, v119, v56 wave_shr:1 row_mask:0xf bank_mask:0xf bound_ctrl:0
    ds_read_b128 v[144:147], v54 offset:832
    ds_read_b128 v[148:151], v54 offset:864
    ds_read_b128 v[152:155], v54 offset:896
    ds_read_b128 v[156:159], v54 offset:928
    s_waitcnt lgkmcnt(4)
    v_mfma_f32_32x32x16_bf16 v[72:87], v[132:135], v[104:107], v[72:87]
    v_mfma_f32_32x32x16_bf16 v[88:103], v[140:143], v[104:107], v[88:103]
    v_and_b32_dpp v104, v104, v56 wave_shr:1 row_mask:0xf bank_mask:0xf bound_ctrl:0
    v_and_b32_dpp v105, v105, v56 wave_shr:1 row_mask:0xf bank_mask:0xf bound_ctrl:0
    v_and_b32_dpp v106, v106, v56 wave_shr:1 row_mask:0xf bank_mask:0xf bound_ctrl:0
    v_and_b32_dpp v107, v107, v56 wave_shr:1 row_mask:0xf bank_mask:0xf bound_ctrl:0
    v_mfma_f32_32x32x16_bf16 v[72:87], v[128:131], v[108:111], v[72:87]
    v_mfma_f32_32x32x16_bf16 v[88:103], v[136:139], v[108:111], v[88:103]
    v_and_b32_dpp v108, v108, v56 wave_shr:1 row_mask:0xf bank_mask:0xf bound_ctrl:0
    v_and_b32_dpp v109, v109, v56 wave_shr:1 row_mask:0xf bank_mask:0xf bound_ctrl:0
    v_and_b32_dpp v110, v110, v56 wave_shr:1 row_mask:0xf bank_mask:0xf bound_ctrl:0
    v_and_b32_dpp v111, v111, v56 wave_shr:1 row_mask:0xf bank_mask:0xf bound_ctrl:0
    v_mfma_f32_32x32x16_bf16 v[72:87], v[124:127], v[112:115], v[72:87]
    v_mfma_f32_32x32x16_bf16 v[88:103], v[132:135], v[112:115], v[88:103]
    v_and_b32_dpp v112, v112, v56 wave_shr:1 row_mask:0xf bank_mask:0xf bound_ctrl:0
    v_and_b32_dpp v113, v113, v56 wave_shr:1 row_mask:0xf bank_mask:0xf bound_ctrl:0
    v_and_b32_dpp v114, v114, v56 wave_shr:1 row_mask:0xf bank_mask:0xf bound_ctrl:0
    v_and_b32_dpp v115, v115, v56 wave_shr:1 row_mask:0xf bank_mask:0xf bound_ctrl:0
    v_mfma_f32_32x32x16_bf16 v[72:87], v[120:123], v[116:119], v[72:87]
    v_mfma_f32_32x32x16_bf16 v[88:103], v[128:131], v[116:119], v[88:103]
    v_and_b32_dpp v116, v116, v56 wave_shr:1 row_mask:0xf bank_mask:0xf bound_ctrl:0
    v_and_b32_dpp v117, v117, v56 wave_shr:1 row_mask:0xf bank_mask:0xf bound_ctrl:0
    v_and_b32_dpp v118, v118, v56 wave_shr:1 row_mask:0xf bank_mask:0xf bound_ctrl:0
    v_and_b32_dpp v119, v119, v56 wave_shr:1 row_mask:0xf bank_mask:0xf bound_ctrl:0
    ds_read_b128 v[120:123], v54 offset:960
    ds_read_b128 v[124:127], v54 offset:992
    ds_read_b128 v[128:131], v54 offset:1024
    ds_read_b128 v[132:135], v54 offset:1056
    s_waitcnt lgkmcnt(4)
    v_mfma_f32_32x32x16_bf16 v[72:87], v[148:151], v[104:107], v[72:87]
    v_mfma_f32_32x32x16_bf16 v[88:103], v[156:159], v[104:107], v[88:103]
    v_and_b32_dpp v104, v104, v56 wave_shr:1 row_mask:0xf bank_mask:0xf bound_ctrl:0
    v_and_b32_dpp v105, v105, v56 wave_shr:1 row_mask:0xf bank_mask:0xf bound_ctrl:0
    v_and_b32_dpp v106, v106, v56 wave_shr:1 row_mask:0xf bank_mask:0xf bound_ctrl:0
    v_and_b32_dpp v107, v107, v56 wave_shr:1 row_mask:0xf bank_mask:0xf bound_ctrl:0
    v_mfma_f32_32x32x16_bf16 v[72:87], v[144:147], v[108:111], v[72:87]
    v_mfma_f32_32x32x16_bf16 v[88:103], v[152:155], v[108:111], v[88:103]
    v_and_b32_dpp v108, v108, v56 wave_shr:1 row_mask:0xf bank_mask:0xf bound_ctrl:0
    v_and_b32_dpp v109, v109, v56 wave_shr:1 row_mask:0xf bank_mask:0xf bound_ctrl:0
    v_and_b32_dpp v110, v110, v56 wave_shr:1 row_mask:0xf bank_mask:0xf bound_ctrl:0
    v_and_b32_dpp v111, v111, v56 wave_shr:1 row_mask:0xf bank_mask:0xf bound_ctrl:0
    v_mfma_f32_32x32x16_bf16 v[72:87], v[140:143], v[112:115], v[72:87]
    v_mfma_f32_32x32x16_bf16 v[88:103], v[148:151], v[112:115], v[88:103]
    v_and_b32_dpp v112, v112, v56 wave_shr:1 row_mask:0xf bank_mask:0xf bound_ctrl:0
    v_and_b32_dpp v113, v113, v56 wave_shr:1 row_mask:0xf bank_mask:0xf bound_ctrl:0
    v_and_b32_dpp v114, v114, v56 wave_shr:1 row_mask:0xf bank_mask:0xf bound_ctrl:0
    v_and_b32_dpp v115, v115, v56 wave_shr:1 row_mask:0xf bank_mask:0xf bound_ctrl:0
    v_mfma_f32_32x32x16_bf16 v[72:87], v[136:139], v[116:119], v[72:87]
    v_mfma_f32_32x32x16_bf16 v[88:103], v[144:147], v[116:119], v[88:103]
    v_and_b32_dpp v116, v116, v56 wave_shr:1 row_mask:0xf bank_mask:0xf bound_ctrl:0
    v_and_b32_dpp v117, v117, v56 wave_shr:1 row_mask:0xf bank_mask:0xf bound_ctrl:0
    v_and_b32_dpp v118, v118, v56 wave_shr:1 row_mask:0xf bank_mask:0xf bound_ctrl:0
    v_and_b32_dpp v119, v119, v56 wave_shr:1 row_mask:0xf bank_mask:0xf bound_ctrl:0
    s_waitcnt lgkmcnt(0)
    v_mfma_f32_32x32x16_bf16 v[72:87], v[124:127], v[104:107], v[72:87]
    v_mfma_f32_32x32x16_bf16 v[88:103], v[132:135], v[104:107], v[88:103]
    v_mfma_f32_32x32x16_bf16 v[72:87], v[120:123], v[108:111], v[72:87]
    v_mfma_f32_32x32x16_bf16 v[88:103], v[128:131], v[108:111], v[88:103]
    v_mfma_f32_32x32x16_bf16 v[72:87], v[156:159], v[112:115], v[72:87]
    v_mfma_f32_32x32x16_bf16 v[88:103], v[124:127], v[112:115], v[88:103]
    v_mfma_f32_32x32x16_bf16 v[72:87], v[152:155], v[116:119], v[72:87]
    v_mfma_f32_32x32x16_bf16 v[88:103], v[120:123], v[116:119], v[88:103]
    s_nop 10
    ds_write_b128 v68, v[72:75] offset:0
    ds_write_b128 v68, v[76:79] offset:32
    ds_write_b128 v68, v[80:83] offset:64
    ds_write_b128 v68, v[84:87] offset:96
    ds_write_b128 v68, v[88:91] offset:128
    ds_write_b128 v68, v[92:95] offset:160
    ds_write_b128 v68, v[96:99] offset:192
    ds_write_b128 v68, v[100:103] offset:224
    s_waitcnt lgkmcnt(0)
    s_barrier
    ds_read_b128 v[120:123], v69 offset:0
    ds_read_b128 v[124:127], v69 offset:16
    ds_read_b128 v[128:131], v69 offset:8704
    ds_read_b128 v[132:135], v69 offset:8720
    ds_read_b128 v[136:139], v69 offset:17408
    ds_read_b128 v[140:143], v69 offset:17424
    ds_read_b128 v[144:147], v69 offset:26112
    ds_read_b128 v[148:151], v69 offset:26128
    s_waitcnt lgkmcnt(0)
    v_pk_add_f32 v[120:121], v[120:121], v[128:129]
    v_pk_add_f32 v[122:123], v[122:123], v[130:131]
    v_pk_add_f32 v[124:125], v[124:125], v[132:133]
    v_pk_add_f32 v[126:127], v[126:127], v[134:135]
    v_pk_add_f32 v[120:121], v[120:121], v[136:137]
    v_pk_add_f32 v[122:123], v[122:123], v[138:139]
    v_pk_add_f32 v[124:125], v[124:125], v[140:141]
    v_pk_add_f32 v[126:127], v[126:127], v[142:143]
    v_pk_add_f32 v[120:121], v[120:121], v[144:145]
    v_pk_add_f32 v[122:123], v[122:123], v[146:147]
    v_pk_add_f32 v[124:125], v[124:125], v[148:149]
    v_pk_add_f32 v[126:127], v[126:127], v[150:151]
    v_cvt_pk_bf16_f32 v168, v120, v121
    v_cvt_pk_bf16_f32 v169, v122, v123
    v_cvt_pk_bf16_f32 v170, v124, v125
    v_cvt_pk_bf16_f32 v171, v126, v127
    s_lshl_b32 s40, s35, 12
    s_add_u32 s40, s40, 8912896
    buffer_store_dwordx4 v[168:171], v2, s[8:11], s40 offen
    s_nop 1
    s_cmp_ge_u32 s32, 128
    s_cbranch_scc1 k2_kernel_cend
    s_add_u32 s35, s32, 512
    s_waitcnt vmcnt(2)
    v_cmp_ne_u32 vcc, 0, v0
    s_nop 1
    v_cndmask_b32 v24, 0, v24, vcc
    v_cndmask_b32 v25, 0, v25, vcc
    v_cndmask_b32 v26, 0, v26, vcc
    v_cndmask_b32 v27, 0, v27, vcc
    v_alignbit_b32 v160, v25, v24, 16
    v_alignbit_b32 v161, v26, v25, 16
    v_alignbit_b32 v162, v27, v26, 16
    v_alignbit_b32 v163, v28, v27, 16
    v_alignbit_b32 v164, v29, v28, 16
    v_alignbit_b32 v165, v30, v29, 16
    v_alignbit_b32 v166, v31, v30, 16
    ds_write_b128 v52, v[160:163] offset:0
    v_mov_b32 v168, v25
    v_mov_b32 v169, v26
    v_mov_b32 v170, v27
    v_mov_b32 v171, v28
    ds_write_b128 v52, v[168:171] offset:4416
    s_nop 1
    v_mov_b32 v168, v161
    v_mov_b32 v169, v162
    v_mov_b32 v170, v163
    v_mov_b32 v171, v164
    ds_write_b128 v52, v[168:171] offset:8832
    s_nop 1
    ds_write_b128 v52, v[26:29] offset:13248
    ds_write_b128 v52, v[162:165] offset:17664
    v_mov_b32 v168, v27
    v_mov_b32 v169, v28
    v_mov_b32 v170, v29
    v_mov_b32 v171, v30
    ds_write_b128 v52, v[168:171] offset:22080
    s_nop 1
    v_mov_b32 v168, v163
    v_mov_b32 v169, v164
    v_mov_b32 v170, v165
    v_mov_b32 v171, v166
    ds_write_b128 v52, v[168:171] offset:26496
    s_nop 1
    ds_write_b128 v52, v[28:31] offset:30912
    ds_write_b128 v53, v[40:43]
    v_lshlrev_b32 v3, 16, v46
    v_or_b32 v3, v3, v46
    v_and_b32 v172, v60, v3
    v_and_b32 v173, v61, v3
    v_and_b32 v174, v62, v3
    v_and_b32 v175, v63, v3
    v_and_b32 v176, v64, v3
    v_and_b32 v177, v65, v3
    v_and_b32 v178, v66, v3
    v_and_b32 v179, v67, v3
    s_waitcnt lgkmcnt(0)
    s_barrier
    ds_read_b128 v[104:107], v55 offset:35328
    ds_read_b128 v[108:111], v55 offset:35360
    ds_read_b128 v[112:115], v55 offset:35392
    ds_read_b128 v[116:119], v55 offset:35424
    ds_read_b128 v[120:123], v54 offset:0
    ds_read_b128 v[124:127], v54 offset:32
    ds_read_b128 v[128:131], v54 offset:64
    ds_read_b128 v[132:135], v54 offset:96
    ds_read_b128 v[136:139], v54 offset:128
    ds_read_b128 v[140:143], v54 offset:160
    ds_read_b128 v[144:147], v54 offset:192
    ds_read_b128 v[148:151], v54 offset:224
    ds_read_b128 v[152:155], v54 offset:256
    ds_read_b128 v[156:159], v54 offset:288
    s_waitcnt lgkmcnt(4)
    v_mfma_f32_32x32x16_bf16 v[72:87], v[132:135], v[104:107], 0
    v_mfma_f32_32x32x16_bf16 v[88:103], v[140:143], v[104:107], 0
    s_cmp_lg_u32 s34, 0
    s_cbranch_scc1 c_dg_15
    v_mfma_f32_32x32x16_bf16 v[72:87], v[172:175], v[104:107], v[72:87]
c_dg_15:
    v_and_b32_dpp v104, v104, v56 wave_shr:1 row_mask:0xf bank_mask:0xf bound_ctrl:0
    v_and_b32_dpp v105, v105, v56 wave_shr:1 row_mask:0xf bank_mask:0xf bound_ctrl:0
    v_and_b32_dpp v106, v106, v56 wave_shr:1 row_mask:0xf bank_mask:0xf bound_ctrl:0
    v_and_b32_dpp v107, v107, v56 wave_shr:1 row_mask:0xf bank_mask:0xf bound_ctrl:0
    v_mfma_f32_32x32x16_bf16 v[72:87], v[128:131], v[108:111], v[72:87]
    v_mfma_f32_32x32x16_bf16 v[88:103], v[136:139], v[108:111], v[88:103]
    s_cmp_lg_u32 s34, 0
    s_cbranch_scc1 c_dg_16
    v_mfma_f32_32x32x16_bf16 v[72:87], v[176:179], v[108:111], v[72:87]
c_dg_16:
    v_and_b32_dpp v108, v108, v56 wave_shr:1 row_mask:0xf bank_mask:0xf bound_ctrl:0
    v_and_b32_dpp v109, v109, v56 wave_shr:1 row_mask:0xf bank_mask:0xf bound_ctrl:0
    v_and_b32_dpp v110, v110, v56 wave_shr:1 row_mask:0xf bank_mask:0xf bound_ctrl:0
    v_and_b32_dpp v111, v111, v56 wave_shr:1 row_mask:0xf bank_mask:0xf bound_ctrl:0
    v_mfma_f32_32x32x16_bf16 v[72:87], v[124:127], v[112:115], v[72:87]
    v_mfma_f32_32x32x16_bf16 v[88:103], v[132:135], v[112:115], v[88:103]
    s_cmp_lg_u32 s34, 0
    s_cbranch_scc1 c_dg_17
    v_mfma_f32_32x32x16_bf16 v[88:103], v[172:175], v[112:115], v[88:103]
c_dg_17:
    v_and_b32_dpp v112, v112, v56 wave_shr:1 row_mask:0xf bank_mask:0xf bound_ctrl:0
    v_and_b32_dpp v113, v113, v56 wave_shr:1 row_mask:0xf bank_mask:0xf bound_ctrl:0
    v_and_b32_dpp v114, v114, v56 wave_shr:1 row_mask:0xf bank_mask:0xf bound_ctrl:0
    v_and_b32_dpp v115, v115, v56 wave_shr:1 row_mask:0xf bank_mask:0xf bound_ctrl:0
    v_mfma_f32_32x32x16_bf16 v[72:87], v[120:123], v[116:119], v[72:87]
    v_mfma_f32_32x32x16_bf16 v[88:103], v[128:131], v[116:119], v[88:103]
    s_cmp_lg_u32 s34, 0
    s_cbranch_scc1 c_dg_18
    v_mfma_f32_32x32x16_bf16 v[88:103], v[176:179], v[116:119], v[88:103]
c_dg_18:
    v_and_b32_dpp v116, v116, v56 wave_shr:1 row_mask:0xf bank_mask:0xf bound_ctrl:0
    v_and_b32_dpp v117, v117, v56 wave_shr:1 row_mask:0xf bank_mask:0xf bound_ctrl:0
    v_and_b32_dpp v118, v118, v56 wave_shr:1 row_mask:0xf bank_mask:0xf bound_ctrl:0
    v_and_b32_dpp v119, v119, v56 wave_shr:1 row_mask:0xf bank_mask:0xf bound_ctrl:0
    ds_read_b128 v[120:123], v54 offset:320
    ds_read_b128 v[124:127], v54 offset:352
    ds_read_b128 v[128:131], v54 offset:384
    ds_read_b128 v[132:135], v54 offset:416
    s_waitcnt lgkmcnt(4)
    v_mfma_f32_32x32x16_bf16 v[72:87], v[148:151], v[104:107], v[72:87]
    v_mfma_f32_32x32x16_bf16 v[88:103], v[156:159], v[104:107], v[88:103]
    v_and_b32_dpp v104, v104, v56 wave_shr:1 row_mask:0xf bank_mask:0xf bound_ctrl:0
    v_and_b32_dpp v105, v105, v56 wave_shr:1 row_mask:0xf bank_mask:0xf bound_ctrl:0
    v_and_b32_dpp v106, v106, v56 wave_shr:1 row_mask:0xf bank_mask:0xf bound_ctrl:0
    v_and_b32_dpp v107, v107, v56 wave_shr:1 row_mask:0xf bank_mask:0xf bound_ctrl:0
    v_mfma_f32_32x32x16_bf16 v[72:87], v[144:147], v[108:111], v[72:87]
    v_mfma_f32_32x32x16_bf16 v[88:103], v[152:155], v[108:111], v[88:103]
    v_and_b32_dpp v108, v108, v56 wave_shr:1 row_mask:0xf bank_mask:0xf bound_ctrl:0
    v_and_b32_dpp v109, v109, v56 wave_shr:1 row_mask:0xf bank_mask:0xf bound_ctrl:0
    v_and_b32_dpp v110, v110, v56 wave_shr:1 row_mask:0xf bank_mask:0xf bound_ctrl:0
    v_and_b32_dpp v111, v111, v56 wave_shr:1 row_mask:0xf bank_mask:0xf bound_ctrl:0
    v_mfma_f32_32x32x16_bf16 v[72:87], v[140:143], v[112:115], v[72:87]
    v_mfma_f32_32x32x16_bf16 v[88:103], v[148:151], v[112:115], v[88:103]
    v_and_b32_dpp v112, v112, v56 wave_shr:1 row_mask:0xf bank_mask:0xf bound_ctrl:0
    v_and_b32_dpp v113, v113, v56 wave_shr:1 row_mask:0xf bank_mask:0xf bound_ctrl:0
    v_and_b32_dpp v114, v114, v56 wave_shr:1 row_mask:0xf bank_mask:0xf bound_ctrl:0
    v_and_b32_dpp v115, v115, v56 wave_shr:1 row_mask:0xf bank_mask:0xf bound_ctrl:0
    v_mfma_f32_32x32x16_bf16 v[72:87], v[136:139], v[116:119], v[72:87]
    v_mfma_f32_32x32x16_bf16 v[88:103], v[144:147], v[116:119], v[88:103]
    v_and_b32_dpp v116, v116, v56 wave_shr:1 row_mask:0xf bank_mask:0xf bound_ctrl:0
    v_and_b32_dpp v117, v117, v56 wave_shr:1 row_mask:0xf bank_mask:0xf bound_ctrl:0
    v_and_b32_dpp v118, v118, v56 wave_shr:1 row_mask:0xf bank_mask:0xf bound_ctrl:0
    v_and_b32_dpp v119, v119, v56 wave_shr:1 row_mask:0xf bank_mask:0xf bound_ctrl:0
    ds_read_b128 v[136:139], v54 offset:448
    ds_read_b128 v[140:143], v54 offset:480
    ds_read_b128 v[144:147], v54 offset:512
    ds_read_b128 v[148:151], v54 offset:544
    s_waitcnt lgkmcnt(4)
    v_mfma_f32_32x32x16_bf16 v[72:87], v[124:127], v[104:107], v[72:87]
    v_mfma_f32_32x32x16_bf16 v[88:103], v[132:135], v[104:107], v[88:103]
    v_and_b32_dpp v104, v104, v56 wave_shr:1 row_mask:0xf bank_mask:0xf bound_ctrl:0
    v_and_b32_dpp v105, v105, v56 wave_shr:1 row_mask:0xf bank_mask:0xf bound_ctrl:0
    v_and_b32_dpp v106, v106, v56 wave_shr:1 row_mask:0xf bank_mask:0xf bound_ctrl:0
    v_and_b32_dpp v107, v107, v56 wave_shr:1 row_mask:0xf bank_mask:0xf bound_ctrl:0
    v_mfma_f32_32x32x16_bf16 v[72:87], v[120:123], v[108:111], v[72:87]
    v_mfma_f32_32x32x16_bf16 v[88:103], v[128:131], v[108:111], v[88:103]
    v_and_b32_dpp v108, v108, v56 wave_shr:1 row_mask:0xf bank_mask:0xf bound_ctrl:0
    v_and_b32_dpp v109, v109, v56 wave_shr:1 row_mask:0xf bank_mask:0xf bound_ctrl:0
    v_and_b32_dpp v110, v110, v56 wave_shr:1 row_mask:0xf bank_mask:0xf bound_ctrl:0
    v_and_b32_dpp v111, v111, v56 wave_shr:1 row_mask:0xf bank_mask:0xf bound_ctrl:0
    v_mfma_f32_32x32x16_bf16 v[72:87], v[156:159], v[112:115], v[72:87]
    v_mfma_f32_32x32x16_bf16 v[88:103], v[124:127], v[112:115], v[88:103]
    v_and_b32_dpp v112, v112, v56 wave_shr:1 row_mask:0xf bank_mask:0xf bound_ctrl:0
    v_and_b32_dpp v113, v113, v56 wave_shr:1 row_mask:0xf bank_mask:0xf bound_ctrl:0
    v_and_b32_dpp v114, v114, v56 wave_shr:1 row_mask:0xf bank_mask:0xf bound_ctrl:0
    v_and_b32_dpp v115, v115, v56 wave_shr:1 row_mask:0xf bank_mask:0xf bound_ctrl:0
    v_mfma_f32_32x32x16_bf16 v[72:87], v[152:155], v[116:119], v[72:87]
    v_mfma_f32_32x32x16_bf16 v[88:103], v[120:123], v[116:119], v[88:103]
    v_and_b32_dpp v116, v116, v56 wave_shr:1 row_mask:0xf bank_mask:0xf bound_ctrl:0
    v_and_b32_dpp v117, v117, v56 wave_shr:1 row_mask:0xf bank_mask:0xf bound_ctrl:0
    v_and_b32_dpp v118, v118, v56 wave_shr:1 row_mask:0xf bank_mask:0xf bound_ctrl:0
    v_and_b32_dpp v119, v119, v56 wave_shr:1 row_mask:0xf bank_mask:0xf bound_ctrl:0
    ds_read_b128 v[152:155], v54 offset:576
    ds_read_b128 v[156:159], v54 offset:608
    ds_read_b128 v[120:123], v54 offset:640
    ds_read_b128 v[124:127], v54 offset:672
    s_waitcnt lgkmcnt(4)
    v_mfma_f32_32x32x16_bf16 v[72:87], v[140:143], v[104:107], v[72:87]
    v_mfma_f32_32x32x16_bf16 v[88:103], v[148:151], v[104:107], v[88:103]
    v_and_b32_dpp v104, v104, v56 wave_shr:1 row_mask:0xf bank_mask:0xf bound_ctrl:0
    v_and_b32_dpp v105, v105, v56 wave_shr:1 row_mask:0xf bank_mask:0xf bound_ctrl:0
    v_and_b32_dpp v106, v106, v56 wave_shr:1 row_mask:0xf bank_mask:0xf bound_ctrl:0
    v_and_b32_dpp v107, v107, v56 wave_shr:1 row_mask:0xf bank_mask:0xf bound_ctrl:0
    v_mfma_f32_32x32x16_bf16 v[72:87], v[136:139], v[108:111], v[72:87]
    v_mfma_f32_32x32x16_bf16 v[88:103], v[144:147], v[108:111], v[88:103]
    v_and_b32_dpp v108, v108, v56 wave_shr:1 row_mask:0xf bank_mask:0xf bound_ctrl:0
    v_and_b32_dpp v109, v109, v56 wave_shr:1 row_mask:0xf bank_mask:0xf bound_ctrl:0
    v_and_b32_dpp v110, v110, v56 wave_shr:1 row_mask:0xf bank_mask:0xf bound_ctrl:0
    v_and_b32_dpp v111, v111, v56 wave_shr:1 row_mask:0xf bank_mask:0xf bound_ctrl:0
    v_mfma_f32_32x32x16_bf16 v[72:87], v[132:135], v[112:115], v[72:87]
    v_mfma_f32_32x32x16_bf16 v[88:103], v[140:143], v[112:115], v[88:103]
    v_and_b32_dpp v112, v112, v56 wave_shr:1 row_mask:0xf bank_mask:0xf bound_ctrl:0
    v_and_b32_dpp v113, v113, v56 wave_shr:1 row_mask:0xf bank_mask:0xf bound_ctrl:0
    v_and_b32_dpp v114, v114, v56 wave_shr:1 row_mask:0xf bank_mask:0xf bound_ctrl:0
    v_and_b32_dpp v115, v115, v56 wave_shr:1 row_mask:0xf bank_mask:0xf bound_ctrl:0
    v_mfma_f32_32x32x16_bf16 v[72:87], v[128:131], v[116:119], v[72:87]
    v_mfma_f32_32x32x16_bf16 v[88:103], v[136:139], v[116:119], v[88:103]
    v_and_b32_dpp v116, v116, v56 wave_shr:1 row_mask:0xf bank_mask:0xf bound_ctrl:0
    v_and_b32_dpp v117, v117, v56 wave_shr:1 row_mask:0xf bank_mask:0xf bound_ctrl:0
    v_and_b32_dpp v118, v118, v56 wave_shr:1 row_mask:0xf bank_mask:0xf bound_ctrl:0
    v_and_b32_dpp v119, v119, v56 wave_shr:1 row_mask:0xf bank_mask:0xf bound_ctrl:0
    ds_read_b128 v[128:131], v54 offset:704
    ds_read_b128 v[132:135], v54 offset:736
    ds_read_b128 v[136:139], v54 offset:768
    ds_read_b128 v[140:143], v54 offset:800
    s_waitcnt lgkmcnt(4)
    v_mfma_f32_32x32x16_bf16 v[72:87], v[156:159], v[104:107], v[72:87]
    v_mfma_f32_32x32x16_bf16 v[88:103], v[124:127], v[104:107], v[88:103]
    v_and_b32_dpp v104, v104, v56 wave_shr:1 row_mask:0xf bank_mask:0xf bound_ctrl:0
    v_and_b32_dpp v105, v105, v56 wave_shr:1 row_mask:0xf bank_mask:0xf bound_ctrl:0
    v_and_b32_dpp v106, v106, v56 wave_shr:1 row_mask:0xf bank_mask:0xf bound_ctrl:0
    v_and_b32_dpp v107, v107, v56 wave_shr:1 row_mask:0xf bank_mask:0xf bound_ctrl:0
    v_mfma_f32_32x32x16_bf16 v[72:87], v[152:155], v[108:111], v[72:87]
    v_mfma_f32_32x32x16_bf16 v[88:103], v[120:123], v[108:111], v[88:103]
    v_and_b32_dpp v108, v108, v56 wave_shr:1 row_mask:0xf bank_mask:0xf bound_ctrl:0
    v_and_b32_dpp v109, v109, v56 wave_shr:1 row_mask:0xf bank_mask:0xf bound_ctrl:0
    v_and_b32_dpp v110, v110, v56 wave_shr:1 row_mask:0xf bank_mask:0xf bound_ctrl:0
    v_and_b32_dpp v111, v111, v56 wave_shr:1 row_mask:0xf bank_mask:0xf bound_ctrl:0
    v_mfma_f32_32x32x16_bf16 v[72:87], v[148:151], v[112:115], v[72:87]
    v_mfma_f32_32x32x16_bf16 v[88:103], v[156:159], v[112:115], v[88:103]
    v_and_b32_dpp v112, v112, v56 wave_shr:1 row_mask:0xf bank_mask:0xf bound_ctrl:0
    v_and_b32_dpp v113, v113, v56 wave_shr:1 row_mask:0xf bank_mask:0xf bound_ctrl:0
    v_and_b32_dpp v114, v114, v56 wave_shr:1 row_mask:0xf bank_mask:0xf bound_ctrl:0
    v_and_b32_dpp v115, v115, v56 wave_shr:1 row_mask:0xf bank_mask:0xf bound_ctrl:0
    v_mfma_f32_32x32x16_bf16 v[72:87], v[144:147], v[116:119], v[72:87]
    v_mfma_f32_32x32x16_bf16 v[88:103], v[152:155], v[116:119], v[88:103]
    v_and_b32_dpp v116, v116, v56 wave_shr:1 row_mask:0xf bank_mask:0xf bound_ctrl:0
    v_and_b32_dpp v117, v117, v56 wave_shr:1 row_mask:0xf bank_mask:0xf bound_ctrl:0
    v_and_b32_dpp v118, v118, v56 wave_shr:1 row_mask:0xf bank_mask:0xf bound_ctrl:0
    v_and_b32_dpp v119, v119, v56 wave_shr:1 row_mask:0xf bank_mask:0xf bound_ctrl:0
    ds_read_b128 v[144:147], v54 offset:832
    ds_read_b128 v[148:151], v54 offset:864
    ds_read_b128 v[152:155], v54 offset:896
    ds_read_b128 v[156:159], v54 offset:928
    s_waitcnt lgkmcnt(4)
    v_mfma_f32_32x32x16_bf16 v[72:87], v[132:135], v[104:107], v[72:87]
    v_mfma_f32_32x32x16_bf16 v[88:103], v[140:143], v[104:107], v[88:103]
    v_and_b32_dpp v104, v104, v56 wave_shr:1 row_mask:0xf bank_mask:0xf bound_ctrl:0
    v_and_b32_dpp v105, v105, v56 wave_shr:1 row_mask:0xf bank_mask:0xf bound_ctrl:0
    v_and_b32_dpp v106, v106, v56 wave_shr:1 row_mask:0xf bank_mask:0xf bound_ctrl:0
    v_and_b32_dpp v107, v107, v56 wave_shr:1 row_mask:0xf bank_mask:0xf bound_ctrl:0
    v_mfma_f32_32x32x16_bf16 v[72:87], v[128:131], v[108:111], v[72:87]
    v_mfma_f32_32x32x16_bf16 v[88:103], v[136:139], v[108:111], v[88:103]
    v_and_b32_dpp v108, v108, v56 wave_shr:1 row_mask:0xf bank_mask:0xf bound_ctrl:0
    v_and_b32_dpp v109, v109, v56 wave_shr:1 row_mask:0xf bank_mask:0xf bound_ctrl:0
    v_and_b32_dpp v110, v110, v56 wave_shr:1 row_mask:0xf bank_mask:0xf bound_ctrl:0
    v_and_b32_dpp v111, v111, v56 wave_shr:1 row_mask:0xf bank_mask:0xf bound_ctrl:0
    v_mfma_f32_32x32x16_bf16 v[72:87], v[124:127], v[112:115], v[72:87]
    v_mfma_f32_32x32x16_bf16 v[88:103], v[132:135], v[112:115], v[88:103]
    v_and_b32_dpp v112, v112, v56 wave_shr:1 row_mask:0xf bank_mask:0xf bound_ctrl:0
    v_and_b32_dpp v113, v113, v56 wave_shr:1 row_mask:0xf bank_mask:0xf bound_ctrl:0
    v_and_b32_dpp v114, v114, v56 wave_shr:1 row_mask:0xf bank_mask:0xf bound_ctrl:0
    v_and_b32_dpp v115, v115, v56 wave_shr:1 row_mask:0xf bank_mask:0xf bound_ctrl:0
    v_mfma_f32_32x32x16_bf16 v[72:87], v[120:123], v[116:119], v[72:87]
    v_mfma_f32_32x32x16_bf16 v[88:103], v[128:131], v[116:119], v[88:103]
    v_and_b32_dpp v116, v116, v56 wave_shr:1 row_mask:0xf bank_mask:0xf bound_ctrl:0
    v_and_b32_dpp v117, v117, v56 wave_shr:1 row_mask:0xf bank_mask:0xf bound_ctrl:0
    v_and_b32_dpp v118, v118, v56 wave_shr:1 row_mask:0xf bank_mask:0xf bound_ctrl:0
    v_and_b32_dpp v119, v119, v56 wave_shr:1 row_mask:0xf bank_mask:0xf bound_ctrl:0
    ds_read_b128 v[120:123], v54 offset:960
    ds_read_b128 v[124:127], v54 offset:992
    ds_read_b128 v[128:131], v54 offset:1024
    ds_read_b128 v[132:135], v54 offset:1056
    s_waitcnt lgkmcnt(4)
    v_mfma_f32_32x32x16_bf16 v[72:87], v[148:151], v[104:107], v[72:87]
    v_mfma_f32_32x32x16_bf16 v[88:103], v[156:159], v[104:107], v[88:103]
    v_and_b32_dpp v104, v104, v56 wave_shr:1 row_mask:0xf bank_mask:0xf bound_ctrl:0
    v_and_b32_dpp v105, v105, v56 wave_shr:1 row_mask:0xf bank_mask:0xf bound_ctrl:0
    v_and_b32_dpp v106, v106, v56 wave_shr:1 row_mask:0xf bank_mask:0xf bound_ctrl:0
    v_and_b32_dpp v107, v107, v56 wave_shr:1 row_mask:0xf bank_mask:0xf bound_ctrl:0
    v_mfma_f32_32x32x16_bf16 v[72:87], v[144:147], v[108:111], v[72:87]
    v_mfma_f32_32x32x16_bf16 v[88:103], v[152:155], v[108:111], v[88:103]
    v_and_b32_dpp v108, v108, v56 wave_shr:1 row_mask:0xf bank_mask:0xf bound_ctrl:0
    v_and_b32_dpp v109, v109, v56 wave_shr:1 row_mask:0xf bank_mask:0xf bound_ctrl:0
    v_and_b32_dpp v110, v110, v56 wave_shr:1 row_mask:0xf bank_mask:0xf bound_ctrl:0
    v_and_b32_dpp v111, v111, v56 wave_shr:1 row_mask:0xf bank_mask:0xf bound_ctrl:0
    v_mfma_f32_32x32x16_bf16 v[72:87], v[140:143], v[112:115], v[72:87]
    v_mfma_f32_32x32x16_bf16 v[88:103], v[148:151], v[112:115], v[88:103]
    v_and_b32_dpp v112, v112, v56 wave_shr:1 row_mask:0xf bank_mask:0xf bound_ctrl:0
    v_and_b32_dpp v113, v113, v56 wave_shr:1 row_mask:0xf bank_mask:0xf bound_ctrl:0
    v_and_b32_dpp v114, v114, v56 wave_shr:1 row_mask:0xf bank_mask:0xf bound_ctrl:0
    v_and_b32_dpp v115, v115, v56 wave_shr:1 row_mask:0xf bank_mask:0xf bound_ctrl:0
    v_mfma_f32_32x32x16_bf16 v[72:87], v[136:139], v[116:119], v[72:87]
    v_mfma_f32_32x32x16_bf16 v[88:103], v[144:147], v[116:119], v[88:103]
    v_and_b32_dpp v116, v116, v56 wave_shr:1 row_mask:0xf bank_mask:0xf bound_ctrl:0
    v_and_b32_dpp v117, v117, v56 wave_shr:1 row_mask:0xf bank_mask:0xf bound_ctrl:0
    v_and_b32_dpp v118, v118, v56 wave_shr:1 row_mask:0xf bank_mask:0xf bound_ctrl:0
    v_and_b32_dpp v119, v119, v56 wave_shr:1 row_mask:0xf bank_mask:0xf bound_ctrl:0
    s_waitcnt lgkmcnt(0)
    v_mfma_f32_32x32x16_bf16 v[72:87], v[124:127], v[104:107], v[72:87]
    v_mfma_f32_32x32x16_bf16 v[88:103], v[132:135], v[104:107], v[88:103]
    v_mfma_f32_32x32x16_bf16 v[72:87], v[120:123], v[108:111], v[72:87]
    v_mfma_f32_32x32x16_bf16 v[88:103], v[128:131], v[108:111], v[88:103]
    v_mfma_f32_32x32x16_bf16 v[72:87], v[156:159], v[112:115], v[72:87]
    v_mfma_f32_32x32x16_bf16 v[88:103], v[124:127], v[112:115], v[88:103]
    v_mfma_f32_32x32x16_bf16 v[72:87], v[152:155], v[116:119], v[72:87]
    v_mfma_f32_32x32x16_bf16 v[88:103], v[120:123], v[116:119], v[88:103]
    s_nop 10
    ds_write_b128 v68, v[72:75] offset:0
    ds_write_b128 v68, v[76:79] offset:32
    ds_write_b128 v68, v[80:83] offset:64
    ds_write_b128 v68, v[84:87] offset:96
    ds_write_b128 v68, v[88:91] offset:128
    ds_write_b128 v68, v[92:95] offset:160
    ds_write_b128 v68, v[96:99] offset:192
    ds_write_b128 v68, v[100:103] offset:224
    s_waitcnt lgkmcnt(0)
    s_barrier
    ds_read_b128 v[120:123], v69 offset:0
    ds_read_b128 v[124:127], v69 offset:16
    ds_read_b128 v[128:131], v69 offset:8704
    ds_read_b128 v[132:135], v69 offset:8720
    ds_read_b128 v[136:139], v69 offset:17408
    ds_read_b128 v[140:143], v69 offset:17424
    ds_read_b128 v[144:147], v69 offset:26112
    ds_read_b128 v[148:151], v69 offset:26128
    s_waitcnt lgkmcnt(0)
    v_pk_add_f32 v[120:121], v[120:121], v[128:129]
    v_pk_add_f32 v[122:123], v[122:123], v[130:131]
    v_pk_add_f32 v[124:125], v[124:125], v[132:133]
    v_pk_add_f32 v[126:127], v[126:127], v[134:135]
    v_pk_add_f32 v[120:121], v[120:121], v[136:137]
    v_pk_add_f32 v[122:123], v[122:123], v[138:139]
    v_pk_add_f32 v[124:125], v[124:125], v[140:141]
    v_pk_add_f32 v[126:127], v[126:127], v[142:143]
    v_pk_add_f32 v[120:121], v[120:121], v[144:145]
    v_pk_add_f32 v[122:123], v[122:123], v[146:147]
    v_pk_add_f32 v[124:125], v[124:125], v[148:149]
    v_pk_add_f32 v[126:127], v[126:127], v[150:151]
    v_cvt_pk_bf16_f32 v168, v120, v121
    v_cvt_pk_bf16_f32 v169, v122, v123
    v_cvt_pk_bf16_f32 v170, v124, v125
    v_cvt_pk_bf16_f32 v171, v126, v127
    s_lshl_b32 s40, s35, 12
    s_add_u32 s40, s40, 8912896
    buffer_store_dwordx4 v[168:171], v2, s[8:11], s40 offen
    s_nop 1
k2_kernel_cend:
k2_kernel_end:
    s_endpgm

.globl k3_kernel
.p2align 8
.type k3_kernel,@function
k3_kernel:
    s_cmp_ge_u32 s2, 256
    s_cbranch_scc1 k3_kernel_end
    s_load_dwordx2 s[4:5], s[0:1], 80
    s_load_dwordx2 s[8:9], s[0:1], 0
    s_load_dwordx2 s[12:13], s[0:1], 104
    s_load_dwordx2 s[16:17], s[0:1], 88
    s_mov_b32 s6, 983040
    s_mov_b32 s7, 0x20000
    s_mov_b32 s10, 2621440
    s_mov_b32 s11, 0x20000
    s_mov_b32 s14, 15007744
    s_mov_b32 s15, 0x20000
    s_mov_b32 s18, 2621440
    s_mov_b32 s19, 0x20000
    v_lshrrev_b32 v4, 6, v0
    v_and_b32 v1, 63, v0
    v_readfirstlane_b32 s34, v4
    v_lshrrev_b32 v2, 4, v1
    v_and_b32 v3, 15, v1
    s_and_b32 s40, s2, 7
    s_lshr_b32 s41, s2, 3
    s_lshr_b32 s32, s40, 1
    s_lshl_b32 s32, s32, 3
    s_and_b32 s42, s41, 7
    s_add_u32 s32, s32, s42
    s_and_b32 s33, s40, 1
    s_lshl_b32 s33, s33, 2
    s_lshr_b32 s42, s41, 3
    s_add_u32 s33, s33, s42
    s_mul_i32 s44, s33, 160
    s_mul_i32 s45, s32, 81920
    s_add_u32 s45, s45, s44
    v_add_u32 v4, 0, v1
    v_mul_u32_u24 v5, 6554, v4
    v_lshrrev_b32 v5, 16, v5
    v_mul_u32_u24 v6, 10, v5
    v_sub_u32 v4, v4, v6
    v_lshlrev_b32 v4, 4, v4
    v_mul_u32_u24 v5, 1280, v5
    v_add_u32 v7, v4, v5
    v_add_u32 v4, 64, v1
    v_mul_u32_u24 v5, 6554, v4
    v_lshrrev_b32 v5, 16, v5
    v_mul_u32_u24 v6, 10, v5
    v_sub_u32 v4, v4, v6
    v_lshlrev_b32 v4, 4, v4
    v_mul_u32_u24 v5, 1280, v5
    v_add_u32 v8, v4, v5
    v_add_u32 v4, 128, v1
    v_mul_u32_u24 v5, 6554, v4
    v_lshrrev_b32 v5, 16, v5
    v_mul_u32_u24 v6, 10, v5
    v_sub_u32 v4, v4, v6
    v_lshlrev_b32 v4, 4, v4
    v_mul_u32_u24 v5, 1280, v5
    v_add_u32 v9, v4, v5
    v_add_u32 v4, 192, v1
    v_mul_u32_u24 v5, 6554, v4
    v_lshrrev_b32 v5, 16, v5
    v_mul_u32_u24 v6, 10, v5
    v_sub_u32 v4, v4, v6
    v_lshlrev_b32 v4, 4, v4
    v_mul_u32_u24 v5, 1280, v5
    v_add_u32 v10, v4, v5
    v_add_u32 v4, 256, v1
    v_mul_u32_u24 v5, 6554, v4
    v_lshrrev_b32 v5, 16, v5
    v_mul_u32_u24 v6, 10, v5
    v_sub_u32 v4, v4, v6
    v_lshlrev_b32 v4, 4, v4
    v_mul_u32_u24 v5, 1280, v5
    v_add_u32 v11, v4, v5
    v_lshlrev_b32 v12, 4, v1
    s_waitcnt lgkmcnt(0)
    s_mul_i32 s40, s32, 98304
    s_mul_i32 s41, s34, 24576
    s_add_u32 s43, s40, s41
    s_add_u32 s43, s43, 11534336
    s_mul_i32 s40, s34, 40960
    s_add_u32 s40, s40, 0
    s_add_u32 s40, s40, s44
    s_mul_i32 s41, s34, 5120
    s_add_u32 m0, s41, 0
    s_nop 0
    buffer_load_dwordx4 v7, s[4:7], s40 offen lds
    s_add_u32 m0, s41, 1024
    s_nop 0
    buffer_load_dwordx4 v8, s[4:7], s40 offen lds
    s_add_u32 m0, s41, 2048
    s_nop 0
    buffer_load_dwordx4 v9, s[4:7], s40 offen lds
    s_add_u32 m0, s41, 3072
    s_nop 0
    buffer_load_dwordx4 v10, s[4:7], s40 offen lds
    s_add_u32 m0, s41, 4096
    s_nop 0
    buffer_load_dwordx4 v11, s[4:7], s40 offen lds
    s_add_u32 s42, s43, 0
    buffer_load_dwordx4 v[16:19], v12, s[12:15], s42 offen offset:0
    s_add_u32 s42, s43, 0
    buffer_load_dwordx4 v[20:23], v12, s[12:15], s42 offen offset:1024
    s_add_u32 s42, s43, 0
    buffer_load_dwordx4 v[24:27], v12, s[12:15], s42 offen offset:2048
    s_add_u32 s42, s43, 0
    buffer_load_dwordx4 v[28:31], v12, s[12:15], s42 offen offset:3072
    s_barrier
    s_mul_i32 s40, s34, 40960
    s_add_u32 s40, s40, 163840
    s_add_u32 s40, s40, s44
    s_mul_i32 s41, s34, 5120
    s_add_u32 m0, s41, 20480
    s_nop 0
    buffer_load_dwordx4 v7, s[4:7], s40 offen lds
    s_add_u32 m0, s41, 21504
    s_nop 0
    buffer_load_dwordx4 v8, s[4:7], s40 offen lds
    s_add_u32 m0, s41, 22528
    s_nop 0
    buffer_load_dwordx4 v9, s[4:7], s40 offen lds
    s_add_u32 m0, s41, 23552
    s_nop 0
    buffer_load_dwordx4 v10, s[4:7], s40 offen lds
    s_add_u32 m0, s41, 24576
    s_nop 0
    buffer_load_dwordx4 v11, s[4:7], s40 offen lds
    s_add_u32 s42, s43, 4096
    buffer_load_dwordx4 v[32:35], v12, s[12:15], s42 offen offset:0
    s_add_u32 s42, s43, 4096
    buffer_load_dwordx4 v[36:39], v12, s[12:15], s42 offen offset:1024
    s_add_u32 s42, s43, 4096
    buffer_load_dwordx4 v[40:43], v12, s[12:15], s42 offen offset:2048
    s_add_u32 s42, s43, 4096
    buffer_load_dwordx4 v[44:47], v12, s[12:15], s42 offen offset:3072
    s_mul_i32 s40, s34, 40960
    s_add_u32 s40, s40, 327680
    s_add_u32 s40, s40, s44
    s_mul_i32 s41, s34, 5120
    s_add_u32 m0, s41, 40960
    s_nop 0
    buffer_load_dwordx4 v7, s[4:7], s40 offen lds
    s_add_u32 m0, s41, 41984
    s_nop 0
    buffer_load_dwordx4 v8, s[4:7], s40 offen lds
    s_add_u32 m0, s41, 43008
    s_nop 0
    buffer_load_dwordx4 v9, s[4:7], s40 offen lds
    s_add_u32 m0, s41, 44032
    s_nop 0
    buffer_load_dwordx4 v10, s[4:7], s40 offen lds
    s_add_u32 m0, s41, 45056
    s_nop 0
    buffer_load_dwordx4 v11, s[4:7], s40 offen lds
    s_add_u32 s42, s43, 8192
    buffer_load_dwordx4 v[48:51], v12, s[12:15], s42 offen offset:0
    s_add_u32 s42, s43, 8192
    buffer_load_dwordx4 v[52:55], v12, s[12:15], s42 offen offset:1024
    s_add_u32 s42, s43, 8192
    buffer_load_dwordx4 v[56:59], v12, s[12:15], s42 offen offset:2048
    s_add_u32 s42, s43, 8192
    buffer_load_dwordx4 v[60:63], v12, s[12:15], s42 offen offset:3072
    s_mul_i32 s40, s34, 40960
    s_add_u32 s40, s40, 491520
    s_add_u32 s40, s40, s44
    s_mul_i32 s41, s34, 5120
    s_add_u32 m0, s41, 61440
    s_nop 0
    buffer_load_dwordx4 v7, s[4:7], s40 offen lds
    s_add_u32 m0, s41, 62464
    s_nop 0
    buffer_load_dwordx4 v8, s[4:7], s40 offen lds
    s_add_u32 m0, s41, 63488
    s_nop 0
    buffer_load_dwordx4 v9, s[4:7], s40 offen lds
    s_add_u32 m0, s41, 64512
    s_nop 0
    buffer_load_dwordx4 v10, s[4:7], s40 offen lds
    s_add_u32 m0, s41, 65536
    s_nop 0
    buffer_load_dwordx4 v11, s[4:7], s40 offen lds
    s_add_u32 s42, s43, 12288
    buffer_load_dwordx4 v[64:67], v12, s[12:15], s42 offen offset:0
    s_add_u32 s42, s43, 12288
    buffer_load_dwordx4 v[68:71], v12, s[12:15], s42 offen offset:1024
    s_add_u32 s42, s43, 12288
    buffer_load_dwordx4 v[72:75], v12, s[12:15], s42 offen offset:2048
    s_add_u32 s42, s43, 12288
    buffer_load_dwordx4 v[76:79], v12, s[12:15], s42 offen offset:3072
    s_mul_i32 s40, s34, 40960
    s_add_u32 s40, s40, 655360
    s_add_u32 s40, s40, s44
    s_mul_i32 s41, s34, 5120
    s_add_u32 m0, s41, 81920
    s_nop 0
    buffer_load_dwordx4 v7, s[4:7], s40 offen lds
    s_add_u32 m0, s41, 82944
    s_nop 0
    buffer_load_dwordx4 v8, s[4:7], s40 offen lds
    s_add_u32 m0, s41, 83968
    s_nop 0
    buffer_load_dwordx4 v9, s[4:7], s40 offen lds
    s_add_u32 m0, s41, 84992
    s_nop 0
    buffer_load_dwordx4 v10, s[4:7], s40 offen lds
    s_add_u32 m0, s41, 86016
    s_nop 0
    buffer_load_dwordx4 v11, s[4:7], s40 offen lds
    s_add_u32 s42, s43, 16384
    buffer_load_dwordx4 v[80:83], v12, s[12:15], s42 offen offset:0
    s_add_u32 s42, s43, 16384
    buffer_load_dwordx4 v[84:87], v12, s[12:15], s42 offen offset:1024
    s_add_u32 s42, s43, 16384
    buffer_load_dwordx4 v[88:91], v12, s[12:15], s42 offen offset:2048
    s_add_u32 s42, s43, 16384
    buffer_load_dwordx4 v[92:95], v12, s[12:15], s42 offen offset:3072
    s_mul_i32 s40, s34, 40960
    s_add_u32 s40, s40, 819200
    s_add_u32 s40, s40, s44
    s_mul_i32 s41, s34, 5120
    s_add_u32 m0, s41, 102400
    s_nop 0
    buffer_load_dwordx4 v7, s[4:7], s40 offen lds
    s_add_u32 m0, s41, 103424
    s_nop 0
    buffer_load_dwordx4 v8, s[4:7], s40 offen lds
    s_add_u32 m0, s41, 104448
    s_nop 0
    buffer_load_dwordx4 v9, s[4:7], s40 offen lds
    s_add_u32 m0, s41, 105472
    s_nop 0
    buffer_load_dwordx4 v10, s[4:7], s40 offen lds
    s_add_u32 m0, s41, 106496
    s_nop 0
    buffer_load_dwordx4 v11, s[4:7], s40 offen lds
    s_add_u32 s42, s43, 20480
    buffer_load_dwordx4 v[96:99], v12, s[12:15], s42 offen offset:0
    s_add_u32 s42, s43, 20480
    buffer_load_dwordx4 v[100:103], v12, s[12:15], s42 offen offset:1024
    s_add_u32 s42, s43, 20480
    buffer_load_dwordx4 v[104:107], v12, s[12:15], s42 offen offset:2048
    s_add_u32 s42, s43, 20480
    buffer_load_dwordx4 v[108:111], v12, s[12:15], s42 offen offset:3072
    s_cmp_ge_u32 s34, 2
    s_cbranch_scc1 k3_y_1
    s_mul_i32 s40, s34, 40960
    s_add_u32 s40, s40, s45
    s_mul_i32 s41, s34, 5120
    s_add_u32 m0, s41, 122880
    s_nop 0
    buffer_load_dwordx4 v7, s[8:11], s40 offen lds
    s_add_u32 m0, s41, 123904
    s_nop 0
    buffer_load_dwordx4 v8, s[8:11], s40 offen lds
    s_add_u32 m0, s41, 124928
    s_nop 0
    buffer_load_dwordx4 v9, s[8:11], s40 offen lds
    s_add_u32 m0, s41, 125952
    s_nop 0
    buffer_load_dwordx4 v10, s[8:11], s40 offen lds
    s_add_u32 m0, s41, 126976
    s_nop 0
    buffer_load_dwordx4 v11, s[8:11], s40 offen lds
    s_branch k3_xy_2
k3_y_1:
    v_lshrrev_b32 v4, 3, v1
    v_lshlrev_b32 v4, 12, v4
    v_and_b32 v5, 7, v1
    v_lshlrev_b32 v5, 4, v5
    v_add_u32 v4, v4, v5
    s_sub_u32 s42, s34, 2
    s_mul_i32 s40, s42, 40
    s_mul_i32 s41, s33, 80
    s_add_u32 s40, s40, s41
    s_lshl_b32 s40, s40, 12
    s_lshl_b32 s41, s32, 7
    s_add_u32 s40, s40, s41
    s_add_u32 s40, s40, 8912896
    s_mul_i32 s41, s42, 5120
    s_add_u32 m0, s41, 133120
    s_nop 0
    buffer_load_dwordx4 v4, s[12:15], s40 offen lds
    s_add_u32 s40, s40, 32768
    s_add_u32 m0, s41, 134144
    s_nop 0
    buffer_load_dwordx4 v4, s[12:15], s40 offen lds
    s_add_u32 s40, s40, 32768
    s_add_u32 m0, s41, 135168
    s_nop 0
    buffer_load_dwordx4 v4, s[12:15], s40 offen lds
    s_add_u32 s40, s40, 32768
    s_add_u32 m0, s41, 136192
    s_nop 0
    buffer_load_dwordx4 v4, s[12:15], s40 offen lds
    s_add_u32 s40, s40, 32768
    s_add_u32 m0, s41, 137216
    s_nop 0
    buffer_load_dwordx4 v4, s[12:15], s40 offen lds
    s_add_u32 s40, s40, 32768
k3_xy_2:
    s_lshl_b32 s40, s32, 9
    s_lshl_b32 s41, s34, 7
    s_add_u32 s40, s40, s41
    s_add_u32 s40, s40, 14680064
    v_lshlrev_b32 v4, 3, v3
    buffer_load_dwordx2 v[112:113], v4, s[12:15], s40 offen
    v_lshlrev_b32 v4, 2, v2
    v_lshrrev_b32 v5, 2, v3
    v_add_u32 v4, v4, v5
    v_mul_u32_u24 v4, 160, v4
    v_and_b32 v5, 3, v3
    v_lshlrev_b32 v5, 3, v5
    v_add_u32 v114, v4, v5
    v_add_u32 v115, 61440, v114
    s_waitcnt vmcnt(55)
    s_barrier
    ds_read_b64_tr_b16 v[136:137], v114 offset:0
    ds_read_b64_tr_b16 v[138:139], v114 offset:2560
    ds_read_b64_tr_b16 v[140:141], v114 offset:32
    ds_read_b64_tr_b16 v[142:143], v114 offset:2592
    ds_read_b64_tr_b16 v[144:145], v114 offset:64
    ds_read_b64_tr_b16 v[146:147], v114 offset:2624
    ds_read_b64_tr_b16 v[148:149], v114 offset:96
    ds_read_b64_tr_b16 v[150:151], v114 offset:2656
    ds_read_b64_tr_b16 v[152:153], v114 offset:128
    ds_read_b64_tr_b16 v[154:155], v114 offset:2688
    ds_read_b64_tr_b16 v[156:157], v114 offset:5120
    ds_read_b64_tr_b16 v[158:159], v114 offset:7680
    ds_read_b64_tr_b16 v[160:161], v114 offset:5152
    ds_read_b64_tr_b16 v[162:163], v114 offset:7712
    ds_read_b64_tr_b16 v[164:165], v114 offset:5184
    ds_read_b64_tr_b16 v[166:167], v114 offset:7744
    ds_read_b64_tr_b16 v[168:169], v114 offset:5216
    ds_read_b64_tr_b16 v[170:171], v114 offset:7776
    ds_read_b64_tr_b16 v[172:173], v114 offset:5248
    ds_read_b64_tr_b16 v[174:175], v114 offset:7808
    s_waitcnt vmcnt(54)
    s_waitcnt lgkmcnt(15)
    v_mfma_f32_16x16x32_bf16 v[116:119], v[136:139], v[16:19], 0
    s_waitcnt lgkmcnt(15)
    v_mfma_f32_16x16x32_bf16 v[120:123], v[140:143], v[16:19], 0
    s_waitcnt lgkmcnt(14)
    v_mfma_f32_16x16x32_bf16 v[124:127], v[144:147], v[16:19], 0
    s_waitcnt lgkmcnt(12)
    v_mfma_f32_16x16x32_bf16 v[128:131], v[148:151], v[16:19], 0
    s_waitcnt lgkmcnt(10)
    v_mfma_f32_16x16x32_bf16 v[132:135], v[152:155], v[16:19], 0
    ds_read_b64_tr_b16 v[136:137], v114 offset:10240
    ds_read_b64_tr_b16 v[138:139], v114 offset:12800
    ds_read_b64_tr_b16 v[140:141], v114 offset:10272
    ds_read_b64_tr_b16 v[142:143], v114 offset:12832
    ds_read_b64_tr_b16 v[144:145], v114 offset:10304
    ds_read_b64_tr_b16 v[146:147], v114 offset:12864
    ds_read_b64_tr_b16 v[148:149], v114 offset:10336
    ds_read_b64_tr_b16 v[150:151], v114 offset:12896
    ds_read_b64_tr_b16 v[152:153], v114 offset:10368
    ds_read_b64_tr_b16 v[154:155], v114 offset:12928
    s_waitcnt vmcnt(53)
    s_waitcnt lgkmcnt(15)
    v_mfma_f32_16x16x32_bf16 v[116:119], v[156:159], v[20:23], v[116:119]
    s_waitcnt lgkmcnt(15)
    v_mfma_f32_16x16x32_bf16 v[120:123], v[160:163], v[20:23], v[120:123]
    s_waitcnt lgkmcnt(14)
    v_mfma_f32_16x16x32_bf16 v[124:127], v[164:167], v[20:23], v[124:127]
    s_waitcnt lgkmcnt(12)
    v_mfma_f32_16x16x32_bf16 v[128:131], v[168:171], v[20:23], v[128:131]
    s_waitcnt lgkmcnt(10)
    v_mfma_f32_16x16x32_bf16 v[132:135], v[172:175], v[20:23], v[132:135]
    ds_read_b64_tr_b16 v[156:157], v114 offset:15360
    ds_read_b64_tr_b16 v[158:159], v114 offset:17920
    ds_read_b64_tr_b16 v[160:161], v114 offset:15392
    ds_read_b64_tr_b16 v[162:163], v114 offset:17952
    ds_read_b64_tr_b16 v[164:165], v114 offset:15424
    ds_read_b64_tr_b16 v[166:167], v114 offset:17984
    ds_read_b64_tr_b16 v[168:169], v114 offset:15456
    ds_read_b64_tr_b16 v[170:171], v114 offset:18016
    ds_read_b64_tr_b16 v[172:173], v114 offset:15488
    ds_read_b64_tr_b16 v[174:175], v114 offset:18048
    s_waitcnt vmcnt(52)
    s_waitcnt lgkmcnt(15)
    v_mfma_f32_16x16x32_bf16 v[116:119], v[136:139], v[24:27], v[116:119]
    s_waitcnt lgkmcnt(15)
    v_mfma_f32_16x16x32_bf16 v[120:123], v[140:143], v[24:27], v[120:123]
    s_waitcnt lgkmcnt(14)
    v_mfma_f32_16x16x32_bf16 v[124:127], v[144:147], v[24:27], v[124:127]
    s_waitcnt lgkmcnt(12)
    v_mfma_f32_16x16x32_bf16 v[128:131], v[148:151], v[24:27], v[128:131]
    s_waitcnt lgkmcnt(10)
    v_mfma_f32_16x16x32_bf16 v[132:135], v[152:155], v[24:27], v[132:135]
    s_waitcnt vmcnt(51)
    s_waitcnt lgkmcnt(8)
    v_mfma_f32_16x16x32_bf16 v[116:119], v[156:159], v[28:31], v[116:119]
    s_waitcnt lgkmcnt(6)
    v_mfma_f32_16x16x32_bf16 v[120:123], v[160:163], v[28:31], v[120:123]
    s_waitcnt lgkmcnt(4)
    v_mfma_f32_16x16x32_bf16 v[124:127], v[164:167], v[28:31], v[124:127]
    s_waitcnt lgkmcnt(2)
    v_mfma_f32_16x16x32_bf16 v[128:131], v[168:171], v[28:31], v[128:131]
    s_waitcnt lgkmcnt(0)
    v_mfma_f32_16x16x32_bf16 v[132:135], v[172:175], v[28:31], v[132:135]
    s_waitcnt vmcnt(46)
    s_barrier
    ds_read_b64_tr_b16 v[136:137], v114 offset:20480
    ds_read_b64_tr_b16 v[138:139], v114 offset:23040
    ds_read_b64_tr_b16 v[140:141], v114 offset:20512
    ds_read_b64_tr_b16 v[142:143], v114 offset:23072
    ds_read_b64_tr_b16 v[144:145], v114 offset:20544
    ds_read_b64_tr_b16 v[146:147], v114 offset:23104
    ds_read_b64_tr_b16 v[148:149], v114 offset:20576
    ds_read_b64_tr_b16 v[150:151], v114 offset:23136
    ds_read_b64_tr_b16 v[152:153], v114 offset:20608
    ds_read_b64_tr_b16 v[154:155], v114 offset:23168
    ds_read_b64_tr_b16 v[156:157], v114 offset:25600
    ds_read_b64_tr_b16 v[158:159], v114 offset:28160
    ds_read_b64_tr_b16 v[160:161], v114 offset:25632
    ds_read_b64_tr_b16 v[162:163], v114 offset:28192
    ds_read_b64_tr_b16 v[164:165], v114 offset:25664
    ds_read_b64_tr_b16 v[166:167], v114 offset:28224
    ds_read_b64_tr_b16 v[168:169], v114 offset:25696
    ds_read_b64_tr_b16 v[170:171], v114 offset:28256
    ds_read_b64_tr_b16 v[172:173], v114 offset:25728
    ds_read_b64_tr_b16 v[174:175], v114 offset:28288
    s_waitcnt vmcnt(45)
    s_waitcnt lgkmcnt(15)
    v_mfma_f32_16x16x32_bf16 v[116:119], v[136:139], v[32:35], v[116:119]
    s_waitcnt lgkmcnt(15)
    v_mfma_f32_16x16x32_bf16 v[120:123], v[140:143], v[32:35], v[120:123]
    s_waitcnt lgkmcnt(14)
    v_mfma_f32_16x16x32_bf16 v[124:127], v[144:147], v[32:35], v[124:127]
    s_waitcnt lgkmcnt(12)
    v_mfma_f32_16x16x32_bf16 v[128:131], v[148:151], v[32:35], v[128:131]
    s_waitcnt lgkmcnt(10)
    v_mfma_f32_16x16x32_bf16 v[132:135], v[152:155], v[32:35], v[132:135]
    ds_read_b64_tr_b16 v[136:137], v114 offset:30720
    ds_read_b64_tr_b16 v[138:139], v114 offset:33280
    ds_read_b64_tr_b16 v[140:141], v114 offset:30752
    ds_read_b64_tr_b16 v[142:143], v114 offset:33312
    ds_read_b64_tr_b16 v[144:145], v114 offset:30784
    ds_read_b64_tr_b16 v[146:147], v114 offset:33344
    ds_read_b64_tr_b16 v[148:149], v114 offset:30816
    ds_read_b64_tr_b16 v[150:151], v114 offset:33376
    ds_read_b64_tr_b16 v[152:153], v114 offset:30848
    ds_read_b64_tr_b16 v[154:155], v114 offset:33408
    s_waitcnt vmcnt(44)
    s_waitcnt lgkmcnt(15)
    v_mfma_f32_16x16x32_bf16 v[116:119], v[156:159], v[36:39], v[116:119]
    s_waitcnt lgkmcnt(15)
    v_mfma_f32_16x16x32_bf16 v[120:123], v[160:163], v[36:39], v[120:123]
    s_waitcnt lgkmcnt(14)
    v_mfma_f32_16x16x32_bf16 v[124:127], v[164:167], v[36:39], v[124:127]
    s_waitcnt lgkmcnt(12)
    v_mfma_f32_16x16x32_bf16 v[128:131], v[168:171], v[36:39], v[128:131]
    s_waitcnt lgkmcnt(10)
    v_mfma_f32_16x16x32_bf16 v[132:135], v[172:175], v[36:39], v[132:135]
    ds_read_b64_tr_b16 v[156:157], v114 offset:35840
    ds_read_b64_tr_b16 v[158:159], v114 offset:38400
    ds_read_b64_tr_b16 v[160:161], v114 offset:35872
    ds_read_b64_tr_b16 v[162:163], v114 offset:38432
    ds_read_b64_tr_b16 v[164:165], v114 offset:35904
    ds_read_b64_tr_b16 v[166:167], v114 offset:38464
    ds_read_b64_tr_b16 v[168:169], v114 offset:35936
    ds_read_b64_tr_b16 v[170:171], v114 offset:38496
    ds_read_b64_tr_b16 v[172:173], v114 offset:35968
    ds_read_b64_tr_b16 v[174:175], v114 offset:38528
    s_waitcnt vmcnt(43)
    s_waitcnt lgkmcnt(15)
    v_mfma_f32_16x16x32_bf16 v[116:119], v[136:139], v[40:43], v[116:119]
    s_waitcnt lgkmcnt(15)
    v_mfma_f32_16x16x32_bf16 v[120:123], v[140:143], v[40:43], v[120:123]
    s_waitcnt lgkmcnt(14)
    v_mfma_f32_16x16x32_bf16 v[124:127], v[144:147], v[40:43], v[124:127]
    s_waitcnt lgkmcnt(12)
    v_mfma_f32_16x16x32_bf16 v[128:131], v[148:151], v[40:43], v[128:131]
    s_waitcnt lgkmcnt(10)
    v_mfma_f32_16x16x32_bf16 v[132:135], v[152:155], v[40:43], v[132:135]
    s_waitcnt vmcnt(42)
    s_waitcnt lgkmcnt(8)
    v_mfma_f32_16x16x32_bf16 v[116:119], v[156:159], v[44:47], v[116:119]
    s_waitcnt lgkmcnt(6)
    v_mfma_f32_16x16x32_bf16 v[120:123], v[160:163], v[44:47], v[120:123]
    s_waitcnt lgkmcnt(4)
    v_mfma_f32_16x16x32_bf16 v[124:127], v[164:167], v[44:47], v[124:127]
    s_waitcnt lgkmcnt(2)
    v_mfma_f32_16x16x32_bf16 v[128:131], v[168:171], v[44:47], v[128:131]
    s_waitcnt lgkmcnt(0)
    v_mfma_f32_16x16x32_bf16 v[132:135], v[172:175], v[44:47], v[132:135]
    s_waitcnt vmcnt(37)
    s_barrier
    ds_read_b64_tr_b16 v[136:137], v114 offset:40960
    ds_read_b64_tr_b16 v[138:139], v114 offset:43520
    ds_read_b64_tr_b16 v[140:141], v114 offset:40992
    ds_read_b64_tr_b16 v[142:143], v114 offset:43552
    ds_read_b64_tr_b16 v[144:145], v114 offset:41024
    ds_read_b64_tr_b16 v[146:147], v114 offset:43584
    ds_read_b64_tr_b16 v[148:149], v114 offset:41056
    ds_read_b64_tr_b16 v[150:151], v114 offset:43616
    ds_read_b64_tr_b16 v[152:153], v114 offset:41088
    ds_read_b64_tr_b16 v[154:155], v114 offset:43648
    ds_read_b64_tr_b16 v[156:157], v114 offset:46080
    ds_read_b64_tr_b16 v[158:159], v114 offset:48640
    ds_read_b64_tr_b16 v[160:161], v114 offset:46112
    ds_read_b64_tr_b16 v[162:163], v114 offset:48672
    ds_read_b64_tr_b16 v[164:165], v114 offset:46144
    ds_read_b64_tr_b16 v[166:167], v114 offset:48704
    ds_read_b64_tr_b16 v[168:169], v114 offset:46176
    ds_read_b64_tr_b16 v[170:171], v114 offset:48736
    ds_read_b64_tr_b16 v[172:173], v114 offset:46208
    ds_read_b64_tr_b16 v[174:175], v114 offset:48768
    s_waitcnt vmcnt(36)
    s_waitcnt lgkmcnt(15)
    v_mfma_f32_16x16x32_bf16 v[116:119], v[136:139], v[48:51], v[116:119]
    s_waitcnt lgkmcnt(15)
    v_mfma_f32_16x16x32_bf16 v[120:123], v[140:143], v[48:51], v[120:123]
    s_waitcnt lgkmcnt(14)
    v_mfma_f32_16x16x32_bf16 v[124:127], v[144:147], v[48:51], v[124:127]
    s_waitcnt lgkmcnt(12)
    v_mfma_f32_16x16x32_bf16 v[128:131], v[148:151], v[48:51], v[128:131]
    s_waitcnt lgkmcnt(10)
    v_mfma_f32_16x16x32_bf16 v[132:135], v[152:155], v[48:51], v[132:135]
    ds_read_b64_tr_b16 v[136:137], v114 offset:51200
    ds_read_b64_tr_b16 v[138:139], v114 offset:53760
    ds_read_b64_tr_b16 v[140:141], v114 offset:51232
    ds_read_b64_tr_b16 v[142:143], v114 offset:53792
    ds_read_b64_tr_b16 v[144:145], v114 offset:51264
    ds_read_b64_tr_b16 v[146:147], v114 offset:53824
    ds_read_b64_tr_b16 v[148:149], v114 offset:51296
    ds_read_b64_tr_b16 v[150:151], v114 offset:53856
    ds_read_b64_tr_b16 v[152:153], v114 offset:51328
    ds_read_b64_tr_b16 v[154:155], v114 offset:53888
    s_waitcnt vmcnt(35)
    s_waitcnt lgkmcnt(15)
    v_mfma_f32_16x16x32_bf16 v[116:119], v[156:159], v[52:55], v[116:119]
    s_waitcnt lgkmcnt(15)
    v_mfma_f32_16x16x32_bf16 v[120:123], v[160:163], v[52:55], v[120:123]
    s_waitcnt lgkmcnt(14)
    v_mfma_f32_16x16x32_bf16 v[124:127], v[164:167], v[52:55], v[124:127]
    s_waitcnt lgkmcnt(12)
    v_mfma_f32_16x16x32_bf16 v[128:131], v[168:171], v[52:55], v[128:131]
    s_waitcnt lgkmcnt(10)
    v_mfma_f32_16x16x32_bf16 v[132:135], v[172:175], v[52:55], v[132:135]
    ds_read_b64_tr_b16 v[156:157], v114 offset:56320
    ds_read_b64_tr_b16 v[158:159], v114 offset:58880
    ds_read_b64_tr_b16 v[160:161], v114 offset:56352
    ds_read_b64_tr_b16 v[162:163], v114 offset:58912
    ds_read_b64_tr_b16 v[164:165], v114 offset:56384
    ds_read_b64_tr_b16 v[166:167], v114 offset:58944
    ds_read_b64_tr_b16 v[168:169], v114 offset:56416
    ds_read_b64_tr_b16 v[170:171], v114 offset:58976
    ds_read_b64_tr_b16 v[172:173], v114 offset:56448
    ds_read_b64_tr_b16 v[174:175], v114 offset:59008
    s_waitcnt vmcnt(34)
    s_waitcnt lgkmcnt(15)
    v_mfma_f32_16x16x32_bf16 v[116:119], v[136:139], v[56:59], v[116:119]
    s_waitcnt lgkmcnt(15)
    v_mfma_f32_16x16x32_bf16 v[120:123], v[140:143], v[56:59], v[120:123]
    s_waitcnt lgkmcnt(14)
    v_mfma_f32_16x16x32_bf16 v[124:127], v[144:147], v[56:59], v[124:127]
    s_waitcnt lgkmcnt(12)
    v_mfma_f32_16x16x32_bf16 v[128:131], v[148:151], v[56:59], v[128:131]
    s_waitcnt lgkmcnt(10)
    v_mfma_f32_16x16x32_bf16 v[132:135], v[152:155], v[56:59], v[132:135]
    s_waitcnt vmcnt(33)
    s_waitcnt lgkmcnt(8)
    v_mfma_f32_16x16x32_bf16 v[116:119], v[156:159], v[60:63], v[116:119]
    s_waitcnt lgkmcnt(6)
    v_mfma_f32_16x16x32_bf16 v[120:123], v[160:163], v[60:63], v[120:123]
    s_waitcnt lgkmcnt(4)
    v_mfma_f32_16x16x32_bf16 v[124:127], v[164:167], v[60:63], v[124:127]
    s_waitcnt lgkmcnt(2)
    v_mfma_f32_16x16x32_bf16 v[128:131], v[168:171], v[60:63], v[128:131]
    s_waitcnt lgkmcnt(0)
    v_mfma_f32_16x16x32_bf16 v[132:135], v[172:175], v[60:63], v[132:135]
    s_waitcnt vmcnt(28)
    s_barrier
    ds_read_b64_tr_b16 v[136:137], v115 offset:0
    ds_read_b64_tr_b16 v[138:139], v115 offset:2560
    ds_read_b64_tr_b16 v[140:141], v115 offset:32
    ds_read_b64_tr_b16 v[142:143], v115 offset:2592
    ds_read_b64_tr_b16 v[144:145], v115 offset:64
    ds_read_b64_tr_b16 v[146:147], v115 offset:2624
    ds_read_b64_tr_b16 v[148:149], v115 offset:96
    ds_read_b64_tr_b16 v[150:151], v115 offset:2656
    ds_read_b64_tr_b16 v[152:153], v115 offset:128
    ds_read_b64_tr_b16 v[154:155], v115 offset:2688
    ds_read_b64_tr_b16 v[156:157], v115 offset:5120
    ds_read_b64_tr_b16 v[158:159], v115 offset:7680
    ds_read_b64_tr_b16 v[160:161], v115 offset:5152
    ds_read_b64_tr_b16 v[162:163], v115 offset:7712
    ds_read_b64_tr_b16 v[164:165], v115 offset:5184
    ds_read_b64_tr_b16 v[166:167], v115 offset:7744
    ds_read_b64_tr_b16 v[168:169], v115 offset:5216
    ds_read_b64_tr_b16 v[170:171], v115 offset:7776
    ds_read_b64_tr_b16 v[172:173], v115 offset:5248
    ds_read_b64_tr_b16 v[174:175], v115 offset:7808
    s_waitcnt vmcnt(27)
    s_waitcnt lgkmcnt(15)
    v_mfma_f32_16x16x32_bf16 v[116:119], v[136:139], v[64:67], v[116:119]
    s_waitcnt lgkmcnt(15)
    v_mfma_f32_16x16x32_bf16 v[120:123], v[140:143], v[64:67], v[120:123]
    s_waitcnt lgkmcnt(14)
    v_mfma_f32_16x16x32_bf16 v[124:127], v[144:147], v[64:67], v[124:127]
    s_waitcnt lgkmcnt(12)
    v_mfma_f32_16x16x32_bf16 v[128:131], v[148:151], v[64:67], v[128:131]
    s_waitcnt lgkmcnt(10)
    v_mfma_f32_16x16x32_bf16 v[132:135], v[152:155], v[64:67], v[132:135]
    ds_read_b64_tr_b16 v[136:137], v115 offset:10240
    ds_read_b64_tr_b16 v[138:139], v115 offset:12800
    ds_read_b64_tr_b16 v[140:141], v115 offset:10272
    ds_read_b64_tr_b16 v[142:143], v115 offset:12832
    ds_read_b64_tr_b16 v[144:145], v115 offset:10304
    ds_read_b64_tr_b16 v[146:147], v115 offset:12864
    ds_read_b64_tr_b16 v[148:149], v115 offset:10336
    ds_read_b64_tr_b16 v[150:151], v115 offset:12896
    ds_read_b64_tr_b16 v[152:153], v115 offset:10368
    ds_read_b64_tr_b16 v[154:155], v115 offset:12928
    s_waitcnt vmcnt(26)
    s_waitcnt lgkmcnt(15)
    v_mfma_f32_16x16x32_bf16 v[116:119], v[156:159], v[68:71], v[116:119]
    s_waitcnt lgkmcnt(15)
    v_mfma_f32_16x16x32_bf16 v[120:123], v[160:163], v[68:71], v[120:123]
    s_waitcnt lgkmcnt(14)
    v_mfma_f32_16x16x32_bf16 v[124:127], v[164:167], v[68:71], v[124:127]
    s_waitcnt lgkmcnt(12)
    v_mfma_f32_16x16x32_bf16 v[128:131], v[168:171], v[68:71], v[128:131]
    s_waitcnt lgkmcnt(10)
    v_mfma_f32_16x16x32_bf16 v[132:135], v[172:175], v[68:71], v[132:135]
    ds_read_b64_tr_b16 v[156:157], v115 offset:15360
    ds_read_b64_tr_b16 v[158:159], v115 offset:17920
    ds_read_b64_tr_b16 v[160:161], v115 offset:15392
    ds_read_b64_tr_b16 v[162:163], v115 offset:17952
    ds_read_b64_tr_b16 v[164:165], v115 offset:15424
    ds_read_b64_tr_b16 v[166:167], v115 offset:17984
    ds_read_b64_tr_b16 v[168:169], v115 offset:15456
    ds_read_b64_tr_b16 v[170:171], v115 offset:18016
    ds_read_b64_tr_b16 v[172:173], v115 offset:15488
    ds_read_b64_tr_b16 v[174:175], v115 offset:18048
    s_waitcnt vmcnt(25)
    s_waitcnt lgkmcnt(15)
    v_mfma_f32_16x16x32_bf16 v[116:119], v[136:139], v[72:75], v[116:119]
    s_waitcnt lgkmcnt(15)
    v_mfma_f32_16x16x32_bf16 v[120:123], v[140:143], v[72:75], v[120:123]
    s_waitcnt lgkmcnt(14)
    v_mfma_f32_16x16x32_bf16 v[124:127], v[144:147], v[72:75], v[124:127]
    s_waitcnt lgkmcnt(12)
    v_mfma_f32_16x16x32_bf16 v[128:131], v[148:151], v[72:75], v[128:131]
    s_waitcnt lgkmcnt(10)
    v_mfma_f32_16x16x32_bf16 v[132:135], v[152:155], v[72:75], v[132:135]
    s_waitcnt vmcnt(24)
    s_waitcnt lgkmcnt(8)
    v_mfma_f32_16x16x32_bf16 v[116:119], v[156:159], v[76:79], v[116:119]
    s_waitcnt lgkmcnt(6)
    v_mfma_f32_16x16x32_bf16 v[120:123], v[160:163], v[76:79], v[120:123]
    s_waitcnt lgkmcnt(4)
    v_mfma_f32_16x16x32_bf16 v[124:127], v[164:167], v[76:79], v[124:127]
    s_waitcnt lgkmcnt(2)
    v_mfma_f32_16x16x32_bf16 v[128:131], v[168:171], v[76:79], v[128:131]
    s_waitcnt lgkmcnt(0)
    v_mfma_f32_16x16x32_bf16 v[132:135], v[172:175], v[76:79], v[132:135]
    s_waitcnt vmcnt(19)
    s_barrier
    ds_read_b64_tr_b16 v[136:137], v115 offset:20480
    ds_read_b64_tr_b16 v[138:139], v115 offset:23040
    ds_read_b64_tr_b16 v[140:141], v115 offset:20512
    ds_read_b64_tr_b16 v[142:143], v115 offset:23072
    ds_read_b64_tr_b16 v[144:145], v115 offset:20544
    ds_read_b64_tr_b16 v[146:147], v115 offset:23104
    ds_read_b64_tr_b16 v[148:149], v115 offset:20576
    ds_read_b64_tr_b16 v[150:151], v115 offset:23136
    ds_read_b64_tr_b16 v[152:153], v115 offset:20608
    ds_read_b64_tr_b16 v[154:155], v115 offset:23168
    ds_read_b64_tr_b16 v[156:157], v115 offset:25600
    ds_read_b64_tr_b16 v[158:159], v115 offset:28160
    ds_read_b64_tr_b16 v[160:161], v115 offset:25632
    ds_read_b64_tr_b16 v[162:163], v115 offset:28192
    ds_read_b64_tr_b16 v[164:165], v115 offset:25664
    ds_read_b64_tr_b16 v[166:167], v115 offset:28224
    ds_read_b64_tr_b16 v[168:169], v115 offset:25696
    ds_read_b64_tr_b16 v[170:171], v115 offset:28256
    ds_read_b64_tr_b16 v[172:173], v115 offset:25728
    ds_read_b64_tr_b16 v[174:175], v115 offset:28288
    s_waitcnt vmcnt(18)
    s_waitcnt lgkmcnt(15)
    v_mfma_f32_16x16x32_bf16 v[116:119], v[136:139], v[80:83], v[116:119]
    s_waitcnt lgkmcnt(15)
    v_mfma_f32_16x16x32_bf16 v[120:123], v[140:143], v[80:83], v[120:123]
    s_waitcnt lgkmcnt(14)
    v_mfma_f32_16x16x32_bf16 v[124:127], v[144:147], v[80:83], v[124:127]
    s_waitcnt lgkmcnt(12)
    v_mfma_f32_16x16x32_bf16 v[128:131], v[148:151], v[80:83], v[128:131]
    s_waitcnt lgkmcnt(10)
    v_mfma_f32_16x16x32_bf16 v[132:135], v[152:155], v[80:83], v[132:135]
    ds_read_b64_tr_b16 v[136:137], v115 offset:30720
    ds_read_b64_tr_b16 v[138:139], v115 offset:33280
    ds_read_b64_tr_b16 v[140:141], v115 offset:30752
    ds_read_b64_tr_b16 v[142:143], v115 offset:33312
    ds_read_b64_tr_b16 v[144:145], v115 offset:30784
    ds_read_b64_tr_b16 v[146:147], v115 offset:33344
    ds_read_b64_tr_b16 v[148:149], v115 offset:30816
    ds_read_b64_tr_b16 v[150:151], v115 offset:33376
    ds_read_b64_tr_b16 v[152:153], v115 offset:30848
    ds_read_b64_tr_b16 v[154:155], v115 offset:33408
    s_waitcnt vmcnt(17)
    s_waitcnt lgkmcnt(15)
    v_mfma_f32_16x16x32_bf16 v[116:119], v[156:159], v[84:87], v[116:119]
    s_waitcnt lgkmcnt(15)
    v_mfma_f32_16x16x32_bf16 v[120:123], v[160:163], v[84:87], v[120:123]
    s_waitcnt lgkmcnt(14)
    v_mfma_f32_16x16x32_bf16 v[124:127], v[164:167], v[84:87], v[124:127]
    s_waitcnt lgkmcnt(12)
    v_mfma_f32_16x16x32_bf16 v[128:131], v[168:171], v[84:87], v[128:131]
    s_waitcnt lgkmcnt(10)
    v_mfma_f32_16x16x32_bf16 v[132:135], v[172:175], v[84:87], v[132:135]
    ds_read_b64_tr_b16 v[156:157], v115 offset:35840
    ds_read_b64_tr_b16 v[158:159], v115 offset:38400
    ds_read_b64_tr_b16 v[160:161], v115 offset:35872
    ds_read_b64_tr_b16 v[162:163], v115 offset:38432
    ds_read_b64_tr_b16 v[164:165], v115 offset:35904
    ds_read_b64_tr_b16 v[166:167], v115 offset:38464
    ds_read_b64_tr_b16 v[168:169], v115 offset:35936
    ds_read_b64_tr_b16 v[170:171], v115 offset:38496
    ds_read_b64_tr_b16 v[172:173], v115 offset:35968
    ds_read_b64_tr_b16 v[174:175], v115 offset:38528
    s_waitcnt vmcnt(16)
    s_waitcnt lgkmcnt(15)
    v_mfma_f32_16x16x32_bf16 v[116:119], v[136:139], v[88:91], v[116:119]
    s_waitcnt lgkmcnt(15)
    v_mfma_f32_16x16x32_bf16 v[120:123], v[140:143], v[88:91], v[120:123]
    s_waitcnt lgkmcnt(14)
    v_mfma_f32_16x16x32_bf16 v[124:127], v[144:147], v[88:91], v[124:127]
    s_waitcnt lgkmcnt(12)
    v_mfma_f32_16x16x32_bf16 v[128:131], v[148:151], v[88:91], v[128:131]
    s_waitcnt lgkmcnt(10)
    v_mfma_f32_16x16x32_bf16 v[132:135], v[152:155], v[88:91], v[132:135]
    s_waitcnt vmcnt(15)
    s_waitcnt lgkmcnt(8)
    v_mfma_f32_16x16x32_bf16 v[116:119], v[156:159], v[92:95], v[116:119]
    s_waitcnt lgkmcnt(6)
    v_mfma_f32_16x16x32_bf16 v[120:123], v[160:163], v[92:95], v[120:123]
    s_waitcnt lgkmcnt(4)
    v_mfma_f32_16x16x32_bf16 v[124:127], v[164:167], v[92:95], v[124:127]
    s_waitcnt lgkmcnt(2)
    v_mfma_f32_16x16x32_bf16 v[128:131], v[168:171], v[92:95], v[128:131]
    s_waitcnt lgkmcnt(0)
    v_mfma_f32_16x16x32_bf16 v[132:135], v[172:175], v[92:95], v[132:135]
    s_waitcnt vmcnt(10)
    s_barrier
    ds_read_b64_tr_b16 v[136:137], v115 offset:40960
    ds_read_b64_tr_b16 v[138:139], v115 offset:43520
    ds_read_b64_tr_b16 v[140:141], v115 offset:40992
    ds_read_b64_tr_b16 v[142:143], v115 offset:43552
    ds_read_b64_tr_b16 v[144:145], v115 offset:41024
    ds_read_b64_tr_b16 v[146:147], v115 offset:43584
    ds_read_b64_tr_b16 v[148:149], v115 offset:41056
    ds_read_b64_tr_b16 v[150:151], v115 offset:43616
    ds_read_b64_tr_b16 v[152:153], v115 offset:41088
    ds_read_b64_tr_b16 v[154:155], v115 offset:43648
    ds_read_b64_tr_b16 v[156:157], v115 offset:46080
    ds_read_b64_tr_b16 v[158:159], v115 offset:48640
    ds_read_b64_tr_b16 v[160:161], v115 offset:46112
    ds_read_b64_tr_b16 v[162:163], v115 offset:48672
    ds_read_b64_tr_b16 v[164:165], v115 offset:46144
    ds_read_b64_tr_b16 v[166:167], v115 offset:48704
    ds_read_b64_tr_b16 v[168:169], v115 offset:46176
    ds_read_b64_tr_b16 v[170:171], v115 offset:48736
    ds_read_b64_tr_b16 v[172:173], v115 offset:46208
    ds_read_b64_tr_b16 v[174:175], v115 offset:48768
    s_waitcnt vmcnt(9)
    s_waitcnt lgkmcnt(15)
    v_mfma_f32_16x16x32_bf16 v[116:119], v[136:139], v[96:99], v[116:119]
    s_waitcnt lgkmcnt(15)
    v_mfma_f32_16x16x32_bf16 v[120:123], v[140:143], v[96:99], v[120:123]
    s_waitcnt lgkmcnt(14)
    v_mfma_f32_16x16x32_bf16 v[124:127], v[144:147], v[96:99], v[124:127]
    s_waitcnt lgkmcnt(12)
    v_mfma_f32_16x16x32_bf16 v[128:131], v[148:151], v[96:99], v[128:131]
    s_waitcnt lgkmcnt(10)
    v_mfma_f32_16x16x32_bf16 v[132:135], v[152:155], v[96:99], v[132:135]
    ds_read_b64_tr_b16 v[136:137], v115 offset:51200
    ds_read_b64_tr_b16 v[138:139], v115 offset:53760
    ds_read_b64_tr_b16 v[140:141], v115 offset:51232
    ds_read_b64_tr_b16 v[142:143], v115 offset:53792
    ds_read_b64_tr_b16 v[144:145], v115 offset:51264
    ds_read_b64_tr_b16 v[146:147], v115 offset:53824
    ds_read_b64_tr_b16 v[148:149], v115 offset:51296
    ds_read_b64_tr_b16 v[150:151], v115 offset:53856
    ds_read_b64_tr_b16 v[152:153], v115 offset:51328
    ds_read_b64_tr_b16 v[154:155], v115 offset:53888
    s_waitcnt vmcnt(8)
    s_waitcnt lgkmcnt(15)
    v_mfma_f32_16x16x32_bf16 v[116:119], v[156:159], v[100:103], v[116:119]
    s_waitcnt lgkmcnt(15)
    v_mfma_f32_16x16x32_bf16 v[120:123], v[160:163], v[100:103], v[120:123]
    s_waitcnt lgkmcnt(14)
    v_mfma_f32_16x16x32_bf16 v[124:127], v[164:167], v[100:103], v[124:127]
    s_waitcnt lgkmcnt(12)
    v_mfma_f32_16x16x32_bf16 v[128:131], v[168:171], v[100:103], v[128:131]
    s_waitcnt lgkmcnt(10)
    v_mfma_f32_16x16x32_bf16 v[132:135], v[172:175], v[100:103], v[132:135]
    ds_read_b64_tr_b16 v[156:157], v115 offset:56320
    ds_read_b64_tr_b16 v[158:159], v115 offset:58880
    ds_read_b64_tr_b16 v[160:161], v115 offset:56352
    ds_read_b64_tr_b16 v[162:163], v115 offset:58912
    ds_read_b64_tr_b16 v[164:165], v115 offset:56384
    ds_read_b64_tr_b16 v[166:167], v115 offset:58944
    ds_read_b64_tr_b16 v[168:169], v115 offset:56416
    ds_read_b64_tr_b16 v[170:171], v115 offset:58976
    ds_read_b64_tr_b16 v[172:173], v115 offset:56448
    ds_read_b64_tr_b16 v[174:175], v115 offset:59008
    s_waitcnt vmcnt(7)
    s_waitcnt lgkmcnt(15)
    v_mfma_f32_16x16x32_bf16 v[116:119], v[136:139], v[104:107], v[116:119]
    s_waitcnt lgkmcnt(15)
    v_mfma_f32_16x16x32_bf16 v[120:123], v[140:143], v[104:107], v[120:123]
    s_waitcnt lgkmcnt(14)
    v_mfma_f32_16x16x32_bf16 v[124:127], v[144:147], v[104:107], v[124:127]
    s_waitcnt lgkmcnt(12)
    v_mfma_f32_16x16x32_bf16 v[128:131], v[148:151], v[104:107], v[128:131]
    s_waitcnt lgkmcnt(10)
    v_mfma_f32_16x16x32_bf16 v[132:135], v[152:155], v[104:107], v[132:135]
    s_waitcnt vmcnt(6)
    s_waitcnt lgkmcnt(8)
    v_mfma_f32_16x16x32_bf16 v[116:119], v[156:159], v[108:111], v[116:119]
    s_waitcnt lgkmcnt(6)
    v_mfma_f32_16x16x32_bf16 v[120:123], v[160:163], v[108:111], v[120:123]
    s_waitcnt lgkmcnt(4)
    v_mfma_f32_16x16x32_bf16 v[124:127], v[164:167], v[108:111], v[124:127]
    s_waitcnt lgkmcnt(2)
    v_mfma_f32_16x16x32_bf16 v[128:131], v[168:171], v[108:111], v[128:131]
    s_waitcnt lgkmcnt(0)
    v_mfma_f32_16x16x32_bf16 v[132:135], v[172:175], v[108:111], v[132:135]
    s_waitcnt vmcnt(0)
    s_barrier
    s_lshl_b32 s40, s34, 4
    v_add_u32 v4, s40, v3
    v_mul_u32_u24 v4, 160, v4
    v_lshlrev_b32 v5, 3, v2
    v_add_u32 v176, v4, v5
    v_add_u32 v177, 122880, v176
    ds_read_b64 v[136:137], v177 offset:0
    ds_read_b64 v[138:139], v177 offset:32
    ds_read_b64 v[140:141], v177 offset:64
    ds_read_b64 v[142:143], v177 offset:96
    ds_read_b64 v[144:145], v177 offset:128
    v_lshlrev_b32 v4, 2, v2
    v_lshrrev_b32 v5, 2, v3
    v_add_u32 v4, v4, v5
    v_lshlrev_b32 v4, 7, v4
    v_and_b32 v5, 3, v3
    v_lshlrev_b32 v5, 3, v5
    v_add_u32 v4, v4, v5
    s_lshl_b32 s40, s34, 5
    s_add_u32 s40, s40, 133120
    v_add_u32 v4, s40, v4
    ds_read_b64_tr_b16 v[146:147], v4 offset:0
    ds_read_b64_tr_b16 v[148:149], v4 offset:2048
    ds_read_b64_tr_b16 v[150:151], v4 offset:4096
    ds_read_b64_tr_b16 v[152:153], v4 offset:6144
    ds_read_b64_tr_b16 v[154:155], v4 offset:8192
    s_waitcnt lgkmcnt(0)
    s_mov_b32 s46, 0xbfb8aa3b
    v_lshlrev_b32 v156, 16, v136
    v_and_b32 v157, 0xffff0000, v136
    v_lshlrev_b32 v158, 16, v146
    v_and_b32 v159, 0xffff0000, v146
    v_mul_f32 v160, s46, v116
    v_mul_f32 v161, s46, v117
    v_exp_f32 v160, v160
    v_exp_f32 v161, v161
    v_add_f32 v160, 1.0, v160
    v_add_f32 v161, 1.0, v161
    v_rcp_f32 v160, v160
    v_rcp_f32 v161, v161
    v_mul_f32 v160, v160, v116
    v_mul_f32 v161, v161, v117
    v_sub_f32 v162, v156, v112
    v_mul_f32 v162, v162, v113
    v_mul_f32 v162, v162, v158
    v_fma_f32 v156, v162, v160, v156
    v_sub_f32 v162, v157, v112
    v_mul_f32 v162, v162, v113
    v_mul_f32 v162, v162, v159
    v_fma_f32 v157, v162, v161, v157
    v_cvt_pk_bf16_f32 v16, v156, v157
    v_lshlrev_b32 v156, 16, v137
    v_and_b32 v157, 0xffff0000, v137
    v_lshlrev_b32 v158, 16, v147
    v_and_b32 v159, 0xffff0000, v147
    v_mul_f32 v160, s46, v118
    v_mul_f32 v161, s46, v119
    v_exp_f32 v160, v160
    v_exp_f32 v161, v161
    v_add_f32 v160, 1.0, v160
    v_add_f32 v161, 1.0, v161
    v_rcp_f32 v160, v160
    v_rcp_f32 v161, v161
    v_mul_f32 v160, v160, v118
    v_mul_f32 v161, v161, v119
    v_sub_f32 v162, v156, v112
    v_mul_f32 v162, v162, v113
    v_mul_f32 v162, v162, v158
    v_fma_f32 v156, v162, v160, v156
    v_sub_f32 v162, v157, v112
    v_mul_f32 v162, v162, v113
    v_mul_f32 v162, v162, v159
    v_fma_f32 v157, v162, v161, v157
    v_cvt_pk_bf16_f32 v17, v156, v157
    v_lshlrev_b32 v156, 16, v138
    v_and_b32 v157, 0xffff0000, v138
    v_lshlrev_b32 v158, 16, v148
    v_and_b32 v159, 0xffff0000, v148
    v_mul_f32 v160, s46, v120
    v_mul_f32 v161, s46, v121
    v_exp_f32 v160, v160
    v_exp_f32 v161, v161
    v_add_f32 v160, 1.0, v160
    v_add_f32 v161, 1.0, v161
    v_rcp_f32 v160, v160
    v_rcp_f32 v161, v161
    v_mul_f32 v160, v160, v120
    v_mul_f32 v161, v161, v121
    v_sub_f32 v162, v156, v112
    v_mul_f32 v162, v162, v113
    v_mul_f32 v162, v162, v158
    v_fma_f32 v156, v162, v160, v156
    v_sub_f32 v162, v157, v112
    v_mul_f32 v162, v162, v113
    v_mul_f32 v162, v162, v159
    v_fma_f32 v157, v162, v161, v157
    v_cvt_pk_bf16_f32 v18, v156, v157
    v_lshlrev_b32 v156, 16, v139
    v_and_b32 v157, 0xffff0000, v139
    v_lshlrev_b32 v158, 16, v149
    v_and_b32 v159, 0xffff0000, v149
    v_mul_f32 v160, s46, v122
    v_mul_f32 v161, s46, v123
    v_exp_f32 v160, v160
    v_exp_f32 v161, v161
    v_add_f32 v160, 1.0, v160
    v_add_f32 v161, 1.0, v161
    v_rcp_f32 v160, v160
    v_rcp_f32 v161, v161
    v_mul_f32 v160, v160, v122
    v_mul_f32 v161, v161, v123
    v_sub_f32 v162, v156, v112
    v_mul_f32 v162, v162, v113
    v_mul_f32 v162, v162, v158
    v_fma_f32 v156, v162, v160, v156
    v_sub_f32 v162, v157, v112
    v_mul_f32 v162, v162, v113
    v_mul_f32 v162, v162, v159
    v_fma_f32 v157, v162, v161, v157
    v_cvt_pk_bf16_f32 v19, v156, v157
    v_lshlrev_b32 v156, 16, v140
    v_and_b32 v157, 0xffff0000, v140
    v_lshlrev_b32 v158, 16, v150
    v_and_b32 v159, 0xffff0000, v150
    v_mul_f32 v160, s46, v124
    v_mul_f32 v161, s46, v125
    v_exp_f32 v160, v160
    v_exp_f32 v161, v161
    v_add_f32 v160, 1.0, v160
    v_add_f32 v161, 1.0, v161
    v_rcp_f32 v160, v160
    v_rcp_f32 v161, v161
    v_mul_f32 v160, v160, v124
    v_mul_f32 v161, v161, v125
    v_sub_f32 v162, v156, v112
    v_mul_f32 v162, v162, v113
    v_mul_f32 v162, v162, v158
    v_fma_f32 v156, v162, v160, v156
    v_sub_f32 v162, v157, v112
    v_mul_f32 v162, v162, v113
    v_mul_f32 v162, v162, v159
    v_fma_f32 v157, v162, v161, v157
    v_cvt_pk_bf16_f32 v20, v156, v157
    v_lshlrev_b32 v156, 16, v141
    v_and_b32 v157, 0xffff0000, v141
    v_lshlrev_b32 v158, 16, v151
    v_and_b32 v159, 0xffff0000, v151
    v_mul_f32 v160, s46, v126
    v_mul_f32 v161, s46, v127
    v_exp_f32 v160, v160
    v_exp_f32 v161, v161
    v_add_f32 v160, 1.0, v160
    v_add_f32 v161, 1.0, v161
    v_rcp_f32 v160, v160
    v_rcp_f32 v161, v161
    v_mul_f32 v160, v160, v126
    v_mul_f32 v161, v161, v127
    v_sub_f32 v162, v156, v112
    v_mul_f32 v162, v162, v113
    v_mul_f32 v162, v162, v158
    v_fma_f32 v156, v162, v160, v156
    v_sub_f32 v162, v157, v112
    v_mul_f32 v162, v162, v113
    v_mul_f32 v162, v162, v159
    v_fma_f32 v157, v162, v161, v157
    v_cvt_pk_bf16_f32 v21, v156, v157
    v_lshlrev_b32 v156, 16, v142
    v_and_b32 v157, 0xffff0000, v142
    v_lshlrev_b32 v158, 16, v152
    v_and_b32 v159, 0xffff0000, v152
    v_mul_f32 v160, s46, v128
    v_mul_f32 v161, s46, v129
    v_exp_f32 v160, v160
    v_exp_f32 v161, v161
    v_add_f32 v160, 1.0, v160
    v_add_f32 v161, 1.0, v161
    v_rcp_f32 v160, v160
    v_rcp_f32 v161, v161
    v_mul_f32 v160, v160, v128
    v_mul_f32 v161, v161, v129
    v_sub_f32 v162, v156, v112
    v_mul_f32 v162, v162, v113
    v_mul_f32 v162, v162, v158
    v_fma_f32 v156, v162, v160, v156
    v_sub_f32 v162, v157, v112
    v_mul_f32 v162, v162, v113
    v_mul_f32 v162, v162, v159
    v_fma_f32 v157, v162, v161, v157
    v_cvt_pk_bf16_f32 v22, v156, v157
    v_lshlrev_b32 v156, 16, v143
    v_and_b32 v157, 0xffff0000, v143
    v_lshlrev_b32 v158, 16, v153
    v_and_b32 v159, 0xffff0000, v153
    v_mul_f32 v160, s46, v130
    v_mul_f32 v161, s46, v131
    v_exp_f32 v160, v160
    v_exp_f32 v161, v161
    v_add_f32 v160, 1.0, v160
    v_add_f32 v161, 1.0, v161
    v_rcp_f32 v160, v160
    v_rcp_f32 v161, v161
    v_mul_f32 v160, v160, v130
    v_mul_f32 v161, v161, v131
    v_sub_f32 v162, v156, v112
    v_mul_f32 v162, v162, v113
    v_mul_f32 v162, v162, v158
    v_fma_f32 v156, v162, v160, v156
    v_sub_f32 v162, v157, v112
    v_mul_f32 v162, v162, v113
    v_mul_f32 v162, v162, v159
    v_fma_f32 v157, v162, v161, v157
    v_cvt_pk_bf16_f32 v23, v156, v157
    v_lshlrev_b32 v156, 16, v144
    v_and_b32 v157, 0xffff0000, v144
    v_lshlrev_b32 v158, 16, v154
    v_and_b32 v159, 0xffff0000, v154
    v_mul_f32 v160, s46, v132
    v_mul_f32 v161, s46, v133
    v_exp_f32 v160, v160
    v_exp_f32 v161, v161
    v_add_f32 v160, 1.0, v160
    v_add_f32 v161, 1.0, v161
    v_rcp_f32 v160, v160
    v_rcp_f32 v161, v161
    v_mul_f32 v160, v160, v132
    v_mul_f32 v161, v161, v133
    v_sub_f32 v162, v156, v112
    v_mul_f32 v162, v162, v113
    v_mul_f32 v162, v162, v158
    v_fma_f32 v156, v162, v160, v156
    v_sub_f32 v162, v157, v112
    v_mul_f32 v162, v162, v113
    v_mul_f32 v162, v162, v159
    v_fma_f32 v157, v162, v161, v157
    v_cvt_pk_bf16_f32 v24, v156, v157
    v_lshlrev_b32 v156, 16, v145
    v_and_b32 v157, 0xffff0000, v145
    v_lshlrev_b32 v158, 16, v155
    v_and_b32 v159, 0xffff0000, v155
    v_mul_f32 v160, s46, v134
    v_mul_f32 v161, s46, v135
    v_exp_f32 v160, v160
    v_exp_f32 v161, v161
    v_add_f32 v160, 1.0, v160
    v_add_f32 v161, 1.0, v161
    v_rcp_f32 v160, v160
    v_rcp_f32 v161, v161
    v_mul_f32 v160, v160, v134
    v_mul_f32 v161, v161, v135
    v_sub_f32 v162, v156, v112
    v_mul_f32 v162, v162, v113
    v_mul_f32 v162, v162, v158
    v_fma_f32 v156, v162, v160, v156
    v_sub_f32 v162, v157, v112
    v_mul_f32 v162, v162, v113
    v_mul_f32 v162, v162, v159
    v_fma_f32 v157, v162, v161, v157
    v_cvt_pk_bf16_f32 v25, v156, v157
    v_add_u32 v178, 143360, v176
    ds_write_b64 v178, v[16:17] offset:0
    ds_write_b64 v178, v[18:19] offset:32
    ds_write_b64 v178, v[20:21] offset:64
    ds_write_b64 v178, v[22:23] offset:96
    ds_write_b64 v178, v[24:25] offset:128
    s_waitcnt lgkmcnt(0)
    s_mul_i32 s40, s34, 2560
    s_add_u32 s40, s40, 143360
    v_add_u32 v4, s40, v12
    ds_read_b128 v[156:159], v4 offset:0
    ds_read_b128 v[160:163], v4 offset:1024
    ds_read_b128 v[164:167], v4 offset:2048
    s_mul_i32 s40, s34, 20480
    s_add_u32 s40, s40, s45
    s_waitcnt lgkmcnt(0)
    buffer_store_dwordx4 v[156:159], v7, s[16:19], s40 offen
    buffer_store_dwordx4 v[160:163], v8, s[16:19], s40 offen
    s_mov_b32 exec_hi, 0
    buffer_store_dwordx4 v[164:167], v9, s[16:19], s40 offen
    s_mov_b64 exec, -1
k3_kernel_end:
    s_endpgm
.section .rodata,"a"
.p2align 6
.amdhsa_kernel k1_kernel
  .amdhsa_next_free_vgpr 226
  .amdhsa_next_free_sgpr 102
  .amdhsa_accum_offset 228
  .amdhsa_group_segment_fixed_size 0
  .amdhsa_kernarg_size 112
  .amdhsa_user_sgpr_count 2
  .amdhsa_user_sgpr_kernarg_segment_ptr 1
  .amdhsa_system_sgpr_workgroup_id_x 1
.end_amdhsa_kernel
.p2align 6
.amdhsa_kernel k2_kernel
  .amdhsa_next_free_vgpr 237
  .amdhsa_next_free_sgpr 102
  .amdhsa_accum_offset 240
  .amdhsa_group_segment_fixed_size 0
  .amdhsa_kernarg_size 112
  .amdhsa_user_sgpr_count 2
  .amdhsa_user_sgpr_kernarg_segment_ptr 1
  .amdhsa_system_sgpr_workgroup_id_x 1
.end_amdhsa_kernel
.p2align 6
.amdhsa_kernel k3_kernel
  .amdhsa_next_free_vgpr 179
  .amdhsa_next_free_sgpr 102
  .amdhsa_accum_offset 180
  .amdhsa_group_segment_fixed_size 0
  .amdhsa_kernarg_size 112
  .amdhsa_user_sgpr_count 2
  .amdhsa_user_sgpr_kernarg_segment_ptr 1
  .amdhsa_system_sgpr_workgroup_id_x 1
.end_amdhsa_kernel
```

```asm
; @launch kernel=k1_kernel grid=(256,1,1) block=(512,1,1) lds=163840
; @launch kernel=k2_kernel grid=(512,1,1) block=(256,1,1) lds=81920
; @launch kernel=k3_kernel grid=(256,1,1) block=(256,1,1) lds=153600
.amdgcn_target "amdgcn-amd-amdhsa--gfx950"
.text
.globl k1_kernel
.p2align 8
.type k1_kernel,@function
k1_kernel:
    s_cmp_ge_u32 s2, 256
    s_cbranch_scc1 k1_kernel_end
    s_load_dwordx2 s[4:5], s[0:1], 0
    s_load_dwordx2 s[8:9], s[0:1], 56
    s_load_dwordx2 s[12:13], s[0:1], 8
    s_load_dwordx2 s[16:17], s[0:1], 16
    s_load_dwordx2 s[20:21], s[0:1], 24
    s_load_dwordx2 s[24:25], s[0:1], 104
    s_load_dwordx2 s[28:29], s[0:1], 96
    s_load_dwordx2 s[32:33], s[0:1], 64
    s_load_dwordx2 s[36:37], s[0:1], 32
    v_lshrrev_b32 v2, 6, v0
    v_and_b32 v1, 63, v0
    v_readfirstlane_b32 s42, v2
    s_mov_b32 s6, 2621440
    s_mov_b32 s7, 0x20000
    s_mov_b32 s10, 1966080
    s_mov_b32 s11, 0x20000
    s_mov_b32 s14, 2621440
    s_mov_b32 s15, 0x20000
    s_mov_b32 s18, 2621440
    s_mov_b32 s19, 0x20000
    s_mov_b32 s22, 5120
    s_mov_b32 s23, 0x20000
    s_mov_b32 s26, 15007744
    s_mov_b32 s27, 0x20000
    s_mov_b32 s30, 256
    s_mov_b32 s31, 0x20000
    s_mov_b32 s34, 8388608
    s_mov_b32 s35, 0x20000
    s_mov_b32 s38, 2621440
    s_mov_b32 s39, 0x20000
    s_and_b32 s48, s2, 7
    s_lshr_b32 s49, s2, 3
    s_lshr_b32 s66, s48, 1
    s_and_b32 s67, s48, 1
    s_lshl_b32 s57, s49, 3
    s_add_u32 s57, s57, s42
    v_lshrrev_b32 v4, 2, v1
    s_lshl_b32 s50, s57, 1
    v_add_u32 v4, s50, v4
    v_mul_u32_u24 v4, 1280, v4
    v_and_b32 v5, 3, v1
    v_lshl_add_u32 v4, v5, 7, v4
    s_mul_i32 s50, s57, 3072
    s_sub_u32 s50, s50, 1024
    v_lshl_add_u32 v5, v1, 7, s50
    v_cmp_gt_u32 vcc, 8, v1
    s_nop 1
    v_cndmask_b32 v36, v5, v4, vcc
    s_mul_i32 s86, s66, 655360
    s_mul_i32 s87, s67, 768
    s_mul_i32 s88, s67, 640
    s_add_u32 s88, s88, s86
    s_lshl_b32 s40, s66, 3
    s_and_b32 s48, s49, 7
    s_add_u32 s40, s40, s48
    s_lshl_b32 s41, s67, 2
    s_lshr_b32 s48, s49, 3
    s_add_u32 s41, s41, s48
    s_mul_i32 s52, s40, 81920
    s_mul_i32 s54, s41, 192
    s_add_u32 s53, s54, 1536
    s_lshl_b32 s60, s42, 11
    s_mul_i32 s61, s42, 3072
    v_lshrrev_b32 v2, 4, v1
    v_and_b32 v3, 15, v1
    s_waitcnt lgkmcnt(0)
    v_mov_b32 v4, 14712832
    buffer_load_dwordx2 v[34:35], v4, s[24:27], 0 offen sc1
    s_lshl_b32 s48, s42, 3
    v_add_u32 v4, s48, v2
    v_and_b32 v5, 15, v4
    v_xor_b32 v5, v5, v3
    v_lshlrev_b32 v5, 4, v5
    v_mul_u32_u24 v4, 1280, v4
    v_add_u32 v38, v4, v5
    v_add_u32 v4, s48, v2
    v_add_u32 v4, 4, v4
    v_and_b32 v5, 15, v4
    v_xor_b32 v5, v5, v3
    v_lshlrev_b32 v5, 4, v5
    v_mul_u32_u24 v4, 1280, v4
    v_add_u32 v39, v4, v5
    s_add_u32 s48, s40, s41
    s_mul_i32 s49, s48, 52
    s_lshr_b32 s49, s49, 8
    s_mul_i32 s49, s49, 5
    s_sub_u32 s48, s48, s49
    s_add_u32 s49, s48, 0
    s_sub_u32 s50, s49, 5
    s_cmp_ge_u32 s49, 5
    s_cselect_b32 s49, s50, s49
    s_lshl_b32 s90, s49, 8
    s_mul_i32 s95, s49, 393216
    s_add_u32 s49, s48, 1
    s_sub_u32 s50, s49, 5
    s_cmp_ge_u32 s49, 5
    s_cselect_b32 s49, s50, s49
    s_lshl_b32 s91, s49, 8
    s_mul_i32 s96, s49, 393216
    s_add_u32 s49, s48, 2
    s_sub_u32 s50, s49, 5
    s_cmp_ge_u32 s49, 5
    s_cselect_b32 s49, s50, s49
    s_lshl_b32 s92, s49, 8
    s_mul_i32 s97, s49, 393216
    s_add_u32 s49, s48, 3
    s_sub_u32 s50, s49, 5
    s_cmp_ge_u32 s49, 5
    s_cselect_b32 s49, s50, s49
    s_lshl_b32 s93, s49, 8
    s_mul_i32 s98, s49, 393216
    s_add_u32 s49, s48, 4
    s_sub_u32 s50, s49, 5
    s_cmp_ge_u32 s49, 5
    s_cselect_b32 s49, s50, s49
    s_lshl_b32 s94, s49, 8
    s_mul_i32 s99, s49, 393216
    s_barrier
    s_add_u32 s65, s52, s90
    s_add_u32 m0, s60, 0
    s_nop 0
    buffer_load_dwordx4 v38, s[4:7], s65 offen lds
    s_add_u32 s65, s52, s90
    s_add_u32 m0, s60, 1024
    s_nop 0
    buffer_load_dwordx4 v39, s[4:7], s65 offen lds
    s_mul_i32 s48, s42, 192
    v_add_u32 v4, s48, v1
    v_mul_u32_u24 v5, 43691, v4
    v_lshrrev_b32 v5, 19, v5
    v_mul_u32_u24 v6, 12, v5
    v_sub_u32 v4, v4, v6
    v_lshrrev_b32 v6, 2, v5
    v_and_b32 v6, 2, v6
    v_xor_b32 v4, v4, v6
    v_lshlrev_b32 v4, 4, v4
    v_mul_u32_u24 v5, 3072, v5
    v_add_u32 v40, v4, v5
    v_add_u32 v4, s48, v1
    v_add_u32 v4, 64, v4
    v_mul_u32_u24 v5, 43691, v4
    v_lshrrev_b32 v5, 19, v5
    v_mul_u32_u24 v6, 12, v5
    v_sub_u32 v4, v4, v6
    v_lshrrev_b32 v6, 2, v5
    v_and_b32 v6, 2, v6
    v_xor_b32 v4, v4, v6
    v_lshlrev_b32 v4, 4, v4
    v_mul_u32_u24 v5, 3072, v5
    v_add_u32 v41, v4, v5
    v_add_u32 v4, s48, v1
    v_add_u32 v4, 128, v4
    v_mul_u32_u24 v5, 43691, v4
    v_lshrrev_b32 v5, 19, v5
    v_mul_u32_u24 v6, 12, v5
    v_sub_u32 v4, v4, v6
    v_lshrrev_b32 v6, 2, v5
    v_and_b32 v6, 2, v6
    v_xor_b32 v4, v4, v6
    v_lshlrev_b32 v4, 4, v4
    v_mul_u32_u24 v5, 3072, v5
    v_add_u32 v42, v4, v5
    s_add_u32 s65, s53, s95
    s_add_u32 m0, s61, 81920
    s_nop 0
    buffer_load_dwordx4 v40, s[8:11], s65 offen lds
    s_add_u32 s65, s53, s95
    s_add_u32 m0, s61, 82944
    s_nop 0
    buffer_load_dwordx4 v41, s[8:11], s65 offen lds
    s_add_u32 s65, s53, s95
    s_add_u32 m0, s61, 83968
    s_nop 0
    buffer_load_dwordx4 v42, s[8:11], s65 offen lds
    s_barrier
    s_cmp_lg_u32 s42, 7
    s_cbranch_scc1 k1_shk_1
    v_lshlrev_b32 v4, 4, v1
    s_mul_i32 s48, s41, 640
    s_mov_b32 m0, 160768
    s_mov_b32 exec_lo, -1
    s_mov_b32 exec_hi, 0xff
    buffer_load_dwordx4 v4, s[20:23], s48 offen lds
    s_mov_b64 exec, -1
k1_shk_1:
    s_add_u32 s65, s52, s91
    s_add_u32 m0, s60, 16384
    s_nop 0
    buffer_load_dwordx4 v38, s[4:7], s65 offen lds
    s_add_u32 s65, s52, s91
    s_add_u32 m0, s60, 17408
    s_nop 0
    buffer_load_dwordx4 v39, s[4:7], s65 offen lds
    s_add_u32 s65, s53, s96
    s_add_u32 m0, s61, 106496
    s_nop 0
    buffer_load_dwordx4 v40, s[8:11], s65 offen lds
    s_add_u32 s65, s53, s96
    s_add_u32 m0, s61, 107520
    s_nop 0
    buffer_load_dwordx4 v41, s[8:11], s65 offen lds
    s_add_u32 s65, s53, s96
    s_add_u32 m0, s61, 108544
    s_nop 0
    buffer_load_dwordx4 v42, s[8:11], s65 offen lds
    s_and_b32 s43, s42, 1
    s_lshr_b32 s44, s42, 1
    s_and_b32 s44, s44, 1
    s_lshr_b32 s45, s42, 2
    s_xor_b32 s46, s43, s45
    s_lshl_b32 s47, s44, 1
    s_add_u32 s47, s47, s46
    s_mov_b32 s55, 0x3727c5ac
    s_mov_b32 s56, 0x3f803f80
    s_mov_b32 s58, 0xbdd2d3e8
    s_mov_b32 s59, 0xbdd2d3e8
    s_lshl_b32 s48, s45, 1
    s_add_u32 s63, s48, s44
    s_xor_b32 s64, s63, 1
    v_xor_b32 v4, v2, v3
    v_lshlrev_b32 v6, 8, v3
    s_lshl_b32 s48, s44, 13
    s_lshl_b32 s49, s46, 12
    s_add_u32 s50, s48, s49
    s_xor_b32 s49, s49, 4096
    s_add_u32 s51, s48, s49
    s_lshl_b32 s48, s63, 2
    v_xor_b32 v5, s48, v4
    v_lshl_add_u32 v5, v5, 4, v6
    v_add_u32 v45, s50, v5
    v_add_u32 v46, s51, v5
    s_lshl_b32 s48, s64, 2
    v_xor_b32 v5, s48, v4
    v_lshl_add_u32 v5, v5, 4, v6
    v_add_u32 v47, s50, v5
    v_add_u32 v224, s51, v5
    v_lshrrev_b32 v5, 2, v3
    v_lshl_add_u32 v4, v2, 3, v5
    v_mul_u32_u24 v4, 192, v4
    v_and_b32 v5, 3, v3
    v_lshl_add_u32 v4, v5, 3, v4
    v_and_b32 v5, 1, v2
    s_mul_i32 s51, s43, 3
    s_mul_i32 s49, s63, 6144
    s_add_u32 s49, s49, 81920
    s_mul_i32 s50, s64, 6144
    s_add_u32 s50, s50, 81920
    s_add_u32 s48, s51, 0
    v_xor_b32 v6, s48, v5
    v_lshl_add_u32 v6, v6, 5, v4
    v_add_u32 v225, s49, v6
    v_add_u32 v228, s50, v6
    s_add_u32 s48, s51, 1
    v_xor_b32 v6, s48, v5
    v_lshl_add_u32 v6, v6, 5, v4
    v_add_u32 v226, s49, v6
    v_add_u32 v229, s50, v6
    s_add_u32 s48, s51, 2
    v_xor_b32 v6, s48, v5
    v_lshl_add_u32 v6, v6, 5, v4
    v_add_u32 v227, s49, v6
    v_add_u32 v230, s50, v6
    v_mov_b32 v252, s56
    v_mov_b32 v253, s56
    v_mov_b32 v254, s56
    v_mov_b32 v255, s56
    v_mul_u32_u24 v43, 205, v1
    v_lshrrev_b32 v43, 11, v43
    v_mul_u32_u24 v4, 10, v43
    v_sub_u32 v44, v1, v4
    s_lshl_b32 s48, s42, 3
    v_lshl_add_u32 v4, v43, 1, s48
    v_mul_u32_u24 v4, 1280, v4
    v_lshl_add_u32 v4, v44, 4, v4
    s_mul_i32 s48, s41, 160
    s_add_u32 s48, s48, s52
    v_add_u32 v7, s48, v4
    s_waitcnt vmcnt(5)
    s_barrier
    v_readfirstlane_b32 s100, v34
    v_readfirstlane_b32 s101, v35
    s_add_u32 s100, s100, 1
    s_addc_u32 s101, s101, 0
    ds_read_b128 v[48:51], v45 offset:0
    ds_read_b128 v[52:55], v46 offset:0
    ds_read_b128 v[56:59], v47 offset:0
    ds_read_b128 v[60:63], v224 offset:0
    ds_read_b64_tr_b16 v[128:129], v225 offset:0
    ds_read_b64_tr_b16 v[130:131], v225 offset:768
    ds_read_b64_tr_b16 v[132:133], v226 offset:0
    ds_read_b64_tr_b16 v[134:135], v226 offset:768
    ds_read_b64_tr_b16 v[136:137], v227 offset:0
    ds_read_b64_tr_b16 v[138:139], v227 offset:768
    ds_read_b64_tr_b16 v[140:141], v228 offset:0
    ds_read_b64_tr_b16 v[142:143], v228 offset:768
    ds_read_b64_tr_b16 v[144:145], v229 offset:0
    ds_read_b64_tr_b16 v[146:147], v229 offset:768
    ds_read_b64_tr_b16 v[148:149], v230 offset:0
    ds_read_b64_tr_b16 v[150:151], v230 offset:768
    s_add_u32 s65, s52, s92
    s_add_u32 m0, s60, 32768
    s_nop 0
    buffer_load_dwordx4 v38, s[4:7], s65 offen lds
    s_add_u32 s65, s52, s92
    s_add_u32 m0, s60, 33792
    s_nop 0
    buffer_load_dwordx4 v39, s[4:7], s65 offen lds
    s_add_u32 s65, s53, s97
    s_add_u32 m0, s61, 131072
    s_nop 0
    buffer_load_dwordx4 v40, s[8:11], s65 offen lds
    s_add_u32 s65, s53, s97
    s_add_u32 m0, s61, 132096
    s_nop 0
    buffer_load_dwordx4 v41, s[8:11], s65 offen lds
    s_add_u32 s65, s53, s97
    s_add_u32 m0, s61, 133120
    s_nop 0
    buffer_load_dwordx4 v42, s[8:11], s65 offen lds
    s_waitcnt vmcnt(5)
    s_waitcnt lgkmcnt(0)
    s_barrier
    ds_read_b128 v[64:67], v45 offset:16384
    ds_read_b128 v[68:71], v46 offset:16384
    ds_read_b128 v[72:75], v47 offset:16384
    ds_read_b128 v[76:79], v224 offset:16384
    ds_read_b64_tr_b16 v[152:153], v225 offset:24576
    ds_read_b64_tr_b16 v[154:155], v225 offset:25344
    ds_read_b64_tr_b16 v[156:157], v226 offset:24576
    ds_read_b64_tr_b16 v[158:159], v226 offset:25344
    ds_read_b64_tr_b16 v[160:161], v227 offset:24576
    ds_read_b64_tr_b16 v[162:163], v227 offset:25344
    ds_read_b64_tr_b16 v[164:165], v228 offset:24576
    ds_read_b64_tr_b16 v[166:167], v228 offset:25344
    ds_read_b64_tr_b16 v[168:169], v229 offset:24576
    ds_read_b64_tr_b16 v[170:171], v229 offset:25344
    ds_read_b64_tr_b16 v[172:173], v230 offset:24576
    ds_read_b64_tr_b16 v[174:175], v230 offset:25344
    v_mfma_f32_16x16x32_bf16 v[176:179], v[128:131], v[48:51], 0
    v_mfma_f32_16x16x32_bf16 v[180:183], v[128:131], v[52:55], 0
    v_mfma_f32_16x16x32_bf16 v[232:235], v[128:131], v[252:255], 0
    v_mfma_f32_16x16x32_bf16 v[184:187], v[132:135], v[48:51], 0
    v_mfma_f32_16x16x32_bf16 v[188:191], v[132:135], v[52:55], 0
    v_mfma_f32_16x16x32_bf16 v[236:239], v[132:135], v[252:255], 0
    v_mfma_f32_16x16x32_bf16 v[192:195], v[136:139], v[48:51], 0
    v_mfma_f32_16x16x32_bf16 v[196:199], v[136:139], v[52:55], 0
    s_add_u32 s65, s52, s93
    s_add_u32 m0, s60, 49152
    s_nop 0
    buffer_load_dwordx4 v38, s[4:7], s65 offen lds
    v_mfma_f32_16x16x32_bf16 v[240:243], v[136:139], v[252:255], 0
    v_mfma_f32_16x16x32_bf16 v[244:247], v[252:255], v[48:51], 0
    v_mfma_f32_16x16x32_bf16 v[248:251], v[48:51], v[48:51], 0
    s_add_u32 s65, s52, s93
    s_add_u32 m0, s60, 50176
    s_nop 0
    buffer_load_dwordx4 v39, s[4:7], s65 offen lds
    v_mfma_f32_16x16x32_bf16 v[176:179], v[140:143], v[56:59], v[176:179]
    v_mfma_f32_16x16x32_bf16 v[180:183], v[140:143], v[60:63], v[180:183]
    v_mfma_f32_16x16x32_bf16 v[184:187], v[144:147], v[56:59], v[184:187]
    s_add_u32 s65, s53, s98
    s_add_u32 m0, s61, 81920
    s_nop 0
    buffer_load_dwordx4 v40, s[8:11], s65 offen lds
    v_mfma_f32_16x16x32_bf16 v[188:191], v[144:147], v[60:63], v[188:191]
    v_mfma_f32_16x16x32_bf16 v[192:195], v[148:151], v[56:59], v[192:195]
    v_mfma_f32_16x16x32_bf16 v[196:199], v[148:151], v[60:63], v[196:199]
    s_add_u32 s65, s53, s98
    s_add_u32 m0, s61, 82944
    s_nop 0
    buffer_load_dwordx4 v41, s[8:11], s65 offen lds
    v_mfma_f32_16x16x32_bf16 v[244:247], v[252:255], v[56:59], v[244:247]
    v_mfma_f32_16x16x32_bf16 v[248:251], v[56:59], v[56:59], v[248:251]
    s_add_u32 s65, s53, s98
    s_add_u32 m0, s61, 83968
    s_nop 0
    buffer_load_dwordx4 v42, s[8:11], s65 offen lds
    v_subrev_u32 v32, 3840, v7
    v_subrev_u32 v33, 2560, v7
    v_subrev_u32 v34, 1280, v7
    s_mov_b32 exec_lo, -1
    s_mov_b32 exec_hi, 0xff
    buffer_load_dwordx4 v[112:115], v32, s[12:15], 0 offen
    buffer_load_dwordx4 v[116:119], v33, s[12:15], 0 offen
    buffer_load_dwordx4 v[120:123], v34, s[12:15], 0 offen
    buffer_load_dwordx4 v[124:127], v7, s[12:15], 0 offen
    buffer_load_dwordx4 v[212:215], v7, s[12:15], 0 offen offset:1280
    buffer_load_dwordx4 v[216:219], v7, s[16:19], 0 offen
    buffer_load_dwordx4 v[220:223], v7, s[16:19], 0 offen offset:1280
    s_mov_b64 exec, -1
    s_waitcnt vmcnt(12)
    s_waitcnt lgkmcnt(0)
    s_barrier
    ds_read_b128 v[80:83], v45 offset:32768
    ds_read_b128 v[84:87], v46 offset:32768
    ds_read_b128 v[88:91], v47 offset:32768
    ds_read_b128 v[92:95], v224 offset:32768
    ds_read_b64_tr_b16 v[128:129], v225 offset:49152
    ds_read_b64_tr_b16 v[130:131], v225 offset:49920
    ds_read_b64_tr_b16 v[132:133], v226 offset:49152
    ds_read_b64_tr_b16 v[134:135], v226 offset:49920
    ds_read_b64_tr_b16 v[136:137], v227 offset:49152
    ds_read_b64_tr_b16 v[138:139], v227 offset:49920
    ds_read_b64_tr_b16 v[140:141], v228 offset:49152
    ds_read_b64_tr_b16 v[142:143], v228 offset:49920
    ds_read_b64_tr_b16 v[144:145], v229 offset:49152
    ds_read_b64_tr_b16 v[146:147], v229 offset:49920
    ds_read_b64_tr_b16 v[148:149], v230 offset:49152
    ds_read_b64_tr_b16 v[150:151], v230 offset:49920
    v_mfma_f32_16x16x32_bf16 v[176:179], v[152:155], v[64:67], v[176:179]
    s_waitcnt vmcnt(0)
    v_mul_u32_u24 v7, 1152, v44
    v_lshlrev_b32 v34, 2, v43
    v_sub_u32 v7, v7, v34
    s_lshl_b32 s48, s42, 4
    s_add_u32 s48, s48, 12
    v_add_u32 v7, s48, v7
    v_mfma_f32_16x16x32_bf16 v[180:183], v[152:155], v[68:71], v[180:183]
    v_lshlrev_b32 v44, 6, v44
    v_add_u32 v44, 160768, v44
    ds_read_b128 v[200:203], v44 offset:0
    ds_read_b128 v[204:207], v44 offset:16
    v_lshlrev_b32 v8, 16, v112
    v_and_b32 v9, 0xffff0000, v112
    v_mfma_f32_16x16x32_bf16 v[232:235], v[152:155], v[252:255], v[232:235]
    v_lshlrev_b32 v10, 16, v116
    v_and_b32 v11, 0xffff0000, v116
    v_lshlrev_b32 v12, 16, v120
    v_and_b32 v13, 0xffff0000, v120
    v_lshlrev_b32 v14, 16, v124
    v_mfma_f32_16x16x32_bf16 v[184:187], v[156:159], v[64:67], v[184:187]
    v_and_b32 v15, 0xffff0000, v124
    v_lshlrev_b32 v16, 16, v212
    v_and_b32 v17, 0xffff0000, v212
    s_waitcnt lgkmcnt(0)
    v_lshlrev_b32 v18, 16, v200
    v_lshlrev_b32 v19, 16, v202
    v_mfma_f32_16x16x32_bf16 v[188:191], v[156:159], v[68:71], v[188:191]
    s_add_u32 s65, s52, s94
    s_add_u32 m0, s60, 65536
    s_nop 0
    buffer_load_dwordx4 v38, s[4:7], s65 offen lds
    v_and_b32 v20, 0xffff0000, v200
    v_and_b32 v21, 0xffff0000, v202
    v_lshlrev_b32 v22, 16, v201
    v_lshlrev_b32 v23, 16, v203
    v_and_b32 v24, 0xffff0000, v201
    v_mfma_f32_16x16x32_bf16 v[236:239], v[156:159], v[252:255], v[236:239]
    v_and_b32 v25, 0xffff0000, v203
    v_mul_f32 v26, v14, v18
    v_mul_f32 v27, v15, v19
    v_mul_f32 v28, v16, v18
    v_mul_f32 v29, v17, v19
    v_mfma_f32_16x16x32_bf16 v[192:195], v[160:163], v[64:67], v[192:195]
    v_fma_f32 v26, v12, v20, v26
    v_fma_f32 v27, v13, v21, v27
    v_fma_f32 v28, v14, v20, v28
    v_fma_f32 v29, v15, v21, v29
    v_fma_f32 v26, v10, v22, v26
    v_mfma_f32_16x16x32_bf16 v[196:199], v[160:163], v[68:71], v[196:199]
    s_add_u32 s65, s52, s94
    s_add_u32 m0, s60, 66560
    s_nop 0
    buffer_load_dwordx4 v39, s[4:7], s65 offen lds
    v_fma_f32 v27, v11, v23, v27
    v_fma_f32 v28, v12, v22, v28
    v_fma_f32 v29, v13, v23, v29
    v_fma_f32 v26, v8, v24, v26
    v_fma_f32 v27, v9, v25, v27
    v_mfma_f32_16x16x32_bf16 v[240:243], v[160:163], v[252:255], v[240:243]
    v_fma_f32 v28, v10, v24, v28
    v_fma_f32 v29, v11, v25, v29
    v_lshlrev_b32 v30, 16, v216
    v_and_b32 v31, 0xffff0000, v216
    v_lshlrev_b32 v32, 16, v220
    v_mfma_f32_16x16x32_bf16 v[244:247], v[252:255], v[64:67], v[244:247]
    v_and_b32 v33, 0xffff0000, v220
    v_mul_f32 v26, v26, v30
    v_mul_f32 v27, v27, v31
    v_mul_f32 v28, v28, v32
    v_mul_f32 v29, v29, v33
    v_mfma_f32_16x16x32_bf16 v[248:251], v[64:67], v[64:67], v[248:251]
    s_add_u32 s65, s53, s99
    s_add_u32 m0, s61, 106496
    s_nop 0
    buffer_load_dwordx4 v40, s[8:11], s65 offen lds
    v_cvt_pk_bf16_f32 v34, v28, v26
    v_cvt_pk_bf16_f32 v35, v29, v27
    s_mov_b32 exec_hi, 0xff
    ds_write_b32 v7, v34 offset:0
    ds_write_b32 v7, v35 offset:144
    s_mov_b32 exec_hi, -1
    v_lshlrev_b32 v8, 16, v113
    v_and_b32 v9, 0xffff0000, v113
    v_mfma_f32_16x16x32_bf16 v[176:179], v[164:167], v[72:75], v[176:179]
    v_lshlrev_b32 v10, 16, v117
    v_and_b32 v11, 0xffff0000, v117
    v_lshlrev_b32 v12, 16, v121
    v_and_b32 v13, 0xffff0000, v121
    v_lshlrev_b32 v14, 16, v125
    v_mfma_f32_16x16x32_bf16 v[180:183], v[164:167], v[76:79], v[180:183]
    v_and_b32 v15, 0xffff0000, v125
    v_lshlrev_b32 v16, 16, v213
    v_and_b32 v17, 0xffff0000, v213
    v_lshlrev_b32 v18, 16, v204
    v_lshlrev_b32 v19, 16, v206
    v_mfma_f32_16x16x32_bf16 v[184:187], v[168:171], v[72:75], v[184:187]
    s_add_u32 s65, s53, s99
    s_add_u32 m0, s61, 107520
    s_nop 0
    buffer_load_dwordx4 v41, s[8:11], s65 offen lds
    v_and_b32 v20, 0xffff0000, v204
    v_and_b32 v21, 0xffff0000, v206
    v_lshlrev_b32 v22, 16, v205
    v_lshlrev_b32 v23, 16, v207
    v_and_b32 v24, 0xffff0000, v205
    v_mfma_f32_16x16x32_bf16 v[188:191], v[168:171], v[76:79], v[188:191]
    v_and_b32 v25, 0xffff0000, v207
    v_mul_f32 v26, v14, v18
    v_mul_f32 v27, v15, v19
    v_mul_f32 v28, v16, v18
    v_mul_f32 v29, v17, v19
    v_mfma_f32_16x16x32_bf16 v[192:195], v[172:175], v[72:75], v[192:195]
    v_fma_f32 v26, v12, v20, v26
    v_fma_f32 v27, v13, v21, v27
    v_fma_f32 v28, v14, v20, v28
    v_fma_f32 v29, v15, v21, v29
    v_fma_f32 v26, v10, v22, v26
    v_mfma_f32_16x16x32_bf16 v[196:199], v[172:175], v[76:79], v[196:199]
    s_add_u32 s65, s53, s99
    s_add_u32 m0, s61, 108544
    s_nop 0
    buffer_load_dwordx4 v42, s[8:11], s65 offen lds
    v_fma_f32 v27, v11, v23, v27
    v_fma_f32 v28, v12, v22, v28
    v_fma_f32 v29, v13, v23, v29
    v_fma_f32 v26, v8, v24, v26
    v_fma_f32 v27, v9, v25, v27
    v_mfma_f32_16x16x32_bf16 v[244:247], v[252:255], v[72:75], v[244:247]
    v_fma_f32 v28, v10, v24, v28
    v_fma_f32 v29, v11, v25, v29
    v_lshlrev_b32 v30, 16, v217
    v_and_b32 v31, 0xffff0000, v217
    v_lshlrev_b32 v32, 16, v221
    v_mfma_f32_16x16x32_bf16 v[248:251], v[72:75], v[72:75], v[248:251]
    v_and_b32 v33, 0xffff0000, v221
    v_mul_f32 v26, v26, v30
    v_mul_f32 v27, v27, v31
    v_mul_f32 v28, v28, v32
    v_mul_f32 v29, v29, v33
    s_waitcnt vmcnt(12)
    s_waitcnt lgkmcnt(0)
    s_barrier
    ds_read_b128 v[96:99], v45 offset:49152
    ds_read_b128 v[100:103], v46 offset:49152
    ds_read_b128 v[104:107], v47 offset:49152
    ds_read_b128 v[108:111], v224 offset:49152
    ds_read_b64_tr_b16 v[152:153], v225 offset:0
    ds_read_b64_tr_b16 v[154:155], v225 offset:768
    ds_read_b64_tr_b16 v[156:157], v226 offset:0
    ds_read_b64_tr_b16 v[158:159], v226 offset:768
    ds_read_b64_tr_b16 v[160:161], v227 offset:0
    ds_read_b64_tr_b16 v[162:163], v227 offset:768
    ds_read_b64_tr_b16 v[164:165], v228 offset:0
    ds_read_b64_tr_b16 v[166:167], v228 offset:768
    ds_read_b64_tr_b16 v[168:169], v229 offset:0
    ds_read_b64_tr_b16 v[170:171], v229 offset:768
    ds_read_b64_tr_b16 v[172:173], v230 offset:0
    ds_read_b64_tr_b16 v[174:175], v230 offset:768
    v_mfma_f32_16x16x32_bf16 v[176:179], v[128:131], v[80:83], v[176:179]
    v_cvt_pk_bf16_f32 v34, v28, v26
    v_cvt_pk_bf16_f32 v35, v29, v27
    s_mov_b32 exec_hi, 0xff
    ds_write_b32 v7, v34 offset:288
    ds_write_b32 v7, v35 offset:432
    s_mov_b32 exec_hi, -1
    ds_read_b128 v[200:203], v44 offset:32
    ds_read_b128 v[204:207], v44 offset:48
    v_lshlrev_b32 v8, 16, v114
    v_mfma_f32_16x16x32_bf16 v[180:183], v[128:131], v[84:87], v[180:183]
    s_add_u32 s65, s54, s95
    s_add_u32 m0, s61, 131072
    s_nop 0
    buffer_load_dwordx4 v40, s[8:11], s65 offen lds
    v_and_b32 v9, 0xffff0000, v114
    v_lshlrev_b32 v10, 16, v118
    v_and_b32 v11, 0xffff0000, v118
    v_lshlrev_b32 v12, 16, v122
    v_and_b32 v13, 0xffff0000, v122
    v_mfma_f32_16x16x32_bf16 v[232:235], v[128:131], v[252:255], v[232:235]
    v_lshlrev_b32 v14, 16, v126
    v_and_b32 v15, 0xffff0000, v126
    v_lshlrev_b32 v16, 16, v214
    v_and_b32 v17, 0xffff0000, v214
    s_waitcnt lgkmcnt(0)
    v_lshlrev_b32 v18, 16, v200
    v_mfma_f32_16x16x32_bf16 v[184:187], v[132:135], v[80:83], v[184:187]
    v_lshlrev_b32 v19, 16, v202
    v_and_b32 v20, 0xffff0000, v200
    v_and_b32 v21, 0xffff0000, v202
    v_lshlrev_b32 v22, 16, v201
    v_lshlrev_b32 v23, 16, v203
    v_mfma_f32_16x16x32_bf16 v[188:191], v[132:135], v[84:87], v[188:191]
    s_add_u32 s65, s54, s95
    s_add_u32 m0, s61, 132096
    s_nop 0
    buffer_load_dwordx4 v41, s[8:11], s65 offen lds
    v_and_b32 v24, 0xffff0000, v201
    v_and_b32 v25, 0xffff0000, v203
    v_mul_f32 v26, v14, v18
    v_mul_f32 v27, v15, v19
    v_mul_f32 v28, v16, v18
    v_mfma_f32_16x16x32_bf16 v[236:239], v[132:135], v[252:255], v[236:239]
    v_mul_f32 v29, v17, v19
    v_fma_f32 v26, v12, v20, v26
    v_fma_f32 v27, v13, v21, v27
    v_fma_f32 v28, v14, v20, v28
    v_fma_f32 v29, v15, v21, v29
    v_mfma_f32_16x16x32_bf16 v[192:195], v[136:139], v[80:83], v[192:195]
    v_fma_f32 v26, v10, v22, v26
    v_fma_f32 v27, v11, v23, v27
    v_fma_f32 v28, v12, v22, v28
    v_fma_f32 v29, v13, v23, v29
    v_fma_f32 v26, v8, v24, v26
    v_mfma_f32_16x16x32_bf16 v[196:199], v[136:139], v[84:87], v[196:199]
    s_add_u32 s65, s54, s95
    s_add_u32 m0, s61, 133120
    s_nop 0
    buffer_load_dwordx4 v42, s[8:11], s65 offen lds
    v_fma_f32 v27, v9, v25, v27
    v_fma_f32 v28, v10, v24, v28
    v_fma_f32 v29, v11, v25, v29
    v_lshlrev_b32 v30, 16, v218
    v_and_b32 v31, 0xffff0000, v218
    v_mfma_f32_16x16x32_bf16 v[240:243], v[136:139], v[252:255], v[240:243]
    v_lshlrev_b32 v32, 16, v222
    v_and_b32 v33, 0xffff0000, v222
    v_mul_f32 v26, v26, v30
    v_mul_f32 v27, v27, v31
    v_mul_f32 v28, v28, v32
    v_mfma_f32_16x16x32_bf16 v[244:247], v[252:255], v[80:83], v[244:247]
    v_mul_f32 v29, v29, v33
    v_cvt_pk_bf16_f32 v34, v28, v26
    v_cvt_pk_bf16_f32 v35, v29, v27
    s_mov_b32 exec_hi, 0xff
    ds_write_b32 v7, v34 offset:576
    ds_write_b32 v7, v35 offset:720
    s_mov_b32 exec_hi, -1
    v_lshlrev_b32 v8, 16, v115
    v_mfma_f32_16x16x32_bf16 v[248:251], v[80:83], v[80:83], v[248:251]
    v_and_b32 v9, 0xffff0000, v115
    v_lshlrev_b32 v10, 16, v119
    v_and_b32 v11, 0xffff0000, v119
    v_lshlrev_b32 v12, 16, v123
    v_and_b32 v13, 0xffff0000, v123
    v_mfma_f32_16x16x32_bf16 v[176:179], v[140:143], v[88:91], v[176:179]
    v_lshlrev_b32 v14, 16, v127
    v_and_b32 v15, 0xffff0000, v127
    v_lshlrev_b32 v16, 16, v215
    v_and_b32 v17, 0xffff0000, v215
    v_lshlrev_b32 v18, 16, v204
    v_mfma_f32_16x16x32_bf16 v[180:183], v[140:143], v[92:95], v[180:183]
    v_lshlrev_b32 v19, 16, v206
    v_and_b32 v20, 0xffff0000, v204
    v_and_b32 v21, 0xffff0000, v206
    v_lshlrev_b32 v22, 16, v205
    v_lshlrev_b32 v23, 16, v207
    v_mfma_f32_16x16x32_bf16 v[184:187], v[144:147], v[88:91], v[184:187]
    v_and_b32 v24, 0xffff0000, v205
    v_and_b32 v25, 0xffff0000, v207
    v_mul_f32 v26, v14, v18
    v_mul_f32 v27, v15, v19
    v_mul_f32 v28, v16, v18
    v_mfma_f32_16x16x32_bf16 v[188:191], v[144:147], v[92:95], v[188:191]
    v_mul_f32 v29, v17, v19
    v_fma_f32 v26, v12, v20, v26
    v_fma_f32 v27, v13, v21, v27
    v_fma_f32 v28, v14, v20, v28
    v_fma_f32 v29, v15, v21, v29
    v_mfma_f32_16x16x32_bf16 v[192:195], v[148:151], v[88:91], v[192:195]
    v_fma_f32 v26, v10, v22, v26
    v_fma_f32 v27, v11, v23, v27
    v_fma_f32 v28, v12, v22, v28
    v_fma_f32 v29, v13, v23, v29
    v_fma_f32 v26, v8, v24, v26
    v_mfma_f32_16x16x32_bf16 v[196:199], v[148:151], v[92:95], v[196:199]
    v_fma_f32 v27, v9, v25, v27
    v_fma_f32 v28, v10, v24, v28
    v_fma_f32 v29, v11, v25, v29
    v_lshlrev_b32 v30, 16, v219
    v_and_b32 v31, 0xffff0000, v219
    v_mfma_f32_16x16x32_bf16 v[244:247], v[252:255], v[88:91], v[244:247]
    v_lshlrev_b32 v32, 16, v223
    v_and_b32 v33, 0xffff0000, v223
    v_mul_f32 v26, v26, v30
    v_mul_f32 v27, v27, v31
    v_mul_f32 v28, v28, v32
    v_mfma_f32_16x16x32_bf16 v[248:251], v[88:91], v[88:91], v[248:251]
    v_mul_f32 v29, v29, v33
    v_cvt_pk_bf16_f32 v34, v28, v26
    v_cvt_pk_bf16_f32 v35, v29, v27
    s_mov_b32 exec_hi, 0xff
    ds_write_b32 v7, v34 offset:864
    ds_write_b32 v7, v35 offset:1008
    s_mov_b32 exec_hi, -1
    s_waitcnt vmcnt(3)
    s_waitcnt lgkmcnt(0)
    s_barrier
    v_add_u32 v45, 0x10000, v45
    v_add_u32 v46, 0x10000, v46
    v_add_u32 v47, 0x10000, v47
    v_add_u32 v224, 0x10000, v224
    ds_read_b128 v[112:115], v45 offset:0
    ds_read_b128 v[116:119], v46 offset:0
    ds_read_b128 v[120:123], v47 offset:0
    ds_read_b128 v[124:127], v224 offset:0
    ds_read_b64_tr_b16 v[128:129], v225 offset:24576
    ds_read_b64_tr_b16 v[130:131], v225 offset:25344
    ds_read_b64_tr_b16 v[132:133], v226 offset:24576
    ds_read_b64_tr_b16 v[134:135], v226 offset:25344
    ds_read_b64_tr_b16 v[136:137], v227 offset:24576
    ds_read_b64_tr_b16 v[138:139], v227 offset:25344
    ds_read_b64_tr_b16 v[140:141], v228 offset:24576
    ds_read_b64_tr_b16 v[142:143], v228 offset:25344
    ds_read_b64_tr_b16 v[144:145], v229 offset:24576
    ds_read_b64_tr_b16 v[146:147], v229 offset:25344
    ds_read_b64_tr_b16 v[148:149], v230 offset:24576
    ds_read_b64_tr_b16 v[150:151], v230 offset:25344
    v_mfma_f32_16x16x32_bf16 v[176:179], v[152:155], v[96:99], v[176:179]
    s_lshl_b32 s48, s42, 3
    v_lshrrev_b32 v4, 3, v1
    v_add_u32 v4, s48, v4
    v_mfma_f32_16x16x32_bf16 v[180:183], v[152:155], v[100:103], v[180:183]
    v_and_b32 v5, 7, v1
    v_lshlrev_b32 v5, 4, v5
    v_mfma_f32_16x16x32_bf16 v[232:235], v[152:155], v[252:255], v[232:235]
    v_mul_u32_u24 v6, 144, v4
    v_add_u32 v6, v6, v5
    v_mfma_f32_16x16x32_bf16 v[184:187], v[156:159], v[96:99], v[184:187]
    ds_read_b128 v[8:11], v6 offset:0
    v_mfma_f32_16x16x32_bf16 v[188:191], v[156:159], v[100:103], v[188:191]
    s_add_u32 s65, s54, s96
    s_add_u32 m0, s61, 81920
    s_nop 0
    buffer_load_dwordx4 v40, s[8:11], s65 offen lds
    v_lshlrev_b32 v4, 12, v4
    v_add_u32 v4, v4, v5
    v_mfma_f32_16x16x32_bf16 v[236:239], v[156:159], v[252:255], v[236:239]
    s_mul_i32 s48, s41, 327680
    s_lshl_b32 s49, s40, 7
    s_add_u32 s48, s48, s49
    s_add_u32 s48, s48, 6291456
    s_waitcnt lgkmcnt(0)
    buffer_store_dwordx4 v[8:11], v4, s[24:27], s48 offen
    v_mfma_f32_16x16x32_bf16 v[192:195], v[160:163], v[96:99], v[192:195]
    s_lshl_b32 s48, s42, 3
    s_add_u32 s48, s48, 64
    v_lshrrev_b32 v4, 3, v1
    v_add_u32 v4, s48, v4
    v_mfma_f32_16x16x32_bf16 v[196:199], v[160:163], v[100:103], v[196:199]
    s_add_u32 s65, s54, s96
    s_add_u32 m0, s61, 82944
    s_nop 0
    buffer_load_dwordx4 v41, s[8:11], s65 offen lds
    v_and_b32 v5, 7, v1
    v_lshlrev_b32 v5, 4, v5
    v_mfma_f32_16x16x32_bf16 v[240:243], v[160:163], v[252:255], v[240:243]
    v_mul_u32_u24 v6, 144, v4
    v_add_u32 v6, v6, v5
    v_mfma_f32_16x16x32_bf16 v[244:247], v[252:255], v[96:99], v[244:247]
    ds_read_b128 v[12:15], v6 offset:0
    v_mfma_f32_16x16x32_bf16 v[248:251], v[96:99], v[96:99], v[248:251]
    s_add_u32 s65, s54, s96
    s_add_u32 m0, s61, 83968
    s_nop 0
    buffer_load_dwordx4 v42, s[8:11], s65 offen lds
    v_lshlrev_b32 v4, 12, v4
    v_add_u32 v4, v4, v5
    v_mfma_f32_16x16x32_bf16 v[176:179], v[164:167], v[104:107], v[176:179]
    s_mul_i32 s48, s41, 327680
    s_lshl_b32 s49, s40, 7
    s_add_u32 s48, s48, s49
    s_add_u32 s48, s48, 6291456
    s_waitcnt lgkmcnt(0)
    s_cmp_ge_u32 s42, 2
    s_cbranch_scc1 k1_kvskip_2
    buffer_store_dwordx4 v[12:15], v4, s[24:27], s48 offen
k1_kvskip_2:
    v_mfma_f32_16x16x32_bf16 v[180:183], v[164:167], v[108:111], v[180:183]
    v_mfma_f32_16x16x32_bf16 v[184:187], v[168:171], v[104:107], v[184:187]
    v_mfma_f32_16x16x32_bf16 v[188:191], v[168:171], v[108:111], v[188:191]
    v_mfma_f32_16x16x32_bf16 v[192:195], v[172:175], v[104:107], v[192:195]
    v_mfma_f32_16x16x32_bf16 v[196:199], v[172:175], v[108:111], v[196:199]
    v_mfma_f32_16x16x32_bf16 v[244:247], v[252:255], v[104:107], v[244:247]
    v_mfma_f32_16x16x32_bf16 v[248:251], v[104:107], v[104:107], v[248:251]
    s_waitcnt vmcnt(4)
    s_waitcnt lgkmcnt(0)
    s_barrier
    ds_read_b64_tr_b16 v[152:153], v225 offset:49152
    ds_read_b64_tr_b16 v[154:155], v225 offset:49920
    ds_read_b64_tr_b16 v[156:157], v226 offset:49152
    ds_read_b64_tr_b16 v[158:159], v226 offset:49920
    ds_read_b64_tr_b16 v[160:161], v227 offset:49152
    ds_read_b64_tr_b16 v[162:163], v227 offset:49920
    ds_read_b64_tr_b16 v[164:165], v228 offset:49152
    ds_read_b64_tr_b16 v[166:167], v228 offset:49920
    ds_read_b64_tr_b16 v[168:169], v229 offset:49152
    ds_read_b64_tr_b16 v[170:171], v229 offset:49920
    ds_read_b64_tr_b16 v[172:173], v230 offset:49152
    ds_read_b64_tr_b16 v[174:175], v230 offset:49920
    v_mfma_f32_16x16x32_bf16 v[176:179], v[128:131], v[112:115], v[176:179]
    v_mfma_f32_16x16x32_bf16 v[180:183], v[128:131], v[116:119], v[180:183]
    s_add_u32 s65, s54, s97
    s_add_u32 m0, s61, 106496
    s_nop 0
    buffer_load_dwordx4 v40, s[8:11], s65 offen lds
    v_mfma_f32_16x16x32_bf16 v[232:235], v[128:131], v[252:255], v[232:235]
    v_mfma_f32_16x16x32_bf16 v[184:187], v[132:135], v[112:115], v[184:187]
    v_mfma_f32_16x16x32_bf16 v[188:191], v[132:135], v[116:119], v[188:191]
    s_add_u32 s65, s54, s97
    s_add_u32 m0, s61, 107520
    s_nop 0
    buffer_load_dwordx4 v41, s[8:11], s65 offen lds
    v_mfma_f32_16x16x32_bf16 v[236:239], v[132:135], v[252:255], v[236:239]
    v_mfma_f32_16x16x32_bf16 v[192:195], v[136:139], v[112:115], v[192:195]
    v_mfma_f32_16x16x32_bf16 v[196:199], v[136:139], v[116:119], v[196:199]
    s_add_u32 s65, s54, s97
    s_add_u32 m0, s61, 108544
    s_nop 0
    buffer_load_dwordx4 v42, s[8:11], s65 offen lds
    v_mfma_f32_16x16x32_bf16 v[240:243], v[136:139], v[252:255], v[240:243]
    v_mfma_f32_16x16x32_bf16 v[244:247], v[252:255], v[112:115], v[244:247]
    v_mfma_f32_16x16x32_bf16 v[248:251], v[112:115], v[112:115], v[248:251]
    v_mfma_f32_16x16x32_bf16 v[176:179], v[140:143], v[120:123], v[176:179]
    v_mfma_f32_16x16x32_bf16 v[180:183], v[140:143], v[124:127], v[180:183]
    v_mfma_f32_16x16x32_bf16 v[184:187], v[144:147], v[120:123], v[184:187]
    v_mfma_f32_16x16x32_bf16 v[188:191], v[144:147], v[124:127], v[188:191]
    v_mfma_f32_16x16x32_bf16 v[192:195], v[148:151], v[120:123], v[192:195]
    v_mfma_f32_16x16x32_bf16 v[196:199], v[148:151], v[124:127], v[196:199]
    v_mfma_f32_16x16x32_bf16 v[244:247], v[252:255], v[120:123], v[244:247]
    v_mfma_f32_16x16x32_bf16 v[248:251], v[120:123], v[120:123], v[248:251]
    s_mul_i32 s48, s42, 3072
    s_add_u32 s48, s48, 16384
    v_lshl_add_u32 v4, v1, 4, s48
    s_lshl_b32 s48, s43, 2
    s_lshl_b32 s49, s44, 1
    s_add_u32 s48, s48, s49
    s_add_u32 s48, s48, s45
    s_mul_i32 s48, s48, 192
    s_add_u32 s48, s48, 155648
    v_lshl_add_u32 v5, v2, 4, s48
    ds_write_b128 v4, v[180:183] offset:0
    ds_write_b128 v4, v[188:191] offset:1024
    ds_write_b128 v4, v[196:199] offset:2048
    s_mov_b32 exec_lo, 0x00010001
    s_mov_b32 exec_hi, 0x00010001
    ds_write_b128 v5, v[232:235] offset:0
    ds_write_b128 v5, v[236:239] offset:64
    ds_write_b128 v5, v[240:243] offset:128
    s_mov_b64 exec, -1
    v_and_b32 v8, 3, v3
    v_cmp_eq_u32 vcc, 1, v8
    s_nop 1
    v_cndmask_b32 v245, v248, v249, vcc
    v_cmp_eq_u32 vcc, 2, v8
    s_nop 1
    v_cndmask_b32 v245, v245, v250, vcc
    v_cmp_eq_u32 vcc, 3, v8
    s_nop 1
    v_cndmask_b32 v245, v245, v251, vcc
    s_lshl_b32 s48, s47, 1
    s_add_u32 s48, s48, s45
    s_lshl_b32 s48, s48, 7
    s_add_u32 s48, s48, 158720
    v_lshl_add_u32 v6, v3, 3, s48
    s_mov_b32 exec_lo, 0x00F0000F
    s_mov_b32 exec_hi, 0xF0000F00
    ds_write_b64 v6, v[244:245]
    s_mov_b64 exec, -1
    v_pk_add_f32 v[200:201], v[176:177], 0
    v_pk_add_f32 v[202:203], v[178:179], 0
    v_pk_add_f32 v[204:205], v[184:185], 0
    v_pk_add_f32 v[206:207], v[186:187], 0
    v_pk_add_f32 v[208:209], v[192:193], 0
    v_pk_add_f32 v[210:211], v[194:195], 0
    v_mov_b32 v246, 0xc0135761
    v_mov_b32 v247, 0xc0135761
    s_waitcnt vmcnt(3)
    s_waitcnt lgkmcnt(0)
    s_barrier
    ds_read_b64_tr_b16 v[128:129], v225 offset:0
    ds_read_b64_tr_b16 v[130:131], v225 offset:768
    ds_read_b64_tr_b16 v[132:133], v226 offset:0
    ds_read_b64_tr_b16 v[134:135], v226 offset:768
    ds_read_b64_tr_b16 v[136:137], v227 offset:0
    ds_read_b64_tr_b16 v[138:139], v227 offset:768
    ds_read_b64_tr_b16 v[140:141], v228 offset:0
    ds_read_b64_tr_b16 v[142:143], v228 offset:768
    ds_read_b64_tr_b16 v[144:145], v229 offset:0
    ds_read_b64_tr_b16 v[146:147], v229 offset:768
    ds_read_b64_tr_b16 v[148:149], v230 offset:0
    ds_read_b64_tr_b16 v[150:151], v230 offset:768
    v_mfma_f32_16x16x32_bf16 v[176:179], v[152:155], v[48:51], 0
    s_xor_b32 s48, s42, 4
    s_mul_i32 s48, s48, 3072
    s_add_u32 s48, s48, 16384
    v_lshl_add_u32 v4, v1, 4, s48
    ds_read_b128 v[8:11], v4 offset:0
    ds_read_b128 v[12:15], v4 offset:1024
    ds_read_b128 v[16:19], v4 offset:2048
    s_mul_i32 s48, s43, 768
    s_add_u32 s48, s48, 155648
    v_lshl_add_u32 v4, v2, 4, s48
    ds_read_b128 v[20:23], v4 offset:0
    ds_read_b128 v[24:27], v4 offset:64
    ds_read_b128 v[28:31], v4 offset:128
    s_lshl_b32 s48, s47, 8
    s_add_u32 s48, s48, 158720
    v_lshl_add_u32 v5, v3, 3, s48
    v_mfma_f32_16x16x32_bf16 v[180:183], v[152:155], v[52:55], 0
    s_add_u32 s65, s54, s98
    s_add_u32 m0, s61, 131072
    s_nop 0
    buffer_load_dwordx4 v40, s[8:11], s65 offen lds
    ds_read_b64 v[248:249], v5
    ds_read_b64 v[32:33], v5 offset:128
    s_waitcnt lgkmcnt(5)
    v_add_f32 v200, v200, v8
    v_add_f32 v201, v201, v9
    v_add_f32 v202, v202, v10
    v_add_f32 v203, v203, v11
    v_mfma_f32_16x16x32_bf16 v[232:235], v[152:155], v[252:255], 0
    v_add_f32 v204, v204, v12
    v_add_f32 v205, v205, v13
    v_add_f32 v206, v206, v14
    v_add_f32 v207, v207, v15
    v_add_f32 v208, v208, v16
    v_mfma_f32_16x16x32_bf16 v[184:187], v[156:159], v[48:51], 0
    v_add_f32 v209, v209, v17
    v_add_f32 v210, v210, v18
    v_add_f32 v211, v211, v19
    ds_read_b128 v[8:11], v4 offset:192
    ds_read_b128 v[12:15], v4 offset:256
    ds_read_b128 v[16:19], v4 offset:320
    s_waitcnt lgkmcnt(3)
    v_add_f32 v248, v248, v32
    v_mfma_f32_16x16x32_bf16 v[188:191], v[156:159], v[52:55], 0
    s_add_u32 s65, s54, s98
    s_add_u32 m0, s61, 132096
    s_nop 0
    buffer_load_dwordx4 v41, s[8:11], s65 offen lds
    v_add_f32 v249, v249, v33
    v_mul_f32 v248, 0x3acccccd, v248
    v_mul_f32 v249, 0x3acccccd, v249
    v_fma_f32 v249, -v248, v248, v249
    v_max_f32 v249, 0, v249
    v_mfma_f32_16x16x32_bf16 v[236:239], v[156:159], v[252:255], 0
    v_cvt_pk_bf16_f32 v249, v249, v248
    v_and_b32 v248, 0xffff0000, v249
    v_lshlrev_b32 v249, 16, v249
    v_add_f32 v249, s55, v249
    v_cvt_pk_bf16_f32 v249, v249, v249
    v_mfma_f32_16x16x32_bf16 v[192:195], v[160:163], v[48:51], 0
    v_and_b32 v249, 0xffff0000, v249
    v_sqrt_f32 v249, v249
    s_nop 0
    v_cvt_pk_bf16_f32 v249, v249, v249
    v_and_b32 v249, 0xffff0000, v249
    v_rcp_f32 v249, v249
    v_mfma_f32_16x16x32_bf16 v[196:199], v[160:163], v[52:55], 0
    s_add_u32 s65, s54, s98
    s_add_u32 m0, s61, 133120
    s_nop 0
    buffer_load_dwordx4 v42, s[8:11], s65 offen lds
    v_mov_b32 v250, v249
    s_waitcnt lgkmcnt(0)
    v_add_f32 v20, v20, v8
    v_add_f32 v21, v21, v9
    v_add_f32 v22, v22, v10
    v_add_f32 v23, v23, v11
    v_mfma_f32_16x16x32_bf16 v[240:243], v[160:163], v[252:255], 0
    v_add_f32 v24, v24, v12
    v_add_f32 v25, v25, v13
    v_add_f32 v26, v26, v14
    v_add_f32 v27, v27, v15
    v_add_f32 v28, v28, v16
    v_mfma_f32_16x16x32_bf16 v[176:179], v[164:167], v[56:59], v[176:179]
    v_add_f32 v29, v29, v17
    v_add_f32 v30, v30, v18
    v_add_f32 v31, v31, v19
    ds_read_b128 v[8:11], v4 offset:384
    ds_read_b128 v[12:15], v4 offset:448
    ds_read_b128 v[16:19], v4 offset:512
    s_waitcnt lgkmcnt(0)
    v_add_f32 v20, v20, v8
    v_mfma_f32_16x16x32_bf16 v[180:183], v[164:167], v[60:63], v[180:183]
    v_add_f32 v21, v21, v9
    v_add_f32 v22, v22, v10
    v_add_f32 v23, v23, v11
    v_add_f32 v24, v24, v12
    v_add_f32 v25, v25, v13
    v_mfma_f32_16x16x32_bf16 v[184:187], v[168:171], v[56:59], v[184:187]
    v_add_f32 v26, v26, v14
    v_add_f32 v27, v27, v15
    v_add_f32 v28, v28, v16
    v_add_f32 v29, v29, v17
    v_add_f32 v30, v30, v18
    v_mfma_f32_16x16x32_bf16 v[188:191], v[168:171], v[60:63], v[188:191]
    v_add_f32 v31, v31, v19
    ds_read_b128 v[8:11], v4 offset:576
    ds_read_b128 v[12:15], v4 offset:640
    ds_read_b128 v[16:19], v4 offset:704
    s_waitcnt lgkmcnt(0)
    v_add_f32 v20, v20, v8
    v_add_f32 v21, v21, v9
    v_add_f32 v22, v22, v10
    v_mfma_f32_16x16x32_bf16 v[192:195], v[172:175], v[56:59], v[192:195]
    v_add_f32 v23, v23, v11
    v_add_f32 v24, v24, v12
    v_add_f32 v25, v25, v13
    v_add_f32 v26, v26, v14
    v_add_f32 v27, v27, v15
    v_mfma_f32_16x16x32_bf16 v[196:199], v[172:175], v[60:63], v[196:199]
    v_add_f32 v28, v28, v16
    v_add_f32 v29, v29, v17
    v_add_f32 v30, v30, v18
    v_add_f32 v31, v31, v19
    v_fma_f32 v200, v20, -v248, v200
    s_waitcnt vmcnt(3)
    s_waitcnt lgkmcnt(0)
    s_barrier
    ds_read_b64_tr_b16 v[152:153], v225 offset:24576
    ds_read_b64_tr_b16 v[154:155], v225 offset:25344
    ds_read_b64_tr_b16 v[156:157], v226 offset:24576
    ds_read_b64_tr_b16 v[158:159], v226 offset:25344
    ds_read_b64_tr_b16 v[160:161], v227 offset:24576
    ds_read_b64_tr_b16 v[162:163], v227 offset:25344
    ds_read_b64_tr_b16 v[164:165], v228 offset:24576
    ds_read_b64_tr_b16 v[166:167], v228 offset:25344
    ds_read_b64_tr_b16 v[168:169], v229 offset:24576
    ds_read_b64_tr_b16 v[170:171], v229 offset:25344
    ds_read_b64_tr_b16 v[172:173], v230 offset:24576
    ds_read_b64_tr_b16 v[174:175], v230 offset:25344
    v_mfma_f32_16x16x32_bf16 v[176:179], v[128:131], v[64:67], v[176:179]
    v_fma_f32 v201, v21, -v248, v201
    v_fma_f32 v202, v22, -v248, v202
    v_fma_f32 v203, v23, -v248, v203
    v_fma_f32 v204, v24, -v248, v204
    v_fma_f32 v205, v25, -v248, v205
    v_mfma_f32_16x16x32_bf16 v[180:183], v[128:131], v[68:71], v[180:183]
    s_add_u32 s65, s54, s99
    s_add_u32 m0, s61, 81920
    s_nop 0
    buffer_load_dwordx4 v40, s[8:11], s65 offen lds
    v_fma_f32 v206, v26, -v248, v206
    v_fma_f32 v207, v27, -v248, v207
    v_fma_f32 v208, v28, -v248, v208
    v_fma_f32 v209, v29, -v248, v209
    v_fma_f32 v210, v30, -v248, v210
    v_mfma_f32_16x16x32_bf16 v[232:235], v[128:131], v[252:255], v[232:235]
    v_fma_f32 v211, v31, -v248, v211
    v_mul_f32 v200, v200, v250
    v_mul_f32 v201, v201, v250
    v_mul_f32 v202, v202, v250
    v_mul_f32 v203, v203, v250
    v_mfma_f32_16x16x32_bf16 v[184:187], v[132:135], v[64:67], v[184:187]
    v_mul_f32 v204, v204, v250
    v_mul_f32 v205, v205, v250
    v_mul_f32 v206, v206, v250
    v_mul_f32 v207, v207, v250
    v_mul_f32 v208, v208, v250
    v_mfma_f32_16x16x32_bf16 v[188:191], v[132:135], v[68:71], v[188:191]
    s_add_u32 s65, s54, s99
    s_add_u32 m0, s61, 82944
    s_nop 0
    buffer_load_dwordx4 v41, s[8:11], s65 offen lds
    v_mul_f32 v209, v209, v250
    v_mul_f32 v210, v210, v250
    v_mul_f32 v211, v211, v250
    v_mul_f32 v8, v200, v200
    v_mul_f32 v9, v201, v201
    v_mfma_f32_16x16x32_bf16 v[236:239], v[132:135], v[252:255], v[236:239]
    v_mul_f32 v10, v202, v202
    v_mul_f32 v11, v203, v203
    v_mul_f32 v12, v204, v204
    v_mul_f32 v13, v205, v205
    v_mul_f32 v14, v206, v206
    v_mfma_f32_16x16x32_bf16 v[192:195], v[136:139], v[64:67], v[192:195]
    v_mul_f32 v15, v207, v207
    v_mul_f32 v16, v208, v208
    v_mul_f32 v17, v209, v209
    v_mul_f32 v18, v210, v210
    v_mul_f32 v19, v211, v211
    v_mfma_f32_16x16x32_bf16 v[196:199], v[136:139], v[68:71], v[196:199]
    s_add_u32 s65, s54, s99
    s_add_u32 m0, s61, 83968
    s_nop 0
    buffer_load_dwordx4 v42, s[8:11], s65 offen lds
    v_fma_f32 v8, v8, s58, v246
    v_fma_f32 v9, v9, s58, v247
    v_fma_f32 v10, v10, s58, v246
    v_fma_f32 v11, v11, s58, v247
    v_fma_f32 v12, v12, s58, v246
    v_mfma_f32_16x16x32_bf16 v[240:243], v[136:139], v[252:255], v[240:243]
    v_fma_f32 v13, v13, s58, v247
    v_fma_f32 v14, v14, s58, v246
    v_fma_f32 v15, v15, s58, v247
    v_fma_f32 v16, v16, s58, v246
    v_fma_f32 v17, v17, s58, v247
    v_mfma_f32_16x16x32_bf16 v[176:179], v[140:143], v[72:75], v[176:179]
    v_fma_f32 v18, v18, s58, v246
    v_fma_f32 v19, v19, s58, v247
    v_mul_f32 v8, v8, v200
    v_mul_f32 v9, v9, v201
    v_mul_f32 v10, v10, v202
    v_mfma_f32_16x16x32_bf16 v[180:183], v[140:143], v[76:79], v[180:183]
    v_mul_f32 v11, v11, v203
    v_mul_f32 v12, v12, v204
    v_mul_f32 v13, v13, v205
    v_mul_f32 v14, v14, v206
    v_mul_f32 v15, v15, v207
    v_mfma_f32_16x16x32_bf16 v[184:187], v[144:147], v[72:75], v[184:187]
    v_mul_f32 v16, v16, v208
    v_mul_f32 v17, v17, v209
    v_mul_f32 v18, v18, v210
    v_mul_f32 v19, v19, v211
    v_exp_f32 v8, v8
    v_mfma_f32_16x16x32_bf16 v[188:191], v[144:147], v[76:79], v[188:191]
    v_exp_f32 v9, v9
    v_exp_f32 v10, v10
    v_exp_f32 v11, v11
    v_exp_f32 v12, v12
    v_exp_f32 v13, v13
    v_mfma_f32_16x16x32_bf16 v[192:195], v[148:151], v[72:75], v[192:195]
    v_exp_f32 v14, v14
    v_exp_f32 v15, v15
    v_exp_f32 v16, v16
    v_exp_f32 v17, v17
    v_exp_f32 v18, v18
    v_mfma_f32_16x16x32_bf16 v[196:199], v[148:151], v[76:79], v[196:199]
    v_exp_f32 v19, v19
    v_add_f32 v8, 1.0, v8
    v_add_f32 v9, 1.0, v9
    v_add_f32 v10, 1.0, v10
    v_add_f32 v11, 1.0, v11
    s_waitcnt vmcnt(3)
    s_waitcnt lgkmcnt(0)
    s_barrier
    ds_read_b64_tr_b16 v[128:129], v225 offset:49152
    ds_read_b64_tr_b16 v[130:131], v225 offset:49920
    ds_read_b64_tr_b16 v[132:133], v226 offset:49152
    ds_read_b64_tr_b16 v[134:135], v226 offset:49920
    ds_read_b64_tr_b16 v[136:137], v227 offset:49152
    ds_read_b64_tr_b16 v[138:139], v227 offset:49920
    ds_read_b64_tr_b16 v[140:141], v228 offset:49152
    ds_read_b64_tr_b16 v[142:143], v228 offset:49920
    ds_read_b64_tr_b16 v[144:145], v229 offset:49152
    ds_read_b64_tr_b16 v[146:147], v229 offset:49920
    ds_read_b64_tr_b16 v[148:149], v230 offset:49152
    ds_read_b64_tr_b16 v[150:151], v230 offset:49920
    v_mfma_f32_16x16x32_bf16 v[176:179], v[152:155], v[80:83], v[176:179]
    v_add_f32 v12, 1.0, v12
    v_add_f32 v13, 1.0, v13
    v_add_f32 v14, 1.0, v14
    v_add_f32 v15, 1.0, v15
    v_add_f32 v16, 1.0, v16
    v_mfma_f32_16x16x32_bf16 v[180:183], v[152:155], v[84:87], v[180:183]
    v_add_f32 v17, 1.0, v17
    v_add_f32 v18, 1.0, v18
    v_add_f32 v19, 1.0, v19
    v_rcp_f32 v8, v8
    v_rcp_f32 v9, v9
    v_mfma_f32_16x16x32_bf16 v[232:235], v[152:155], v[252:255], v[232:235]
    v_rcp_f32 v10, v10
    v_rcp_f32 v11, v11
    v_rcp_f32 v12, v12
    v_rcp_f32 v13, v13
    v_rcp_f32 v14, v14
    v_mfma_f32_16x16x32_bf16 v[184:187], v[156:159], v[80:83], v[184:187]
    v_rcp_f32 v15, v15
    v_rcp_f32 v16, v16
    v_rcp_f32 v17, v17
    v_rcp_f32 v18, v18
    v_rcp_f32 v19, v19
    v_mfma_f32_16x16x32_bf16 v[188:191], v[156:159], v[84:87], v[188:191]
    v_mul_f32 v200, v200, v8
    v_mul_f32 v201, v201, v9
    v_mul_f32 v202, v202, v10
    v_mul_f32 v203, v203, v11
    v_mul_f32 v204, v204, v12
    v_mfma_f32_16x16x32_bf16 v[236:239], v[156:159], v[252:255], v[236:239]
    v_mul_f32 v205, v205, v13
    v_mul_f32 v206, v206, v14
    v_mul_f32 v207, v207, v15
    v_mul_f32 v208, v208, v16
    v_mul_f32 v209, v209, v17
    v_mfma_f32_16x16x32_bf16 v[192:195], v[160:163], v[80:83], v[192:195]
    v_mul_f32 v210, v210, v18
    v_mul_f32 v211, v211, v19
    v_add_f32 v8, v200, v201
    v_mul_f32 v9, v200, v200
    v_add_f32 v10, v202, v203
    v_mfma_f32_16x16x32_bf16 v[196:199], v[160:163], v[84:87], v[196:199]
    v_mul_f32 v11, v201, v201
    v_fmac_f32 v9, v202, v202
    v_fmac_f32 v11, v203, v203
    v_add_f32 v8, v8, v204
    v_fmac_f32 v9, v204, v204
    v_mfma_f32_16x16x32_bf16 v[240:243], v[160:163], v[252:255], v[240:243]
    v_add_f32 v10, v10, v205
    v_fmac_f32 v11, v205, v205
    v_add_f32 v8, v8, v206
    v_fmac_f32 v9, v206, v206
    v_add_f32 v10, v10, v207
    v_mfma_f32_16x16x32_bf16 v[176:179], v[164:167], v[88:91], v[176:179]
    v_fmac_f32 v11, v207, v207
    v_add_f32 v8, v8, v208
    v_fmac_f32 v9, v208, v208
    v_add_f32 v10, v10, v209
    v_fmac_f32 v11, v209, v209
    v_mfma_f32_16x16x32_bf16 v[180:183], v[164:167], v[92:95], v[180:183]
    v_add_f32 v8, v8, v210
    v_fmac_f32 v9, v210, v210
    v_add_f32 v10, v10, v211
    v_fmac_f32 v11, v211, v211
    s_lshl_b32 s48, s47, 7
    s_lshl_b32 s49, s43, 9
    s_add_u32 s48, s48, s49
    s_add_u32 s48, s48, 159744
    v_lshl_add_u32 v4, v3, 3, s48
    v_mfma_f32_16x16x32_bf16 v[184:187], v[168:171], v[88:91], v[184:187]
    v_add_f32 v8, v8, v10
    v_add_f32 v9, v9, v11
    v_mov_b32 v12, v8
    v_mov_b32 v13, v9
    s_nop 0
    v_permlane16_swap_b32 v8, v12
    v_mfma_f32_16x16x32_bf16 v[188:191], v[168:171], v[92:95], v[188:191]
    v_permlane16_swap_b32 v9, v13
    v_add_f32 v8, v8, v12
    v_add_f32 v9, v9, v13
    v_mov_b32 v12, v8
    v_mov_b32 v13, v9
    v_mfma_f32_16x16x32_bf16 v[192:195], v[172:175], v[88:91], v[192:195]
    v_permlane32_swap_b32 v8, v12
    v_permlane32_swap_b32 v9, v13
    v_add_f32 v8, v8, v12
    v_add_f32 v9, v9, v13
    s_mov_b64 exec, 0xffff
    ds_write_b64 v4, v[8:9]
    s_mov_b64 exec, -1
    v_mfma_f32_16x16x32_bf16 v[196:199], v[172:175], v[92:95], v[196:199]
    s_or_b32 s48, s41, s43
    s_cmp_lg_u32 s48, 0
    s_cbranch_scc1 k1_xst_3
    s_lshl_b32 s48, s40, 9
    s_lshl_b32 s49, s47, 7
    s_add_u32 s48, s48, s49
    s_add_u32 s48, s48, 14680064
    v_lshlrev_b32 v4, 3, v3
    s_mov_b64 exec, 0xffff
    buffer_store_dwordx2 v[248:249], v4, s[24:27], s48 offen
    s_mov_b64 exec, -1
k1_xst_3:
    s_waitcnt vmcnt(0)
    s_waitcnt lgkmcnt(0)
    s_barrier
    s_cmp_lg_u32 s42, 0
    s_cbranch_scc1 k1_pub_4
    v_lshlrev_b32 v4, 3, v1
    v_add_u32 v5, 159744, v4
    ds_read_b64 v[8:9], v5
    ds_read_b64 v[12:13], v5 offset:512
    s_lshl_b32 s48, s40, 3
    s_add_u32 s48, s48, s41
    s_lshl_b32 s48, s48, 10
    s_add_u32 s48, s48, 14745600
    v_lshlrev_b32 v4, 4, v1
    v_mov_b32 v10, s100
    v_mov_b32 v11, s101
    s_waitcnt lgkmcnt(0)
    v_pk_add_f32 v[8:9], v[8:9], v[12:13]
    buffer_store_dwordx4 v[8:11], v4, s[24:27], s48 offen sc1
k1_pub_4:
    ds_read_b64_tr_b16 v[152:153], v225 offset:0
    ds_read_b64_tr_b16 v[154:155], v225 offset:768
    ds_read_b64_tr_b16 v[156:157], v226 offset:0
    ds_read_b64_tr_b16 v[158:159], v226 offset:768
    ds_read_b64_tr_b16 v[160:161], v227 offset:0
    ds_read_b64_tr_b16 v[162:163], v227 offset:768
    ds_read_b64_tr_b16 v[164:165], v228 offset:0
    ds_read_b64_tr_b16 v[166:167], v228 offset:768
    ds_read_b64_tr_b16 v[168:169], v229 offset:0
    ds_read_b64_tr_b16 v[170:171], v229 offset:768
    ds_read_b64_tr_b16 v[172:173], v230 offset:0
    ds_read_b64_tr_b16 v[174:175], v230 offset:768
    v_mfma_f32_16x16x32_bf16 v[176:179], v[128:131], v[96:99], v[176:179]
    v_mfma_f32_16x16x32_bf16 v[180:183], v[128:131], v[100:103], v[180:183]
    v_mfma_f32_16x16x32_bf16 v[232:235], v[128:131], v[252:255], v[232:235]
    v_mfma_f32_16x16x32_bf16 v[184:187], v[132:135], v[96:99], v[184:187]
    v_mfma_f32_16x16x32_bf16 v[188:191], v[132:135], v[100:103], v[188:191]
    v_mfma_f32_16x16x32_bf16 v[236:239], v[132:135], v[252:255], v[236:239]
    v_mfma_f32_16x16x32_bf16 v[192:195], v[136:139], v[96:99], v[192:195]
    v_mfma_f32_16x16x32_bf16 v[196:199], v[136:139], v[100:103], v[196:199]
    v_mfma_f32_16x16x32_bf16 v[240:243], v[136:139], v[252:255], v[240:243]
    v_mfma_f32_16x16x32_bf16 v[176:179], v[140:143], v[104:107], v[176:179]
    v_mfma_f32_16x16x32_bf16 v[180:183], v[140:143], v[108:111], v[180:183]
    v_mfma_f32_16x16x32_bf16 v[184:187], v[144:147], v[104:107], v[184:187]
    v_mfma_f32_16x16x32_bf16 v[188:191], v[144:147], v[108:111], v[188:191]
    v_mfma_f32_16x16x32_bf16 v[192:195], v[148:151], v[104:107], v[192:195]
    v_mfma_f32_16x16x32_bf16 v[196:199], v[148:151], v[108:111], v[196:199]
    s_waitcnt lgkmcnt(0)
    s_barrier
    s_lshl_b32 s48, s40, 13
    s_lshl_b32 s49, s47, 8
    s_add_u32 s48, s48, s49
    s_add_u32 s62, s48, 14745600
    v_lshlrev_b32 v7, 4, v3
    v_lshl_add_u32 v7, v2, 11, v7
    buffer_load_dwordx4 v[28:31], v7, s[24:27], s62 offen sc1
    buffer_load_dwordx4 v[32:35], v7, s[24:27], s62 offen offset:1024 sc1
    v_mfma_f32_16x16x32_bf16 v[176:179], v[152:155], v[112:115], v[176:179]
    v_mfma_f32_16x16x32_bf16 v[180:183], v[152:155], v[116:119], v[180:183]
    v_mfma_f32_16x16x32_bf16 v[232:235], v[152:155], v[252:255], v[232:235]
    v_mfma_f32_16x16x32_bf16 v[184:187], v[156:159], v[112:115], v[184:187]
    v_mfma_f32_16x16x32_bf16 v[188:191], v[156:159], v[116:119], v[188:191]
    v_mfma_f32_16x16x32_bf16 v[236:239], v[156:159], v[252:255], v[236:239]
    v_mfma_f32_16x16x32_bf16 v[192:195], v[160:163], v[112:115], v[192:195]
    v_mfma_f32_16x16x32_bf16 v[196:199], v[160:163], v[116:119], v[196:199]
    v_mfma_f32_16x16x32_bf16 v[240:243], v[160:163], v[252:255], v[240:243]
    v_mfma_f32_16x16x32_bf16 v[176:179], v[164:167], v[120:123], v[176:179]
    v_mfma_f32_16x16x32_bf16 v[180:183], v[164:167], v[124:127], v[180:183]
    v_mfma_f32_16x16x32_bf16 v[184:187], v[168:171], v[120:123], v[184:187]
    v_mfma_f32_16x16x32_bf16 v[188:191], v[168:171], v[124:127], v[188:191]
    v_mfma_f32_16x16x32_bf16 v[192:195], v[172:175], v[120:123], v[192:195]
    v_mfma_f32_16x16x32_bf16 v[196:199], v[172:175], v[124:127], v[196:199]
    s_mul_i32 s48, s42, 3072
    s_add_u32 s48, s48, 16384
    v_lshl_add_u32 v4, v1, 4, s48
    s_lshl_b32 s48, s43, 2
    s_lshl_b32 s49, s44, 1
    s_add_u32 s48, s48, s49
    s_add_u32 s48, s48, s45
    s_mul_i32 s48, s48, 192
    s_add_u32 s48, s48, 157184
    v_lshl_add_u32 v5, v2, 4, s48
    ds_write_b128 v4, v[180:183] offset:0
    ds_write_b128 v4, v[188:191] offset:1024
    ds_write_b128 v4, v[196:199] offset:2048
    s_mov_b32 exec_lo, 0x00010001
    s_mov_b32 exec_hi, 0x00010001
    ds_write_b128 v5, v[232:235] offset:0
    ds_write_b128 v5, v[236:239] offset:64
    ds_write_b128 v5, v[240:243] offset:128
    s_mov_b64 exec, -1
    v_pk_add_f32 v[128:129], v[176:177], 0
    v_pk_add_f32 v[130:131], v[178:179], 0
    v_pk_add_f32 v[132:133], v[184:185], 0
    v_pk_add_f32 v[134:135], v[186:187], 0
    v_pk_add_f32 v[136:137], v[192:193], 0
    v_pk_add_f32 v[138:139], v[194:195], 0
    s_lshl_b32 s48, s47, 4
    v_add_u32 v43, s48, v3
    v_mul_u32_u24 v43, 200, v43
    v_lshl_add_u32 v43, v2, 3, v43
    s_mul_i32 s48, s43, 96
    s_add_u32 s48, s48, 0
    v_add_u32 v43, s48, v43
    s_waitcnt vmcnt(0)
k1_poll_5:
    v_cmp_ne_u32 vcc, s100, v30
    v_cmp_ne_u32 s[50:51], s101, v31
    s_nop 0
    s_or_b64 vcc, vcc, s[50:51]
    v_cmp_ne_u32 s[50:51], s100, v34
    s_nop 0
    s_or_b64 vcc, vcc, s[50:51]
    v_cmp_ne_u32 s[50:51], s101, v35
    s_nop 0
    s_or_b64 vcc, vcc, s[50:51]
    s_cmp_eq_u64 vcc, 0
    s_cbranch_scc1 k1_polled_6
    s_sleep 4
    buffer_load_dwordx4 v[28:31], v7, s[24:27], s62 offen sc1
    buffer_load_dwordx4 v[32:35], v7, s[24:27], s62 offen offset:1024 sc1
    s_waitcnt vmcnt(0)
    s_branch k1_poll_5
k1_polled_6:
    s_xor_b32 s48, s42, 1
    s_or_b32 s48, s48, s41
    s_cmp_lg_u32 s48, 0
    s_cbranch_scc1 k1_ep_7
    v_mov_b32 v4, 0
    v_mov_b32 v44, 1
    s_mov_b64 exec, 1
    buffer_atomic_add v44, v4, s[28:31], 0 offen sc0
    s_mov_b64 exec, -1
k1_ep_7:
    v_pk_add_f32 v[8:9], v[28:29], v[32:33]
    v_mov_b32 v10, v8
    v_mov_b32 v11, v9
    s_nop 0
    v_permlane16_swap_b32 v8, v10
    v_permlane16_swap_b32 v9, v11
    v_add_f32 v8, v8, v10
    v_add_f32 v9, v9, v11
    v_mov_b32 v10, v8
    v_mov_b32 v11, v9
    s_nop 0
    v_permlane32_swap_b32 v8, v10
    v_permlane32_swap_b32 v9, v11
    v_add_f32 v8, v8, v10
    v_add_f32 v9, v9, v11
    v_mul_f32 v8, 0x3aaaaaab, v8
    v_mul_f32 v9, 0x3aaaaaab, v9
    v_fma_f32 v9, -v8, v8, v9
    v_max_f32 v9, 0, v9
    v_cvt_pk_bf16_f32 v9, v9, v8
    v_and_b32 v8, 0xffff0000, v9
    v_lshlrev_b32 v9, 16, v9
    v_add_f32 v9, s55, v9
    v_cvt_pk_bf16_f32 v9, v9, v9
    v_and_b32 v9, 0xffff0000, v9
    v_sqrt_f32 v9, v9
    s_nop 0
    v_cvt_pk_bf16_f32 v9, v9, v9
    v_and_b32 v9, 0xffff0000, v9
    v_rcp_f32 v9, v9
    s_nop 0
    v_mov_b32 v10, v9
    v_pk_add_f32 v[200:201], v[200:201], v[8:9] op_sel_hi:[1,0] neg_lo:[0,1] neg_hi:[0,1]
    v_pk_add_f32 v[202:203], v[202:203], v[8:9] op_sel_hi:[1,0] neg_lo:[0,1] neg_hi:[0,1]
    v_pk_add_f32 v[204:205], v[204:205], v[8:9] op_sel_hi:[1,0] neg_lo:[0,1] neg_hi:[0,1]
    v_pk_add_f32 v[206:207], v[206:207], v[8:9] op_sel_hi:[1,0] neg_lo:[0,1] neg_hi:[0,1]
    v_pk_add_f32 v[208:209], v[208:209], v[8:9] op_sel_hi:[1,0] neg_lo:[0,1] neg_hi:[0,1]
    v_pk_add_f32 v[210:211], v[210:211], v[8:9] op_sel_hi:[1,0] neg_lo:[0,1] neg_hi:[0,1]
    v_pk_mul_f32 v[200:201], v[200:201], v[10:11] op_sel_hi:[1,0]
    v_pk_mul_f32 v[202:203], v[202:203], v[10:11] op_sel_hi:[1,0]
    v_pk_mul_f32 v[204:205], v[204:205], v[10:11] op_sel_hi:[1,0]
    v_pk_mul_f32 v[206:207], v[206:207], v[10:11] op_sel_hi:[1,0]
    v_pk_mul_f32 v[208:209], v[208:209], v[10:11] op_sel_hi:[1,0]
    v_pk_mul_f32 v[210:211], v[210:211], v[10:11] op_sel_hi:[1,0]
    v_cvt_pk_bf16_f32 v16, v200, v201
    v_cvt_pk_bf16_f32 v17, v202, v203
    ds_write_b64 v43, v[16:17] offset:0
    v_cvt_pk_bf16_f32 v18, v204, v205
    v_cvt_pk_bf16_f32 v19, v206, v207
    ds_write_b64 v43, v[18:19] offset:32
    v_cvt_pk_bf16_f32 v20, v208, v209
    v_cvt_pk_bf16_f32 v21, v210, v211
    ds_write_b64 v43, v[20:21] offset:64
    v_lshrrev_b32 v226, 1, v2
    v_lshrrev_b32 v5, 2, v3
    v_lshl_add_u32 v226, v226, 3, v5
    v_mul_u32_u24 v226, 200, v226
    v_and_b32 v5, 1, v2
    v_lshl_add_u32 v226, v5, 5, v226
    v_and_b32 v5, 3, v3
    v_lshl_add_u32 v226, v5, 3, v226
    v_lshlrev_b32 v227, 4, v1
    s_waitcnt lgkmcnt(0)
    s_barrier
    s_add_u32 s48, s42, 0
    s_mul_i32 s49, s48, 43
    s_lshr_b32 s49, s49, 7
    s_mul_i32 s50, s49, 3
    s_sub_u32 s50, s48, s50
    s_mul_i32 s49, s49, 3200
    s_lshl_b32 s50, s50, 6
    s_add_u32 s49, s49, s50
    s_add_u32 s49, s49, 0
    v_add_u32 v5, s49, v226
    ds_read_b64_tr_b16 v[8:9], v5
    ds_read_b64_tr_b16 v[10:11], v5 offset:800
    s_lshl_b32 s49, s41, 7
    s_lshl_b32 s50, s40, 2
    s_add_u32 s49, s49, s50
    s_mul_i32 s49, s49, 3
    s_add_u32 s49, s49, s48
    s_lshl_b32 s49, s49, 10
    s_add_u32 s49, s49, 0
    s_waitcnt lgkmcnt(0)
    buffer_store_dwordx4 v[8:11], v227, s[24:27], s49 offen
    s_cmp_ge_u32 s42, 4
    s_cbranch_scc1 k1_fr_8
    s_add_u32 s48, s42, 8
    s_mul_i32 s49, s48, 43
    s_lshr_b32 s49, s49, 7
    s_mul_i32 s50, s49, 3
    s_sub_u32 s50, s48, s50
    s_mul_i32 s49, s49, 3200
    s_lshl_b32 s50, s50, 6
    s_add_u32 s49, s49, s50
    s_add_u32 s49, s49, 0
    v_add_u32 v5, s49, v226
    ds_read_b64_tr_b16 v[12:13], v5
    ds_read_b64_tr_b16 v[14:15], v5 offset:800
    s_lshl_b32 s49, s41, 7
    s_lshl_b32 s50, s40, 2
    s_add_u32 s49, s49, s50
    s_mul_i32 s49, s49, 3
    s_add_u32 s49, s49, s48
    s_lshl_b32 s49, s49, 10
    s_add_u32 s49, s49, 0
    s_waitcnt lgkmcnt(0)
    buffer_store_dwordx4 v[12:15], v227, s[24:27], s49 offen
k1_fr_8:
    s_xor_b32 s48, s42, 4
    s_mul_i32 s48, s48, 3072
    s_add_u32 s48, s48, 16384
    v_lshl_add_u32 v4, v1, 4, s48
    ds_read_b128 v[48:51], v4 offset:0
    ds_read_b128 v[52:55], v4 offset:1024
    ds_read_b128 v[56:59], v4 offset:2048
    s_mul_i32 s48, s43, 768
    s_add_u32 s48, s48, 157184
    v_lshl_add_u32 v4, v2, 4, s48
    ds_read_b128 v[60:63], v4 offset:0
    ds_read_b128 v[64:67], v4 offset:64
    ds_read_b128 v[68:71], v4 offset:128
    s_waitcnt lgkmcnt(3)
    v_pk_add_f32 v[128:129], v[128:129], v[48:49]
    v_pk_add_f32 v[130:131], v[130:131], v[50:51]
    v_pk_add_f32 v[132:133], v[132:133], v[52:53]
    v_pk_add_f32 v[134:135], v[134:135], v[54:55]
    v_pk_add_f32 v[136:137], v[136:137], v[56:57]
    v_pk_add_f32 v[138:139], v[138:139], v[58:59]
    ds_read_b128 v[48:51], v4 offset:192
    ds_read_b128 v[52:55], v4 offset:256
    ds_read_b128 v[56:59], v4 offset:320
    s_waitcnt lgkmcnt(0)
    v_pk_add_f32 v[60:61], v[60:61], v[48:49]
    v_pk_add_f32 v[62:63], v[62:63], v[50:51]
    v_pk_add_f32 v[64:65], v[64:65], v[52:53]
    v_pk_add_f32 v[66:67], v[66:67], v[54:55]
    v_pk_add_f32 v[68:69], v[68:69], v[56:57]
    v_pk_add_f32 v[70:71], v[70:71], v[58:59]
    ds_read_b128 v[48:51], v4 offset:384
    ds_read_b128 v[52:55], v4 offset:448
    ds_read_b128 v[56:59], v4 offset:512
    s_waitcnt lgkmcnt(0)
    v_pk_add_f32 v[60:61], v[60:61], v[48:49]
    v_pk_add_f32 v[62:63], v[62:63], v[50:51]
    v_pk_add_f32 v[64:65], v[64:65], v[52:53]
    v_pk_add_f32 v[66:67], v[66:67], v[54:55]
    v_pk_add_f32 v[68:69], v[68:69], v[56:57]
    v_pk_add_f32 v[70:71], v[70:71], v[58:59]
    ds_read_b128 v[48:51], v4 offset:576
    ds_read_b128 v[52:55], v4 offset:640
    ds_read_b128 v[56:59], v4 offset:704
    s_waitcnt lgkmcnt(0)
    v_pk_add_f32 v[60:61], v[60:61], v[48:49]
    v_pk_add_f32 v[62:63], v[62:63], v[50:51]
    v_pk_add_f32 v[64:65], v[64:65], v[52:53]
    v_pk_add_f32 v[66:67], v[66:67], v[54:55]
    v_pk_add_f32 v[68:69], v[68:69], v[56:57]
    v_pk_add_f32 v[70:71], v[70:71], v[58:59]
    v_pk_fma_f32 v[128:129], v[60:61], v[248:249], v[128:129] op_sel_hi:[1,0,1] neg_lo:[0,1,0] neg_hi:[0,1,0]
    v_pk_fma_f32 v[130:131], v[62:63], v[248:249], v[130:131] op_sel_hi:[1,0,1] neg_lo:[0,1,0] neg_hi:[0,1,0]
    v_pk_fma_f32 v[132:133], v[64:65], v[248:249], v[132:133] op_sel_hi:[1,0,1] neg_lo:[0,1,0] neg_hi:[0,1,0]
    v_pk_fma_f32 v[134:135], v[66:67], v[248:249], v[134:135] op_sel_hi:[1,0,1] neg_lo:[0,1,0] neg_hi:[0,1,0]
    v_pk_fma_f32 v[136:137], v[68:69], v[248:249], v[136:137] op_sel_hi:[1,0,1] neg_lo:[0,1,0] neg_hi:[0,1,0]
    v_pk_fma_f32 v[138:139], v[70:71], v[248:249], v[138:139] op_sel_hi:[1,0,1] neg_lo:[0,1,0] neg_hi:[0,1,0]
    v_pk_mul_f32 v[128:129], v[128:129], v[250:251] op_sel_hi:[1,0]
    v_pk_mul_f32 v[130:131], v[130:131], v[250:251] op_sel_hi:[1,0]
    v_pk_mul_f32 v[132:133], v[132:133], v[250:251] op_sel_hi:[1,0]
    v_pk_mul_f32 v[134:135], v[134:135], v[250:251] op_sel_hi:[1,0]
    v_pk_mul_f32 v[136:137], v[136:137], v[250:251] op_sel_hi:[1,0]
    v_pk_mul_f32 v[138:139], v[138:139], v[250:251] op_sel_hi:[1,0]
    v_pk_mul_f32 v[48:49], v[128:129], v[128:129]
    v_pk_mul_f32 v[50:51], v[130:131], v[130:131]
    v_pk_mul_f32 v[52:53], v[132:133], v[132:133]
    v_pk_mul_f32 v[54:55], v[134:135], v[134:135]
    v_pk_mul_f32 v[56:57], v[136:137], v[136:137]
    v_pk_mul_f32 v[58:59], v[138:139], v[138:139]
    v_pk_fma_f32 v[48:49], v[48:49], s[58:59], v[246:247]
    v_pk_fma_f32 v[50:51], v[50:51], s[58:59], v[246:247]
    v_pk_fma_f32 v[52:53], v[52:53], s[58:59], v[246:247]
    v_pk_fma_f32 v[54:55], v[54:55], s[58:59], v[246:247]
    v_pk_fma_f32 v[56:57], v[56:57], s[58:59], v[246:247]
    v_pk_fma_f32 v[58:59], v[58:59], s[58:59], v[246:247]
    v_pk_mul_f32 v[48:49], v[48:49], v[128:129]
    v_pk_mul_f32 v[50:51], v[50:51], v[130:131]
    v_pk_mul_f32 v[52:53], v[52:53], v[132:133]
    v_pk_mul_f32 v[54:55], v[54:55], v[134:135]
    v_pk_mul_f32 v[56:57], v[56:57], v[136:137]
    v_pk_mul_f32 v[58:59], v[58:59], v[138:139]
    v_exp_f32 v48, v48
    v_exp_f32 v49, v49
    v_exp_f32 v50, v50
    v_exp_f32 v51, v51
    v_exp_f32 v52, v52
    v_exp_f32 v53, v53
    v_exp_f32 v54, v54
    v_exp_f32 v55, v55
    v_exp_f32 v56, v56
    v_exp_f32 v57, v57
    v_exp_f32 v58, v58
    v_exp_f32 v59, v59
    v_pk_add_f32 v[48:49], v[48:49], 1.0 op_sel_hi:[1,0]
    v_pk_add_f32 v[50:51], v[50:51], 1.0 op_sel_hi:[1,0]
    v_pk_add_f32 v[52:53], v[52:53], 1.0 op_sel_hi:[1,0]
    v_pk_add_f32 v[54:55], v[54:55], 1.0 op_sel_hi:[1,0]
    v_pk_add_f32 v[56:57], v[56:57], 1.0 op_sel_hi:[1,0]
    v_pk_add_f32 v[58:59], v[58:59], 1.0 op_sel_hi:[1,0]
    v_rcp_f32 v48, v48
    v_rcp_f32 v49, v49
    v_rcp_f32 v50, v50
    v_rcp_f32 v51, v51
    v_rcp_f32 v52, v52
    v_rcp_f32 v53, v53
    v_rcp_f32 v54, v54
    v_rcp_f32 v55, v55
    v_rcp_f32 v56, v56
    v_rcp_f32 v57, v57
    v_rcp_f32 v58, v58
    v_rcp_f32 v59, v59
    v_pk_mul_f32 v[128:129], v[128:129], v[48:49]
    v_pk_mul_f32 v[130:131], v[130:131], v[50:51]
    v_pk_mul_f32 v[132:133], v[132:133], v[52:53]
    v_pk_mul_f32 v[134:135], v[134:135], v[54:55]
    v_pk_mul_f32 v[136:137], v[136:137], v[56:57]
    v_pk_mul_f32 v[138:139], v[138:139], v[58:59]
    v_lshrrev_b32 v4, 1, v2
    v_mul_u32_u24 v4, 3072, v4
    v_and_b32 v5, 1, v2
    v_lshlrev_b32 v5, 5, v5
    v_add_u32 v5, v5, v3
    v_lshl_add_u32 v4, v5, 4, v4
    s_lshl_b32 s48, s40, 3
    s_add_u32 s48, s48, s41
    s_mul_i32 s62, s48, 12288
    s_lshr_b32 s48, s47, 1
    s_mul_i32 s48, s48, 6144
    s_add_u32 s62, s62, s48
    s_and_b32 s48, s47, 1
    s_lshl_b32 s48, s48, 8
    s_add_u32 s62, s62, s48
    s_add_u32 s62, s62, 3145728
    s_mul_i32 s51, s43, 3
    v_cvt_pk_bf16_f32 v48, v128, v129
    v_cvt_pk_bf16_f32 v49, v130, v131
    s_add_u32 s48, s51, 0
    s_lshr_b32 s49, s48, 1
    s_lshl_b32 s49, s49, 10
    s_and_b32 s48, s48, 1
    s_lshl_b32 s48, s48, 3
    s_add_u32 s48, s48, s49
    s_add_u32 s48, s48, s62
    buffer_store_dwordx2 v[48:49], v4, s[24:27], s48 offen
    v_cvt_pk_bf16_f32 v50, v132, v133
    v_cvt_pk_bf16_f32 v51, v134, v135
    s_add_u32 s48, s51, 1
    s_lshr_b32 s49, s48, 1
    s_lshl_b32 s49, s49, 10
    s_and_b32 s48, s48, 1
    s_lshl_b32 s48, s48, 3
    s_add_u32 s48, s48, s49
    s_add_u32 s48, s48, s62
    buffer_store_dwordx2 v[50:51], v4, s[24:27], s48 offen
    v_cvt_pk_bf16_f32 v52, v136, v137
    v_cvt_pk_bf16_f32 v53, v138, v139
    s_add_u32 s48, s51, 2
    s_lshr_b32 s49, s48, 1
    s_lshl_b32 s49, s49, 10
    s_and_b32 s48, s48, 1
    s_lshl_b32 s48, s48, 3
    s_add_u32 s48, s48, s49
    s_add_u32 s48, s48, s62
    buffer_store_dwordx2 v[52:53], v4, s[24:27], s48 offen
    s_xor_b32 s48, s42, 1
    s_or_b32 s48, s48, s41
    s_cmp_lg_u32 s48, 0
    s_cbranch_scc1 k1_ep2_9
    s_waitcnt vmcnt(0)
    v_readfirstlane_b32 s48, v44
    s_nop 0
    s_cmp_lg_u32 s48, 31
    s_cbranch_scc1 k1_ep2_9
    v_mov_b32 v8, s100
    v_mov_b32 v9, s101
    v_mov_b32 v4, 14712832
    s_mov_b64 exec, 1
    buffer_store_dwordx2 v[8:9], v4, s[24:27], 0 offen sc1
    s_mov_b64 exec, -1
k1_ep2_9:
k1_kernel_end:
    s_endpgm

.globl k2_kernel
.p2align 8
.type k2_kernel,@function
k2_kernel:
    s_cmp_ge_u32 s2, 512
    s_cbranch_scc1 k2_kernel_end
    s_cmp_ge_u32 s2, 256
    s_cbranch_scc1 k2_kernel_conv
    s_load_dwordx2 s[4:5], s[0:1], 64
    s_load_dwordx2 s[8:9], s[0:1], 104
    s_load_dwordx2 s[12:13], s[0:1], 72
    s_mov_b32 s6, 8388608
    s_mov_b32 s7, 0x20000
    s_mov_b32 s10, 15007744
    s_mov_b32 s11, 0x20000
    s_mov_b32 s14, 4096
    s_mov_b32 s15, 0x20000
    v_lshrrev_b32 v2, 6, v0
    v_and_b32 v1, 63, v0
    v_readfirstlane_b32 s34, v2
    s_and_b32 s40, s2, 7
    s_lshr_b32 s41, s2, 3
    s_lshr_b32 s32, s40, 1
    s_lshl_b32 s32, s32, 3
    s_and_b32 s42, s41, 7
    s_add_u32 s32, s32, s42
    s_and_b32 s33, s40, 1
    s_lshl_b32 s33, s33, 2
    s_lshr_b32 s42, s41, 3
    s_add_u32 s33, s33, s42
    s_lshl_b32 s44, s33, 7
    s_lshl_b32 s40, s34, 5
    s_add_u32 s44, s44, s40
    s_mul_i32 s44, s44, 3072
    s_add_u32 s44, s44, 0
    s_lshl_b32 s45, s32, 18
    s_lshl_b32 s40, s34, 10
    s_add_u32 s45, s45, s40
    s_lshl_b32 s46, s34, 14
    v_lshlrev_b32 v5, 4, v1
    v_lshrrev_b32 v2, 3, v1
    v_lshlrev_b32 v2, 12, v2
    v_and_b32 v3, 7, v1
    v_lshrrev_b32 v4, 4, v1
    v_xor_b32 v3, v3, v4
    v_lshlrev_b32 v4, 4, v3
    v_add_u32 v6, v2, v4
    v_xor_b32 v3, 4, v3
    v_lshlrev_b32 v4, 4, v3
    v_add_u32 v7, v2, v4
    v_and_b32 v2, 31, v1
    v_lshrrev_b32 v3, 1, v2
    v_and_b32 v3, 7, v3
    v_lshrrev_b32 v4, 5, v1
    v_xor_b32 v3, v3, v4
    v_lshlrev_b32 v2, 7, v2
    v_add_u32 v2, s46, v2
    v_xor_b32 v4, 0, v3
    v_lshlrev_b32 v4, 4, v4
    v_add_u32 v8, v2, v4
    v_xor_b32 v4, 2, v3
    v_lshlrev_b32 v4, 4, v4
    v_add_u32 v9, v2, v4
    v_xor_b32 v4, 4, v3
    v_lshlrev_b32 v4, 4, v4
    v_add_u32 v10, v2, v4
    v_xor_b32 v4, 6, v3
    v_lshlrev_b32 v4, 4, v4
    v_add_u32 v11, v2, v4
    s_lshr_b32 s47, s2, 3
    s_and_b32 s47, s47, 31
    s_lshl_b32 s47, s47, 2
    s_add_u32 s47, s47, s34
    s_lshl_b32 s40, s47, 4
    v_add_u32 v2, s40, v1
    v_lshrrev_b32 v3, 2, v2
    v_lshlrev_b32 v3, 12, v3
    v_and_b32 v2, 3, v2
    v_lshl_add_u32 v220, v2, 10, v3
    s_mul_i32 s40, s47, 12
    v_add_u32 v2, s40, v1
    v_mul_u32_u24 v3, 43691, v2
    v_lshrrev_b32 v3, 22, v3
    v_mul_u32_u24 v4, 96, v3
    v_sub_u32 v2, v2, v4
    v_mul_u32_u24 v3, 98304, v3
    v_lshl_add_u32 v221, v2, 7, v3
    s_and_b32 s40, s2, 7
    s_lshr_b32 s48, s40, 1
    s_lshl_b32 s48, s48, 21
    s_and_b32 s49, s40, 1
    s_mul_i32 s49, s49, 1572864
    s_add_u32 s49, s49, 0
    s_mov_b32 s50, 0
    s_waitcnt lgkmcnt(0)
    s_add_u32 s43, s50, 0
    s_and_b32 s43, s43, 7
    s_lshl_b32 s43, s43, 7
    s_add_u32 s43, s43, s45
    s_add_u32 s41, s43, 0
    s_add_u32 m0, s46, 0
    s_nop 0
    buffer_load_dwordx4 v6, s[4:7], s41 offen lds
    s_add_u32 s41, s43, 32768
    s_add_u32 m0, s46, 1024
    s_nop 0
    buffer_load_dwordx4 v7, s[4:7], s41 offen lds
    s_add_u32 s41, s43, 65536
    s_add_u32 m0, s46, 2048
    s_nop 0
    buffer_load_dwordx4 v6, s[4:7], s41 offen lds
    s_add_u32 s41, s43, 98304
    s_add_u32 m0, s46, 3072
    s_nop 0
    buffer_load_dwordx4 v7, s[4:7], s41 offen lds
    s_add_u32 s41, s43, 131072
    s_add_u32 m0, s46, 4096
    s_nop 0
    buffer_load_dwordx4 v6, s[4:7], s41 offen lds
    s_add_u32 s41, s43, 163840
    s_add_u32 m0, s46, 5120
    s_nop 0
    buffer_load_dwordx4 v7, s[4:7], s41 offen lds
    s_add_u32 s41, s43, 196608
    s_add_u32 m0, s46, 6144
    s_nop 0
    buffer_load_dwordx4 v6, s[4:7], s41 offen lds
    s_add_u32 s41, s43, 229376
    s_add_u32 m0, s46, 7168
    s_nop 0
    buffer_load_dwordx4 v7, s[4:7], s41 offen lds
    s_add_u32 s41, s50, 0
    s_and_b32 s41, s41, 7
    s_mul_i32 s41, s41, 12288
    s_add_u32 s41, s41, s44
    buffer_load_dwordx4 v[108:111], v5, s[8:11], s41 offen offset:0
    buffer_load_dwordx4 v[112:115], v5, s[8:11], s41 offen offset:1024
    buffer_load_dwordx4 v[116:119], v5, s[8:11], s41 offen offset:2048
    s_add_u32 s41, s50, 0
    s_and_b32 s41, s41, 7
    s_mul_i32 s41, s41, 12288
    s_add_u32 s41, s41, s44
    s_add_u32 s41, s41, 3072
    buffer_load_dwordx4 v[120:123], v5, s[8:11], s41 offen offset:0
    buffer_load_dwordx4 v[124:127], v5, s[8:11], s41 offen offset:1024
    buffer_load_dwordx4 v[128:131], v5, s[8:11], s41 offen offset:2048
    s_add_u32 s41, s50, 0
    s_and_b32 s41, s41, 7
    s_mul_i32 s41, s41, 12288
    s_add_u32 s41, s41, s44
    s_add_u32 s41, s41, 6144
    buffer_load_dwordx4 v[132:135], v5, s[8:11], s41 offen offset:0
    buffer_load_dwordx4 v[136:139], v5, s[8:11], s41 offen offset:1024
    buffer_load_dwordx4 v[140:143], v5, s[8:11], s41 offen offset:2048
    s_add_u32 s41, s50, 0
    s_and_b32 s41, s41, 7
    s_mul_i32 s41, s41, 12288
    s_add_u32 s41, s41, s44
    s_add_u32 s41, s41, 9216
    buffer_load_dwordx4 v[144:147], v5, s[8:11], s41 offen offset:0
    buffer_load_dwordx4 v[148:151], v5, s[8:11], s41 offen offset:1024
    buffer_load_dwordx4 v[152:155], v5, s[8:11], s41 offen offset:2048
    s_add_u32 s43, s50, 1
    s_and_b32 s43, s43, 7
    s_lshl_b32 s43, s43, 7
    s_add_u32 s43, s43, s45
    s_add_u32 s41, s43, 0
    s_add_u32 m0, s46, 8192
    s_nop 0
    buffer_load_dwordx4 v6, s[4:7], s41 offen lds
    s_add_u32 s41, s43, 32768
    s_add_u32 m0, s46, 9216
    s_nop 0
    buffer_load_dwordx4 v7, s[4:7], s41 offen lds
    s_add_u32 s41, s43, 65536
    s_add_u32 m0, s46, 10240
    s_nop 0
    buffer_load_dwordx4 v6, s[4:7], s41 offen lds
    s_add_u32 s41, s43, 98304
    s_add_u32 m0, s46, 11264
    s_nop 0
    buffer_load_dwordx4 v7, s[4:7], s41 offen lds
    s_add_u32 s41, s43, 131072
    s_add_u32 m0, s46, 12288
    s_nop 0
    buffer_load_dwordx4 v6, s[4:7], s41 offen lds
    s_add_u32 s41, s43, 163840
    s_add_u32 m0, s46, 13312
    s_nop 0
    buffer_load_dwordx4 v7, s[4:7], s41 offen lds
    s_add_u32 s41, s43, 196608
    s_add_u32 m0, s46, 14336
    s_nop 0
    buffer_load_dwordx4 v6, s[4:7], s41 offen lds
    s_add_u32 s41, s43, 229376
    s_add_u32 m0, s46, 15360
    s_nop 0
    buffer_load_dwordx4 v7, s[4:7], s41 offen lds
    s_add_u32 s41, s50, 1
    s_and_b32 s41, s41, 7
    s_mul_i32 s41, s41, 12288
    s_add_u32 s41, s41, s44
    buffer_load_dwordx4 v[156:159], v5, s[8:11], s41 offen offset:0
    buffer_load_dwordx4 v[160:163], v5, s[8:11], s41 offen offset:1024
    buffer_load_dwordx4 v[164:167], v5, s[8:11], s41 offen offset:2048
    s_add_u32 s41, s50, 1
    s_and_b32 s41, s41, 7
    s_mul_i32 s41, s41, 12288
    s_add_u32 s41, s41, s44
    s_add_u32 s41, s41, 3072
    buffer_load_dwordx4 v[168:171], v5, s[8:11], s41 offen offset:0
    buffer_load_dwordx4 v[172:175], v5, s[8:11], s41 offen offset:1024
    buffer_load_dwordx4 v[176:179], v5, s[8:11], s41 offen offset:2048
    s_add_u32 s41, s50, 1
    s_and_b32 s41, s41, 7
    s_mul_i32 s41, s41, 12288
    s_add_u32 s41, s41, s44
    s_add_u32 s41, s41, 6144
    buffer_load_dwordx4 v[180:183], v5, s[8:11], s41 offen offset:0
    buffer_load_dwordx4 v[184:187], v5, s[8:11], s41 offen offset:1024
    buffer_load_dwordx4 v[188:191], v5, s[8:11], s41 offen offset:2048
    s_add_u32 s41, s50, 1
    s_and_b32 s41, s41, 7
    s_mul_i32 s41, s41, 12288
    s_add_u32 s41, s41, s44
    s_add_u32 s41, s41, 9216
    buffer_load_dwordx4 v[192:195], v5, s[8:11], s41 offen offset:0
    buffer_load_dwordx4 v[196:199], v5, s[8:11], s41 offen offset:1024
    buffer_load_dwordx4 v[200:203], v5, s[8:11], s41 offen offset:2048
    s_lshl_b32 s40, s32, 3
    s_add_u32 s40, s40, s33
    s_lshl_b32 s40, s40, 2
    s_add_u32 s40, s40, s34
    s_mul_i32 s40, s40, 3072
    s_add_u32 s40, s40, 3145728
    buffer_load_dwordx4 v[224:227], v5, s[8:11], s40 offen offset:0
    buffer_load_dwordx4 v[228:231], v5, s[8:11], s40 offen offset:1024
    buffer_load_dwordx4 v[232:235], v5, s[8:11], s40 offen offset:2048
    v_and_b32 v2, 31, v1
    v_lshlrev_b32 v2, 1, v2
    s_lshr_b32 s40, s34, 1
    s_lshl_b32 s40, s40, 6
    s_lshl_b32 s41, s32, 7
    s_add_u32 s40, s40, s41
    buffer_load_ushort v236, v2, s[12:15], s40 offen
    s_waitcnt vmcnt(36)
    ds_read_b128 v[204:207], v8 offset:0
    ds_read_b128 v[208:211], v8 offset:4096
    ds_read_b128 v[212:215], v9 offset:0
    ds_read_b128 v[216:219], v9 offset:4096
    s_waitcnt vmcnt(33)
    s_waitcnt lgkmcnt(2)
    v_mfma_f32_32x32x16_bf16 v[12:27], v[108:111], v[204:207], 0
    v_mfma_f32_32x32x16_bf16 v[28:43], v[108:111], v[208:211], 0
    v_mfma_f32_32x32x16_bf16 v[44:59], v[112:115], v[204:207], 0
    v_mfma_f32_32x32x16_bf16 v[60:75], v[112:115], v[208:211], 0
    v_mfma_f32_32x32x16_bf16 v[76:91], v[116:119], v[204:207], 0
    v_mfma_f32_32x32x16_bf16 v[92:107], v[116:119], v[208:211], 0
    s_add_u32 s41, s50, 2
    s_and_b32 s41, s41, 7
    s_mul_i32 s41, s41, 12288
    s_add_u32 s41, s41, s44
    buffer_load_dwordx4 v[108:111], v5, s[8:11], s41 offen offset:0
    buffer_load_dwordx4 v[112:115], v5, s[8:11], s41 offen offset:1024
    buffer_load_dwordx4 v[116:119], v5, s[8:11], s41 offen offset:2048
    ds_read_b128 v[204:207], v10 offset:0
    ds_read_b128 v[208:211], v10 offset:4096
    s_waitcnt vmcnt(33)
    s_waitcnt lgkmcnt(2)
    v_mfma_f32_32x32x16_bf16 v[12:27], v[120:123], v[212:215], v[12:27]
    v_mfma_f32_32x32x16_bf16 v[28:43], v[120:123], v[216:219], v[28:43]
    v_mfma_f32_32x32x16_bf16 v[44:59], v[124:127], v[212:215], v[44:59]
    v_mfma_f32_32x32x16_bf16 v[60:75], v[124:127], v[216:219], v[60:75]
    v_mfma_f32_32x32x16_bf16 v[76:91], v[128:131], v[212:215], v[76:91]
    v_mfma_f32_32x32x16_bf16 v[92:107], v[128:131], v[216:219], v[92:107]
    s_add_u32 s41, s50, 2
    s_and_b32 s41, s41, 7
    s_mul_i32 s41, s41, 12288
    s_add_u32 s41, s41, s44
    s_add_u32 s41, s41, 3072
    buffer_load_dwordx4 v[120:123], v5, s[8:11], s41 offen offset:0
    buffer_load_dwordx4 v[124:127], v5, s[8:11], s41 offen offset:1024
    buffer_load_dwordx4 v[128:131], v5, s[8:11], s41 offen offset:2048
    ds_read_b128 v[212:215], v11 offset:0
    ds_read_b128 v[216:219], v11 offset:4096
    s_waitcnt vmcnt(33)
    s_waitcnt lgkmcnt(2)
    v_mfma_f32_32x32x16_bf16 v[12:27], v[132:135], v[204:207], v[12:27]
    v_mfma_f32_32x32x16_bf16 v[28:43], v[132:135], v[208:211], v[28:43]
    v_mfma_f32_32x32x16_bf16 v[44:59], v[136:139], v[204:207], v[44:59]
    v_mfma_f32_32x32x16_bf16 v[60:75], v[136:139], v[208:211], v[60:75]
    v_mfma_f32_32x32x16_bf16 v[76:91], v[140:143], v[204:207], v[76:91]
    v_mfma_f32_32x32x16_bf16 v[92:107], v[140:143], v[208:211], v[92:107]
    s_add_u32 s41, s50, 2
    s_and_b32 s41, s41, 7
    s_mul_i32 s41, s41, 12288
    s_add_u32 s41, s41, s44
    s_add_u32 s41, s41, 6144
    buffer_load_dwordx4 v[132:135], v5, s[8:11], s41 offen offset:0
    buffer_load_dwordx4 v[136:139], v5, s[8:11], s41 offen offset:1024
    buffer_load_dwordx4 v[140:143], v5, s[8:11], s41 offen offset:2048
    s_waitcnt vmcnt(25)
    ds_read_b128 v[204:207], v8 offset:8192
    ds_read_b128 v[208:211], v8 offset:12288
    s_waitcnt vmcnt(33)
    s_waitcnt lgkmcnt(2)
    v_mfma_f32_32x32x16_bf16 v[12:27], v[144:147], v[212:215], v[12:27]
    v_mfma_f32_32x32x16_bf16 v[28:43], v[144:147], v[216:219], v[28:43]
    v_mfma_f32_32x32x16_bf16 v[44:59], v[148:151], v[212:215], v[44:59]
    v_mfma_f32_32x32x16_bf16 v[60:75], v[148:151], v[216:219], v[60:75]
    v_mfma_f32_32x32x16_bf16 v[76:91], v[152:155], v[212:215], v[76:91]
    v_mfma_f32_32x32x16_bf16 v[92:107], v[152:155], v[216:219], v[92:107]
    s_add_u32 s41, s50, 2
    s_and_b32 s41, s41, 7
    s_mul_i32 s41, s41, 12288
    s_add_u32 s41, s41, s44
    s_add_u32 s41, s41, 9216
    buffer_load_dwordx4 v[144:147], v5, s[8:11], s41 offen offset:0
    buffer_load_dwordx4 v[148:151], v5, s[8:11], s41 offen offset:1024
    buffer_load_dwordx4 v[152:155], v5, s[8:11], s41 offen offset:2048
    s_add_u32 s43, s50, 2
    s_and_b32 s43, s43, 7
    s_lshl_b32 s43, s43, 7
    s_add_u32 s43, s43, s45
    s_add_u32 s41, s43, 0
    s_add_u32 m0, s46, 0
    s_nop 0
    buffer_load_dwordx4 v6, s[4:7], s41 offen lds
    s_add_u32 s41, s43, 32768
    s_add_u32 m0, s46, 1024
    s_nop 0
    buffer_load_dwordx4 v7, s[4:7], s41 offen lds
    s_add_u32 s41, s43, 65536
    s_add_u32 m0, s46, 2048
    s_nop 0
    buffer_load_dwordx4 v6, s[4:7], s41 offen lds
    s_add_u32 s41, s43, 98304
    s_add_u32 m0, s46, 3072
    s_nop 0
    buffer_load_dwordx4 v7, s[4:7], s41 offen lds
    s_add_u32 s41, s43, 131072
    s_add_u32 m0, s46, 4096
    s_nop 0
    buffer_load_dwordx4 v6, s[4:7], s41 offen lds
    s_add_u32 s41, s43, 163840
    s_add_u32 m0, s46, 5120
    s_nop 0
    buffer_load_dwordx4 v7, s[4:7], s41 offen lds
    s_add_u32 s41, s43, 196608
    s_add_u32 m0, s46, 6144
    s_nop 0
    buffer_load_dwordx4 v6, s[4:7], s41 offen lds
    s_add_u32 s41, s43, 229376
    s_add_u32 m0, s46, 7168
    s_nop 0
    buffer_load_dwordx4 v7, s[4:7], s41 offen lds
    ds_read_b128 v[212:215], v9 offset:8192
    ds_read_b128 v[216:219], v9 offset:12288
    s_waitcnt vmcnt(33)
    s_waitcnt lgkmcnt(2)
    v_mfma_f32_32x32x16_bf16 v[12:27], v[156:159], v[204:207], v[12:27]
    v_mfma_f32_32x32x16_bf16 v[28:43], v[156:159], v[208:211], v[28:43]
    v_mfma_f32_32x32x16_bf16 v[44:59], v[160:163], v[204:207], v[44:59]
    v_mfma_f32_32x32x16_bf16 v[60:75], v[160:163], v[208:211], v[60:75]
    v_mfma_f32_32x32x16_bf16 v[76:91], v[164:167], v[204:207], v[76:91]
    v_mfma_f32_32x32x16_bf16 v[92:107], v[164:167], v[208:211], v[92:107]
    s_add_u32 s41, s50, 3
    s_and_b32 s41, s41, 7
    s_mul_i32 s41, s41, 12288
    s_add_u32 s41, s41, s44
    buffer_load_dwordx4 v[156:159], v5, s[8:11], s41 offen offset:0
    buffer_load_dwordx4 v[160:163], v5, s[8:11], s41 offen offset:1024
    buffer_load_dwordx4 v[164:167], v5, s[8:11], s41 offen offset:2048
    ds_read_b128 v[204:207], v10 offset:8192
    ds_read_b128 v[208:211], v10 offset:12288
    s_waitcnt vmcnt(33)
    s_waitcnt lgkmcnt(2)
    v_mfma_f32_32x32x16_bf16 v[12:27], v[168:171], v[212:215], v[12:27]
    v_mfma_f32_32x32x16_bf16 v[28:43], v[168:171], v[216:219], v[28:43]
    v_mfma_f32_32x32x16_bf16 v[44:59], v[172:175], v[212:215], v[44:59]
    v_mfma_f32_32x32x16_bf16 v[60:75], v[172:175], v[216:219], v[60:75]
    v_mfma_f32_32x32x16_bf16 v[76:91], v[176:179], v[212:215], v[76:91]
    v_mfma_f32_32x32x16_bf16 v[92:107], v[176:179], v[216:219], v[92:107]
    s_add_u32 s41, s50, 3
    s_and_b32 s41, s41, 7
    s_mul_i32 s41, s41, 12288
    s_add_u32 s41, s41, s44
    s_add_u32 s41, s41, 3072
    buffer_load_dwordx4 v[168:171], v5, s[8:11], s41 offen offset:0
    buffer_load_dwordx4 v[172:175], v5, s[8:11], s41 offen offset:1024
    buffer_load_dwordx4 v[176:179], v5, s[8:11], s41 offen offset:2048
    ds_read_b128 v[212:215], v11 offset:8192
    ds_read_b128 v[216:219], v11 offset:12288
    s_waitcnt vmcnt(33)
    s_waitcnt lgkmcnt(2)
    v_mfma_f32_32x32x16_bf16 v[12:27], v[180:183], v[204:207], v[12:27]
    v_mfma_f32_32x32x16_bf16 v[28:43], v[180:183], v[208:211], v[28:43]
    v_mfma_f32_32x32x16_bf16 v[44:59], v[184:187], v[204:207], v[44:59]
    v_mfma_f32_32x32x16_bf16 v[60:75], v[184:187], v[208:211], v[60:75]
    v_mfma_f32_32x32x16_bf16 v[76:91], v[188:191], v[204:207], v[76:91]
    v_mfma_f32_32x32x16_bf16 v[92:107], v[188:191], v[208:211], v[92:107]
    s_add_u32 s41, s50, 3
    s_and_b32 s41, s41, 7
    s_mul_i32 s41, s41, 12288
    s_add_u32 s41, s41, s44
    s_add_u32 s41, s41, 6144
    buffer_load_dwordx4 v[180:183], v5, s[8:11], s41 offen offset:0
    buffer_load_dwordx4 v[184:187], v5, s[8:11], s41 offen offset:1024
    buffer_load_dwordx4 v[188:191], v5, s[8:11], s41 offen offset:2048
    s_waitcnt vmcnt(9)
    ds_read_b128 v[204:207], v8 offset:0
    ds_read_b128 v[208:211], v8 offset:4096
    s_waitcnt vmcnt(33)
    s_waitcnt lgkmcnt(2)
    v_mfma_f32_32x32x16_bf16 v[12:27], v[192:195], v[212:215], v[12:27]
    v_mfma_f32_32x32x16_bf16 v[28:43], v[192:195], v[216:219], v[28:43]
    v_mfma_f32_32x32x16_bf16 v[44:59], v[196:199], v[212:215], v[44:59]
    v_mfma_f32_32x32x16_bf16 v[60:75], v[196:199], v[216:219], v[60:75]
    v_mfma_f32_32x32x16_bf16 v[76:91], v[200:203], v[212:215], v[76:91]
    v_mfma_f32_32x32x16_bf16 v[92:107], v[200:203], v[216:219], v[92:107]
    s_add_u32 s41, s50, 3
    s_and_b32 s41, s41, 7
    s_mul_i32 s41, s41, 12288
    s_add_u32 s41, s41, s44
    s_add_u32 s41, s41, 9216
    buffer_load_dwordx4 v[192:195], v5, s[8:11], s41 offen offset:0
    buffer_load_dwordx4 v[196:199], v5, s[8:11], s41 offen offset:1024
    buffer_load_dwordx4 v[200:203], v5, s[8:11], s41 offen offset:2048
    s_add_u32 s43, s50, 3
    s_and_b32 s43, s43, 7
    s_lshl_b32 s43, s43, 7
    s_add_u32 s43, s43, s45
    s_add_u32 s41, s43, 0
    s_add_u32 m0, s46, 8192
    s_nop 0
    buffer_load_dwordx4 v6, s[4:7], s41 offen lds
    s_add_u32 s41, s43, 32768
    s_add_u32 m0, s46, 9216
    s_nop 0
    buffer_load_dwordx4 v7, s[4:7], s41 offen lds
    s_add_u32 s41, s43, 65536
    s_add_u32 m0, s46, 10240
    s_nop 0
    buffer_load_dwordx4 v6, s[4:7], s41 offen lds
    s_add_u32 s41, s43, 98304
    s_add_u32 m0, s46, 11264
    s_nop 0
    buffer_load_dwordx4 v7, s[4:7], s41 offen lds
    s_add_u32 s41, s43, 131072
    s_add_u32 m0, s46, 12288
    s_nop 0
    buffer_load_dwordx4 v6, s[4:7], s41 offen lds
    s_add_u32 s41, s43, 163840
    s_add_u32 m0, s46, 13312
    s_nop 0
    buffer_load_dwordx4 v7, s[4:7], s41 offen lds
    s_add_u32 s41, s43, 196608
    s_add_u32 m0, s46, 14336
    s_nop 0
    buffer_load_dwordx4 v6, s[4:7], s41 offen lds
    s_add_u32 s41, s43, 229376
    s_add_u32 m0, s46, 15360
    s_nop 0
    buffer_load_dwordx4 v7, s[4:7], s41 offen lds
    ds_read_b128 v[212:215], v9 offset:0
    ds_read_b128 v[216:219], v9 offset:4096
    s_waitcnt vmcnt(37)
    s_waitcnt lgkmcnt(2)
    v_mfma_f32_32x32x16_bf16 v[12:27], v[108:111], v[204:207], v[12:27]
    v_mfma_f32_32x32x16_bf16 v[28:43], v[108:111], v[208:211], v[28:43]
    v_mfma_f32_32x32x16_bf16 v[44:59], v[112:115], v[204:207], v[44:59]
    v_mfma_f32_32x32x16_bf16 v[60:75], v[112:115], v[208:211], v[60:75]
    v_mfma_f32_32x32x16_bf16 v[76:91], v[116:119], v[204:207], v[76:91]
    v_mfma_f32_32x32x16_bf16 v[92:107], v[116:119], v[208:211], v[92:107]
    s_add_u32 s41, s50, 4
    s_and_b32 s41, s41, 7
    s_mul_i32 s41, s41, 12288
    s_add_u32 s41, s41, s44
    buffer_load_dwordx4 v[108:111], v5, s[8:11], s41 offen offset:0
    buffer_load_dwordx4 v[112:115], v5, s[8:11], s41 offen offset:1024
    buffer_load_dwordx4 v[116:119], v5, s[8:11], s41 offen offset:2048
    ds_read_b128 v[204:207], v10 offset:0
    ds_read_b128 v[208:211], v10 offset:4096
    s_waitcnt vmcnt(37)
    s_waitcnt lgkmcnt(2)
    v_mfma_f32_32x32x16_bf16 v[12:27], v[120:123], v[212:215], v[12:27]
    v_mfma_f32_32x32x16_bf16 v[28:43], v[120:123], v[216:219], v[28:43]
    v_mfma_f32_32x32x16_bf16 v[44:59], v[124:127], v[212:215], v[44:59]
    v_mfma_f32_32x32x16_bf16 v[60:75], v[124:127], v[216:219], v[60:75]
    v_mfma_f32_32x32x16_bf16 v[76:91], v[128:131], v[212:215], v[76:91]
    v_mfma_f32_32x32x16_bf16 v[92:107], v[128:131], v[216:219], v[92:107]
    s_add_u32 s41, s50, 4
    s_and_b32 s41, s41, 7
    s_mul_i32 s41, s41, 12288
    s_add_u32 s41, s41, s44
    s_add_u32 s41, s41, 3072
    buffer_load_dwordx4 v[120:123], v5, s[8:11], s41 offen offset:0
    buffer_load_dwordx4 v[124:127], v5, s[8:11], s41 offen offset:1024
    buffer_load_dwordx4 v[128:131], v5, s[8:11], s41 offen offset:2048
    ds_read_b128 v[212:215], v11 offset:0
    ds_read_b128 v[216:219], v11 offset:4096
    s_waitcnt vmcnt(37)
    s_waitcnt lgkmcnt(2)
    v_mfma_f32_32x32x16_bf16 v[12:27], v[132:135], v[204:207], v[12:27]
    v_mfma_f32_32x32x16_bf16 v[28:43], v[132:135], v[208:211], v[28:43]
    v_mfma_f32_32x32x16_bf16 v[44:59], v[136:139], v[204:207], v[44:59]
    v_mfma_f32_32x32x16_bf16 v[60:75], v[136:139], v[208:211], v[60:75]
    v_mfma_f32_32x32x16_bf16 v[76:91], v[140:143], v[204:207], v[76:91]
    v_mfma_f32_32x32x16_bf16 v[92:107], v[140:143], v[208:211], v[92:107]
    s_add_u32 s41, s50, 4
    s_and_b32 s41, s41, 7
    s_mul_i32 s41, s41, 12288
    s_add_u32 s41, s41, s44
    s_add_u32 s41, s41, 6144
    buffer_load_dwordx4 v[132:135], v5, s[8:11], s41 offen offset:0
    buffer_load_dwordx4 v[136:139], v5, s[8:11], s41 offen offset:1024
    buffer_load_dwordx4 v[140:143], v5, s[8:11], s41 offen offset:2048
    s_waitcnt vmcnt(9)
    ds_read_b128 v[204:207], v8 offset:8192
    ds_read_b128 v[208:211], v8 offset:12288
    s_waitcnt vmcnt(37)
    s_waitcnt lgkmcnt(2)
    v_mfma_f32_32x32x16_bf16 v[12:27], v[144:147], v[212:215], v[12:27]
    v_mfma_f32_32x32x16_bf16 v[28:43], v[144:147], v[216:219], v[28:43]
    v_mfma_f32_32x32x16_bf16 v[44:59], v[148:151], v[212:215], v[44:59]
    v_mfma_f32_32x32x16_bf16 v[60:75], v[148:151], v[216:219], v[60:75]
    v_mfma_f32_32x32x16_bf16 v[76:91], v[152:155], v[212:215], v[76:91]
    v_mfma_f32_32x32x16_bf16 v[92:107], v[152:155], v[216:219], v[92:107]
    s_add_u32 s41, s50, 4
    s_and_b32 s41, s41, 7
    s_mul_i32 s41, s41, 12288
    s_add_u32 s41, s41, s44
    s_add_u32 s41, s41, 9216
    buffer_load_dwordx4 v[144:147], v5, s[8:11], s41 offen offset:0
    buffer_load_dwordx4 v[148:151], v5, s[8:11], s41 offen offset:1024
    buffer_load_dwordx4 v[152:155], v5, s[8:11], s41 offen offset:2048
    s_add_u32 s43, s50, 4
    s_and_b32 s43, s43, 7
    s_lshl_b32 s43, s43, 7
    s_add_u32 s43, s43, s45
    s_add_u32 s41, s43, 0
    s_add_u32 m0, s46, 0
    s_nop 0
    buffer_load_dwordx4 v6, s[4:7], s41 offen lds
    s_add_u32 s41, s43, 32768
    s_add_u32 m0, s46, 1024
    s_nop 0
    buffer_load_dwordx4 v7, s[4:7], s41 offen lds
    s_add_u32 s41, s43, 65536
    s_add_u32 m0, s46, 2048
    s_nop 0
    buffer_load_dwordx4 v6, s[4:7], s41 offen lds
    s_add_u32 s41, s43, 98304
    s_add_u32 m0, s46, 3072
    s_nop 0
    buffer_load_dwordx4 v7, s[4:7], s41 offen lds
    s_add_u32 s41, s43, 131072
    s_add_u32 m0, s46, 4096
    s_nop 0
    buffer_load_dwordx4 v6, s[4:7], s41 offen lds
    s_add_u32 s41, s43, 163840
    s_add_u32 m0, s46, 5120
    s_nop 0
    buffer_load_dwordx4 v7, s[4:7], s41 offen lds
    s_add_u32 s41, s43, 196608
    s_add_u32 m0, s46, 6144
    s_nop 0
    buffer_load_dwordx4 v6, s[4:7], s41 offen lds
    s_add_u32 s41, s43, 229376
    s_add_u32 m0, s46, 7168
    s_nop 0
    buffer_load_dwordx4 v7, s[4:7], s41 offen lds
    ds_read_b128 v[212:215], v9 offset:8192
    ds_read_b128 v[216:219], v9 offset:12288
    s_waitcnt vmcnt(37)
    s_waitcnt lgkmcnt(2)
    v_mfma_f32_32x32x16_bf16 v[12:27], v[156:159], v[204:207], v[12:27]
    v_mfma_f32_32x32x16_bf16 v[28:43], v[156:159], v[208:211], v[28:43]
    v_mfma_f32_32x32x16_bf16 v[44:59], v[160:163], v[204:207], v[44:59]
    v_mfma_f32_32x32x16_bf16 v[60:75], v[160:163], v[208:211], v[60:75]
    v_mfma_f32_32x32x16_bf16 v[76:91], v[164:167], v[204:207], v[76:91]
    v_mfma_f32_32x32x16_bf16 v[92:107], v[164:167], v[208:211], v[92:107]
    s_add_u32 s41, s50, 5
    s_and_b32 s41, s41, 7
    s_mul_i32 s41, s41, 12288
    s_add_u32 s41, s41, s44
    buffer_load_dwordx4 v[156:159], v5, s[8:11], s41 offen offset:0
    buffer_load_dwordx4 v[160:163], v5, s[8:11], s41 offen offset:1024
    buffer_load_dwordx4 v[164:167], v5, s[8:11], s41 offen offset:2048
    ds_read_b128 v[204:207], v10 offset:8192
    ds_read_b128 v[208:211], v10 offset:12288
    s_waitcnt vmcnt(37)
    s_waitcnt lgkmcnt(2)
    v_mfma_f32_32x32x16_bf16 v[12:27], v[168:171], v[212:215], v[12:27]
    v_mfma_f32_32x32x16_bf16 v[28:43], v[168:171], v[216:219], v[28:43]
    v_mfma_f32_32x32x16_bf16 v[44:59], v[172:175], v[212:215], v[44:59]
    v_mfma_f32_32x32x16_bf16 v[60:75], v[172:175], v[216:219], v[60:75]
    v_mfma_f32_32x32x16_bf16 v[76:91], v[176:179], v[212:215], v[76:91]
    v_mfma_f32_32x32x16_bf16 v[92:107], v[176:179], v[216:219], v[92:107]
    s_add_u32 s41, s50, 5
    s_and_b32 s41, s41, 7
    s_mul_i32 s41, s41, 12288
    s_add_u32 s41, s41, s44
    s_add_u32 s41, s41, 3072
    buffer_load_dwordx4 v[168:171], v5, s[8:11], s41 offen offset:0
    buffer_load_dwordx4 v[172:175], v5, s[8:11], s41 offen offset:1024
    buffer_load_dwordx4 v[176:179], v5, s[8:11], s41 offen offset:2048
    ds_read_b128 v[212:215], v11 offset:8192
    ds_read_b128 v[216:219], v11 offset:12288
    s_waitcnt vmcnt(37)
    s_waitcnt lgkmcnt(2)
    v_mfma_f32_32x32x16_bf16 v[12:27], v[180:183], v[204:207], v[12:27]
    v_mfma_f32_32x32x16_bf16 v[28:43], v[180:183], v[208:211], v[28:43]
    v_mfma_f32_32x32x16_bf16 v[44:59], v[184:187], v[204:207], v[44:59]
    v_mfma_f32_32x32x16_bf16 v[60:75], v[184:187], v[208:211], v[60:75]
    v_mfma_f32_32x32x16_bf16 v[76:91], v[188:191], v[204:207], v[76:91]
    v_mfma_f32_32x32x16_bf16 v[92:107], v[188:191], v[208:211], v[92:107]
    s_add_u32 s41, s50, 5
    s_and_b32 s41, s41, 7
    s_mul_i32 s41, s41, 12288
    s_add_u32 s41, s41, s44
    s_add_u32 s41, s41, 6144
    buffer_load_dwordx4 v[180:183], v5, s[8:11], s41 offen offset:0
    buffer_load_dwordx4 v[184:187], v5, s[8:11], s41 offen offset:1024
    buffer_load_dwordx4 v[188:191], v5, s[8:11], s41 offen offset:2048
    s_waitcnt vmcnt(9)
    ds_read_b128 v[204:207], v8 offset:0
    ds_read_b128 v[208:211], v8 offset:4096
    s_waitcnt vmcnt(37)
    s_waitcnt lgkmcnt(2)
    v_mfma_f32_32x32x16_bf16 v[12:27], v[192:195], v[212:215], v[12:27]
    v_mfma_f32_32x32x16_bf16 v[28:43], v[192:195], v[216:219], v[28:43]
    v_mfma_f32_32x32x16_bf16 v[44:59], v[196:199], v[212:215], v[44:59]
    v_mfma_f32_32x32x16_bf16 v[60:75], v[196:199], v[216:219], v[60:75]
    v_mfma_f32_32x32x16_bf16 v[76:91], v[200:203], v[212:215], v[76:91]
    v_mfma_f32_32x32x16_bf16 v[92:107], v[200:203], v[216:219], v[92:107]
    s_add_u32 s41, s50, 5
    s_and_b32 s41, s41, 7
    s_mul_i32 s41, s41, 12288
    s_add_u32 s41, s41, s44
    s_add_u32 s41, s41, 9216
    buffer_load_dwordx4 v[192:195], v5, s[8:11], s41 offen offset:0
    buffer_load_dwordx4 v[196:199], v5, s[8:11], s41 offen offset:1024
    buffer_load_dwordx4 v[200:203], v5, s[8:11], s41 offen offset:2048
    s_add_u32 s43, s50, 5
    s_and_b32 s43, s43, 7
    s_lshl_b32 s43, s43, 7
    s_add_u32 s43, s43, s45
    s_add_u32 s41, s43, 0
    s_add_u32 m0, s46, 8192
    s_nop 0
    buffer_load_dwordx4 v6, s[4:7], s41 offen lds
    s_add_u32 s41, s43, 32768
    s_add_u32 m0, s46, 9216
    s_nop 0
    buffer_load_dwordx4 v7, s[4:7], s41 offen lds
    s_add_u32 s41, s43, 65536
    s_add_u32 m0, s46, 10240
    s_nop 0
    buffer_load_dwordx4 v6, s[4:7], s41 offen lds
    s_add_u32 s41, s43, 98304
    s_add_u32 m0, s46, 11264
    s_nop 0
    buffer_load_dwordx4 v7, s[4:7], s41 offen lds
    s_add_u32 s41, s43, 131072
    s_add_u32 m0, s46, 12288
    s_nop 0
    buffer_load_dwordx4 v6, s[4:7], s41 offen lds
    s_add_u32 s41, s43, 163840
    s_add_u32 m0, s46, 13312
    s_nop 0
    buffer_load_dwordx4 v7, s[4:7], s41 offen lds
    s_add_u32 s41, s43, 196608
    s_add_u32 m0, s46, 14336
    s_nop 0
    buffer_load_dwordx4 v6, s[4:7], s41 offen lds
    s_add_u32 s41, s43, 229376
    s_add_u32 m0, s46, 15360
    s_nop 0
    buffer_load_dwordx4 v7, s[4:7], s41 offen lds
    ds_read_b128 v[212:215], v9 offset:0
    ds_read_b128 v[216:219], v9 offset:4096
    s_waitcnt vmcnt(37)
    s_waitcnt lgkmcnt(2)
    v_mfma_f32_32x32x16_bf16 v[12:27], v[108:111], v[204:207], v[12:27]
    v_mfma_f32_32x32x16_bf16 v[28:43], v[108:111], v[208:211], v[28:43]
    v_mfma_f32_32x32x16_bf16 v[44:59], v[112:115], v[204:207], v[44:59]
    v_mfma_f32_32x32x16_bf16 v[60:75], v[112:115], v[208:211], v[60:75]
    v_mfma_f32_32x32x16_bf16 v[76:91], v[116:119], v[204:207], v[76:91]
    v_mfma_f32_32x32x16_bf16 v[92:107], v[116:119], v[208:211], v[92:107]
    s_add_u32 s41, s50, 6
    s_and_b32 s41, s41, 7
    s_mul_i32 s41, s41, 12288
    s_add_u32 s41, s41, s44
    buffer_load_dwordx4 v[108:111], v5, s[8:11], s41 offen offset:0
    buffer_load_dwordx4 v[112:115], v5, s[8:11], s41 offen offset:1024
    buffer_load_dwordx4 v[116:119], v5, s[8:11], s41 offen offset:2048
    ds_read_b128 v[204:207], v10 offset:0
    ds_read_b128 v[208:211], v10 offset:4096
    s_waitcnt vmcnt(37)
    s_waitcnt lgkmcnt(2)
    v_mfma_f32_32x32x16_bf16 v[12:27], v[120:123], v[212:215], v[12:27]
    v_mfma_f32_32x32x16_bf16 v[28:43], v[120:123], v[216:219], v[28:43]
    v_mfma_f32_32x32x16_bf16 v[44:59], v[124:127], v[212:215], v[44:59]
    v_mfma_f32_32x32x16_bf16 v[60:75], v[124:127], v[216:219], v[60:75]
    v_mfma_f32_32x32x16_bf16 v[76:91], v[128:131], v[212:215], v[76:91]
    v_mfma_f32_32x32x16_bf16 v[92:107], v[128:131], v[216:219], v[92:107]
    s_add_u32 s41, s50, 6
    s_and_b32 s41, s41, 7
    s_mul_i32 s41, s41, 12288
    s_add_u32 s41, s41, s44
    s_add_u32 s41, s41, 3072
    buffer_load_dwordx4 v[120:123], v5, s[8:11], s41 offen offset:0
    buffer_load_dwordx4 v[124:127], v5, s[8:11], s41 offen offset:1024
    buffer_load_dwordx4 v[128:131], v5, s[8:11], s41 offen offset:2048
    ds_read_b128 v[212:215], v11 offset:0
    ds_read_b128 v[216:219], v11 offset:4096
    s_waitcnt vmcnt(37)
    s_waitcnt lgkmcnt(2)
    v_mfma_f32_32x32x16_bf16 v[12:27], v[132:135], v[204:207], v[12:27]
    v_mfma_f32_32x32x16_bf16 v[28:43], v[132:135], v[208:211], v[28:43]
    v_mfma_f32_32x32x16_bf16 v[44:59], v[136:139], v[204:207], v[44:59]
    v_mfma_f32_32x32x16_bf16 v[60:75], v[136:139], v[208:211], v[60:75]
    v_mfma_f32_32x32x16_bf16 v[76:91], v[140:143], v[204:207], v[76:91]
    v_mfma_f32_32x32x16_bf16 v[92:107], v[140:143], v[208:211], v[92:107]
    s_add_u32 s41, s50, 6
    s_and_b32 s41, s41, 7
    s_mul_i32 s41, s41, 12288
    s_add_u32 s41, s41, s44
    s_add_u32 s41, s41, 6144
    buffer_load_dwordx4 v[132:135], v5, s[8:11], s41 offen offset:0
    buffer_load_dwordx4 v[136:139], v5, s[8:11], s41 offen offset:1024
    buffer_load_dwordx4 v[140:143], v5, s[8:11], s41 offen offset:2048
    s_waitcnt vmcnt(9)
    ds_read_b128 v[204:207], v8 offset:8192
    ds_read_b128 v[208:211], v8 offset:12288
    s_waitcnt vmcnt(37)
    s_waitcnt lgkmcnt(2)
    v_mfma_f32_32x32x16_bf16 v[12:27], v[144:147], v[212:215], v[12:27]
    v_mfma_f32_32x32x16_bf16 v[28:43], v[144:147], v[216:219], v[28:43]
    v_mfma_f32_32x32x16_bf16 v[44:59], v[148:151], v[212:215], v[44:59]
    v_mfma_f32_32x32x16_bf16 v[60:75], v[148:151], v[216:219], v[60:75]
    v_mfma_f32_32x32x16_bf16 v[76:91], v[152:155], v[212:215], v[76:91]
    v_mfma_f32_32x32x16_bf16 v[92:107], v[152:155], v[216:219], v[92:107]
    s_add_u32 s41, s50, 6
    s_and_b32 s41, s41, 7
    s_mul_i32 s41, s41, 12288
    s_add_u32 s41, s41, s44
    s_add_u32 s41, s41, 9216
    buffer_load_dwordx4 v[144:147], v5, s[8:11], s41 offen offset:0
    buffer_load_dwordx4 v[148:151], v5, s[8:11], s41 offen offset:1024
    buffer_load_dwordx4 v[152:155], v5, s[8:11], s41 offen offset:2048
    s_add_u32 s43, s50, 6
    s_and_b32 s43, s43, 7
    s_lshl_b32 s43, s43, 7
    s_add_u32 s43, s43, s45
    s_add_u32 s41, s43, 0
    s_add_u32 m0, s46, 0
    s_nop 0
    buffer_load_dwordx4 v6, s[4:7], s41 offen lds
    s_add_u32 s41, s43, 32768
    s_add_u32 m0, s46, 1024
    s_nop 0
    buffer_load_dwordx4 v7, s[4:7], s41 offen lds
    s_add_u32 s41, s43, 65536
    s_add_u32 m0, s46, 2048
    s_nop 0
    buffer_load_dwordx4 v6, s[4:7], s41 offen lds
    s_add_u32 s41, s43, 98304
    s_add_u32 m0, s46, 3072
    s_nop 0
    buffer_load_dwordx4 v7, s[4:7], s41 offen lds
    s_add_u32 s41, s43, 131072
    s_add_u32 m0, s46, 4096
    s_nop 0
    buffer_load_dwordx4 v6, s[4:7], s41 offen lds
    s_add_u32 s41, s43, 163840
    s_add_u32 m0, s46, 5120
    s_nop 0
    buffer_load_dwordx4 v7, s[4:7], s41 offen lds
    s_add_u32 s41, s43, 196608
    s_add_u32 m0, s46, 6144
    s_nop 0
    buffer_load_dwordx4 v6, s[4:7], s41 offen lds
    s_add_u32 s41, s43, 229376
    s_add_u32 m0, s46, 7168
    s_nop 0
    buffer_load_dwordx4 v7, s[4:7], s41 offen lds
    ds_read_b128 v[212:215], v9 offset:8192
    ds_read_b128 v[216:219], v9 offset:12288
    s_waitcnt vmcnt(37)
    s_waitcnt lgkmcnt(2)
    v_mfma_f32_32x32x16_bf16 v[12:27], v[156:159], v[204:207], v[12:27]
    v_mfma_f32_32x32x16_bf16 v[28:43], v[156:159], v[208:211], v[28:43]
    v_mfma_f32_32x32x16_bf16 v[44:59], v[160:163], v[204:207], v[44:59]
    v_mfma_f32_32x32x16_bf16 v[60:75], v[160:163], v[208:211], v[60:75]
    v_mfma_f32_32x32x16_bf16 v[76:91], v[164:167], v[204:207], v[76:91]
    v_mfma_f32_32x32x16_bf16 v[92:107], v[164:167], v[208:211], v[92:107]
    s_add_u32 s41, s50, 7
    s_and_b32 s41, s41, 7
    s_mul_i32 s41, s41, 12288
    s_add_u32 s41, s41, s44
    buffer_load_dwordx4 v[156:159], v5, s[8:11], s41 offen offset:0
    buffer_load_dwordx4 v[160:163], v5, s[8:11], s41 offen offset:1024
    buffer_load_dwordx4 v[164:167], v5, s[8:11], s41 offen offset:2048
    ds_read_b128 v[204:207], v10 offset:8192
    ds_read_b128 v[208:211], v10 offset:12288
    s_waitcnt vmcnt(37)
    s_waitcnt lgkmcnt(2)
    v_mfma_f32_32x32x16_bf16 v[12:27], v[168:171], v[212:215], v[12:27]
    v_mfma_f32_32x32x16_bf16 v[28:43], v[168:171], v[216:219], v[28:43]
    v_mfma_f32_32x32x16_bf16 v[44:59], v[172:175], v[212:215], v[44:59]
    v_mfma_f32_32x32x16_bf16 v[60:75], v[172:175], v[216:219], v[60:75]
    v_mfma_f32_32x32x16_bf16 v[76:91], v[176:179], v[212:215], v[76:91]
    v_mfma_f32_32x32x16_bf16 v[92:107], v[176:179], v[216:219], v[92:107]
    s_add_u32 s41, s50, 7
    s_and_b32 s41, s41, 7
    s_mul_i32 s41, s41, 12288
    s_add_u32 s41, s41, s44
    s_add_u32 s41, s41, 3072
    buffer_load_dwordx4 v[168:171], v5, s[8:11], s41 offen offset:0
    buffer_load_dwordx4 v[172:175], v5, s[8:11], s41 offen offset:1024
    buffer_load_dwordx4 v[176:179], v5, s[8:11], s41 offen offset:2048
    ds_read_b128 v[212:215], v11 offset:8192
    ds_read_b128 v[216:219], v11 offset:12288
    s_waitcnt vmcnt(37)
    s_waitcnt lgkmcnt(2)
    v_mfma_f32_32x32x16_bf16 v[12:27], v[180:183], v[204:207], v[12:27]
    v_mfma_f32_32x32x16_bf16 v[28:43], v[180:183], v[208:211], v[28:43]
    v_mfma_f32_32x32x16_bf16 v[44:59], v[184:187], v[204:207], v[44:59]
    v_mfma_f32_32x32x16_bf16 v[60:75], v[184:187], v[208:211], v[60:75]
    v_mfma_f32_32x32x16_bf16 v[76:91], v[188:191], v[204:207], v[76:91]
    v_mfma_f32_32x32x16_bf16 v[92:107], v[188:191], v[208:211], v[92:107]
    s_add_u32 s41, s50, 7
    s_and_b32 s41, s41, 7
    s_mul_i32 s41, s41, 12288
    s_add_u32 s41, s41, s44
    s_add_u32 s41, s41, 6144
    buffer_load_dwordx4 v[180:183], v5, s[8:11], s41 offen offset:0
    buffer_load_dwordx4 v[184:187], v5, s[8:11], s41 offen offset:1024
    buffer_load_dwordx4 v[188:191], v5, s[8:11], s41 offen offset:2048
    s_waitcnt vmcnt(9)
    ds_read_b128 v[204:207], v8 offset:0
    ds_read_b128 v[208:211], v8 offset:4096
    s_waitcnt vmcnt(37)
    s_waitcnt lgkmcnt(2)
    v_mfma_f32_32x32x16_bf16 v[12:27], v[192:195], v[212:215], v[12:27]
    v_mfma_f32_32x32x16_bf16 v[28:43], v[192:195], v[216:219], v[28:43]
    v_mfma_f32_32x32x16_bf16 v[44:59], v[196:199], v[212:215], v[44:59]
    v_mfma_f32_32x32x16_bf16 v[60:75], v[196:199], v[216:219], v[60:75]
    v_mfma_f32_32x32x16_bf16 v[76:91], v[200:203], v[212:215], v[76:91]
    v_mfma_f32_32x32x16_bf16 v[92:107], v[200:203], v[216:219], v[92:107]
    s_add_u32 s41, s50, 7
    s_and_b32 s41, s41, 7
    s_mul_i32 s41, s41, 12288
    s_add_u32 s41, s41, s44
    s_add_u32 s41, s41, 9216
    buffer_load_dwordx4 v[192:195], v5, s[8:11], s41 offen offset:0
    buffer_load_dwordx4 v[196:199], v5, s[8:11], s41 offen offset:1024
    buffer_load_dwordx4 v[200:203], v5, s[8:11], s41 offen offset:2048
    s_add_u32 s43, s50, 7
    s_and_b32 s43, s43, 7
    s_lshl_b32 s43, s43, 7
    s_add_u32 s43, s43, s45
    s_add_u32 s41, s43, 0
    s_add_u32 m0, s46, 8192
    s_nop 0
    buffer_load_dwordx4 v6, s[4:7], s41 offen lds
    s_add_u32 s41, s43, 32768
    s_add_u32 m0, s46, 9216
    s_nop 0
    buffer_load_dwordx4 v7, s[4:7], s41 offen lds
    s_add_u32 s41, s43, 65536
    s_add_u32 m0, s46, 10240
    s_nop 0
    buffer_load_dwordx4 v6, s[4:7], s41 offen lds
    s_add_u32 s41, s43, 98304
    s_add_u32 m0, s46, 11264
    s_nop 0
    buffer_load_dwordx4 v7, s[4:7], s41 offen lds
    s_add_u32 s41, s43, 131072
    s_add_u32 m0, s46, 12288
    s_nop 0
    buffer_load_dwordx4 v6, s[4:7], s41 offen lds
    s_add_u32 s41, s43, 163840
    s_add_u32 m0, s46, 13312
    s_nop 0
    buffer_load_dwordx4 v7, s[4:7], s41 offen lds
    s_add_u32 s41, s43, 196608
    s_add_u32 m0, s46, 14336
    s_nop 0
    buffer_load_dwordx4 v6, s[4:7], s41 offen lds
    s_add_u32 s41, s43, 229376
    s_add_u32 m0, s46, 15360
    s_nop 0
    buffer_load_dwordx4 v7, s[4:7], s41 offen lds
    ds_read_b128 v[212:215], v9 offset:0
    ds_read_b128 v[216:219], v9 offset:4096
    s_waitcnt vmcnt(37)
    s_waitcnt lgkmcnt(2)
    v_mfma_f32_32x32x16_bf16 v[12:27], v[108:111], v[204:207], v[12:27]
    v_mfma_f32_32x32x16_bf16 v[28:43], v[108:111], v[208:211], v[28:43]
    v_mfma_f32_32x32x16_bf16 v[44:59], v[112:115], v[204:207], v[44:59]
    v_mfma_f32_32x32x16_bf16 v[60:75], v[112:115], v[208:211], v[60:75]
    v_mfma_f32_32x32x16_bf16 v[76:91], v[116:119], v[204:207], v[76:91]
    v_mfma_f32_32x32x16_bf16 v[92:107], v[116:119], v[208:211], v[92:107]
    ds_read_b128 v[204:207], v10 offset:0
    ds_read_b128 v[208:211], v10 offset:4096
    s_waitcnt vmcnt(34)
    s_waitcnt lgkmcnt(2)
    v_mfma_f32_32x32x16_bf16 v[12:27], v[120:123], v[212:215], v[12:27]
    v_mfma_f32_32x32x16_bf16 v[28:43], v[120:123], v[216:219], v[28:43]
    v_mfma_f32_32x32x16_bf16 v[44:59], v[124:127], v[212:215], v[44:59]
    v_mfma_f32_32x32x16_bf16 v[60:75], v[124:127], v[216:219], v[60:75]
    v_mfma_f32_32x32x16_bf16 v[76:91], v[128:131], v[212:215], v[76:91]
    v_mfma_f32_32x32x16_bf16 v[92:107], v[128:131], v[216:219], v[92:107]
    ds_read_b128 v[212:215], v11 offset:0
    ds_read_b128 v[216:219], v11 offset:4096
    s_waitcnt vmcnt(31)
    s_waitcnt lgkmcnt(2)
    v_mfma_f32_32x32x16_bf16 v[12:27], v[132:135], v[204:207], v[12:27]
    v_mfma_f32_32x32x16_bf16 v[28:43], v[132:135], v[208:211], v[28:43]
    v_mfma_f32_32x32x16_bf16 v[44:59], v[136:139], v[204:207], v[44:59]
    v_mfma_f32_32x32x16_bf16 v[60:75], v[136:139], v[208:211], v[60:75]
    v_mfma_f32_32x32x16_bf16 v[76:91], v[140:143], v[204:207], v[76:91]
    v_mfma_f32_32x32x16_bf16 v[92:107], v[140:143], v[208:211], v[92:107]
    s_waitcnt vmcnt(0)
    ds_read_b128 v[204:207], v8 offset:8192
    ds_read_b128 v[208:211], v8 offset:12288
    s_waitcnt vmcnt(28)
    s_waitcnt lgkmcnt(2)
    v_mfma_f32_32x32x16_bf16 v[12:27], v[144:147], v[212:215], v[12:27]
    v_mfma_f32_32x32x16_bf16 v[28:43], v[144:147], v[216:219], v[28:43]
    v_mfma_f32_32x32x16_bf16 v[44:59], v[148:151], v[212:215], v[44:59]
    v_mfma_f32_32x32x16_bf16 v[60:75], v[148:151], v[216:219], v[60:75]
    v_mfma_f32_32x32x16_bf16 v[76:91], v[152:155], v[212:215], v[76:91]
    v_mfma_f32_32x32x16_bf16 v[92:107], v[152:155], v[216:219], v[92:107]
    ds_read_b128 v[212:215], v9 offset:8192
    ds_read_b128 v[216:219], v9 offset:12288
    s_waitcnt vmcnt(17)
    s_waitcnt lgkmcnt(2)
    v_mfma_f32_32x32x16_bf16 v[12:27], v[156:159], v[204:207], v[12:27]
    v_mfma_f32_32x32x16_bf16 v[28:43], v[156:159], v[208:211], v[28:43]
    v_mfma_f32_32x32x16_bf16 v[44:59], v[160:163], v[204:207], v[44:59]
    v_mfma_f32_32x32x16_bf16 v[60:75], v[160:163], v[208:211], v[60:75]
    v_mfma_f32_32x32x16_bf16 v[76:91], v[164:167], v[204:207], v[76:91]
    v_mfma_f32_32x32x16_bf16 v[92:107], v[164:167], v[208:211], v[92:107]
    ds_read_b128 v[204:207], v10 offset:8192
    ds_read_b128 v[208:211], v10 offset:12288
    s_waitcnt vmcnt(14)
    s_waitcnt lgkmcnt(2)
    v_mfma_f32_32x32x16_bf16 v[12:27], v[168:171], v[212:215], v[12:27]
    v_mfma_f32_32x32x16_bf16 v[28:43], v[168:171], v[216:219], v[28:43]
    v_mfma_f32_32x32x16_bf16 v[44:59], v[172:175], v[212:215], v[44:59]
    v_mfma_f32_32x32x16_bf16 v[60:75], v[172:175], v[216:219], v[60:75]
    v_mfma_f32_32x32x16_bf16 v[76:91], v[176:179], v[212:215], v[76:91]
    v_mfma_f32_32x32x16_bf16 v[92:107], v[176:179], v[216:219], v[92:107]
    ds_read_b128 v[212:215], v11 offset:8192
    ds_read_b128 v[216:219], v11 offset:12288
    s_waitcnt vmcnt(11)
    s_waitcnt lgkmcnt(2)
    v_mfma_f32_32x32x16_bf16 v[12:27], v[180:183], v[204:207], v[12:27]
    v_mfma_f32_32x32x16_bf16 v[28:43], v[180:183], v[208:211], v[28:43]
    v_mfma_f32_32x32x16_bf16 v[44:59], v[184:187], v[204:207], v[44:59]
    v_mfma_f32_32x32x16_bf16 v[60:75], v[184:187], v[208:211], v[60:75]
    v_mfma_f32_32x32x16_bf16 v[76:91], v[188:191], v[204:207], v[76:91]
    v_mfma_f32_32x32x16_bf16 v[92:107], v[188:191], v[208:211], v[92:107]
    s_waitcnt vmcnt(8)
    s_waitcnt lgkmcnt(0)
    v_mfma_f32_32x32x16_bf16 v[12:27], v[192:195], v[212:215], v[12:27]
    v_mfma_f32_32x32x16_bf16 v[28:43], v[192:195], v[216:219], v[28:43]
    v_mfma_f32_32x32x16_bf16 v[44:59], v[196:199], v[212:215], v[44:59]
    v_mfma_f32_32x32x16_bf16 v[60:75], v[196:199], v[216:219], v[60:75]
    v_mfma_f32_32x32x16_bf16 v[76:91], v[200:203], v[212:215], v[76:91]
    v_mfma_f32_32x32x16_bf16 v[92:107], v[200:203], v[216:219], v[92:107]
    s_barrier
    s_mul_i32 s40, s34, 18432
    v_add_u32 v2, s40, v5
    s_sub_u32 s41, 3, s34
    s_and_b32 s41, s41, 3
    s_mul_i32 s42, s41, 6144
    s_add_u32 s42, s42, s40
    s_cmp_eq_u32 s41, 3
    s_cselect_b32 s42, 73728, s42
    v_add_u32 v237, s42, v5
    s_sub_u32 s41, 4, s34
    s_and_b32 s41, s41, 3
    s_mul_i32 s42, s41, 6144
    s_add_u32 s42, s42, s40
    s_cmp_eq_u32 s41, 3
    s_cselect_b32 s42, 73728, s42
    v_add_u32 v238, s42, v5
    s_sub_u32 s41, 5, s34
    s_and_b32 s41, s41, 3
    s_mul_i32 s42, s41, 6144
    s_add_u32 s42, s42, s40
    s_cmp_eq_u32 s41, 3
    s_cselect_b32 s42, 73728, s42
    v_add_u32 v239, s42, v5
    s_sub_u32 s41, 6, s34
    s_and_b32 s41, s41, 3
    s_mul_i32 s42, s41, 6144
    s_add_u32 s42, s42, s40
    s_cmp_eq_u32 s41, 3
    s_cselect_b32 s42, 73728, s42
    v_add_u32 v240, s42, v5
    ds_write_b128 v237, v[12:15] offset:0
    ds_write_b128 v237, v[20:23] offset:1024
    ds_write_b128 v237, v[44:47] offset:2048
    ds_write_b128 v237, v[52:55] offset:3072
    ds_write_b128 v237, v[76:79] offset:4096
    ds_write_b128 v237, v[84:87] offset:5120
    ds_write_b128 v238, v[16:19] offset:0
    ds_write_b128 v238, v[24:27] offset:1024
    ds_write_b128 v238, v[48:51] offset:2048
    ds_write_b128 v238, v[56:59] offset:3072
    ds_write_b128 v238, v[80:83] offset:4096
    ds_write_b128 v238, v[88:91] offset:5120
    ds_write_b128 v239, v[28:31] offset:0
    ds_write_b128 v239, v[36:39] offset:1024
    ds_write_b128 v239, v[60:63] offset:2048
    ds_write_b128 v239, v[68:71] offset:3072
    ds_write_b128 v239, v[92:95] offset:4096
    ds_write_b128 v239, v[100:103] offset:5120
    ds_write_b128 v240, v[32:35] offset:0
    ds_write_b128 v240, v[40:43] offset:1024
    ds_write_b128 v240, v[64:67] offset:2048
    ds_write_b128 v240, v[72:75] offset:3072
    ds_write_b128 v240, v[96:99] offset:4096
    ds_write_b128 v240, v[104:107] offset:5120
    s_waitcnt lgkmcnt(0)
    s_barrier
    s_cmp_lg_u32 s34, 0
    s_cbranch_scc1 g_own_1
    v_mov_b32 v108, v12
    v_mov_b32 v109, v13
    v_mov_b32 v110, v14
    v_mov_b32 v111, v15
    v_mov_b32 v112, v20
    v_mov_b32 v113, v21
    v_mov_b32 v114, v22
    v_mov_b32 v115, v23
    v_mov_b32 v116, v44
    v_mov_b32 v117, v45
    v_mov_b32 v118, v46
    v_mov_b32 v119, v47
    v_mov_b32 v120, v52
    v_mov_b32 v121, v53
    v_mov_b32 v122, v54
    v_mov_b32 v123, v55
    v_mov_b32 v124, v76
    v_mov_b32 v125, v77
    v_mov_b32 v126, v78
    v_mov_b32 v127, v79
    v_mov_b32 v128, v84
    v_mov_b32 v129, v85
    v_mov_b32 v130, v86
    v_mov_b32 v131, v87
    s_branch g_ownend_5
g_own_1:
    s_cmp_lg_u32 s34, 1
    s_cbranch_scc1 g_own_2
    v_mov_b32 v108, v16
    v_mov_b32 v109, v17
    v_mov_b32 v110, v18
    v_mov_b32 v111, v19
    v_mov_b32 v112, v24
    v_mov_b32 v113, v25
    v_mov_b32 v114, v26
    v_mov_b32 v115, v27
    v_mov_b32 v116, v48
    v_mov_b32 v117, v49
    v_mov_b32 v118, v50
    v_mov_b32 v119, v51
    v_mov_b32 v120, v56
    v_mov_b32 v121, v57
    v_mov_b32 v122, v58
    v_mov_b32 v123, v59
    v_mov_b32 v124, v80
    v_mov_b32 v125, v81
    v_mov_b32 v126, v82
    v_mov_b32 v127, v83
    v_mov_b32 v128, v88
    v_mov_b32 v129, v89
    v_mov_b32 v130, v90
    v_mov_b32 v131, v91
    s_branch g_ownend_5
g_own_2:
    s_cmp_lg_u32 s34, 2
    s_cbranch_scc1 g_own_3
    v_mov_b32 v108, v28
    v_mov_b32 v109, v29
    v_mov_b32 v110, v30
    v_mov_b32 v111, v31
    v_mov_b32 v112, v36
    v_mov_b32 v113, v37
    v_mov_b32 v114, v38
    v_mov_b32 v115, v39
    v_mov_b32 v116, v60
    v_mov_b32 v117, v61
    v_mov_b32 v118, v62
    v_mov_b32 v119, v63
    v_mov_b32 v120, v68
    v_mov_b32 v121, v69
    v_mov_b32 v122, v70
    v_mov_b32 v123, v71
    v_mov_b32 v124, v92
    v_mov_b32 v125, v93
    v_mov_b32 v126, v94
    v_mov_b32 v127, v95
    v_mov_b32 v128, v100
    v_mov_b32 v129, v101
    v_mov_b32 v130, v102
    v_mov_b32 v131, v103
    s_branch g_ownend_5
g_own_3:
    v_mov_b32 v108, v32
    v_mov_b32 v109, v33
    v_mov_b32 v110, v34
    v_mov_b32 v111, v35
    v_mov_b32 v112, v40
    v_mov_b32 v113, v41
    v_mov_b32 v114, v42
    v_mov_b32 v115, v43
    v_mov_b32 v116, v64
    v_mov_b32 v117, v65
    v_mov_b32 v118, v66
    v_mov_b32 v119, v67
    v_mov_b32 v120, v72
    v_mov_b32 v121, v73
    v_mov_b32 v122, v74
    v_mov_b32 v123, v75
    v_mov_b32 v124, v96
    v_mov_b32 v125, v97
    v_mov_b32 v126, v98
    v_mov_b32 v127, v99
    v_mov_b32 v128, v104
    v_mov_b32 v129, v105
    v_mov_b32 v130, v106
    v_mov_b32 v131, v107
g_ownend_5:
    s_add_u32 s41, s34, 1
    s_and_b32 s41, s41, 3
    s_mul_i32 s42, s41, 18432
    s_add_u32 s42, s42, 12288
    v_add_u32 v2, s42, v5
    ds_read_b128 v[12:15], v2 offset:0
    ds_read_b128 v[16:19], v2 offset:1024
    ds_read_b128 v[20:23], v2 offset:2048
    ds_read_b128 v[24:27], v2 offset:3072
    ds_read_b128 v[28:31], v2 offset:4096
    ds_read_b128 v[32:35], v2 offset:5120
    s_add_u32 s41, s34, 2
    s_and_b32 s41, s41, 3
    s_mul_i32 s42, s41, 18432
    s_add_u32 s42, s42, 6144
    v_add_u32 v2, s42, v5
    ds_read_b128 v[36:39], v2 offset:0
    ds_read_b128 v[40:43], v2 offset:1024
    ds_read_b128 v[44:47], v2 offset:2048
    ds_read_b128 v[48:51], v2 offset:3072
    ds_read_b128 v[52:55], v2 offset:4096
    ds_read_b128 v[56:59], v2 offset:5120
    s_add_u32 s41, s34, 3
    s_and_b32 s41, s41, 3
    s_mul_i32 s42, s41, 18432
    s_add_u32 s42, s42, 0
    v_add_u32 v2, s42, v5
    ds_read_b128 v[60:63], v2 offset:0
    ds_read_b128 v[64:67], v2 offset:1024
    ds_read_b128 v[68:71], v2 offset:2048
    ds_read_b128 v[72:75], v2 offset:3072
    ds_read_b128 v[76:79], v2 offset:4096
    ds_read_b128 v[80:83], v2 offset:5120
    s_waitcnt vmcnt(63)
    v_lshlrev_b32 v236, 16, v236
    s_waitcnt lgkmcnt(0)
    v_pk_add_f32 v[108:109], v[108:109], v[12:13]
    v_pk_add_f32 v[110:111], v[110:111], v[14:15]
    v_pk_add_f32 v[112:113], v[112:113], v[16:17]
    v_pk_add_f32 v[114:115], v[114:115], v[18:19]
    v_pk_add_f32 v[116:117], v[116:117], v[20:21]
    v_pk_add_f32 v[118:119], v[118:119], v[22:23]
    v_pk_add_f32 v[120:121], v[120:121], v[24:25]
    v_pk_add_f32 v[122:123], v[122:123], v[26:27]
    v_pk_add_f32 v[124:125], v[124:125], v[28:29]
    v_pk_add_f32 v[126:127], v[126:127], v[30:31]
    v_pk_add_f32 v[128:129], v[128:129], v[32:33]
    v_pk_add_f32 v[130:131], v[130:131], v[34:35]
    v_pk_add_f32 v[108:109], v[108:109], v[36:37]
    v_pk_add_f32 v[110:111], v[110:111], v[38:39]
    v_pk_add_f32 v[112:113], v[112:113], v[40:41]
    v_pk_add_f32 v[114:115], v[114:115], v[42:43]
    v_pk_add_f32 v[116:117], v[116:117], v[44:45]
    v_pk_add_f32 v[118:119], v[118:119], v[46:47]
    v_pk_add_f32 v[120:121], v[120:121], v[48:49]
    v_pk_add_f32 v[122:123], v[122:123], v[50:51]
    v_pk_add_f32 v[124:125], v[124:125], v[52:53]
    v_pk_add_f32 v[126:127], v[126:127], v[54:55]
    v_pk_add_f32 v[128:129], v[128:129], v[56:57]
    v_pk_add_f32 v[130:131], v[130:131], v[58:59]
    v_pk_add_f32 v[108:109], v[108:109], v[60:61]
    v_pk_add_f32 v[110:111], v[110:111], v[62:63]
    v_pk_add_f32 v[112:113], v[112:113], v[64:65]
    v_pk_add_f32 v[114:115], v[114:115], v[66:67]
    v_pk_add_f32 v[116:117], v[116:117], v[68:69]
    v_pk_add_f32 v[118:119], v[118:119], v[70:71]
    v_pk_add_f32 v[120:121], v[120:121], v[72:73]
    v_pk_add_f32 v[122:123], v[122:123], v[74:75]
    v_pk_add_f32 v[124:125], v[124:125], v[76:77]
    v_pk_add_f32 v[126:127], v[126:127], v[78:79]
    v_pk_add_f32 v[128:129], v[128:129], v[80:81]
    v_pk_add_f32 v[130:131], v[130:131], v[82:83]
    v_add_f32 v108, v108, v236
    v_add_f32 v109, v109, v236
    v_lshlrev_b32 v3, 16, v224
    v_and_b32 v4, 0xffff0000, v224
    v_mul_f32 v108, v108, v3
    v_mul_f32 v109, v109, v4
    v_cvt_pk_bf16_f32 v12, v108, v109
    v_add_f32 v110, v110, v236
    v_add_f32 v111, v111, v236
    v_lshlrev_b32 v3, 16, v225
    v_and_b32 v4, 0xffff0000, v225
    v_mul_f32 v110, v110, v3
    v_mul_f32 v111, v111, v4
    v_cvt_pk_bf16_f32 v13, v110, v111
    v_add_f32 v112, v112, v236
    v_add_f32 v113, v113, v236
    v_lshlrev_b32 v3, 16, v226
    v_and_b32 v4, 0xffff0000, v226
    v_mul_f32 v112, v112, v3
    v_mul_f32 v113, v113, v4
    v_cvt_pk_bf16_f32 v14, v112, v113
    v_add_f32 v114, v114, v236
    v_add_f32 v115, v115, v236
    v_lshlrev_b32 v3, 16, v227
    v_and_b32 v4, 0xffff0000, v227
    v_mul_f32 v114, v114, v3
    v_mul_f32 v115, v115, v4
    v_cvt_pk_bf16_f32 v15, v114, v115
    v_add_f32 v116, v116, v236
    v_add_f32 v117, v117, v236
    v_lshlrev_b32 v3, 16, v228
    v_and_b32 v4, 0xffff0000, v228
    v_mul_f32 v116, v116, v3
    v_mul_f32 v117, v117, v4
    v_cvt_pk_bf16_f32 v16, v116, v117
    v_add_f32 v118, v118, v236
    v_add_f32 v119, v119, v236
    v_lshlrev_b32 v3, 16, v229
    v_and_b32 v4, 0xffff0000, v229
    v_mul_f32 v118, v118, v3
    v_mul_f32 v119, v119, v4
    v_cvt_pk_bf16_f32 v17, v118, v119
    v_add_f32 v120, v120, v236
    v_add_f32 v121, v121, v236
    v_lshlrev_b32 v3, 16, v230
    v_and_b32 v4, 0xffff0000, v230
    v_mul_f32 v120, v120, v3
    v_mul_f32 v121, v121, v4
    v_cvt_pk_bf16_f32 v18, v120, v121
    v_add_f32 v122, v122, v236
    v_add_f32 v123, v123, v236
    v_lshlrev_b32 v3, 16, v231
    v_and_b32 v4, 0xffff0000, v231
    v_mul_f32 v122, v122, v3
    v_mul_f32 v123, v123, v4
    v_cvt_pk_bf16_f32 v19, v122, v123
    v_add_f32 v124, v124, v236
    v_add_f32 v125, v125, v236
    v_lshlrev_b32 v3, 16, v232
    v_and_b32 v4, 0xffff0000, v232
    v_mul_f32 v124, v124, v3
    v_mul_f32 v125, v125, v4
    v_cvt_pk_bf16_f32 v20, v124, v125
    v_add_f32 v126, v126, v236
    v_add_f32 v127, v127, v236
    v_lshlrev_b32 v3, 16, v233
    v_and_b32 v4, 0xffff0000, v233
    v_mul_f32 v126, v126, v3
    v_mul_f32 v127, v127, v4
    v_cvt_pk_bf16_f32 v21, v126, v127
    v_add_f32 v128, v128, v236
    v_add_f32 v129, v129, v236
    v_lshlrev_b32 v3, 16, v234
    v_and_b32 v4, 0xffff0000, v234
    v_mul_f32 v128, v128, v3
    v_mul_f32 v129, v129, v4
    v_cvt_pk_bf16_f32 v22, v128, v129
    v_add_f32 v130, v130, v236
    v_add_f32 v131, v131, v236
    v_lshlrev_b32 v3, 16, v235
    v_and_b32 v4, 0xffff0000, v235
    v_mul_f32 v130, v130, v3
    v_mul_f32 v131, v131, v4
    v_cvt_pk_bf16_f32 v23, v130, v131
    v_lshrrev_b32 v2, 4, v1
    v_and_b32 v2, 1, v2
    v_mul_u32_u24 v2, 24576, v2
    v_and_b32 v3, 15, v1
    v_lshrrev_b32 v4, 5, v1
    v_lshlrev_b32 v4, 4, v4
    v_add_u32 v3, v3, v4
    v_lshlrev_b32 v3, 4, v3
    v_add_u32 v2, v2, v3
    s_mul_i32 s40, s32, 98304
    s_lshr_b32 s41, s34, 1
    s_mul_i32 s41, s41, 49152
    s_add_u32 s40, s40, s41
    s_mul_i32 s41, s33, 3072
    s_add_u32 s40, s40, s41
    s_and_b32 s41, s34, 1
    s_lshl_b32 s41, s41, 9
    s_add_u32 s40, s40, s41
    s_add_u32 s40, s40, 11534336
    buffer_store_dwordx4 v[12:15], v2, s[8:11], s40 offen offset:0
    buffer_store_dwordx4 v[16:19], v2, s[8:11], s40 offen offset:1024
    buffer_store_dwordx4 v[20:23], v2, s[8:11], s40 offen offset:2048
    s_endpgm
k2_kernel_conv:
    s_load_dwordx2 s[4:5], s[0:1], 32
    s_load_dwordx2 s[8:9], s[0:1], 104
    s_load_dwordx2 s[12:13], s[0:1], 40
    s_mov_b32 s6, 2621440
    s_mov_b32 s7, 0x20000
    s_mov_b32 s10, 15007744
    s_mov_b32 s11, 0x20000
    s_mov_b32 s14, 1280
    s_mov_b32 s15, 0x20000
    v_lshrrev_b32 v3, 6, v0
    v_and_b32 v1, 63, v0
    v_readfirstlane_b32 s34, v3
    s_sub_u32 s32, s2, 256
    v_lshlrev_b32 v2, 4, v0
    v_subrev_u32 v47, 16, v2
    s_waitcnt lgkmcnt(0)
    s_add_u32 s35, s32, 0
    s_min_u32 s35, s35, 639
    s_lshl_b32 s40, s35, 12
    buffer_load_dwordx4 v[12:15], v2, s[4:7], s40 offen
    buffer_load_dwordx4 v[8:11], v47, s[4:7], s40 offen
    s_add_u32 s40, s40, 6291456
    buffer_load_dwordx4 v[32:35], v2, s[8:11], s40 offen
    s_lshl_b32 s40, s35, 1
    v_mov_b32 v3, 0
    buffer_load_ushort v44, v3, s[12:15], s40 offen
    s_add_u32 s35, s32, 256
    s_min_u32 s35, s35, 639
    s_lshl_b32 s40, s35, 12
    buffer_load_dwordx4 v[20:23], v2, s[4:7], s40 offen
    buffer_load_dwordx4 v[16:19], v47, s[4:7], s40 offen
    s_add_u32 s40, s40, 6291456
    buffer_load_dwordx4 v[36:39], v2, s[8:11], s40 offen
    s_lshl_b32 s40, s35, 1
    v_mov_b32 v3, 0
    buffer_load_ushort v45, v3, s[12:15], s40 offen
    s_add_u32 s35, s32, 512
    s_min_u32 s35, s35, 639
    s_lshl_b32 s40, s35, 12
    buffer_load_dwordx4 v[28:31], v2, s[4:7], s40 offen
    buffer_load_dwordx4 v[24:27], v47, s[4:7], s40 offen
    s_add_u32 s40, s40, 6291456
    buffer_load_dwordx4 v[40:43], v2, s[8:11], s40 offen
    s_lshl_b32 s40, s35, 1
    v_mov_b32 v3, 0
    buffer_load_ushort v46, v3, s[12:15], s40 offen
    v_mov_b32 v48, 0
    v_mov_b32 v49, 0
    v_mov_b32 v50, 0
    v_mov_b32 v51, 0
    v_lshrrev_b32 v3, 3, v0
    v_mul_u32_u24 v3, 4416, v3
    v_and_b32 v4, 7, v0
    v_lshlrev_b32 v4, 4, v4
    v_add_u32 v3, v3, v4
    v_cmp_gt_u32 vcc, 64, v0
    s_nop 0
    s_and_saveexec_b64 s[50:51], vcc
    s_cbranch_execz c_z_6
    ds_write_b128 v3, v[48:51] offset:0
    v_cmp_gt_u32 vcc, 8, v0
    s_nop 0
    s_and_b64 exec, exec, vcc
    ds_write_b128 v2, v[48:51] offset:35328
c_z_6:
    s_mov_b64 exec, s[50:51]
    s_waitcnt lgkmcnt(0)
    s_barrier
    v_add_u32 v52, 112, v2
    v_lshrrev_b32 v3, 3, v0
    v_mul_u32_u24 v3, 144, v3
    v_and_b32 v4, 7, v0
    v_lshlrev_b32 v4, 4, v4
    v_add_u32 v53, v3, v4
    v_add_u32 v53, 35472, v53
    v_and_b32 v3, 7, v1
    v_mul_u32_u24 v3, 4416, v3
    v_and_b32 v4, 31, v1
    v_lshrrev_b32 v4, 3, v4
    v_lshrrev_b32 v5, 5, v1
    v_sub_u32 v4, v4, v5
    v_lshlrev_b32 v4, 4, v4
    v_add_u32 v3, v3, v4
    s_lshl_b32 s40, s34, 10
    s_add_u32 s40, s40, 16
    v_add_u32 v54, s40, v3
    v_and_b32 v3, 31, v1
    s_lshl_b32 s40, s34, 3
    v_subrev_u32 v3, s40, v3
    v_max_i32 v3, -1, v3
    v_add_u32 v3, 1, v3
    v_mul_u32_u24 v3, 144, v3
    v_lshrrev_b32 v4, 5, v1
    v_lshlrev_b32 v4, 4, v4
    v_add_u32 v55, v3, v4
    v_and_b32 v3, 31, v1
    v_cmp_ne_u32 vcc, 0, v3
    s_nop 1
    v_cndmask_b32 v56, 0, -1, vcc
    v_and_b32 v3, 31, v1
    v_lshrrev_b32 v4, 5, v1
    v_lshlrev_b32 v4, 3, v4
    v_add_u32 v4, 7, v4
    v_sub_u32 v4, v4, v3
    v_cmp_eq_u32 vcc, 0, v4
    v_mov_b32 v5, 0xffff
    s_nop 0
    v_cndmask_b32 v60, 0, v5, vcc
    v_cmp_eq_u32 vcc, 1, v4
    v_mov_b32 v5, 0xffff0000
    s_nop 0
    v_cndmask_b32 v5, 0, v5, vcc
    v_or_b32 v60, v60, v5
    v_cmp_eq_u32 vcc, 2, v4
    v_mov_b32 v5, 0xffff
    s_nop 0
    v_cndmask_b32 v61, 0, v5, vcc
    v_cmp_eq_u32 vcc, 3, v4
    v_mov_b32 v5, 0xffff0000
    s_nop 0
    v_cndmask_b32 v5, 0, v5, vcc
    v_or_b32 v61, v61, v5
    v_cmp_eq_u32 vcc, 4, v4
    v_mov_b32 v5, 0xffff
    s_nop 0
    v_cndmask_b32 v62, 0, v5, vcc
    v_cmp_eq_u32 vcc, 5, v4
    v_mov_b32 v5, 0xffff0000
    s_nop 0
    v_cndmask_b32 v5, 0, v5, vcc
    v_or_b32 v62, v62, v5
    v_cmp_eq_u32 vcc, 6, v4
    v_mov_b32 v5, 0xffff
    s_nop 0
    v_cndmask_b32 v63, 0, v5, vcc
    v_cmp_eq_u32 vcc, 7, v4
    v_mov_b32 v5, 0xffff0000
    s_nop 0
    v_cndmask_b32 v5, 0, v5, vcc
    v_or_b32 v63, v63, v5
    v_cmp_eq_u32 vcc, -16, v4
    v_mov_b32 v5, 0xffff
    s_nop 0
    v_cndmask_b32 v64, 0, v5, vcc
    v_cmp_eq_u32 vcc, -15, v4
    v_mov_b32 v5, 0xffff0000
    s_nop 0
    v_cndmask_b32 v5, 0, v5, vcc
    v_or_b32 v64, v64, v5
    v_cmp_eq_u32 vcc, -14, v4
    v_mov_b32 v5, 0xffff
    s_nop 0
    v_cndmask_b32 v65, 0, v5, vcc
    v_cmp_eq_u32 vcc, -13, v4
    v_mov_b32 v5, 0xffff0000
    s_nop 0
    v_cndmask_b32 v5, 0, v5, vcc
    v_or_b32 v65, v65, v5
    v_cmp_eq_u32 vcc, -12, v4
    v_mov_b32 v5, 0xffff
    s_nop 0
    v_cndmask_b32 v66, 0, v5, vcc
    v_cmp_eq_u32 vcc, -11, v4
    v_mov_b32 v5, 0xffff0000
    s_nop 0
    v_cndmask_b32 v5, 0, v5, vcc
    v_or_b32 v66, v66, v5
    v_cmp_eq_u32 vcc, -10, v4
    v_mov_b32 v5, 0xffff
    s_nop 0
    v_cndmask_b32 v67, 0, v5, vcc
    v_cmp_eq_u32 vcc, -9, v4
    v_mov_b32 v5, 0xffff0000
    s_nop 0
    v_cndmask_b32 v5, 0, v5, vcc
    v_or_b32 v67, v67, v5
    v_and_b32 v3, 31, v1
    v_mul_u32_u24 v3, 272, v3
    v_lshrrev_b32 v4, 5, v1
    v_lshlrev_b32 v4, 4, v4
    v_add_u32 v3, v3, v4
    s_mul_i32 s40, s34, 8704
    s_add_u32 s40, s40, 40128
    v_add_u32 v68, s40, v3
    v_lshrrev_b32 v3, 3, v0
    v_mul_u32_u24 v3, 272, v3
    v_and_b32 v4, 7, v0
    v_lshlrev_b32 v4, 5, v4
    v_add_u32 v69, v3, v4
    v_add_u32 v69, 40128, v69
    s_add_u32 s35, s32, 0
    s_waitcnt vmcnt(8)
    v_cmp_ne_u32 vcc, 0, v0
    s_nop 1
    v_cndmask_b32 v8, 0, v8, vcc
    v_cndmask_b32 v9, 0, v9, vcc
    v_cndmask_b32 v10, 0, v10, vcc
    v_cndmask_b32 v11, 0, v11, vcc
    v_alignbit_b32 v160, v9, v8, 16
    v_alignbit_b32 v161, v10, v9, 16
    v_alignbit_b32 v162, v11, v10, 16
    v_alignbit_b32 v163, v12, v11, 16
    v_alignbit_b32 v164, v13, v12, 16
    v_alignbit_b32 v165, v14, v13, 16
    v_alignbit_b32 v166, v15, v14, 16
    ds_write_b128 v52, v[160:163] offset:0
    v_mov_b32 v168, v9
    v_mov_b32 v169, v10
    v_mov_b32 v170, v11
    v_mov_b32 v171, v12
    ds_write_b128 v52, v[168:171] offset:4416
    s_nop 1
    v_mov_b32 v168, v161
    v_mov_b32 v169, v162
    v_mov_b32 v170, v163
    v_mov_b32 v171, v164
    ds_write_b128 v52, v[168:171] offset:8832
    s_nop 1
    ds_write_b128 v52, v[10:13] offset:13248
    ds_write_b128 v52, v[162:165] offset:17664
    v_mov_b32 v168, v11
    v_mov_b32 v169, v12
    v_mov_b32 v170, v13
    v_mov_b32 v171, v14
    ds_write_b128 v52, v[168:171] offset:22080
    s_nop 1
    v_mov_b32 v168, v163
    v_mov_b32 v169, v164
    v_mov_b32 v170, v165
    v_mov_b32 v171, v166
    ds_write_b128 v52, v[168:171] offset:26496
    s_nop 1
    ds_write_b128 v52, v[12:15] offset:30912
    ds_write_b128 v53, v[32:35]
    v_lshlrev_b32 v3, 16, v44
    v_or_b32 v3, v3, v44
    v_and_b32 v172, v60, v3
    v_and_b32 v173, v61, v3
    v_and_b32 v174, v62, v3
    v_and_b32 v175, v63, v3
    v_and_b32 v176, v64, v3
    v_and_b32 v177, v65, v3
    v_and_b32 v178, v66, v3
    v_and_b32 v179, v67, v3
    s_waitcnt lgkmcnt(0)
    s_barrier
    ds_read_b128 v[104:107], v55 offset:35328
    ds_read_b128 v[108:111], v55 offset:35360
    ds_read_b128 v[112:115], v55 offset:35392
    ds_read_b128 v[116:119], v55 offset:35424
    ds_read_b128 v[120:123], v54 offset:0
    ds_read_b128 v[124:127], v54 offset:32
    ds_read_b128 v[128:131], v54 offset:64
    ds_read_b128 v[132:135], v54 offset:96
    ds_read_b128 v[136:139], v54 offset:128
    ds_read_b128 v[140:143], v54 offset:160
    ds_read_b128 v[144:147], v54 offset:192
    ds_read_b128 v[148:151], v54 offset:224
    ds_read_b128 v[152:155], v54 offset:256
    ds_read_b128 v[156:159], v54 offset:288
    s_waitcnt lgkmcnt(4)
    v_mfma_f32_32x32x16_bf16 v[72:87], v[132:135], v[104:107], 0
    v_mfma_f32_32x32x16_bf16 v[88:103], v[140:143], v[104:107], 0
    s_cmp_lg_u32 s34, 0
    s_cbranch_scc1 c_dg_7
    v_mfma_f32_32x32x16_bf16 v[72:87], v[172:175], v[104:107], v[72:87]
c_dg_7:
    v_and_b32_dpp v104, v104, v56 wave_shr:1 row_mask:0xf bank_mask:0xf bound_ctrl:0
    v_and_b32_dpp v105, v105, v56 wave_shr:1 row_mask:0xf bank_mask:0xf bound_ctrl:0
    v_and_b32_dpp v106, v106, v56 wave_shr:1 row_mask:0xf bank_mask:0xf bound_ctrl:0
    v_and_b32_dpp v107, v107, v56 wave_shr:1 row_mask:0xf bank_mask:0xf bound_ctrl:0
    v_mfma_f32_32x32x16_bf16 v[72:87], v[128:131], v[108:111], v[72:87]
    v_mfma_f32_32x32x16_bf16 v[88:103], v[136:139], v[108:111], v[88:103]
    s_cmp_lg_u32 s34, 0
    s_cbranch_scc1 c_dg_8
    v_mfma_f32_32x32x16_bf16 v[72:87], v[176:179], v[108:111], v[72:87]
c_dg_8:
    v_and_b32_dpp v108, v108, v56 wave_shr:1 row_mask:0xf bank_mask:0xf bound_ctrl:0
    v_and_b32_dpp v109, v109, v56 wave_shr:1 row_mask:0xf bank_mask:0xf bound_ctrl:0
    v_and_b32_dpp v110, v110, v56 wave_shr:1 row_mask:0xf bank_mask:0xf bound_ctrl:0
    v_and_b32_dpp v111, v111, v56 wave_shr:1 row_mask:0xf bank_mask:0xf bound_ctrl:0
    v_mfma_f32_32x32x16_bf16 v[72:87], v[124:127], v[112:115], v[72:87]
    v_mfma_f32_32x32x16_bf16 v[88:103], v[132:135], v[112:115], v[88:103]
    s_cmp_lg_u32 s34, 0
    s_cbranch_scc1 c_dg_9
    v_mfma_f32_32x32x16_bf16 v[88:103], v[172:175], v[112:115], v[88:103]
c_dg_9:
    v_and_b32_dpp v112, v112, v56 wave_shr:1 row_mask:0xf bank_mask:0xf bound_ctrl:0
    v_and_b32_dpp v113, v113, v56 wave_shr:1 row_mask:0xf bank_mask:0xf bound_ctrl:0
    v_and_b32_dpp v114, v114, v56 wave_shr:1 row_mask:0xf bank_mask:0xf bound_ctrl:0
    v_and_b32_dpp v115, v115, v56 wave_shr:1 row_mask:0xf bank_mask:0xf bound_ctrl:0
    v_mfma_f32_32x32x16_bf16 v[72:87], v[120:123], v[116:119], v[72:87]
    v_mfma_f32_32x32x16_bf16 v[88:103], v[128:131], v[116:119], v[88:103]
    s_cmp_lg_u32 s34, 0
    s_cbranch_scc1 c_dg_10
    v_mfma_f32_32x32x16_bf16 v[88:103], v[176:179], v[116:119], v[88:103]
c_dg_10:
    v_and_b32_dpp v116, v116, v56 wave_shr:1 row_mask:0xf bank_mask:0xf bound_ctrl:0
    v_and_b32_dpp v117, v117, v56 wave_shr:1 row_mask:0xf bank_mask:0xf bound_ctrl:0
    v_and_b32_dpp v118, v118, v56 wave_shr:1 row_mask:0xf bank_mask:0xf bound_ctrl:0
    v_and_b32_dpp v119, v119, v56 wave_shr:1 row_mask:0xf bank_mask:0xf bound_ctrl:0
    ds_read_b128 v[120:123], v54 offset:320
    ds_read_b128 v[124:127], v54 offset:352
    ds_read_b128 v[128:131], v54 offset:384
    ds_read_b128 v[132:135], v54 offset:416
    s_waitcnt lgkmcnt(4)
    v_mfma_f32_32x32x16_bf16 v[72:87], v[148:151], v[104:107], v[72:87]
    v_mfma_f32_32x32x16_bf16 v[88:103], v[156:159], v[104:107], v[88:103]
    v_and_b32_dpp v104, v104, v56 wave_shr:1 row_mask:0xf bank_mask:0xf bound_ctrl:0
    v_and_b32_dpp v105, v105, v56 wave_shr:1 row_mask:0xf bank_mask:0xf bound_ctrl:0
    v_and_b32_dpp v106, v106, v56 wave_shr:1 row_mask:0xf bank_mask:0xf bound_ctrl:0
    v_and_b32_dpp v107, v107, v56 wave_shr:1 row_mask:0xf bank_mask:0xf bound_ctrl:0
    v_mfma_f32_32x32x16_bf16 v[72:87], v[144:147], v[108:111], v[72:87]
    v_mfma_f32_32x32x16_bf16 v[88:103], v[152:155], v[108:111], v[88:103]
    v_and_b32_dpp v108, v108, v56 wave_shr:1 row_mask:0xf bank_mask:0xf bound_ctrl:0
    v_and_b32_dpp v109, v109, v56 wave_shr:1 row_mask:0xf bank_mask:0xf bound_ctrl:0
    v_and_b32_dpp v110, v110, v56 wave_shr:1 row_mask:0xf bank_mask:0xf bound_ctrl:0
    v_and_b32_dpp v111, v111, v56 wave_shr:1 row_mask:0xf bank_mask:0xf bound_ctrl:0
    v_mfma_f32_32x32x16_bf16 v[72:87], v[140:143], v[112:115], v[72:87]
    v_mfma_f32_32x32x16_bf16 v[88:103], v[148:151], v[112:115], v[88:103]
    v_and_b32_dpp v112, v112, v56 wave_shr:1 row_mask:0xf bank_mask:0xf bound_ctrl:0
    v_and_b32_dpp v113, v113, v56 wave_shr:1 row_mask:0xf bank_mask:0xf bound_ctrl:0
    v_and_b32_dpp v114, v114, v56 wave_shr:1 row_mask:0xf bank_mask:0xf bound_ctrl:0
    v_and_b32_dpp v115, v115, v56 wave_shr:1 row_mask:0xf bank_mask:0xf bound_ctrl:0
    v_mfma_f32_32x32x16_bf16 v[72:87], v[136:139], v[116:119], v[72:87]
    v_mfma_f32_32x32x16_bf16 v[88:103], v[144:147], v[116:119], v[88:103]
    v_and_b32_dpp v116, v116, v56 wave_shr:1 row_mask:0xf bank_mask:0xf bound_ctrl:0
    v_and_b32_dpp v117, v117, v56 wave_shr:1 row_mask:0xf bank_mask:0xf bound_ctrl:0
    v_and_b32_dpp v118, v118, v56 wave_shr:1 row_mask:0xf bank_mask:0xf bound_ctrl:0
    v_and_b32_dpp v119, v119, v56 wave_shr:1 row_mask:0xf bank_mask:0xf bound_ctrl:0
    ds_read_b128 v[136:139], v54 offset:448
    ds_read_b128 v[140:143], v54 offset:480
    ds_read_b128 v[144:147], v54 offset:512
    ds_read_b128 v[148:151], v54 offset:544
    s_waitcnt lgkmcnt(4)
    v_mfma_f32_32x32x16_bf16 v[72:87], v[124:127], v[104:107], v[72:87]
    v_mfma_f32_32x32x16_bf16 v[88:103], v[132:135], v[104:107], v[88:103]
    v_and_b32_dpp v104, v104, v56 wave_shr:1 row_mask:0xf bank_mask:0xf bound_ctrl:0
    v_and_b32_dpp v105, v105, v56 wave_shr:1 row_mask:0xf bank_mask:0xf bound_ctrl:0
    v_and_b32_dpp v106, v106, v56 wave_shr:1 row_mask:0xf bank_mask:0xf bound_ctrl:0
    v_and_b32_dpp v107, v107, v56 wave_shr:1 row_mask:0xf bank_mask:0xf bound_ctrl:0
    v_mfma_f32_32x32x16_bf16 v[72:87], v[120:123], v[108:111], v[72:87]
    v_mfma_f32_32x32x16_bf16 v[88:103], v[128:131], v[108:111], v[88:103]
    v_and_b32_dpp v108, v108, v56 wave_shr:1 row_mask:0xf bank_mask:0xf bound_ctrl:0
    v_and_b32_dpp v109, v109, v56 wave_shr:1 row_mask:0xf bank_mask:0xf bound_ctrl:0
    v_and_b32_dpp v110, v110, v56 wave_shr:1 row_mask:0xf bank_mask:0xf bound_ctrl:0
    v_and_b32_dpp v111, v111, v56 wave_shr:1 row_mask:0xf bank_mask:0xf bound_ctrl:0
    v_mfma_f32_32x32x16_bf16 v[72:87], v[156:159], v[112:115], v[72:87]
    v_mfma_f32_32x32x16_bf16 v[88:103], v[124:127], v[112:115], v[88:103]
    v_and_b32_dpp v112, v112, v56 wave_shr:1 row_mask:0xf bank_mask:0xf bound_ctrl:0
    v_and_b32_dpp v113, v113, v56 wave_shr:1 row_mask:0xf bank_mask:0xf bound_ctrl:0
    v_and_b32_dpp v114, v114, v56 wave_shr:1 row_mask:0xf bank_mask:0xf bound_ctrl:0
    v_and_b32_dpp v115, v115, v56 wave_shr:1 row_mask:0xf bank_mask:0xf bound_ctrl:0
    v_mfma_f32_32x32x16_bf16 v[72:87], v[152:155], v[116:119], v[72:87]
    v_mfma_f32_32x32x16_bf16 v[88:103], v[120:123], v[116:119], v[88:103]
    v_and_b32_dpp v116, v116, v56 wave_shr:1 row_mask:0xf bank_mask:0xf bound_ctrl:0
    v_and_b32_dpp v117, v117, v56 wave_shr:1 row_mask:0xf bank_mask:0xf bound_ctrl:0
    v_and_b32_dpp v118, v118, v56 wave_shr:1 row_mask:0xf bank_mask:0xf bound_ctrl:0
    v_and_b32_dpp v119, v119, v56 wave_shr:1 row_mask:0xf bank_mask:0xf bound_ctrl:0
    ds_read_b128 v[152:155], v54 offset:576
    ds_read_b128 v[156:159], v54 offset:608
    ds_read_b128 v[120:123], v54 offset:640
    ds_read_b128 v[124:127], v54 offset:672
    s_waitcnt lgkmcnt(4)
    v_mfma_f32_32x32x16_bf16 v[72:87], v[140:143], v[104:107], v[72:87]
    v_mfma_f32_32x32x16_bf16 v[88:103], v[148:151], v[104:107], v[88:103]
    v_and_b32_dpp v104, v104, v56 wave_shr:1 row_mask:0xf bank_mask:0xf bound_ctrl:0
    v_and_b32_dpp v105, v105, v56 wave_shr:1 row_mask:0xf bank_mask:0xf bound_ctrl:0
    v_and_b32_dpp v106, v106, v56 wave_shr:1 row_mask:0xf bank_mask:0xf bound_ctrl:0
    v_and_b32_dpp v107, v107, v56 wave_shr:1 row_mask:0xf bank_mask:0xf bound_ctrl:0
    v_mfma_f32_32x32x16_bf16 v[72:87], v[136:139], v[108:111], v[72:87]
    v_mfma_f32_32x32x16_bf16 v[88:103], v[144:147], v[108:111], v[88:103]
    v_and_b32_dpp v108, v108, v56 wave_shr:1 row_mask:0xf bank_mask:0xf bound_ctrl:0
    v_and_b32_dpp v109, v109, v56 wave_shr:1 row_mask:0xf bank_mask:0xf bound_ctrl:0
    v_and_b32_dpp v110, v110, v56 wave_shr:1 row_mask:0xf bank_mask:0xf bound_ctrl:0
    v_and_b32_dpp v111, v111, v56 wave_shr:1 row_mask:0xf bank_mask:0xf bound_ctrl:0
    v_mfma_f32_32x32x16_bf16 v[72:87], v[132:135], v[112:115], v[72:87]
    v_mfma_f32_32x32x16_bf16 v[88:103], v[140:143], v[112:115], v[88:103]
    v_and_b32_dpp v112, v112, v56 wave_shr:1 row_mask:0xf bank_mask:0xf bound_ctrl:0
    v_and_b32_dpp v113, v113, v56 wave_shr:1 row_mask:0xf bank_mask:0xf bound_ctrl:0
    v_and_b32_dpp v114, v114, v56 wave_shr:1 row_mask:0xf bank_mask:0xf bound_ctrl:0
    v_and_b32_dpp v115, v115, v56 wave_shr:1 row_mask:0xf bank_mask:0xf bound_ctrl:0
    v_mfma_f32_32x32x16_bf16 v[72:87], v[128:131], v[116:119], v[72:87]
    v_mfma_f32_32x32x16_bf16 v[88:103], v[136:139], v[116:119], v[88:103]
    v_and_b32_dpp v116, v116, v56 wave_shr:1 row_mask:0xf bank_mask:0xf bound_ctrl:0
    v_and_b32_dpp v117, v117, v56 wave_shr:1 row_mask:0xf bank_mask:0xf bound_ctrl:0
    v_and_b32_dpp v118, v118, v56 wave_shr:1 row_mask:0xf bank_mask:0xf bound_ctrl:0
    v_and_b32_dpp v119, v119, v56 wave_shr:1 row_mask:0xf bank_mask:0xf bound_ctrl:0
    ds_read_b128 v[128:131], v54 offset:704
    ds_read_b128 v[132:135], v54 offset:736
    ds_read_b128 v[136:139], v54 offset:768
    ds_read_b128 v[140:143], v54 offset:800
    s_waitcnt lgkmcnt(4)
    v_mfma_f32_32x32x16_bf16 v[72:87], v[156:159], v[104:107], v[72:87]
    v_mfma_f32_32x32x16_bf16 v[88:103], v[124:127], v[104:107], v[88:103]
    v_and_b32_dpp v104, v104, v56 wave_shr:1 row_mask:0xf bank_mask:0xf bound_ctrl:0
    v_and_b32_dpp v105, v105, v56 wave_shr:1 row_mask:0xf bank_mask:0xf bound_ctrl:0
    v_and_b32_dpp v106, v106, v56 wave_shr:1 row_mask:0xf bank_mask:0xf bound_ctrl:0
    v_and_b32_dpp v107, v107, v56 wave_shr:1 row_mask:0xf bank_mask:0xf bound_ctrl:0
    v_mfma_f32_32x32x16_bf16 v[72:87], v[152:155], v[108:111], v[72:87]
    v_mfma_f32_32x32x16_bf16 v[88:103], v[120:123], v[108:111], v[88:103]
    v_and_b32_dpp v108, v108, v56 wave_shr:1 row_mask:0xf bank_mask:0xf bound_ctrl:0
    v_and_b32_dpp v109, v109, v56 wave_shr:1 row_mask:0xf bank_mask:0xf bound_ctrl:0
    v_and_b32_dpp v110, v110, v56 wave_shr:1 row_mask:0xf bank_mask:0xf bound_ctrl:0
    v_and_b32_dpp v111, v111, v56 wave_shr:1 row_mask:0xf bank_mask:0xf bound_ctrl:0
    v_mfma_f32_32x32x16_bf16 v[72:87], v[148:151], v[112:115], v[72:87]
    v_mfma_f32_32x32x16_bf16 v[88:103], v[156:159], v[112:115], v[88:103]
    v_and_b32_dpp v112, v112, v56 wave_shr:1 row_mask:0xf bank_mask:0xf bound_ctrl:0
    v_and_b32_dpp v113, v113, v56 wave_shr:1 row_mask:0xf bank_mask:0xf bound_ctrl:0
    v_and_b32_dpp v114, v114, v56 wave_shr:1 row_mask:0xf bank_mask:0xf bound_ctrl:0
    v_and_b32_dpp v115, v115, v56 wave_shr:1 row_mask:0xf bank_mask:0xf bound_ctrl:0
    v_mfma_f32_32x32x16_bf16 v[72:87], v[144:147], v[116:119], v[72:87]
    v_mfma_f32_32x32x16_bf16 v[88:103], v[152:155], v[116:119], v[88:103]
    v_and_b32_dpp v116, v116, v56 wave_shr:1 row_mask:0xf bank_mask:0xf bound_ctrl:0
    v_and_b32_dpp v117, v117, v56 wave_shr:1 row_mask:0xf bank_mask:0xf bound_ctrl:0
    v_and_b32_dpp v118, v118, v56 wave_shr:1 row_mask:0xf bank_mask:0xf bound_ctrl:0
    v_and_b32_dpp v119, v119, v56 wave_shr:1 row_mask:0xf bank_mask:0xf bound_ctrl:0
    ds_read_b128 v[144:147], v54 offset:832
    ds_read_b128 v[148:151], v54 offset:864
    ds_read_b128 v[152:155], v54 offset:896
    ds_read_b128 v[156:159], v54 offset:928
    s_waitcnt lgkmcnt(4)
    v_mfma_f32_32x32x16_bf16 v[72:87], v[132:135], v[104:107], v[72:87]
    v_mfma_f32_32x32x16_bf16 v[88:103], v[140:143], v[104:107], v[88:103]
    v_and_b32_dpp v104, v104, v56 wave_shr:1 row_mask:0xf bank_mask:0xf bound_ctrl:0
    v_and_b32_dpp v105, v105, v56 wave_shr:1 row_mask:0xf bank_mask:0xf bound_ctrl:0
    v_and_b32_dpp v106, v106, v56 wave_shr:1 row_mask:0xf bank_mask:0xf bound_ctrl:0
    v_and_b32_dpp v107, v107, v56 wave_shr:1 row_mask:0xf bank_mask:0xf bound_ctrl:0
    v_mfma_f32_32x32x16_bf16 v[72:87], v[128:131], v[108:111], v[72:87]
    v_mfma_f32_32x32x16_bf16 v[88:103], v[136:139], v[108:111], v[88:103]
    v_and_b32_dpp v108, v108, v56 wave_shr:1 row_mask:0xf bank_mask:0xf bound_ctrl:0
    v_and_b32_dpp v109, v109, v56 wave_shr:1 row_mask:0xf bank_mask:0xf bound_ctrl:0
    v_and_b32_dpp v110, v110, v56 wave_shr:1 row_mask:0xf bank_mask:0xf bound_ctrl:0
    v_and_b32_dpp v111, v111, v56 wave_shr:1 row_mask:0xf bank_mask:0xf bound_ctrl:0
    v_mfma_f32_32x32x16_bf16 v[72:87], v[124:127], v[112:115], v[72:87]
    v_mfma_f32_32x32x16_bf16 v[88:103], v[132:135], v[112:115], v[88:103]
    v_and_b32_dpp v112, v112, v56 wave_shr:1 row_mask:0xf bank_mask:0xf bound_ctrl:0
    v_and_b32_dpp v113, v113, v56 wave_shr:1 row_mask:0xf bank_mask:0xf bound_ctrl:0
    v_and_b32_dpp v114, v114, v56 wave_shr:1 row_mask:0xf bank_mask:0xf bound_ctrl:0
    v_and_b32_dpp v115, v115, v56 wave_shr:1 row_mask:0xf bank_mask:0xf bound_ctrl:0
    v_mfma_f32_32x32x16_bf16 v[72:87], v[120:123], v[116:119], v[72:87]
    v_mfma_f32_32x32x16_bf16 v[88:103], v[128:131], v[116:119], v[88:103]
    v_and_b32_dpp v116, v116, v56 wave_shr:1 row_mask:0xf bank_mask:0xf bound_ctrl:0
    v_and_b32_dpp v117, v117, v56 wave_shr:1 row_mask:0xf bank_mask:0xf bound_ctrl:0
    v_and_b32_dpp v118, v118, v56 wave_shr:1 row_mask:0xf bank_mask:0xf bound_ctrl:0
    v_and_b32_dpp v119, v119, v56 wave_shr:1 row_mask:0xf bank_mask:0xf bound_ctrl:0
    ds_read_b128 v[120:123], v54 offset:960
    ds_read_b128 v[124:127], v54 offset:992
    ds_read_b128 v[128:131], v54 offset:1024
    ds_read_b128 v[132:135], v54 offset:1056
    s_waitcnt lgkmcnt(4)
    v_mfma_f32_32x32x16_bf16 v[72:87], v[148:151], v[104:107], v[72:87]
    v_mfma_f32_32x32x16_bf16 v[88:103], v[156:159], v[104:107], v[88:103]
    v_and_b32_dpp v104, v104, v56 wave_shr:1 row_mask:0xf bank_mask:0xf bound_ctrl:0
    v_and_b32_dpp v105, v105, v56 wave_shr:1 row_mask:0xf bank_mask:0xf bound_ctrl:0
    v_and_b32_dpp v106, v106, v56 wave_shr:1 row_mask:0xf bank_mask:0xf bound_ctrl:0
    v_and_b32_dpp v107, v107, v56 wave_shr:1 row_mask:0xf bank_mask:0xf bound_ctrl:0
    v_mfma_f32_32x32x16_bf16 v[72:87], v[144:147], v[108:111], v[72:87]
    v_mfma_f32_32x32x16_bf16 v[88:103], v[152:155], v[108:111], v[88:103]
    v_and_b32_dpp v108, v108, v56 wave_shr:1 row_mask:0xf bank_mask:0xf bound_ctrl:0
    v_and_b32_dpp v109, v109, v56 wave_shr:1 row_mask:0xf bank_mask:0xf bound_ctrl:0
    v_and_b32_dpp v110, v110, v56 wave_shr:1 row_mask:0xf bank_mask:0xf bound_ctrl:0
    v_and_b32_dpp v111, v111, v56 wave_shr:1 row_mask:0xf bank_mask:0xf bound_ctrl:0
    v_mfma_f32_32x32x16_bf16 v[72:87], v[140:143], v[112:115], v[72:87]
    v_mfma_f32_32x32x16_bf16 v[88:103], v[148:151], v[112:115], v[88:103]
    v_and_b32_dpp v112, v112, v56 wave_shr:1 row_mask:0xf bank_mask:0xf bound_ctrl:0
    v_and_b32_dpp v113, v113, v56 wave_shr:1 row_mask:0xf bank_mask:0xf bound_ctrl:0
    v_and_b32_dpp v114, v114, v56 wave_shr:1 row_mask:0xf bank_mask:0xf bound_ctrl:0
    v_and_b32_dpp v115, v115, v56 wave_shr:1 row_mask:0xf bank_mask:0xf bound_ctrl:0
    v_mfma_f32_32x32x16_bf16 v[72:87], v[136:139], v[116:119], v[72:87]
    v_mfma_f32_32x32x16_bf16 v[88:103], v[144:147], v[116:119], v[88:103]
    v_and_b32_dpp v116, v116, v56 wave_shr:1 row_mask:0xf bank_mask:0xf bound_ctrl:0
    v_and_b32_dpp v117, v117, v56 wave_shr:1 row_mask:0xf bank_mask:0xf bound_ctrl:0
    v_and_b32_dpp v118, v118, v56 wave_shr:1 row_mask:0xf bank_mask:0xf bound_ctrl:0
    v_and_b32_dpp v119, v119, v56 wave_shr:1 row_mask:0xf bank_mask:0xf bound_ctrl:0
    s_waitcnt lgkmcnt(0)
    v_mfma_f32_32x32x16_bf16 v[72:87], v[124:127], v[104:107], v[72:87]
    v_mfma_f32_32x32x16_bf16 v[88:103], v[132:135], v[104:107], v[88:103]
    v_mfma_f32_32x32x16_bf16 v[72:87], v[120:123], v[108:111], v[72:87]
    v_mfma_f32_32x32x16_bf16 v[88:103], v[128:131], v[108:111], v[88:103]
    v_mfma_f32_32x32x16_bf16 v[72:87], v[156:159], v[112:115], v[72:87]
    v_mfma_f32_32x32x16_bf16 v[88:103], v[124:127], v[112:115], v[88:103]
    v_mfma_f32_32x32x16_bf16 v[72:87], v[152:155], v[116:119], v[72:87]
    v_mfma_f32_32x32x16_bf16 v[88:103], v[120:123], v[116:119], v[88:103]
    s_nop 10
    ds_write_b128 v68, v[72:75] offset:0
    ds_write_b128 v68, v[76:79] offset:32
    ds_write_b128 v68, v[80:83] offset:64
    ds_write_b128 v68, v[84:87] offset:96
    ds_write_b128 v68, v[88:91] offset:128
    ds_write_b128 v68, v[92:95] offset:160
    ds_write_b128 v68, v[96:99] offset:192
    ds_write_b128 v68, v[100:103] offset:224
    s_waitcnt lgkmcnt(0)
    s_barrier
    ds_read_b128 v[120:123], v69 offset:0
    ds_read_b128 v[124:127], v69 offset:16
    ds_read_b128 v[128:131], v69 offset:8704
    ds_read_b128 v[132:135], v69 offset:8720
    ds_read_b128 v[136:139], v69 offset:17408
    ds_read_b128 v[140:143], v69 offset:17424
    ds_read_b128 v[144:147], v69 offset:26112
    ds_read_b128 v[148:151], v69 offset:26128
    s_waitcnt lgkmcnt(0)
    v_pk_add_f32 v[120:121], v[120:121], v[128:129]
    v_pk_add_f32 v[122:123], v[122:123], v[130:131]
    v_pk_add_f32 v[124:125], v[124:125], v[132:133]
    v_pk_add_f32 v[126:127], v[126:127], v[134:135]
    v_pk_add_f32 v[120:121], v[120:121], v[136:137]
    v_pk_add_f32 v[122:123], v[122:123], v[138:139]
    v_pk_add_f32 v[124:125], v[124:125], v[140:141]
    v_pk_add_f32 v[126:127], v[126:127], v[142:143]
    v_pk_add_f32 v[120:121], v[120:121], v[144:145]
    v_pk_add_f32 v[122:123], v[122:123], v[146:147]
    v_pk_add_f32 v[124:125], v[124:125], v[148:149]
    v_pk_add_f32 v[126:127], v[126:127], v[150:151]
    v_cvt_pk_bf16_f32 v168, v120, v121
    v_cvt_pk_bf16_f32 v169, v122, v123
    v_cvt_pk_bf16_f32 v170, v124, v125
    v_cvt_pk_bf16_f32 v171, v126, v127
    s_lshl_b32 s40, s35, 12
    s_add_u32 s40, s40, 8912896
    buffer_store_dwordx4 v[168:171], v2, s[8:11], s40 offen
    s_nop 1
    s_add_u32 s35, s32, 256
    s_waitcnt vmcnt(5)
    v_cmp_ne_u32 vcc, 0, v0
    s_nop 1
    v_cndmask_b32 v16, 0, v16, vcc
    v_cndmask_b32 v17, 0, v17, vcc
    v_cndmask_b32 v18, 0, v18, vcc
    v_cndmask_b32 v19, 0, v19, vcc
    v_alignbit_b32 v160, v17, v16, 16
    v_alignbit_b32 v161, v18, v17, 16
    v_alignbit_b32 v162, v19, v18, 16
    v_alignbit_b32 v163, v20, v19, 16
    v_alignbit_b32 v164, v21, v20, 16
    v_alignbit_b32 v165, v22, v21, 16
    v_alignbit_b32 v166, v23, v22, 16
    ds_write_b128 v52, v[160:163] offset:0
    v_mov_b32 v168, v17
    v_mov_b32 v169, v18
    v_mov_b32 v170, v19
    v_mov_b32 v171, v20
    ds_write_b128 v52, v[168:171] offset:4416
    s_nop 1
    v_mov_b32 v168, v161
    v_mov_b32 v169, v162
    v_mov_b32 v170, v163
    v_mov_b32 v171, v164
    ds_write_b128 v52, v[168:171] offset:8832
    s_nop 1
    ds_write_b128 v52, v[18:21] offset:13248
    ds_write_b128 v52, v[162:165] offset:17664
    v_mov_b32 v168, v19
    v_mov_b32 v169, v20
    v_mov_b32 v170, v21
    v_mov_b32 v171, v22
    ds_write_b128 v52, v[168:171] offset:22080
    s_nop 1
    v_mov_b32 v168, v163
    v_mov_b32 v169, v164
    v_mov_b32 v170, v165
    v_mov_b32 v171, v166
    ds_write_b128 v52, v[168:171] offset:26496
    s_nop 1
    ds_write_b128 v52, v[20:23] offset:30912
    ds_write_b128 v53, v[36:39]
    v_lshlrev_b32 v3, 16, v45
    v_or_b32 v3, v3, v45
    v_and_b32 v172, v60, v3
    v_and_b32 v173, v61, v3
    v_and_b32 v174, v62, v3
    v_and_b32 v175, v63, v3
    v_and_b32 v176, v64, v3
    v_and_b32 v177, v65, v3
    v_and_b32 v178, v66, v3
    v_and_b32 v179, v67, v3
    s_waitcnt lgkmcnt(0)
    s_barrier
    ds_read_b128 v[104:107], v55 offset:35328
    ds_read_b128 v[108:111], v55 offset:35360
    ds_read_b128 v[112:115], v55 offset:35392
    ds_read_b128 v[116:119], v55 offset:35424
    ds_read_b128 v[120:123], v54 offset:0
    ds_read_b128 v[124:127], v54 offset:32
    ds_read_b128 v[128:131], v54 offset:64
    ds_read_b128 v[132:135], v54 offset:96
    ds_read_b128 v[136:139], v54 offset:128
    ds_read_b128 v[140:143], v54 offset:160
    ds_read_b128 v[144:147], v54 offset:192
    ds_read_b128 v[148:151], v54 offset:224
    ds_read_b128 v[152:155], v54 offset:256
    ds_read_b128 v[156:159], v54 offset:288
    s_waitcnt lgkmcnt(4)
    v_mfma_f32_32x32x16_bf16 v[72:87], v[132:135], v[104:107], 0
    v_mfma_f32_32x32x16_bf16 v[88:103], v[140:143], v[104:107], 0
    s_cmp_lg_u32 s34, 0
    s_cbranch_scc1 c_dg_11
    v_mfma_f32_32x32x16_bf16 v[72:87], v[172:175], v[104:107], v[72:87]
c_dg_11:
    v_and_b32_dpp v104, v104, v56 wave_shr:1 row_mask:0xf bank_mask:0xf bound_ctrl:0
    v_and_b32_dpp v105, v105, v56 wave_shr:1 row_mask:0xf bank_mask:0xf bound_ctrl:0
    v_and_b32_dpp v106, v106, v56 wave_shr:1 row_mask:0xf bank_mask:0xf bound_ctrl:0
    v_and_b32_dpp v107, v107, v56 wave_shr:1 row_mask:0xf bank_mask:0xf bound_ctrl:0
    v_mfma_f32_32x32x16_bf16 v[72:87], v[128:131], v[108:111], v[72:87]
    v_mfma_f32_32x32x16_bf16 v[88:103], v[136:139], v[108:111], v[88:103]
    s_cmp_lg_u32 s34, 0
    s_cbranch_scc1 c_dg_12
    v_mfma_f32_32x32x16_bf16 v[72:87], v[176:179], v[108:111], v[72:87]
c_dg_12:
    v_and_b32_dpp v108, v108, v56 wave_shr:1 row_mask:0xf bank_mask:0xf bound_ctrl:0
    v_and_b32_dpp v109, v109, v56 wave_shr:1 row_mask:0xf bank_mask:0xf bound_ctrl:0
    v_and_b32_dpp v110, v110, v56 wave_shr:1 row_mask:0xf bank_mask:0xf bound_ctrl:0
    v_and_b32_dpp v111, v111, v56 wave_shr:1 row_mask:0xf bank_mask:0xf bound_ctrl:0
    v_mfma_f32_32x32x16_bf16 v[72:87], v[124:127], v[112:115], v[72:87]
    v_mfma_f32_32x32x16_bf16 v[88:103], v[132:135], v[112:115], v[88:103]
    s_cmp_lg_u32 s34, 0
    s_cbranch_scc1 c_dg_13
    v_mfma_f32_32x32x16_bf16 v[88:103], v[172:175], v[112:115], v[88:103]
c_dg_13:
    v_and_b32_dpp v112, v112, v56 wave_shr:1 row_mask:0xf bank_mask:0xf bound_ctrl:0
    v_and_b32_dpp v113, v113, v56 wave_shr:1 row_mask:0xf bank_mask:0xf bound_ctrl:0
    v_and_b32_dpp v114, v114, v56 wave_shr:1 row_mask:0xf bank_mask:0xf bound_ctrl:0
    v_and_b32_dpp v115, v115, v56 wave_shr:1 row_mask:0xf bank_mask:0xf bound_ctrl:0
    v_mfma_f32_32x32x16_bf16 v[72:87], v[120:123], v[116:119], v[72:87]
    v_mfma_f32_32x32x16_bf16 v[88:103], v[128:131], v[116:119], v[88:103]
    s_cmp_lg_u32 s34, 0
    s_cbranch_scc1 c_dg_14
    v_mfma_f32_32x32x16_bf16 v[88:103], v[176:179], v[116:119], v[88:103]
c_dg_14:
    v_and_b32_dpp v116, v116, v56 wave_shr:1 row_mask:0xf bank_mask:0xf bound_ctrl:0
    v_and_b32_dpp v117, v117, v56 wave_shr:1 row_mask:0xf bank_mask:0xf bound_ctrl:0
    v_and_b32_dpp v118, v118, v56 wave_shr:1 row_mask:0xf bank_mask:0xf bound_ctrl:0
    v_and_b32_dpp v119, v119, v56 wave_shr:1 row_mask:0xf bank_mask:0xf bound_ctrl:0
    ds_read_b128 v[120:123], v54 offset:320
    ds_read_b128 v[124:127], v54 offset:352
    ds_read_b128 v[128:131], v54 offset:384
    ds_read_b128 v[132:135], v54 offset:416
    s_waitcnt lgkmcnt(4)
    v_mfma_f32_32x32x16_bf16 v[72:87], v[148:151], v[104:107], v[72:87]
    v_mfma_f32_32x32x16_bf16 v[88:103], v[156:159], v[104:107], v[88:103]
    v_and_b32_dpp v104, v104, v56 wave_shr:1 row_mask:0xf bank_mask:0xf bound_ctrl:0
    v_and_b32_dpp v105, v105, v56 wave_shr:1 row_mask:0xf bank_mask:0xf bound_ctrl:0
    v_and_b32_dpp v106, v106, v56 wave_shr:1 row_mask:0xf bank_mask:0xf bound_ctrl:0
    v_and_b32_dpp v107, v107, v56 wave_shr:1 row_mask:0xf bank_mask:0xf bound_ctrl:0
    v_mfma_f32_32x32x16_bf16 v[72:87], v[144:147], v[108:111], v[72:87]
    v_mfma_f32_32x32x16_bf16 v[88:103], v[152:155], v[108:111], v[88:103]
    v_and_b32_dpp v108, v108, v56 wave_shr:1 row_mask:0xf bank_mask:0xf bound_ctrl:0
    v_and_b32_dpp v109, v109, v56 wave_shr:1 row_mask:0xf bank_mask:0xf bound_ctrl:0
    v_and_b32_dpp v110, v110, v56 wave_shr:1 row_mask:0xf bank_mask:0xf bound_ctrl:0
    v_and_b32_dpp v111, v111, v56 wave_shr:1 row_mask:0xf bank_mask:0xf bound_ctrl:0
    v_mfma_f32_32x32x16_bf16 v[72:87], v[140:143], v[112:115], v[72:87]
    v_mfma_f32_32x32x16_bf16 v[88:103], v[148:151], v[112:115], v[88:103]
    v_and_b32_dpp v112, v112, v56 wave_shr:1 row_mask:0xf bank_mask:0xf bound_ctrl:0
    v_and_b32_dpp v113, v113, v56 wave_shr:1 row_mask:0xf bank_mask:0xf bound_ctrl:0
    v_and_b32_dpp v114, v114, v56 wave_shr:1 row_mask:0xf bank_mask:0xf bound_ctrl:0
    v_and_b32_dpp v115, v115, v56 wave_shr:1 row_mask:0xf bank_mask:0xf bound_ctrl:0
    v_mfma_f32_32x32x16_bf16 v[72:87], v[136:139], v[116:119], v[72:87]
    v_mfma_f32_32x32x16_bf16 v[88:103], v[144:147], v[116:119], v[88:103]
    v_and_b32_dpp v116, v116, v56 wave_shr:1 row_mask:0xf bank_mask:0xf bound_ctrl:0
    v_and_b32_dpp v117, v117, v56 wave_shr:1 row_mask:0xf bank_mask:0xf bound_ctrl:0
    v_and_b32_dpp v118, v118, v56 wave_shr:1 row_mask:0xf bank_mask:0xf bound_ctrl:0
    v_and_b32_dpp v119, v119, v56 wave_shr:1 row_mask:0xf bank_mask:0xf bound_ctrl:0
    ds_read_b128 v[136:139], v54 offset:448
    ds_read_b128 v[140:143], v54 offset:480
    ds_read_b128 v[144:147], v54 offset:512
    ds_read_b128 v[148:151], v54 offset:544
    s_waitcnt lgkmcnt(4)
    v_mfma_f32_32x32x16_bf16 v[72:87], v[124:127], v[104:107], v[72:87]
    v_mfma_f32_32x32x16_bf16 v[88:103], v[132:135], v[104:107], v[88:103]
    v_and_b32_dpp v104, v104, v56 wave_shr:1 row_mask:0xf bank_mask:0xf bound_ctrl:0
    v_and_b32_dpp v105, v105, v56 wave_shr:1 row_mask:0xf bank_mask:0xf bound_ctrl:0
    v_and_b32_dpp v106, v106, v56 wave_shr:1 row_mask:0xf bank_mask:0xf bound_ctrl:0
    v_and_b32_dpp v107, v107, v56 wave_shr:1 row_mask:0xf bank_mask:0xf bound_ctrl:0
    v_mfma_f32_32x32x16_bf16 v[72:87], v[120:123], v[108:111], v[72:87]
    v_mfma_f32_32x32x16_bf16 v[88:103], v[128:131], v[108:111], v[88:103]
    v_and_b32_dpp v108, v108, v56 wave_shr:1 row_mask:0xf bank_mask:0xf bound_ctrl:0
    v_and_b32_dpp v109, v109, v56 wave_shr:1 row_mask:0xf bank_mask:0xf bound_ctrl:0
    v_and_b32_dpp v110, v110, v56 wave_shr:1 row_mask:0xf bank_mask:0xf bound_ctrl:0
    v_and_b32_dpp v111, v111, v56 wave_shr:1 row_mask:0xf bank_mask:0xf bound_ctrl:0
    v_mfma_f32_32x32x16_bf16 v[72:87], v[156:159], v[112:115], v[72:87]
    v_mfma_f32_32x32x16_bf16 v[88:103], v[124:127], v[112:115], v[88:103]
    v_and_b32_dpp v112, v112, v56 wave_shr:1 row_mask:0xf bank_mask:0xf bound_ctrl:0
    v_and_b32_dpp v113, v113, v56 wave_shr:1 row_mask:0xf bank_mask:0xf bound_ctrl:0
    v_and_b32_dpp v114, v114, v56 wave_shr:1 row_mask:0xf bank_mask:0xf bound_ctrl:0
    v_and_b32_dpp v115, v115, v56 wave_shr:1 row_mask:0xf bank_mask:0xf bound_ctrl:0
    v_mfma_f32_32x32x16_bf16 v[72:87], v[152:155], v[116:119], v[72:87]
    v_mfma_f32_32x32x16_bf16 v[88:103], v[120:123], v[116:119], v[88:103]
    v_and_b32_dpp v116, v116, v56 wave_shr:1 row_mask:0xf bank_mask:0xf bound_ctrl:0
    v_and_b32_dpp v117, v117, v56 wave_shr:1 row_mask:0xf bank_mask:0xf bound_ctrl:0
    v_and_b32_dpp v118, v118, v56 wave_shr:1 row_mask:0xf bank_mask:0xf bound_ctrl:0
    v_and_b32_dpp v119, v119, v56 wave_shr:1 row_mask:0xf bank_mask:0xf bound_ctrl:0
    ds_read_b128 v[152:155], v54 offset:576
    ds_read_b128 v[156:159], v54 offset:608
    ds_read_b128 v[120:123], v54 offset:640
    ds_read_b128 v[124:127], v54 offset:672
    s_waitcnt lgkmcnt(4)
    v_mfma_f32_32x32x16_bf16 v[72:87], v[140:143], v[104:107], v[72:87]
    v_mfma_f32_32x32x16_bf16 v[88:103], v[148:151], v[104:107], v[88:103]
    v_and_b32_dpp v104, v104, v56 wave_shr:1 row_mask:0xf bank_mask:0xf bound_ctrl:0
    v_and_b32_dpp v105, v105, v56 wave_shr:1 row_mask:0xf bank_mask:0xf bound_ctrl:0
    v_and_b32_dpp v106, v106, v56 wave_shr:1 row_mask:0xf bank_mask:0xf bound_ctrl:0
    v_and_b32_dpp v107, v107, v56 wave_shr:1 row_mask:0xf bank_mask:0xf bound_ctrl:0
    v_mfma_f32_32x32x16_bf16 v[72:87], v[136:139], v[108:111], v[72:87]
    v_mfma_f32_32x32x16_bf16 v[88:103], v[144:147], v[108:111], v[88:103]
    v_and_b32_dpp v108, v108, v56 wave_shr:1 row_mask:0xf bank_mask:0xf bound_ctrl:0
    v_and_b32_dpp v109, v109, v56 wave_shr:1 row_mask:0xf bank_mask:0xf bound_ctrl:0
    v_and_b32_dpp v110, v110, v56 wave_shr:1 row_mask:0xf bank_mask:0xf bound_ctrl:0
    v_and_b32_dpp v111, v111, v56 wave_shr:1 row_mask:0xf bank_mask:0xf bound_ctrl:0
    v_mfma_f32_32x32x16_bf16 v[72:87], v[132:135], v[112:115], v[72:87]
    v_mfma_f32_32x32x16_bf16 v[88:103], v[140:143], v[112:115], v[88:103]
    v_and_b32_dpp v112, v112, v56 wave_shr:1 row_mask:0xf bank_mask:0xf bound_ctrl:0
    v_and_b32_dpp v113, v113, v56 wave_shr:1 row_mask:0xf bank_mask:0xf bound_ctrl:0
    v_and_b32_dpp v114, v114, v56 wave_shr:1 row_mask:0xf bank_mask:0xf bound_ctrl:0
    v_and_b32_dpp v115, v115, v56 wave_shr:1 row_mask:0xf bank_mask:0xf bound_ctrl:0
    v_mfma_f32_32x32x16_bf16 v[72:87], v[128:131], v[116:119], v[72:87]
    v_mfma_f32_32x32x16_bf16 v[88:103], v[136:139], v[116:119], v[88:103]
    v_and_b32_dpp v116, v116, v56 wave_shr:1 row_mask:0xf bank_mask:0xf bound_ctrl:0
    v_and_b32_dpp v117, v117, v56 wave_shr:1 row_mask:0xf bank_mask:0xf bound_ctrl:0
    v_and_b32_dpp v118, v118, v56 wave_shr:1 row_mask:0xf bank_mask:0xf bound_ctrl:0
    v_and_b32_dpp v119, v119, v56 wave_shr:1 row_mask:0xf bank_mask:0xf bound_ctrl:0
    ds_read_b128 v[128:131], v54 offset:704
    ds_read_b128 v[132:135], v54 offset:736
    ds_read_b128 v[136:139], v54 offset:768
    ds_read_b128 v[140:143], v54 offset:800
    s_waitcnt lgkmcnt(4)
    v_mfma_f32_32x32x16_bf16 v[72:87], v[156:159], v[104:107], v[72:87]
    v_mfma_f32_32x32x16_bf16 v[88:103], v[124:127], v[104:107], v[88:103]
    v_and_b32_dpp v104, v104, v56 wave_shr:1 row_mask:0xf bank_mask:0xf bound_ctrl:0
    v_and_b32_dpp v105, v105, v56 wave_shr:1 row_mask:0xf bank_mask:0xf bound_ctrl:0
    v_and_b32_dpp v106, v106, v56 wave_shr:1 row_mask:0xf bank_mask:0xf bound_ctrl:0
    v_and_b32_dpp v107, v107, v56 wave_shr:1 row_mask:0xf bank_mask:0xf bound_ctrl:0
    v_mfma_f32_32x32x16_bf16 v[72:87], v[152:155], v[108:111], v[72:87]
    v_mfma_f32_32x32x16_bf16 v[88:103], v[120:123], v[108:111], v[88:103]
    v_and_b32_dpp v108, v108, v56 wave_shr:1 row_mask:0xf bank_mask:0xf bound_ctrl:0
    v_and_b32_dpp v109, v109, v56 wave_shr:1 row_mask:0xf bank_mask:0xf bound_ctrl:0
    v_and_b32_dpp v110, v110, v56 wave_shr:1 row_mask:0xf bank_mask:0xf bound_ctrl:0
    v_and_b32_dpp v111, v111, v56 wave_shr:1 row_mask:0xf bank_mask:0xf bound_ctrl:0
    v_mfma_f32_32x32x16_bf16 v[72:87], v[148:151], v[112:115], v[72:87]
    v_mfma_f32_32x32x16_bf16 v[88:103], v[156:159], v[112:115], v[88:103]
    v_and_b32_dpp v112, v112, v56 wave_shr:1 row_mask:0xf bank_mask:0xf bound_ctrl:0
    v_and_b32_dpp v113, v113, v56 wave_shr:1 row_mask:0xf bank_mask:0xf bound_ctrl:0
    v_and_b32_dpp v114, v114, v56 wave_shr:1 row_mask:0xf bank_mask:0xf bound_ctrl:0
    v_and_b32_dpp v115, v115, v56 wave_shr:1 row_mask:0xf bank_mask:0xf bound_ctrl:0
    v_mfma_f32_32x32x16_bf16 v[72:87], v[144:147], v[116:119], v[72:87]
    v_mfma_f32_32x32x16_bf16 v[88:103], v[152:155], v[116:119], v[88:103]
    v_and_b32_dpp v116, v116, v56 wave_shr:1 row_mask:0xf bank_mask:0xf bound_ctrl:0
    v_and_b32_dpp v117, v117, v56 wave_shr:1 row_mask:0xf bank_mask:0xf bound_ctrl:0
    v_and_b32_dpp v118, v118, v56 wave_shr:1 row_mask:0xf bank_mask:0xf bound_ctrl:0
    v_and_b32_dpp v119, v119, v56 wave_shr:1 row_mask:0xf bank_mask:0xf bound_ctrl:0
    ds_read_b128 v[144:147], v54 offset:832
    ds_read_b128 v[148:151], v54 offset:864
    ds_read_b128 v[152:155], v54 offset:896
    ds_read_b128 v[156:159], v54 offset:928
    s_waitcnt lgkmcnt(4)
    v_mfma_f32_32x32x16_bf16 v[72:87], v[132:135], v[104:107], v[72:87]
    v_mfma_f32_32x32x16_bf16 v[88:103], v[140:143], v[104:107], v[88:103]
    v_and_b32_dpp v104, v104, v56 wave_shr:1 row_mask:0xf bank_mask:0xf bound_ctrl:0
    v_and_b32_dpp v105, v105, v56 wave_shr:1 row_mask:0xf bank_mask:0xf bound_ctrl:0
    v_and_b32_dpp v106, v106, v56 wave_shr:1 row_mask:0xf bank_mask:0xf bound_ctrl:0
    v_and_b32_dpp v107, v107, v56 wave_shr:1 row_mask:0xf bank_mask:0xf bound_ctrl:0
    v_mfma_f32_32x32x16_bf16 v[72:87], v[128:131], v[108:111], v[72:87]
    v_mfma_f32_32x32x16_bf16 v[88:103], v[136:139], v[108:111], v[88:103]
    v_and_b32_dpp v108, v108, v56 wave_shr:1 row_mask:0xf bank_mask:0xf bound_ctrl:0
    v_and_b32_dpp v109, v109, v56 wave_shr:1 row_mask:0xf bank_mask:0xf bound_ctrl:0
    v_and_b32_dpp v110, v110, v56 wave_shr:1 row_mask:0xf bank_mask:0xf bound_ctrl:0
    v_and_b32_dpp v111, v111, v56 wave_shr:1 row_mask:0xf bank_mask:0xf bound_ctrl:0
    v_mfma_f32_32x32x16_bf16 v[72:87], v[124:127], v[112:115], v[72:87]
    v_mfma_f32_32x32x16_bf16 v[88:103], v[132:135], v[112:115], v[88:103]
    v_and_b32_dpp v112, v112, v56 wave_shr:1 row_mask:0xf bank_mask:0xf bound_ctrl:0
    v_and_b32_dpp v113, v113, v56 wave_shr:1 row_mask:0xf bank_mask:0xf bound_ctrl:0
    v_and_b32_dpp v114, v114, v56 wave_shr:1 row_mask:0xf bank_mask:0xf bound_ctrl:0
    v_and_b32_dpp v115, v115, v56 wave_shr:1 row_mask:0xf bank_mask:0xf bound_ctrl:0
    v_mfma_f32_32x32x16_bf16 v[72:87], v[120:123], v[116:119], v[72:87]
    v_mfma_f32_32x32x16_bf16 v[88:103], v[128:131], v[116:119], v[88:103]
    v_and_b32_dpp v116, v116, v56 wave_shr:1 row_mask:0xf bank_mask:0xf bound_ctrl:0
    v_and_b32_dpp v117, v117, v56 wave_shr:1 row_mask:0xf bank_mask:0xf bound_ctrl:0
    v_and_b32_dpp v118, v118, v56 wave_shr:1 row_mask:0xf bank_mask:0xf bound_ctrl:0
    v_and_b32_dpp v119, v119, v56 wave_shr:1 row_mask:0xf bank_mask:0xf bound_ctrl:0
    ds_read_b128 v[120:123], v54 offset:960
    ds_read_b128 v[124:127], v54 offset:992
    ds_read_b128 v[128:131], v54 offset:1024
    ds_read_b128 v[132:135], v54 offset:1056
    s_waitcnt lgkmcnt(4)
    v_mfma_f32_32x32x16_bf16 v[72:87], v[148:151], v[104:107], v[72:87]
    v_mfma_f32_32x32x16_bf16 v[88:103], v[156:159], v[104:107], v[88:103]
    v_and_b32_dpp v104, v104, v56 wave_shr:1 row_mask:0xf bank_mask:0xf bound_ctrl:0
    v_and_b32_dpp v105, v105, v56 wave_shr:1 row_mask:0xf bank_mask:0xf bound_ctrl:0
    v_and_b32_dpp v106, v106, v56 wave_shr:1 row_mask:0xf bank_mask:0xf bound_ctrl:0
    v_and_b32_dpp v107, v107, v56 wave_shr:1 row_mask:0xf bank_mask:0xf bound_ctrl:0
    v_mfma_f32_32x32x16_bf16 v[72:87], v[144:147], v[108:111], v[72:87]
    v_mfma_f32_32x32x16_bf16 v[88:103], v[152:155], v[108:111], v[88:103]
    v_and_b32_dpp v108, v108, v56 wave_shr:1 row_mask:0xf bank_mask:0xf bound_ctrl:0
    v_and_b32_dpp v109, v109, v56 wave_shr:1 row_mask:0xf bank_mask:0xf bound_ctrl:0
    v_and_b32_dpp v110, v110, v56 wave_shr:1 row_mask:0xf bank_mask:0xf bound_ctrl:0
    v_and_b32_dpp v111, v111, v56 wave_shr:1 row_mask:0xf bank_mask:0xf bound_ctrl:0
    v_mfma_f32_32x32x16_bf16 v[72:87], v[140:143], v[112:115], v[72:87]
    v_mfma_f32_32x32x16_bf16 v[88:103], v[148:151], v[112:115], v[88:103]
    v_and_b32_dpp v112, v112, v56 wave_shr:1 row_mask:0xf bank_mask:0xf bound_ctrl:0
    v_and_b32_dpp v113, v113, v56 wave_shr:1 row_mask:0xf bank_mask:0xf bound_ctrl:0
    v_and_b32_dpp v114, v114, v56 wave_shr:1 row_mask:0xf bank_mask:0xf bound_ctrl:0
    v_and_b32_dpp v115, v115, v56 wave_shr:1 row_mask:0xf bank_mask:0xf bound_ctrl:0
    v_mfma_f32_32x32x16_bf16 v[72:87], v[136:139], v[116:119], v[72:87]
    v_mfma_f32_32x32x16_bf16 v[88:103], v[144:147], v[116:119], v[88:103]
    v_and_b32_dpp v116, v116, v56 wave_shr:1 row_mask:0xf bank_mask:0xf bound_ctrl:0
    v_and_b32_dpp v117, v117, v56 wave_shr:1 row_mask:0xf bank_mask:0xf bound_ctrl:0
    v_and_b32_dpp v118, v118, v56 wave_shr:1 row_mask:0xf bank_mask:0xf bound_ctrl:0
    v_and_b32_dpp v119, v119, v56 wave_shr:1 row_mask:0xf bank_mask:0xf bound_ctrl:0
    s_waitcnt lgkmcnt(0)
    v_mfma_f32_32x32x16_bf16 v[72:87], v[124:127], v[104:107], v[72:87]
    v_mfma_f32_32x32x16_bf16 v[88:103], v[132:135], v[104:107], v[88:103]
    v_mfma_f32_32x32x16_bf16 v[72:87], v[120:123], v[108:111], v[72:87]
    v_mfma_f32_32x32x16_bf16 v[88:103], v[128:131], v[108:111], v[88:103]
    v_mfma_f32_32x32x16_bf16 v[72:87], v[156:159], v[112:115], v[72:87]
    v_mfma_f32_32x32x16_bf16 v[88:103], v[124:127], v[112:115], v[88:103]
    v_mfma_f32_32x32x16_bf16 v[72:87], v[152:155], v[116:119], v[72:87]
    v_mfma_f32_32x32x16_bf16 v[88:103], v[120:123], v[116:119], v[88:103]
    s_nop 10
    ds_write_b128 v68, v[72:75] offset:0
    ds_write_b128 v68, v[76:79] offset:32
    ds_write_b128 v68, v[80:83] offset:64
    ds_write_b128 v68, v[84:87] offset:96
    ds_write_b128 v68, v[88:91] offset:128
    ds_write_b128 v68, v[92:95] offset:160
    ds_write_b128 v68, v[96:99] offset:192
    ds_write_b128 v68, v[100:103] offset:224
    s_waitcnt lgkmcnt(0)
    s_barrier
    ds_read_b128 v[120:123], v69 offset:0
    ds_read_b128 v[124:127], v69 offset:16
    ds_read_b128 v[128:131], v69 offset:8704
    ds_read_b128 v[132:135], v69 offset:8720
    ds_read_b128 v[136:139], v69 offset:17408
    ds_read_b128 v[140:143], v69 offset:17424
    ds_read_b128 v[144:147], v69 offset:26112
    ds_read_b128 v[148:151], v69 offset:26128
    s_waitcnt lgkmcnt(0)
    v_pk_add_f32 v[120:121], v[120:121], v[128:129]
    v_pk_add_f32 v[122:123], v[122:123], v[130:131]
    v_pk_add_f32 v[124:125], v[124:125], v[132:133]
    v_pk_add_f32 v[126:127], v[126:127], v[134:135]
    v_pk_add_f32 v[120:121], v[120:121], v[136:137]
    v_pk_add_f32 v[122:123], v[122:123], v[138:139]
    v_pk_add_f32 v[124:125], v[124:125], v[140:141]
    v_pk_add_f32 v[126:127], v[126:127], v[142:143]
    v_pk_add_f32 v[120:121], v[120:121], v[144:145]
    v_pk_add_f32 v[122:123], v[122:123], v[146:147]
    v_pk_add_f32 v[124:125], v[124:125], v[148:149]
    v_pk_add_f32 v[126:127], v[126:127], v[150:151]
    v_cvt_pk_bf16_f32 v168, v120, v121
    v_cvt_pk_bf16_f32 v169, v122, v123
    v_cvt_pk_bf16_f32 v170, v124, v125
    v_cvt_pk_bf16_f32 v171, v126, v127
    s_lshl_b32 s40, s35, 12
    s_add_u32 s40, s40, 8912896
    buffer_store_dwordx4 v[168:171], v2, s[8:11], s40 offen
    s_nop 1
    s_cmp_ge_u32 s32, 128
    s_cbranch_scc1 k2_kernel_cend
    s_add_u32 s35, s32, 512
    s_waitcnt vmcnt(2)
    v_cmp_ne_u32 vcc, 0, v0
    s_nop 1
    v_cndmask_b32 v24, 0, v24, vcc
    v_cndmask_b32 v25, 0, v25, vcc
    v_cndmask_b32 v26, 0, v26, vcc
    v_cndmask_b32 v27, 0, v27, vcc
    v_alignbit_b32 v160, v25, v24, 16
    v_alignbit_b32 v161, v26, v25, 16
    v_alignbit_b32 v162, v27, v26, 16
    v_alignbit_b32 v163, v28, v27, 16
    v_alignbit_b32 v164, v29, v28, 16
    v_alignbit_b32 v165, v30, v29, 16
    v_alignbit_b32 v166, v31, v30, 16
    ds_write_b128 v52, v[160:163] offset:0
    v_mov_b32 v168, v25
    v_mov_b32 v169, v26
    v_mov_b32 v170, v27
    v_mov_b32 v171, v28
    ds_write_b128 v52, v[168:171] offset:4416
    s_nop 1
    v_mov_b32 v168, v161
    v_mov_b32 v169, v162
    v_mov_b32 v170, v163
    v_mov_b32 v171, v164
    ds_write_b128 v52, v[168:171] offset:8832
    s_nop 1
    ds_write_b128 v52, v[26:29] offset:13248
    ds_write_b128 v52, v[162:165] offset:17664
    v_mov_b32 v168, v27
    v_mov_b32 v169, v28
    v_mov_b32 v170, v29
    v_mov_b32 v171, v30
    ds_write_b128 v52, v[168:171] offset:22080
    s_nop 1
    v_mov_b32 v168, v163
    v_mov_b32 v169, v164
    v_mov_b32 v170, v165
    v_mov_b32 v171, v166
    ds_write_b128 v52, v[168:171] offset:26496
    s_nop 1
    ds_write_b128 v52, v[28:31] offset:30912
    ds_write_b128 v53, v[40:43]
    v_lshlrev_b32 v3, 16, v46
    v_or_b32 v3, v3, v46
    v_and_b32 v172, v60, v3
    v_and_b32 v173, v61, v3
    v_and_b32 v174, v62, v3
    v_and_b32 v175, v63, v3
    v_and_b32 v176, v64, v3
    v_and_b32 v177, v65, v3
    v_and_b32 v178, v66, v3
    v_and_b32 v179, v67, v3
    s_waitcnt lgkmcnt(0)
    s_barrier
    ds_read_b128 v[104:107], v55 offset:35328
    ds_read_b128 v[108:111], v55 offset:35360
    ds_read_b128 v[112:115], v55 offset:35392
    ds_read_b128 v[116:119], v55 offset:35424
    ds_read_b128 v[120:123], v54 offset:0
    ds_read_b128 v[124:127], v54 offset:32
    ds_read_b128 v[128:131], v54 offset:64
    ds_read_b128 v[132:135], v54 offset:96
    ds_read_b128 v[136:139], v54 offset:128
    ds_read_b128 v[140:143], v54 offset:160
    ds_read_b128 v[144:147], v54 offset:192
    ds_read_b128 v[148:151], v54 offset:224
    ds_read_b128 v[152:155], v54 offset:256
    ds_read_b128 v[156:159], v54 offset:288
    s_waitcnt lgkmcnt(4)
    v_mfma_f32_32x32x16_bf16 v[72:87], v[132:135], v[104:107], 0
    v_mfma_f32_32x32x16_bf16 v[88:103], v[140:143], v[104:107], 0
    s_cmp_lg_u32 s34, 0
    s_cbranch_scc1 c_dg_15
    v_mfma_f32_32x32x16_bf16 v[72:87], v[172:175], v[104:107], v[72:87]
c_dg_15:
    v_and_b32_dpp v104, v104, v56 wave_shr:1 row_mask:0xf bank_mask:0xf bound_ctrl:0
    v_and_b32_dpp v105, v105, v56 wave_shr:1 row_mask:0xf bank_mask:0xf bound_ctrl:0
    v_and_b32_dpp v106, v106, v56 wave_shr:1 row_mask:0xf bank_mask:0xf bound_ctrl:0
    v_and_b32_dpp v107, v107, v56 wave_shr:1 row_mask:0xf bank_mask:0xf bound_ctrl:0
    v_mfma_f32_32x32x16_bf16 v[72:87], v[128:131], v[108:111], v[72:87]
    v_mfma_f32_32x32x16_bf16 v[88:103], v[136:139], v[108:111], v[88:103]
    s_cmp_lg_u32 s34, 0
    s_cbranch_scc1 c_dg_16
    v_mfma_f32_32x32x16_bf16 v[72:87], v[176:179], v[108:111], v[72:87]
c_dg_16:
    v_and_b32_dpp v108, v108, v56 wave_shr:1 row_mask:0xf bank_mask:0xf bound_ctrl:0
    v_and_b32_dpp v109, v109, v56 wave_shr:1 row_mask:0xf bank_mask:0xf bound_ctrl:0
    v_and_b32_dpp v110, v110, v56 wave_shr:1 row_mask:0xf bank_mask:0xf bound_ctrl:0
    v_and_b32_dpp v111, v111, v56 wave_shr:1 row_mask:0xf bank_mask:0xf bound_ctrl:0
    v_mfma_f32_32x32x16_bf16 v[72:87], v[124:127], v[112:115], v[72:87]
    v_mfma_f32_32x32x16_bf16 v[88:103], v[132:135], v[112:115], v[88:103]
    s_cmp_lg_u32 s34, 0
    s_cbranch_scc1 c_dg_17
    v_mfma_f32_32x32x16_bf16 v[88:103], v[172:175], v[112:115], v[88:103]
c_dg_17:
    v_and_b32_dpp v112, v112, v56 wave_shr:1 row_mask:0xf bank_mask:0xf bound_ctrl:0
    v_and_b32_dpp v113, v113, v56 wave_shr:1 row_mask:0xf bank_mask:0xf bound_ctrl:0
    v_and_b32_dpp v114, v114, v56 wave_shr:1 row_mask:0xf bank_mask:0xf bound_ctrl:0
    v_and_b32_dpp v115, v115, v56 wave_shr:1 row_mask:0xf bank_mask:0xf bound_ctrl:0
    v_mfma_f32_32x32x16_bf16 v[72:87], v[120:123], v[116:119], v[72:87]
    v_mfma_f32_32x32x16_bf16 v[88:103], v[128:131], v[116:119], v[88:103]
    s_cmp_lg_u32 s34, 0
    s_cbranch_scc1 c_dg_18
    v_mfma_f32_32x32x16_bf16 v[88:103], v[176:179], v[116:119], v[88:103]
c_dg_18:
    v_and_b32_dpp v116, v116, v56 wave_shr:1 row_mask:0xf bank_mask:0xf bound_ctrl:0
    v_and_b32_dpp v117, v117, v56 wave_shr:1 row_mask:0xf bank_mask:0xf bound_ctrl:0
    v_and_b32_dpp v118, v118, v56 wave_shr:1 row_mask:0xf bank_mask:0xf bound_ctrl:0
    v_and_b32_dpp v119, v119, v56 wave_shr:1 row_mask:0xf bank_mask:0xf bound_ctrl:0
    ds_read_b128 v[120:123], v54 offset:320
    ds_read_b128 v[124:127], v54 offset:352
    ds_read_b128 v[128:131], v54 offset:384
    ds_read_b128 v[132:135], v54 offset:416
    s_waitcnt lgkmcnt(4)
    v_mfma_f32_32x32x16_bf16 v[72:87], v[148:151], v[104:107], v[72:87]
    v_mfma_f32_32x32x16_bf16 v[88:103], v[156:159], v[104:107], v[88:103]
    v_and_b32_dpp v104, v104, v56 wave_shr:1 row_mask:0xf bank_mask:0xf bound_ctrl:0
    v_and_b32_dpp v105, v105, v56 wave_shr:1 row_mask:0xf bank_mask:0xf bound_ctrl:0
    v_and_b32_dpp v106, v106, v56 wave_shr:1 row_mask:0xf bank_mask:0xf bound_ctrl:0
    v_and_b32_dpp v107, v107, v56 wave_shr:1 row_mask:0xf bank_mask:0xf bound_ctrl:0
    v_mfma_f32_32x32x16_bf16 v[72:87], v[144:147], v[108:111], v[72:87]
    v_mfma_f32_32x32x16_bf16 v[88:103], v[152:155], v[108:111], v[88:103]
    v_and_b32_dpp v108, v108, v56 wave_shr:1 row_mask:0xf bank_mask:0xf bound_ctrl:0
    v_and_b32_dpp v109, v109, v56 wave_shr:1 row_mask:0xf bank_mask:0xf bound_ctrl:0
    v_and_b32_dpp v110, v110, v56 wave_shr:1 row_mask:0xf bank_mask:0xf bound_ctrl:0
    v_and_b32_dpp v111, v111, v56 wave_shr:1 row_mask:0xf bank_mask:0xf bound_ctrl:0
    v_mfma_f32_32x32x16_bf16 v[72:87], v[140:143], v[112:115], v[72:87]
    v_mfma_f32_32x32x16_bf16 v[88:103], v[148:151], v[112:115], v[88:103]
    v_and_b32_dpp v112, v112, v56 wave_shr:1 row_mask:0xf bank_mask:0xf bound_ctrl:0
    v_and_b32_dpp v113, v113, v56 wave_shr:1 row_mask:0xf bank_mask:0xf bound_ctrl:0
    v_and_b32_dpp v114, v114, v56 wave_shr:1 row_mask:0xf bank_mask:0xf bound_ctrl:0
    v_and_b32_dpp v115, v115, v56 wave_shr:1 row_mask:0xf bank_mask:0xf bound_ctrl:0
    v_mfma_f32_32x32x16_bf16 v[72:87], v[136:139], v[116:119], v[72:87]
    v_mfma_f32_32x32x16_bf16 v[88:103], v[144:147], v[116:119], v[88:103]
    v_and_b32_dpp v116, v116, v56 wave_shr:1 row_mask:0xf bank_mask:0xf bound_ctrl:0
    v_and_b32_dpp v117, v117, v56 wave_shr:1 row_mask:0xf bank_mask:0xf bound_ctrl:0
    v_and_b32_dpp v118, v118, v56 wave_shr:1 row_mask:0xf bank_mask:0xf bound_ctrl:0
    v_and_b32_dpp v119, v119, v56 wave_shr:1 row_mask:0xf bank_mask:0xf bound_ctrl:0
    ds_read_b128 v[136:139], v54 offset:448
    ds_read_b128 v[140:143], v54 offset:480
    ds_read_b128 v[144:147], v54 offset:512
    ds_read_b128 v[148:151], v54 offset:544
    s_waitcnt lgkmcnt(4)
    v_mfma_f32_32x32x16_bf16 v[72:87], v[124:127], v[104:107], v[72:87]
    v_mfma_f32_32x32x16_bf16 v[88:103], v[132:135], v[104:107], v[88:103]
    v_and_b32_dpp v104, v104, v56 wave_shr:1 row_mask:0xf bank_mask:0xf bound_ctrl:0
    v_and_b32_dpp v105, v105, v56 wave_shr:1 row_mask:0xf bank_mask:0xf bound_ctrl:0
    v_and_b32_dpp v106, v106, v56 wave_shr:1 row_mask:0xf bank_mask:0xf bound_ctrl:0
    v_and_b32_dpp v107, v107, v56 wave_shr:1 row_mask:0xf bank_mask:0xf bound_ctrl:0
    v_mfma_f32_32x32x16_bf16 v[72:87], v[120:123], v[108:111], v[72:87]
    v_mfma_f32_32x32x16_bf16 v[88:103], v[128:131], v[108:111], v[88:103]
    v_and_b32_dpp v108, v108, v56 wave_shr:1 row_mask:0xf bank_mask:0xf bound_ctrl:0
    v_and_b32_dpp v109, v109, v56 wave_shr:1 row_mask:0xf bank_mask:0xf bound_ctrl:0
    v_and_b32_dpp v110, v110, v56 wave_shr:1 row_mask:0xf bank_mask:0xf bound_ctrl:0
    v_and_b32_dpp v111, v111, v56 wave_shr:1 row_mask:0xf bank_mask:0xf bound_ctrl:0
    v_mfma_f32_32x32x16_bf16 v[72:87], v[156:159], v[112:115], v[72:87]
    v_mfma_f32_32x32x16_bf16 v[88:103], v[124:127], v[112:115], v[88:103]
    v_and_b32_dpp v112, v112, v56 wave_shr:1 row_mask:0xf bank_mask:0xf bound_ctrl:0
    v_and_b32_dpp v113, v113, v56 wave_shr:1 row_mask:0xf bank_mask:0xf bound_ctrl:0
    v_and_b32_dpp v114, v114, v56 wave_shr:1 row_mask:0xf bank_mask:0xf bound_ctrl:0
    v_and_b32_dpp v115, v115, v56 wave_shr:1 row_mask:0xf bank_mask:0xf bound_ctrl:0
    v_mfma_f32_32x32x16_bf16 v[72:87], v[152:155], v[116:119], v[72:87]
    v_mfma_f32_32x32x16_bf16 v[88:103], v[120:123], v[116:119], v[88:103]
    v_and_b32_dpp v116, v116, v56 wave_shr:1 row_mask:0xf bank_mask:0xf bound_ctrl:0
    v_and_b32_dpp v117, v117, v56 wave_shr:1 row_mask:0xf bank_mask:0xf bound_ctrl:0
    v_and_b32_dpp v118, v118, v56 wave_shr:1 row_mask:0xf bank_mask:0xf bound_ctrl:0
    v_and_b32_dpp v119, v119, v56 wave_shr:1 row_mask:0xf bank_mask:0xf bound_ctrl:0
    ds_read_b128 v[152:155], v54 offset:576
    ds_read_b128 v[156:159], v54 offset:608
    ds_read_b128 v[120:123], v54 offset:640
    ds_read_b128 v[124:127], v54 offset:672
    s_waitcnt lgkmcnt(4)
    v_mfma_f32_32x32x16_bf16 v[72:87], v[140:143], v[104:107], v[72:87]
    v_mfma_f32_32x32x16_bf16 v[88:103], v[148:151], v[104:107], v[88:103]
    v_and_b32_dpp v104, v104, v56 wave_shr:1 row_mask:0xf bank_mask:0xf bound_ctrl:0
    v_and_b32_dpp v105, v105, v56 wave_shr:1 row_mask:0xf bank_mask:0xf bound_ctrl:0
    v_and_b32_dpp v106, v106, v56 wave_shr:1 row_mask:0xf bank_mask:0xf bound_ctrl:0
    v_and_b32_dpp v107, v107, v56 wave_shr:1 row_mask:0xf bank_mask:0xf bound_ctrl:0
    v_mfma_f32_32x32x16_bf16 v[72:87], v[136:139], v[108:111], v[72:87]
    v_mfma_f32_32x32x16_bf16 v[88:103], v[144:147], v[108:111], v[88:103]
    v_and_b32_dpp v108, v108, v56 wave_shr:1 row_mask:0xf bank_mask:0xf bound_ctrl:0
    v_and_b32_dpp v109, v109, v56 wave_shr:1 row_mask:0xf bank_mask:0xf bound_ctrl:0
    v_and_b32_dpp v110, v110, v56 wave_shr:1 row_mask:0xf bank_mask:0xf bound_ctrl:0
    v_and_b32_dpp v111, v111, v56 wave_shr:1 row_mask:0xf bank_mask:0xf bound_ctrl:0
    v_mfma_f32_32x32x16_bf16 v[72:87], v[132:135], v[112:115], v[72:87]
    v_mfma_f32_32x32x16_bf16 v[88:103], v[140:143], v[112:115], v[88:103]
    v_and_b32_dpp v112, v112, v56 wave_shr:1 row_mask:0xf bank_mask:0xf bound_ctrl:0
    v_and_b32_dpp v113, v113, v56 wave_shr:1 row_mask:0xf bank_mask:0xf bound_ctrl:0
    v_and_b32_dpp v114, v114, v56 wave_shr:1 row_mask:0xf bank_mask:0xf bound_ctrl:0
    v_and_b32_dpp v115, v115, v56 wave_shr:1 row_mask:0xf bank_mask:0xf bound_ctrl:0
    v_mfma_f32_32x32x16_bf16 v[72:87], v[128:131], v[116:119], v[72:87]
    v_mfma_f32_32x32x16_bf16 v[88:103], v[136:139], v[116:119], v[88:103]
    v_and_b32_dpp v116, v116, v56 wave_shr:1 row_mask:0xf bank_mask:0xf bound_ctrl:0
    v_and_b32_dpp v117, v117, v56 wave_shr:1 row_mask:0xf bank_mask:0xf bound_ctrl:0
    v_and_b32_dpp v118, v118, v56 wave_shr:1 row_mask:0xf bank_mask:0xf bound_ctrl:0
    v_and_b32_dpp v119, v119, v56 wave_shr:1 row_mask:0xf bank_mask:0xf bound_ctrl:0
    ds_read_b128 v[128:131], v54 offset:704
    ds_read_b128 v[132:135], v54 offset:736
    ds_read_b128 v[136:139], v54 offset:768
    ds_read_b128 v[140:143], v54 offset:800
    s_waitcnt lgkmcnt(4)
    v_mfma_f32_32x32x16_bf16 v[72:87], v[156:159], v[104:107], v[72:87]
    v_mfma_f32_32x32x16_bf16 v[88:103], v[124:127], v[104:107], v[88:103]
    v_and_b32_dpp v104, v104, v56 wave_shr:1 row_mask:0xf bank_mask:0xf bound_ctrl:0
    v_and_b32_dpp v105, v105, v56 wave_shr:1 row_mask:0xf bank_mask:0xf bound_ctrl:0
    v_and_b32_dpp v106, v106, v56 wave_shr:1 row_mask:0xf bank_mask:0xf bound_ctrl:0
    v_and_b32_dpp v107, v107, v56 wave_shr:1 row_mask:0xf bank_mask:0xf bound_ctrl:0
    v_mfma_f32_32x32x16_bf16 v[72:87], v[152:155], v[108:111], v[72:87]
    v_mfma_f32_32x32x16_bf16 v[88:103], v[120:123], v[108:111], v[88:103]
    v_and_b32_dpp v108, v108, v56 wave_shr:1 row_mask:0xf bank_mask:0xf bound_ctrl:0
    v_and_b32_dpp v109, v109, v56 wave_shr:1 row_mask:0xf bank_mask:0xf bound_ctrl:0
    v_and_b32_dpp v110, v110, v56 wave_shr:1 row_mask:0xf bank_mask:0xf bound_ctrl:0
    v_and_b32_dpp v111, v111, v56 wave_shr:1 row_mask:0xf bank_mask:0xf bound_ctrl:0
    v_mfma_f32_32x32x16_bf16 v[72:87], v[148:151], v[112:115], v[72:87]
    v_mfma_f32_32x32x16_bf16 v[88:103], v[156:159], v[112:115], v[88:103]
    v_and_b32_dpp v112, v112, v56 wave_shr:1 row_mask:0xf bank_mask:0xf bound_ctrl:0
    v_and_b32_dpp v113, v113, v56 wave_shr:1 row_mask:0xf bank_mask:0xf bound_ctrl:0
    v_and_b32_dpp v114, v114, v56 wave_shr:1 row_mask:0xf bank_mask:0xf bound_ctrl:0
    v_and_b32_dpp v115, v115, v56 wave_shr:1 row_mask:0xf bank_mask:0xf bound_ctrl:0
    v_mfma_f32_32x32x16_bf16 v[72:87], v[144:147], v[116:119], v[72:87]
    v_mfma_f32_32x32x16_bf16 v[88:103], v[152:155], v[116:119], v[88:103]
    v_and_b32_dpp v116, v116, v56 wave_shr:1 row_mask:0xf bank_mask:0xf bound_ctrl:0
    v_and_b32_dpp v117, v117, v56 wave_shr:1 row_mask:0xf bank_mask:0xf bound_ctrl:0
    v_and_b32_dpp v118, v118, v56 wave_shr:1 row_mask:0xf bank_mask:0xf bound_ctrl:0
    v_and_b32_dpp v119, v119, v56 wave_shr:1 row_mask:0xf bank_mask:0xf bound_ctrl:0
    ds_read_b128 v[144:147], v54 offset:832
    ds_read_b128 v[148:151], v54 offset:864
    ds_read_b128 v[152:155], v54 offset:896
    ds_read_b128 v[156:159], v54 offset:928
    s_waitcnt lgkmcnt(4)
    v_mfma_f32_32x32x16_bf16 v[72:87], v[132:135], v[104:107], v[72:87]
    v_mfma_f32_32x32x16_bf16 v[88:103], v[140:143], v[104:107], v[88:103]
    v_and_b32_dpp v104, v104, v56 wave_shr:1 row_mask:0xf bank_mask:0xf bound_ctrl:0
    v_and_b32_dpp v105, v105, v56 wave_shr:1 row_mask:0xf bank_mask:0xf bound_ctrl:0
    v_and_b32_dpp v106, v106, v56 wave_shr:1 row_mask:0xf bank_mask:0xf bound_ctrl:0
    v_and_b32_dpp v107, v107, v56 wave_shr:1 row_mask:0xf bank_mask:0xf bound_ctrl:0
    v_mfma_f32_32x32x16_bf16 v[72:87], v[128:131], v[108:111], v[72:87]
    v_mfma_f32_32x32x16_bf16 v[88:103], v[136:139], v[108:111], v[88:103]
    v_and_b32_dpp v108, v108, v56 wave_shr:1 row_mask:0xf bank_mask:0xf bound_ctrl:0
    v_and_b32_dpp v109, v109, v56 wave_shr:1 row_mask:0xf bank_mask:0xf bound_ctrl:0
    v_and_b32_dpp v110, v110, v56 wave_shr:1 row_mask:0xf bank_mask:0xf bound_ctrl:0
    v_and_b32_dpp v111, v111, v56 wave_shr:1 row_mask:0xf bank_mask:0xf bound_ctrl:0
    v_mfma_f32_32x32x16_bf16 v[72:87], v[124:127], v[112:115], v[72:87]
    v_mfma_f32_32x32x16_bf16 v[88:103], v[132:135], v[112:115], v[88:103]
    v_and_b32_dpp v112, v112, v56 wave_shr:1 row_mask:0xf bank_mask:0xf bound_ctrl:0
    v_and_b32_dpp v113, v113, v56 wave_shr:1 row_mask:0xf bank_mask:0xf bound_ctrl:0
    v_and_b32_dpp v114, v114, v56 wave_shr:1 row_mask:0xf bank_mask:0xf bound_ctrl:0
    v_and_b32_dpp v115, v115, v56 wave_shr:1 row_mask:0xf bank_mask:0xf bound_ctrl:0
    v_mfma_f32_32x32x16_bf16 v[72:87], v[120:123], v[116:119], v[72:87]
    v_mfma_f32_32x32x16_bf16 v[88:103], v[128:131], v[116:119], v[88:103]
    v_and_b32_dpp v116, v116, v56 wave_shr:1 row_mask:0xf bank_mask:0xf bound_ctrl:0
    v_and_b32_dpp v117, v117, v56 wave_shr:1 row_mask:0xf bank_mask:0xf bound_ctrl:0
    v_and_b32_dpp v118, v118, v56 wave_shr:1 row_mask:0xf bank_mask:0xf bound_ctrl:0
    v_and_b32_dpp v119, v119, v56 wave_shr:1 row_mask:0xf bank_mask:0xf bound_ctrl:0
    ds_read_b128 v[120:123], v54 offset:960
    ds_read_b128 v[124:127], v54 offset:992
    ds_read_b128 v[128:131], v54 offset:1024
    ds_read_b128 v[132:135], v54 offset:1056
    s_waitcnt lgkmcnt(4)
    v_mfma_f32_32x32x16_bf16 v[72:87], v[148:151], v[104:107], v[72:87]
    v_mfma_f32_32x32x16_bf16 v[88:103], v[156:159], v[104:107], v[88:103]
    v_and_b32_dpp v104, v104, v56 wave_shr:1 row_mask:0xf bank_mask:0xf bound_ctrl:0
    v_and_b32_dpp v105, v105, v56 wave_shr:1 row_mask:0xf bank_mask:0xf bound_ctrl:0
    v_and_b32_dpp v106, v106, v56 wave_shr:1 row_mask:0xf bank_mask:0xf bound_ctrl:0
    v_and_b32_dpp v107, v107, v56 wave_shr:1 row_mask:0xf bank_mask:0xf bound_ctrl:0
    v_mfma_f32_32x32x16_bf16 v[72:87], v[144:147], v[108:111], v[72:87]
    v_mfma_f32_32x32x16_bf16 v[88:103], v[152:155], v[108:111], v[88:103]
    v_and_b32_dpp v108, v108, v56 wave_shr:1 row_mask:0xf bank_mask:0xf bound_ctrl:0
    v_and_b32_dpp v109, v109, v56 wave_shr:1 row_mask:0xf bank_mask:0xf bound_ctrl:0
    v_and_b32_dpp v110, v110, v56 wave_shr:1 row_mask:0xf bank_mask:0xf bound_ctrl:0
    v_and_b32_dpp v111, v111, v56 wave_shr:1 row_mask:0xf bank_mask:0xf bound_ctrl:0
    v_mfma_f32_32x32x16_bf16 v[72:87], v[140:143], v[112:115], v[72:87]
    v_mfma_f32_32x32x16_bf16 v[88:103], v[148:151], v[112:115], v[88:103]
    v_and_b32_dpp v112, v112, v56 wave_shr:1 row_mask:0xf bank_mask:0xf bound_ctrl:0
    v_and_b32_dpp v113, v113, v56 wave_shr:1 row_mask:0xf bank_mask:0xf bound_ctrl:0
    v_and_b32_dpp v114, v114, v56 wave_shr:1 row_mask:0xf bank_mask:0xf bound_ctrl:0
    v_and_b32_dpp v115, v115, v56 wave_shr:1 row_mask:0xf bank_mask:0xf bound_ctrl:0
    v_mfma_f32_32x32x16_bf16 v[72:87], v[136:139], v[116:119], v[72:87]
    v_mfma_f32_32x32x16_bf16 v[88:103], v[144:147], v[116:119], v[88:103]
    v_and_b32_dpp v116, v116, v56 wave_shr:1 row_mask:0xf bank_mask:0xf bound_ctrl:0
    v_and_b32_dpp v117, v117, v56 wave_shr:1 row_mask:0xf bank_mask:0xf bound_ctrl:0
    v_and_b32_dpp v118, v118, v56 wave_shr:1 row_mask:0xf bank_mask:0xf bound_ctrl:0
    v_and_b32_dpp v119, v119, v56 wave_shr:1 row_mask:0xf bank_mask:0xf bound_ctrl:0
    s_waitcnt lgkmcnt(0)
    v_mfma_f32_32x32x16_bf16 v[72:87], v[124:127], v[104:107], v[72:87]
    v_mfma_f32_32x32x16_bf16 v[88:103], v[132:135], v[104:107], v[88:103]
    v_mfma_f32_32x32x16_bf16 v[72:87], v[120:123], v[108:111], v[72:87]
    v_mfma_f32_32x32x16_bf16 v[88:103], v[128:131], v[108:111], v[88:103]
    v_mfma_f32_32x32x16_bf16 v[72:87], v[156:159], v[112:115], v[72:87]
    v_mfma_f32_32x32x16_bf16 v[88:103], v[124:127], v[112:115], v[88:103]
    v_mfma_f32_32x32x16_bf16 v[72:87], v[152:155], v[116:119], v[72:87]
    v_mfma_f32_32x32x16_bf16 v[88:103], v[120:123], v[116:119], v[88:103]
    s_nop 10
    ds_write_b128 v68, v[72:75] offset:0
    ds_write_b128 v68, v[76:79] offset:32
    ds_write_b128 v68, v[80:83] offset:64
    ds_write_b128 v68, v[84:87] offset:96
    ds_write_b128 v68, v[88:91] offset:128
    ds_write_b128 v68, v[92:95] offset:160
    ds_write_b128 v68, v[96:99] offset:192
    ds_write_b128 v68, v[100:103] offset:224
    s_waitcnt lgkmcnt(0)
    s_barrier
    ds_read_b128 v[120:123], v69 offset:0
    ds_read_b128 v[124:127], v69 offset:16
    ds_read_b128 v[128:131], v69 offset:8704
    ds_read_b128 v[132:135], v69 offset:8720
    ds_read_b128 v[136:139], v69 offset:17408
    ds_read_b128 v[140:143], v69 offset:17424
    ds_read_b128 v[144:147], v69 offset:26112
    ds_read_b128 v[148:151], v69 offset:26128
    s_waitcnt lgkmcnt(0)
    v_pk_add_f32 v[120:121], v[120:121], v[128:129]
    v_pk_add_f32 v[122:123], v[122:123], v[130:131]
    v_pk_add_f32 v[124:125], v[124:125], v[132:133]
    v_pk_add_f32 v[126:127], v[126:127], v[134:135]
    v_pk_add_f32 v[120:121], v[120:121], v[136:137]
    v_pk_add_f32 v[122:123], v[122:123], v[138:139]
    v_pk_add_f32 v[124:125], v[124:125], v[140:141]
    v_pk_add_f32 v[126:127], v[126:127], v[142:143]
    v_pk_add_f32 v[120:121], v[120:121], v[144:145]
    v_pk_add_f32 v[122:123], v[122:123], v[146:147]
    v_pk_add_f32 v[124:125], v[124:125], v[148:149]
    v_pk_add_f32 v[126:127], v[126:127], v[150:151]
    v_cvt_pk_bf16_f32 v168, v120, v121
    v_cvt_pk_bf16_f32 v169, v122, v123
    v_cvt_pk_bf16_f32 v170, v124, v125
    v_cvt_pk_bf16_f32 v171, v126, v127
    s_lshl_b32 s40, s35, 12
    s_add_u32 s40, s40, 8912896
    buffer_store_dwordx4 v[168:171], v2, s[8:11], s40 offen
    s_nop 1
k2_kernel_cend:
k2_kernel_end:
    s_endpgm

.globl k3_kernel
.p2align 8
.type k3_kernel,@function
k3_kernel:
    s_cmp_ge_u32 s2, 256
    s_cbranch_scc1 k3_kernel_end
    s_load_dwordx2 s[4:5], s[0:1], 80
    s_load_dwordx2 s[8:9], s[0:1], 0
    s_load_dwordx2 s[12:13], s[0:1], 104
    s_load_dwordx2 s[16:17], s[0:1], 88
    s_mov_b32 s6, 983040
    s_mov_b32 s7, 0x20000
    s_mov_b32 s10, 2621440
    s_mov_b32 s11, 0x20000
    s_mov_b32 s14, 15007744
    s_mov_b32 s15, 0x20000
    s_mov_b32 s18, 2621440
    s_mov_b32 s19, 0x20000
    v_lshrrev_b32 v4, 6, v0
    v_and_b32 v1, 63, v0
    v_readfirstlane_b32 s34, v4
    v_lshrrev_b32 v2, 4, v1
    v_and_b32 v3, 15, v1
    s_and_b32 s40, s2, 7
    s_lshr_b32 s41, s2, 3
    s_lshr_b32 s32, s40, 1
    s_lshl_b32 s32, s32, 3
    s_and_b32 s42, s41, 7
    s_add_u32 s32, s32, s42
    s_and_b32 s33, s40, 1
    s_lshl_b32 s33, s33, 2
    s_lshr_b32 s42, s41, 3
    s_add_u32 s33, s33, s42
    s_mul_i32 s44, s33, 160
    s_mul_i32 s45, s32, 81920
    s_add_u32 s45, s45, s44
    v_add_u32 v4, 0, v1
    v_mul_u32_u24 v5, 6554, v4
    v_lshrrev_b32 v5, 16, v5
    v_mul_u32_u24 v6, 10, v5
    v_sub_u32 v4, v4, v6
    v_lshlrev_b32 v4, 4, v4
    v_mul_u32_u24 v5, 1280, v5
    v_add_u32 v7, v4, v5
    v_add_u32 v4, 64, v1
    v_mul_u32_u24 v5, 6554, v4
    v_lshrrev_b32 v5, 16, v5
    v_mul_u32_u24 v6, 10, v5
    v_sub_u32 v4, v4, v6
    v_lshlrev_b32 v4, 4, v4
    v_mul_u32_u24 v5, 1280, v5
    v_add_u32 v8, v4, v5
    v_add_u32 v4, 128, v1
    v_mul_u32_u24 v5, 6554, v4
    v_lshrrev_b32 v5, 16, v5
    v_mul_u32_u24 v6, 10, v5
    v_sub_u32 v4, v4, v6
    v_lshlrev_b32 v4, 4, v4
    v_mul_u32_u24 v5, 1280, v5
    v_add_u32 v9, v4, v5
    v_add_u32 v4, 192, v1
    v_mul_u32_u24 v5, 6554, v4
    v_lshrrev_b32 v5, 16, v5
    v_mul_u32_u24 v6, 10, v5
    v_sub_u32 v4, v4, v6
    v_lshlrev_b32 v4, 4, v4
    v_mul_u32_u24 v5, 1280, v5
    v_add_u32 v10, v4, v5
    v_add_u32 v4, 256, v1
    v_mul_u32_u24 v5, 6554, v4
    v_lshrrev_b32 v5, 16, v5
    v_mul_u32_u24 v6, 10, v5
    v_sub_u32 v4, v4, v6
    v_lshlrev_b32 v4, 4, v4
    v_mul_u32_u24 v5, 1280, v5
    v_add_u32 v11, v4, v5
    v_lshlrev_b32 v12, 4, v1
    s_waitcnt lgkmcnt(0)
    s_mul_i32 s40, s32, 98304
    s_mul_i32 s41, s34, 24576
    s_add_u32 s43, s40, s41
    s_add_u32 s43, s43, 11534336
    s_mul_i32 s40, s34, 40960
    s_add_u32 s40, s40, 0
    s_add_u32 s40, s40, s44
    s_mul_i32 s41, s34, 5120
    s_add_u32 m0, s41, 0
    s_nop 0
    buffer_load_dwordx4 v7, s[4:7], s40 offen lds
    s_add_u32 m0, s41, 1024
    s_nop 0
    buffer_load_dwordx4 v8, s[4:7], s40 offen lds
    s_add_u32 m0, s41, 2048
    s_nop 0
    buffer_load_dwordx4 v9, s[4:7], s40 offen lds
    s_add_u32 m0, s41, 3072
    s_nop 0
    buffer_load_dwordx4 v10, s[4:7], s40 offen lds
    s_add_u32 m0, s41, 4096
    s_nop 0
    buffer_load_dwordx4 v11, s[4:7], s40 offen lds
    s_add_u32 s42, s43, 0
    buffer_load_dwordx4 v[16:19], v12, s[12:15], s42 offen offset:0
    s_add_u32 s42, s43, 0
    buffer_load_dwordx4 v[20:23], v12, s[12:15], s42 offen offset:1024
    s_add_u32 s42, s43, 0
    buffer_load_dwordx4 v[24:27], v12, s[12:15], s42 offen offset:2048
    s_add_u32 s42, s43, 0
    buffer_load_dwordx4 v[28:31], v12, s[12:15], s42 offen offset:3072
    s_barrier
    s_mul_i32 s40, s34, 40960
    s_add_u32 s40, s40, 163840
    s_add_u32 s40, s40, s44
    s_mul_i32 s41, s34, 5120
    s_add_u32 m0, s41, 20480
    s_nop 0
    buffer_load_dwordx4 v7, s[4:7], s40 offen lds
    s_add_u32 m0, s41, 21504
    s_nop 0
    buffer_load_dwordx4 v8, s[4:7], s40 offen lds
    s_add_u32 m0, s41, 22528
    s_nop 0
    buffer_load_dwordx4 v9, s[4:7], s40 offen lds
    s_add_u32 m0, s41, 23552
    s_nop 0
    buffer_load_dwordx4 v10, s[4:7], s40 offen lds
    s_add_u32 m0, s41, 24576
    s_nop 0
    buffer_load_dwordx4 v11, s[4:7], s40 offen lds
    s_add_u32 s42, s43, 4096
    buffer_load_dwordx4 v[32:35], v12, s[12:15], s42 offen offset:0
    s_add_u32 s42, s43, 4096
    buffer_load_dwordx4 v[36:39], v12, s[12:15], s42 offen offset:1024
    s_add_u32 s42, s43, 4096
    buffer_load_dwordx4 v[40:43], v12, s[12:15], s42 offen offset:2048
    s_add_u32 s42, s43, 4096
    buffer_load_dwordx4 v[44:47], v12, s[12:15], s42 offen offset:3072
    s_mul_i32 s40, s34, 40960
    s_add_u32 s40, s40, 327680
    s_add_u32 s40, s40, s44
    s_mul_i32 s41, s34, 5120
    s_add_u32 m0, s41, 40960
    s_nop 0
    buffer_load_dwordx4 v7, s[4:7], s40 offen lds
    s_add_u32 m0, s41, 41984
    s_nop 0
    buffer_load_dwordx4 v8, s[4:7], s40 offen lds
    s_add_u32 m0, s41, 43008
    s_nop 0
    buffer_load_dwordx4 v9, s[4:7], s40 offen lds
    s_add_u32 m0, s41, 44032
    s_nop 0
    buffer_load_dwordx4 v10, s[4:7], s40 offen lds
    s_add_u32 m0, s41, 45056
    s_nop 0
    buffer_load_dwordx4 v11, s[4:7], s40 offen lds
    s_add_u32 s42, s43, 8192
    buffer_load_dwordx4 v[48:51], v12, s[12:15], s42 offen offset:0
    s_add_u32 s42, s43, 8192
    buffer_load_dwordx4 v[52:55], v12, s[12:15], s42 offen offset:1024
    s_add_u32 s42, s43, 8192
    buffer_load_dwordx4 v[56:59], v12, s[12:15], s42 offen offset:2048
    s_add_u32 s42, s43, 8192
    buffer_load_dwordx4 v[60:63], v12, s[12:15], s42 offen offset:3072
    s_mul_i32 s40, s34, 40960
    s_add_u32 s40, s40, 491520
    s_add_u32 s40, s40, s44
    s_mul_i32 s41, s34, 5120
    s_add_u32 m0, s41, 61440
    s_nop 0
    buffer_load_dwordx4 v7, s[4:7], s40 offen lds
    s_add_u32 m0, s41, 62464
    s_nop 0
    buffer_load_dwordx4 v8, s[4:7], s40 offen lds
    s_add_u32 m0, s41, 63488
    s_nop 0
    buffer_load_dwordx4 v9, s[4:7], s40 offen lds
    s_add_u32 m0, s41, 64512
    s_nop 0
    buffer_load_dwordx4 v10, s[4:7], s40 offen lds
    s_add_u32 m0, s41, 65536
    s_nop 0
    buffer_load_dwordx4 v11, s[4:7], s40 offen lds
    s_add_u32 s42, s43, 12288
    buffer_load_dwordx4 v[64:67], v12, s[12:15], s42 offen offset:0
    s_add_u32 s42, s43, 12288
    buffer_load_dwordx4 v[68:71], v12, s[12:15], s42 offen offset:1024
    s_add_u32 s42, s43, 12288
    buffer_load_dwordx4 v[72:75], v12, s[12:15], s42 offen offset:2048
    s_add_u32 s42, s43, 12288
    buffer_load_dwordx4 v[76:79], v12, s[12:15], s42 offen offset:3072
    s_mul_i32 s40, s34, 40960
    s_add_u32 s40, s40, 655360
    s_add_u32 s40, s40, s44
    s_mul_i32 s41, s34, 5120
    s_add_u32 m0, s41, 81920
    s_nop 0
    buffer_load_dwordx4 v7, s[4:7], s40 offen lds
    s_add_u32 m0, s41, 82944
    s_nop 0
    buffer_load_dwordx4 v8, s[4:7], s40 offen lds
    s_add_u32 m0, s41, 83968
    s_nop 0
    buffer_load_dwordx4 v9, s[4:7], s40 offen lds
    s_add_u32 m0, s41, 84992
    s_nop 0
    buffer_load_dwordx4 v10, s[4:7], s40 offen lds
    s_add_u32 m0, s41, 86016
    s_nop 0
    buffer_load_dwordx4 v11, s[4:7], s40 offen lds
    s_add_u32 s42, s43, 16384
    buffer_load_dwordx4 v[80:83], v12, s[12:15], s42 offen offset:0
    s_add_u32 s42, s43, 16384
    buffer_load_dwordx4 v[84:87], v12, s[12:15], s42 offen offset:1024
    s_add_u32 s42, s43, 16384
    buffer_load_dwordx4 v[88:91], v12, s[12:15], s42 offen offset:2048
    s_add_u32 s42, s43, 16384
    buffer_load_dwordx4 v[92:95], v12, s[12:15], s42 offen offset:3072
    s_mul_i32 s40, s34, 40960
    s_add_u32 s40, s40, 819200
    s_add_u32 s40, s40, s44
    s_mul_i32 s41, s34, 5120
    s_add_u32 m0, s41, 102400
    s_nop 0
    buffer_load_dwordx4 v7, s[4:7], s40 offen lds
    s_add_u32 m0, s41, 103424
    s_nop 0
    buffer_load_dwordx4 v8, s[4:7], s40 offen lds
    s_add_u32 m0, s41, 104448
    s_nop 0
    buffer_load_dwordx4 v9, s[4:7], s40 offen lds
    s_add_u32 m0, s41, 105472
    s_nop 0
    buffer_load_dwordx4 v10, s[4:7], s40 offen lds
    s_add_u32 m0, s41, 106496
    s_nop 0
    buffer_load_dwordx4 v11, s[4:7], s40 offen lds
    s_add_u32 s42, s43, 20480
    buffer_load_dwordx4 v[96:99], v12, s[12:15], s42 offen offset:0
    s_add_u32 s42, s43, 20480
    buffer_load_dwordx4 v[100:103], v12, s[12:15], s42 offen offset:1024
    s_add_u32 s42, s43, 20480
    buffer_load_dwordx4 v[104:107], v12, s[12:15], s42 offen offset:2048
    s_add_u32 s42, s43, 20480
    buffer_load_dwordx4 v[108:111], v12, s[12:15], s42 offen offset:3072
    s_cmp_ge_u32 s34, 2
    s_cbranch_scc1 k3_y_1
    s_mul_i32 s40, s34, 40960
    s_add_u32 s40, s40, s45
    s_mul_i32 s41, s34, 5120
    s_add_u32 m0, s41, 122880
    s_nop 0
    buffer_load_dwordx4 v7, s[8:11], s40 offen lds
    s_add_u32 m0, s41, 123904
    s_nop 0
    buffer_load_dwordx4 v8, s[8:11], s40 offen lds
    s_add_u32 m0, s41, 124928
    s_nop 0
    buffer_load_dwordx4 v9, s[8:11], s40 offen lds
    s_add_u32 m0, s41, 125952
    s_nop 0
    buffer_load_dwordx4 v10, s[8:11], s40 offen lds
    s_add_u32 m0, s41, 126976
    s_nop 0
    buffer_load_dwordx4 v11, s[8:11], s40 offen lds
    s_branch k3_xy_2
k3_y_1:
    v_lshrrev_b32 v4, 3, v1
    v_lshlrev_b32 v4, 12, v4
    v_and_b32 v5, 7, v1
    v_lshlrev_b32 v5, 4, v5
    v_add_u32 v4, v4, v5
    s_sub_u32 s42, s34, 2
    s_mul_i32 s40, s42, 40
    s_mul_i32 s41, s33, 80
    s_add_u32 s40, s40, s41
    s_lshl_b32 s40, s40, 12
    s_lshl_b32 s41, s32, 7
    s_add_u32 s40, s40, s41
    s_add_u32 s40, s40, 8912896
    s_mul_i32 s41, s42, 5120
    s_add_u32 m0, s41, 133120
    s_nop 0
    buffer_load_dwordx4 v4, s[12:15], s40 offen lds
    s_add_u32 s40, s40, 32768
    s_add_u32 m0, s41, 134144
    s_nop 0
    buffer_load_dwordx4 v4, s[12:15], s40 offen lds
    s_add_u32 s40, s40, 32768
    s_add_u32 m0, s41, 135168
    s_nop 0
    buffer_load_dwordx4 v4, s[12:15], s40 offen lds
    s_add_u32 s40, s40, 32768
    s_add_u32 m0, s41, 136192
    s_nop 0
    buffer_load_dwordx4 v4, s[12:15], s40 offen lds
    s_add_u32 s40, s40, 32768
    s_add_u32 m0, s41, 137216
    s_nop 0
    buffer_load_dwordx4 v4, s[12:15], s40 offen lds
    s_add_u32 s40, s40, 32768
k3_xy_2:
    s_lshl_b32 s40, s32, 9
    s_lshl_b32 s41, s34, 7
    s_add_u32 s40, s40, s41
    s_add_u32 s40, s40, 14680064
    v_lshlrev_b32 v4, 3, v3
    buffer_load_dwordx2 v[112:113], v4, s[12:15], s40 offen
    v_lshlrev_b32 v4, 2, v2
    v_lshrrev_b32 v5, 2, v3
    v_add_u32 v4, v4, v5
    v_mul_u32_u24 v4, 160, v4
    v_and_b32 v5, 3, v3
    v_lshlrev_b32 v5, 3, v5
    v_add_u32 v114, v4, v5
    v_add_u32 v115, 61440, v114
    s_waitcnt vmcnt(55)
    s_barrier
    ds_read_b64_tr_b16 v[136:137], v114 offset:0
    ds_read_b64_tr_b16 v[138:139], v114 offset:2560
    ds_read_b64_tr_b16 v[140:141], v114 offset:32
    ds_read_b64_tr_b16 v[142:143], v114 offset:2592
    ds_read_b64_tr_b16 v[144:145], v114 offset:64
    ds_read_b64_tr_b16 v[146:147], v114 offset:2624
    ds_read_b64_tr_b16 v[148:149], v114 offset:96
    ds_read_b64_tr_b16 v[150:151], v114 offset:2656
    ds_read_b64_tr_b16 v[152:153], v114 offset:128
    ds_read_b64_tr_b16 v[154:155], v114 offset:2688
    ds_read_b64_tr_b16 v[156:157], v114 offset:5120
    ds_read_b64_tr_b16 v[158:159], v114 offset:7680
    ds_read_b64_tr_b16 v[160:161], v114 offset:5152
    ds_read_b64_tr_b16 v[162:163], v114 offset:7712
    ds_read_b64_tr_b16 v[164:165], v114 offset:5184
    ds_read_b64_tr_b16 v[166:167], v114 offset:7744
    ds_read_b64_tr_b16 v[168:169], v114 offset:5216
    ds_read_b64_tr_b16 v[170:171], v114 offset:7776
    ds_read_b64_tr_b16 v[172:173], v114 offset:5248
    ds_read_b64_tr_b16 v[174:175], v114 offset:7808
    s_waitcnt vmcnt(54)
    s_waitcnt lgkmcnt(15)
    v_mfma_f32_16x16x32_bf16 v[116:119], v[136:139], v[16:19], 0
    s_waitcnt lgkmcnt(15)
    v_mfma_f32_16x16x32_bf16 v[120:123], v[140:143], v[16:19], 0
    s_waitcnt lgkmcnt(14)
    v_mfma_f32_16x16x32_bf16 v[124:127], v[144:147], v[16:19], 0
    s_waitcnt lgkmcnt(12)
    v_mfma_f32_16x16x32_bf16 v[128:131], v[148:151], v[16:19], 0
    s_waitcnt lgkmcnt(10)
    v_mfma_f32_16x16x32_bf16 v[132:135], v[152:155], v[16:19], 0
    ds_read_b64_tr_b16 v[136:137], v114 offset:10240
    ds_read_b64_tr_b16 v[138:139], v114 offset:12800
    ds_read_b64_tr_b16 v[140:141], v114 offset:10272
    ds_read_b64_tr_b16 v[142:143], v114 offset:12832
    ds_read_b64_tr_b16 v[144:145], v114 offset:10304
    ds_read_b64_tr_b16 v[146:147], v114 offset:12864
    ds_read_b64_tr_b16 v[148:149], v114 offset:10336
    ds_read_b64_tr_b16 v[150:151], v114 offset:12896
    ds_read_b64_tr_b16 v[152:153], v114 offset:10368
    ds_read_b64_tr_b16 v[154:155], v114 offset:12928
    s_waitcnt vmcnt(53)
    s_waitcnt lgkmcnt(15)
    v_mfma_f32_16x16x32_bf16 v[116:119], v[156:159], v[20:23], v[116:119]
    s_waitcnt lgkmcnt(15)
    v_mfma_f32_16x16x32_bf16 v[120:123], v[160:163], v[20:23], v[120:123]
    s_waitcnt lgkmcnt(14)
    v_mfma_f32_16x16x32_bf16 v[124:127], v[164:167], v[20:23], v[124:127]
    s_waitcnt lgkmcnt(12)
    v_mfma_f32_16x16x32_bf16 v[128:131], v[168:171], v[20:23], v[128:131]
    s_waitcnt lgkmcnt(10)
    v_mfma_f32_16x16x32_bf16 v[132:135], v[172:175], v[20:23], v[132:135]
    ds_read_b64_tr_b16 v[156:157], v114 offset:15360
    ds_read_b64_tr_b16 v[158:159], v114 offset:17920
    ds_read_b64_tr_b16 v[160:161], v114 offset:15392
    ds_read_b64_tr_b16 v[162:163], v114 offset:17952
    ds_read_b64_tr_b16 v[164:165], v114 offset:15424
    ds_read_b64_tr_b16 v[166:167], v114 offset:17984
    ds_read_b64_tr_b16 v[168:169], v114 offset:15456
    ds_read_b64_tr_b16 v[170:171], v114 offset:18016
    ds_read_b64_tr_b16 v[172:173], v114 offset:15488
    ds_read_b64_tr_b16 v[174:175], v114 offset:18048
    s_waitcnt vmcnt(52)
    s_waitcnt lgkmcnt(15)
    v_mfma_f32_16x16x32_bf16 v[116:119], v[136:139], v[24:27], v[116:119]
    s_waitcnt lgkmcnt(15)
    v_mfma_f32_16x16x32_bf16 v[120:123], v[140:143], v[24:27], v[120:123]
    s_waitcnt lgkmcnt(14)
    v_mfma_f32_16x16x32_bf16 v[124:127], v[144:147], v[24:27], v[124:127]
    s_waitcnt lgkmcnt(12)
    v_mfma_f32_16x16x32_bf16 v[128:131], v[148:151], v[24:27], v[128:131]
    s_waitcnt lgkmcnt(10)
    v_mfma_f32_16x16x32_bf16 v[132:135], v[152:155], v[24:27], v[132:135]
    s_waitcnt vmcnt(51)
    s_waitcnt lgkmcnt(8)
    v_mfma_f32_16x16x32_bf16 v[116:119], v[156:159], v[28:31], v[116:119]
    s_waitcnt lgkmcnt(6)
    v_mfma_f32_16x16x32_bf16 v[120:123], v[160:163], v[28:31], v[120:123]
    s_waitcnt lgkmcnt(4)
    v_mfma_f32_16x16x32_bf16 v[124:127], v[164:167], v[28:31], v[124:127]
    s_waitcnt lgkmcnt(2)
    v_mfma_f32_16x16x32_bf16 v[128:131], v[168:171], v[28:31], v[128:131]
    s_waitcnt lgkmcnt(0)
    v_mfma_f32_16x16x32_bf16 v[132:135], v[172:175], v[28:31], v[132:135]
    s_waitcnt vmcnt(46)
    s_barrier
    ds_read_b64_tr_b16 v[136:137], v114 offset:20480
    ds_read_b64_tr_b16 v[138:139], v114 offset:23040
    ds_read_b64_tr_b16 v[140:141], v114 offset:20512
    ds_read_b64_tr_b16 v[142:143], v114 offset:23072
    ds_read_b64_tr_b16 v[144:145], v114 offset:20544
    ds_read_b64_tr_b16 v[146:147], v114 offset:23104
    ds_read_b64_tr_b16 v[148:149], v114 offset:20576
    ds_read_b64_tr_b16 v[150:151], v114 offset:23136
    ds_read_b64_tr_b16 v[152:153], v114 offset:20608
    ds_read_b64_tr_b16 v[154:155], v114 offset:23168
    ds_read_b64_tr_b16 v[156:157], v114 offset:25600
    ds_read_b64_tr_b16 v[158:159], v114 offset:28160
    ds_read_b64_tr_b16 v[160:161], v114 offset:25632
    ds_read_b64_tr_b16 v[162:163], v114 offset:28192
    ds_read_b64_tr_b16 v[164:165], v114 offset:25664
    ds_read_b64_tr_b16 v[166:167], v114 offset:28224
    ds_read_b64_tr_b16 v[168:169], v114 offset:25696
    ds_read_b64_tr_b16 v[170:171], v114 offset:28256
    ds_read_b64_tr_b16 v[172:173], v114 offset:25728
    ds_read_b64_tr_b16 v[174:175], v114 offset:28288
    s_waitcnt vmcnt(45)
    s_waitcnt lgkmcnt(15)
    v_mfma_f32_16x16x32_bf16 v[116:119], v[136:139], v[32:35], v[116:119]
    s_waitcnt lgkmcnt(15)
    v_mfma_f32_16x16x32_bf16 v[120:123], v[140:143], v[32:35], v[120:123]
    s_waitcnt lgkmcnt(14)
    v_mfma_f32_16x16x32_bf16 v[124:127], v[144:147], v[32:35], v[124:127]
    s_waitcnt lgkmcnt(12)
    v_mfma_f32_16x16x32_bf16 v[128:131], v[148:151], v[32:35], v[128:131]
    s_waitcnt lgkmcnt(10)
    v_mfma_f32_16x16x32_bf16 v[132:135], v[152:155], v[32:35], v[132:135]
    ds_read_b64_tr_b16 v[136:137], v114 offset:30720
    ds_read_b64_tr_b16 v[138:139], v114 offset:33280
    ds_read_b64_tr_b16 v[140:141], v114 offset:30752
    ds_read_b64_tr_b16 v[142:143], v114 offset:33312
    ds_read_b64_tr_b16 v[144:145], v114 offset:30784
    ds_read_b64_tr_b16 v[146:147], v114 offset:33344
    ds_read_b64_tr_b16 v[148:149], v114 offset:30816
    ds_read_b64_tr_b16 v[150:151], v114 offset:33376
    ds_read_b64_tr_b16 v[152:153], v114 offset:30848
    ds_read_b64_tr_b16 v[154:155], v114 offset:33408
    s_waitcnt vmcnt(44)
    s_waitcnt lgkmcnt(15)
    v_mfma_f32_16x16x32_bf16 v[116:119], v[156:159], v[36:39], v[116:119]
    s_waitcnt lgkmcnt(15)
    v_mfma_f32_16x16x32_bf16 v[120:123], v[160:163], v[36:39], v[120:123]
    s_waitcnt lgkmcnt(14)
    v_mfma_f32_16x16x32_bf16 v[124:127], v[164:167], v[36:39], v[124:127]
    s_waitcnt lgkmcnt(12)
    v_mfma_f32_16x16x32_bf16 v[128:131], v[168:171], v[36:39], v[128:131]
    s_waitcnt lgkmcnt(10)
    v_mfma_f32_16x16x32_bf16 v[132:135], v[172:175], v[36:39], v[132:135]
    ds_read_b64_tr_b16 v[156:157], v114 offset:35840
    ds_read_b64_tr_b16 v[158:159], v114 offset:38400
    ds_read_b64_tr_b16 v[160:161], v114 offset:35872
    ds_read_b64_tr_b16 v[162:163], v114 offset:38432
    ds_read_b64_tr_b16 v[164:165], v114 offset:35904
    ds_read_b64_tr_b16 v[166:167], v114 offset:38464
    ds_read_b64_tr_b16 v[168:169], v114 offset:35936
    ds_read_b64_tr_b16 v[170:171], v114 offset:38496
    ds_read_b64_tr_b16 v[172:173], v114 offset:35968
    ds_read_b64_tr_b16 v[174:175], v114 offset:38528
    s_waitcnt vmcnt(43)
    s_waitcnt lgkmcnt(15)
    v_mfma_f32_16x16x32_bf16 v[116:119], v[136:139], v[40:43], v[116:119]
    s_waitcnt lgkmcnt(15)
    v_mfma_f32_16x16x32_bf16 v[120:123], v[140:143], v[40:43], v[120:123]
    s_waitcnt lgkmcnt(14)
    v_mfma_f32_16x16x32_bf16 v[124:127], v[144:147], v[40:43], v[124:127]
    s_waitcnt lgkmcnt(12)
    v_mfma_f32_16x16x32_bf16 v[128:131], v[148:151], v[40:43], v[128:131]
    s_waitcnt lgkmcnt(10)
    v_mfma_f32_16x16x32_bf16 v[132:135], v[152:155], v[40:43], v[132:135]
    s_waitcnt vmcnt(42)
    s_waitcnt lgkmcnt(8)
    v_mfma_f32_16x16x32_bf16 v[116:119], v[156:159], v[44:47], v[116:119]
    s_waitcnt lgkmcnt(6)
    v_mfma_f32_16x16x32_bf16 v[120:123], v[160:163], v[44:47], v[120:123]
    s_waitcnt lgkmcnt(4)
    v_mfma_f32_16x16x32_bf16 v[124:127], v[164:167], v[44:47], v[124:127]
    s_waitcnt lgkmcnt(2)
    v_mfma_f32_16x16x32_bf16 v[128:131], v[168:171], v[44:47], v[128:131]
    s_waitcnt lgkmcnt(0)
    v_mfma_f32_16x16x32_bf16 v[132:135], v[172:175], v[44:47], v[132:135]
    s_waitcnt vmcnt(37)
    s_barrier
    ds_read_b64_tr_b16 v[136:137], v114 offset:40960
    ds_read_b64_tr_b16 v[138:139], v114 offset:43520
    ds_read_b64_tr_b16 v[140:141], v114 offset:40992
    ds_read_b64_tr_b16 v[142:143], v114 offset:43552
    ds_read_b64_tr_b16 v[144:145], v114 offset:41024
    ds_read_b64_tr_b16 v[146:147], v114 offset:43584
    ds_read_b64_tr_b16 v[148:149], v114 offset:41056
    ds_read_b64_tr_b16 v[150:151], v114 offset:43616
    ds_read_b64_tr_b16 v[152:153], v114 offset:41088
    ds_read_b64_tr_b16 v[154:155], v114 offset:43648
    ds_read_b64_tr_b16 v[156:157], v114 offset:46080
    ds_read_b64_tr_b16 v[158:159], v114 offset:48640
    ds_read_b64_tr_b16 v[160:161], v114 offset:46112
    ds_read_b64_tr_b16 v[162:163], v114 offset:48672
    ds_read_b64_tr_b16 v[164:165], v114 offset:46144
    ds_read_b64_tr_b16 v[166:167], v114 offset:48704
    ds_read_b64_tr_b16 v[168:169], v114 offset:46176
    ds_read_b64_tr_b16 v[170:171], v114 offset:48736
    ds_read_b64_tr_b16 v[172:173], v114 offset:46208
    ds_read_b64_tr_b16 v[174:175], v114 offset:48768
    s_waitcnt vmcnt(36)
    s_waitcnt lgkmcnt(15)
    v_mfma_f32_16x16x32_bf16 v[116:119], v[136:139], v[48:51], v[116:119]
    s_waitcnt lgkmcnt(15)
    v_mfma_f32_16x16x32_bf16 v[120:123], v[140:143], v[48:51], v[120:123]
    s_waitcnt lgkmcnt(14)
    v_mfma_f32_16x16x32_bf16 v[124:127], v[144:147], v[48:51], v[124:127]
    s_waitcnt lgkmcnt(12)
    v_mfma_f32_16x16x32_bf16 v[128:131], v[148:151], v[48:51], v[128:131]
    s_waitcnt lgkmcnt(10)
    v_mfma_f32_16x16x32_bf16 v[132:135], v[152:155], v[48:51], v[132:135]
    ds_read_b64_tr_b16 v[136:137], v114 offset:51200
    ds_read_b64_tr_b16 v[138:139], v114 offset:53760
    ds_read_b64_tr_b16 v[140:141], v114 offset:51232
    ds_read_b64_tr_b16 v[142:143], v114 offset:53792
    ds_read_b64_tr_b16 v[144:145], v114 offset:51264
    ds_read_b64_tr_b16 v[146:147], v114 offset:53824
    ds_read_b64_tr_b16 v[148:149], v114 offset:51296
    ds_read_b64_tr_b16 v[150:151], v114 offset:53856
    ds_read_b64_tr_b16 v[152:153], v114 offset:51328
    ds_read_b64_tr_b16 v[154:155], v114 offset:53888
    s_waitcnt vmcnt(35)
    s_waitcnt lgkmcnt(15)
    v_mfma_f32_16x16x32_bf16 v[116:119], v[156:159], v[52:55], v[116:119]
    s_waitcnt lgkmcnt(15)
    v_mfma_f32_16x16x32_bf16 v[120:123], v[160:163], v[52:55], v[120:123]
    s_waitcnt lgkmcnt(14)
    v_mfma_f32_16x16x32_bf16 v[124:127], v[164:167], v[52:55], v[124:127]
    s_waitcnt lgkmcnt(12)
    v_mfma_f32_16x16x32_bf16 v[128:131], v[168:171], v[52:55], v[128:131]
    s_waitcnt lgkmcnt(10)
    v_mfma_f32_16x16x32_bf16 v[132:135], v[172:175], v[52:55], v[132:135]
    ds_read_b64_tr_b16 v[156:157], v114 offset:56320
    ds_read_b64_tr_b16 v[158:159], v114 offset:58880
    ds_read_b64_tr_b16 v[160:161], v114 offset:56352
    ds_read_b64_tr_b16 v[162:163], v114 offset:58912
    ds_read_b64_tr_b16 v[164:165], v114 offset:56384
    ds_read_b64_tr_b16 v[166:167], v114 offset:58944
    ds_read_b64_tr_b16 v[168:169], v114 offset:56416
    ds_read_b64_tr_b16 v[170:171], v114 offset:58976
    ds_read_b64_tr_b16 v[172:173], v114 offset:56448
    ds_read_b64_tr_b16 v[174:175], v114 offset:59008
    s_waitcnt vmcnt(34)
    s_waitcnt lgkmcnt(15)
    v_mfma_f32_16x16x32_bf16 v[116:119], v[136:139], v[56:59], v[116:119]
    s_waitcnt lgkmcnt(15)
    v_mfma_f32_16x16x32_bf16 v[120:123], v[140:143], v[56:59], v[120:123]
    s_waitcnt lgkmcnt(14)
    v_mfma_f32_16x16x32_bf16 v[124:127], v[144:147], v[56:59], v[124:127]
    s_waitcnt lgkmcnt(12)
    v_mfma_f32_16x16x32_bf16 v[128:131], v[148:151], v[56:59], v[128:131]
    s_waitcnt lgkmcnt(10)
    v_mfma_f32_16x16x32_bf16 v[132:135], v[152:155], v[56:59], v[132:135]
    s_waitcnt vmcnt(33)
    s_waitcnt lgkmcnt(8)
    v_mfma_f32_16x16x32_bf16 v[116:119], v[156:159], v[60:63], v[116:119]
    s_waitcnt lgkmcnt(6)
    v_mfma_f32_16x16x32_bf16 v[120:123], v[160:163], v[60:63], v[120:123]
    s_waitcnt lgkmcnt(4)
    v_mfma_f32_16x16x32_bf16 v[124:127], v[164:167], v[60:63], v[124:127]
    s_waitcnt lgkmcnt(2)
    v_mfma_f32_16x16x32_bf16 v[128:131], v[168:171], v[60:63], v[128:131]
    s_waitcnt lgkmcnt(0)
    v_mfma_f32_16x16x32_bf16 v[132:135], v[172:175], v[60:63], v[132:135]
    s_waitcnt vmcnt(28)
    s_barrier
    ds_read_b64_tr_b16 v[136:137], v115 offset:0
    ds_read_b64_tr_b16 v[138:139], v115 offset:2560
    ds_read_b64_tr_b16 v[140:141], v115 offset:32
    ds_read_b64_tr_b16 v[142:143], v115 offset:2592
    ds_read_b64_tr_b16 v[144:145], v115 offset:64
    ds_read_b64_tr_b16 v[146:147], v115 offset:2624
    ds_read_b64_tr_b16 v[148:149], v115 offset:96
    ds_read_b64_tr_b16 v[150:151], v115 offset:2656
    ds_read_b64_tr_b16 v[152:153], v115 offset:128
    ds_read_b64_tr_b16 v[154:155], v115 offset:2688
    ds_read_b64_tr_b16 v[156:157], v115 offset:5120
    ds_read_b64_tr_b16 v[158:159], v115 offset:7680
    ds_read_b64_tr_b16 v[160:161], v115 offset:5152
    ds_read_b64_tr_b16 v[162:163], v115 offset:7712
    ds_read_b64_tr_b16 v[164:165], v115 offset:5184
    ds_read_b64_tr_b16 v[166:167], v115 offset:7744
    ds_read_b64_tr_b16 v[168:169], v115 offset:5216
    ds_read_b64_tr_b16 v[170:171], v115 offset:7776
    ds_read_b64_tr_b16 v[172:173], v115 offset:5248
    ds_read_b64_tr_b16 v[174:175], v115 offset:7808
    s_waitcnt vmcnt(27)
    s_waitcnt lgkmcnt(15)
    v_mfma_f32_16x16x32_bf16 v[116:119], v[136:139], v[64:67], v[116:119]
    s_waitcnt lgkmcnt(15)
    v_mfma_f32_16x16x32_bf16 v[120:123], v[140:143], v[64:67], v[120:123]
    s_waitcnt lgkmcnt(14)
    v_mfma_f32_16x16x32_bf16 v[124:127], v[144:147], v[64:67], v[124:127]
    s_waitcnt lgkmcnt(12)
    v_mfma_f32_16x16x32_bf16 v[128:131], v[148:151], v[64:67], v[128:131]
    s_waitcnt lgkmcnt(10)
    v_mfma_f32_16x16x32_bf16 v[132:135], v[152:155], v[64:67], v[132:135]
    ds_read_b64_tr_b16 v[136:137], v115 offset:10240
    ds_read_b64_tr_b16 v[138:139], v115 offset:12800
    ds_read_b64_tr_b16 v[140:141], v115 offset:10272
    ds_read_b64_tr_b16 v[142:143], v115 offset:12832
    ds_read_b64_tr_b16 v[144:145], v115 offset:10304
    ds_read_b64_tr_b16 v[146:147], v115 offset:12864
    ds_read_b64_tr_b16 v[148:149], v115 offset:10336
    ds_read_b64_tr_b16 v[150:151], v115 offset:12896
    ds_read_b64_tr_b16 v[152:153], v115 offset:10368
    ds_read_b64_tr_b16 v[154:155], v115 offset:12928
    s_waitcnt vmcnt(26)
    s_waitcnt lgkmcnt(15)
    v_mfma_f32_16x16x32_bf16 v[116:119], v[156:159], v[68:71], v[116:119]
    s_waitcnt lgkmcnt(15)
    v_mfma_f32_16x16x32_bf16 v[120:123], v[160:163], v[68:71], v[120:123]
    s_waitcnt lgkmcnt(14)
    v_mfma_f32_16x16x32_bf16 v[124:127], v[164:167], v[68:71], v[124:127]
    s_waitcnt lgkmcnt(12)
    v_mfma_f32_16x16x32_bf16 v[128:131], v[168:171], v[68:71], v[128:131]
    s_waitcnt lgkmcnt(10)
    v_mfma_f32_16x16x32_bf16 v[132:135], v[172:175], v[68:71], v[132:135]
    ds_read_b64_tr_b16 v[156:157], v115 offset:15360
    ds_read_b64_tr_b16 v[158:159], v115 offset:17920
    ds_read_b64_tr_b16 v[160:161], v115 offset:15392
    ds_read_b64_tr_b16 v[162:163], v115 offset:17952
    ds_read_b64_tr_b16 v[164:165], v115 offset:15424
    ds_read_b64_tr_b16 v[166:167], v115 offset:17984
    ds_read_b64_tr_b16 v[168:169], v115 offset:15456
    ds_read_b64_tr_b16 v[170:171], v115 offset:18016
    ds_read_b64_tr_b16 v[172:173], v115 offset:15488
    ds_read_b64_tr_b16 v[174:175], v115 offset:18048
    s_waitcnt vmcnt(25)
    s_waitcnt lgkmcnt(15)
    v_mfma_f32_16x16x32_bf16 v[116:119], v[136:139], v[72:75], v[116:119]
    s_waitcnt lgkmcnt(15)
    v_mfma_f32_16x16x32_bf16 v[120:123], v[140:143], v[72:75], v[120:123]
    s_waitcnt lgkmcnt(14)
    v_mfma_f32_16x16x32_bf16 v[124:127], v[144:147], v[72:75], v[124:127]
    s_waitcnt lgkmcnt(12)
    v_mfma_f32_16x16x32_bf16 v[128:131], v[148:151], v[72:75], v[128:131]
    s_waitcnt lgkmcnt(10)
    v_mfma_f32_16x16x32_bf16 v[132:135], v[152:155], v[72:75], v[132:135]
    s_waitcnt vmcnt(24)
    s_waitcnt lgkmcnt(8)
    v_mfma_f32_16x16x32_bf16 v[116:119], v[156:159], v[76:79], v[116:119]
    s_waitcnt lgkmcnt(6)
    v_mfma_f32_16x16x32_bf16 v[120:123], v[160:163], v[76:79], v[120:123]
    s_waitcnt lgkmcnt(4)
    v_mfma_f32_16x16x32_bf16 v[124:127], v[164:167], v[76:79], v[124:127]
    s_waitcnt lgkmcnt(2)
    v_mfma_f32_16x16x32_bf16 v[128:131], v[168:171], v[76:79], v[128:131]
    s_waitcnt lgkmcnt(0)
    v_mfma_f32_16x16x32_bf16 v[132:135], v[172:175], v[76:79], v[132:135]
    s_waitcnt vmcnt(19)
    s_barrier
    ds_read_b64_tr_b16 v[136:137], v115 offset:20480
    ds_read_b64_tr_b16 v[138:139], v115 offset:23040
    ds_read_b64_tr_b16 v[140:141], v115 offset:20512
    ds_read_b64_tr_b16 v[142:143], v115 offset:23072
    ds_read_b64_tr_b16 v[144:145], v115 offset:20544
    ds_read_b64_tr_b16 v[146:147], v115 offset:23104
    ds_read_b64_tr_b16 v[148:149], v115 offset:20576
    ds_read_b64_tr_b16 v[150:151], v115 offset:23136
    ds_read_b64_tr_b16 v[152:153], v115 offset:20608
    ds_read_b64_tr_b16 v[154:155], v115 offset:23168
    ds_read_b64_tr_b16 v[156:157], v115 offset:25600
    ds_read_b64_tr_b16 v[158:159], v115 offset:28160
    ds_read_b64_tr_b16 v[160:161], v115 offset:25632
    ds_read_b64_tr_b16 v[162:163], v115 offset:28192
    ds_read_b64_tr_b16 v[164:165], v115 offset:25664
    ds_read_b64_tr_b16 v[166:167], v115 offset:28224
    ds_read_b64_tr_b16 v[168:169], v115 offset:25696
    ds_read_b64_tr_b16 v[170:171], v115 offset:28256
    ds_read_b64_tr_b16 v[172:173], v115 offset:25728
    ds_read_b64_tr_b16 v[174:175], v115 offset:28288
    s_waitcnt vmcnt(18)
    s_waitcnt lgkmcnt(15)
    v_mfma_f32_16x16x32_bf16 v[116:119], v[136:139], v[80:83], v[116:119]
    s_waitcnt lgkmcnt(15)
    v_mfma_f32_16x16x32_bf16 v[120:123], v[140:143], v[80:83], v[120:123]
    s_waitcnt lgkmcnt(14)
    v_mfma_f32_16x16x32_bf16 v[124:127], v[144:147], v[80:83], v[124:127]
    s_waitcnt lgkmcnt(12)
    v_mfma_f32_16x16x32_bf16 v[128:131], v[148:151], v[80:83], v[128:131]
    s_waitcnt lgkmcnt(10)
    v_mfma_f32_16x16x32_bf16 v[132:135], v[152:155], v[80:83], v[132:135]
    ds_read_b64_tr_b16 v[136:137], v115 offset:30720
    ds_read_b64_tr_b16 v[138:139], v115 offset:33280
    ds_read_b64_tr_b16 v[140:141], v115 offset:30752
    ds_read_b64_tr_b16 v[142:143], v115 offset:33312
    ds_read_b64_tr_b16 v[144:145], v115 offset:30784
    ds_read_b64_tr_b16 v[146:147], v115 offset:33344
    ds_read_b64_tr_b16 v[148:149], v115 offset:30816
    ds_read_b64_tr_b16 v[150:151], v115 offset:33376
    ds_read_b64_tr_b16 v[152:153], v115 offset:30848
    ds_read_b64_tr_b16 v[154:155], v115 offset:33408
    s_waitcnt vmcnt(17)
    s_waitcnt lgkmcnt(15)
    v_mfma_f32_16x16x32_bf16 v[116:119], v[156:159], v[84:87], v[116:119]
    s_waitcnt lgkmcnt(15)
    v_mfma_f32_16x16x32_bf16 v[120:123], v[160:163], v[84:87], v[120:123]
    s_waitcnt lgkmcnt(14)
    v_mfma_f32_16x16x32_bf16 v[124:127], v[164:167], v[84:87], v[124:127]
    s_waitcnt lgkmcnt(12)
    v_mfma_f32_16x16x32_bf16 v[128:131], v[168:171], v[84:87], v[128:131]
    s_waitcnt lgkmcnt(10)
    v_mfma_f32_16x16x32_bf16 v[132:135], v[172:175], v[84:87], v[132:135]
    ds_read_b64_tr_b16 v[156:157], v115 offset:35840
    ds_read_b64_tr_b16 v[158:159], v115 offset:38400
    ds_read_b64_tr_b16 v[160:161], v115 offset:35872
    ds_read_b64_tr_b16 v[162:163], v115 offset:38432
    ds_read_b64_tr_b16 v[164:165], v115 offset:35904
    ds_read_b64_tr_b16 v[166:167], v115 offset:38464
    ds_read_b64_tr_b16 v[168:169], v115 offset:35936
    ds_read_b64_tr_b16 v[170:171], v115 offset:38496
    ds_read_b64_tr_b16 v[172:173], v115 offset:35968
    ds_read_b64_tr_b16 v[174:175], v115 offset:38528
    s_waitcnt vmcnt(16)
    s_waitcnt lgkmcnt(15)
    v_mfma_f32_16x16x32_bf16 v[116:119], v[136:139], v[88:91], v[116:119]
    s_waitcnt lgkmcnt(15)
    v_mfma_f32_16x16x32_bf16 v[120:123], v[140:143], v[88:91], v[120:123]
    s_waitcnt lgkmcnt(14)
    v_mfma_f32_16x16x32_bf16 v[124:127], v[144:147], v[88:91], v[124:127]
    s_waitcnt lgkmcnt(12)
    v_mfma_f32_16x16x32_bf16 v[128:131], v[148:151], v[88:91], v[128:131]
    s_waitcnt lgkmcnt(10)
    v_mfma_f32_16x16x32_bf16 v[132:135], v[152:155], v[88:91], v[132:135]
    s_waitcnt vmcnt(15)
    s_waitcnt lgkmcnt(8)
    v_mfma_f32_16x16x32_bf16 v[116:119], v[156:159], v[92:95], v[116:119]
    s_waitcnt lgkmcnt(6)
    v_mfma_f32_16x16x32_bf16 v[120:123], v[160:163], v[92:95], v[120:123]
    s_waitcnt lgkmcnt(4)
    v_mfma_f32_16x16x32_bf16 v[124:127], v[164:167], v[92:95], v[124:127]
    s_waitcnt lgkmcnt(2)
    v_mfma_f32_16x16x32_bf16 v[128:131], v[168:171], v[92:95], v[128:131]
    s_waitcnt lgkmcnt(0)
    v_mfma_f32_16x16x32_bf16 v[132:135], v[172:175], v[92:95], v[132:135]
    s_waitcnt vmcnt(10)
    s_barrier
    ds_read_b64_tr_b16 v[136:137], v115 offset:40960
    ds_read_b64_tr_b16 v[138:139], v115 offset:43520
    ds_read_b64_tr_b16 v[140:141], v115 offset:40992
    ds_read_b64_tr_b16 v[142:143], v115 offset:43552
    ds_read_b64_tr_b16 v[144:145], v115 offset:41024
    ds_read_b64_tr_b16 v[146:147], v115 offset:43584
    ds_read_b64_tr_b16 v[148:149], v115 offset:41056
    ds_read_b64_tr_b16 v[150:151], v115 offset:43616
    ds_read_b64_tr_b16 v[152:153], v115 offset:41088
    ds_read_b64_tr_b16 v[154:155], v115 offset:43648
    ds_read_b64_tr_b16 v[156:157], v115 offset:46080
    ds_read_b64_tr_b16 v[158:159], v115 offset:48640
    ds_read_b64_tr_b16 v[160:161], v115 offset:46112
    ds_read_b64_tr_b16 v[162:163], v115 offset:48672
    ds_read_b64_tr_b16 v[164:165], v115 offset:46144
    ds_read_b64_tr_b16 v[166:167], v115 offset:48704
    ds_read_b64_tr_b16 v[168:169], v115 offset:46176
    ds_read_b64_tr_b16 v[170:171], v115 offset:48736
    ds_read_b64_tr_b16 v[172:173], v115 offset:46208
    ds_read_b64_tr_b16 v[174:175], v115 offset:48768
    s_waitcnt vmcnt(9)
    s_waitcnt lgkmcnt(15)
    v_mfma_f32_16x16x32_bf16 v[116:119], v[136:139], v[96:99], v[116:119]
    s_waitcnt lgkmcnt(15)
    v_mfma_f32_16x16x32_bf16 v[120:123], v[140:143], v[96:99], v[120:123]
    s_waitcnt lgkmcnt(14)
    v_mfma_f32_16x16x32_bf16 v[124:127], v[144:147], v[96:99], v[124:127]
    s_waitcnt lgkmcnt(12)
    v_mfma_f32_16x16x32_bf16 v[128:131], v[148:151], v[96:99], v[128:131]
    s_waitcnt lgkmcnt(10)
    v_mfma_f32_16x16x32_bf16 v[132:135], v[152:155], v[96:99], v[132:135]
    ds_read_b64_tr_b16 v[136:137], v115 offset:51200
    ds_read_b64_tr_b16 v[138:139], v115 offset:53760
    ds_read_b64_tr_b16 v[140:141], v115 offset:51232
    ds_read_b64_tr_b16 v[142:143], v115 offset:53792
    ds_read_b64_tr_b16 v[144:145], v115 offset:51264
    ds_read_b64_tr_b16 v[146:147], v115 offset:53824
    ds_read_b64_tr_b16 v[148:149], v115 offset:51296
    ds_read_b64_tr_b16 v[150:151], v115 offset:53856
    ds_read_b64_tr_b16 v[152:153], v115 offset:51328
    ds_read_b64_tr_b16 v[154:155], v115 offset:53888
    s_waitcnt vmcnt(8)
    s_waitcnt lgkmcnt(15)
    v_mfma_f32_16x16x32_bf16 v[116:119], v[156:159], v[100:103], v[116:119]
    s_waitcnt lgkmcnt(15)
    v_mfma_f32_16x16x32_bf16 v[120:123], v[160:163], v[100:103], v[120:123]
    s_waitcnt lgkmcnt(14)
    v_mfma_f32_16x16x32_bf16 v[124:127], v[164:167], v[100:103], v[124:127]
    s_waitcnt lgkmcnt(12)
    v_mfma_f32_16x16x32_bf16 v[128:131], v[168:171], v[100:103], v[128:131]
    s_waitcnt lgkmcnt(10)
    v_mfma_f32_16x16x32_bf16 v[132:135], v[172:175], v[100:103], v[132:135]
    ds_read_b64_tr_b16 v[156:157], v115 offset:56320
    ds_read_b64_tr_b16 v[158:159], v115 offset:58880
    ds_read_b64_tr_b16 v[160:161], v115 offset:56352
    ds_read_b64_tr_b16 v[162:163], v115 offset:58912
    ds_read_b64_tr_b16 v[164:165], v115 offset:56384
    ds_read_b64_tr_b16 v[166:167], v115 offset:58944
    ds_read_b64_tr_b16 v[168:169], v115 offset:56416
    ds_read_b64_tr_b16 v[170:171], v115 offset:58976
    ds_read_b64_tr_b16 v[172:173], v115 offset:56448
    ds_read_b64_tr_b16 v[174:175], v115 offset:59008
    s_waitcnt vmcnt(7)
    s_waitcnt lgkmcnt(15)
    v_mfma_f32_16x16x32_bf16 v[116:119], v[136:139], v[104:107], v[116:119]
    s_waitcnt lgkmcnt(15)
    v_mfma_f32_16x16x32_bf16 v[120:123], v[140:143], v[104:107], v[120:123]
    s_waitcnt lgkmcnt(14)
    v_mfma_f32_16x16x32_bf16 v[124:127], v[144:147], v[104:107], v[124:127]
    s_waitcnt lgkmcnt(12)
    v_mfma_f32_16x16x32_bf16 v[128:131], v[148:151], v[104:107], v[128:131]
    s_waitcnt lgkmcnt(10)
    v_mfma_f32_16x16x32_bf16 v[132:135], v[152:155], v[104:107], v[132:135]
    s_waitcnt vmcnt(6)
    s_waitcnt lgkmcnt(8)
    v_mfma_f32_16x16x32_bf16 v[116:119], v[156:159], v[108:111], v[116:119]
    s_waitcnt lgkmcnt(6)
    v_mfma_f32_16x16x32_bf16 v[120:123], v[160:163], v[108:111], v[120:123]
    s_waitcnt lgkmcnt(4)
    v_mfma_f32_16x16x32_bf16 v[124:127], v[164:167], v[108:111], v[124:127]
    s_waitcnt lgkmcnt(2)
    v_mfma_f32_16x16x32_bf16 v[128:131], v[168:171], v[108:111], v[128:131]
    s_waitcnt lgkmcnt(0)
    v_mfma_f32_16x16x32_bf16 v[132:135], v[172:175], v[108:111], v[132:135]
    s_waitcnt vmcnt(0)
    s_barrier
    s_lshl_b32 s40, s34, 4
    v_add_u32 v4, s40, v3
    v_mul_u32_u24 v4, 160, v4
    v_lshlrev_b32 v5, 3, v2
    v_add_u32 v176, v4, v5
    v_add_u32 v177, 122880, v176
    ds_read_b64 v[136:137], v177 offset:0
    ds_read_b64 v[138:139], v177 offset:32
    ds_read_b64 v[140:141], v177 offset:64
    ds_read_b64 v[142:143], v177 offset:96
    ds_read_b64 v[144:145], v177 offset:128
    v_lshlrev_b32 v4, 2, v2
    v_lshrrev_b32 v5, 2, v3
    v_add_u32 v4, v4, v5
    v_lshlrev_b32 v4, 7, v4
    v_and_b32 v5, 3, v3
    v_lshlrev_b32 v5, 3, v5
    v_add_u32 v4, v4, v5
    s_lshl_b32 s40, s34, 5
    s_add_u32 s40, s40, 133120
    v_add_u32 v4, s40, v4
    ds_read_b64_tr_b16 v[146:147], v4 offset:0
    ds_read_b64_tr_b16 v[148:149], v4 offset:2048
    ds_read_b64_tr_b16 v[150:151], v4 offset:4096
    ds_read_b64_tr_b16 v[152:153], v4 offset:6144
    ds_read_b64_tr_b16 v[154:155], v4 offset:8192
    s_waitcnt lgkmcnt(0)
    s_mov_b32 s46, 0xbfb8aa3b
    v_lshlrev_b32 v156, 16, v136
    v_and_b32 v157, 0xffff0000, v136
    v_lshlrev_b32 v158, 16, v146
    v_and_b32 v159, 0xffff0000, v146
    v_mul_f32 v160, s46, v116
    v_mul_f32 v161, s46, v117
    v_exp_f32 v160, v160
    v_exp_f32 v161, v161
    v_add_f32 v160, 1.0, v160
    v_add_f32 v161, 1.0, v161
    v_rcp_f32 v160, v160
    v_rcp_f32 v161, v161
    v_mul_f32 v160, v160, v116
    v_mul_f32 v161, v161, v117
    v_sub_f32 v162, v156, v112
    v_mul_f32 v162, v162, v113
    v_mul_f32 v162, v162, v158
    v_fma_f32 v156, v162, v160, v156
    v_sub_f32 v162, v157, v112
    v_mul_f32 v162, v162, v113
    v_mul_f32 v162, v162, v159
    v_fma_f32 v157, v162, v161, v157
    v_cvt_pk_bf16_f32 v16, v156, v157
    v_lshlrev_b32 v156, 16, v137
    v_and_b32 v157, 0xffff0000, v137
    v_lshlrev_b32 v158, 16, v147
    v_and_b32 v159, 0xffff0000, v147
    v_mul_f32 v160, s46, v118
    v_mul_f32 v161, s46, v119
    v_exp_f32 v160, v160
    v_exp_f32 v161, v161
    v_add_f32 v160, 1.0, v160
    v_add_f32 v161, 1.0, v161
    v_rcp_f32 v160, v160
    v_rcp_f32 v161, v161
    v_mul_f32 v160, v160, v118
    v_mul_f32 v161, v161, v119
    v_sub_f32 v162, v156, v112
    v_mul_f32 v162, v162, v113
    v_mul_f32 v162, v162, v158
    v_fma_f32 v156, v162, v160, v156
    v_sub_f32 v162, v157, v112
    v_mul_f32 v162, v162, v113
    v_mul_f32 v162, v162, v159
    v_fma_f32 v157, v162, v161, v157
    v_cvt_pk_bf16_f32 v17, v156, v157
    v_lshlrev_b32 v156, 16, v138
    v_and_b32 v157, 0xffff0000, v138
    v_lshlrev_b32 v158, 16, v148
    v_and_b32 v159, 0xffff0000, v148
    v_mul_f32 v160, s46, v120
    v_mul_f32 v161, s46, v121
    v_exp_f32 v160, v160
    v_exp_f32 v161, v161
    v_add_f32 v160, 1.0, v160
    v_add_f32 v161, 1.0, v161
    v_rcp_f32 v160, v160
    v_rcp_f32 v161, v161
    v_mul_f32 v160, v160, v120
    v_mul_f32 v161, v161, v121
    v_sub_f32 v162, v156, v112
    v_mul_f32 v162, v162, v113
    v_mul_f32 v162, v162, v158
    v_fma_f32 v156, v162, v160, v156
    v_sub_f32 v162, v157, v112
    v_mul_f32 v162, v162, v113
    v_mul_f32 v162, v162, v159
    v_fma_f32 v157, v162, v161, v157
    v_cvt_pk_bf16_f32 v18, v156, v157
    v_lshlrev_b32 v156, 16, v139
    v_and_b32 v157, 0xffff0000, v139
    v_lshlrev_b32 v158, 16, v149
    v_and_b32 v159, 0xffff0000, v149
    v_mul_f32 v160, s46, v122
    v_mul_f32 v161, s46, v123
    v_exp_f32 v160, v160
    v_exp_f32 v161, v161
    v_add_f32 v160, 1.0, v160
    v_add_f32 v161, 1.0, v161
    v_rcp_f32 v160, v160
    v_rcp_f32 v161, v161
    v_mul_f32 v160, v160, v122
    v_mul_f32 v161, v161, v123
    v_sub_f32 v162, v156, v112
    v_mul_f32 v162, v162, v113
    v_mul_f32 v162, v162, v158
    v_fma_f32 v156, v162, v160, v156
    v_sub_f32 v162, v157, v112
    v_mul_f32 v162, v162, v113
    v_mul_f32 v162, v162, v159
    v_fma_f32 v157, v162, v161, v157
    v_cvt_pk_bf16_f32 v19, v156, v157
    v_lshlrev_b32 v156, 16, v140
    v_and_b32 v157, 0xffff0000, v140
    v_lshlrev_b32 v158, 16, v150
    v_and_b32 v159, 0xffff0000, v150
    v_mul_f32 v160, s46, v124
    v_mul_f32 v161, s46, v125
    v_exp_f32 v160, v160
    v_exp_f32 v161, v161
    v_add_f32 v160, 1.0, v160
    v_add_f32 v161, 1.0, v161
    v_rcp_f32 v160, v160
    v_rcp_f32 v161, v161
    v_mul_f32 v160, v160, v124
    v_mul_f32 v161, v161, v125
    v_sub_f32 v162, v156, v112
    v_mul_f32 v162, v162, v113
    v_mul_f32 v162, v162, v158
    v_fma_f32 v156, v162, v160, v156
    v_sub_f32 v162, v157, v112
    v_mul_f32 v162, v162, v113
    v_mul_f32 v162, v162, v159
    v_fma_f32 v157, v162, v161, v157
    v_cvt_pk_bf16_f32 v20, v156, v157
    v_lshlrev_b32 v156, 16, v141
    v_and_b32 v157, 0xffff0000, v141
    v_lshlrev_b32 v158, 16, v151
    v_and_b32 v159, 0xffff0000, v151
    v_mul_f32 v160, s46, v126
    v_mul_f32 v161, s46, v127
    v_exp_f32 v160, v160
    v_exp_f32 v161, v161
    v_add_f32 v160, 1.0, v160
    v_add_f32 v161, 1.0, v161
    v_rcp_f32 v160, v160
    v_rcp_f32 v161, v161
    v_mul_f32 v160, v160, v126
    v_mul_f32 v161, v161, v127
    v_sub_f32 v162, v156, v112
    v_mul_f32 v162, v162, v113
    v_mul_f32 v162, v162, v158
    v_fma_f32 v156, v162, v160, v156
    v_sub_f32 v162, v157, v112
    v_mul_f32 v162, v162, v113
    v_mul_f32 v162, v162, v159
    v_fma_f32 v157, v162, v161, v157
    v_cvt_pk_bf16_f32 v21, v156, v157
    v_lshlrev_b32 v156, 16, v142
    v_and_b32 v157, 0xffff0000, v142
    v_lshlrev_b32 v158, 16, v152
    v_and_b32 v159, 0xffff0000, v152
    v_mul_f32 v160, s46, v128
    v_mul_f32 v161, s46, v129
    v_exp_f32 v160, v160
    v_exp_f32 v161, v161
    v_add_f32 v160, 1.0, v160
    v_add_f32 v161, 1.0, v161
    v_rcp_f32 v160, v160
    v_rcp_f32 v161, v161
    v_mul_f32 v160, v160, v128
    v_mul_f32 v161, v161, v129
    v_sub_f32 v162, v156, v112
    v_mul_f32 v162, v162, v113
    v_mul_f32 v162, v162, v158
    v_fma_f32 v156, v162, v160, v156
    v_sub_f32 v162, v157, v112
    v_mul_f32 v162, v162, v113
    v_mul_f32 v162, v162, v159
    v_fma_f32 v157, v162, v161, v157
    v_cvt_pk_bf16_f32 v22, v156, v157
    v_lshlrev_b32 v156, 16, v143
    v_and_b32 v157, 0xffff0000, v143
    v_lshlrev_b32 v158, 16, v153
    v_and_b32 v159, 0xffff0000, v153
    v_mul_f32 v160, s46, v130
    v_mul_f32 v161, s46, v131
    v_exp_f32 v160, v160
    v_exp_f32 v161, v161
    v_add_f32 v160, 1.0, v160
    v_add_f32 v161, 1.0, v161
    v_rcp_f32 v160, v160
    v_rcp_f32 v161, v161
    v_mul_f32 v160, v160, v130
    v_mul_f32 v161, v161, v131
    v_sub_f32 v162, v156, v112
    v_mul_f32 v162, v162, v113
    v_mul_f32 v162, v162, v158
    v_fma_f32 v156, v162, v160, v156
    v_sub_f32 v162, v157, v112
    v_mul_f32 v162, v162, v113
    v_mul_f32 v162, v162, v159
    v_fma_f32 v157, v162, v161, v157
    v_cvt_pk_bf16_f32 v23, v156, v157
    v_lshlrev_b32 v156, 16, v144
    v_and_b32 v157, 0xffff0000, v144
    v_lshlrev_b32 v158, 16, v154
    v_and_b32 v159, 0xffff0000, v154
    v_mul_f32 v160, s46, v132
    v_mul_f32 v161, s46, v133
    v_exp_f32 v160, v160
    v_exp_f32 v161, v161
    v_add_f32 v160, 1.0, v160
    v_add_f32 v161, 1.0, v161
    v_rcp_f32 v160, v160
    v_rcp_f32 v161, v161
    v_mul_f32 v160, v160, v132
    v_mul_f32 v161, v161, v133
    v_sub_f32 v162, v156, v112
    v_mul_f32 v162, v162, v113
    v_mul_f32 v162, v162, v158
    v_fma_f32 v156, v162, v160, v156
    v_sub_f32 v162, v157, v112
    v_mul_f32 v162, v162, v113
    v_mul_f32 v162, v162, v159
    v_fma_f32 v157, v162, v161, v157
    v_cvt_pk_bf16_f32 v24, v156, v157
    v_lshlrev_b32 v156, 16, v145
    v_and_b32 v157, 0xffff0000, v145
    v_lshlrev_b32 v158, 16, v155
    v_and_b32 v159, 0xffff0000, v155
    v_mul_f32 v160, s46, v134
    v_mul_f32 v161, s46, v135
    v_exp_f32 v160, v160
    v_exp_f32 v161, v161
    v_add_f32 v160, 1.0, v160
    v_add_f32 v161, 1.0, v161
    v_rcp_f32 v160, v160
    v_rcp_f32 v161, v161
    v_mul_f32 v160, v160, v134
    v_mul_f32 v161, v161, v135
    v_sub_f32 v162, v156, v112
    v_mul_f32 v162, v162, v113
    v_mul_f32 v162, v162, v158
    v_fma_f32 v156, v162, v160, v156
    v_sub_f32 v162, v157, v112
    v_mul_f32 v162, v162, v113
    v_mul_f32 v162, v162, v159
    v_fma_f32 v157, v162, v161, v157
    v_cvt_pk_bf16_f32 v25, v156, v157
    v_add_u32 v178, 143360, v176
    ds_write_b64 v178, v[16:17] offset:0
    ds_write_b64 v178, v[18:19] offset:32
    ds_write_b64 v178, v[20:21] offset:64
    ds_write_b64 v178, v[22:23] offset:96
    ds_write_b64 v178, v[24:25] offset:128
    s_waitcnt lgkmcnt(0)
    s_mul_i32 s40, s34, 2560
    s_add_u32 s40, s40, 143360
    v_add_u32 v4, s40, v12
    ds_read_b128 v[156:159], v4 offset:0
    ds_read_b128 v[160:163], v4 offset:1024
    ds_read_b128 v[164:167], v4 offset:2048
    s_mul_i32 s40, s34, 20480
    s_add_u32 s40, s40, s45
    s_waitcnt lgkmcnt(0)
    buffer_store_dwordx4 v[156:159], v7, s[16:19], s40 offen
    buffer_store_dwordx4 v[160:163], v8, s[16:19], s40 offen
    s_mov_b32 exec_hi, 0
    buffer_store_dwordx4 v[164:167], v9, s[16:19], s40 offen
    s_mov_b64 exec, -1
k3_kernel_end:
    s_endpgm
.section .rodata,"a"
.p2align 6
.amdhsa_kernel k1_kernel
  .amdhsa_next_free_vgpr 256
  .amdhsa_next_free_sgpr 102
  .amdhsa_accum_offset 256
  .amdhsa_group_segment_fixed_size 0
  .amdhsa_kernarg_size 112
  .amdhsa_user_sgpr_count 2
  .amdhsa_user_sgpr_kernarg_segment_ptr 1
  .amdhsa_system_sgpr_workgroup_id_x 1
.end_amdhsa_kernel
.p2align 6
.amdhsa_kernel k2_kernel
  .amdhsa_next_free_vgpr 241
  .amdhsa_next_free_sgpr 102
  .amdhsa_accum_offset 244
  .amdhsa_group_segment_fixed_size 0
  .amdhsa_kernarg_size 112
  .amdhsa_user_sgpr_count 2
  .amdhsa_user_sgpr_kernarg_segment_ptr 1
  .amdhsa_system_sgpr_workgroup_id_x 1
.end_amdhsa_kernel
.p2align 6
.amdhsa_kernel k3_kernel
  .amdhsa_next_free_vgpr 179
  .amdhsa_next_free_sgpr 102
  .amdhsa_accum_offset 180
  .amdhsa_group_segment_fixed_size 0
  .amdhsa_kernarg_size 112
  .amdhsa_user_sgpr_count 2
  .amdhsa_user_sgpr_kernarg_segment_ptr 1
  .amdhsa_system_sgpr_workgroup_id_x 1
.end_amdhsa_kernel
```

```asm
; @launch kernel=k1_kernel grid=(256,1,1) block=(512,1,1) lds=163840
; @launch kernel=k2_kernel grid=(512,1,1) block=(256,1,1) lds=81920
; @launch kernel=k3_kernel grid=(256,1,1) block=(256,1,1) lds=153600
.amdgcn_target "amdgcn-amd-amdhsa--gfx950"
.text
.globl k1_kernel
.p2align 8
.type k1_kernel,@function
k1_kernel:
    s_cmp_ge_u32 s2, 256
    s_cbranch_scc1 k1_kernel_end
    s_load_dwordx2 s[4:5], s[0:1], 0
    s_load_dwordx2 s[8:9], s[0:1], 56
    s_load_dwordx2 s[12:13], s[0:1], 8
    s_load_dwordx2 s[16:17], s[0:1], 16
    s_load_dwordx2 s[20:21], s[0:1], 24
    s_load_dwordx2 s[24:25], s[0:1], 104
    s_load_dwordx2 s[28:29], s[0:1], 96
    s_load_dwordx2 s[32:33], s[0:1], 64
    s_load_dwordx2 s[36:37], s[0:1], 32
    v_lshrrev_b32 v2, 6, v0
    v_and_b32 v1, 63, v0
    v_readfirstlane_b32 s42, v2
    s_mov_b32 s6, 2621440
    s_mov_b32 s7, 0x20000
    s_mov_b32 s10, 1966080
    s_mov_b32 s11, 0x20000
    s_mov_b32 s14, 2621440
    s_mov_b32 s15, 0x20000
    s_mov_b32 s18, 2621440
    s_mov_b32 s19, 0x20000
    s_mov_b32 s22, 5120
    s_mov_b32 s23, 0x20000
    s_mov_b32 s26, 15990784
    s_mov_b32 s27, 0x20000
    s_mov_b32 s30, 256
    s_mov_b32 s31, 0x20000
    s_mov_b32 s34, 8388608
    s_mov_b32 s35, 0x20000
    s_mov_b32 s38, 2621440
    s_mov_b32 s39, 0x20000
    s_and_b32 s48, s2, 7
    s_lshr_b32 s49, s2, 3
    s_lshr_b32 s66, s48, 1
    s_and_b32 s67, s48, 1
    s_lshl_b32 s57, s49, 3
    s_add_u32 s57, s57, s42
    v_lshrrev_b32 v4, 2, v1
    s_lshl_b32 s50, s57, 1
    v_add_u32 v4, s50, v4
    v_mul_u32_u24 v4, 1280, v4
    v_and_b32 v5, 3, v1
    v_lshl_add_u32 v4, v5, 7, v4
    s_mul_i32 s50, s57, 3072
    s_sub_u32 s50, s50, 1024
    v_lshl_add_u32 v5, v1, 7, s50
    v_cmp_gt_u32 vcc, 8, v1
    s_nop 1
    v_cndmask_b32 v36, v5, v4, vcc
    s_mul_i32 s86, s66, 655360
    s_mul_i32 s87, s67, 768
    s_mul_i32 s88, s67, 640
    s_add_u32 s88, s88, s86
    s_lshl_b32 s40, s66, 3
    s_and_b32 s48, s49, 7
    s_add_u32 s40, s40, s48
    s_lshl_b32 s41, s67, 2
    s_lshr_b32 s48, s49, 3
    s_add_u32 s41, s41, s48
    s_mul_i32 s52, s40, 81920
    s_mul_i32 s54, s41, 192
    s_add_u32 s53, s54, 1536
    s_lshl_b32 s60, s42, 11
    s_mul_i32 s61, s42, 3072
    v_lshrrev_b32 v2, 4, v1
    v_and_b32 v3, 15, v1
    s_waitcnt lgkmcnt(0)
    v_mov_b32 v4, 14712832
    buffer_load_dwordx2 v[34:35], v4, s[24:27], 0 offen sc1
    s_lshl_b32 s48, s42, 3
    v_add_u32 v4, s48, v2
    v_and_b32 v5, 15, v4
    v_xor_b32 v5, v5, v3
    v_lshlrev_b32 v5, 4, v5
    v_mul_u32_u24 v4, 1280, v4
    v_add_u32 v38, v4, v5
    v_add_u32 v4, s48, v2
    v_add_u32 v4, 4, v4
    v_and_b32 v5, 15, v4
    v_xor_b32 v5, v5, v3
    v_lshlrev_b32 v5, 4, v5
    v_mul_u32_u24 v4, 1280, v4
    v_add_u32 v39, v4, v5
    s_add_u32 s48, s40, s41
    s_mul_i32 s49, s48, 52
    s_lshr_b32 s49, s49, 8
    s_mul_i32 s49, s49, 5
    s_sub_u32 s48, s48, s49
    s_add_u32 s49, s48, 0
    s_sub_u32 s50, s49, 5
    s_cmp_ge_u32 s49, 5
    s_cselect_b32 s49, s50, s49
    s_lshl_b32 s90, s49, 8
    s_mul_i32 s95, s49, 393216
    s_add_u32 s49, s48, 1
    s_sub_u32 s50, s49, 5
    s_cmp_ge_u32 s49, 5
    s_cselect_b32 s49, s50, s49
    s_lshl_b32 s91, s49, 8
    s_mul_i32 s96, s49, 393216
    s_add_u32 s49, s48, 2
    s_sub_u32 s50, s49, 5
    s_cmp_ge_u32 s49, 5
    s_cselect_b32 s49, s50, s49
    s_lshl_b32 s92, s49, 8
    s_mul_i32 s97, s49, 393216
    s_add_u32 s49, s48, 3
    s_sub_u32 s50, s49, 5
    s_cmp_ge_u32 s49, 5
    s_cselect_b32 s49, s50, s49
    s_lshl_b32 s93, s49, 8
    s_mul_i32 s98, s49, 393216
    s_add_u32 s49, s48, 4
    s_sub_u32 s50, s49, 5
    s_cmp_ge_u32 s49, 5
    s_cselect_b32 s49, s50, s49
    s_lshl_b32 s94, s49, 8
    s_mul_i32 s99, s49, 393216
    s_barrier
    s_add_u32 s65, s52, s90
    s_add_u32 m0, s60, 0
    s_nop 0
    buffer_load_dwordx4 v38, s[4:7], s65 offen lds
    s_add_u32 s65, s52, s90
    s_add_u32 m0, s60, 1024
    s_nop 0
    buffer_load_dwordx4 v39, s[4:7], s65 offen lds
    s_mul_i32 s48, s42, 192
    v_add_u32 v4, s48, v1
    v_mul_u32_u24 v5, 43691, v4
    v_lshrrev_b32 v5, 19, v5
    v_mul_u32_u24 v6, 12, v5
    v_sub_u32 v4, v4, v6
    v_lshrrev_b32 v6, 2, v5
    v_and_b32 v6, 2, v6
    v_xor_b32 v4, v4, v6
    v_lshlrev_b32 v4, 4, v4
    v_mul_u32_u24 v5, 3072, v5
    v_add_u32 v40, v4, v5
    v_add_u32 v4, s48, v1
    v_add_u32 v4, 64, v4
    v_mul_u32_u24 v5, 43691, v4
    v_lshrrev_b32 v5, 19, v5
    v_mul_u32_u24 v6, 12, v5
    v_sub_u32 v4, v4, v6
    v_lshrrev_b32 v6, 2, v5
    v_and_b32 v6, 2, v6
    v_xor_b32 v4, v4, v6
    v_lshlrev_b32 v4, 4, v4
    v_mul_u32_u24 v5, 3072, v5
    v_add_u32 v41, v4, v5
    v_add_u32 v4, s48, v1
    v_add_u32 v4, 128, v4
    v_mul_u32_u24 v5, 43691, v4
    v_lshrrev_b32 v5, 19, v5
    v_mul_u32_u24 v6, 12, v5
    v_sub_u32 v4, v4, v6
    v_lshrrev_b32 v6, 2, v5
    v_and_b32 v6, 2, v6
    v_xor_b32 v4, v4, v6
    v_lshlrev_b32 v4, 4, v4
    v_mul_u32_u24 v5, 3072, v5
    v_add_u32 v42, v4, v5
    s_add_u32 s65, s53, s95
    s_add_u32 m0, s61, 81920
    s_nop 0
    buffer_load_dwordx4 v40, s[8:11], s65 offen lds
    s_add_u32 s65, s53, s95
    s_add_u32 m0, s61, 82944
    s_nop 0
    buffer_load_dwordx4 v41, s[8:11], s65 offen lds
    s_add_u32 s65, s53, s95
    s_add_u32 m0, s61, 83968
    s_nop 0
    buffer_load_dwordx4 v42, s[8:11], s65 offen lds
    s_barrier
    s_cmp_lg_u32 s42, 7
    s_cbranch_scc1 k1_shk_1
    v_lshlrev_b32 v4, 4, v1
    s_mul_i32 s48, s41, 640
    s_mov_b32 m0, 160768
    s_mov_b32 exec_lo, -1
    s_mov_b32 exec_hi, 0xff
    buffer_load_dwordx4 v4, s[20:23], s48 offen lds
    s_mov_b64 exec, -1
k1_shk_1:
    s_add_u32 s65, s52, s91
    s_add_u32 m0, s60, 16384
    s_nop 0
    buffer_load_dwordx4 v38, s[4:7], s65 offen lds
    s_add_u32 s65, s52, s91
    s_add_u32 m0, s60, 17408
    s_nop 0
    buffer_load_dwordx4 v39, s[4:7], s65 offen lds
    s_add_u32 s65, s53, s96
    s_add_u32 m0, s61, 106496
    s_nop 0
    buffer_load_dwordx4 v40, s[8:11], s65 offen lds
    s_add_u32 s65, s53, s96
    s_add_u32 m0, s61, 107520
    s_nop 0
    buffer_load_dwordx4 v41, s[8:11], s65 offen lds
    s_add_u32 s65, s53, s96
    s_add_u32 m0, s61, 108544
    s_nop 0
    buffer_load_dwordx4 v42, s[8:11], s65 offen lds
    s_and_b32 s43, s42, 1
    s_lshr_b32 s44, s42, 1
    s_and_b32 s44, s44, 1
    s_lshr_b32 s45, s42, 2
    s_xor_b32 s46, s43, s45
    s_lshl_b32 s47, s44, 1
    s_add_u32 s47, s47, s46
    s_mov_b32 s55, 0x3727c5ac
    s_mov_b32 s56, 0x3f803f80
    s_mov_b32 s58, 0xbdd2d3e8
    s_mov_b32 s59, 0xbdd2d3e8
    s_lshl_b32 s48, s45, 1
    s_add_u32 s63, s48, s44
    s_xor_b32 s64, s63, 1
    v_xor_b32 v4, v2, v3
    v_lshlrev_b32 v6, 8, v3
    s_lshl_b32 s48, s44, 13
    s_lshl_b32 s49, s46, 12
    s_add_u32 s50, s48, s49
    s_xor_b32 s49, s49, 4096
    s_add_u32 s51, s48, s49
    s_lshl_b32 s48, s63, 2
    v_xor_b32 v5, s48, v4
    v_lshl_add_u32 v5, v5, 4, v6
    v_add_u32 v45, s50, v5
    v_add_u32 v46, s51, v5
    s_lshl_b32 s48, s64, 2
    v_xor_b32 v5, s48, v4
    v_lshl_add_u32 v5, v5, 4, v6
    v_add_u32 v47, s50, v5
    v_add_u32 v224, s51, v5
    v_lshrrev_b32 v5, 2, v3
    v_lshl_add_u32 v4, v2, 3, v5
    v_mul_u32_u24 v4, 192, v4
    v_and_b32 v5, 3, v3
    v_lshl_add_u32 v4, v5, 3, v4
    v_and_b32 v5, 1, v2
    s_mul_i32 s51, s43, 3
    s_mul_i32 s49, s63, 6144
    s_add_u32 s49, s49, 81920
    s_mul_i32 s50, s64, 6144
    s_add_u32 s50, s50, 81920
    s_add_u32 s48, s51, 0
    v_xor_b32 v6, s48, v5
    v_lshl_add_u32 v6, v6, 5, v4
    v_add_u32 v225, s49, v6
    v_add_u32 v228, s50, v6
    s_add_u32 s48, s51, 1
    v_xor_b32 v6, s48, v5
    v_lshl_add_u32 v6, v6, 5, v4
    v_add_u32 v226, s49, v6
    v_add_u32 v229, s50, v6
    s_add_u32 s48, s51, 2
    v_xor_b32 v6, s48, v5
    v_lshl_add_u32 v6, v6, 5, v4
    v_add_u32 v227, s49, v6
    v_add_u32 v230, s50, v6
    v_mov_b32 v252, s56
    v_mov_b32 v253, s56
    v_mov_b32 v254, s56
    v_mov_b32 v255, s56
    v_mul_u32_u24 v43, 205, v1
    v_lshrrev_b32 v43, 11, v43
    v_mul_u32_u24 v4, 10, v43
    v_sub_u32 v44, v1, v4
    s_lshl_b32 s48, s42, 3
    v_lshl_add_u32 v4, v43, 1, s48
    v_mul_u32_u24 v4, 1280, v4
    v_lshl_add_u32 v4, v44, 4, v4
    s_mul_i32 s48, s41, 160
    s_add_u32 s48, s48, s52
    v_add_u32 v7, s48, v4
    s_waitcnt vmcnt(5)
    s_barrier
    v_readfirstlane_b32 s100, v34
    v_readfirstlane_b32 s101, v35
    s_add_u32 s100, s100, 1
    s_addc_u32 s101, s101, 0
    ds_read_b128 v[48:51], v45 offset:0
    ds_read_b128 v[52:55], v46 offset:0
    ds_read_b128 v[56:59], v47 offset:0
    ds_read_b128 v[60:63], v224 offset:0
    ds_read_b64_tr_b16 v[128:129], v225 offset:0
    ds_read_b64_tr_b16 v[130:131], v225 offset:768
    ds_read_b64_tr_b16 v[132:133], v226 offset:0
    ds_read_b64_tr_b16 v[134:135], v226 offset:768
    ds_read_b64_tr_b16 v[136:137], v227 offset:0
    ds_read_b64_tr_b16 v[138:139], v227 offset:768
    ds_read_b64_tr_b16 v[140:141], v228 offset:0
    ds_read_b64_tr_b16 v[142:143], v228 offset:768
    ds_read_b64_tr_b16 v[144:145], v229 offset:0
    ds_read_b64_tr_b16 v[146:147], v229 offset:768
    ds_read_b64_tr_b16 v[148:149], v230 offset:0
    ds_read_b64_tr_b16 v[150:151], v230 offset:768
    s_add_u32 s65, s52, s92
    s_add_u32 m0, s60, 32768
    s_nop 0
    buffer_load_dwordx4 v38, s[4:7], s65 offen lds
    s_add_u32 s65, s52, s92
    s_add_u32 m0, s60, 33792
    s_nop 0
    buffer_load_dwordx4 v39, s[4:7], s65 offen lds
    s_add_u32 s65, s53, s97
    s_add_u32 m0, s61, 131072
    s_nop 0
    buffer_load_dwordx4 v40, s[8:11], s65 offen lds
    s_add_u32 s65, s53, s97
    s_add_u32 m0, s61, 132096
    s_nop 0
    buffer_load_dwordx4 v41, s[8:11], s65 offen lds
    s_add_u32 s65, s53, s97
    s_add_u32 m0, s61, 133120
    s_nop 0
    buffer_load_dwordx4 v42, s[8:11], s65 offen lds
    s_waitcnt vmcnt(5)
    s_waitcnt lgkmcnt(0)
    s_barrier
    ds_read_b128 v[64:67], v45 offset:16384
    ds_read_b128 v[68:71], v46 offset:16384
    ds_read_b128 v[72:75], v47 offset:16384
    ds_read_b128 v[76:79], v224 offset:16384
    ds_read_b64_tr_b16 v[152:153], v225 offset:24576
    ds_read_b64_tr_b16 v[154:155], v225 offset:25344
    ds_read_b64_tr_b16 v[156:157], v226 offset:24576
    ds_read_b64_tr_b16 v[158:159], v226 offset:25344
    ds_read_b64_tr_b16 v[160:161], v227 offset:24576
    ds_read_b64_tr_b16 v[162:163], v227 offset:25344
    ds_read_b64_tr_b16 v[164:165], v228 offset:24576
    ds_read_b64_tr_b16 v[166:167], v228 offset:25344
    ds_read_b64_tr_b16 v[168:169], v229 offset:24576
    ds_read_b64_tr_b16 v[170:171], v229 offset:25344
    ds_read_b64_tr_b16 v[172:173], v230 offset:24576
    ds_read_b64_tr_b16 v[174:175], v230 offset:25344
    v_mfma_f32_16x16x32_bf16 v[176:179], v[128:131], v[48:51], 0
    v_mfma_f32_16x16x32_bf16 v[180:183], v[128:131], v[52:55], 0
    v_mfma_f32_16x16x32_bf16 v[232:235], v[128:131], v[252:255], 0
    v_mfma_f32_16x16x32_bf16 v[184:187], v[132:135], v[48:51], 0
    v_mfma_f32_16x16x32_bf16 v[188:191], v[132:135], v[52:55], 0
    v_mfma_f32_16x16x32_bf16 v[236:239], v[132:135], v[252:255], 0
    v_mfma_f32_16x16x32_bf16 v[192:195], v[136:139], v[48:51], 0
    v_mfma_f32_16x16x32_bf16 v[196:199], v[136:139], v[52:55], 0
    s_add_u32 s65, s52, s93
    s_add_u32 m0, s60, 49152
    s_nop 0
    buffer_load_dwordx4 v38, s[4:7], s65 offen lds
    v_mfma_f32_16x16x32_bf16 v[240:243], v[136:139], v[252:255], 0
    v_mfma_f32_16x16x32_bf16 v[244:247], v[252:255], v[48:51], 0
    v_mfma_f32_16x16x32_bf16 v[248:251], v[48:51], v[48:51], 0
    s_add_u32 s65, s52, s93
    s_add_u32 m0, s60, 50176
    s_nop 0
    buffer_load_dwordx4 v39, s[4:7], s65 offen lds
    v_mfma_f32_16x16x32_bf16 v[176:179], v[140:143], v[56:59], v[176:179]
    v_mfma_f32_16x16x32_bf16 v[180:183], v[140:143], v[60:63], v[180:183]
    v_mfma_f32_16x16x32_bf16 v[184:187], v[144:147], v[56:59], v[184:187]
    s_add_u32 s65, s53, s98
    s_add_u32 m0, s61, 81920
    s_nop 0
    buffer_load_dwordx4 v40, s[8:11], s65 offen lds
    v_mfma_f32_16x16x32_bf16 v[188:191], v[144:147], v[60:63], v[188:191]
    v_mfma_f32_16x16x32_bf16 v[192:195], v[148:151], v[56:59], v[192:195]
    v_mfma_f32_16x16x32_bf16 v[196:199], v[148:151], v[60:63], v[196:199]
    s_add_u32 s65, s53, s98
    s_add_u32 m0, s61, 82944
    s_nop 0
    buffer_load_dwordx4 v41, s[8:11], s65 offen lds
    v_mfma_f32_16x16x32_bf16 v[244:247], v[252:255], v[56:59], v[244:247]
    v_mfma_f32_16x16x32_bf16 v[248:251], v[56:59], v[56:59], v[248:251]
    s_add_u32 s65, s53, s98
    s_add_u32 m0, s61, 83968
    s_nop 0
    buffer_load_dwordx4 v42, s[8:11], s65 offen lds
    v_subrev_u32 v32, 3840, v7
    v_subrev_u32 v33, 2560, v7
    v_subrev_u32 v34, 1280, v7
    s_mov_b32 exec_lo, -1
    s_mov_b32 exec_hi, 0xff
    buffer_load_dwordx4 v[112:115], v32, s[12:15], 0 offen
    buffer_load_dwordx4 v[116:119], v33, s[12:15], 0 offen
    buffer_load_dwordx4 v[120:123], v34, s[12:15], 0 offen
    buffer_load_dwordx4 v[124:127], v7, s[12:15], 0 offen
    buffer_load_dwordx4 v[212:215], v7, s[12:15], 0 offen offset:1280
    buffer_load_dwordx4 v[216:219], v7, s[16:19], 0 offen
    buffer_load_dwordx4 v[220:223], v7, s[16:19], 0 offen offset:1280
    s_mov_b64 exec, -1
    s_waitcnt vmcnt(12)
    s_waitcnt lgkmcnt(0)
    s_barrier
    ds_read_b128 v[80:83], v45 offset:32768
    ds_read_b128 v[84:87], v46 offset:32768
    ds_read_b128 v[88:91], v47 offset:32768
    ds_read_b128 v[92:95], v224 offset:32768
    ds_read_b64_tr_b16 v[128:129], v225 offset:49152
    ds_read_b64_tr_b16 v[130:131], v225 offset:49920
    ds_read_b64_tr_b16 v[132:133], v226 offset:49152
    ds_read_b64_tr_b16 v[134:135], v226 offset:49920
    ds_read_b64_tr_b16 v[136:137], v227 offset:49152
    ds_read_b64_tr_b16 v[138:139], v227 offset:49920
    ds_read_b64_tr_b16 v[140:141], v228 offset:49152
    ds_read_b64_tr_b16 v[142:143], v228 offset:49920
    ds_read_b64_tr_b16 v[144:145], v229 offset:49152
    ds_read_b64_tr_b16 v[146:147], v229 offset:49920
    ds_read_b64_tr_b16 v[148:149], v230 offset:49152
    ds_read_b64_tr_b16 v[150:151], v230 offset:49920
    v_mfma_f32_16x16x32_bf16 v[176:179], v[152:155], v[64:67], v[176:179]
    s_waitcnt vmcnt(0)
    v_mul_u32_u24 v7, 1152, v44
    v_lshlrev_b32 v34, 2, v43
    v_sub_u32 v7, v7, v34
    s_lshl_b32 s48, s42, 4
    s_add_u32 s48, s48, 12
    v_add_u32 v7, s48, v7
    v_mfma_f32_16x16x32_bf16 v[180:183], v[152:155], v[68:71], v[180:183]
    v_lshlrev_b32 v44, 6, v44
    v_add_u32 v44, 160768, v44
    ds_read_b128 v[200:203], v44 offset:0
    ds_read_b128 v[204:207], v44 offset:16
    v_lshlrev_b32 v8, 16, v112
    v_and_b32 v9, 0xffff0000, v112
    v_mfma_f32_16x16x32_bf16 v[232:235], v[152:155], v[252:255], v[232:235]
    v_lshlrev_b32 v10, 16, v116
    v_and_b32 v11, 0xffff0000, v116
    v_lshlrev_b32 v12, 16, v120
    v_and_b32 v13, 0xffff0000, v120
    v_lshlrev_b32 v14, 16, v124
    v_mfma_f32_16x16x32_bf16 v[184:187], v[156:159], v[64:67], v[184:187]
    v_and_b32 v15, 0xffff0000, v124
    v_lshlrev_b32 v16, 16, v212
    v_and_b32 v17, 0xffff0000, v212
    s_waitcnt lgkmcnt(0)
    v_lshlrev_b32 v18, 16, v200
    v_lshlrev_b32 v19, 16, v202
    v_mfma_f32_16x16x32_bf16 v[188:191], v[156:159], v[68:71], v[188:191]
    s_add_u32 s65, s52, s94
    s_add_u32 m0, s60, 65536
    s_nop 0
    buffer_load_dwordx4 v38, s[4:7], s65 offen lds
    v_and_b32 v20, 0xffff0000, v200
    v_and_b32 v21, 0xffff0000, v202
    v_lshlrev_b32 v22, 16, v201
    v_lshlrev_b32 v23, 16, v203
    v_and_b32 v24, 0xffff0000, v201
    v_mfma_f32_16x16x32_bf16 v[236:239], v[156:159], v[252:255], v[236:239]
    v_and_b32 v25, 0xffff0000, v203
    v_mul_f32 v26, v14, v18
    v_mul_f32 v27, v15, v19
    v_mul_f32 v28, v16, v18
    v_mul_f32 v29, v17, v19
    v_mfma_f32_16x16x32_bf16 v[192:195], v[160:163], v[64:67], v[192:195]
    v_fma_f32 v26, v12, v20, v26
    v_fma_f32 v27, v13, v21, v27
    v_fma_f32 v28, v14, v20, v28
    v_fma_f32 v29, v15, v21, v29
    v_fma_f32 v26, v10, v22, v26
    v_mfma_f32_16x16x32_bf16 v[196:199], v[160:163], v[68:71], v[196:199]
    s_add_u32 s65, s52, s94
    s_add_u32 m0, s60, 66560
    s_nop 0
    buffer_load_dwordx4 v39, s[4:7], s65 offen lds
    v_fma_f32 v27, v11, v23, v27
    v_fma_f32 v28, v12, v22, v28
    v_fma_f32 v29, v13, v23, v29
    v_fma_f32 v26, v8, v24, v26
    v_fma_f32 v27, v9, v25, v27
    v_mfma_f32_16x16x32_bf16 v[240:243], v[160:163], v[252:255], v[240:243]
    v_fma_f32 v28, v10, v24, v28
    v_fma_f32 v29, v11, v25, v29
    v_lshlrev_b32 v30, 16, v216
    v_and_b32 v31, 0xffff0000, v216
    v_lshlrev_b32 v32, 16, v220
    v_mfma_f32_16x16x32_bf16 v[244:247], v[252:255], v[64:67], v[244:247]
    v_and_b32 v33, 0xffff0000, v220
    v_mul_f32 v26, v26, v30
    v_mul_f32 v27, v27, v31
    v_mul_f32 v28, v28, v32
    v_mul_f32 v29, v29, v33
    v_mfma_f32_16x16x32_bf16 v[248:251], v[64:67], v[64:67], v[248:251]
    s_add_u32 s65, s53, s99
    s_add_u32 m0, s61, 106496
    s_nop 0
    buffer_load_dwordx4 v40, s[8:11], s65 offen lds
    v_cvt_pk_bf16_f32 v34, v28, v26
    v_cvt_pk_bf16_f32 v35, v29, v27
    s_mov_b32 exec_hi, 0xff
    ds_write_b32 v7, v34 offset:0
    ds_write_b32 v7, v35 offset:144
    s_mov_b32 exec_hi, -1
    v_lshlrev_b32 v8, 16, v113
    v_and_b32 v9, 0xffff0000, v113
    v_mfma_f32_16x16x32_bf16 v[176:179], v[164:167], v[72:75], v[176:179]
    v_lshlrev_b32 v10, 16, v117
    v_and_b32 v11, 0xffff0000, v117
    v_lshlrev_b32 v12, 16, v121
    v_and_b32 v13, 0xffff0000, v121
    v_lshlrev_b32 v14, 16, v125
    v_mfma_f32_16x16x32_bf16 v[180:183], v[164:167], v[76:79], v[180:183]
    v_and_b32 v15, 0xffff0000, v125
    v_lshlrev_b32 v16, 16, v213
    v_and_b32 v17, 0xffff0000, v213
    v_lshlrev_b32 v18, 16, v204
    v_lshlrev_b32 v19, 16, v206
    v_mfma_f32_16x16x32_bf16 v[184:187], v[168:171], v[72:75], v[184:187]
    s_add_u32 s65, s53, s99
    s_add_u32 m0, s61, 107520
    s_nop 0
    buffer_load_dwordx4 v41, s[8:11], s65 offen lds
    v_and_b32 v20, 0xffff0000, v204
    v_and_b32 v21, 0xffff0000, v206
    v_lshlrev_b32 v22, 16, v205
    v_lshlrev_b32 v23, 16, v207
    v_and_b32 v24, 0xffff0000, v205
    v_mfma_f32_16x16x32_bf16 v[188:191], v[168:171], v[76:79], v[188:191]
    v_and_b32 v25, 0xffff0000, v207
    v_mul_f32 v26, v14, v18
    v_mul_f32 v27, v15, v19
    v_mul_f32 v28, v16, v18
    v_mul_f32 v29, v17, v19
    v_mfma_f32_16x16x32_bf16 v[192:195], v[172:175], v[72:75], v[192:195]
    v_fma_f32 v26, v12, v20, v26
    v_fma_f32 v27, v13, v21, v27
    v_fma_f32 v28, v14, v20, v28
    v_fma_f32 v29, v15, v21, v29
    v_fma_f32 v26, v10, v22, v26
    v_mfma_f32_16x16x32_bf16 v[196:199], v[172:175], v[76:79], v[196:199]
    s_add_u32 s65, s53, s99
    s_add_u32 m0, s61, 108544
    s_nop 0
    buffer_load_dwordx4 v42, s[8:11], s65 offen lds
    v_fma_f32 v27, v11, v23, v27
    v_fma_f32 v28, v12, v22, v28
    v_fma_f32 v29, v13, v23, v29
    v_fma_f32 v26, v8, v24, v26
    v_fma_f32 v27, v9, v25, v27
    v_mfma_f32_16x16x32_bf16 v[244:247], v[252:255], v[72:75], v[244:247]
    v_fma_f32 v28, v10, v24, v28
    v_fma_f32 v29, v11, v25, v29
    v_lshlrev_b32 v30, 16, v217
    v_and_b32 v31, 0xffff0000, v217
    v_lshlrev_b32 v32, 16, v221
    v_mfma_f32_16x16x32_bf16 v[248:251], v[72:75], v[72:75], v[248:251]
    v_and_b32 v33, 0xffff0000, v221
    v_mul_f32 v26, v26, v30
    v_mul_f32 v27, v27, v31
    v_mul_f32 v28, v28, v32
    v_mul_f32 v29, v29, v33
    s_waitcnt vmcnt(12)
    s_waitcnt lgkmcnt(0)
    s_barrier
    ds_read_b128 v[96:99], v45 offset:49152
    ds_read_b128 v[100:103], v46 offset:49152
    ds_read_b128 v[104:107], v47 offset:49152
    ds_read_b128 v[108:111], v224 offset:49152
    ds_read_b64_tr_b16 v[152:153], v225 offset:0
    ds_read_b64_tr_b16 v[154:155], v225 offset:768
    ds_read_b64_tr_b16 v[156:157], v226 offset:0
    ds_read_b64_tr_b16 v[158:159], v226 offset:768
    ds_read_b64_tr_b16 v[160:161], v227 offset:0
    ds_read_b64_tr_b16 v[162:163], v227 offset:768
    ds_read_b64_tr_b16 v[164:165], v228 offset:0
    ds_read_b64_tr_b16 v[166:167], v228 offset:768
    ds_read_b64_tr_b16 v[168:169], v229 offset:0
    ds_read_b64_tr_b16 v[170:171], v229 offset:768
    ds_read_b64_tr_b16 v[172:173], v230 offset:0
    ds_read_b64_tr_b16 v[174:175], v230 offset:768
    v_mfma_f32_16x16x32_bf16 v[176:179], v[128:131], v[80:83], v[176:179]
    v_cvt_pk_bf16_f32 v34, v28, v26
    v_cvt_pk_bf16_f32 v35, v29, v27
    s_mov_b32 exec_hi, 0xff
    ds_write_b32 v7, v34 offset:288
    ds_write_b32 v7, v35 offset:432
    s_mov_b32 exec_hi, -1
    ds_read_b128 v[200:203], v44 offset:32
    ds_read_b128 v[204:207], v44 offset:48
    v_lshlrev_b32 v8, 16, v114
    v_mfma_f32_16x16x32_bf16 v[180:183], v[128:131], v[84:87], v[180:183]
    s_add_u32 s65, s54, s95
    s_add_u32 m0, s61, 131072
    s_nop 0
    buffer_load_dwordx4 v40, s[8:11], s65 offen lds
    v_and_b32 v9, 0xffff0000, v114
    v_lshlrev_b32 v10, 16, v118
    v_and_b32 v11, 0xffff0000, v118
    v_lshlrev_b32 v12, 16, v122
    v_and_b32 v13, 0xffff0000, v122
    v_mfma_f32_16x16x32_bf16 v[232:235], v[128:131], v[252:255], v[232:235]
    v_lshlrev_b32 v14, 16, v126
    v_and_b32 v15, 0xffff0000, v126
    v_lshlrev_b32 v16, 16, v214
    v_and_b32 v17, 0xffff0000, v214
    s_waitcnt lgkmcnt(0)
    v_lshlrev_b32 v18, 16, v200
    v_mfma_f32_16x16x32_bf16 v[184:187], v[132:135], v[80:83], v[184:187]
    v_lshlrev_b32 v19, 16, v202
    v_and_b32 v20, 0xffff0000, v200
    v_and_b32 v21, 0xffff0000, v202
    v_lshlrev_b32 v22, 16, v201
    v_lshlrev_b32 v23, 16, v203
    v_mfma_f32_16x16x32_bf16 v[188:191], v[132:135], v[84:87], v[188:191]
    s_add_u32 s65, s54, s95
    s_add_u32 m0, s61, 132096
    s_nop 0
    buffer_load_dwordx4 v41, s[8:11], s65 offen lds
    v_and_b32 v24, 0xffff0000, v201
    v_and_b32 v25, 0xffff0000, v203
    v_mul_f32 v26, v14, v18
    v_mul_f32 v27, v15, v19
    v_mul_f32 v28, v16, v18
    v_mfma_f32_16x16x32_bf16 v[236:239], v[132:135], v[252:255], v[236:239]
    v_mul_f32 v29, v17, v19
    v_fma_f32 v26, v12, v20, v26
    v_fma_f32 v27, v13, v21, v27
    v_fma_f32 v28, v14, v20, v28
    v_fma_f32 v29, v15, v21, v29
    v_mfma_f32_16x16x32_bf16 v[192:195], v[136:139], v[80:83], v[192:195]
    v_fma_f32 v26, v10, v22, v26
    v_fma_f32 v27, v11, v23, v27
    v_fma_f32 v28, v12, v22, v28
    v_fma_f32 v29, v13, v23, v29
    v_fma_f32 v26, v8, v24, v26
    v_mfma_f32_16x16x32_bf16 v[196:199], v[136:139], v[84:87], v[196:199]
    s_add_u32 s65, s54, s95
    s_add_u32 m0, s61, 133120
    s_nop 0
    buffer_load_dwordx4 v42, s[8:11], s65 offen lds
    v_fma_f32 v27, v9, v25, v27
    v_fma_f32 v28, v10, v24, v28
    v_fma_f32 v29, v11, v25, v29
    v_lshlrev_b32 v30, 16, v218
    v_and_b32 v31, 0xffff0000, v218
    v_mfma_f32_16x16x32_bf16 v[240:243], v[136:139], v[252:255], v[240:243]
    v_lshlrev_b32 v32, 16, v222
    v_and_b32 v33, 0xffff0000, v222
    v_mul_f32 v26, v26, v30
    v_mul_f32 v27, v27, v31
    v_mul_f32 v28, v28, v32
    v_mfma_f32_16x16x32_bf16 v[244:247], v[252:255], v[80:83], v[244:247]
    v_mul_f32 v29, v29, v33
    v_cvt_pk_bf16_f32 v34, v28, v26
    v_cvt_pk_bf16_f32 v35, v29, v27
    s_mov_b32 exec_hi, 0xff
    ds_write_b32 v7, v34 offset:576
    ds_write_b32 v7, v35 offset:720
    s_mov_b32 exec_hi, -1
    v_lshlrev_b32 v8, 16, v115
    v_mfma_f32_16x16x32_bf16 v[248:251], v[80:83], v[80:83], v[248:251]
    v_and_b32 v9, 0xffff0000, v115
    v_lshlrev_b32 v10, 16, v119
    v_and_b32 v11, 0xffff0000, v119
    v_lshlrev_b32 v12, 16, v123
    v_and_b32 v13, 0xffff0000, v123
    v_mfma_f32_16x16x32_bf16 v[176:179], v[140:143], v[88:91], v[176:179]
    v_lshlrev_b32 v14, 16, v127
    v_and_b32 v15, 0xffff0000, v127
    v_lshlrev_b32 v16, 16, v215
    v_and_b32 v17, 0xffff0000, v215
    v_lshlrev_b32 v18, 16, v204
    v_mfma_f32_16x16x32_bf16 v[180:183], v[140:143], v[92:95], v[180:183]
    v_lshlrev_b32 v19, 16, v206
    v_and_b32 v20, 0xffff0000, v204
    v_and_b32 v21, 0xffff0000, v206
    v_lshlrev_b32 v22, 16, v205
    v_lshlrev_b32 v23, 16, v207
    v_mfma_f32_16x16x32_bf16 v[184:187], v[144:147], v[88:91], v[184:187]
    v_and_b32 v24, 0xffff0000, v205
    v_and_b32 v25, 0xffff0000, v207
    v_mul_f32 v26, v14, v18
    v_mul_f32 v27, v15, v19
    v_mul_f32 v28, v16, v18
    v_mfma_f32_16x16x32_bf16 v[188:191], v[144:147], v[92:95], v[188:191]
    v_mul_f32 v29, v17, v19
    v_fma_f32 v26, v12, v20, v26
    v_fma_f32 v27, v13, v21, v27
    v_fma_f32 v28, v14, v20, v28
    v_fma_f32 v29, v15, v21, v29
    v_mfma_f32_16x16x32_bf16 v[192:195], v[148:151], v[88:91], v[192:195]
    v_fma_f32 v26, v10, v22, v26
    v_fma_f32 v27, v11, v23, v27
    v_fma_f32 v28, v12, v22, v28
    v_fma_f32 v29, v13, v23, v29
    v_fma_f32 v26, v8, v24, v26
    v_mfma_f32_16x16x32_bf16 v[196:199], v[148:151], v[92:95], v[196:199]
    v_fma_f32 v27, v9, v25, v27
    v_fma_f32 v28, v10, v24, v28
    v_fma_f32 v29, v11, v25, v29
    v_lshlrev_b32 v30, 16, v219
    v_and_b32 v31, 0xffff0000, v219
    v_mfma_f32_16x16x32_bf16 v[244:247], v[252:255], v[88:91], v[244:247]
    v_lshlrev_b32 v32, 16, v223
    v_and_b32 v33, 0xffff0000, v223
    v_mul_f32 v26, v26, v30
    v_mul_f32 v27, v27, v31
    v_mul_f32 v28, v28, v32
    v_mfma_f32_16x16x32_bf16 v[248:251], v[88:91], v[88:91], v[248:251]
    v_mul_f32 v29, v29, v33
    v_cvt_pk_bf16_f32 v34, v28, v26
    v_cvt_pk_bf16_f32 v35, v29, v27
    s_mov_b32 exec_hi, 0xff
    ds_write_b32 v7, v34 offset:864
    ds_write_b32 v7, v35 offset:1008
    s_mov_b32 exec_hi, -1
    s_waitcnt vmcnt(3)
    s_waitcnt lgkmcnt(0)
    s_barrier
    v_add_u32 v45, 0x10000, v45
    v_add_u32 v46, 0x10000, v46
    v_add_u32 v47, 0x10000, v47
    v_add_u32 v224, 0x10000, v224
    ds_read_b128 v[112:115], v45 offset:0
    ds_read_b128 v[116:119], v46 offset:0
    ds_read_b128 v[120:123], v47 offset:0
    ds_read_b128 v[124:127], v224 offset:0
    ds_read_b64_tr_b16 v[128:129], v225 offset:24576
    ds_read_b64_tr_b16 v[130:131], v225 offset:25344
    ds_read_b64_tr_b16 v[132:133], v226 offset:24576
    ds_read_b64_tr_b16 v[134:135], v226 offset:25344
    ds_read_b64_tr_b16 v[136:137], v227 offset:24576
    ds_read_b64_tr_b16 v[138:139], v227 offset:25344
    ds_read_b64_tr_b16 v[140:141], v228 offset:24576
    ds_read_b64_tr_b16 v[142:143], v228 offset:25344
    ds_read_b64_tr_b16 v[144:145], v229 offset:24576
    ds_read_b64_tr_b16 v[146:147], v229 offset:25344
    ds_read_b64_tr_b16 v[148:149], v230 offset:24576
    ds_read_b64_tr_b16 v[150:151], v230 offset:25344
    v_mfma_f32_16x16x32_bf16 v[176:179], v[152:155], v[96:99], v[176:179]
    s_lshl_b32 s48, s42, 3
    v_lshrrev_b32 v4, 3, v1
    v_add_u32 v4, s48, v4
    v_mfma_f32_16x16x32_bf16 v[180:183], v[152:155], v[100:103], v[180:183]
    v_and_b32 v5, 7, v1
    v_lshlrev_b32 v5, 4, v5
    v_mfma_f32_16x16x32_bf16 v[232:235], v[152:155], v[252:255], v[232:235]
    v_mul_u32_u24 v6, 144, v4
    v_add_u32 v6, v6, v5
    v_mfma_f32_16x16x32_bf16 v[184:187], v[156:159], v[96:99], v[184:187]
    ds_read_b128 v[8:11], v6 offset:0
    v_mfma_f32_16x16x32_bf16 v[188:191], v[156:159], v[100:103], v[188:191]
    s_add_u32 s65, s54, s96
    s_add_u32 m0, s61, 81920
    s_nop 0
    buffer_load_dwordx4 v40, s[8:11], s65 offen lds
    v_lshlrev_b32 v4, 12, v4
    v_add_u32 v4, v4, v5
    v_mfma_f32_16x16x32_bf16 v[236:239], v[156:159], v[252:255], v[236:239]
    s_mul_i32 s48, s41, 327680
    s_lshl_b32 s49, s40, 7
    s_add_u32 s48, s48, s49
    s_add_u32 s48, s48, 6291456
    s_waitcnt lgkmcnt(0)
    buffer_store_dwordx4 v[8:11], v4, s[24:27], s48 offen
    v_mfma_f32_16x16x32_bf16 v[192:195], v[160:163], v[96:99], v[192:195]
    s_lshl_b32 s48, s42, 3
    s_add_u32 s48, s48, 64
    v_lshrrev_b32 v4, 3, v1
    v_add_u32 v4, s48, v4
    v_mfma_f32_16x16x32_bf16 v[196:199], v[160:163], v[100:103], v[196:199]
    s_add_u32 s65, s54, s96
    s_add_u32 m0, s61, 82944
    s_nop 0
    buffer_load_dwordx4 v41, s[8:11], s65 offen lds
    v_and_b32 v5, 7, v1
    v_lshlrev_b32 v5, 4, v5
    v_mfma_f32_16x16x32_bf16 v[240:243], v[160:163], v[252:255], v[240:243]
    v_mul_u32_u24 v6, 144, v4
    v_add_u32 v6, v6, v5
    v_mfma_f32_16x16x32_bf16 v[244:247], v[252:255], v[96:99], v[244:247]
    ds_read_b128 v[12:15], v6 offset:0
    v_mfma_f32_16x16x32_bf16 v[248:251], v[96:99], v[96:99], v[248:251]
    s_add_u32 s65, s54, s96
    s_add_u32 m0, s61, 83968
    s_nop 0
    buffer_load_dwordx4 v42, s[8:11], s65 offen lds
    v_lshlrev_b32 v4, 12, v4
    v_add_u32 v4, v4, v5
    v_mfma_f32_16x16x32_bf16 v[176:179], v[164:167], v[104:107], v[176:179]
    s_mul_i32 s48, s41, 327680
    s_lshl_b32 s49, s40, 7
    s_add_u32 s48, s48, s49
    s_add_u32 s48, s48, 6291456
    s_waitcnt lgkmcnt(0)
    s_cmp_ge_u32 s42, 2
    s_cbranch_scc1 k1_kvskip_2
    buffer_store_dwordx4 v[12:15], v4, s[24:27], s48 offen
k1_kvskip_2:
    v_mfma_f32_16x16x32_bf16 v[180:183], v[164:167], v[108:111], v[180:183]
    v_mfma_f32_16x16x32_bf16 v[184:187], v[168:171], v[104:107], v[184:187]
    v_mfma_f32_16x16x32_bf16 v[188:191], v[168:171], v[108:111], v[188:191]
    v_mfma_f32_16x16x32_bf16 v[192:195], v[172:175], v[104:107], v[192:195]
    v_mfma_f32_16x16x32_bf16 v[196:199], v[172:175], v[108:111], v[196:199]
    v_mfma_f32_16x16x32_bf16 v[244:247], v[252:255], v[104:107], v[244:247]
    v_mfma_f32_16x16x32_bf16 v[248:251], v[104:107], v[104:107], v[248:251]
    s_waitcnt vmcnt(4)
    s_waitcnt lgkmcnt(0)
    s_barrier
    ds_read_b64_tr_b16 v[152:153], v225 offset:49152
    ds_read_b64_tr_b16 v[154:155], v225 offset:49920
    ds_read_b64_tr_b16 v[156:157], v226 offset:49152
    ds_read_b64_tr_b16 v[158:159], v226 offset:49920
    ds_read_b64_tr_b16 v[160:161], v227 offset:49152
    ds_read_b64_tr_b16 v[162:163], v227 offset:49920
    ds_read_b64_tr_b16 v[164:165], v228 offset:49152
    ds_read_b64_tr_b16 v[166:167], v228 offset:49920
    ds_read_b64_tr_b16 v[168:169], v229 offset:49152
    ds_read_b64_tr_b16 v[170:171], v229 offset:49920
    ds_read_b64_tr_b16 v[172:173], v230 offset:49152
    ds_read_b64_tr_b16 v[174:175], v230 offset:49920
    v_mfma_f32_16x16x32_bf16 v[176:179], v[128:131], v[112:115], v[176:179]
    v_mfma_f32_16x16x32_bf16 v[180:183], v[128:131], v[116:119], v[180:183]
    s_add_u32 s65, s54, s97
    s_add_u32 m0, s61, 106496
    s_nop 0
    buffer_load_dwordx4 v40, s[8:11], s65 offen lds
    v_mfma_f32_16x16x32_bf16 v[232:235], v[128:131], v[252:255], v[232:235]
    v_mfma_f32_16x16x32_bf16 v[184:187], v[132:135], v[112:115], v[184:187]
    v_mfma_f32_16x16x32_bf16 v[188:191], v[132:135], v[116:119], v[188:191]
    s_add_u32 s65, s54, s97
    s_add_u32 m0, s61, 107520
    s_nop 0
    buffer_load_dwordx4 v41, s[8:11], s65 offen lds
    v_mfma_f32_16x16x32_bf16 v[236:239], v[132:135], v[252:255], v[236:239]
    v_mfma_f32_16x16x32_bf16 v[192:195], v[136:139], v[112:115], v[192:195]
    v_mfma_f32_16x16x32_bf16 v[196:199], v[136:139], v[116:119], v[196:199]
    s_add_u32 s65, s54, s97
    s_add_u32 m0, s61, 108544
    s_nop 0
    buffer_load_dwordx4 v42, s[8:11], s65 offen lds
    v_mfma_f32_16x16x32_bf16 v[240:243], v[136:139], v[252:255], v[240:243]
    v_mfma_f32_16x16x32_bf16 v[244:247], v[252:255], v[112:115], v[244:247]
    v_mfma_f32_16x16x32_bf16 v[248:251], v[112:115], v[112:115], v[248:251]
    v_mfma_f32_16x16x32_bf16 v[176:179], v[140:143], v[120:123], v[176:179]
    v_mfma_f32_16x16x32_bf16 v[180:183], v[140:143], v[124:127], v[180:183]
    v_mfma_f32_16x16x32_bf16 v[184:187], v[144:147], v[120:123], v[184:187]
    v_mfma_f32_16x16x32_bf16 v[188:191], v[144:147], v[124:127], v[188:191]
    v_mfma_f32_16x16x32_bf16 v[192:195], v[148:151], v[120:123], v[192:195]
    v_mfma_f32_16x16x32_bf16 v[196:199], v[148:151], v[124:127], v[196:199]
    v_mfma_f32_16x16x32_bf16 v[244:247], v[252:255], v[120:123], v[244:247]
    v_mfma_f32_16x16x32_bf16 v[248:251], v[120:123], v[120:123], v[248:251]
    s_mul_i32 s48, s42, 3072
    s_add_u32 s48, s48, 16384
    v_lshl_add_u32 v4, v1, 4, s48
    s_lshl_b32 s48, s43, 2
    s_lshl_b32 s49, s44, 1
    s_add_u32 s48, s48, s49
    s_add_u32 s48, s48, s45
    s_mul_i32 s48, s48, 192
    s_add_u32 s48, s48, 155648
    v_lshl_add_u32 v5, v2, 4, s48
    ds_write_b128 v4, v[180:183] offset:0
    ds_write_b128 v4, v[188:191] offset:1024
    ds_write_b128 v4, v[196:199] offset:2048
    s_mov_b32 exec_lo, 0x00010001
    s_mov_b32 exec_hi, 0x00010001
    ds_write_b128 v5, v[232:235] offset:0
    ds_write_b128 v5, v[236:239] offset:64
    ds_write_b128 v5, v[240:243] offset:128
    s_mov_b64 exec, -1
    v_and_b32 v8, 3, v3
    v_cmp_eq_u32 vcc, 1, v8
    s_nop 1
    v_cndmask_b32 v245, v248, v249, vcc
    v_cmp_eq_u32 vcc, 2, v8
    s_nop 1
    v_cndmask_b32 v245, v245, v250, vcc
    v_cmp_eq_u32 vcc, 3, v8
    s_nop 1
    v_cndmask_b32 v245, v245, v251, vcc
    s_lshl_b32 s48, s47, 1
    s_add_u32 s48, s48, s45
    s_lshl_b32 s48, s48, 7
    s_add_u32 s48, s48, 158720
    v_lshl_add_u32 v6, v3, 3, s48
    s_mov_b32 exec_lo, 0x00F0000F
    s_mov_b32 exec_hi, 0xF0000F00
    ds_write_b64 v6, v[244:245]
    s_mov_b64 exec, -1
    v_pk_add_f32 v[200:201], v[176:177], 0
    v_pk_add_f32 v[202:203], v[178:179], 0
    v_pk_add_f32 v[204:205], v[184:185], 0
    v_pk_add_f32 v[206:207], v[186:187], 0
    v_pk_add_f32 v[208:209], v[192:193], 0
    v_pk_add_f32 v[210:211], v[194:195], 0
    v_mov_b32 v246, 0xc0135761
    v_mov_b32 v247, 0xc0135761
    s_waitcnt vmcnt(3)
    s_waitcnt lgkmcnt(0)
    s_barrier
    ds_read_b64_tr_b16 v[128:129], v225 offset:0
    ds_read_b64_tr_b16 v[130:131], v225 offset:768
    ds_read_b64_tr_b16 v[132:133], v226 offset:0
    ds_read_b64_tr_b16 v[134:135], v226 offset:768
    ds_read_b64_tr_b16 v[136:137], v227 offset:0
    ds_read_b64_tr_b16 v[138:139], v227 offset:768
    ds_read_b64_tr_b16 v[140:141], v228 offset:0
    ds_read_b64_tr_b16 v[142:143], v228 offset:768
    ds_read_b64_tr_b16 v[144:145], v229 offset:0
    ds_read_b64_tr_b16 v[146:147], v229 offset:768
    ds_read_b64_tr_b16 v[148:149], v230 offset:0
    ds_read_b64_tr_b16 v[150:151], v230 offset:768
    v_mfma_f32_16x16x32_bf16 v[176:179], v[152:155], v[48:51], 0
    s_xor_b32 s48, s42, 4
    s_mul_i32 s48, s48, 3072
    s_add_u32 s48, s48, 16384
    v_lshl_add_u32 v4, v1, 4, s48
    ds_read_b128 v[8:11], v4 offset:0
    ds_read_b128 v[12:15], v4 offset:1024
    ds_read_b128 v[16:19], v4 offset:2048
    s_mul_i32 s48, s43, 768
    s_add_u32 s48, s48, 155648
    v_lshl_add_u32 v4, v2, 4, s48
    ds_read_b128 v[20:23], v4 offset:0
    ds_read_b128 v[24:27], v4 offset:64
    ds_read_b128 v[28:31], v4 offset:128
    s_lshl_b32 s48, s47, 8
    s_add_u32 s48, s48, 158720
    v_lshl_add_u32 v5, v3, 3, s48
    v_mfma_f32_16x16x32_bf16 v[180:183], v[152:155], v[52:55], 0
    s_add_u32 s65, s54, s98
    s_add_u32 m0, s61, 131072
    s_nop 0
    buffer_load_dwordx4 v40, s[8:11], s65 offen lds
    ds_read_b64 v[248:249], v5
    ds_read_b64 v[32:33], v5 offset:128
    s_waitcnt lgkmcnt(5)
    v_add_f32 v200, v200, v8
    v_add_f32 v201, v201, v9
    v_add_f32 v202, v202, v10
    v_add_f32 v203, v203, v11
    v_mfma_f32_16x16x32_bf16 v[232:235], v[152:155], v[252:255], 0
    v_add_f32 v204, v204, v12
    v_add_f32 v205, v205, v13
    v_add_f32 v206, v206, v14
    v_add_f32 v207, v207, v15
    v_add_f32 v208, v208, v16
    v_mfma_f32_16x16x32_bf16 v[184:187], v[156:159], v[48:51], 0
    v_add_f32 v209, v209, v17
    v_add_f32 v210, v210, v18
    v_add_f32 v211, v211, v19
    ds_read_b128 v[8:11], v4 offset:192
    ds_read_b128 v[12:15], v4 offset:256
    ds_read_b128 v[16:19], v4 offset:320
    s_waitcnt lgkmcnt(3)
    v_add_f32 v248, v248, v32
    v_mfma_f32_16x16x32_bf16 v[188:191], v[156:159], v[52:55], 0
    s_add_u32 s65, s54, s98
    s_add_u32 m0, s61, 132096
    s_nop 0
    buffer_load_dwordx4 v41, s[8:11], s65 offen lds
    v_add_f32 v249, v249, v33
    v_mul_f32 v248, 0x3acccccd, v248
    v_mul_f32 v249, 0x3acccccd, v249
    v_fma_f32 v249, -v248, v248, v249
    v_max_f32 v249, 0, v249
    v_mfma_f32_16x16x32_bf16 v[236:239], v[156:159], v[252:255], 0
    v_cvt_pk_bf16_f32 v249, v249, v248
    v_and_b32 v248, 0xffff0000, v249
    v_lshlrev_b32 v249, 16, v249
    v_add_f32 v249, s55, v249
    v_cvt_pk_bf16_f32 v249, v249, v249
    v_mfma_f32_16x16x32_bf16 v[192:195], v[160:163], v[48:51], 0
    v_and_b32 v249, 0xffff0000, v249
    v_sqrt_f32 v249, v249
    s_nop 0
    v_cvt_pk_bf16_f32 v249, v249, v249
    v_and_b32 v249, 0xffff0000, v249
    v_rcp_f32 v249, v249
    v_mfma_f32_16x16x32_bf16 v[196:199], v[160:163], v[52:55], 0
    s_add_u32 s65, s54, s98
    s_add_u32 m0, s61, 133120
    s_nop 0
    buffer_load_dwordx4 v42, s[8:11], s65 offen lds
    v_mov_b32 v250, v249
    s_waitcnt lgkmcnt(0)
    v_add_f32 v20, v20, v8
    v_add_f32 v21, v21, v9
    v_add_f32 v22, v22, v10
    v_add_f32 v23, v23, v11
    v_mfma_f32_16x16x32_bf16 v[240:243], v[160:163], v[252:255], 0
    v_add_f32 v24, v24, v12
    v_add_f32 v25, v25, v13
    v_add_f32 v26, v26, v14
    v_add_f32 v27, v27, v15
    v_add_f32 v28, v28, v16
    v_mfma_f32_16x16x32_bf16 v[176:179], v[164:167], v[56:59], v[176:179]
    v_add_f32 v29, v29, v17
    v_add_f32 v30, v30, v18
    v_add_f32 v31, v31, v19
    ds_read_b128 v[8:11], v4 offset:384
    ds_read_b128 v[12:15], v4 offset:448
    ds_read_b128 v[16:19], v4 offset:512
    s_waitcnt lgkmcnt(0)
    v_add_f32 v20, v20, v8
    v_mfma_f32_16x16x32_bf16 v[180:183], v[164:167], v[60:63], v[180:183]
    v_add_f32 v21, v21, v9
    v_add_f32 v22, v22, v10
    v_add_f32 v23, v23, v11
    v_add_f32 v24, v24, v12
    v_add_f32 v25, v25, v13
    v_mfma_f32_16x16x32_bf16 v[184:187], v[168:171], v[56:59], v[184:187]
    v_add_f32 v26, v26, v14
    v_add_f32 v27, v27, v15
    v_add_f32 v28, v28, v16
    v_add_f32 v29, v29, v17
    v_add_f32 v30, v30, v18
    v_mfma_f32_16x16x32_bf16 v[188:191], v[168:171], v[60:63], v[188:191]
    v_add_f32 v31, v31, v19
    ds_read_b128 v[8:11], v4 offset:576
    ds_read_b128 v[12:15], v4 offset:640
    ds_read_b128 v[16:19], v4 offset:704
    s_waitcnt lgkmcnt(0)
    v_add_f32 v20, v20, v8
    v_add_f32 v21, v21, v9
    v_add_f32 v22, v22, v10
    v_mfma_f32_16x16x32_bf16 v[192:195], v[172:175], v[56:59], v[192:195]
    v_add_f32 v23, v23, v11
    v_add_f32 v24, v24, v12
    v_add_f32 v25, v25, v13
    v_add_f32 v26, v26, v14
    v_add_f32 v27, v27, v15
    v_mfma_f32_16x16x32_bf16 v[196:199], v[172:175], v[60:63], v[196:199]
    v_add_f32 v28, v28, v16
    v_add_f32 v29, v29, v17
    v_add_f32 v30, v30, v18
    v_add_f32 v31, v31, v19
    v_fma_f32 v200, v20, -v248, v200
    s_waitcnt vmcnt(3)
    s_waitcnt lgkmcnt(0)
    s_barrier
    ds_read_b64_tr_b16 v[152:153], v225 offset:24576
    ds_read_b64_tr_b16 v[154:155], v225 offset:25344
    ds_read_b64_tr_b16 v[156:157], v226 offset:24576
    ds_read_b64_tr_b16 v[158:159], v226 offset:25344
    ds_read_b64_tr_b16 v[160:161], v227 offset:24576
    ds_read_b64_tr_b16 v[162:163], v227 offset:25344
    ds_read_b64_tr_b16 v[164:165], v228 offset:24576
    ds_read_b64_tr_b16 v[166:167], v228 offset:25344
    ds_read_b64_tr_b16 v[168:169], v229 offset:24576
    ds_read_b64_tr_b16 v[170:171], v229 offset:25344
    ds_read_b64_tr_b16 v[172:173], v230 offset:24576
    ds_read_b64_tr_b16 v[174:175], v230 offset:25344
    v_mfma_f32_16x16x32_bf16 v[176:179], v[128:131], v[64:67], v[176:179]
    v_fma_f32 v201, v21, -v248, v201
    v_fma_f32 v202, v22, -v248, v202
    v_fma_f32 v203, v23, -v248, v203
    v_fma_f32 v204, v24, -v248, v204
    v_fma_f32 v205, v25, -v248, v205
    v_mfma_f32_16x16x32_bf16 v[180:183], v[128:131], v[68:71], v[180:183]
    s_add_u32 s65, s54, s99
    s_add_u32 m0, s61, 81920
    s_nop 0
    buffer_load_dwordx4 v40, s[8:11], s65 offen lds
    v_fma_f32 v206, v26, -v248, v206
    v_fma_f32 v207, v27, -v248, v207
    v_fma_f32 v208, v28, -v248, v208
    v_fma_f32 v209, v29, -v248, v209
    v_fma_f32 v210, v30, -v248, v210
    v_mfma_f32_16x16x32_bf16 v[232:235], v[128:131], v[252:255], v[232:235]
    v_fma_f32 v211, v31, -v248, v211
    v_mul_f32 v200, v200, v250
    v_mul_f32 v201, v201, v250
    v_mul_f32 v202, v202, v250
    v_mul_f32 v203, v203, v250
    v_mfma_f32_16x16x32_bf16 v[184:187], v[132:135], v[64:67], v[184:187]
    v_mul_f32 v204, v204, v250
    v_mul_f32 v205, v205, v250
    v_mul_f32 v206, v206, v250
    v_mul_f32 v207, v207, v250
    v_mul_f32 v208, v208, v250
    v_mfma_f32_16x16x32_bf16 v[188:191], v[132:135], v[68:71], v[188:191]
    s_add_u32 s65, s54, s99
    s_add_u32 m0, s61, 82944
    s_nop 0
    buffer_load_dwordx4 v41, s[8:11], s65 offen lds
    v_mul_f32 v209, v209, v250
    v_mul_f32 v210, v210, v250
    v_mul_f32 v211, v211, v250
    v_mul_f32 v8, v200, v200
    v_mul_f32 v9, v201, v201
    v_mfma_f32_16x16x32_bf16 v[236:239], v[132:135], v[252:255], v[236:239]
    v_mul_f32 v10, v202, v202
    v_mul_f32 v11, v203, v203
    v_mul_f32 v12, v204, v204
    v_mul_f32 v13, v205, v205
    v_mul_f32 v14, v206, v206
    v_mfma_f32_16x16x32_bf16 v[192:195], v[136:139], v[64:67], v[192:195]
    v_mul_f32 v15, v207, v207
    v_mul_f32 v16, v208, v208
    v_mul_f32 v17, v209, v209
    v_mul_f32 v18, v210, v210
    v_mul_f32 v19, v211, v211
    v_mfma_f32_16x16x32_bf16 v[196:199], v[136:139], v[68:71], v[196:199]
    s_add_u32 s65, s54, s99
    s_add_u32 m0, s61, 83968
    s_nop 0
    buffer_load_dwordx4 v42, s[8:11], s65 offen lds
    v_fma_f32 v8, v8, s58, v246
    v_fma_f32 v9, v9, s58, v247
    v_fma_f32 v10, v10, s58, v246
    v_fma_f32 v11, v11, s58, v247
    v_fma_f32 v12, v12, s58, v246
    v_mfma_f32_16x16x32_bf16 v[240:243], v[136:139], v[252:255], v[240:243]
    v_fma_f32 v13, v13, s58, v247
    v_fma_f32 v14, v14, s58, v246
    v_fma_f32 v15, v15, s58, v247
    v_fma_f32 v16, v16, s58, v246
    v_fma_f32 v17, v17, s58, v247
    v_mfma_f32_16x16x32_bf16 v[176:179], v[140:143], v[72:75], v[176:179]
    v_fma_f32 v18, v18, s58, v246
    v_fma_f32 v19, v19, s58, v247
    v_mul_f32 v8, v8, v200
    v_mul_f32 v9, v9, v201
    v_mul_f32 v10, v10, v202
    v_mfma_f32_16x16x32_bf16 v[180:183], v[140:143], v[76:79], v[180:183]
    v_mul_f32 v11, v11, v203
    v_mul_f32 v12, v12, v204
    v_mul_f32 v13, v13, v205
    v_mul_f32 v14, v14, v206
    v_mul_f32 v15, v15, v207
    v_mfma_f32_16x16x32_bf16 v[184:187], v[144:147], v[72:75], v[184:187]
    v_mul_f32 v16, v16, v208
    v_mul_f32 v17, v17, v209
    v_mul_f32 v18, v18, v210
    v_mul_f32 v19, v19, v211
    v_exp_f32 v8, v8
    v_mfma_f32_16x16x32_bf16 v[188:191], v[144:147], v[76:79], v[188:191]
    v_exp_f32 v9, v9
    v_exp_f32 v10, v10
    v_exp_f32 v11, v11
    v_exp_f32 v12, v12
    v_exp_f32 v13, v13
    v_mfma_f32_16x16x32_bf16 v[192:195], v[148:151], v[72:75], v[192:195]
    v_exp_f32 v14, v14
    v_exp_f32 v15, v15
    v_exp_f32 v16, v16
    v_exp_f32 v17, v17
    v_exp_f32 v18, v18
    v_mfma_f32_16x16x32_bf16 v[196:199], v[148:151], v[76:79], v[196:199]
    v_exp_f32 v19, v19
    v_add_f32 v8, 1.0, v8
    v_add_f32 v9, 1.0, v9
    v_add_f32 v10, 1.0, v10
    v_add_f32 v11, 1.0, v11
    s_waitcnt vmcnt(3)
    s_waitcnt lgkmcnt(0)
    s_barrier
    ds_read_b64_tr_b16 v[128:129], v225 offset:49152
    ds_read_b64_tr_b16 v[130:131], v225 offset:49920
    ds_read_b64_tr_b16 v[132:133], v226 offset:49152
    ds_read_b64_tr_b16 v[134:135], v226 offset:49920
    ds_read_b64_tr_b16 v[136:137], v227 offset:49152
    ds_read_b64_tr_b16 v[138:139], v227 offset:49920
    ds_read_b64_tr_b16 v[140:141], v228 offset:49152
    ds_read_b64_tr_b16 v[142:143], v228 offset:49920
    ds_read_b64_tr_b16 v[144:145], v229 offset:49152
    ds_read_b64_tr_b16 v[146:147], v229 offset:49920
    ds_read_b64_tr_b16 v[148:149], v230 offset:49152
    ds_read_b64_tr_b16 v[150:151], v230 offset:49920
    v_mfma_f32_16x16x32_bf16 v[176:179], v[152:155], v[80:83], v[176:179]
    v_add_f32 v12, 1.0, v12
    v_add_f32 v13, 1.0, v13
    v_add_f32 v14, 1.0, v14
    v_add_f32 v15, 1.0, v15
    v_add_f32 v16, 1.0, v16
    v_mfma_f32_16x16x32_bf16 v[180:183], v[152:155], v[84:87], v[180:183]
    v_add_f32 v17, 1.0, v17
    v_add_f32 v18, 1.0, v18
    v_add_f32 v19, 1.0, v19
    v_rcp_f32 v8, v8
    v_rcp_f32 v9, v9
    v_mfma_f32_16x16x32_bf16 v[232:235], v[152:155], v[252:255], v[232:235]
    v_rcp_f32 v10, v10
    v_rcp_f32 v11, v11
    v_rcp_f32 v12, v12
    v_rcp_f32 v13, v13
    v_rcp_f32 v14, v14
    v_mfma_f32_16x16x32_bf16 v[184:187], v[156:159], v[80:83], v[184:187]
    v_rcp_f32 v15, v15
    v_rcp_f32 v16, v16
    v_rcp_f32 v17, v17
    v_rcp_f32 v18, v18
    v_rcp_f32 v19, v19
    v_mfma_f32_16x16x32_bf16 v[188:191], v[156:159], v[84:87], v[188:191]
    v_mul_f32 v200, v200, v8
    v_mul_f32 v201, v201, v9
    v_mul_f32 v202, v202, v10
    v_mul_f32 v203, v203, v11
    v_mul_f32 v204, v204, v12
    v_mfma_f32_16x16x32_bf16 v[236:239], v[156:159], v[252:255], v[236:239]
    v_mul_f32 v205, v205, v13
    v_mul_f32 v206, v206, v14
    v_mul_f32 v207, v207, v15
    v_mul_f32 v208, v208, v16
    v_mul_f32 v209, v209, v17
    v_mfma_f32_16x16x32_bf16 v[192:195], v[160:163], v[80:83], v[192:195]
    v_mul_f32 v210, v210, v18
    v_mul_f32 v211, v211, v19
    v_add_f32 v8, v200, v201
    v_mul_f32 v9, v200, v200
    v_add_f32 v10, v202, v203
    v_mfma_f32_16x16x32_bf16 v[196:199], v[160:163], v[84:87], v[196:199]
    v_mul_f32 v11, v201, v201
    v_fmac_f32 v9, v202, v202
    v_fmac_f32 v11, v203, v203
    v_add_f32 v8, v8, v204
    v_fmac_f32 v9, v204, v204
    v_mfma_f32_16x16x32_bf16 v[240:243], v[160:163], v[252:255], v[240:243]
    v_add_f32 v10, v10, v205
    v_fmac_f32 v11, v205, v205
    v_add_f32 v8, v8, v206
    v_fmac_f32 v9, v206, v206
    v_add_f32 v10, v10, v207
    v_mfma_f32_16x16x32_bf16 v[176:179], v[164:167], v[88:91], v[176:179]
    v_fmac_f32 v11, v207, v207
    v_add_f32 v8, v8, v208
    v_fmac_f32 v9, v208, v208
    v_add_f32 v10, v10, v209
    v_fmac_f32 v11, v209, v209
    v_mfma_f32_16x16x32_bf16 v[180:183], v[164:167], v[92:95], v[180:183]
    v_add_f32 v8, v8, v210
    v_fmac_f32 v9, v210, v210
    v_add_f32 v10, v10, v211
    v_fmac_f32 v11, v211, v211
    s_lshl_b32 s48, s47, 7
    s_lshl_b32 s49, s43, 9
    s_add_u32 s48, s48, s49
    s_add_u32 s48, s48, 159744
    v_lshl_add_u32 v4, v3, 3, s48
    v_mfma_f32_16x16x32_bf16 v[184:187], v[168:171], v[88:91], v[184:187]
    v_add_f32 v8, v8, v10
    v_add_f32 v9, v9, v11
    v_mov_b32 v12, v8
    v_mov_b32 v13, v9
    s_nop 0
    v_permlane16_swap_b32 v8, v12
    v_mfma_f32_16x16x32_bf16 v[188:191], v[168:171], v[92:95], v[188:191]
    v_permlane16_swap_b32 v9, v13
    v_add_f32 v8, v8, v12
    v_add_f32 v9, v9, v13
    v_mov_b32 v12, v8
    v_mov_b32 v13, v9
    v_mfma_f32_16x16x32_bf16 v[192:195], v[172:175], v[88:91], v[192:195]
    v_permlane32_swap_b32 v8, v12
    v_permlane32_swap_b32 v9, v13
    v_add_f32 v8, v8, v12
    v_add_f32 v9, v9, v13
    s_mov_b64 exec, 0xffff
    ds_write_b64 v4, v[8:9]
    s_mov_b64 exec, -1
    v_mfma_f32_16x16x32_bf16 v[196:199], v[172:175], v[92:95], v[196:199]
    s_or_b32 s48, s41, s43
    s_cmp_lg_u32 s48, 0
    s_cbranch_scc1 k1_xst_3
    s_lshl_b32 s48, s40, 9
    s_lshl_b32 s49, s47, 7
    s_add_u32 s48, s48, s49
    s_add_u32 s48, s48, 14680064
    v_lshlrev_b32 v4, 3, v3
    s_mov_b64 exec, 0xffff
    buffer_store_dwordx2 v[248:249], v4, s[24:27], s48 offen
    s_mov_b64 exec, -1
k1_xst_3:
    s_waitcnt vmcnt(0)
    s_waitcnt lgkmcnt(0)
    s_barrier
    s_cmp_lg_u32 s42, 0
    s_cbranch_scc1 k1_pub_4
    v_lshlrev_b32 v4, 3, v1
    v_add_u32 v5, 159744, v4
    ds_read_b64 v[8:9], v5
    ds_read_b64 v[12:13], v5 offset:512
    s_lshl_b32 s48, s40, 3
    s_add_u32 s48, s48, s41
    s_lshl_b32 s48, s48, 10
    s_add_u32 s48, s48, 14745600
    v_lshlrev_b32 v4, 4, v1
    v_mov_b32 v10, s100
    v_mov_b32 v11, s101
    s_waitcnt lgkmcnt(0)
    v_pk_add_f32 v[8:9], v[8:9], v[12:13]
    buffer_store_dwordx4 v[8:11], v4, s[24:27], s48 offen sc1
k1_pub_4:
    ds_read_b64_tr_b16 v[152:153], v225 offset:0
    ds_read_b64_tr_b16 v[154:155], v225 offset:768
    ds_read_b64_tr_b16 v[156:157], v226 offset:0
    ds_read_b64_tr_b16 v[158:159], v226 offset:768
    ds_read_b64_tr_b16 v[160:161], v227 offset:0
    ds_read_b64_tr_b16 v[162:163], v227 offset:768
    ds_read_b64_tr_b16 v[164:165], v228 offset:0
    ds_read_b64_tr_b16 v[166:167], v228 offset:768
    ds_read_b64_tr_b16 v[168:169], v229 offset:0
    ds_read_b64_tr_b16 v[170:171], v229 offset:768
    ds_read_b64_tr_b16 v[172:173], v230 offset:0
    ds_read_b64_tr_b16 v[174:175], v230 offset:768
    v_mfma_f32_16x16x32_bf16 v[176:179], v[128:131], v[96:99], v[176:179]
    v_mfma_f32_16x16x32_bf16 v[180:183], v[128:131], v[100:103], v[180:183]
    v_mfma_f32_16x16x32_bf16 v[232:235], v[128:131], v[252:255], v[232:235]
    v_mfma_f32_16x16x32_bf16 v[184:187], v[132:135], v[96:99], v[184:187]
    v_mfma_f32_16x16x32_bf16 v[188:191], v[132:135], v[100:103], v[188:191]
    v_mfma_f32_16x16x32_bf16 v[236:239], v[132:135], v[252:255], v[236:239]
    v_mfma_f32_16x16x32_bf16 v[192:195], v[136:139], v[96:99], v[192:195]
    v_mfma_f32_16x16x32_bf16 v[196:199], v[136:139], v[100:103], v[196:199]
    v_mfma_f32_16x16x32_bf16 v[240:243], v[136:139], v[252:255], v[240:243]
    v_mfma_f32_16x16x32_bf16 v[176:179], v[140:143], v[104:107], v[176:179]
    v_mfma_f32_16x16x32_bf16 v[180:183], v[140:143], v[108:111], v[180:183]
    v_mfma_f32_16x16x32_bf16 v[184:187], v[144:147], v[104:107], v[184:187]
    v_mfma_f32_16x16x32_bf16 v[188:191], v[144:147], v[108:111], v[188:191]
    v_mfma_f32_16x16x32_bf16 v[192:195], v[148:151], v[104:107], v[192:195]
    v_mfma_f32_16x16x32_bf16 v[196:199], v[148:151], v[108:111], v[196:199]
    s_waitcnt lgkmcnt(0)
    s_barrier
    s_lshl_b32 s48, s40, 13
    s_lshl_b32 s49, s47, 8
    s_add_u32 s48, s48, s49
    s_add_u32 s62, s48, 14745600
    v_lshlrev_b32 v7, 4, v3
    v_lshl_add_u32 v7, v2, 11, v7
    buffer_load_dwordx4 v[28:31], v7, s[24:27], s62 offen sc1
    buffer_load_dwordx4 v[32:35], v7, s[24:27], s62 offen offset:1024 sc1
    v_mfma_f32_16x16x32_bf16 v[176:179], v[152:155], v[112:115], v[176:179]
    v_mfma_f32_16x16x32_bf16 v[180:183], v[152:155], v[116:119], v[180:183]
    v_mfma_f32_16x16x32_bf16 v[232:235], v[152:155], v[252:255], v[232:235]
    v_mfma_f32_16x16x32_bf16 v[184:187], v[156:159], v[112:115], v[184:187]
    v_mfma_f32_16x16x32_bf16 v[188:191], v[156:159], v[116:119], v[188:191]
    v_mfma_f32_16x16x32_bf16 v[236:239], v[156:159], v[252:255], v[236:239]
    v_mfma_f32_16x16x32_bf16 v[192:195], v[160:163], v[112:115], v[192:195]
    v_mfma_f32_16x16x32_bf16 v[196:199], v[160:163], v[116:119], v[196:199]
    v_mfma_f32_16x16x32_bf16 v[240:243], v[160:163], v[252:255], v[240:243]
    v_mfma_f32_16x16x32_bf16 v[176:179], v[164:167], v[120:123], v[176:179]
    v_mfma_f32_16x16x32_bf16 v[180:183], v[164:167], v[124:127], v[180:183]
    v_mfma_f32_16x16x32_bf16 v[184:187], v[168:171], v[120:123], v[184:187]
    v_mfma_f32_16x16x32_bf16 v[188:191], v[168:171], v[124:127], v[188:191]
    v_mfma_f32_16x16x32_bf16 v[192:195], v[172:175], v[120:123], v[192:195]
    v_mfma_f32_16x16x32_bf16 v[196:199], v[172:175], v[124:127], v[196:199]
    s_mul_i32 s48, s42, 3072
    s_add_u32 s48, s48, 16384
    v_lshl_add_u32 v4, v1, 4, s48
    s_lshl_b32 s48, s43, 2
    s_lshl_b32 s49, s44, 1
    s_add_u32 s48, s48, s49
    s_add_u32 s48, s48, s45
    s_mul_i32 s48, s48, 192
    s_add_u32 s48, s48, 157184
    v_lshl_add_u32 v5, v2, 4, s48
    ds_write_b128 v4, v[180:183] offset:0
    ds_write_b128 v4, v[188:191] offset:1024
    ds_write_b128 v4, v[196:199] offset:2048
    s_mov_b32 exec_lo, 0x00010001
    s_mov_b32 exec_hi, 0x00010001
    ds_write_b128 v5, v[232:235] offset:0
    ds_write_b128 v5, v[236:239] offset:64
    ds_write_b128 v5, v[240:243] offset:128
    s_mov_b64 exec, -1
    v_pk_add_f32 v[128:129], v[176:177], 0
    v_pk_add_f32 v[130:131], v[178:179], 0
    v_pk_add_f32 v[132:133], v[184:185], 0
    v_pk_add_f32 v[134:135], v[186:187], 0
    v_pk_add_f32 v[136:137], v[192:193], 0
    v_pk_add_f32 v[138:139], v[194:195], 0
    s_lshl_b32 s48, s47, 4
    v_add_u32 v43, s48, v3
    v_mul_u32_u24 v43, 200, v43
    v_lshl_add_u32 v43, v2, 3, v43
    s_mul_i32 s48, s43, 96
    s_add_u32 s48, s48, 0
    v_add_u32 v43, s48, v43
    s_waitcnt vmcnt(0)
k1_poll_5:
    v_cmp_ne_u32 vcc, s100, v30
    v_cmp_ne_u32 s[50:51], s101, v31
    s_nop 0
    s_or_b64 vcc, vcc, s[50:51]
    v_cmp_ne_u32 s[50:51], s100, v34
    s_nop 0
    s_or_b64 vcc, vcc, s[50:51]
    v_cmp_ne_u32 s[50:51], s101, v35
    s_nop 0
    s_or_b64 vcc, vcc, s[50:51]
    s_cmp_eq_u64 vcc, 0
    s_cbranch_scc1 k1_polled_6
    s_sleep 4
    buffer_load_dwordx4 v[28:31], v7, s[24:27], s62 offen sc1
    buffer_load_dwordx4 v[32:35], v7, s[24:27], s62 offen offset:1024 sc1
    s_waitcnt vmcnt(0)
    s_branch k1_poll_5
k1_polled_6:
    s_xor_b32 s48, s42, 1
    s_or_b32 s48, s48, s41
    s_cmp_lg_u32 s48, 0
    s_cbranch_scc1 k1_ep_7
    v_mov_b32 v4, 0
    v_mov_b32 v44, 1
    s_mov_b64 exec, 1
    buffer_atomic_add v44, v4, s[28:31], 0 offen sc0
    s_mov_b64 exec, -1
k1_ep_7:
    v_pk_add_f32 v[8:9], v[28:29], v[32:33]
    v_mov_b32 v10, v8
    v_mov_b32 v11, v9
    s_nop 0
    v_permlane16_swap_b32 v8, v10
    v_permlane16_swap_b32 v9, v11
    v_add_f32 v8, v8, v10
    v_add_f32 v9, v9, v11
    v_mov_b32 v10, v8
    v_mov_b32 v11, v9
    s_nop 0
    v_permlane32_swap_b32 v8, v10
    v_permlane32_swap_b32 v9, v11
    v_add_f32 v8, v8, v10
    v_add_f32 v9, v9, v11
    v_mul_f32 v8, 0x3aaaaaab, v8
    v_mul_f32 v9, 0x3aaaaaab, v9
    v_fma_f32 v9, -v8, v8, v9
    v_max_f32 v9, 0, v9
    v_cvt_pk_bf16_f32 v9, v9, v8
    v_and_b32 v8, 0xffff0000, v9
    v_lshlrev_b32 v9, 16, v9
    v_add_f32 v9, s55, v9
    v_cvt_pk_bf16_f32 v9, v9, v9
    v_and_b32 v9, 0xffff0000, v9
    v_sqrt_f32 v9, v9
    s_nop 0
    v_cvt_pk_bf16_f32 v9, v9, v9
    v_and_b32 v9, 0xffff0000, v9
    v_rcp_f32 v9, v9
    s_nop 0
    v_mov_b32 v10, v9
    v_pk_add_f32 v[200:201], v[200:201], v[8:9] op_sel_hi:[1,0] neg_lo:[0,1] neg_hi:[0,1]
    v_pk_add_f32 v[202:203], v[202:203], v[8:9] op_sel_hi:[1,0] neg_lo:[0,1] neg_hi:[0,1]
    v_pk_add_f32 v[204:205], v[204:205], v[8:9] op_sel_hi:[1,0] neg_lo:[0,1] neg_hi:[0,1]
    v_pk_add_f32 v[206:207], v[206:207], v[8:9] op_sel_hi:[1,0] neg_lo:[0,1] neg_hi:[0,1]
    v_pk_add_f32 v[208:209], v[208:209], v[8:9] op_sel_hi:[1,0] neg_lo:[0,1] neg_hi:[0,1]
    v_pk_add_f32 v[210:211], v[210:211], v[8:9] op_sel_hi:[1,0] neg_lo:[0,1] neg_hi:[0,1]
    v_pk_mul_f32 v[200:201], v[200:201], v[10:11] op_sel_hi:[1,0]
    v_pk_mul_f32 v[202:203], v[202:203], v[10:11] op_sel_hi:[1,0]
    v_pk_mul_f32 v[204:205], v[204:205], v[10:11] op_sel_hi:[1,0]
    v_pk_mul_f32 v[206:207], v[206:207], v[10:11] op_sel_hi:[1,0]
    v_pk_mul_f32 v[208:209], v[208:209], v[10:11] op_sel_hi:[1,0]
    v_pk_mul_f32 v[210:211], v[210:211], v[10:11] op_sel_hi:[1,0]
    v_cvt_pk_bf16_f32 v16, v200, v201
    v_cvt_pk_bf16_f32 v17, v202, v203
    ds_write_b64 v43, v[16:17] offset:0
    v_cvt_pk_bf16_f32 v18, v204, v205
    v_cvt_pk_bf16_f32 v19, v206, v207
    ds_write_b64 v43, v[18:19] offset:32
    v_cvt_pk_bf16_f32 v20, v208, v209
    v_cvt_pk_bf16_f32 v21, v210, v211
    ds_write_b64 v43, v[20:21] offset:64
    s_lshl_b32 s48, s57, 13
    s_lshl_b32 s49, s66, 21
    s_add_u32 s48, s48, s49
    v_lshlrev_b32 v4, 7, v1
    buffer_load_dword v37, v4, s[32:35], s48 offen
    s_mul_i32 s48, s57, 10
    v_add_u32 v4, s48, v1
    v_lshrrev_b32 v5, 5, v4
    v_lshlrev_b32 v5, 15, v5
    v_and_b32 v4, 31, v4
    v_lshl_add_u32 v4, v4, 7, v5
    s_and_b32 s48, s2, 7
    s_lshl_b32 s48, s48, 12
    s_mov_b64 exec, 0x3ff
    buffer_load_dword v37, v4, s[36:39], s48 offen
    s_mov_b64 exec, -1
    v_lshrrev_b32 v226, 1, v2
    v_lshrrev_b32 v5, 2, v3
    v_lshl_add_u32 v226, v226, 3, v5
    v_mul_u32_u24 v226, 200, v226
    v_and_b32 v5, 1, v2
    v_lshl_add_u32 v226, v5, 5, v226
    v_and_b32 v5, 3, v3
    v_lshl_add_u32 v226, v5, 3, v226
    v_lshlrev_b32 v227, 4, v1
    s_waitcnt lgkmcnt(0)
    s_barrier
    s_add_u32 s48, s42, 0
    s_mul_i32 s49, s48, 43
    s_lshr_b32 s49, s49, 7
    s_mul_i32 s50, s49, 3
    s_sub_u32 s50, s48, s50
    s_mul_i32 s49, s49, 3200
    s_lshl_b32 s50, s50, 6
    s_add_u32 s49, s49, s50
    s_add_u32 s49, s49, 0
    v_add_u32 v5, s49, v226
    ds_read_b64_tr_b16 v[8:9], v5
    ds_read_b64_tr_b16 v[10:11], v5 offset:800
    s_lshl_b32 s49, s41, 7
    s_lshl_b32 s50, s40, 2
    s_add_u32 s49, s49, s50
    s_mul_i32 s49, s49, 3
    s_add_u32 s49, s49, s48
    s_lshl_b32 s49, s49, 10
    s_add_u32 s49, s49, 0
    s_waitcnt lgkmcnt(0)
    buffer_store_dwordx4 v[8:11], v227, s[24:27], s49 offen
    s_cmp_ge_u32 s42, 4
    s_cbranch_scc1 k1_fr_8
    s_add_u32 s48, s42, 8
    s_mul_i32 s49, s48, 43
    s_lshr_b32 s49, s49, 7
    s_mul_i32 s50, s49, 3
    s_sub_u32 s50, s48, s50
    s_mul_i32 s49, s49, 3200
    s_lshl_b32 s50, s50, 6
    s_add_u32 s49, s49, s50
    s_add_u32 s49, s49, 0
    v_add_u32 v5, s49, v226
    ds_read_b64_tr_b16 v[12:13], v5
    ds_read_b64_tr_b16 v[14:15], v5 offset:800
    s_lshl_b32 s49, s41, 7
    s_lshl_b32 s50, s40, 2
    s_add_u32 s49, s49, s50
    s_mul_i32 s49, s49, 3
    s_add_u32 s49, s49, s48
    s_lshl_b32 s49, s49, 10
    s_add_u32 s49, s49, 0
    s_waitcnt lgkmcnt(0)
    buffer_store_dwordx4 v[12:15], v227, s[24:27], s49 offen
k1_fr_8:
    s_xor_b32 s48, s42, 4
    s_mul_i32 s48, s48, 3072
    s_add_u32 s48, s48, 16384
    v_lshl_add_u32 v4, v1, 4, s48
    ds_read_b128 v[48:51], v4 offset:0
    ds_read_b128 v[52:55], v4 offset:1024
    ds_read_b128 v[56:59], v4 offset:2048
    s_mul_i32 s48, s43, 768
    s_add_u32 s48, s48, 157184
    v_lshl_add_u32 v4, v2, 4, s48
    ds_read_b128 v[60:63], v4 offset:0
    ds_read_b128 v[64:67], v4 offset:64
    ds_read_b128 v[68:71], v4 offset:128
    s_waitcnt lgkmcnt(3)
    v_pk_add_f32 v[128:129], v[128:129], v[48:49]
    v_pk_add_f32 v[130:131], v[130:131], v[50:51]
    v_pk_add_f32 v[132:133], v[132:133], v[52:53]
    v_pk_add_f32 v[134:135], v[134:135], v[54:55]
    v_pk_add_f32 v[136:137], v[136:137], v[56:57]
    v_pk_add_f32 v[138:139], v[138:139], v[58:59]
    ds_read_b128 v[48:51], v4 offset:192
    ds_read_b128 v[52:55], v4 offset:256
    ds_read_b128 v[56:59], v4 offset:320
    s_waitcnt lgkmcnt(0)
    v_pk_add_f32 v[60:61], v[60:61], v[48:49]
    v_pk_add_f32 v[62:63], v[62:63], v[50:51]
    v_pk_add_f32 v[64:65], v[64:65], v[52:53]
    v_pk_add_f32 v[66:67], v[66:67], v[54:55]
    v_pk_add_f32 v[68:69], v[68:69], v[56:57]
    v_pk_add_f32 v[70:71], v[70:71], v[58:59]
    ds_read_b128 v[48:51], v4 offset:384
    ds_read_b128 v[52:55], v4 offset:448
    ds_read_b128 v[56:59], v4 offset:512
    s_waitcnt lgkmcnt(0)
    v_pk_add_f32 v[60:61], v[60:61], v[48:49]
    v_pk_add_f32 v[62:63], v[62:63], v[50:51]
    v_pk_add_f32 v[64:65], v[64:65], v[52:53]
    v_pk_add_f32 v[66:67], v[66:67], v[54:55]
    v_pk_add_f32 v[68:69], v[68:69], v[56:57]
    v_pk_add_f32 v[70:71], v[70:71], v[58:59]
    ds_read_b128 v[48:51], v4 offset:576
    ds_read_b128 v[52:55], v4 offset:640
    ds_read_b128 v[56:59], v4 offset:704
    s_waitcnt lgkmcnt(0)
    v_pk_add_f32 v[60:61], v[60:61], v[48:49]
    v_pk_add_f32 v[62:63], v[62:63], v[50:51]
    v_pk_add_f32 v[64:65], v[64:65], v[52:53]
    v_pk_add_f32 v[66:67], v[66:67], v[54:55]
    v_pk_add_f32 v[68:69], v[68:69], v[56:57]
    v_pk_add_f32 v[70:71], v[70:71], v[58:59]
    v_pk_fma_f32 v[128:129], v[60:61], v[248:249], v[128:129] op_sel_hi:[1,0,1] neg_lo:[0,1,0] neg_hi:[0,1,0]
    v_pk_fma_f32 v[130:131], v[62:63], v[248:249], v[130:131] op_sel_hi:[1,0,1] neg_lo:[0,1,0] neg_hi:[0,1,0]
    v_pk_fma_f32 v[132:133], v[64:65], v[248:249], v[132:133] op_sel_hi:[1,0,1] neg_lo:[0,1,0] neg_hi:[0,1,0]
    v_pk_fma_f32 v[134:135], v[66:67], v[248:249], v[134:135] op_sel_hi:[1,0,1] neg_lo:[0,1,0] neg_hi:[0,1,0]
    v_pk_fma_f32 v[136:137], v[68:69], v[248:249], v[136:137] op_sel_hi:[1,0,1] neg_lo:[0,1,0] neg_hi:[0,1,0]
    v_pk_fma_f32 v[138:139], v[70:71], v[248:249], v[138:139] op_sel_hi:[1,0,1] neg_lo:[0,1,0] neg_hi:[0,1,0]
    v_pk_mul_f32 v[128:129], v[128:129], v[250:251] op_sel_hi:[1,0]
    v_pk_mul_f32 v[130:131], v[130:131], v[250:251] op_sel_hi:[1,0]
    v_pk_mul_f32 v[132:133], v[132:133], v[250:251] op_sel_hi:[1,0]
    v_pk_mul_f32 v[134:135], v[134:135], v[250:251] op_sel_hi:[1,0]
    v_pk_mul_f32 v[136:137], v[136:137], v[250:251] op_sel_hi:[1,0]
    v_pk_mul_f32 v[138:139], v[138:139], v[250:251] op_sel_hi:[1,0]
    v_pk_mul_f32 v[48:49], v[128:129], v[128:129]
    v_pk_mul_f32 v[50:51], v[130:131], v[130:131]
    v_pk_mul_f32 v[52:53], v[132:133], v[132:133]
    v_pk_mul_f32 v[54:55], v[134:135], v[134:135]
    v_pk_mul_f32 v[56:57], v[136:137], v[136:137]
    v_pk_mul_f32 v[58:59], v[138:139], v[138:139]
    v_pk_fma_f32 v[48:49], v[48:49], s[58:59], v[246:247]
    v_pk_fma_f32 v[50:51], v[50:51], s[58:59], v[246:247]
    v_pk_fma_f32 v[52:53], v[52:53], s[58:59], v[246:247]
    v_pk_fma_f32 v[54:55], v[54:55], s[58:59], v[246:247]
    v_pk_fma_f32 v[56:57], v[56:57], s[58:59], v[246:247]
    v_pk_fma_f32 v[58:59], v[58:59], s[58:59], v[246:247]
    v_pk_mul_f32 v[48:49], v[48:49], v[128:129]
    v_pk_mul_f32 v[50:51], v[50:51], v[130:131]
    v_pk_mul_f32 v[52:53], v[52:53], v[132:133]
    v_pk_mul_f32 v[54:55], v[54:55], v[134:135]
    v_pk_mul_f32 v[56:57], v[56:57], v[136:137]
    v_pk_mul_f32 v[58:59], v[58:59], v[138:139]
    v_exp_f32 v48, v48
    v_exp_f32 v49, v49
    v_exp_f32 v50, v50
    v_exp_f32 v51, v51
    v_exp_f32 v52, v52
    v_exp_f32 v53, v53
    v_exp_f32 v54, v54
    v_exp_f32 v55, v55
    v_exp_f32 v56, v56
    v_exp_f32 v57, v57
    v_exp_f32 v58, v58
    v_exp_f32 v59, v59
    v_pk_add_f32 v[48:49], v[48:49], 1.0 op_sel_hi:[1,0]
    v_pk_add_f32 v[50:51], v[50:51], 1.0 op_sel_hi:[1,0]
    v_pk_add_f32 v[52:53], v[52:53], 1.0 op_sel_hi:[1,0]
    v_pk_add_f32 v[54:55], v[54:55], 1.0 op_sel_hi:[1,0]
    v_pk_add_f32 v[56:57], v[56:57], 1.0 op_sel_hi:[1,0]
    v_pk_add_f32 v[58:59], v[58:59], 1.0 op_sel_hi:[1,0]
    v_rcp_f32 v48, v48
    v_rcp_f32 v49, v49
    v_rcp_f32 v50, v50
    v_rcp_f32 v51, v51
    v_rcp_f32 v52, v52
    v_rcp_f32 v53, v53
    v_rcp_f32 v54, v54
    v_rcp_f32 v55, v55
    v_rcp_f32 v56, v56
    v_rcp_f32 v57, v57
    v_rcp_f32 v58, v58
    v_rcp_f32 v59, v59
    v_pk_mul_f32 v[128:129], v[128:129], v[48:49]
    v_pk_mul_f32 v[130:131], v[130:131], v[50:51]
    v_pk_mul_f32 v[132:133], v[132:133], v[52:53]
    v_pk_mul_f32 v[134:135], v[134:135], v[54:55]
    v_pk_mul_f32 v[136:137], v[136:137], v[56:57]
    v_pk_mul_f32 v[138:139], v[138:139], v[58:59]
    v_lshrrev_b32 v4, 1, v2
    v_mul_u32_u24 v4, 3072, v4
    v_and_b32 v5, 1, v2
    v_lshlrev_b32 v5, 5, v5
    v_add_u32 v5, v5, v3
    v_lshl_add_u32 v4, v5, 4, v4
    s_lshl_b32 s48, s40, 3
    s_add_u32 s48, s48, s41
    s_mul_i32 s62, s48, 12288
    s_lshr_b32 s48, s47, 1
    s_mul_i32 s48, s48, 6144
    s_add_u32 s62, s62, s48
    s_and_b32 s48, s47, 1
    s_lshl_b32 s48, s48, 8
    s_add_u32 s62, s62, s48
    s_add_u32 s62, s62, 3145728
    s_mul_i32 s51, s43, 3
    v_cvt_pk_bf16_f32 v48, v128, v129
    v_cvt_pk_bf16_f32 v49, v130, v131
    s_add_u32 s48, s51, 0
    s_lshr_b32 s49, s48, 1
    s_lshl_b32 s49, s49, 10
    s_and_b32 s48, s48, 1
    s_lshl_b32 s48, s48, 3
    s_add_u32 s48, s48, s49
    s_add_u32 s48, s48, s62
    buffer_store_dwordx2 v[48:49], v4, s[24:27], s48 offen
    v_cvt_pk_bf16_f32 v50, v132, v133
    v_cvt_pk_bf16_f32 v51, v134, v135
    s_add_u32 s48, s51, 1
    s_lshr_b32 s49, s48, 1
    s_lshl_b32 s49, s49, 10
    s_and_b32 s48, s48, 1
    s_lshl_b32 s48, s48, 3
    s_add_u32 s48, s48, s49
    s_add_u32 s48, s48, s62
    buffer_store_dwordx2 v[50:51], v4, s[24:27], s48 offen
    v_cvt_pk_bf16_f32 v52, v136, v137
    v_cvt_pk_bf16_f32 v53, v138, v139
    s_add_u32 s48, s51, 2
    s_lshr_b32 s49, s48, 1
    s_lshl_b32 s49, s49, 10
    s_and_b32 s48, s48, 1
    s_lshl_b32 s48, s48, 3
    s_add_u32 s48, s48, s49
    s_add_u32 s48, s48, s62
    buffer_store_dwordx2 v[52:53], v4, s[24:27], s48 offen
    s_xor_b32 s48, s42, 1
    s_or_b32 s48, s48, s41
    s_cmp_lg_u32 s48, 0
    s_cbranch_scc1 k1_ep2_9
    s_waitcnt vmcnt(0)
    v_readfirstlane_b32 s48, v44
    s_nop 0
    s_cmp_lg_u32 s48, 31
    s_cbranch_scc1 k1_ep2_9
    v_mov_b32 v8, s100
    v_mov_b32 v9, s101
    v_mov_b32 v4, 14712832
    s_mov_b64 exec, 1
    buffer_store_dwordx2 v[8:9], v4, s[24:27], 0 offen sc1
    s_mov_b64 exec, -1
k1_ep2_9:
k1_kernel_end:
    s_endpgm

.globl k2_kernel
.p2align 8
.type k2_kernel,@function
k2_kernel:
    s_cmp_ge_u32 s2, 512
    s_cbranch_scc1 k2_kernel_end
    s_cmp_lt_u32 s2, 256
    s_cbranch_scc1 k2_kernel_conv
    s_load_dwordx2 s[4:5], s[0:1], 64
    s_load_dwordx2 s[8:9], s[0:1], 104
    s_load_dwordx2 s[12:13], s[0:1], 72
    v_lshrrev_b32 v2, 6, v0
    v_and_b32 v1, 63, v0
    v_readfirstlane_b32 s34, v2
    s_mov_b32 s6, 8388608
    s_mov_b32 s7, 0x20000
    s_mov_b32 s10, 15990784
    s_mov_b32 s11, 0x20000
    s_mov_b32 s14, 4096
    s_mov_b32 s15, 0x20000
    s_and_b32 s40, s2, 7
    s_lshr_b32 s41, s2, 3
    s_and_b32 s41, s41, 31
    s_lshr_b32 s32, s40, 1
    s_lshl_b32 s32, s32, 3
    s_and_b32 s42, s41, 7
    s_add_u32 s32, s32, s42
    s_and_b32 s33, s40, 1
    s_lshl_b32 s33, s33, 2
    s_lshr_b32 s42, s41, 3
    s_add_u32 s33, s33, s42
    s_lshl_b32 s44, s33, 7
    s_lshl_b32 s40, s34, 5
    s_add_u32 s44, s44, s40
    s_mul_i32 s44, s44, 3072
    s_add_u32 s44, s44, 0
    s_lshl_b32 s45, s32, 18
    s_lshl_b32 s40, s34, 10
    s_add_u32 s45, s45, s40
    s_lshl_b32 s46, s34, 14
    v_lshlrev_b32 v5, 4, v1
    v_lshrrev_b32 v2, 3, v1
    v_lshlrev_b32 v2, 12, v2
    v_and_b32 v3, 7, v1
    v_lshrrev_b32 v4, 4, v1
    v_xor_b32 v3, v3, v4
    v_lshl_add_u32 v6, v3, 4, v2
    v_xor_b32 v7, 64, v6
    s_mov_b32 s50, 0
    s_waitcnt lgkmcnt(0)
    s_add_u32 s52, s50, 0
    s_and_b32 s52, s52, 7
    s_mul_i32 s52, s52, 12288
    s_add_u32 s52, s52, s44
    buffer_load_dwordx4 v[104:107], v5, s[8:11], s52 offen offset:0
    buffer_load_dwordx4 v[108:111], v5, s[8:11], s52 offen offset:1024
    buffer_load_dwordx4 v[112:115], v5, s[8:11], s52 offen offset:2048
    s_add_u32 s54, s50, 0
    s_and_b32 s54, s54, 7
    s_lshl_b32 s54, s54, 7
    s_add_u32 s54, s54, s45
    s_add_u32 s42, s54, 0
    s_add_u32 m0, s46, 0
    s_nop 0
    buffer_load_dwordx4 v6, s[4:7], s42 offen lds
    s_add_u32 s42, s54, 32768
    s_add_u32 m0, s46, 1024
    s_nop 0
    buffer_load_dwordx4 v7, s[4:7], s42 offen lds
    s_add_u32 s42, s54, 65536
    s_add_u32 m0, s46, 2048
    s_nop 0
    buffer_load_dwordx4 v6, s[4:7], s42 offen lds
    s_add_u32 s42, s54, 98304
    s_add_u32 m0, s46, 3072
    s_nop 0
    buffer_load_dwordx4 v7, s[4:7], s42 offen lds
    s_add_u32 s42, s54, 131072
    s_add_u32 m0, s46, 4096
    s_nop 0
    buffer_load_dwordx4 v6, s[4:7], s42 offen lds
    s_add_u32 s42, s54, 163840
    s_add_u32 m0, s46, 5120
    s_nop 0
    buffer_load_dwordx4 v7, s[4:7], s42 offen lds
    s_add_u32 s42, s54, 196608
    s_add_u32 m0, s46, 6144
    s_nop 0
    buffer_load_dwordx4 v6, s[4:7], s42 offen lds
    s_add_u32 s42, s54, 229376
    s_add_u32 m0, s46, 7168
    s_nop 0
    buffer_load_dwordx4 v7, s[4:7], s42 offen lds
    s_add_u32 s41, s52, 3072
    buffer_load_dwordx4 v[116:119], v5, s[8:11], s41 offen offset:0
    s_add_u32 s41, s52, 3072
    buffer_load_dwordx4 v[120:123], v5, s[8:11], s41 offen offset:1024
    s_add_u32 s41, s52, 3072
    buffer_load_dwordx4 v[124:127], v5, s[8:11], s41 offen offset:2048
    s_add_u32 s41, s52, 6144
    buffer_load_dwordx4 v[128:131], v5, s[8:11], s41 offen offset:0
    s_add_u32 s41, s52, 6144
    buffer_load_dwordx4 v[132:135], v5, s[8:11], s41 offen offset:1024
    s_add_u32 s41, s52, 6144
    buffer_load_dwordx4 v[136:139], v5, s[8:11], s41 offen offset:2048
    s_add_u32 s41, s52, 9216
    buffer_load_dwordx4 v[140:143], v5, s[8:11], s41 offen offset:0
    s_add_u32 s41, s52, 9216
    buffer_load_dwordx4 v[144:147], v5, s[8:11], s41 offen offset:1024
    s_add_u32 s41, s52, 9216
    buffer_load_dwordx4 v[148:151], v5, s[8:11], s41 offen offset:2048
    v_and_b32 v2, 31, v1
    v_lshrrev_b32 v3, 1, v2
    v_and_b32 v3, 7, v3
    v_lshrrev_b32 v4, 5, v1
    v_xor_b32 v3, v3, v4
    v_lshl_add_u32 v2, v2, 7, s46
    v_xor_b32 v4, 0, v3
    v_lshl_add_u32 v180, v4, 4, v2
    v_xor_b32 v4, 2, v3
    v_lshl_add_u32 v181, v4, 4, v2
    v_xor_b32 v4, 4, v3
    v_lshl_add_u32 v182, v4, 4, v2
    v_xor_b32 v4, 6, v3
    v_lshl_add_u32 v183, v4, 4, v2
    s_waitcnt vmcnt(9)
    s_setprio 2
    ds_read_b128 v[164:167], v180 offset:0
    ds_read_b128 v[168:171], v180 offset:4096
    s_waitcnt vmcnt(17)
    s_waitcnt lgkmcnt(0)
    v_mfma_f32_32x32x16_bf16 v[8:23], v[104:107], v[164:167], 0
    ds_read_b128 v[172:175], v181 offset:0
    ds_read_b128 v[176:179], v181 offset:4096
    v_mfma_f32_32x32x16_bf16 v[24:39], v[104:107], v[168:171], 0
    s_add_u32 s53, s50, 1
    s_and_b32 s53, s53, 7
    s_mul_i32 s53, s53, 12288
    s_add_u32 s53, s53, s44
    buffer_load_dwordx4 v[152:155], v5, s[8:11], s53 offen offset:0
    v_mfma_f32_32x32x16_bf16 v[40:55], v[108:111], v[164:167], 0
    buffer_load_dwordx4 v[156:159], v5, s[8:11], s53 offen offset:1024
    v_mfma_f32_32x32x16_bf16 v[56:71], v[108:111], v[168:171], 0
    buffer_load_dwordx4 v[160:163], v5, s[8:11], s53 offen offset:2048
    v_mfma_f32_32x32x16_bf16 v[72:87], v[112:115], v[164:167], 0
    s_add_u32 s55, s50, 1
    s_and_b32 s55, s55, 7
    s_lshl_b32 s55, s55, 7
    s_add_u32 s55, s55, s45
    s_add_u32 s42, s55, 0
    s_add_u32 m0, s46, 8192
    s_nop 0
    buffer_load_dwordx4 v6, s[4:7], s42 offen lds
    v_mfma_f32_32x32x16_bf16 v[88:103], v[112:115], v[168:171], 0
    s_add_u32 s42, s55, 32768
    s_add_u32 m0, s46, 9216
    s_nop 0
    buffer_load_dwordx4 v7, s[4:7], s42 offen lds
    s_add_u32 s42, s55, 65536
    s_add_u32 m0, s46, 10240
    s_nop 0
    buffer_load_dwordx4 v6, s[4:7], s42 offen lds
    s_add_u32 s42, s55, 98304
    s_add_u32 m0, s46, 11264
    s_nop 0
    buffer_load_dwordx4 v7, s[4:7], s42 offen lds
    s_waitcnt vmcnt(13)
    s_waitcnt lgkmcnt(0)
    v_mfma_f32_32x32x16_bf16 v[8:23], v[116:119], v[172:175], v[8:23]
    ds_read_b128 v[164:167], v182 offset:0
    ds_read_b128 v[168:171], v182 offset:4096
    v_mfma_f32_32x32x16_bf16 v[24:39], v[116:119], v[176:179], v[24:39]
    s_add_u32 s41, s53, 3072
    buffer_load_dwordx4 v[104:107], v5, s[8:11], s41 offen offset:0
    v_mfma_f32_32x32x16_bf16 v[40:55], v[120:123], v[172:175], v[40:55]
    s_add_u32 s41, s53, 3072
    buffer_load_dwordx4 v[108:111], v5, s[8:11], s41 offen offset:1024
    v_mfma_f32_32x32x16_bf16 v[56:71], v[120:123], v[176:179], v[56:71]
    s_add_u32 s41, s53, 3072
    buffer_load_dwordx4 v[112:115], v5, s[8:11], s41 offen offset:2048
    v_mfma_f32_32x32x16_bf16 v[72:87], v[124:127], v[172:175], v[72:87]
    s_add_u32 s42, s55, 131072
    s_add_u32 m0, s46, 12288
    s_nop 0
    buffer_load_dwordx4 v6, s[4:7], s42 offen lds
    v_mfma_f32_32x32x16_bf16 v[88:103], v[124:127], v[176:179], v[88:103]
    s_add_u32 s42, s55, 163840
    s_add_u32 m0, s46, 13312
    s_nop 0
    buffer_load_dwordx4 v7, s[4:7], s42 offen lds
    s_add_u32 s42, s55, 196608
    s_add_u32 m0, s46, 14336
    s_nop 0
    buffer_load_dwordx4 v6, s[4:7], s42 offen lds
    s_add_u32 s42, s55, 229376
    s_add_u32 m0, s46, 15360
    s_nop 0
    buffer_load_dwordx4 v7, s[4:7], s42 offen lds
    s_waitcnt vmcnt(17)
    s_waitcnt lgkmcnt(0)
    v_mfma_f32_32x32x16_bf16 v[8:23], v[128:131], v[164:167], v[8:23]
    ds_read_b128 v[172:175], v183 offset:0
    ds_read_b128 v[176:179], v183 offset:4096
    v_mfma_f32_32x32x16_bf16 v[24:39], v[128:131], v[168:171], v[24:39]
    s_add_u32 s41, s53, 6144
    buffer_load_dwordx4 v[116:119], v5, s[8:11], s41 offen offset:0
    v_mfma_f32_32x32x16_bf16 v[40:55], v[132:135], v[164:167], v[40:55]
    s_add_u32 s41, s53, 6144
    buffer_load_dwordx4 v[120:123], v5, s[8:11], s41 offen offset:1024
    v_mfma_f32_32x32x16_bf16 v[56:71], v[132:135], v[168:171], v[56:71]
    s_add_u32 s41, s53, 6144
    buffer_load_dwordx4 v[124:127], v5, s[8:11], s41 offen offset:2048
    v_mfma_f32_32x32x16_bf16 v[72:87], v[136:139], v[164:167], v[72:87]
    v_mfma_f32_32x32x16_bf16 v[88:103], v[136:139], v[168:171], v[88:103]
    s_waitcnt vmcnt(17)
    s_waitcnt lgkmcnt(0)
    v_mfma_f32_32x32x16_bf16 v[8:23], v[140:143], v[172:175], v[8:23]
    s_waitcnt vmcnt(3)
    ds_read_b128 v[164:167], v180 offset:8192
    ds_read_b128 v[168:171], v180 offset:12288
    v_mfma_f32_32x32x16_bf16 v[24:39], v[140:143], v[176:179], v[24:39]
    s_add_u32 s41, s53, 9216
    buffer_load_dwordx4 v[128:131], v5, s[8:11], s41 offen offset:0
    v_mfma_f32_32x32x16_bf16 v[40:55], v[144:147], v[172:175], v[40:55]
    s_add_u32 s41, s53, 9216
    buffer_load_dwordx4 v[132:135], v5, s[8:11], s41 offen offset:1024
    v_mfma_f32_32x32x16_bf16 v[56:71], v[144:147], v[176:179], v[56:71]
    s_add_u32 s41, s53, 9216
    buffer_load_dwordx4 v[136:139], v5, s[8:11], s41 offen offset:2048
    v_mfma_f32_32x32x16_bf16 v[72:87], v[148:151], v[172:175], v[72:87]
    s_add_u32 s54, s50, 2
    s_and_b32 s54, s54, 7
    s_lshl_b32 s54, s54, 7
    s_add_u32 s54, s54, s45
    s_add_u32 s42, s54, 0
    s_add_u32 m0, s46, 0
    s_nop 0
    buffer_load_dwordx4 v6, s[4:7], s42 offen lds
    v_mfma_f32_32x32x16_bf16 v[88:103], v[148:151], v[176:179], v[88:103]
    s_add_u32 s42, s54, 32768
    s_add_u32 m0, s46, 1024
    s_nop 0
    buffer_load_dwordx4 v7, s[4:7], s42 offen lds
    s_waitcnt vmcnt(19)
    s_waitcnt lgkmcnt(0)
    v_mfma_f32_32x32x16_bf16 v[8:23], v[152:155], v[164:167], v[8:23]
    ds_read_b128 v[172:175], v181 offset:8192
    ds_read_b128 v[176:179], v181 offset:12288
    v_mfma_f32_32x32x16_bf16 v[24:39], v[152:155], v[168:171], v[24:39]
    s_add_u32 s52, s50, 2
    s_and_b32 s52, s52, 7
    s_mul_i32 s52, s52, 12288
    s_add_u32 s52, s52, s44
    buffer_load_dwordx4 v[140:143], v5, s[8:11], s52 offen offset:0
    v_mfma_f32_32x32x16_bf16 v[40:55], v[156:159], v[164:167], v[40:55]
    buffer_load_dwordx4 v[144:147], v5, s[8:11], s52 offen offset:1024
    v_mfma_f32_32x32x16_bf16 v[56:71], v[156:159], v[168:171], v[56:71]
    buffer_load_dwordx4 v[148:151], v5, s[8:11], s52 offen offset:2048
    v_mfma_f32_32x32x16_bf16 v[72:87], v[160:163], v[164:167], v[72:87]
    s_add_u32 s42, s54, 65536
    s_add_u32 m0, s46, 2048
    s_nop 0
    buffer_load_dwordx4 v6, s[4:7], s42 offen lds
    v_mfma_f32_32x32x16_bf16 v[88:103], v[160:163], v[168:171], v[88:103]
    s_add_u32 s42, s54, 98304
    s_add_u32 m0, s46, 3072
    s_nop 0
    buffer_load_dwordx4 v7, s[4:7], s42 offen lds
    s_add_u32 s42, s54, 131072
    s_add_u32 m0, s46, 4096
    s_nop 0
    buffer_load_dwordx4 v6, s[4:7], s42 offen lds
    s_waitcnt vmcnt(18)
    s_waitcnt lgkmcnt(0)
    v_mfma_f32_32x32x16_bf16 v[8:23], v[104:107], v[172:175], v[8:23]
    ds_read_b128 v[164:167], v182 offset:8192
    ds_read_b128 v[168:171], v182 offset:12288
    v_mfma_f32_32x32x16_bf16 v[24:39], v[104:107], v[176:179], v[24:39]
    s_add_u32 s41, s52, 3072
    buffer_load_dwordx4 v[152:155], v5, s[8:11], s41 offen offset:0
    v_mfma_f32_32x32x16_bf16 v[40:55], v[108:111], v[172:175], v[40:55]
    s_add_u32 s41, s52, 3072
    buffer_load_dwordx4 v[156:159], v5, s[8:11], s41 offen offset:1024
    v_mfma_f32_32x32x16_bf16 v[56:71], v[108:111], v[176:179], v[56:71]
    s_add_u32 s41, s52, 3072
    buffer_load_dwordx4 v[160:163], v5, s[8:11], s41 offen offset:2048
    v_mfma_f32_32x32x16_bf16 v[72:87], v[112:115], v[172:175], v[72:87]
    s_add_u32 s42, s54, 163840
    s_add_u32 m0, s46, 5120
    s_nop 0
    buffer_load_dwordx4 v7, s[4:7], s42 offen lds
    v_mfma_f32_32x32x16_bf16 v[88:103], v[112:115], v[176:179], v[88:103]
    s_add_u32 s42, s54, 196608
    s_add_u32 m0, s46, 6144
    s_nop 0
    buffer_load_dwordx4 v6, s[4:7], s42 offen lds
    s_add_u32 s42, s54, 229376
    s_add_u32 m0, s46, 7168
    s_nop 0
    buffer_load_dwordx4 v7, s[4:7], s42 offen lds
    s_waitcnt vmcnt(17)
    s_waitcnt lgkmcnt(0)
    v_mfma_f32_32x32x16_bf16 v[8:23], v[116:119], v[164:167], v[8:23]
    ds_read_b128 v[172:175], v183 offset:8192
    ds_read_b128 v[176:179], v183 offset:12288
    v_mfma_f32_32x32x16_bf16 v[24:39], v[116:119], v[168:171], v[24:39]
    s_add_u32 s41, s52, 6144
    buffer_load_dwordx4 v[104:107], v5, s[8:11], s41 offen offset:0
    v_mfma_f32_32x32x16_bf16 v[40:55], v[120:123], v[164:167], v[40:55]
    s_add_u32 s41, s52, 6144
    buffer_load_dwordx4 v[108:111], v5, s[8:11], s41 offen offset:1024
    v_mfma_f32_32x32x16_bf16 v[56:71], v[120:123], v[168:171], v[56:71]
    s_add_u32 s41, s52, 6144
    buffer_load_dwordx4 v[112:115], v5, s[8:11], s41 offen offset:2048
    v_mfma_f32_32x32x16_bf16 v[72:87], v[124:127], v[164:167], v[72:87]
    v_mfma_f32_32x32x16_bf16 v[88:103], v[124:127], v[168:171], v[88:103]
    s_waitcnt vmcnt(17)
    s_waitcnt lgkmcnt(0)
    v_mfma_f32_32x32x16_bf16 v[8:23], v[128:131], v[172:175], v[8:23]
    s_waitcnt vmcnt(3)
    ds_read_b128 v[164:167], v180 offset:0
    ds_read_b128 v[168:171], v180 offset:4096
    v_mfma_f32_32x32x16_bf16 v[24:39], v[128:131], v[176:179], v[24:39]
    s_add_u32 s41, s52, 9216
    buffer_load_dwordx4 v[116:119], v5, s[8:11], s41 offen offset:0
    v_mfma_f32_32x32x16_bf16 v[40:55], v[132:135], v[172:175], v[40:55]
    s_add_u32 s41, s52, 9216
    buffer_load_dwordx4 v[120:123], v5, s[8:11], s41 offen offset:1024
    v_mfma_f32_32x32x16_bf16 v[56:71], v[132:135], v[176:179], v[56:71]
    s_add_u32 s41, s52, 9216
    buffer_load_dwordx4 v[124:127], v5, s[8:11], s41 offen offset:2048
    v_mfma_f32_32x32x16_bf16 v[72:87], v[136:139], v[172:175], v[72:87]
    s_add_u32 s55, s50, 3
    s_and_b32 s55, s55, 7
    s_lshl_b32 s55, s55, 7
    s_add_u32 s55, s55, s45
    s_add_u32 s42, s55, 0
    s_add_u32 m0, s46, 8192
    s_nop 0
    buffer_load_dwordx4 v6, s[4:7], s42 offen lds
    v_mfma_f32_32x32x16_bf16 v[88:103], v[136:139], v[176:179], v[88:103]
    s_add_u32 s42, s55, 32768
    s_add_u32 m0, s46, 9216
    s_nop 0
    buffer_load_dwordx4 v7, s[4:7], s42 offen lds
    s_waitcnt vmcnt(17)
    s_waitcnt lgkmcnt(0)
    v_mfma_f32_32x32x16_bf16 v[8:23], v[140:143], v[164:167], v[8:23]
    ds_read_b128 v[172:175], v181 offset:0
    ds_read_b128 v[176:179], v181 offset:4096
    v_mfma_f32_32x32x16_bf16 v[24:39], v[140:143], v[168:171], v[24:39]
    s_add_u32 s53, s50, 3
    s_and_b32 s53, s53, 7
    s_mul_i32 s53, s53, 12288
    s_add_u32 s53, s53, s44
    buffer_load_dwordx4 v[128:131], v5, s[8:11], s53 offen offset:0
    v_mfma_f32_32x32x16_bf16 v[40:55], v[144:147], v[164:167], v[40:55]
    buffer_load_dwordx4 v[132:135], v5, s[8:11], s53 offen offset:1024
    v_mfma_f32_32x32x16_bf16 v[56:71], v[144:147], v[168:171], v[56:71]
    buffer_load_dwordx4 v[136:139], v5, s[8:11], s53 offen offset:2048
    v_mfma_f32_32x32x16_bf16 v[72:87], v[148:151], v[164:167], v[72:87]
    s_add_u32 s42, s55, 65536
    s_add_u32 m0, s46, 10240
    s_nop 0
    buffer_load_dwordx4 v6, s[4:7], s42 offen lds
    v_mfma_f32_32x32x16_bf16 v[88:103], v[148:151], v[168:171], v[88:103]
    s_add_u32 s42, s55, 98304
    s_add_u32 m0, s46, 11264
    s_nop 0
    buffer_load_dwordx4 v7, s[4:7], s42 offen lds
    s_add_u32 s42, s55, 131072
    s_add_u32 m0, s46, 12288
    s_nop 0
    buffer_load_dwordx4 v6, s[4:7], s42 offen lds
    s_waitcnt vmcnt(17)
    s_waitcnt lgkmcnt(0)
    v_mfma_f32_32x32x16_bf16 v[8:23], v[152:155], v[172:175], v[8:23]
    ds_read_b128 v[164:167], v182 offset:0
    ds_read_b128 v[168:171], v182 offset:4096
    v_mfma_f32_32x32x16_bf16 v[24:39], v[152:155], v[176:179], v[24:39]
    s_add_u32 s41, s53, 3072
    buffer_load_dwordx4 v[140:143], v5, s[8:11], s41 offen offset:0
    v_mfma_f32_32x32x16_bf16 v[40:55], v[156:159], v[172:175], v[40:55]
    s_add_u32 s41, s53, 3072
    buffer_load_dwordx4 v[144:147], v5, s[8:11], s41 offen offset:1024
    v_mfma_f32_32x32x16_bf16 v[56:71], v[156:159], v[176:179], v[56:71]
    s_add_u32 s41, s53, 3072
    buffer_load_dwordx4 v[148:151], v5, s[8:11], s41 offen offset:2048
    v_mfma_f32_32x32x16_bf16 v[72:87], v[160:163], v[172:175], v[72:87]
    s_add_u32 s42, s55, 163840
    s_add_u32 m0, s46, 13312
    s_nop 0
    buffer_load_dwordx4 v7, s[4:7], s42 offen lds
    v_mfma_f32_32x32x16_bf16 v[88:103], v[160:163], v[176:179], v[88:103]
    s_add_u32 s42, s55, 196608
    s_add_u32 m0, s46, 14336
    s_nop 0
    buffer_load_dwordx4 v6, s[4:7], s42 offen lds
    s_add_u32 s42, s55, 229376
    s_add_u32 m0, s46, 15360
    s_nop 0
    buffer_load_dwordx4 v7, s[4:7], s42 offen lds
    s_waitcnt vmcnt(17)
    s_waitcnt lgkmcnt(0)
    v_mfma_f32_32x32x16_bf16 v[8:23], v[104:107], v[164:167], v[8:23]
    ds_read_b128 v[172:175], v183 offset:0
    ds_read_b128 v[176:179], v183 offset:4096
    v_mfma_f32_32x32x16_bf16 v[24:39], v[104:107], v[168:171], v[24:39]
    s_add_u32 s41, s53, 6144
    buffer_load_dwordx4 v[152:155], v5, s[8:11], s41 offen offset:0
    v_mfma_f32_32x32x16_bf16 v[40:55], v[108:111], v[164:167], v[40:55]
    s_add_u32 s41, s53, 6144
    buffer_load_dwordx4 v[156:159], v5, s[8:11], s41 offen offset:1024
    v_mfma_f32_32x32x16_bf16 v[56:71], v[108:111], v[168:171], v[56:71]
    s_add_u32 s41, s53, 6144
    buffer_load_dwordx4 v[160:163], v5, s[8:11], s41 offen offset:2048
    v_mfma_f32_32x32x16_bf16 v[72:87], v[112:115], v[164:167], v[72:87]
    v_mfma_f32_32x32x16_bf16 v[88:103], v[112:115], v[168:171], v[88:103]
    s_waitcnt vmcnt(17)
    s_waitcnt lgkmcnt(0)
    v_mfma_f32_32x32x16_bf16 v[8:23], v[116:119], v[172:175], v[8:23]
    s_waitcnt vmcnt(3)
    ds_read_b128 v[164:167], v180 offset:8192
    ds_read_b128 v[168:171], v180 offset:12288
    v_mfma_f32_32x32x16_bf16 v[24:39], v[116:119], v[176:179], v[24:39]
    s_add_u32 s41, s53, 9216
    buffer_load_dwordx4 v[104:107], v5, s[8:11], s41 offen offset:0
    v_mfma_f32_32x32x16_bf16 v[40:55], v[120:123], v[172:175], v[40:55]
    s_add_u32 s41, s53, 9216
    buffer_load_dwordx4 v[108:111], v5, s[8:11], s41 offen offset:1024
    v_mfma_f32_32x32x16_bf16 v[56:71], v[120:123], v[176:179], v[56:71]
    s_add_u32 s41, s53, 9216
    buffer_load_dwordx4 v[112:115], v5, s[8:11], s41 offen offset:2048
    v_mfma_f32_32x32x16_bf16 v[72:87], v[124:127], v[172:175], v[72:87]
    s_add_u32 s54, s50, 4
    s_and_b32 s54, s54, 7
    s_lshl_b32 s54, s54, 7
    s_add_u32 s54, s54, s45
    s_add_u32 s42, s54, 0
    s_add_u32 m0, s46, 0
    s_nop 0
    buffer_load_dwordx4 v6, s[4:7], s42 offen lds
    v_mfma_f32_32x32x16_bf16 v[88:103], v[124:127], v[176:179], v[88:103]
    s_add_u32 s42, s54, 32768
    s_add_u32 m0, s46, 1024
    s_nop 0
    buffer_load_dwordx4 v7, s[4:7], s42 offen lds
    s_waitcnt vmcnt(17)
    s_waitcnt lgkmcnt(0)
    v_mfma_f32_32x32x16_bf16 v[8:23], v[128:131], v[164:167], v[8:23]
    ds_read_b128 v[172:175], v181 offset:8192
    ds_read_b128 v[176:179], v181 offset:12288
    v_mfma_f32_32x32x16_bf16 v[24:39], v[128:131], v[168:171], v[24:39]
    s_add_u32 s52, s50, 4
    s_and_b32 s52, s52, 7
    s_mul_i32 s52, s52, 12288
    s_add_u32 s52, s52, s44
    buffer_load_dwordx4 v[116:119], v5, s[8:11], s52 offen offset:0
    v_mfma_f32_32x32x16_bf16 v[40:55], v[132:135], v[164:167], v[40:55]
    buffer_load_dwordx4 v[120:123], v5, s[8:11], s52 offen offset:1024
    v_mfma_f32_32x32x16_bf16 v[56:71], v[132:135], v[168:171], v[56:71]
    buffer_load_dwordx4 v[124:127], v5, s[8:11], s52 offen offset:2048
    v_mfma_f32_32x32x16_bf16 v[72:87], v[136:139], v[164:167], v[72:87]
    s_add_u32 s42, s54, 65536
    s_add_u32 m0, s46, 2048
    s_nop 0
    buffer_load_dwordx4 v6, s[4:7], s42 offen lds
    v_mfma_f32_32x32x16_bf16 v[88:103], v[136:139], v[168:171], v[88:103]
    s_add_u32 s42, s54, 98304
    s_add_u32 m0, s46, 3072
    s_nop 0
    buffer_load_dwordx4 v7, s[4:7], s42 offen lds
    s_add_u32 s42, s54, 131072
    s_add_u32 m0, s46, 4096
    s_nop 0
    buffer_load_dwordx4 v6, s[4:7], s42 offen lds
    s_waitcnt vmcnt(17)
    s_waitcnt lgkmcnt(0)
    v_mfma_f32_32x32x16_bf16 v[8:23], v[140:143], v[172:175], v[8:23]
    ds_read_b128 v[164:167], v182 offset:8192
    ds_read_b128 v[168:171], v182 offset:12288
    v_mfma_f32_32x32x16_bf16 v[24:39], v[140:143], v[176:179], v[24:39]
    s_add_u32 s41, s52, 3072
    buffer_load_dwordx4 v[128:131], v5, s[8:11], s41 offen offset:0
    v_mfma_f32_32x32x16_bf16 v[40:55], v[144:147], v[172:175], v[40:55]
    s_add_u32 s41, s52, 3072
    buffer_load_dwordx4 v[132:135], v5, s[8:11], s41 offen offset:1024
    v_mfma_f32_32x32x16_bf16 v[56:71], v[144:147], v[176:179], v[56:71]
    s_add_u32 s41, s52, 3072
    buffer_load_dwordx4 v[136:139], v5, s[8:11], s41 offen offset:2048
    v_mfma_f32_32x32x16_bf16 v[72:87], v[148:151], v[172:175], v[72:87]
    s_add_u32 s42, s54, 163840
    s_add_u32 m0, s46, 5120
    s_nop 0
    buffer_load_dwordx4 v7, s[4:7], s42 offen lds
    v_mfma_f32_32x32x16_bf16 v[88:103], v[148:151], v[176:179], v[88:103]
    s_add_u32 s42, s54, 196608
    s_add_u32 m0, s46, 6144
    s_nop 0
    buffer_load_dwordx4 v6, s[4:7], s42 offen lds
    s_add_u32 s42, s54, 229376
    s_add_u32 m0, s46, 7168
    s_nop 0
    buffer_load_dwordx4 v7, s[4:7], s42 offen lds
    s_waitcnt vmcnt(17)
    s_waitcnt lgkmcnt(0)
    v_mfma_f32_32x32x16_bf16 v[8:23], v[152:155], v[164:167], v[8:23]
    ds_read_b128 v[172:175], v183 offset:8192
    ds_read_b128 v[176:179], v183 offset:12288
    v_mfma_f32_32x32x16_bf16 v[24:39], v[152:155], v[168:171], v[24:39]
    s_add_u32 s41, s52, 6144
    buffer_load_dwordx4 v[140:143], v5, s[8:11], s41 offen offset:0
    v_mfma_f32_32x32x16_bf16 v[40:55], v[156:159], v[164:167], v[40:55]
    s_add_u32 s41, s52, 6144
    buffer_load_dwordx4 v[144:147], v5, s[8:11], s41 offen offset:1024
    v_mfma_f32_32x32x16_bf16 v[56:71], v[156:159], v[168:171], v[56:71]
    s_add_u32 s41, s52, 6144
    buffer_load_dwordx4 v[148:151], v5, s[8:11], s41 offen offset:2048
    v_mfma_f32_32x32x16_bf16 v[72:87], v[160:163], v[164:167], v[72:87]
    v_mfma_f32_32x32x16_bf16 v[88:103], v[160:163], v[168:171], v[88:103]
    s_waitcnt vmcnt(17)
    s_waitcnt lgkmcnt(0)
    v_mfma_f32_32x32x16_bf16 v[8:23], v[104:107], v[172:175], v[8:23]
    s_waitcnt vmcnt(3)
    ds_read_b128 v[164:167], v180 offset:0
    ds_read_b128 v[168:171], v180 offset:4096
    v_mfma_f32_32x32x16_bf16 v[24:39], v[104:107], v[176:179], v[24:39]
    s_add_u32 s41, s52, 9216
    buffer_load_dwordx4 v[152:155], v5, s[8:11], s41 offen offset:0
    v_mfma_f32_32x32x16_bf16 v[40:55], v[108:111], v[172:175], v[40:55]
    s_add_u32 s41, s52, 9216
    buffer_load_dwordx4 v[156:159], v5, s[8:11], s41 offen offset:1024
    v_mfma_f32_32x32x16_bf16 v[56:71], v[108:111], v[176:179], v[56:71]
    s_add_u32 s41, s52, 9216
    buffer_load_dwordx4 v[160:163], v5, s[8:11], s41 offen offset:2048
    v_mfma_f32_32x32x16_bf16 v[72:87], v[112:115], v[172:175], v[72:87]
    s_add_u32 s55, s50, 5
    s_and_b32 s55, s55, 7
    s_lshl_b32 s55, s55, 7
    s_add_u32 s55, s55, s45
    s_add_u32 s42, s55, 0
    s_add_u32 m0, s46, 8192
    s_nop 0
    buffer_load_dwordx4 v6, s[4:7], s42 offen lds
    v_mfma_f32_32x32x16_bf16 v[88:103], v[112:115], v[176:179], v[88:103]
    s_add_u32 s42, s55, 32768
    s_add_u32 m0, s46, 9216
    s_nop 0
    buffer_load_dwordx4 v7, s[4:7], s42 offen lds
    s_waitcnt vmcnt(17)
    s_waitcnt lgkmcnt(0)
    v_mfma_f32_32x32x16_bf16 v[8:23], v[116:119], v[164:167], v[8:23]
    ds_read_b128 v[172:175], v181 offset:0
    ds_read_b128 v[176:179], v181 offset:4096
    v_mfma_f32_32x32x16_bf16 v[24:39], v[116:119], v[168:171], v[24:39]
    s_add_u32 s53, s50, 5
    s_and_b32 s53, s53, 7
    s_mul_i32 s53, s53, 12288
    s_add_u32 s53, s53, s44
    buffer_load_dwordx4 v[104:107], v5, s[8:11], s53 offen offset:0
    v_mfma_f32_32x32x16_bf16 v[40:55], v[120:123], v[164:167], v[40:55]
    buffer_load_dwordx4 v[108:111], v5, s[8:11], s53 offen offset:1024
    v_mfma_f32_32x32x16_bf16 v[56:71], v[120:123], v[168:171], v[56:71]
    buffer_load_dwordx4 v[112:115], v5, s[8:11], s53 offen offset:2048
    v_mfma_f32_32x32x16_bf16 v[72:87], v[124:127], v[164:167], v[72:87]
    s_add_u32 s42, s55, 65536
    s_add_u32 m0, s46, 10240
    s_nop 0
    buffer_load_dwordx4 v6, s[4:7], s42 offen lds
    v_mfma_f32_32x32x16_bf16 v[88:103], v[124:127], v[168:171], v[88:103]
    s_add_u32 s42, s55, 98304
    s_add_u32 m0, s46, 11264
    s_nop 0
    buffer_load_dwordx4 v7, s[4:7], s42 offen lds
    s_add_u32 s42, s55, 131072
    s_add_u32 m0, s46, 12288
    s_nop 0
    buffer_load_dwordx4 v6, s[4:7], s42 offen lds
    s_waitcnt vmcnt(17)
    s_waitcnt lgkmcnt(0)
    v_mfma_f32_32x32x16_bf16 v[8:23], v[128:131], v[172:175], v[8:23]
    ds_read_b128 v[164:167], v182 offset:0
    ds_read_b128 v[168:171], v182 offset:4096
    v_mfma_f32_32x32x16_bf16 v[24:39], v[128:131], v[176:179], v[24:39]
    s_add_u32 s41, s53, 3072
    buffer_load_dwordx4 v[116:119], v5, s[8:11], s41 offen offset:0
    v_mfma_f32_32x32x16_bf16 v[40:55], v[132:135], v[172:175], v[40:55]
    s_add_u32 s41, s53, 3072
    buffer_load_dwordx4 v[120:123], v5, s[8:11], s41 offen offset:1024
    v_mfma_f32_32x32x16_bf16 v[56:71], v[132:135], v[176:179], v[56:71]
    s_add_u32 s41, s53, 3072
    buffer_load_dwordx4 v[124:127], v5, s[8:11], s41 offen offset:2048
    v_mfma_f32_32x32x16_bf16 v[72:87], v[136:139], v[172:175], v[72:87]
    s_add_u32 s42, s55, 163840
    s_add_u32 m0, s46, 13312
    s_nop 0
    buffer_load_dwordx4 v7, s[4:7], s42 offen lds
    v_mfma_f32_32x32x16_bf16 v[88:103], v[136:139], v[176:179], v[88:103]
    s_add_u32 s42, s55, 196608
    s_add_u32 m0, s46, 14336
    s_nop 0
    buffer_load_dwordx4 v6, s[4:7], s42 offen lds
    s_add_u32 s42, s55, 229376
    s_add_u32 m0, s46, 15360
    s_nop 0
    buffer_load_dwordx4 v7, s[4:7], s42 offen lds
    s_waitcnt vmcnt(17)
    s_waitcnt lgkmcnt(0)
    v_mfma_f32_32x32x16_bf16 v[8:23], v[140:143], v[164:167], v[8:23]
    ds_read_b128 v[172:175], v183 offset:0
    ds_read_b128 v[176:179], v183 offset:4096
    v_mfma_f32_32x32x16_bf16 v[24:39], v[140:143], v[168:171], v[24:39]
    s_add_u32 s41, s53, 6144
    buffer_load_dwordx4 v[128:131], v5, s[8:11], s41 offen offset:0
    v_mfma_f32_32x32x16_bf16 v[40:55], v[144:147], v[164:167], v[40:55]
    s_add_u32 s41, s53, 6144
    buffer_load_dwordx4 v[132:135], v5, s[8:11], s41 offen offset:1024
    v_mfma_f32_32x32x16_bf16 v[56:71], v[144:147], v[168:171], v[56:71]
    s_add_u32 s41, s53, 6144
    buffer_load_dwordx4 v[136:139], v5, s[8:11], s41 offen offset:2048
    v_mfma_f32_32x32x16_bf16 v[72:87], v[148:151], v[164:167], v[72:87]
    v_mfma_f32_32x32x16_bf16 v[88:103], v[148:151], v[168:171], v[88:103]
    s_waitcnt vmcnt(17)
    s_waitcnt lgkmcnt(0)
    v_mfma_f32_32x32x16_bf16 v[8:23], v[152:155], v[172:175], v[8:23]
    s_waitcnt vmcnt(3)
    ds_read_b128 v[164:167], v180 offset:8192
    ds_read_b128 v[168:171], v180 offset:12288
    v_mfma_f32_32x32x16_bf16 v[24:39], v[152:155], v[176:179], v[24:39]
    s_add_u32 s41, s53, 9216
    buffer_load_dwordx4 v[140:143], v5, s[8:11], s41 offen offset:0
    v_mfma_f32_32x32x16_bf16 v[40:55], v[156:159], v[172:175], v[40:55]
    s_add_u32 s41, s53, 9216
    buffer_load_dwordx4 v[144:147], v5, s[8:11], s41 offen offset:1024
    v_mfma_f32_32x32x16_bf16 v[56:71], v[156:159], v[176:179], v[56:71]
    s_add_u32 s41, s53, 9216
    buffer_load_dwordx4 v[148:151], v5, s[8:11], s41 offen offset:2048
    v_mfma_f32_32x32x16_bf16 v[72:87], v[160:163], v[172:175], v[72:87]
    s_add_u32 s54, s50, 6
    s_and_b32 s54, s54, 7
    s_lshl_b32 s54, s54, 7
    s_add_u32 s54, s54, s45
    s_add_u32 s42, s54, 0
    s_add_u32 m0, s46, 0
    s_nop 0
    buffer_load_dwordx4 v6, s[4:7], s42 offen lds
    v_mfma_f32_32x32x16_bf16 v[88:103], v[160:163], v[176:179], v[88:103]
    s_add_u32 s42, s54, 32768
    s_add_u32 m0, s46, 1024
    s_nop 0
    buffer_load_dwordx4 v7, s[4:7], s42 offen lds
    s_waitcnt vmcnt(17)
    s_waitcnt lgkmcnt(0)
    v_mfma_f32_32x32x16_bf16 v[8:23], v[104:107], v[164:167], v[8:23]
    ds_read_b128 v[172:175], v181 offset:8192
    ds_read_b128 v[176:179], v181 offset:12288
    v_mfma_f32_32x32x16_bf16 v[24:39], v[104:107], v[168:171], v[24:39]
    s_add_u32 s52, s50, 6
    s_and_b32 s52, s52, 7
    s_mul_i32 s52, s52, 12288
    s_add_u32 s52, s52, s44
    buffer_load_dwordx4 v[152:155], v5, s[8:11], s52 offen offset:0
    v_mfma_f32_32x32x16_bf16 v[40:55], v[108:111], v[164:167], v[40:55]
    buffer_load_dwordx4 v[156:159], v5, s[8:11], s52 offen offset:1024
    v_mfma_f32_32x32x16_bf16 v[56:71], v[108:111], v[168:171], v[56:71]
    buffer_load_dwordx4 v[160:163], v5, s[8:11], s52 offen offset:2048
    v_mfma_f32_32x32x16_bf16 v[72:87], v[112:115], v[164:167], v[72:87]
    s_add_u32 s42, s54, 65536
    s_add_u32 m0, s46, 2048
    s_nop 0
    buffer_load_dwordx4 v6, s[4:7], s42 offen lds
    v_mfma_f32_32x32x16_bf16 v[88:103], v[112:115], v[168:171], v[88:103]
    s_add_u32 s42, s54, 98304
    s_add_u32 m0, s46, 3072
    s_nop 0
    buffer_load_dwordx4 v7, s[4:7], s42 offen lds
    s_add_u32 s42, s54, 131072
    s_add_u32 m0, s46, 4096
    s_nop 0
    buffer_load_dwordx4 v6, s[4:7], s42 offen lds
    s_waitcnt vmcnt(17)
    s_waitcnt lgkmcnt(0)
    v_mfma_f32_32x32x16_bf16 v[8:23], v[116:119], v[172:175], v[8:23]
    ds_read_b128 v[164:167], v182 offset:8192
    ds_read_b128 v[168:171], v182 offset:12288
    v_mfma_f32_32x32x16_bf16 v[24:39], v[116:119], v[176:179], v[24:39]
    s_add_u32 s41, s52, 3072
    buffer_load_dwordx4 v[104:107], v5, s[8:11], s41 offen offset:0
    v_mfma_f32_32x32x16_bf16 v[40:55], v[120:123], v[172:175], v[40:55]
    s_add_u32 s41, s52, 3072
    buffer_load_dwordx4 v[108:111], v5, s[8:11], s41 offen offset:1024
    v_mfma_f32_32x32x16_bf16 v[56:71], v[120:123], v[176:179], v[56:71]
    s_add_u32 s41, s52, 3072
    buffer_load_dwordx4 v[112:115], v5, s[8:11], s41 offen offset:2048
    v_mfma_f32_32x32x16_bf16 v[72:87], v[124:127], v[172:175], v[72:87]
    s_add_u32 s42, s54, 163840
    s_add_u32 m0, s46, 5120
    s_nop 0
    buffer_load_dwordx4 v7, s[4:7], s42 offen lds
    v_mfma_f32_32x32x16_bf16 v[88:103], v[124:127], v[176:179], v[88:103]
    s_add_u32 s42, s54, 196608
    s_add_u32 m0, s46, 6144
    s_nop 0
    buffer_load_dwordx4 v6, s[4:7], s42 offen lds
    s_add_u32 s42, s54, 229376
    s_add_u32 m0, s46, 7168
    s_nop 0
    buffer_load_dwordx4 v7, s[4:7], s42 offen lds
    s_waitcnt vmcnt(17)
    s_waitcnt lgkmcnt(0)
    v_mfma_f32_32x32x16_bf16 v[8:23], v[128:131], v[164:167], v[8:23]
    ds_read_b128 v[172:175], v183 offset:8192
    ds_read_b128 v[176:179], v183 offset:12288
    v_mfma_f32_32x32x16_bf16 v[24:39], v[128:131], v[168:171], v[24:39]
    s_add_u32 s41, s52, 6144
    buffer_load_dwordx4 v[116:119], v5, s[8:11], s41 offen offset:0
    v_mfma_f32_32x32x16_bf16 v[40:55], v[132:135], v[164:167], v[40:55]
    s_add_u32 s41, s52, 6144
    buffer_load_dwordx4 v[120:123], v5, s[8:11], s41 offen offset:1024
    v_mfma_f32_32x32x16_bf16 v[56:71], v[132:135], v[168:171], v[56:71]
    s_add_u32 s41, s52, 6144
    buffer_load_dwordx4 v[124:127], v5, s[8:11], s41 offen offset:2048
    v_mfma_f32_32x32x16_bf16 v[72:87], v[136:139], v[164:167], v[72:87]
    v_mfma_f32_32x32x16_bf16 v[88:103], v[136:139], v[168:171], v[88:103]
    s_waitcnt vmcnt(17)
    s_waitcnt lgkmcnt(0)
    v_mfma_f32_32x32x16_bf16 v[8:23], v[140:143], v[172:175], v[8:23]
    s_waitcnt vmcnt(3)
    ds_read_b128 v[164:167], v180 offset:0
    ds_read_b128 v[168:171], v180 offset:4096
    v_mfma_f32_32x32x16_bf16 v[24:39], v[140:143], v[176:179], v[24:39]
    s_add_u32 s41, s52, 9216
    buffer_load_dwordx4 v[128:131], v5, s[8:11], s41 offen offset:0
    v_mfma_f32_32x32x16_bf16 v[40:55], v[144:147], v[172:175], v[40:55]
    s_add_u32 s41, s52, 9216
    buffer_load_dwordx4 v[132:135], v5, s[8:11], s41 offen offset:1024
    v_mfma_f32_32x32x16_bf16 v[56:71], v[144:147], v[176:179], v[56:71]
    s_add_u32 s41, s52, 9216
    buffer_load_dwordx4 v[136:139], v5, s[8:11], s41 offen offset:2048
    v_mfma_f32_32x32x16_bf16 v[72:87], v[148:151], v[172:175], v[72:87]
    s_add_u32 s55, s50, 7
    s_and_b32 s55, s55, 7
    s_lshl_b32 s55, s55, 7
    s_add_u32 s55, s55, s45
    s_add_u32 s42, s55, 0
    s_add_u32 m0, s46, 8192
    s_nop 0
    buffer_load_dwordx4 v6, s[4:7], s42 offen lds
    v_mfma_f32_32x32x16_bf16 v[88:103], v[148:151], v[176:179], v[88:103]
    s_add_u32 s42, s55, 32768
    s_add_u32 m0, s46, 9216
    s_nop 0
    buffer_load_dwordx4 v7, s[4:7], s42 offen lds
    s_waitcnt vmcnt(17)
    s_waitcnt lgkmcnt(0)
    v_mfma_f32_32x32x16_bf16 v[8:23], v[152:155], v[164:167], v[8:23]
    ds_read_b128 v[172:175], v181 offset:0
    ds_read_b128 v[176:179], v181 offset:4096
    v_mfma_f32_32x32x16_bf16 v[24:39], v[152:155], v[168:171], v[24:39]
    s_add_u32 s53, s50, 7
    s_and_b32 s53, s53, 7
    s_mul_i32 s53, s53, 12288
    s_add_u32 s53, s53, s44
    buffer_load_dwordx4 v[140:143], v5, s[8:11], s53 offen offset:0
    v_mfma_f32_32x32x16_bf16 v[40:55], v[156:159], v[164:167], v[40:55]
    buffer_load_dwordx4 v[144:147], v5, s[8:11], s53 offen offset:1024
    v_mfma_f32_32x32x16_bf16 v[56:71], v[156:159], v[168:171], v[56:71]
    buffer_load_dwordx4 v[148:151], v5, s[8:11], s53 offen offset:2048
    v_mfma_f32_32x32x16_bf16 v[72:87], v[160:163], v[164:167], v[72:87]
    s_add_u32 s42, s55, 65536
    s_add_u32 m0, s46, 10240
    s_nop 0
    buffer_load_dwordx4 v6, s[4:7], s42 offen lds
    v_mfma_f32_32x32x16_bf16 v[88:103], v[160:163], v[168:171], v[88:103]
    s_add_u32 s42, s55, 98304
    s_add_u32 m0, s46, 11264
    s_nop 0
    buffer_load_dwordx4 v7, s[4:7], s42 offen lds
    s_add_u32 s42, s55, 131072
    s_add_u32 m0, s46, 12288
    s_nop 0
    buffer_load_dwordx4 v6, s[4:7], s42 offen lds
    s_waitcnt vmcnt(17)
    s_waitcnt lgkmcnt(0)
    v_mfma_f32_32x32x16_bf16 v[8:23], v[104:107], v[172:175], v[8:23]
    ds_read_b128 v[164:167], v182 offset:0
    ds_read_b128 v[168:171], v182 offset:4096
    v_mfma_f32_32x32x16_bf16 v[24:39], v[104:107], v[176:179], v[24:39]
    s_add_u32 s41, s53, 3072
    buffer_load_dwordx4 v[152:155], v5, s[8:11], s41 offen offset:0
    v_mfma_f32_32x32x16_bf16 v[40:55], v[108:111], v[172:175], v[40:55]
    s_add_u32 s41, s53, 3072
    buffer_load_dwordx4 v[156:159], v5, s[8:11], s41 offen offset:1024
    v_mfma_f32_32x32x16_bf16 v[56:71], v[108:111], v[176:179], v[56:71]
    s_add_u32 s41, s53, 3072
    buffer_load_dwordx4 v[160:163], v5, s[8:11], s41 offen offset:2048
    v_mfma_f32_32x32x16_bf16 v[72:87], v[112:115], v[172:175], v[72:87]
    s_add_u32 s42, s55, 163840
    s_add_u32 m0, s46, 13312
    s_nop 0
    buffer_load_dwordx4 v7, s[4:7], s42 offen lds
    v_mfma_f32_32x32x16_bf16 v[88:103], v[112:115], v[176:179], v[88:103]
    s_add_u32 s42, s55, 196608
    s_add_u32 m0, s46, 14336
    s_nop 0
    buffer_load_dwordx4 v6, s[4:7], s42 offen lds
    s_add_u32 s42, s55, 229376
    s_add_u32 m0, s46, 15360
    s_nop 0
    buffer_load_dwordx4 v7, s[4:7], s42 offen lds
    s_waitcnt vmcnt(17)
    s_waitcnt lgkmcnt(0)
    v_mfma_f32_32x32x16_bf16 v[8:23], v[116:119], v[164:167], v[8:23]
    ds_read_b128 v[172:175], v183 offset:0
    ds_read_b128 v[176:179], v183 offset:4096
    v_mfma_f32_32x32x16_bf16 v[24:39], v[116:119], v[168:171], v[24:39]
    s_add_u32 s41, s53, 6144
    buffer_load_dwordx4 v[104:107], v5, s[8:11], s41 offen offset:0
    v_mfma_f32_32x32x16_bf16 v[40:55], v[120:123], v[164:167], v[40:55]
    s_add_u32 s41, s53, 6144
    buffer_load_dwordx4 v[108:111], v5, s[8:11], s41 offen offset:1024
    v_mfma_f32_32x32x16_bf16 v[56:71], v[120:123], v[168:171], v[56:71]
    s_add_u32 s41, s53, 6144
    buffer_load_dwordx4 v[112:115], v5, s[8:11], s41 offen offset:2048
    v_mfma_f32_32x32x16_bf16 v[72:87], v[124:127], v[164:167], v[72:87]
    v_mfma_f32_32x32x16_bf16 v[88:103], v[124:127], v[168:171], v[88:103]
    s_waitcnt vmcnt(17)
    s_waitcnt lgkmcnt(0)
    v_mfma_f32_32x32x16_bf16 v[8:23], v[128:131], v[172:175], v[8:23]
    s_waitcnt vmcnt(3)
    ds_read_b128 v[164:167], v180 offset:8192
    ds_read_b128 v[168:171], v180 offset:12288
    v_mfma_f32_32x32x16_bf16 v[24:39], v[128:131], v[176:179], v[24:39]
    s_add_u32 s41, s53, 9216
    buffer_load_dwordx4 v[116:119], v5, s[8:11], s41 offen offset:0
    v_mfma_f32_32x32x16_bf16 v[40:55], v[132:135], v[172:175], v[40:55]
    s_add_u32 s41, s53, 9216
    buffer_load_dwordx4 v[120:123], v5, s[8:11], s41 offen offset:1024
    v_mfma_f32_32x32x16_bf16 v[56:71], v[132:135], v[176:179], v[56:71]
    s_add_u32 s41, s53, 9216
    buffer_load_dwordx4 v[124:127], v5, s[8:11], s41 offen offset:2048
    v_mfma_f32_32x32x16_bf16 v[72:87], v[136:139], v[172:175], v[72:87]
    v_mfma_f32_32x32x16_bf16 v[88:103], v[136:139], v[176:179], v[88:103]
    s_waitcnt vmcnt(15)
    s_waitcnt lgkmcnt(0)
    v_mfma_f32_32x32x16_bf16 v[8:23], v[140:143], v[164:167], v[8:23]
    ds_read_b128 v[172:175], v181 offset:8192
    ds_read_b128 v[176:179], v181 offset:12288
    v_mfma_f32_32x32x16_bf16 v[24:39], v[140:143], v[168:171], v[24:39]
    v_mfma_f32_32x32x16_bf16 v[40:55], v[144:147], v[164:167], v[40:55]
    v_mfma_f32_32x32x16_bf16 v[56:71], v[144:147], v[168:171], v[56:71]
    v_mfma_f32_32x32x16_bf16 v[72:87], v[148:151], v[164:167], v[72:87]
    v_mfma_f32_32x32x16_bf16 v[88:103], v[148:151], v[168:171], v[88:103]
    s_waitcnt vmcnt(9)
    s_waitcnt lgkmcnt(0)
    v_mfma_f32_32x32x16_bf16 v[8:23], v[152:155], v[172:175], v[8:23]
    ds_read_b128 v[164:167], v182 offset:8192
    ds_read_b128 v[168:171], v182 offset:12288
    v_mfma_f32_32x32x16_bf16 v[24:39], v[152:155], v[176:179], v[24:39]
    v_mfma_f32_32x32x16_bf16 v[40:55], v[156:159], v[172:175], v[40:55]
    v_mfma_f32_32x32x16_bf16 v[56:71], v[156:159], v[176:179], v[56:71]
    v_mfma_f32_32x32x16_bf16 v[72:87], v[160:163], v[172:175], v[72:87]
    v_mfma_f32_32x32x16_bf16 v[88:103], v[160:163], v[176:179], v[88:103]
    s_waitcnt vmcnt(3)
    s_waitcnt lgkmcnt(0)
    v_mfma_f32_32x32x16_bf16 v[8:23], v[104:107], v[164:167], v[8:23]
    ds_read_b128 v[172:175], v183 offset:8192
    ds_read_b128 v[176:179], v183 offset:12288
    v_mfma_f32_32x32x16_bf16 v[24:39], v[104:107], v[168:171], v[24:39]
    s_lshl_b32 s40, s32, 3
    s_add_u32 s40, s40, s33
    s_lshl_b32 s40, s40, 2
    s_add_u32 s40, s40, s34
    s_mul_i32 s40, s40, 3072
    s_add_u32 s40, s40, 3145728
    buffer_load_dwordx4 v[184:187], v5, s[8:11], s40 offen offset:0
    v_mfma_f32_32x32x16_bf16 v[40:55], v[108:111], v[164:167], v[40:55]
    buffer_load_dwordx4 v[188:191], v5, s[8:11], s40 offen offset:1024
    v_mfma_f32_32x32x16_bf16 v[56:71], v[108:111], v[168:171], v[56:71]
    buffer_load_dwordx4 v[192:195], v5, s[8:11], s40 offen offset:2048
    v_mfma_f32_32x32x16_bf16 v[72:87], v[112:115], v[164:167], v[72:87]
    v_and_b32 v2, 31, v1
    v_lshlrev_b32 v2, 1, v2
    s_lshr_b32 s40, s34, 1
    s_lshl_b32 s40, s40, 6
    s_lshl_b32 s43, s32, 7
    s_add_u32 s40, s40, s43
    buffer_load_ushort v196, v2, s[12:15], s40 offen
    v_mfma_f32_32x32x16_bf16 v[88:103], v[112:115], v[168:171], v[88:103]
    s_waitcnt vmcnt(4)
    s_waitcnt lgkmcnt(0)
    v_mfma_f32_32x32x16_bf16 v[8:23], v[116:119], v[172:175], v[8:23]
    v_mfma_f32_32x32x16_bf16 v[24:39], v[116:119], v[176:179], v[24:39]
    v_mfma_f32_32x32x16_bf16 v[40:55], v[120:123], v[172:175], v[40:55]
    v_mfma_f32_32x32x16_bf16 v[56:71], v[120:123], v[176:179], v[56:71]
    v_mfma_f32_32x32x16_bf16 v[72:87], v[124:127], v[172:175], v[72:87]
    v_mfma_f32_32x32x16_bf16 v[88:103], v[124:127], v[176:179], v[88:103]
    s_setprio 0
    v_add_u32 v4, 0x10000, v5
    s_nop 15
    s_barrier
    s_cmp_lg_u32 s34, 0
    s_cbranch_scc1 g_epi_2
    ds_write_b128 v5, v[12:15] offset:30720
    ds_write_b128 v5, v[20:23] offset:31744
    ds_write_b128 v5, v[44:47] offset:32768
    ds_write_b128 v5, v[52:55] offset:33792
    ds_write_b128 v5, v[76:79] offset:34816
    ds_write_b128 v5, v[84:87] offset:35840
    ds_write_b128 v5, v[24:27] offset:43008
    ds_write_b128 v5, v[32:35] offset:44032
    ds_write_b128 v5, v[56:59] offset:45056
    ds_write_b128 v5, v[64:67] offset:46080
    ds_write_b128 v5, v[88:91] offset:47104
    ds_write_b128 v5, v[96:99] offset:48128
    ds_write_b128 v5, v[28:31] offset:55296
    ds_write_b128 v5, v[36:39] offset:56320
    ds_write_b128 v5, v[60:63] offset:57344
    ds_write_b128 v5, v[68:71] offset:58368
    ds_write_b128 v5, v[92:95] offset:59392
    ds_write_b128 v5, v[100:103] offset:60416
    v_pk_add_f32 v[104:105], v[8:9], 0
    v_pk_add_f32 v[106:107], v[10:11], 0
    v_pk_add_f32 v[108:109], v[16:17], 0
    v_pk_add_f32 v[110:111], v[18:19], 0
    v_pk_add_f32 v[112:113], v[40:41], 0
    v_pk_add_f32 v[114:115], v[42:43], 0
    v_pk_add_f32 v[116:117], v[48:49], 0
    v_pk_add_f32 v[118:119], v[50:51], 0
    v_pk_add_f32 v[120:121], v[72:73], 0
    v_pk_add_f32 v[122:123], v[74:75], 0
    v_pk_add_f32 v[124:125], v[80:81], 0
    v_pk_add_f32 v[126:127], v[82:83], 0
    s_branch g_epi_end_1
g_epi_2:
    s_cmp_lg_u32 s34, 1
    s_cbranch_scc1 g_epi_3
    ds_write_b128 v5, v[8:11] offset:0
    ds_write_b128 v5, v[16:19] offset:1024
    ds_write_b128 v5, v[40:43] offset:2048
    ds_write_b128 v5, v[48:51] offset:3072
    ds_write_b128 v5, v[72:75] offset:4096
    ds_write_b128 v5, v[80:83] offset:5120
    ds_write_b128 v5, v[24:27] offset:49152
    ds_write_b128 v5, v[32:35] offset:50176
    ds_write_b128 v5, v[56:59] offset:51200
    ds_write_b128 v5, v[64:67] offset:52224
    ds_write_b128 v5, v[88:91] offset:53248
    ds_write_b128 v5, v[96:99] offset:54272
    ds_write_b128 v5, v[28:31] offset:61440
    ds_write_b128 v5, v[36:39] offset:62464
    ds_write_b128 v5, v[60:63] offset:63488
    ds_write_b128 v5, v[68:71] offset:64512
    ds_write_b128 v4, v[92:95] offset:0
    ds_write_b128 v4, v[100:103] offset:1024
    v_pk_add_f32 v[104:105], v[12:13], 0
    v_pk_add_f32 v[106:107], v[14:15], 0
    v_pk_add_f32 v[108:109], v[20:21], 0
    v_pk_add_f32 v[110:111], v[22:23], 0
    v_pk_add_f32 v[112:113], v[44:45], 0
    v_pk_add_f32 v[114:115], v[46:47], 0
    v_pk_add_f32 v[116:117], v[52:53], 0
    v_pk_add_f32 v[118:119], v[54:55], 0
    v_pk_add_f32 v[120:121], v[76:77], 0
    v_pk_add_f32 v[122:123], v[78:79], 0
    v_pk_add_f32 v[124:125], v[84:85], 0
    v_pk_add_f32 v[126:127], v[86:87], 0
    s_branch g_epi_end_1
g_epi_3:
    s_cmp_lg_u32 s34, 2
    s_cbranch_scc1 g_epi_4
    ds_write_b128 v5, v[8:11] offset:6144
    ds_write_b128 v5, v[16:19] offset:7168
    ds_write_b128 v5, v[40:43] offset:8192
    ds_write_b128 v5, v[48:51] offset:9216
    ds_write_b128 v5, v[72:75] offset:10240
    ds_write_b128 v5, v[80:83] offset:11264
    ds_write_b128 v5, v[12:15] offset:18432
    ds_write_b128 v5, v[20:23] offset:19456
    ds_write_b128 v5, v[44:47] offset:20480
    ds_write_b128 v5, v[52:55] offset:21504
    ds_write_b128 v5, v[76:79] offset:22528
    ds_write_b128 v5, v[84:87] offset:23552
    ds_write_b128 v4, v[28:31] offset:2048
    ds_write_b128 v4, v[36:39] offset:3072
    ds_write_b128 v4, v[60:63] offset:4096
    ds_write_b128 v4, v[68:71] offset:5120
    ds_write_b128 v4, v[92:95] offset:6144
    ds_write_b128 v4, v[100:103] offset:7168
    v_pk_add_f32 v[104:105], v[24:25], 0
    v_pk_add_f32 v[106:107], v[26:27], 0
    v_pk_add_f32 v[108:109], v[32:33], 0
    v_pk_add_f32 v[110:111], v[34:35], 0
    v_pk_add_f32 v[112:113], v[56:57], 0
    v_pk_add_f32 v[114:115], v[58:59], 0
    v_pk_add_f32 v[116:117], v[64:65], 0
    v_pk_add_f32 v[118:119], v[66:67], 0
    v_pk_add_f32 v[120:121], v[88:89], 0
    v_pk_add_f32 v[122:123], v[90:91], 0
    v_pk_add_f32 v[124:125], v[96:97], 0
    v_pk_add_f32 v[126:127], v[98:99], 0
    s_branch g_epi_end_1
g_epi_4:
    ds_write_b128 v5, v[8:11] offset:12288
    ds_write_b128 v5, v[16:19] offset:13312
    ds_write_b128 v5, v[40:43] offset:14336
    ds_write_b128 v5, v[48:51] offset:15360
    ds_write_b128 v5, v[72:75] offset:16384
    ds_write_b128 v5, v[80:83] offset:17408
    ds_write_b128 v5, v[12:15] offset:24576
    ds_write_b128 v5, v[20:23] offset:25600
    ds_write_b128 v5, v[44:47] offset:26624
    ds_write_b128 v5, v[52:55] offset:27648
    ds_write_b128 v5, v[76:79] offset:28672
    ds_write_b128 v5, v[84:87] offset:29696
    ds_write_b128 v5, v[24:27] offset:36864
    ds_write_b128 v5, v[32:35] offset:37888
    ds_write_b128 v5, v[56:59] offset:38912
    ds_write_b128 v5, v[64:67] offset:39936
    ds_write_b128 v5, v[88:91] offset:40960
    ds_write_b128 v5, v[96:99] offset:41984
    v_pk_add_f32 v[104:105], v[28:29], 0
    v_pk_add_f32 v[106:107], v[30:31], 0
    v_pk_add_f32 v[108:109], v[36:37], 0
    v_pk_add_f32 v[110:111], v[38:39], 0
    v_pk_add_f32 v[112:113], v[60:61], 0
    v_pk_add_f32 v[114:115], v[62:63], 0
    v_pk_add_f32 v[116:117], v[68:69], 0
    v_pk_add_f32 v[118:119], v[70:71], 0
    v_pk_add_f32 v[120:121], v[92:93], 0
    v_pk_add_f32 v[122:123], v[94:95], 0
    v_pk_add_f32 v[124:125], v[100:101], 0
    v_pk_add_f32 v[126:127], v[102:103], 0
g_epi_end_1:
    s_waitcnt lgkmcnt(0)
    s_barrier
    s_mul_i32 s40, s34, 18432
    v_add_u32 v2, s40, v5
    ds_read_b128 v[8:11], v2 offset:0
    ds_read_b128 v[12:15], v2 offset:1024
    ds_read_b128 v[16:19], v2 offset:2048
    ds_read_b128 v[20:23], v2 offset:3072
    ds_read_b128 v[24:27], v2 offset:4096
    ds_read_b128 v[28:31], v2 offset:5120
    ds_read_b128 v[32:35], v2 offset:6144
    ds_read_b128 v[36:39], v2 offset:7168
    ds_read_b128 v[40:43], v2 offset:8192
    ds_read_b128 v[44:47], v2 offset:9216
    ds_read_b128 v[48:51], v2 offset:10240
    ds_read_b128 v[52:55], v2 offset:11264
    ds_read_b128 v[56:59], v2 offset:12288
    ds_read_b128 v[60:63], v2 offset:13312
    ds_read_b128 v[64:67], v2 offset:14336
    ds_read_b128 v[68:71], v2 offset:15360
    ds_read_b128 v[72:75], v2 offset:16384
    ds_read_b128 v[76:79], v2 offset:17408
    v_lshrrev_b32 v6, 4, v1
    v_and_b32 v6, 1, v6
    v_mul_u32_u24 v6, 24576, v6
    v_and_b32 v3, 15, v1
    v_lshrrev_b32 v4, 5, v1
    v_lshl_add_u32 v3, v4, 4, v3
    v_lshl_add_u32 v6, v3, 4, v6
    s_mul_i32 s40, s32, 98304
    s_lshr_b32 s41, s34, 1
    s_mul_i32 s41, s41, 49152
    s_add_u32 s40, s40, s41
    s_mul_i32 s41, s33, 3072
    s_add_u32 s40, s40, s41
    s_and_b32 s41, s34, 1
    s_lshl_b32 s41, s41, 9
    s_add_u32 s40, s40, s41
    s_add_u32 s40, s40, 11534336
    s_waitcnt vmcnt(0)
    v_lshlrev_b32 v180, 16, v196
    v_lshlrev_b32 v80, 16, v184
    v_and_b32 v81, 0xffff0000, v184
    v_lshlrev_b32 v82, 16, v185
    v_and_b32 v83, 0xffff0000, v185
    v_lshlrev_b32 v84, 16, v186
    v_and_b32 v85, 0xffff0000, v186
    v_lshlrev_b32 v86, 16, v187
    v_and_b32 v87, 0xffff0000, v187
    v_lshlrev_b32 v88, 16, v188
    v_and_b32 v89, 0xffff0000, v188
    v_lshlrev_b32 v90, 16, v189
    v_and_b32 v91, 0xffff0000, v189
    v_lshlrev_b32 v92, 16, v190
    v_and_b32 v93, 0xffff0000, v190
    v_lshlrev_b32 v94, 16, v191
    v_and_b32 v95, 0xffff0000, v191
    v_lshlrev_b32 v96, 16, v192
    v_and_b32 v97, 0xffff0000, v192
    v_lshlrev_b32 v98, 16, v193
    v_and_b32 v99, 0xffff0000, v193
    v_lshlrev_b32 v100, 16, v194
    v_and_b32 v101, 0xffff0000, v194
    v_lshlrev_b32 v102, 16, v195
    v_and_b32 v103, 0xffff0000, v195
    s_waitcnt lgkmcnt(12)
    v_pk_add_f32 v[104:105], v[104:105], v[8:9]
    v_pk_add_f32 v[106:107], v[106:107], v[10:11]
    v_pk_add_f32 v[108:109], v[108:109], v[12:13]
    v_pk_add_f32 v[110:111], v[110:111], v[14:15]
    v_pk_add_f32 v[112:113], v[112:113], v[16:17]
    v_pk_add_f32 v[114:115], v[114:115], v[18:19]
    v_pk_add_f32 v[116:117], v[116:117], v[20:21]
    v_pk_add_f32 v[118:119], v[118:119], v[22:23]
    v_pk_add_f32 v[120:121], v[120:121], v[24:25]
    v_pk_add_f32 v[122:123], v[122:123], v[26:27]
    v_pk_add_f32 v[124:125], v[124:125], v[28:29]
    v_pk_add_f32 v[126:127], v[126:127], v[30:31]
    s_waitcnt lgkmcnt(6)
    v_pk_add_f32 v[104:105], v[104:105], v[32:33]
    v_pk_add_f32 v[106:107], v[106:107], v[34:35]
    v_pk_add_f32 v[108:109], v[108:109], v[36:37]
    v_pk_add_f32 v[110:111], v[110:111], v[38:39]
    v_pk_add_f32 v[112:113], v[112:113], v[40:41]
    v_pk_add_f32 v[114:115], v[114:115], v[42:43]
    v_pk_add_f32 v[116:117], v[116:117], v[44:45]
    v_pk_add_f32 v[118:119], v[118:119], v[46:47]
    v_pk_add_f32 v[120:121], v[120:121], v[48:49]
    v_pk_add_f32 v[122:123], v[122:123], v[50:51]
    v_pk_add_f32 v[124:125], v[124:125], v[52:53]
    v_pk_add_f32 v[126:127], v[126:127], v[54:55]
    s_waitcnt lgkmcnt(0)
    v_pk_add_f32 v[104:105], v[104:105], v[56:57]
    v_pk_add_f32 v[106:107], v[106:107], v[58:59]
    v_pk_add_f32 v[108:109], v[108:109], v[60:61]
    v_pk_add_f32 v[110:111], v[110:111], v[62:63]
    v_pk_add_f32 v[112:113], v[112:113], v[64:65]
    v_pk_add_f32 v[114:115], v[114:115], v[66:67]
    v_pk_add_f32 v[116:117], v[116:117], v[68:69]
    v_pk_add_f32 v[118:119], v[118:119], v[70:71]
    v_pk_add_f32 v[120:121], v[120:121], v[72:73]
    v_pk_add_f32 v[122:123], v[122:123], v[74:75]
    v_pk_add_f32 v[124:125], v[124:125], v[76:77]
    v_pk_add_f32 v[126:127], v[126:127], v[78:79]
    v_pk_add_f32 v[104:105], v[104:105], v[180:181] op_sel_hi:[1,0]
    v_pk_add_f32 v[106:107], v[106:107], v[180:181] op_sel_hi:[1,0]
    v_pk_add_f32 v[108:109], v[108:109], v[180:181] op_sel_hi:[1,0]
    v_pk_add_f32 v[110:111], v[110:111], v[180:181] op_sel_hi:[1,0]
    v_pk_add_f32 v[112:113], v[112:113], v[180:181] op_sel_hi:[1,0]
    v_pk_add_f32 v[114:115], v[114:115], v[180:181] op_sel_hi:[1,0]
    v_pk_add_f32 v[116:117], v[116:117], v[180:181] op_sel_hi:[1,0]
    v_pk_add_f32 v[118:119], v[118:119], v[180:181] op_sel_hi:[1,0]
    v_pk_add_f32 v[120:121], v[120:121], v[180:181] op_sel_hi:[1,0]
    v_pk_add_f32 v[122:123], v[122:123], v[180:181] op_sel_hi:[1,0]
    v_pk_add_f32 v[124:125], v[124:125], v[180:181] op_sel_hi:[1,0]
    v_pk_add_f32 v[126:127], v[126:127], v[180:181] op_sel_hi:[1,0]
    v_pk_mul_f32 v[104:105], v[104:105], v[80:81]
    v_pk_mul_f32 v[106:107], v[106:107], v[82:83]
    v_pk_mul_f32 v[108:109], v[108:109], v[84:85]
    v_pk_mul_f32 v[110:111], v[110:111], v[86:87]
    v_pk_mul_f32 v[112:113], v[112:113], v[88:89]
    v_pk_mul_f32 v[114:115], v[114:115], v[90:91]
    v_pk_mul_f32 v[116:117], v[116:117], v[92:93]
    v_pk_mul_f32 v[118:119], v[118:119], v[94:95]
    v_pk_mul_f32 v[120:121], v[120:121], v[96:97]
    v_pk_mul_f32 v[122:123], v[122:123], v[98:99]
    v_pk_mul_f32 v[124:125], v[124:125], v[100:101]
    v_pk_mul_f32 v[126:127], v[126:127], v[102:103]
    v_cvt_pk_bf16_f32 v8, v104, v105
    v_cvt_pk_bf16_f32 v9, v106, v107
    v_cvt_pk_bf16_f32 v10, v108, v109
    v_cvt_pk_bf16_f32 v11, v110, v111
    buffer_store_dwordx4 v[8:11], v6, s[8:11], s40 offen offset:0
    v_cvt_pk_bf16_f32 v12, v112, v113
    v_cvt_pk_bf16_f32 v13, v114, v115
    v_cvt_pk_bf16_f32 v14, v116, v117
    v_cvt_pk_bf16_f32 v15, v118, v119
    buffer_store_dwordx4 v[12:15], v6, s[8:11], s40 offen offset:1024
    v_cvt_pk_bf16_f32 v16, v120, v121
    v_cvt_pk_bf16_f32 v17, v122, v123
    v_cvt_pk_bf16_f32 v18, v124, v125
    v_cvt_pk_bf16_f32 v19, v126, v127
    buffer_store_dwordx4 v[16:19], v6, s[8:11], s40 offen offset:2048
    s_endpgm
k2_kernel_conv:
    s_load_dwordx2 s[4:5], s[0:1], 32
    s_load_dwordx2 s[8:9], s[0:1], 104
    s_load_dwordx2 s[12:13], s[0:1], 40
    s_load_dwordx2 s[16:17], s[0:1], 64
    s_load_dwordx2 s[20:21], s[0:1], 80
    v_lshrrev_b32 v3, 6, v0
    v_and_b32 v1, 63, v0
    v_readfirstlane_b32 s34, v3
    s_mov_b32 s6, 2621440
    s_mov_b32 s7, 0x20000
    s_mov_b32 s10, 15990784
    s_mov_b32 s11, 0x20000
    s_mov_b32 s14, 1280
    s_mov_b32 s15, 0x20000
    s_mov_b32 s18, 8388608
    s_mov_b32 s19, 0x20000
    s_mov_b32 s22, 983040
    s_mov_b32 s23, 0x20000
    s_mov_b32 s32, s2
    v_lshlrev_b32 v2, 4, v0
    v_subrev_u32 v47, 16, v2
    s_mov_b32 s56, s2
    s_add_u32 s57, s2, 256
    s_lshr_b32 s58, s2, 1
    s_add_u32 s58, s58, 512
    s_waitcnt lgkmcnt(0)
    s_lshl_b32 s40, s56, 12
    buffer_load_dwordx4 v[12:15], v2, s[4:7], s40 offen
    buffer_load_dwordx4 v[8:11], v47, s[4:7], s40 offen
    s_add_u32 s40, s40, 6291456
    buffer_load_dwordx4 v[32:35], v2, s[8:11], s40 offen
    s_lshl_b32 s40, s56, 1
    v_mov_b32 v3, 0
    buffer_load_ushort v44, v3, s[12:15], s40 offen
    s_lshr_b32 s47, s2, 3
    s_lshl_b32 s47, s47, 2
    s_add_u32 s47, s47, s34
    s_mul_i32 s40, s47, 12
    v_add_u32 v3, s40, v1
    v_mul_u32_u24 v4, 43691, v3
    v_lshrrev_b32 v4, 22, v4
    v_mul_u32_u24 v5, 96, v4
    v_sub_u32 v3, v3, v5
    v_mul_u32_u24 v4, 98304, v4
    v_lshl_add_u32 v49, v3, 7, v4
    s_and_b32 s40, s2, 7
    s_lshr_b32 s52, s40, 1
    s_lshl_b32 s52, s52, 21
    s_and_b32 s53, s40, 1
    s_mul_i32 s53, s53, 1572864
    s_add_u32 s53, s53, 0
    s_lshl_b32 s40, s47, 4
    v_add_u32 v3, s40, v1
    v_lshrrev_b32 v4, 2, v3
    v_lshlrev_b32 v4, 12, v4
    v_and_b32 v3, 3, v3
    v_lshl_add_u32 v48, v3, 10, v4
    s_add_u32 s40, s53, 0
    s_mov_b64 exec, 0xfff
    buffer_load_dword v50, v49, s[8:11], s40 offen
    s_add_u32 s40, s52, 0
    s_mov_b64 exec, 0xffff
    buffer_load_dword v50, v48, s[16:19], s40 offen
    s_mov_b64 exec, -1
    s_add_u32 s40, s53, 12288
    s_mov_b64 exec, 0xfff
    buffer_load_dword v50, v49, s[8:11], s40 offen
    s_add_u32 s40, s52, 128
    s_mov_b64 exec, 0xffff
    buffer_load_dword v50, v48, s[16:19], s40 offen
    s_mov_b64 exec, -1
    s_cmp_ge_u32 s2, 192
    s_cbranch_scc1 c_wj_6
    s_mul_i32 s40, s2, 2731
    s_lshr_b32 s40, s40, 16
    s_mul_i32 s41, s40, 24
    s_sub_u32 s41, s2, s41
    s_mul_i32 s41, s41, 40960
    s_mul_i32 s40, s40, 160
    s_add_u32 s54, s40, s41
    v_mov_b32 v3, v0
    v_mul_u32_u24 v4, 6554, v3
    v_lshrrev_b32 v4, 16, v4
    v_mul_u32_u24 v5, 10, v4
    v_sub_u32 v3, v3, v5
    v_lshlrev_b32 v3, 4, v3
    v_mul_u32_u24 v4, 1280, v4
    v_add_u32 v3, v3, v4
    s_lshl_b32 s40, s34, 10
    s_add_u32 m0, s40, 73216
    s_nop 0
    buffer_load_dwordx4 v3, s[20:23], s54 offen lds
    s_cmp_lg_u32 s34, 0
    s_cbranch_scc1 c_wj2_7
    v_add_u32 v3, 256, v1
    v_mul_u32_u24 v4, 6554, v3
    v_lshrrev_b32 v4, 16, v4
    v_mul_u32_u24 v5, 10, v4
    v_sub_u32 v3, v3, v5
    v_lshlrev_b32 v3, 4, v3
    v_mul_u32_u24 v4, 1280, v4
    v_add_u32 v3, v3, v4
    s_mov_b32 m0, 77312
    s_nop 0
    buffer_load_dwordx4 v3, s[20:23], s54 offen lds
c_wj2_7:
c_wj_6:
    s_lshl_b32 s40, s57, 12
    buffer_load_dwordx4 v[20:23], v2, s[4:7], s40 offen
    buffer_load_dwordx4 v[16:19], v47, s[4:7], s40 offen
    s_add_u32 s40, s40, 6291456
    buffer_load_dwordx4 v[36:39], v2, s[8:11], s40 offen
    s_lshl_b32 s40, s57, 1
    v_mov_b32 v3, 0
    buffer_load_ushort v45, v3, s[12:15], s40 offen
    s_lshl_b32 s40, s58, 12
    buffer_load_dwordx4 v[28:31], v2, s[4:7], s40 offen
    buffer_load_dwordx4 v[24:27], v47, s[4:7], s40 offen
    s_add_u32 s40, s40, 6291456
    buffer_load_dwordx4 v[40:43], v2, s[8:11], s40 offen
    s_lshl_b32 s40, s58, 1
    v_mov_b32 v3, 0
    buffer_load_ushort v46, v3, s[12:15], s40 offen
    v_mov_b32 v52, 0
    v_mov_b32 v53, 0
    v_mov_b32 v54, 0
    v_mov_b32 v55, 0
    v_lshrrev_b32 v3, 2, v0
    v_mul_u32_u24 v3, 4160, v3
    v_and_b32 v4, 3, v0
    v_lshl_add_u32 v3, v4, 4, v3
    v_cmp_gt_u32 vcc, 160, v0
    s_nop 0
    s_and_saveexec_b64 s[50:51], vcc
    s_cbranch_execz c_z_8
    ds_write_b128 v2, v[52:55] offset:33280
    v_cmp_gt_u32 vcc, 32, v0
    s_nop 0
    s_and_b64 exec, exec, vcc
    s_cbranch_execz c_z2_9
    ds_write_b128 v3, v[52:55] offset:0
c_z2_9:
c_z_8:
    s_mov_b64 exec, s[50:51]
    v_add_u32 v56, 48, v2
    v_lshrrev_b32 v3, 2, v0
    v_lshl_add_u32 v57, v3, 4, v2
    v_add_u32 v57, 35840, v57
    v_and_b32 v3, 7, v1
    v_mul_u32_u24 v3, 4160, v3
    v_and_b32 v4, 31, v1
    v_lshrrev_b32 v4, 3, v4
    v_lshrrev_b32 v5, 5, v1
    v_sub_u32 v4, v4, v5
    v_lshl_add_u32 v3, v4, 4, v3
    v_add_u32 v58, 16, v3
    v_and_b32 v3, 31, v1
    v_mul_u32_u24 v3, 80, v3
    v_lshl_add_u32 v59, v5, 4, v3
    v_add_u32 v59, 33280, v59
    v_and_b32 v3, 31, v1
    v_lshlrev_b32 v4, 3, v5
    v_add_u32 v4, 7, v4
    v_sub_u32 v4, v4, v3
    v_mov_b32 v68, 0xffff
    v_mov_b32 v69, 0xffff0000
    v_cmp_eq_u32 vcc, 0, v4
    s_nop 1
    v_cndmask_b32 v60, 0, v68, vcc
    v_cmp_eq_u32 vcc, 1, v4
    s_nop 1
    v_cndmask_b32 v60, v60, v69, vcc
    v_cmp_eq_u32 vcc, 2, v4
    s_nop 1
    v_cndmask_b32 v61, 0, v68, vcc
    v_cmp_eq_u32 vcc, 3, v4
    s_nop 1
    v_cndmask_b32 v61, v61, v69, vcc
    v_cmp_eq_u32 vcc, 4, v4
    s_nop 1
    v_cndmask_b32 v62, 0, v68, vcc
    v_cmp_eq_u32 vcc, 5, v4
    s_nop 1
    v_cndmask_b32 v62, v62, v69, vcc
    v_cmp_eq_u32 vcc, 6, v4
    s_nop 1
    v_cndmask_b32 v63, 0, v68, vcc
    v_cmp_eq_u32 vcc, 7, v4
    s_nop 1
    v_cndmask_b32 v63, v63, v69, vcc
    v_cmp_eq_u32 vcc, -16, v4
    s_nop 1
    v_cndmask_b32 v64, 0, v68, vcc
    v_cmp_eq_u32 vcc, -15, v4
    s_nop 1
    v_cndmask_b32 v64, v64, v69, vcc
    v_cmp_eq_u32 vcc, -14, v4
    s_nop 1
    v_cndmask_b32 v65, 0, v68, vcc
    v_cmp_eq_u32 vcc, -13, v4
    s_nop 1
    v_cndmask_b32 v65, v65, v69, vcc
    v_cmp_eq_u32 vcc, -12, v4
    s_nop 1
    v_cndmask_b32 v66, 0, v68, vcc
    v_cmp_eq_u32 vcc, -11, v4
    s_nop 1
    v_cndmask_b32 v66, v66, v69, vcc
    v_cmp_eq_u32 vcc, -10, v4
    s_nop 1
    v_cndmask_b32 v67, 0, v68, vcc
    v_cmp_eq_u32 vcc, -9, v4
    s_nop 1
    v_cndmask_b32 v67, v67, v69, vcc
    v_and_b32 v3, 31, v1
    v_mul_u32_u24 v3, 144, v3
    v_lshl_add_u32 v70, v5, 4, v3
    v_add_u32 v70, 40960, v70
    v_and_b32 v3, 127, v0
    v_lshrrev_b32 v3, 2, v3
    v_mul_u32_u24 v3, 144, v3
    v_and_b32 v4, 3, v0
    v_lshl_add_u32 v71, v4, 5, v3
    v_add_u32 v71, 40960, v71
    s_waitcnt vmcnt(12)
    v_cmp_ne_u32 vcc, 0, v0
    s_nop 1
    v_cndmask_b32 v8, 0, v8, vcc
    v_cndmask_b32 v9, 0, v9, vcc
    v_cndmask_b32 v10, 0, v10, vcc
    v_cndmask_b32 v11, 0, v11, vcc
    v_alignbit_b32 v176, v9, v8, 16
    v_alignbit_b32 v177, v10, v9, 16
    v_alignbit_b32 v178, v11, v10, 16
    v_alignbit_b32 v179, v12, v11, 16
    v_alignbit_b32 v180, v13, v12, 16
    v_alignbit_b32 v181, v14, v13, 16
    v_alignbit_b32 v182, v15, v14, 16
    ds_write_b128 v56, v[176:179] offset:0
    v_mov_b32 v184, v9
    v_mov_b32 v185, v10
    v_mov_b32 v186, v11
    v_mov_b32 v187, v12
    ds_write_b128 v56, v[184:187] offset:4160
    s_nop 1
    v_mov_b32 v184, v177
    v_mov_b32 v185, v178
    v_mov_b32 v186, v179
    v_mov_b32 v187, v180
    ds_write_b128 v56, v[184:187] offset:8320
    s_nop 1
    ds_write_b128 v56, v[10:13] offset:12480
    ds_write_b128 v56, v[178:181] offset:16640
    v_mov_b32 v184, v11
    v_mov_b32 v185, v12
    v_mov_b32 v186, v13
    v_mov_b32 v187, v14
    ds_write_b128 v56, v[184:187] offset:20800
    s_nop 1
    v_mov_b32 v184, v179
    v_mov_b32 v185, v180
    v_mov_b32 v186, v181
    v_mov_b32 v187, v182
    ds_write_b128 v56, v[184:187] offset:24960
    s_nop 1
    ds_write_b128 v56, v[12:15] offset:29120
    ds_write_b128 v57, v[32:35]
    v_lshlrev_b32 v3, 16, v44
    v_or_b32 v3, v3, v44
    v_and_b32 v188, v60, v3
    v_and_b32 v189, v61, v3
    v_and_b32 v190, v62, v3
    v_and_b32 v191, v63, v3
    v_and_b32 v192, v64, v3
    v_and_b32 v193, v65, v3
    v_and_b32 v194, v66, v3
    v_and_b32 v195, v67, v3
    s_waitcnt vmcnt(4)
    s_waitcnt lgkmcnt(0)
    s_barrier
    s_cmp_ge_u32 s2, 192
    s_cbranch_scc1 c_wj3_10
    v_lshrrev_b32 v3, 4, v1
    v_and_b32 v5, 15, v1
    v_lshrrev_b32 v4, 2, v5
    v_lshl_add_u32 v3, v3, 2, v4
    v_mul_u32_u24 v3, 160, v3
    v_and_b32 v4, 3, v5
    v_lshl_add_u32 v3, v4, 3, v3
    v_lshlrev_b32 v5, 4, v1
    s_lshl_b32 s40, s34, 5
    s_add_u32 s41, s40, 73216
    v_add_u32 v4, s41, v3
    ds_read_b64_tr_b16 v[184:185], v4
    ds_read_b64_tr_b16 v[186:187], v4 offset:2560
    s_mul_i32 s41, s2, 5120
    s_lshl_b32 s40, s40, 5
    s_add_u32 s41, s41, s40
    s_add_u32 s41, s41, 15007744
    s_waitcnt lgkmcnt(0)
    buffer_store_dwordx4 v[184:187], v5, s[8:11], s41 offen
    s_nop 1
    s_cmp_lg_u32 s34, 0
    s_cbranch_scc1 c_wj4_11
    s_mov_b32 s40, 128
    s_add_u32 s41, s40, 73216
    v_add_u32 v4, s41, v3
    ds_read_b64_tr_b16 v[184:185], v4
    ds_read_b64_tr_b16 v[186:187], v4 offset:2560
    s_mul_i32 s41, s2, 5120
    s_lshl_b32 s40, s40, 5
    s_add_u32 s41, s41, s40
    s_add_u32 s41, s41, 15007744
    s_waitcnt lgkmcnt(0)
    buffer_store_dwordx4 v[184:187], v5, s[8:11], s41 offen
    s_nop 1
c_wj4_11:
c_wj3_10:
    s_cmp_lg_u32 s34, 0
    s_cbranch_scc1 c_pw_13
    ds_read_b128 v[104:107], v58 offset:0
    ds_read_b128 v[128:131], v59 offset:2592
    ds_read_b128 v[152:155], v59 offset:5152
    ds_read_b128 v[108:111], v58 offset:32
    ds_read_b128 v[132:135], v59 offset:2560
    ds_read_b128 v[156:159], v59 offset:5120
    ds_read_b128 v[112:115], v58 offset:64
    ds_read_b128 v[136:139], v59 offset:2512
    ds_read_b128 v[160:163], v59 offset:5072
    ds_read_b128 v[116:119], v58 offset:96
    ds_read_b128 v[140:143], v59 offset:2480
    ds_read_b128 v[164:167], v59 offset:5040
    ds_read_b128 v[120:123], v58 offset:128
    ds_read_b128 v[144:147], v59 offset:2432
    ds_read_b128 v[168:171], v59 offset:4992
    s_waitcnt lgkmcnt(12)
    v_mfma_f32_32x32x16_bf16 v[72:87], v[104:107], v[128:131], 0
    v_mfma_f32_32x32x16_bf16 v[88:103], v[104:107], v[152:155], 0
    v_mfma_f32_32x32x16_bf16 v[72:87], v[192:195], v[128:131], v[72:87]
    v_mfma_f32_32x32x16_bf16 v[88:103], v[192:195], v[152:155], v[88:103]
    ds_read_b128 v[124:127], v58 offset:160
    ds_read_b128 v[148:151], v59 offset:2400
    ds_read_b128 v[172:175], v59 offset:4960
    s_waitcnt lgkmcnt(12)
    v_mfma_f32_32x32x16_bf16 v[72:87], v[108:111], v[132:135], v[72:87]
    v_mfma_f32_32x32x16_bf16 v[88:103], v[108:111], v[156:159], v[88:103]
    v_mfma_f32_32x32x16_bf16 v[72:87], v[188:191], v[132:135], v[72:87]
    v_mfma_f32_32x32x16_bf16 v[88:103], v[188:191], v[156:159], v[88:103]
    ds_read_b128 v[104:107], v58 offset:192
    ds_read_b128 v[128:131], v59 offset:2352
    ds_read_b128 v[152:155], v59 offset:4912
    s_waitcnt lgkmcnt(12)
    v_mfma_f32_32x32x16_bf16 v[72:87], v[112:115], v[136:139], v[72:87]
    v_mfma_f32_32x32x16_bf16 v[88:103], v[112:115], v[160:163], v[88:103]
    s_add_u32 s40, s53, 24576
    s_mov_b64 exec, 0xfff
    buffer_load_dword v50, v49, s[8:11], s40 offen
    s_add_u32 s40, s52, 256
    s_mov_b64 exec, 0xffff
    buffer_load_dword v50, v48, s[16:19], s40 offen
    s_mov_b64 exec, -1
    ds_read_b128 v[108:111], v58 offset:224
    ds_read_b128 v[132:135], v59 offset:2320
    ds_read_b128 v[156:159], v59 offset:4880
    s_waitcnt lgkmcnt(12)
    v_mfma_f32_32x32x16_bf16 v[72:87], v[116:119], v[140:143], v[72:87]
    v_mfma_f32_32x32x16_bf16 v[88:103], v[116:119], v[164:167], v[88:103]
    ds_read_b128 v[112:115], v58 offset:256
    ds_read_b128 v[136:139], v59 offset:2272
    ds_read_b128 v[160:163], v59 offset:4832
    s_waitcnt lgkmcnt(12)
    v_mfma_f32_32x32x16_bf16 v[72:87], v[120:123], v[144:147], v[72:87]
    v_mfma_f32_32x32x16_bf16 v[88:103], v[120:123], v[168:171], v[88:103]
    ds_read_b128 v[116:119], v58 offset:288
    ds_read_b128 v[140:143], v59 offset:2240
    ds_read_b128 v[164:167], v59 offset:4800
    s_waitcnt lgkmcnt(12)
    v_mfma_f32_32x32x16_bf16 v[72:87], v[124:127], v[148:151], v[72:87]
    v_mfma_f32_32x32x16_bf16 v[88:103], v[124:127], v[172:175], v[88:103]
    s_add_u32 s40, s53, 36864
    s_mov_b64 exec, 0xfff
    buffer_load_dword v50, v49, s[8:11], s40 offen
    s_add_u32 s40, s52, 384
    s_mov_b64 exec, 0xffff
    buffer_load_dword v50, v48, s[16:19], s40 offen
    s_mov_b64 exec, -1
    ds_read_b128 v[120:123], v58 offset:320
    ds_read_b128 v[144:147], v59 offset:2192
    ds_read_b128 v[168:171], v59 offset:4752
    s_waitcnt lgkmcnt(12)
    v_mfma_f32_32x32x16_bf16 v[72:87], v[104:107], v[128:131], v[72:87]
    v_mfma_f32_32x32x16_bf16 v[88:103], v[104:107], v[152:155], v[88:103]
    ds_read_b128 v[124:127], v58 offset:352
    ds_read_b128 v[148:151], v59 offset:2160
    ds_read_b128 v[172:175], v59 offset:4720
    s_waitcnt lgkmcnt(12)
    v_mfma_f32_32x32x16_bf16 v[72:87], v[108:111], v[132:135], v[72:87]
    v_mfma_f32_32x32x16_bf16 v[88:103], v[108:111], v[156:159], v[88:103]
    ds_read_b128 v[104:107], v58 offset:384
    ds_read_b128 v[128:131], v59 offset:2112
    ds_read_b128 v[152:155], v59 offset:4672
    s_waitcnt lgkmcnt(12)
    v_mfma_f32_32x32x16_bf16 v[72:87], v[112:115], v[136:139], v[72:87]
    v_mfma_f32_32x32x16_bf16 v[88:103], v[112:115], v[160:163], v[88:103]
    s_add_u32 s40, s53, 49152
    s_mov_b64 exec, 0xfff
    buffer_load_dword v50, v49, s[8:11], s40 offen
    s_add_u32 s40, s52, 512
    s_mov_b64 exec, 0xffff
    buffer_load_dword v50, v48, s[16:19], s40 offen
    s_mov_b64 exec, -1
    ds_read_b128 v[108:111], v58 offset:416
    ds_read_b128 v[132:135], v59 offset:2080
    ds_read_b128 v[156:159], v59 offset:4640
    s_waitcnt lgkmcnt(12)
    v_mfma_f32_32x32x16_bf16 v[72:87], v[116:119], v[140:143], v[72:87]
    v_mfma_f32_32x32x16_bf16 v[88:103], v[116:119], v[164:167], v[88:103]
    ds_read_b128 v[112:115], v58 offset:448
    ds_read_b128 v[136:139], v59 offset:2032
    ds_read_b128 v[160:163], v59 offset:4592
    s_waitcnt lgkmcnt(12)
    v_mfma_f32_32x32x16_bf16 v[72:87], v[120:123], v[144:147], v[72:87]
    v_mfma_f32_32x32x16_bf16 v[88:103], v[120:123], v[168:171], v[88:103]
    ds_read_b128 v[116:119], v58 offset:480
    ds_read_b128 v[140:143], v59 offset:2000
    ds_read_b128 v[164:167], v59 offset:4560
    s_waitcnt lgkmcnt(12)
    v_mfma_f32_32x32x16_bf16 v[72:87], v[124:127], v[148:151], v[72:87]
    v_mfma_f32_32x32x16_bf16 v[88:103], v[124:127], v[172:175], v[88:103]
    s_add_u32 s40, s53, 61440
    s_mov_b64 exec, 0xfff
    buffer_load_dword v50, v49, s[8:11], s40 offen
    s_add_u32 s40, s52, 640
    s_mov_b64 exec, 0xffff
    buffer_load_dword v50, v48, s[16:19], s40 offen
    s_mov_b64 exec, -1
    ds_read_b128 v[120:123], v58 offset:512
    ds_read_b128 v[144:147], v59 offset:1952
    ds_read_b128 v[168:171], v59 offset:4512
    s_waitcnt lgkmcnt(12)
    v_mfma_f32_32x32x16_bf16 v[72:87], v[104:107], v[128:131], v[72:87]
    v_mfma_f32_32x32x16_bf16 v[88:103], v[104:107], v[152:155], v[88:103]
    ds_read_b128 v[124:127], v58 offset:544
    ds_read_b128 v[148:151], v59 offset:1920
    ds_read_b128 v[172:175], v59 offset:4480
    s_waitcnt lgkmcnt(12)
    v_mfma_f32_32x32x16_bf16 v[72:87], v[108:111], v[132:135], v[72:87]
    v_mfma_f32_32x32x16_bf16 v[88:103], v[108:111], v[156:159], v[88:103]
    ds_read_b128 v[104:107], v58 offset:576
    ds_read_b128 v[128:131], v59 offset:1872
    ds_read_b128 v[152:155], v59 offset:4432
    s_waitcnt lgkmcnt(12)
    v_mfma_f32_32x32x16_bf16 v[72:87], v[112:115], v[136:139], v[72:87]
    v_mfma_f32_32x32x16_bf16 v[88:103], v[112:115], v[160:163], v[88:103]
    s_add_u32 s40, s53, 73728
    s_mov_b64 exec, 0xfff
    buffer_load_dword v50, v49, s[8:11], s40 offen
    s_add_u32 s40, s52, 768
    s_mov_b64 exec, 0xffff
    buffer_load_dword v50, v48, s[16:19], s40 offen
    s_mov_b64 exec, -1
    ds_read_b128 v[108:111], v58 offset:608
    ds_read_b128 v[132:135], v59 offset:1840
    ds_read_b128 v[156:159], v59 offset:4400
    s_waitcnt lgkmcnt(12)
    v_mfma_f32_32x32x16_bf16 v[72:87], v[116:119], v[140:143], v[72:87]
    v_mfma_f32_32x32x16_bf16 v[88:103], v[116:119], v[164:167], v[88:103]
    ds_read_b128 v[112:115], v58 offset:640
    ds_read_b128 v[136:139], v59 offset:1792
    ds_read_b128 v[160:163], v59 offset:4352
    s_waitcnt lgkmcnt(12)
    v_mfma_f32_32x32x16_bf16 v[72:87], v[120:123], v[144:147], v[72:87]
    v_mfma_f32_32x32x16_bf16 v[88:103], v[120:123], v[168:171], v[88:103]
    ds_read_b128 v[116:119], v58 offset:672
    ds_read_b128 v[140:143], v59 offset:1760
    ds_read_b128 v[164:167], v59 offset:4320
    s_waitcnt lgkmcnt(12)
    v_mfma_f32_32x32x16_bf16 v[72:87], v[124:127], v[148:151], v[72:87]
    v_mfma_f32_32x32x16_bf16 v[88:103], v[124:127], v[172:175], v[88:103]
    s_add_u32 s40, s53, 86016
    s_mov_b64 exec, 0xfff
    buffer_load_dword v50, v49, s[8:11], s40 offen
    s_add_u32 s40, s52, 896
    s_mov_b64 exec, 0xffff
    buffer_load_dword v50, v48, s[16:19], s40 offen
    s_mov_b64 exec, -1
    ds_read_b128 v[120:123], v58 offset:704
    ds_read_b128 v[144:147], v59 offset:1712
    ds_read_b128 v[168:171], v59 offset:4272
    s_waitcnt lgkmcnt(12)
    v_mfma_f32_32x32x16_bf16 v[72:87], v[104:107], v[128:131], v[72:87]
    v_mfma_f32_32x32x16_bf16 v[88:103], v[104:107], v[152:155], v[88:103]
    s_waitcnt lgkmcnt(9)
    v_mfma_f32_32x32x16_bf16 v[72:87], v[108:111], v[132:135], v[72:87]
    v_mfma_f32_32x32x16_bf16 v[88:103], v[108:111], v[156:159], v[88:103]
    s_waitcnt lgkmcnt(6)
    v_mfma_f32_32x32x16_bf16 v[72:87], v[112:115], v[136:139], v[72:87]
    v_mfma_f32_32x32x16_bf16 v[88:103], v[112:115], v[160:163], v[88:103]
    s_waitcnt lgkmcnt(3)
    v_mfma_f32_32x32x16_bf16 v[72:87], v[116:119], v[140:143], v[72:87]
    v_mfma_f32_32x32x16_bf16 v[88:103], v[116:119], v[164:167], v[88:103]
    s_waitcnt lgkmcnt(0)
    v_mfma_f32_32x32x16_bf16 v[72:87], v[120:123], v[144:147], v[72:87]
    v_mfma_f32_32x32x16_bf16 v[88:103], v[120:123], v[168:171], v[88:103]
    s_nop 10
    ds_write_b128 v70, v[72:75] offset:0
    ds_write_b128 v70, v[76:79] offset:32
    ds_write_b128 v70, v[80:83] offset:64
    ds_write_b128 v70, v[84:87] offset:96
    ds_write_b128 v70, v[88:91] offset:13824
    ds_write_b128 v70, v[92:95] offset:13856
    ds_write_b128 v70, v[96:99] offset:13888
    ds_write_b128 v70, v[100:103] offset:13920
    s_branch c_pw_end_12
c_pw_13:
    s_cmp_lg_u32 s34, 1
    s_cbranch_scc1 c_pw_14
    ds_read_b128 v[104:107], v58 offset:736
    ds_read_b128 v[128:131], v59 offset:1680
    ds_read_b128 v[152:155], v59 offset:4240
    ds_read_b128 v[108:111], v58 offset:768
    ds_read_b128 v[132:135], v59 offset:1632
    ds_read_b128 v[156:159], v59 offset:4192
    ds_read_b128 v[112:115], v58 offset:800
    ds_read_b128 v[136:139], v59 offset:1600
    ds_read_b128 v[160:163], v59 offset:4160
    ds_read_b128 v[116:119], v58 offset:832
    ds_read_b128 v[140:143], v59 offset:1552
    ds_read_b128 v[164:167], v59 offset:4112
    ds_read_b128 v[120:123], v58 offset:864
    ds_read_b128 v[144:147], v59 offset:1520
    ds_read_b128 v[168:171], v59 offset:4080
    s_waitcnt lgkmcnt(12)
    v_mfma_f32_32x32x16_bf16 v[72:87], v[104:107], v[128:131], 0
    v_mfma_f32_32x32x16_bf16 v[88:103], v[104:107], v[152:155], 0
    ds_read_b128 v[124:127], v58 offset:896
    ds_read_b128 v[148:151], v59 offset:1472
    ds_read_b128 v[172:175], v59 offset:4032
    s_waitcnt lgkmcnt(12)
    v_mfma_f32_32x32x16_bf16 v[72:87], v[108:111], v[132:135], v[72:87]
    v_mfma_f32_32x32x16_bf16 v[88:103], v[108:111], v[156:159], v[88:103]
    ds_read_b128 v[104:107], v58 offset:928
    ds_read_b128 v[128:131], v59 offset:1440
    ds_read_b128 v[152:155], v59 offset:4000
    s_waitcnt lgkmcnt(12)
    v_mfma_f32_32x32x16_bf16 v[72:87], v[112:115], v[136:139], v[72:87]
    v_mfma_f32_32x32x16_bf16 v[88:103], v[112:115], v[160:163], v[88:103]
    s_add_u32 s40, s53, 24576
    s_mov_b64 exec, 0xfff
    buffer_load_dword v50, v49, s[8:11], s40 offen
    s_add_u32 s40, s52, 256
    s_mov_b64 exec, 0xffff
    buffer_load_dword v50, v48, s[16:19], s40 offen
    s_mov_b64 exec, -1
    ds_read_b128 v[108:111], v58 offset:960
    ds_read_b128 v[132:135], v59 offset:1392
    ds_read_b128 v[156:159], v59 offset:3952
    s_waitcnt lgkmcnt(12)
    v_mfma_f32_32x32x16_bf16 v[72:87], v[116:119], v[140:143], v[72:87]
    v_mfma_f32_32x32x16_bf16 v[88:103], v[116:119], v[164:167], v[88:103]
    ds_read_b128 v[112:115], v58 offset:992
    ds_read_b128 v[136:139], v59 offset:1360
    ds_read_b128 v[160:163], v59 offset:3920
    s_waitcnt lgkmcnt(12)
    v_mfma_f32_32x32x16_bf16 v[72:87], v[120:123], v[144:147], v[72:87]
    v_mfma_f32_32x32x16_bf16 v[88:103], v[120:123], v[168:171], v[88:103]
    ds_read_b128 v[116:119], v58 offset:1024
    ds_read_b128 v[140:143], v59 offset:1312
    ds_read_b128 v[164:167], v59 offset:3872
    s_waitcnt lgkmcnt(12)
    v_mfma_f32_32x32x16_bf16 v[72:87], v[124:127], v[148:151], v[72:87]
    v_mfma_f32_32x32x16_bf16 v[88:103], v[124:127], v[172:175], v[88:103]
    s_add_u32 s40, s53, 36864
    s_mov_b64 exec, 0xfff
    buffer_load_dword v50, v49, s[8:11], s40 offen
    s_add_u32 s40, s52, 384
    s_mov_b64 exec, 0xffff
    buffer_load_dword v50, v48, s[16:19], s40 offen
    s_mov_b64 exec, -1
    ds_read_b128 v[120:123], v58 offset:1056
    ds_read_b128 v[144:147], v59 offset:1280
    ds_read_b128 v[168:171], v59 offset:3840
    s_waitcnt lgkmcnt(12)
    v_mfma_f32_32x32x16_bf16 v[72:87], v[104:107], v[128:131], v[72:87]
    v_mfma_f32_32x32x16_bf16 v[88:103], v[104:107], v[152:155], v[88:103]
    ds_read_b128 v[124:127], v58 offset:1088
    ds_read_b128 v[148:151], v59 offset:1232
    ds_read_b128 v[172:175], v59 offset:3792
    s_waitcnt lgkmcnt(12)
    v_mfma_f32_32x32x16_bf16 v[72:87], v[108:111], v[132:135], v[72:87]
    v_mfma_f32_32x32x16_bf16 v[88:103], v[108:111], v[156:159], v[88:103]
    ds_read_b128 v[104:107], v58 offset:1120
    ds_read_b128 v[128:131], v59 offset:1200
    ds_read_b128 v[152:155], v59 offset:3760
    s_waitcnt lgkmcnt(12)
    v_mfma_f32_32x32x16_bf16 v[72:87], v[112:115], v[136:139], v[72:87]
    v_mfma_f32_32x32x16_bf16 v[88:103], v[112:115], v[160:163], v[88:103]
    s_add_u32 s40, s53, 49152
    s_mov_b64 exec, 0xfff
    buffer_load_dword v50, v49, s[8:11], s40 offen
    s_add_u32 s40, s52, 512
    s_mov_b64 exec, 0xffff
    buffer_load_dword v50, v48, s[16:19], s40 offen
    s_mov_b64 exec, -1
    ds_read_b128 v[108:111], v58 offset:1152
    ds_read_b128 v[132:135], v59 offset:1152
    ds_read_b128 v[156:159], v59 offset:3712
    s_waitcnt lgkmcnt(12)
    v_mfma_f32_32x32x16_bf16 v[72:87], v[116:119], v[140:143], v[72:87]
    v_mfma_f32_32x32x16_bf16 v[88:103], v[116:119], v[164:167], v[88:103]
    ds_read_b128 v[112:115], v58 offset:1184
    ds_read_b128 v[136:139], v59 offset:1120
    ds_read_b128 v[160:163], v59 offset:3680
    s_waitcnt lgkmcnt(12)
    v_mfma_f32_32x32x16_bf16 v[72:87], v[120:123], v[144:147], v[72:87]
    v_mfma_f32_32x32x16_bf16 v[88:103], v[120:123], v[168:171], v[88:103]
    ds_read_b128 v[116:119], v58 offset:1216
    ds_read_b128 v[140:143], v59 offset:1072
    ds_read_b128 v[164:167], v59 offset:3632
    s_waitcnt lgkmcnt(12)
    v_mfma_f32_32x32x16_bf16 v[72:87], v[124:127], v[148:151], v[72:87]
    v_mfma_f32_32x32x16_bf16 v[88:103], v[124:127], v[172:175], v[88:103]
    s_add_u32 s40, s53, 61440
    s_mov_b64 exec, 0xfff
    buffer_load_dword v50, v49, s[8:11], s40 offen
    s_add_u32 s40, s52, 640
    s_mov_b64 exec, 0xffff
    buffer_load_dword v50, v48, s[16:19], s40 offen
    s_mov_b64 exec, -1
    ds_read_b128 v[120:123], v58 offset:1248
    ds_read_b128 v[144:147], v59 offset:1040
    ds_read_b128 v[168:171], v59 offset:3600
    s_waitcnt lgkmcnt(12)
    v_mfma_f32_32x32x16_bf16 v[72:87], v[104:107], v[128:131], v[72:87]
    v_mfma_f32_32x32x16_bf16 v[88:103], v[104:107], v[152:155], v[88:103]
    ds_read_b128 v[124:127], v58 offset:1280
    ds_read_b128 v[148:151], v59 offset:992
    ds_read_b128 v[172:175], v59 offset:3552
    s_waitcnt lgkmcnt(12)
    v_mfma_f32_32x32x16_bf16 v[72:87], v[108:111], v[132:135], v[72:87]
    v_mfma_f32_32x32x16_bf16 v[88:103], v[108:111], v[156:159], v[88:103]
    ds_read_b128 v[104:107], v58 offset:1312
    ds_read_b128 v[128:131], v59 offset:960
    ds_read_b128 v[152:155], v59 offset:3520
    s_waitcnt lgkmcnt(12)
    v_mfma_f32_32x32x16_bf16 v[72:87], v[112:115], v[136:139], v[72:87]
    v_mfma_f32_32x32x16_bf16 v[88:103], v[112:115], v[160:163], v[88:103]
    s_add_u32 s40, s53, 73728
    s_mov_b64 exec, 0xfff
    buffer_load_dword v50, v49, s[8:11], s40 offen
    s_add_u32 s40, s52, 768
    s_mov_b64 exec, 0xffff
    buffer_load_dword v50, v48, s[16:19], s40 offen
    s_mov_b64 exec, -1
    ds_read_b128 v[108:111], v58 offset:1344
    ds_read_b128 v[132:135], v59 offset:912
    ds_read_b128 v[156:159], v59 offset:3472
    s_waitcnt lgkmcnt(12)
    v_mfma_f32_32x32x16_bf16 v[72:87], v[116:119], v[140:143], v[72:87]
    v_mfma_f32_32x32x16_bf16 v[88:103], v[116:119], v[164:167], v[88:103]
    ds_read_b128 v[112:115], v58 offset:1376
    ds_read_b128 v[136:139], v59 offset:880
    ds_read_b128 v[160:163], v59 offset:3440
    s_waitcnt lgkmcnt(12)
    v_mfma_f32_32x32x16_bf16 v[72:87], v[120:123], v[144:147], v[72:87]
    v_mfma_f32_32x32x16_bf16 v[88:103], v[120:123], v[168:171], v[88:103]
    ds_read_b128 v[116:119], v58 offset:1408
    ds_read_b128 v[140:143], v59 offset:832
    ds_read_b128 v[164:167], v59 offset:3392
    s_waitcnt lgkmcnt(12)
    v_mfma_f32_32x32x16_bf16 v[72:87], v[124:127], v[148:151], v[72:87]
    v_mfma_f32_32x32x16_bf16 v[88:103], v[124:127], v[172:175], v[88:103]
    s_add_u32 s40, s53, 86016
    s_mov_b64 exec, 0xfff
    buffer_load_dword v50, v49, s[8:11], s40 offen
    s_add_u32 s40, s52, 896
    s_mov_b64 exec, 0xffff
    buffer_load_dword v50, v48, s[16:19], s40 offen
    s_mov_b64 exec, -1
    ds_read_b128 v[120:123], v58 offset:1440
    ds_read_b128 v[144:147], v59 offset:800
    ds_read_b128 v[168:171], v59 offset:3360
    s_waitcnt lgkmcnt(12)
    v_mfma_f32_32x32x16_bf16 v[72:87], v[104:107], v[128:131], v[72:87]
    v_mfma_f32_32x32x16_bf16 v[88:103], v[104:107], v[152:155], v[88:103]
    ds_read_b128 v[124:127], v58 offset:1472
    ds_read_b128 v[148:151], v59 offset:752
    ds_read_b128 v[172:175], v59 offset:3312
    s_waitcnt lgkmcnt(12)
    v_mfma_f32_32x32x16_bf16 v[72:87], v[108:111], v[132:135], v[72:87]
    v_mfma_f32_32x32x16_bf16 v[88:103], v[108:111], v[156:159], v[88:103]
    s_waitcnt lgkmcnt(9)
    v_mfma_f32_32x32x16_bf16 v[72:87], v[112:115], v[136:139], v[72:87]
    v_mfma_f32_32x32x16_bf16 v[88:103], v[112:115], v[160:163], v[88:103]
    s_waitcnt lgkmcnt(6)
    v_mfma_f32_32x32x16_bf16 v[72:87], v[116:119], v[140:143], v[72:87]
    v_mfma_f32_32x32x16_bf16 v[88:103], v[116:119], v[164:167], v[88:103]
    s_waitcnt lgkmcnt(3)
    v_mfma_f32_32x32x16_bf16 v[72:87], v[120:123], v[144:147], v[72:87]
    v_mfma_f32_32x32x16_bf16 v[88:103], v[120:123], v[168:171], v[88:103]
    s_waitcnt lgkmcnt(0)
    v_mfma_f32_32x32x16_bf16 v[72:87], v[124:127], v[148:151], v[72:87]
    v_mfma_f32_32x32x16_bf16 v[88:103], v[124:127], v[172:175], v[88:103]
    s_nop 10
    ds_write_b128 v70, v[72:75] offset:4608
    ds_write_b128 v70, v[76:79] offset:4640
    ds_write_b128 v70, v[80:83] offset:4672
    ds_write_b128 v70, v[84:87] offset:4704
    ds_write_b128 v70, v[88:91] offset:18432
    ds_write_b128 v70, v[92:95] offset:18464
    ds_write_b128 v70, v[96:99] offset:18496
    ds_write_b128 v70, v[100:103] offset:18528
    s_branch c_pw_end_12
c_pw_14:
    s_cmp_lg_u32 s34, 2
    s_cbranch_scc1 c_pw_15
    ds_read_b128 v[104:107], v58 offset:1504
    ds_read_b128 v[128:131], v59 offset:720
    ds_read_b128 v[152:155], v59 offset:3280
    ds_read_b128 v[108:111], v58 offset:1536
    ds_read_b128 v[132:135], v59 offset:672
    ds_read_b128 v[156:159], v59 offset:3232
    ds_read_b128 v[112:115], v58 offset:1568
    ds_read_b128 v[136:139], v59 offset:640
    ds_read_b128 v[160:163], v59 offset:3200
    ds_read_b128 v[116:119], v58 offset:1600
    ds_read_b128 v[140:143], v59 offset:592
    ds_read_b128 v[164:167], v59 offset:3152
    ds_read_b128 v[120:123], v58 offset:1632
    ds_read_b128 v[144:147], v59 offset:560
    ds_read_b128 v[168:171], v59 offset:3120
    s_waitcnt lgkmcnt(12)
    v_mfma_f32_32x32x16_bf16 v[72:87], v[104:107], v[128:131], 0
    v_mfma_f32_32x32x16_bf16 v[88:103], v[104:107], v[152:155], 0
    ds_read_b128 v[124:127], v58 offset:1664
    ds_read_b128 v[148:151], v59 offset:512
    ds_read_b128 v[172:175], v59 offset:3072
    s_waitcnt lgkmcnt(12)
    v_mfma_f32_32x32x16_bf16 v[72:87], v[108:111], v[132:135], v[72:87]
    v_mfma_f32_32x32x16_bf16 v[88:103], v[108:111], v[156:159], v[88:103]
    ds_read_b128 v[104:107], v58 offset:1696
    ds_read_b128 v[128:131], v59 offset:480
    ds_read_b128 v[152:155], v59 offset:3040
    s_waitcnt lgkmcnt(12)
    v_mfma_f32_32x32x16_bf16 v[72:87], v[112:115], v[136:139], v[72:87]
    v_mfma_f32_32x32x16_bf16 v[88:103], v[112:115], v[160:163], v[88:103]
    s_add_u32 s40, s53, 24576
    s_mov_b64 exec, 0xfff
    buffer_load_dword v50, v49, s[8:11], s40 offen
    s_add_u32 s40, s52, 256
    s_mov_b64 exec, 0xffff
    buffer_load_dword v50, v48, s[16:19], s40 offen
    s_mov_b64 exec, -1
    ds_read_b128 v[108:111], v58 offset:1728
    ds_read_b128 v[132:135], v59 offset:432
    ds_read_b128 v[156:159], v59 offset:2992
    s_waitcnt lgkmcnt(12)
    v_mfma_f32_32x32x16_bf16 v[72:87], v[116:119], v[140:143], v[72:87]
    v_mfma_f32_32x32x16_bf16 v[88:103], v[116:119], v[164:167], v[88:103]
    ds_read_b128 v[112:115], v58 offset:1760
    ds_read_b128 v[136:139], v59 offset:400
    ds_read_b128 v[160:163], v59 offset:2960
    s_waitcnt lgkmcnt(12)
    v_mfma_f32_32x32x16_bf16 v[72:87], v[120:123], v[144:147], v[72:87]
    v_mfma_f32_32x32x16_bf16 v[88:103], v[120:123], v[168:171], v[88:103]
    ds_read_b128 v[116:119], v58 offset:1792
    ds_read_b128 v[140:143], v59 offset:352
    ds_read_b128 v[164:167], v59 offset:2912
    s_waitcnt lgkmcnt(12)
    v_mfma_f32_32x32x16_bf16 v[72:87], v[124:127], v[148:151], v[72:87]
    v_mfma_f32_32x32x16_bf16 v[88:103], v[124:127], v[172:175], v[88:103]
    s_add_u32 s40, s53, 36864
    s_mov_b64 exec, 0xfff
    buffer_load_dword v50, v49, s[8:11], s40 offen
    s_add_u32 s40, s52, 384
    s_mov_b64 exec, 0xffff
    buffer_load_dword v50, v48, s[16:19], s40 offen
    s_mov_b64 exec, -1
    ds_read_b128 v[120:123], v58 offset:1824
    ds_read_b128 v[144:147], v59 offset:320
    ds_read_b128 v[168:171], v59 offset:2880
    s_waitcnt lgkmcnt(12)
    v_mfma_f32_32x32x16_bf16 v[72:87], v[104:107], v[128:131], v[72:87]
    v_mfma_f32_32x32x16_bf16 v[88:103], v[104:107], v[152:155], v[88:103]
    ds_read_b128 v[124:127], v58 offset:1856
    ds_read_b128 v[148:151], v59 offset:272
    ds_read_b128 v[172:175], v59 offset:2832
    s_waitcnt lgkmcnt(12)
    v_mfma_f32_32x32x16_bf16 v[72:87], v[108:111], v[132:135], v[72:87]
    v_mfma_f32_32x32x16_bf16 v[88:103], v[108:111], v[156:159], v[88:103]
    ds_read_b128 v[104:107], v58 offset:1888
    ds_read_b128 v[128:131], v59 offset:240
    ds_read_b128 v[152:155], v59 offset:2800
    s_waitcnt lgkmcnt(12)
    v_mfma_f32_32x32x16_bf16 v[72:87], v[112:115], v[136:139], v[72:87]
    v_mfma_f32_32x32x16_bf16 v[88:103], v[112:115], v[160:163], v[88:103]
    s_add_u32 s40, s53, 49152
    s_mov_b64 exec, 0xfff
    buffer_load_dword v50, v49, s[8:11], s40 offen
    s_add_u32 s40, s52, 512
    s_mov_b64 exec, 0xffff
    buffer_load_dword v50, v48, s[16:19], s40 offen
    s_mov_b64 exec, -1
    ds_read_b128 v[108:111], v58 offset:1920
    ds_read_b128 v[132:135], v59 offset:192
    ds_read_b128 v[156:159], v59 offset:2752
    s_waitcnt lgkmcnt(12)
    v_mfma_f32_32x32x16_bf16 v[72:87], v[116:119], v[140:143], v[72:87]
    v_mfma_f32_32x32x16_bf16 v[88:103], v[116:119], v[164:167], v[88:103]
    ds_read_b128 v[112:115], v58 offset:1952
    ds_read_b128 v[136:139], v59 offset:160
    ds_read_b128 v[160:163], v59 offset:2720
    s_waitcnt lgkmcnt(12)
    v_mfma_f32_32x32x16_bf16 v[72:87], v[120:123], v[144:147], v[72:87]
    v_mfma_f32_32x32x16_bf16 v[88:103], v[120:123], v[168:171], v[88:103]
    ds_read_b128 v[116:119], v58 offset:1984
    ds_read_b128 v[140:143], v59 offset:112
    ds_read_b128 v[164:167], v59 offset:2672
    s_waitcnt lgkmcnt(12)
    v_mfma_f32_32x32x16_bf16 v[72:87], v[124:127], v[148:151], v[72:87]
    v_mfma_f32_32x32x16_bf16 v[88:103], v[124:127], v[172:175], v[88:103]
    s_add_u32 s40, s53, 61440
    s_mov_b64 exec, 0xfff
    buffer_load_dword v50, v49, s[8:11], s40 offen
    s_add_u32 s40, s52, 640
    s_mov_b64 exec, 0xffff
    buffer_load_dword v50, v48, s[16:19], s40 offen
    s_mov_b64 exec, -1
    ds_read_b128 v[120:123], v58 offset:2016
    ds_read_b128 v[144:147], v59 offset:80
    ds_read_b128 v[168:171], v59 offset:2640
    s_waitcnt lgkmcnt(12)
    v_mfma_f32_32x32x16_bf16 v[72:87], v[104:107], v[128:131], v[72:87]
    v_mfma_f32_32x32x16_bf16 v[88:103], v[104:107], v[152:155], v[88:103]
    ds_read_b128 v[124:127], v58 offset:2048
    ds_read_b128 v[172:175], v59 offset:2592
    s_waitcnt lgkmcnt(11)
    v_mfma_f32_32x32x16_bf16 v[72:87], v[108:111], v[132:135], v[72:87]
    v_mfma_f32_32x32x16_bf16 v[88:103], v[108:111], v[156:159], v[88:103]
    ds_read_b128 v[104:107], v58 offset:2080
    ds_read_b128 v[152:155], v59 offset:2560
    s_waitcnt lgkmcnt(10)
    v_mfma_f32_32x32x16_bf16 v[72:87], v[112:115], v[136:139], v[72:87]
    v_mfma_f32_32x32x16_bf16 v[88:103], v[112:115], v[160:163], v[88:103]
    s_add_u32 s40, s53, 73728
    s_mov_b64 exec, 0xfff
    buffer_load_dword v50, v49, s[8:11], s40 offen
    s_add_u32 s40, s52, 768
    s_mov_b64 exec, 0xffff
    buffer_load_dword v50, v48, s[16:19], s40 offen
    s_mov_b64 exec, -1
    ds_read_b128 v[108:111], v58 offset:2112
    ds_read_b128 v[156:159], v59 offset:2512
    s_waitcnt lgkmcnt(9)
    v_mfma_f32_32x32x16_bf16 v[72:87], v[116:119], v[140:143], v[72:87]
    v_mfma_f32_32x32x16_bf16 v[88:103], v[116:119], v[164:167], v[88:103]
    ds_read_b128 v[112:115], v58 offset:2144
    ds_read_b128 v[160:163], v59 offset:2480
    s_waitcnt lgkmcnt(8)
    v_mfma_f32_32x32x16_bf16 v[72:87], v[120:123], v[144:147], v[72:87]
    v_mfma_f32_32x32x16_bf16 v[88:103], v[120:123], v[168:171], v[88:103]
    ds_read_b128 v[116:119], v58 offset:2176
    ds_read_b128 v[164:167], v59 offset:2432
    s_waitcnt lgkmcnt(8)
    v_mfma_f32_32x32x16_bf16 v[88:103], v[124:127], v[172:175], v[88:103]
    s_add_u32 s40, s53, 86016
    s_mov_b64 exec, 0xfff
    buffer_load_dword v50, v49, s[8:11], s40 offen
    s_add_u32 s40, s52, 896
    s_mov_b64 exec, 0xffff
    buffer_load_dword v50, v48, s[16:19], s40 offen
    s_mov_b64 exec, -1
    ds_read_b128 v[120:123], v58 offset:2208
    ds_read_b128 v[168:171], v59 offset:2400
    s_waitcnt lgkmcnt(8)
    v_mfma_f32_32x32x16_bf16 v[88:103], v[104:107], v[152:155], v[88:103]
    ds_read_b128 v[124:127], v58 offset:2240
    ds_read_b128 v[172:175], v59 offset:2352
    s_waitcnt lgkmcnt(8)
    v_mfma_f32_32x32x16_bf16 v[88:103], v[108:111], v[156:159], v[88:103]
    ds_read_b128 v[104:107], v58 offset:2272
    ds_read_b128 v[152:155], v59 offset:2320
    s_waitcnt lgkmcnt(8)
    v_mfma_f32_32x32x16_bf16 v[88:103], v[112:115], v[160:163], v[88:103]
    ds_read_b128 v[108:111], v58 offset:2304
    ds_read_b128 v[156:159], v59 offset:2272
    s_waitcnt lgkmcnt(8)
    v_mfma_f32_32x32x16_bf16 v[88:103], v[116:119], v[164:167], v[88:103]
    ds_read_b128 v[112:115], v58 offset:2336
    ds_read_b128 v[160:163], v59 offset:2240
    s_waitcnt lgkmcnt(8)
    v_mfma_f32_32x32x16_bf16 v[88:103], v[120:123], v[168:171], v[88:103]
    ds_read_b128 v[116:119], v58 offset:2368
    ds_read_b128 v[164:167], v59 offset:2192
    s_waitcnt lgkmcnt(8)
    v_mfma_f32_32x32x16_bf16 v[88:103], v[124:127], v[172:175], v[88:103]
    ds_read_b128 v[120:123], v58 offset:2400
    ds_read_b128 v[168:171], v59 offset:2160
    s_waitcnt lgkmcnt(8)
    v_mfma_f32_32x32x16_bf16 v[88:103], v[104:107], v[152:155], v[88:103]
    ds_read_b128 v[124:127], v58 offset:2432
    ds_read_b128 v[172:175], v59 offset:2112
    s_waitcnt lgkmcnt(8)
    v_mfma_f32_32x32x16_bf16 v[88:103], v[108:111], v[156:159], v[88:103]
    ds_read_b128 v[104:107], v58 offset:2464
    ds_read_b128 v[152:155], v59 offset:2080
    s_waitcnt lgkmcnt(8)
    v_mfma_f32_32x32x16_bf16 v[88:103], v[112:115], v[160:163], v[88:103]
    ds_read_b128 v[108:111], v58 offset:2496
    ds_read_b128 v[156:159], v59 offset:2032
    s_waitcnt lgkmcnt(8)
    v_mfma_f32_32x32x16_bf16 v[88:103], v[116:119], v[164:167], v[88:103]
    s_waitcnt lgkmcnt(6)
    v_mfma_f32_32x32x16_bf16 v[88:103], v[120:123], v[168:171], v[88:103]
    s_waitcnt lgkmcnt(4)
    v_mfma_f32_32x32x16_bf16 v[88:103], v[124:127], v[172:175], v[88:103]
    s_waitcnt lgkmcnt(2)
    v_mfma_f32_32x32x16_bf16 v[88:103], v[104:107], v[152:155], v[88:103]
    s_waitcnt lgkmcnt(0)
    v_mfma_f32_32x32x16_bf16 v[88:103], v[108:111], v[156:159], v[88:103]
    ds_write_b128 v70, v[72:75] offset:9216
    ds_write_b128 v70, v[76:79] offset:9248
    ds_write_b128 v70, v[80:83] offset:9280
    ds_write_b128 v70, v[84:87] offset:9312
    s_nop 7
    ds_write_b128 v70, v[88:91] offset:23040
    ds_write_b128 v70, v[92:95] offset:23072
    ds_write_b128 v70, v[96:99] offset:23104
    ds_write_b128 v70, v[100:103] offset:23136
    s_branch c_pw_end_12
c_pw_15:
    ds_read_b128 v[104:107], v58 offset:2528
    ds_read_b128 v[152:155], v59 offset:2000
    ds_read_b128 v[108:111], v58 offset:2560
    ds_read_b128 v[156:159], v59 offset:1952
    ds_read_b128 v[112:115], v58 offset:2592
    ds_read_b128 v[160:163], v59 offset:1920
    ds_read_b128 v[116:119], v58 offset:2624
    ds_read_b128 v[164:167], v59 offset:1872
    ds_read_b128 v[120:123], v58 offset:2656
    ds_read_b128 v[168:171], v59 offset:1840
    s_waitcnt lgkmcnt(8)
    v_mfma_f32_32x32x16_bf16 v[88:103], v[104:107], v[152:155], 0
    ds_read_b128 v[124:127], v58 offset:2688
    ds_read_b128 v[172:175], v59 offset:1792
    s_waitcnt lgkmcnt(8)
    v_mfma_f32_32x32x16_bf16 v[88:103], v[108:111], v[156:159], v[88:103]
    ds_read_b128 v[104:107], v58 offset:2720
    ds_read_b128 v[152:155], v59 offset:1760
    s_waitcnt lgkmcnt(8)
    v_mfma_f32_32x32x16_bf16 v[88:103], v[112:115], v[160:163], v[88:103]
    s_add_u32 s40, s53, 24576
    s_mov_b64 exec, 0xfff
    buffer_load_dword v50, v49, s[8:11], s40 offen
    s_add_u32 s40, s52, 256
    s_mov_b64 exec, 0xffff
    buffer_load_dword v50, v48, s[16:19], s40 offen
    s_mov_b64 exec, -1
    ds_read_b128 v[108:111], v58 offset:2752
    ds_read_b128 v[156:159], v59 offset:1712
    s_waitcnt lgkmcnt(8)
    v_mfma_f32_32x32x16_bf16 v[88:103], v[116:119], v[164:167], v[88:103]
    ds_read_b128 v[112:115], v58 offset:2784
    ds_read_b128 v[160:163], v59 offset:1680
    s_waitcnt lgkmcnt(8)
    v_mfma_f32_32x32x16_bf16 v[88:103], v[120:123], v[168:171], v[88:103]
    ds_read_b128 v[116:119], v58 offset:2816
    ds_read_b128 v[164:167], v59 offset:1632
    s_waitcnt lgkmcnt(8)
    v_mfma_f32_32x32x16_bf16 v[88:103], v[124:127], v[172:175], v[88:103]
    s_add_u32 s40, s53, 36864
    s_mov_b64 exec, 0xfff
    buffer_load_dword v50, v49, s[8:11], s40 offen
    s_add_u32 s40, s52, 384
    s_mov_b64 exec, 0xffff
    buffer_load_dword v50, v48, s[16:19], s40 offen
    s_mov_b64 exec, -1
    ds_read_b128 v[120:123], v58 offset:2848
    ds_read_b128 v[168:171], v59 offset:1600
    s_waitcnt lgkmcnt(8)
    v_mfma_f32_32x32x16_bf16 v[88:103], v[104:107], v[152:155], v[88:103]
    ds_read_b128 v[124:127], v58 offset:2880
    ds_read_b128 v[172:175], v59 offset:1552
    s_waitcnt lgkmcnt(8)
    v_mfma_f32_32x32x16_bf16 v[88:103], v[108:111], v[156:159], v[88:103]
    ds_read_b128 v[104:107], v58 offset:2912
    ds_read_b128 v[152:155], v59 offset:1520
    s_waitcnt lgkmcnt(8)
    v_mfma_f32_32x32x16_bf16 v[88:103], v[112:115], v[160:163], v[88:103]
    s_add_u32 s40, s53, 49152
    s_mov_b64 exec, 0xfff
    buffer_load_dword v50, v49, s[8:11], s40 offen
    s_add_u32 s40, s52, 512
    s_mov_b64 exec, 0xffff
    buffer_load_dword v50, v48, s[16:19], s40 offen
    s_mov_b64 exec, -1
    ds_read_b128 v[108:111], v58 offset:2944
    ds_read_b128 v[156:159], v59 offset:1472
    s_waitcnt lgkmcnt(8)
    v_mfma_f32_32x32x16_bf16 v[88:103], v[116:119], v[164:167], v[88:103]
    ds_read_b128 v[112:115], v58 offset:2976
    ds_read_b128 v[160:163], v59 offset:1440
    s_waitcnt lgkmcnt(8)
    v_mfma_f32_32x32x16_bf16 v[88:103], v[120:123], v[168:171], v[88:103]
    ds_read_b128 v[116:119], v58 offset:3008
    ds_read_b128 v[164:167], v59 offset:1392
    s_waitcnt lgkmcnt(8)
    v_mfma_f32_32x32x16_bf16 v[88:103], v[124:127], v[172:175], v[88:103]
    s_add_u32 s40, s53, 61440
    s_mov_b64 exec, 0xfff
    buffer_load_dword v50, v49, s[8:11], s40 offen
    s_add_u32 s40, s52, 640
    s_mov_b64 exec, 0xffff
    buffer_load_dword v50, v48, s[16:19], s40 offen
    s_mov_b64 exec, -1
    ds_read_b128 v[120:123], v58 offset:3040
    ds_read_b128 v[168:171], v59 offset:1360
    s_waitcnt lgkmcnt(8)
    v_mfma_f32_32x32x16_bf16 v[88:103], v[104:107], v[152:155], v[88:103]
    ds_read_b128 v[124:127], v58 offset:3072
    ds_read_b128 v[172:175], v59 offset:1312
    s_waitcnt lgkmcnt(8)
    v_mfma_f32_32x32x16_bf16 v[88:103], v[108:111], v[156:159], v[88:103]
    ds_read_b128 v[104:107], v58 offset:3104
    ds_read_b128 v[152:155], v59 offset:1280
    s_waitcnt lgkmcnt(8)
    v_mfma_f32_32x32x16_bf16 v[88:103], v[112:115], v[160:163], v[88:103]
    s_add_u32 s40, s53, 73728
    s_mov_b64 exec, 0xfff
    buffer_load_dword v50, v49, s[8:11], s40 offen
    s_add_u32 s40, s52, 768
    s_mov_b64 exec, 0xffff
    buffer_load_dword v50, v48, s[16:19], s40 offen
    s_mov_b64 exec, -1
    ds_read_b128 v[108:111], v58 offset:3136
    ds_read_b128 v[156:159], v59 offset:1232
    s_waitcnt lgkmcnt(8)
    v_mfma_f32_32x32x16_bf16 v[88:103], v[116:119], v[164:167], v[88:103]
    ds_read_b128 v[112:115], v58 offset:3168
    ds_read_b128 v[160:163], v59 offset:1200
    s_waitcnt lgkmcnt(8)
    v_mfma_f32_32x32x16_bf16 v[88:103], v[120:123], v[168:171], v[88:103]
    ds_read_b128 v[116:119], v58 offset:3200
    ds_read_b128 v[164:167], v59 offset:1152
    s_waitcnt lgkmcnt(8)
    v_mfma_f32_32x32x16_bf16 v[88:103], v[124:127], v[172:175], v[88:103]
    s_add_u32 s40, s53, 86016
    s_mov_b64 exec, 0xfff
    buffer_load_dword v50, v49, s[8:11], s40 offen
    s_add_u32 s40, s52, 896
    s_mov_b64 exec, 0xffff
    buffer_load_dword v50, v48, s[16:19], s40 offen
    s_mov_b64 exec, -1
    ds_read_b128 v[120:123], v58 offset:3232
    ds_read_b128 v[168:171], v59 offset:1120
    s_waitcnt lgkmcnt(8)
    v_mfma_f32_32x32x16_bf16 v[88:103], v[104:107], v[152:155], v[88:103]
    ds_read_b128 v[124:127], v58 offset:3264
    ds_read_b128 v[172:175], v59 offset:1072
    s_waitcnt lgkmcnt(8)
    v_mfma_f32_32x32x16_bf16 v[88:103], v[108:111], v[156:159], v[88:103]
    ds_read_b128 v[104:107], v58 offset:3296
    ds_read_b128 v[152:155], v59 offset:1040
    s_waitcnt lgkmcnt(8)
    v_mfma_f32_32x32x16_bf16 v[88:103], v[112:115], v[160:163], v[88:103]
    ds_read_b128 v[108:111], v58 offset:3328
    ds_read_b128 v[156:159], v59 offset:992
    s_waitcnt lgkmcnt(8)
    v_mfma_f32_32x32x16_bf16 v[88:103], v[116:119], v[164:167], v[88:103]
    ds_read_b128 v[112:115], v58 offset:3360
    ds_read_b128 v[160:163], v59 offset:960
    s_waitcnt lgkmcnt(8)
    v_mfma_f32_32x32x16_bf16 v[88:103], v[120:123], v[168:171], v[88:103]
    ds_read_b128 v[116:119], v58 offset:3392
    ds_read_b128 v[164:167], v59 offset:912
    s_waitcnt lgkmcnt(8)
    v_mfma_f32_32x32x16_bf16 v[88:103], v[124:127], v[172:175], v[88:103]
    ds_read_b128 v[120:123], v58 offset:3424
    ds_read_b128 v[168:171], v59 offset:880
    s_waitcnt lgkmcnt(8)
    v_mfma_f32_32x32x16_bf16 v[88:103], v[104:107], v[152:155], v[88:103]
    ds_read_b128 v[124:127], v58 offset:3456
    ds_read_b128 v[172:175], v59 offset:832
    s_waitcnt lgkmcnt(8)
    v_mfma_f32_32x32x16_bf16 v[88:103], v[108:111], v[156:159], v[88:103]
    ds_read_b128 v[104:107], v58 offset:3488
    ds_read_b128 v[152:155], v59 offset:800
    s_waitcnt lgkmcnt(8)
    v_mfma_f32_32x32x16_bf16 v[88:103], v[112:115], v[160:163], v[88:103]
    ds_read_b128 v[108:111], v58 offset:3520
    ds_read_b128 v[156:159], v59 offset:752
    s_waitcnt lgkmcnt(8)
    v_mfma_f32_32x32x16_bf16 v[88:103], v[116:119], v[164:167], v[88:103]
    ds_read_b128 v[112:115], v58 offset:3552
    ds_read_b128 v[160:163], v59 offset:720
    s_waitcnt lgkmcnt(8)
    v_mfma_f32_32x32x16_bf16 v[88:103], v[120:123], v[168:171], v[88:103]
    ds_read_b128 v[116:119], v58 offset:3584
    ds_read_b128 v[164:167], v59 offset:672
    s_waitcnt lgkmcnt(8)
    v_mfma_f32_32x32x16_bf16 v[88:103], v[124:127], v[172:175], v[88:103]
    ds_read_b128 v[120:123], v58 offset:3616
    ds_read_b128 v[168:171], v59 offset:640
    s_waitcnt lgkmcnt(8)
    v_mfma_f32_32x32x16_bf16 v[88:103], v[104:107], v[152:155], v[88:103]
    ds_read_b128 v[124:127], v58 offset:3648
    ds_read_b128 v[172:175], v59 offset:592
    s_waitcnt lgkmcnt(8)
    v_mfma_f32_32x32x16_bf16 v[88:103], v[108:111], v[156:159], v[88:103]
    ds_read_b128 v[104:107], v58 offset:3680
    ds_read_b128 v[152:155], v59 offset:560
    s_waitcnt lgkmcnt(8)
    v_mfma_f32_32x32x16_bf16 v[88:103], v[112:115], v[160:163], v[88:103]
    ds_read_b128 v[108:111], v58 offset:3712
    ds_read_b128 v[156:159], v59 offset:512
    s_waitcnt lgkmcnt(8)
    v_mfma_f32_32x32x16_bf16 v[88:103], v[116:119], v[164:167], v[88:103]
    ds_read_b128 v[112:115], v58 offset:3744
    ds_read_b128 v[160:163], v59 offset:480
    s_waitcnt lgkmcnt(8)
    v_mfma_f32_32x32x16_bf16 v[88:103], v[120:123], v[168:171], v[88:103]
    ds_read_b128 v[116:119], v58 offset:3776
    ds_read_b128 v[164:167], v59 offset:432
    s_waitcnt lgkmcnt(8)
    v_mfma_f32_32x32x16_bf16 v[88:103], v[124:127], v[172:175], v[88:103]
    ds_read_b128 v[120:123], v58 offset:3808
    ds_read_b128 v[168:171], v59 offset:400
    s_waitcnt lgkmcnt(8)
    v_mfma_f32_32x32x16_bf16 v[88:103], v[104:107], v[152:155], v[88:103]
    ds_read_b128 v[124:127], v58 offset:3840
    ds_read_b128 v[172:175], v59 offset:352
    s_waitcnt lgkmcnt(8)
    v_mfma_f32_32x32x16_bf16 v[88:103], v[108:111], v[156:159], v[88:103]
    ds_read_b128 v[104:107], v58 offset:3872
    ds_read_b128 v[152:155], v59 offset:320
    s_waitcnt lgkmcnt(8)
    v_mfma_f32_32x32x16_bf16 v[88:103], v[112:115], v[160:163], v[88:103]
    ds_read_b128 v[108:111], v58 offset:3904
    ds_read_b128 v[156:159], v59 offset:272
    s_waitcnt lgkmcnt(8)
    v_mfma_f32_32x32x16_bf16 v[88:103], v[116:119], v[164:167], v[88:103]
    ds_read_b128 v[112:115], v58 offset:3936
    ds_read_b128 v[160:163], v59 offset:240
    s_waitcnt lgkmcnt(8)
    v_mfma_f32_32x32x16_bf16 v[88:103], v[120:123], v[168:171], v[88:103]
    ds_read_b128 v[116:119], v58 offset:3968
    ds_read_b128 v[164:167], v59 offset:192
    s_waitcnt lgkmcnt(8)
    v_mfma_f32_32x32x16_bf16 v[88:103], v[124:127], v[172:175], v[88:103]
    ds_read_b128 v[120:123], v58 offset:4000
    ds_read_b128 v[168:171], v59 offset:160
    s_waitcnt lgkmcnt(8)
    v_mfma_f32_32x32x16_bf16 v[88:103], v[104:107], v[152:155], v[88:103]
    ds_read_b128 v[124:127], v58 offset:4032
    ds_read_b128 v[172:175], v59 offset:112
    s_waitcnt lgkmcnt(8)
    v_mfma_f32_32x32x16_bf16 v[88:103], v[108:111], v[156:159], v[88:103]
    ds_read_b128 v[104:107], v58 offset:4064
    ds_read_b128 v[152:155], v59 offset:80
    s_waitcnt lgkmcnt(8)
    v_mfma_f32_32x32x16_bf16 v[88:103], v[112:115], v[160:163], v[88:103]
    s_waitcnt lgkmcnt(6)
    v_mfma_f32_32x32x16_bf16 v[88:103], v[116:119], v[164:167], v[88:103]
    s_waitcnt lgkmcnt(4)
    v_mfma_f32_32x32x16_bf16 v[88:103], v[120:123], v[168:171], v[88:103]
    s_waitcnt lgkmcnt(2)
    v_mfma_f32_32x32x16_bf16 v[88:103], v[124:127], v[172:175], v[88:103]
    s_waitcnt lgkmcnt(0)
    v_mfma_f32_32x32x16_bf16 v[88:103], v[104:107], v[152:155], v[88:103]
    s_nop 11
    ds_write_b128 v70, v[88:91] offset:27648
    ds_write_b128 v70, v[92:95] offset:27680
    ds_write_b128 v70, v[96:99] offset:27712
    ds_write_b128 v70, v[100:103] offset:27744
c_pw_end_12:
    s_waitcnt lgkmcnt(0)
    s_barrier
    s_cmp_ge_u32 s34, 2
    s_cbranch_scc1 c_finH_17
    ds_read_b128 v[104:107], v71 offset:0
    ds_read_b128 v[108:111], v71 offset:16
    ds_read_b128 v[112:115], v71 offset:4608
    ds_read_b128 v[116:119], v71 offset:4624
    ds_read_b128 v[120:123], v71 offset:9216
    ds_read_b128 v[124:127], v71 offset:9232
    s_waitcnt lgkmcnt(0)
    v_pk_add_f32 v[104:105], v[104:105], v[112:113]
    v_pk_add_f32 v[106:107], v[106:107], v[114:115]
    v_pk_add_f32 v[108:109], v[108:109], v[116:117]
    v_pk_add_f32 v[110:111], v[110:111], v[118:119]
    v_pk_add_f32 v[104:105], v[104:105], v[120:121]
    v_pk_add_f32 v[106:107], v[106:107], v[122:123]
    v_pk_add_f32 v[108:109], v[108:109], v[124:125]
    v_pk_add_f32 v[110:111], v[110:111], v[126:127]
    v_cvt_pk_bf16_f32 v184, v104, v105
    v_cvt_pk_bf16_f32 v185, v106, v107
    v_cvt_pk_bf16_f32 v186, v108, v109
    v_cvt_pk_bf16_f32 v187, v110, v111
    s_lshl_b32 s40, s56, 12
    s_add_u32 s40, s40, 8912896
    v_and_b32 v3, 127, v0
    v_lshlrev_b32 v3, 4, v3
    buffer_store_dwordx4 v[184:187], v3, s[8:11], s40 offen
    s_nop 1
    s_branch c_fin_end_18
c_finH_17:
    ds_read_b128 v[104:107], v71 offset:13824
    ds_read_b128 v[108:111], v71 offset:13840
    ds_read_b128 v[112:115], v71 offset:18432
    ds_read_b128 v[116:119], v71 offset:18448
    ds_read_b128 v[120:123], v71 offset:23040
    ds_read_b128 v[124:127], v71 offset:23056
    ds_read_b128 v[128:131], v71 offset:27648
    ds_read_b128 v[132:135], v71 offset:27664
    s_waitcnt lgkmcnt(0)
    v_pk_add_f32 v[104:105], v[104:105], v[112:113]
    v_pk_add_f32 v[106:107], v[106:107], v[114:115]
    v_pk_add_f32 v[108:109], v[108:109], v[116:117]
    v_pk_add_f32 v[110:111], v[110:111], v[118:119]
    v_pk_add_f32 v[104:105], v[104:105], v[120:121]
    v_pk_add_f32 v[106:107], v[106:107], v[122:123]
    v_pk_add_f32 v[108:109], v[108:109], v[124:125]
    v_pk_add_f32 v[110:111], v[110:111], v[126:127]
    v_pk_add_f32 v[104:105], v[104:105], v[128:129]
    v_pk_add_f32 v[106:107], v[106:107], v[130:131]
    v_pk_add_f32 v[108:109], v[108:109], v[132:133]
    v_pk_add_f32 v[110:111], v[110:111], v[134:135]
    v_cvt_pk_bf16_f32 v184, v104, v105
    v_cvt_pk_bf16_f32 v185, v106, v107
    v_cvt_pk_bf16_f32 v186, v108, v109
    v_cvt_pk_bf16_f32 v187, v110, v111
    s_lshl_b32 s40, s56, 12
    s_add_u32 s40, s40, 8914944
    v_and_b32 v3, 127, v0
    v_lshlrev_b32 v3, 4, v3
    buffer_store_dwordx4 v[184:187], v3, s[8:11], s40 offen
    s_nop 1
c_fin_end_18:
    s_waitcnt vmcnt(16)
    v_cmp_ne_u32 vcc, 0, v0
    s_nop 1
    v_cndmask_b32 v16, 0, v16, vcc
    v_cndmask_b32 v17, 0, v17, vcc
    v_cndmask_b32 v18, 0, v18, vcc
    v_cndmask_b32 v19, 0, v19, vcc
    v_alignbit_b32 v176, v17, v16, 16
    v_alignbit_b32 v177, v18, v17, 16
    v_alignbit_b32 v178, v19, v18, 16
    v_alignbit_b32 v179, v20, v19, 16
    v_alignbit_b32 v180, v21, v20, 16
    v_alignbit_b32 v181, v22, v21, 16
    v_alignbit_b32 v182, v23, v22, 16
    ds_write_b128 v56, v[176:179] offset:0
    v_mov_b32 v184, v17
    v_mov_b32 v185, v18
    v_mov_b32 v186, v19
    v_mov_b32 v187, v20
    ds_write_b128 v56, v[184:187] offset:4160
    s_nop 1
    v_mov_b32 v184, v177
    v_mov_b32 v185, v178
    v_mov_b32 v186, v179
    v_mov_b32 v187, v180
    ds_write_b128 v56, v[184:187] offset:8320
    s_nop 1
    ds_write_b128 v56, v[18:21] offset:12480
    ds_write_b128 v56, v[178:181] offset:16640
    v_mov_b32 v184, v19
    v_mov_b32 v185, v20
    v_mov_b32 v186, v21
    v_mov_b32 v187, v22
    ds_write_b128 v56, v[184:187] offset:20800
    s_nop 1
    v_mov_b32 v184, v179
    v_mov_b32 v185, v180
    v_mov_b32 v186, v181
    v_mov_b32 v187, v182
    ds_write_b128 v56, v[184:187] offset:24960
    s_nop 1
    ds_write_b128 v56, v[20:23] offset:29120
    ds_write_b128 v57, v[36:39]
    v_lshlrev_b32 v3, 16, v45
    v_or_b32 v3, v3, v45
    v_and_b32 v188, v60, v3
    v_and_b32 v189, v61, v3
    v_and_b32 v190, v62, v3
    v_and_b32 v191, v63, v3
    v_and_b32 v192, v64, v3
    v_and_b32 v193, v65, v3
    v_and_b32 v194, v66, v3
    v_and_b32 v195, v67, v3
    s_waitcnt lgkmcnt(0)
    s_barrier
    s_cmp_lg_u32 s34, 0
    s_cbranch_scc1 c_pw_20
    ds_read_b128 v[104:107], v58 offset:0
    ds_read_b128 v[128:131], v59 offset:2592
    ds_read_b128 v[152:155], v59 offset:5152
    ds_read_b128 v[108:111], v58 offset:32
    ds_read_b128 v[132:135], v59 offset:2560
    ds_read_b128 v[156:159], v59 offset:5120
    ds_read_b128 v[112:115], v58 offset:64
    ds_read_b128 v[136:139], v59 offset:2512
    ds_read_b128 v[160:163], v59 offset:5072
    ds_read_b128 v[116:119], v58 offset:96
    ds_read_b128 v[140:143], v59 offset:2480
    ds_read_b128 v[164:167], v59 offset:5040
    ds_read_b128 v[120:123], v58 offset:128
    ds_read_b128 v[144:147], v59 offset:2432
    ds_read_b128 v[168:171], v59 offset:4992
    s_waitcnt lgkmcnt(12)
    v_mfma_f32_32x32x16_bf16 v[72:87], v[104:107], v[128:131], 0
    v_mfma_f32_32x32x16_bf16 v[88:103], v[104:107], v[152:155], 0
    v_mfma_f32_32x32x16_bf16 v[72:87], v[192:195], v[128:131], v[72:87]
    v_mfma_f32_32x32x16_bf16 v[88:103], v[192:195], v[152:155], v[88:103]
    ds_read_b128 v[124:127], v58 offset:160
    ds_read_b128 v[148:151], v59 offset:2400
    ds_read_b128 v[172:175], v59 offset:4960
    s_waitcnt lgkmcnt(12)
    v_mfma_f32_32x32x16_bf16 v[72:87], v[108:111], v[132:135], v[72:87]
    v_mfma_f32_32x32x16_bf16 v[88:103], v[108:111], v[156:159], v[88:103]
    v_mfma_f32_32x32x16_bf16 v[72:87], v[188:191], v[132:135], v[72:87]
    v_mfma_f32_32x32x16_bf16 v[88:103], v[188:191], v[156:159], v[88:103]
    ds_read_b128 v[104:107], v58 offset:192
    ds_read_b128 v[128:131], v59 offset:2352
    ds_read_b128 v[152:155], v59 offset:4912
    s_waitcnt lgkmcnt(12)
    v_mfma_f32_32x32x16_bf16 v[72:87], v[112:115], v[136:139], v[72:87]
    v_mfma_f32_32x32x16_bf16 v[88:103], v[112:115], v[160:163], v[88:103]
    ds_read_b128 v[108:111], v58 offset:224
    ds_read_b128 v[132:135], v59 offset:2320
    ds_read_b128 v[156:159], v59 offset:4880
    s_waitcnt lgkmcnt(12)
    v_mfma_f32_32x32x16_bf16 v[72:87], v[116:119], v[140:143], v[72:87]
    v_mfma_f32_32x32x16_bf16 v[88:103], v[116:119], v[164:167], v[88:103]
    ds_read_b128 v[112:115], v58 offset:256
    ds_read_b128 v[136:139], v59 offset:2272
    ds_read_b128 v[160:163], v59 offset:4832
    s_waitcnt lgkmcnt(12)
    v_mfma_f32_32x32x16_bf16 v[72:87], v[120:123], v[144:147], v[72:87]
    v_mfma_f32_32x32x16_bf16 v[88:103], v[120:123], v[168:171], v[88:103]
    ds_read_b128 v[116:119], v58 offset:288
    ds_read_b128 v[140:143], v59 offset:2240
    ds_read_b128 v[164:167], v59 offset:4800
    s_waitcnt lgkmcnt(12)
    v_mfma_f32_32x32x16_bf16 v[72:87], v[124:127], v[148:151], v[72:87]
    v_mfma_f32_32x32x16_bf16 v[88:103], v[124:127], v[172:175], v[88:103]
    ds_read_b128 v[120:123], v58 offset:320
    ds_read_b128 v[144:147], v59 offset:2192
    ds_read_b128 v[168:171], v59 offset:4752
    s_waitcnt lgkmcnt(12)
    v_mfma_f32_32x32x16_bf16 v[72:87], v[104:107], v[128:131], v[72:87]
    v_mfma_f32_32x32x16_bf16 v[88:103], v[104:107], v[152:155], v[88:103]
    ds_read_b128 v[124:127], v58 offset:352
    ds_read_b128 v[148:151], v59 offset:2160
    ds_read_b128 v[172:175], v59 offset:4720
    s_waitcnt lgkmcnt(12)
    v_mfma_f32_32x32x16_bf16 v[72:87], v[108:111], v[132:135], v[72:87]
    v_mfma_f32_32x32x16_bf16 v[88:103], v[108:111], v[156:159], v[88:103]
    ds_read_b128 v[104:107], v58 offset:384
    ds_read_b128 v[128:131], v59 offset:2112
    ds_read_b128 v[152:155], v59 offset:4672
    s_waitcnt lgkmcnt(12)
    v_mfma_f32_32x32x16_bf16 v[72:87], v[112:115], v[136:139], v[72:87]
    v_mfma_f32_32x32x16_bf16 v[88:103], v[112:115], v[160:163], v[88:103]
    ds_read_b128 v[108:111], v58 offset:416
    ds_read_b128 v[132:135], v59 offset:2080
    ds_read_b128 v[156:159], v59 offset:4640
    s_waitcnt lgkmcnt(12)
    v_mfma_f32_32x32x16_bf16 v[72:87], v[116:119], v[140:143], v[72:87]
    v_mfma_f32_32x32x16_bf16 v[88:103], v[116:119], v[164:167], v[88:103]
    ds_read_b128 v[112:115], v58 offset:448
    ds_read_b128 v[136:139], v59 offset:2032
    ds_read_b128 v[160:163], v59 offset:4592
    s_waitcnt lgkmcnt(12)
    v_mfma_f32_32x32x16_bf16 v[72:87], v[120:123], v[144:147], v[72:87]
    v_mfma_f32_32x32x16_bf16 v[88:103], v[120:123], v[168:171], v[88:103]
    ds_read_b128 v[116:119], v58 offset:480
    ds_read_b128 v[140:143], v59 offset:2000
    ds_read_b128 v[164:167], v59 offset:4560
    s_waitcnt lgkmcnt(12)
    v_mfma_f32_32x32x16_bf16 v[72:87], v[124:127], v[148:151], v[72:87]
    v_mfma_f32_32x32x16_bf16 v[88:103], v[124:127], v[172:175], v[88:103]
    ds_read_b128 v[120:123], v58 offset:512
    ds_read_b128 v[144:147], v59 offset:1952
    ds_read_b128 v[168:171], v59 offset:4512
    s_waitcnt lgkmcnt(12)
    v_mfma_f32_32x32x16_bf16 v[72:87], v[104:107], v[128:131], v[72:87]
    v_mfma_f32_32x32x16_bf16 v[88:103], v[104:107], v[152:155], v[88:103]
    ds_read_b128 v[124:127], v58 offset:544
    ds_read_b128 v[148:151], v59 offset:1920
    ds_read_b128 v[172:175], v59 offset:4480
    s_waitcnt lgkmcnt(12)
    v_mfma_f32_32x32x16_bf16 v[72:87], v[108:111], v[132:135], v[72:87]
    v_mfma_f32_32x32x16_bf16 v[88:103], v[108:111], v[156:159], v[88:103]
    ds_read_b128 v[104:107], v58 offset:576
    ds_read_b128 v[128:131], v59 offset:1872
    ds_read_b128 v[152:155], v59 offset:4432
    s_waitcnt lgkmcnt(12)
    v_mfma_f32_32x32x16_bf16 v[72:87], v[112:115], v[136:139], v[72:87]
    v_mfma_f32_32x32x16_bf16 v[88:103], v[112:115], v[160:163], v[88:103]
    ds_read_b128 v[108:111], v58 offset:608
    ds_read_b128 v[132:135], v59 offset:1840
    ds_read_b128 v[156:159], v59 offset:4400
    s_waitcnt lgkmcnt(12)
    v_mfma_f32_32x32x16_bf16 v[72:87], v[116:119], v[140:143], v[72:87]
    v_mfma_f32_32x32x16_bf16 v[88:103], v[116:119], v[164:167], v[88:103]
    ds_read_b128 v[112:115], v58 offset:640
    ds_read_b128 v[136:139], v59 offset:1792
    ds_read_b128 v[160:163], v59 offset:4352
    s_waitcnt lgkmcnt(12)
    v_mfma_f32_32x32x16_bf16 v[72:87], v[120:123], v[144:147], v[72:87]
    v_mfma_f32_32x32x16_bf16 v[88:103], v[120:123], v[168:171], v[88:103]
    ds_read_b128 v[116:119], v58 offset:672
    ds_read_b128 v[140:143], v59 offset:1760
    ds_read_b128 v[164:167], v59 offset:4320
    s_waitcnt lgkmcnt(12)
    v_mfma_f32_32x32x16_bf16 v[72:87], v[124:127], v[148:151], v[72:87]
    v_mfma_f32_32x32x16_bf16 v[88:103], v[124:127], v[172:175], v[88:103]
    ds_read_b128 v[120:123], v58 offset:704
    ds_read_b128 v[144:147], v59 offset:1712
    ds_read_b128 v[168:171], v59 offset:4272
    s_waitcnt lgkmcnt(12)
    v_mfma_f32_32x32x16_bf16 v[72:87], v[104:107], v[128:131], v[72:87]
    v_mfma_f32_32x32x16_bf16 v[88:103], v[104:107], v[152:155], v[88:103]
    s_waitcnt lgkmcnt(9)
    v_mfma_f32_32x32x16_bf16 v[72:87], v[108:111], v[132:135], v[72:87]
    v_mfma_f32_32x32x16_bf16 v[88:103], v[108:111], v[156:159], v[88:103]
    s_waitcnt lgkmcnt(6)
    v_mfma_f32_32x32x16_bf16 v[72:87], v[112:115], v[136:139], v[72:87]
    v_mfma_f32_32x32x16_bf16 v[88:103], v[112:115], v[160:163], v[88:103]
    s_waitcnt lgkmcnt(3)
    v_mfma_f32_32x32x16_bf16 v[72:87], v[116:119], v[140:143], v[72:87]
    v_mfma_f32_32x32x16_bf16 v[88:103], v[116:119], v[164:167], v[88:103]
    s_waitcnt lgkmcnt(0)
    v_mfma_f32_32x32x16_bf16 v[72:87], v[120:123], v[144:147], v[72:87]
    v_mfma_f32_32x32x16_bf16 v[88:103], v[120:123], v[168:171], v[88:103]
    s_nop 10
    ds_write_b128 v70, v[72:75] offset:0
    ds_write_b128 v70, v[76:79] offset:32
    ds_write_b128 v70, v[80:83] offset:64
    ds_write_b128 v70, v[84:87] offset:96
    ds_write_b128 v70, v[88:91] offset:13824
    ds_write_b128 v70, v[92:95] offset:13856
    ds_write_b128 v70, v[96:99] offset:13888
    ds_write_b128 v70, v[100:103] offset:13920
    s_branch c_pw_end_19
c_pw_20:
    s_cmp_lg_u32 s34, 1
    s_cbranch_scc1 c_pw_21
    ds_read_b128 v[104:107], v58 offset:736
    ds_read_b128 v[128:131], v59 offset:1680
    ds_read_b128 v[152:155], v59 offset:4240
    ds_read_b128 v[108:111], v58 offset:768
    ds_read_b128 v[132:135], v59 offset:1632
    ds_read_b128 v[156:159], v59 offset:4192
    ds_read_b128 v[112:115], v58 offset:800
    ds_read_b128 v[136:139], v59 offset:1600
    ds_read_b128 v[160:163], v59 offset:4160
    ds_read_b128 v[116:119], v58 offset:832
    ds_read_b128 v[140:143], v59 offset:1552
    ds_read_b128 v[164:167], v59 offset:4112
    ds_read_b128 v[120:123], v58 offset:864
    ds_read_b128 v[144:147], v59 offset:1520
    ds_read_b128 v[168:171], v59 offset:4080
    s_waitcnt lgkmcnt(12)
    v_mfma_f32_32x32x16_bf16 v[72:87], v[104:107], v[128:131], 0
    v_mfma_f32_32x32x16_bf16 v[88:103], v[104:107], v[152:155], 0
    ds_read_b128 v[124:127], v58 offset:896
    ds_read_b128 v[148:151], v59 offset:1472
    ds_read_b128 v[172:175], v59 offset:4032
    s_waitcnt lgkmcnt(12)
    v_mfma_f32_32x32x16_bf16 v[72:87], v[108:111], v[132:135], v[72:87]
    v_mfma_f32_32x32x16_bf16 v[88:103], v[108:111], v[156:159], v[88:103]
    ds_read_b128 v[104:107], v58 offset:928
    ds_read_b128 v[128:131], v59 offset:1440
    ds_read_b128 v[152:155], v59 offset:4000
    s_waitcnt lgkmcnt(12)
    v_mfma_f32_32x32x16_bf16 v[72:87], v[112:115], v[136:139], v[72:87]
    v_mfma_f32_32x32x16_bf16 v[88:103], v[112:115], v[160:163], v[88:103]
    ds_read_b128 v[108:111], v58 offset:960
    ds_read_b128 v[132:135], v59 offset:1392
    ds_read_b128 v[156:159], v59 offset:3952
    s_waitcnt lgkmcnt(12)
    v_mfma_f32_32x32x16_bf16 v[72:87], v[116:119], v[140:143], v[72:87]
    v_mfma_f32_32x32x16_bf16 v[88:103], v[116:119], v[164:167], v[88:103]
    ds_read_b128 v[112:115], v58 offset:992
    ds_read_b128 v[136:139], v59 offset:1360
    ds_read_b128 v[160:163], v59 offset:3920
    s_waitcnt lgkmcnt(12)
    v_mfma_f32_32x32x16_bf16 v[72:87], v[120:123], v[144:147], v[72:87]
    v_mfma_f32_32x32x16_bf16 v[88:103], v[120:123], v[168:171], v[88:103]
    ds_read_b128 v[116:119], v58 offset:1024
    ds_read_b128 v[140:143], v59 offset:1312
    ds_read_b128 v[164:167], v59 offset:3872
    s_waitcnt lgkmcnt(12)
    v_mfma_f32_32x32x16_bf16 v[72:87], v[124:127], v[148:151], v[72:87]
    v_mfma_f32_32x32x16_bf16 v[88:103], v[124:127], v[172:175], v[88:103]
    ds_read_b128 v[120:123], v58 offset:1056
    ds_read_b128 v[144:147], v59 offset:1280
    ds_read_b128 v[168:171], v59 offset:3840
    s_waitcnt lgkmcnt(12)
    v_mfma_f32_32x32x16_bf16 v[72:87], v[104:107], v[128:131], v[72:87]
    v_mfma_f32_32x32x16_bf16 v[88:103], v[104:107], v[152:155], v[88:103]
    ds_read_b128 v[124:127], v58 offset:1088
    ds_read_b128 v[148:151], v59 offset:1232
    ds_read_b128 v[172:175], v59 offset:3792
    s_waitcnt lgkmcnt(12)
    v_mfma_f32_32x32x16_bf16 v[72:87], v[108:111], v[132:135], v[72:87]
    v_mfma_f32_32x32x16_bf16 v[88:103], v[108:111], v[156:159], v[88:103]
    ds_read_b128 v[104:107], v58 offset:1120
    ds_read_b128 v[128:131], v59 offset:1200
    ds_read_b128 v[152:155], v59 offset:3760
    s_waitcnt lgkmcnt(12)
    v_mfma_f32_32x32x16_bf16 v[72:87], v[112:115], v[136:139], v[72:87]
    v_mfma_f32_32x32x16_bf16 v[88:103], v[112:115], v[160:163], v[88:103]
    ds_read_b128 v[108:111], v58 offset:1152
    ds_read_b128 v[132:135], v59 offset:1152
    ds_read_b128 v[156:159], v59 offset:3712
    s_waitcnt lgkmcnt(12)
    v_mfma_f32_32x32x16_bf16 v[72:87], v[116:119], v[140:143], v[72:87]
    v_mfma_f32_32x32x16_bf16 v[88:103], v[116:119], v[164:167], v[88:103]
    ds_read_b128 v[112:115], v58 offset:1184
    ds_read_b128 v[136:139], v59 offset:1120
    ds_read_b128 v[160:163], v59 offset:3680
    s_waitcnt lgkmcnt(12)
    v_mfma_f32_32x32x16_bf16 v[72:87], v[120:123], v[144:147], v[72:87]
    v_mfma_f32_32x32x16_bf16 v[88:103], v[120:123], v[168:171], v[88:103]
    ds_read_b128 v[116:119], v58 offset:1216
    ds_read_b128 v[140:143], v59 offset:1072
    ds_read_b128 v[164:167], v59 offset:3632
    s_waitcnt lgkmcnt(12)
    v_mfma_f32_32x32x16_bf16 v[72:87], v[124:127], v[148:151], v[72:87]
    v_mfma_f32_32x32x16_bf16 v[88:103], v[124:127], v[172:175], v[88:103]
    ds_read_b128 v[120:123], v58 offset:1248
    ds_read_b128 v[144:147], v59 offset:1040
    ds_read_b128 v[168:171], v59 offset:3600
    s_waitcnt lgkmcnt(12)
    v_mfma_f32_32x32x16_bf16 v[72:87], v[104:107], v[128:131], v[72:87]
    v_mfma_f32_32x32x16_bf16 v[88:103], v[104:107], v[152:155], v[88:103]
    ds_read_b128 v[124:127], v58 offset:1280
    ds_read_b128 v[148:151], v59 offset:992
    ds_read_b128 v[172:175], v59 offset:3552
    s_waitcnt lgkmcnt(12)
    v_mfma_f32_32x32x16_bf16 v[72:87], v[108:111], v[132:135], v[72:87]
    v_mfma_f32_32x32x16_bf16 v[88:103], v[108:111], v[156:159], v[88:103]
    ds_read_b128 v[104:107], v58 offset:1312
    ds_read_b128 v[128:131], v59 offset:960
    ds_read_b128 v[152:155], v59 offset:3520
    s_waitcnt lgkmcnt(12)
    v_mfma_f32_32x32x16_bf16 v[72:87], v[112:115], v[136:139], v[72:87]
    v_mfma_f32_32x32x16_bf16 v[88:103], v[112:115], v[160:163], v[88:103]
    ds_read_b128 v[108:111], v58 offset:1344
    ds_read_b128 v[132:135], v59 offset:912
    ds_read_b128 v[156:159], v59 offset:3472
    s_waitcnt lgkmcnt(12)
    v_mfma_f32_32x32x16_bf16 v[72:87], v[116:119], v[140:143], v[72:87]
    v_mfma_f32_32x32x16_bf16 v[88:103], v[116:119], v[164:167], v[88:103]
    ds_read_b128 v[112:115], v58 offset:1376
    ds_read_b128 v[136:139], v59 offset:880
    ds_read_b128 v[160:163], v59 offset:3440
    s_waitcnt lgkmcnt(12)
    v_mfma_f32_32x32x16_bf16 v[72:87], v[120:123], v[144:147], v[72:87]
    v_mfma_f32_32x32x16_bf16 v[88:103], v[120:123], v[168:171], v[88:103]
    ds_read_b128 v[116:119], v58 offset:1408
    ds_read_b128 v[140:143], v59 offset:832
    ds_read_b128 v[164:167], v59 offset:3392
    s_waitcnt lgkmcnt(12)
    v_mfma_f32_32x32x16_bf16 v[72:87], v[124:127], v[148:151], v[72:87]
    v_mfma_f32_32x32x16_bf16 v[88:103], v[124:127], v[172:175], v[88:103]
    ds_read_b128 v[120:123], v58 offset:1440
    ds_read_b128 v[144:147], v59 offset:800
    ds_read_b128 v[168:171], v59 offset:3360
    s_waitcnt lgkmcnt(12)
    v_mfma_f32_32x32x16_bf16 v[72:87], v[104:107], v[128:131], v[72:87]
    v_mfma_f32_32x32x16_bf16 v[88:103], v[104:107], v[152:155], v[88:103]
    ds_read_b128 v[124:127], v58 offset:1472
    ds_read_b128 v[148:151], v59 offset:752
    ds_read_b128 v[172:175], v59 offset:3312
    s_waitcnt lgkmcnt(12)
    v_mfma_f32_32x32x16_bf16 v[72:87], v[108:111], v[132:135], v[72:87]
    v_mfma_f32_32x32x16_bf16 v[88:103], v[108:111], v[156:159], v[88:103]
    s_waitcnt lgkmcnt(9)
    v_mfma_f32_32x32x16_bf16 v[72:87], v[112:115], v[136:139], v[72:87]
    v_mfma_f32_32x32x16_bf16 v[88:103], v[112:115], v[160:163], v[88:103]
    s_waitcnt lgkmcnt(6)
    v_mfma_f32_32x32x16_bf16 v[72:87], v[116:119], v[140:143], v[72:87]
    v_mfma_f32_32x32x16_bf16 v[88:103], v[116:119], v[164:167], v[88:103]
    s_waitcnt lgkmcnt(3)
    v_mfma_f32_32x32x16_bf16 v[72:87], v[120:123], v[144:147], v[72:87]
    v_mfma_f32_32x32x16_bf16 v[88:103], v[120:123], v[168:171], v[88:103]
    s_waitcnt lgkmcnt(0)
    v_mfma_f32_32x32x16_bf16 v[72:87], v[124:127], v[148:151], v[72:87]
    v_mfma_f32_32x32x16_bf16 v[88:103], v[124:127], v[172:175], v[88:103]
    s_nop 10
    ds_write_b128 v70, v[72:75] offset:4608
    ds_write_b128 v70, v[76:79] offset:4640
    ds_write_b128 v70, v[80:83] offset:4672
    ds_write_b128 v70, v[84:87] offset:4704
    ds_write_b128 v70, v[88:91] offset:18432
    ds_write_b128 v70, v[92:95] offset:18464
    ds_write_b128 v70, v[96:99] offset:18496
    ds_write_b128 v70, v[100:103] offset:18528
    s_branch c_pw_end_19
c_pw_21:
    s_cmp_lg_u32 s34, 2
    s_cbranch_scc1 c_pw_22
    ds_read_b128 v[104:107], v58 offset:1504
    ds_read_b128 v[128:131], v59 offset:720
    ds_read_b128 v[152:155], v59 offset:3280
    ds_read_b128 v[108:111], v58 offset:1536
    ds_read_b128 v[132:135], v59 offset:672
    ds_read_b128 v[156:159], v59 offset:3232
    ds_read_b128 v[112:115], v58 offset:1568
    ds_read_b128 v[136:139], v59 offset:640
    ds_read_b128 v[160:163], v59 offset:3200
    ds_read_b128 v[116:119], v58 offset:1600
    ds_read_b128 v[140:143], v59 offset:592
    ds_read_b128 v[164:167], v59 offset:3152
    ds_read_b128 v[120:123], v58 offset:1632
    ds_read_b128 v[144:147], v59 offset:560
    ds_read_b128 v[168:171], v59 offset:3120
    s_waitcnt lgkmcnt(12)
    v_mfma_f32_32x32x16_bf16 v[72:87], v[104:107], v[128:131], 0
    v_mfma_f32_32x32x16_bf16 v[88:103], v[104:107], v[152:155], 0
    ds_read_b128 v[124:127], v58 offset:1664
    ds_read_b128 v[148:151], v59 offset:512
    ds_read_b128 v[172:175], v59 offset:3072
    s_waitcnt lgkmcnt(12)
    v_mfma_f32_32x32x16_bf16 v[72:87], v[108:111], v[132:135], v[72:87]
    v_mfma_f32_32x32x16_bf16 v[88:103], v[108:111], v[156:159], v[88:103]
    ds_read_b128 v[104:107], v58 offset:1696
    ds_read_b128 v[128:131], v59 offset:480
    ds_read_b128 v[152:155], v59 offset:3040
    s_waitcnt lgkmcnt(12)
    v_mfma_f32_32x32x16_bf16 v[72:87], v[112:115], v[136:139], v[72:87]
    v_mfma_f32_32x32x16_bf16 v[88:103], v[112:115], v[160:163], v[88:103]
    ds_read_b128 v[108:111], v58 offset:1728
    ds_read_b128 v[132:135], v59 offset:432
    ds_read_b128 v[156:159], v59 offset:2992
    s_waitcnt lgkmcnt(12)
    v_mfma_f32_32x32x16_bf16 v[72:87], v[116:119], v[140:143], v[72:87]
    v_mfma_f32_32x32x16_bf16 v[88:103], v[116:119], v[164:167], v[88:103]
    ds_read_b128 v[112:115], v58 offset:1760
    ds_read_b128 v[136:139], v59 offset:400
    ds_read_b128 v[160:163], v59 offset:2960
    s_waitcnt lgkmcnt(12)
    v_mfma_f32_32x32x16_bf16 v[72:87], v[120:123], v[144:147], v[72:87]
    v_mfma_f32_32x32x16_bf16 v[88:103], v[120:123], v[168:171], v[88:103]
    ds_read_b128 v[116:119], v58 offset:1792
    ds_read_b128 v[140:143], v59 offset:352
    ds_read_b128 v[164:167], v59 offset:2912
    s_waitcnt lgkmcnt(12)
    v_mfma_f32_32x32x16_bf16 v[72:87], v[124:127], v[148:151], v[72:87]
    v_mfma_f32_32x32x16_bf16 v[88:103], v[124:127], v[172:175], v[88:103]
    ds_read_b128 v[120:123], v58 offset:1824
    ds_read_b128 v[144:147], v59 offset:320
    ds_read_b128 v[168:171], v59 offset:2880
    s_waitcnt lgkmcnt(12)
    v_mfma_f32_32x32x16_bf16 v[72:87], v[104:107], v[128:131], v[72:87]
    v_mfma_f32_32x32x16_bf16 v[88:103], v[104:107], v[152:155], v[88:103]
    ds_read_b128 v[124:127], v58 offset:1856
    ds_read_b128 v[148:151], v59 offset:272
    ds_read_b128 v[172:175], v59 offset:2832
    s_waitcnt lgkmcnt(12)
    v_mfma_f32_32x32x16_bf16 v[72:87], v[108:111], v[132:135], v[72:87]
    v_mfma_f32_32x32x16_bf16 v[88:103], v[108:111], v[156:159], v[88:103]
    ds_read_b128 v[104:107], v58 offset:1888
    ds_read_b128 v[128:131], v59 offset:240
    ds_read_b128 v[152:155], v59 offset:2800
    s_waitcnt lgkmcnt(12)
    v_mfma_f32_32x32x16_bf16 v[72:87], v[112:115], v[136:139], v[72:87]
    v_mfma_f32_32x32x16_bf16 v[88:103], v[112:115], v[160:163], v[88:103]
    ds_read_b128 v[108:111], v58 offset:1920
    ds_read_b128 v[132:135], v59 offset:192
    ds_read_b128 v[156:159], v59 offset:2752
    s_waitcnt lgkmcnt(12)
    v_mfma_f32_32x32x16_bf16 v[72:87], v[116:119], v[140:143], v[72:87]
    v_mfma_f32_32x32x16_bf16 v[88:103], v[116:119], v[164:167], v[88:103]
    ds_read_b128 v[112:115], v58 offset:1952
    ds_read_b128 v[136:139], v59 offset:160
    ds_read_b128 v[160:163], v59 offset:2720
    s_waitcnt lgkmcnt(12)
    v_mfma_f32_32x32x16_bf16 v[72:87], v[120:123], v[144:147], v[72:87]
    v_mfma_f32_32x32x16_bf16 v[88:103], v[120:123], v[168:171], v[88:103]
    ds_read_b128 v[116:119], v58 offset:1984
    ds_read_b128 v[140:143], v59 offset:112
    ds_read_b128 v[164:167], v59 offset:2672
    s_waitcnt lgkmcnt(12)
    v_mfma_f32_32x32x16_bf16 v[72:87], v[124:127], v[148:151], v[72:87]
    v_mfma_f32_32x32x16_bf16 v[88:103], v[124:127], v[172:175], v[88:103]
    ds_read_b128 v[120:123], v58 offset:2016
    ds_read_b128 v[144:147], v59 offset:80
    ds_read_b128 v[168:171], v59 offset:2640
    s_waitcnt lgkmcnt(12)
    v_mfma_f32_32x32x16_bf16 v[72:87], v[104:107], v[128:131], v[72:87]
    v_mfma_f32_32x32x16_bf16 v[88:103], v[104:107], v[152:155], v[88:103]
    ds_read_b128 v[124:127], v58 offset:2048
    ds_read_b128 v[172:175], v59 offset:2592
    s_waitcnt lgkmcnt(11)
    v_mfma_f32_32x32x16_bf16 v[72:87], v[108:111], v[132:135], v[72:87]
    v_mfma_f32_32x32x16_bf16 v[88:103], v[108:111], v[156:159], v[88:103]
    ds_read_b128 v[104:107], v58 offset:2080
    ds_read_b128 v[152:155], v59 offset:2560
    s_waitcnt lgkmcnt(10)
    v_mfma_f32_32x32x16_bf16 v[72:87], v[112:115], v[136:139], v[72:87]
    v_mfma_f32_32x32x16_bf16 v[88:103], v[112:115], v[160:163], v[88:103]
    ds_read_b128 v[108:111], v58 offset:2112
    ds_read_b128 v[156:159], v59 offset:2512
    s_waitcnt lgkmcnt(9)
    v_mfma_f32_32x32x16_bf16 v[72:87], v[116:119], v[140:143], v[72:87]
    v_mfma_f32_32x32x16_bf16 v[88:103], v[116:119], v[164:167], v[88:103]
    ds_read_b128 v[112:115], v58 offset:2144
    ds_read_b128 v[160:163], v59 offset:2480
    s_waitcnt lgkmcnt(8)
    v_mfma_f32_32x32x16_bf16 v[72:87], v[120:123], v[144:147], v[72:87]
    v_mfma_f32_32x32x16_bf16 v[88:103], v[120:123], v[168:171], v[88:103]
    ds_read_b128 v[116:119], v58 offset:2176
    ds_read_b128 v[164:167], v59 offset:2432
    s_waitcnt lgkmcnt(8)
    v_mfma_f32_32x32x16_bf16 v[88:103], v[124:127], v[172:175], v[88:103]
    ds_read_b128 v[120:123], v58 offset:2208
    ds_read_b128 v[168:171], v59 offset:2400
    s_waitcnt lgkmcnt(8)
    v_mfma_f32_32x32x16_bf16 v[88:103], v[104:107], v[152:155], v[88:103]
    ds_read_b128 v[124:127], v58 offset:2240
    ds_read_b128 v[172:175], v59 offset:2352
    s_waitcnt lgkmcnt(8)
    v_mfma_f32_32x32x16_bf16 v[88:103], v[108:111], v[156:159], v[88:103]
    ds_read_b128 v[104:107], v58 offset:2272
    ds_read_b128 v[152:155], v59 offset:2320
    s_waitcnt lgkmcnt(8)
    v_mfma_f32_32x32x16_bf16 v[88:103], v[112:115], v[160:163], v[88:103]
    ds_read_b128 v[108:111], v58 offset:2304
    ds_read_b128 v[156:159], v59 offset:2272
    s_waitcnt lgkmcnt(8)
    v_mfma_f32_32x32x16_bf16 v[88:103], v[116:119], v[164:167], v[88:103]
    ds_read_b128 v[112:115], v58 offset:2336
    ds_read_b128 v[160:163], v59 offset:2240
    s_waitcnt lgkmcnt(8)
    v_mfma_f32_32x32x16_bf16 v[88:103], v[120:123], v[168:171], v[88:103]
    ds_read_b128 v[116:119], v58 offset:2368
    ds_read_b128 v[164:167], v59 offset:2192
    s_waitcnt lgkmcnt(8)
    v_mfma_f32_32x32x16_bf16 v[88:103], v[124:127], v[172:175], v[88:103]
    ds_read_b128 v[120:123], v58 offset:2400
    ds_read_b128 v[168:171], v59 offset:2160
    s_waitcnt lgkmcnt(8)
    v_mfma_f32_32x32x16_bf16 v[88:103], v[104:107], v[152:155], v[88:103]
    ds_read_b128 v[124:127], v58 offset:2432
    ds_read_b128 v[172:175], v59 offset:2112
    s_waitcnt lgkmcnt(8)
    v_mfma_f32_32x32x16_bf16 v[88:103], v[108:111], v[156:159], v[88:103]
    ds_read_b128 v[104:107], v58 offset:2464
    ds_read_b128 v[152:155], v59 offset:2080
    s_waitcnt lgkmcnt(8)
    v_mfma_f32_32x32x16_bf16 v[88:103], v[112:115], v[160:163], v[88:103]
    ds_read_b128 v[108:111], v58 offset:2496
    ds_read_b128 v[156:159], v59 offset:2032
    s_waitcnt lgkmcnt(8)
    v_mfma_f32_32x32x16_bf16 v[88:103], v[116:119], v[164:167], v[88:103]
    s_waitcnt lgkmcnt(6)
    v_mfma_f32_32x32x16_bf16 v[88:103], v[120:123], v[168:171], v[88:103]
    s_waitcnt lgkmcnt(4)
    v_mfma_f32_32x32x16_bf16 v[88:103], v[124:127], v[172:175], v[88:103]
    s_waitcnt lgkmcnt(2)
    v_mfma_f32_32x32x16_bf16 v[88:103], v[104:107], v[152:155], v[88:103]
    s_waitcnt lgkmcnt(0)
    v_mfma_f32_32x32x16_bf16 v[88:103], v[108:111], v[156:159], v[88:103]
    ds_write_b128 v70, v[72:75] offset:9216
    ds_write_b128 v70, v[76:79] offset:9248
    ds_write_b128 v70, v[80:83] offset:9280
    ds_write_b128 v70, v[84:87] offset:9312
    s_nop 7
    ds_write_b128 v70, v[88:91] offset:23040
    ds_write_b128 v70, v[92:95] offset:23072
    ds_write_b128 v70, v[96:99] offset:23104
    ds_write_b128 v70, v[100:103] offset:23136
    s_branch c_pw_end_19
c_pw_22:
    ds_read_b128 v[104:107], v58 offset:2528
    ds_read_b128 v[152:155], v59 offset:2000
    ds_read_b128 v[108:111], v58 offset:2560
    ds_read_b128 v[156:159], v59 offset:1952
    ds_read_b128 v[112:115], v58 offset:2592
    ds_read_b128 v[160:163], v59 offset:1920
    ds_read_b128 v[116:119], v58 offset:2624
    ds_read_b128 v[164:167], v59 offset:1872
    ds_read_b128 v[120:123], v58 offset:2656
    ds_read_b128 v[168:171], v59 offset:1840
    s_waitcnt lgkmcnt(8)
    v_mfma_f32_32x32x16_bf16 v[88:103], v[104:107], v[152:155], 0
    ds_read_b128 v[124:127], v58 offset:2688
    ds_read_b128 v[172:175], v59 offset:1792
    s_waitcnt lgkmcnt(8)
    v_mfma_f32_32x32x16_bf16 v[88:103], v[108:111], v[156:159], v[88:103]
    ds_read_b128 v[104:107], v58 offset:2720
    ds_read_b128 v[152:155], v59 offset:1760
    s_waitcnt lgkmcnt(8)
    v_mfma_f32_32x32x16_bf16 v[88:103], v[112:115], v[160:163], v[88:103]
    ds_read_b128 v[108:111], v58 offset:2752
    ds_read_b128 v[156:159], v59 offset:1712
    s_waitcnt lgkmcnt(8)
    v_mfma_f32_32x32x16_bf16 v[88:103], v[116:119], v[164:167], v[88:103]
    ds_read_b128 v[112:115], v58 offset:2784
    ds_read_b128 v[160:163], v59 offset:1680
    s_waitcnt lgkmcnt(8)
    v_mfma_f32_32x32x16_bf16 v[88:103], v[120:123], v[168:171], v[88:103]
    ds_read_b128 v[116:119], v58 offset:2816
    ds_read_b128 v[164:167], v59 offset:1632
    s_waitcnt lgkmcnt(8)
    v_mfma_f32_32x32x16_bf16 v[88:103], v[124:127], v[172:175], v[88:103]
    ds_read_b128 v[120:123], v58 offset:2848
    ds_read_b128 v[168:171], v59 offset:1600
    s_waitcnt lgkmcnt(8)
    v_mfma_f32_32x32x16_bf16 v[88:103], v[104:107], v[152:155], v[88:103]
    ds_read_b128 v[124:127], v58 offset:2880
    ds_read_b128 v[172:175], v59 offset:1552
    s_waitcnt lgkmcnt(8)
    v_mfma_f32_32x32x16_bf16 v[88:103], v[108:111], v[156:159], v[88:103]
    ds_read_b128 v[104:107], v58 offset:2912
    ds_read_b128 v[152:155], v59 offset:1520
    s_waitcnt lgkmcnt(8)
    v_mfma_f32_32x32x16_bf16 v[88:103], v[112:115], v[160:163], v[88:103]
    ds_read_b128 v[108:111], v58 offset:2944
    ds_read_b128 v[156:159], v59 offset:1472
    s_waitcnt lgkmcnt(8)
    v_mfma_f32_32x32x16_bf16 v[88:103], v[116:119], v[164:167], v[88:103]
    ds_read_b128 v[112:115], v58 offset:2976
    ds_read_b128 v[160:163], v59 offset:1440
    s_waitcnt lgkmcnt(8)
    v_mfma_f32_32x32x16_bf16 v[88:103], v[120:123], v[168:171], v[88:103]
    ds_read_b128 v[116:119], v58 offset:3008
    ds_read_b128 v[164:167], v59 offset:1392
    s_waitcnt lgkmcnt(8)
    v_mfma_f32_32x32x16_bf16 v[88:103], v[124:127], v[172:175], v[88:103]
    ds_read_b128 v[120:123], v58 offset:3040
    ds_read_b128 v[168:171], v59 offset:1360
    s_waitcnt lgkmcnt(8)
    v_mfma_f32_32x32x16_bf16 v[88:103], v[104:107], v[152:155], v[88:103]
    ds_read_b128 v[124:127], v58 offset:3072
    ds_read_b128 v[172:175], v59 offset:1312
    s_waitcnt lgkmcnt(8)
    v_mfma_f32_32x32x16_bf16 v[88:103], v[108:111], v[156:159], v[88:103]
    ds_read_b128 v[104:107], v58 offset:3104
    ds_read_b128 v[152:155], v59 offset:1280
    s_waitcnt lgkmcnt(8)
    v_mfma_f32_32x32x16_bf16 v[88:103], v[112:115], v[160:163], v[88:103]
    ds_read_b128 v[108:111], v58 offset:3136
    ds_read_b128 v[156:159], v59 offset:1232
    s_waitcnt lgkmcnt(8)
    v_mfma_f32_32x32x16_bf16 v[88:103], v[116:119], v[164:167], v[88:103]
    ds_read_b128 v[112:115], v58 offset:3168
    ds_read_b128 v[160:163], v59 offset:1200
    s_waitcnt lgkmcnt(8)
    v_mfma_f32_32x32x16_bf16 v[88:103], v[120:123], v[168:171], v[88:103]
    ds_read_b128 v[116:119], v58 offset:3200
    ds_read_b128 v[164:167], v59 offset:1152
    s_waitcnt lgkmcnt(8)
    v_mfma_f32_32x32x16_bf16 v[88:103], v[124:127], v[172:175], v[88:103]
    ds_read_b128 v[120:123], v58 offset:3232
    ds_read_b128 v[168:171], v59 offset:1120
    s_waitcnt lgkmcnt(8)
    v_mfma_f32_32x32x16_bf16 v[88:103], v[104:107], v[152:155], v[88:103]
    ds_read_b128 v[124:127], v58 offset:3264
    ds_read_b128 v[172:175], v59 offset:1072
    s_waitcnt lgkmcnt(8)
    v_mfma_f32_32x32x16_bf16 v[88:103], v[108:111], v[156:159], v[88:103]
    ds_read_b128 v[104:107], v58 offset:3296
    ds_read_b128 v[152:155], v59 offset:1040
    s_waitcnt lgkmcnt(8)
    v_mfma_f32_32x32x16_bf16 v[88:103], v[112:115], v[160:163], v[88:103]
    ds_read_b128 v[108:111], v58 offset:3328
    ds_read_b128 v[156:159], v59 offset:992
    s_waitcnt lgkmcnt(8)
    v_mfma_f32_32x32x16_bf16 v[88:103], v[116:119], v[164:167], v[88:103]
    ds_read_b128 v[112:115], v58 offset:3360
    ds_read_b128 v[160:163], v59 offset:960
    s_waitcnt lgkmcnt(8)
    v_mfma_f32_32x32x16_bf16 v[88:103], v[120:123], v[168:171], v[88:103]
    ds_read_b128 v[116:119], v58 offset:3392
    ds_read_b128 v[164:167], v59 offset:912
    s_waitcnt lgkmcnt(8)
    v_mfma_f32_32x32x16_bf16 v[88:103], v[124:127], v[172:175], v[88:103]
    ds_read_b128 v[120:123], v58 offset:3424
    ds_read_b128 v[168:171], v59 offset:880
    s_waitcnt lgkmcnt(8)
    v_mfma_f32_32x32x16_bf16 v[88:103], v[104:107], v[152:155], v[88:103]
    ds_read_b128 v[124:127], v58 offset:3456
    ds_read_b128 v[172:175], v59 offset:832
    s_waitcnt lgkmcnt(8)
    v_mfma_f32_32x32x16_bf16 v[88:103], v[108:111], v[156:159], v[88:103]
    ds_read_b128 v[104:107], v58 offset:3488
    ds_read_b128 v[152:155], v59 offset:800
    s_waitcnt lgkmcnt(8)
    v_mfma_f32_32x32x16_bf16 v[88:103], v[112:115], v[160:163], v[88:103]
    ds_read_b128 v[108:111], v58 offset:3520
    ds_read_b128 v[156:159], v59 offset:752
    s_waitcnt lgkmcnt(8)
    v_mfma_f32_32x32x16_bf16 v[88:103], v[116:119], v[164:167], v[88:103]
    ds_read_b128 v[112:115], v58 offset:3552
    ds_read_b128 v[160:163], v59 offset:720
    s_waitcnt lgkmcnt(8)
    v_mfma_f32_32x32x16_bf16 v[88:103], v[120:123], v[168:171], v[88:103]
    ds_read_b128 v[116:119], v58 offset:3584
    ds_read_b128 v[164:167], v59 offset:672
    s_waitcnt lgkmcnt(8)
    v_mfma_f32_32x32x16_bf16 v[88:103], v[124:127], v[172:175], v[88:103]
    ds_read_b128 v[120:123], v58 offset:3616
    ds_read_b128 v[168:171], v59 offset:640
    s_waitcnt lgkmcnt(8)
    v_mfma_f32_32x32x16_bf16 v[88:103], v[104:107], v[152:155], v[88:103]
    ds_read_b128 v[124:127], v58 offset:3648
    ds_read_b128 v[172:175], v59 offset:592
    s_waitcnt lgkmcnt(8)
    v_mfma_f32_32x32x16_bf16 v[88:103], v[108:111], v[156:159], v[88:103]
    ds_read_b128 v[104:107], v58 offset:3680
    ds_read_b128 v[152:155], v59 offset:560
    s_waitcnt lgkmcnt(8)
    v_mfma_f32_32x32x16_bf16 v[88:103], v[112:115], v[160:163], v[88:103]
    ds_read_b128 v[108:111], v58 offset:3712
    ds_read_b128 v[156:159], v59 offset:512
    s_waitcnt lgkmcnt(8)
    v_mfma_f32_32x32x16_bf16 v[88:103], v[116:119], v[164:167], v[88:103]
    ds_read_b128 v[112:115], v58 offset:3744
    ds_read_b128 v[160:163], v59 offset:480
    s_waitcnt lgkmcnt(8)
    v_mfma_f32_32x32x16_bf16 v[88:103], v[120:123], v[168:171], v[88:103]
    ds_read_b128 v[116:119], v58 offset:3776
    ds_read_b128 v[164:167], v59 offset:432
    s_waitcnt lgkmcnt(8)
    v_mfma_f32_32x32x16_bf16 v[88:103], v[124:127], v[172:175], v[88:103]
    ds_read_b128 v[120:123], v58 offset:3808
    ds_read_b128 v[168:171], v59 offset:400
    s_waitcnt lgkmcnt(8)
    v_mfma_f32_32x32x16_bf16 v[88:103], v[104:107], v[152:155], v[88:103]
    ds_read_b128 v[124:127], v58 offset:3840
    ds_read_b128 v[172:175], v59 offset:352
    s_waitcnt lgkmcnt(8)
    v_mfma_f32_32x32x16_bf16 v[88:103], v[108:111], v[156:159], v[88:103]
    ds_read_b128 v[104:107], v58 offset:3872
    ds_read_b128 v[152:155], v59 offset:320
    s_waitcnt lgkmcnt(8)
    v_mfma_f32_32x32x16_bf16 v[88:103], v[112:115], v[160:163], v[88:103]
    ds_read_b128 v[108:111], v58 offset:3904
    ds_read_b128 v[156:159], v59 offset:272
    s_waitcnt lgkmcnt(8)
    v_mfma_f32_32x32x16_bf16 v[88:103], v[116:119], v[164:167], v[88:103]
    ds_read_b128 v[112:115], v58 offset:3936
    ds_read_b128 v[160:163], v59 offset:240
    s_waitcnt lgkmcnt(8)
    v_mfma_f32_32x32x16_bf16 v[88:103], v[120:123], v[168:171], v[88:103]
    ds_read_b128 v[116:119], v58 offset:3968
    ds_read_b128 v[164:167], v59 offset:192
    s_waitcnt lgkmcnt(8)
    v_mfma_f32_32x32x16_bf16 v[88:103], v[124:127], v[172:175], v[88:103]
    ds_read_b128 v[120:123], v58 offset:4000
    ds_read_b128 v[168:171], v59 offset:160
    s_waitcnt lgkmcnt(8)
    v_mfma_f32_32x32x16_bf16 v[88:103], v[104:107], v[152:155], v[88:103]
    ds_read_b128 v[124:127], v58 offset:4032
    ds_read_b128 v[172:175], v59 offset:112
    s_waitcnt lgkmcnt(8)
    v_mfma_f32_32x32x16_bf16 v[88:103], v[108:111], v[156:159], v[88:103]
    ds_read_b128 v[104:107], v58 offset:4064
    ds_read_b128 v[152:155], v59 offset:80
    s_waitcnt lgkmcnt(8)
    v_mfma_f32_32x32x16_bf16 v[88:103], v[112:115], v[160:163], v[88:103]
    s_waitcnt lgkmcnt(6)
    v_mfma_f32_32x32x16_bf16 v[88:103], v[116:119], v[164:167], v[88:103]
    s_waitcnt lgkmcnt(4)
    v_mfma_f32_32x32x16_bf16 v[88:103], v[120:123], v[168:171], v[88:103]
    s_waitcnt lgkmcnt(2)
    v_mfma_f32_32x32x16_bf16 v[88:103], v[124:127], v[172:175], v[88:103]
    s_waitcnt lgkmcnt(0)
    v_mfma_f32_32x32x16_bf16 v[88:103], v[104:107], v[152:155], v[88:103]
    s_nop 11
    ds_write_b128 v70, v[88:91] offset:27648
    ds_write_b128 v70, v[92:95] offset:27680
    ds_write_b128 v70, v[96:99] offset:27712
    ds_write_b128 v70, v[100:103] offset:27744
c_pw_end_19:
    s_waitcnt lgkmcnt(0)
    s_barrier
    s_cmp_ge_u32 s34, 2
    s_cbranch_scc1 c_finH_24
    ds_read_b128 v[104:107], v71 offset:0
    ds_read_b128 v[108:111], v71 offset:16
    ds_read_b128 v[112:115], v71 offset:4608
    ds_read_b128 v[116:119], v71 offset:4624
    ds_read_b128 v[120:123], v71 offset:9216
    ds_read_b128 v[124:127], v71 offset:9232
    s_waitcnt lgkmcnt(0)
    v_pk_add_f32 v[104:105], v[104:105], v[112:113]
    v_pk_add_f32 v[106:107], v[106:107], v[114:115]
    v_pk_add_f32 v[108:109], v[108:109], v[116:117]
    v_pk_add_f32 v[110:111], v[110:111], v[118:119]
    v_pk_add_f32 v[104:105], v[104:105], v[120:121]
    v_pk_add_f32 v[106:107], v[106:107], v[122:123]
    v_pk_add_f32 v[108:109], v[108:109], v[124:125]
    v_pk_add_f32 v[110:111], v[110:111], v[126:127]
    v_cvt_pk_bf16_f32 v184, v104, v105
    v_cvt_pk_bf16_f32 v185, v106, v107
    v_cvt_pk_bf16_f32 v186, v108, v109
    v_cvt_pk_bf16_f32 v187, v110, v111
    s_lshl_b32 s40, s57, 12
    s_add_u32 s40, s40, 8912896
    v_and_b32 v3, 127, v0
    v_lshlrev_b32 v3, 4, v3
    buffer_store_dwordx4 v[184:187], v3, s[8:11], s40 offen
    s_nop 1
    s_branch c_fin_end_25
c_finH_24:
    ds_read_b128 v[104:107], v71 offset:13824
    ds_read_b128 v[108:111], v71 offset:13840
    ds_read_b128 v[112:115], v71 offset:18432
    ds_read_b128 v[116:119], v71 offset:18448
    ds_read_b128 v[120:123], v71 offset:23040
    ds_read_b128 v[124:127], v71 offset:23056
    ds_read_b128 v[128:131], v71 offset:27648
    ds_read_b128 v[132:135], v71 offset:27664
    s_waitcnt lgkmcnt(0)
    v_pk_add_f32 v[104:105], v[104:105], v[112:113]
    v_pk_add_f32 v[106:107], v[106:107], v[114:115]
    v_pk_add_f32 v[108:109], v[108:109], v[116:117]
    v_pk_add_f32 v[110:111], v[110:111], v[118:119]
    v_pk_add_f32 v[104:105], v[104:105], v[120:121]
    v_pk_add_f32 v[106:107], v[106:107], v[122:123]
    v_pk_add_f32 v[108:109], v[108:109], v[124:125]
    v_pk_add_f32 v[110:111], v[110:111], v[126:127]
    v_pk_add_f32 v[104:105], v[104:105], v[128:129]
    v_pk_add_f32 v[106:107], v[106:107], v[130:131]
    v_pk_add_f32 v[108:109], v[108:109], v[132:133]
    v_pk_add_f32 v[110:111], v[110:111], v[134:135]
    v_cvt_pk_bf16_f32 v184, v104, v105
    v_cvt_pk_bf16_f32 v185, v106, v107
    v_cvt_pk_bf16_f32 v186, v108, v109
    v_cvt_pk_bf16_f32 v187, v110, v111
    s_lshl_b32 s40, s57, 12
    s_add_u32 s40, s40, 8914944
    v_and_b32 v3, 127, v0
    v_lshlrev_b32 v3, 4, v3
    buffer_store_dwordx4 v[184:187], v3, s[8:11], s40 offen
    s_nop 1
c_fin_end_25:
    s_waitcnt vmcnt(12)
    v_cmp_ne_u32 vcc, 0, v0
    s_nop 1
    v_cndmask_b32 v24, 0, v24, vcc
    v_cndmask_b32 v25, 0, v25, vcc
    v_cndmask_b32 v26, 0, v26, vcc
    v_cndmask_b32 v27, 0, v27, vcc
    v_alignbit_b32 v176, v25, v24, 16
    v_alignbit_b32 v177, v26, v25, 16
    v_alignbit_b32 v178, v27, v26, 16
    v_alignbit_b32 v179, v28, v27, 16
    v_alignbit_b32 v180, v29, v28, 16
    v_alignbit_b32 v181, v30, v29, 16
    v_alignbit_b32 v182, v31, v30, 16
    ds_write_b128 v56, v[176:179] offset:0
    v_mov_b32 v184, v25
    v_mov_b32 v185, v26
    v_mov_b32 v186, v27
    v_mov_b32 v187, v28
    ds_write_b128 v56, v[184:187] offset:4160
    s_nop 1
    v_mov_b32 v184, v177
    v_mov_b32 v185, v178
    v_mov_b32 v186, v179
    v_mov_b32 v187, v180
    ds_write_b128 v56, v[184:187] offset:8320
    s_nop 1
    ds_write_b128 v56, v[26:29] offset:12480
    ds_write_b128 v56, v[178:181] offset:16640
    v_mov_b32 v184, v27
    v_mov_b32 v185, v28
    v_mov_b32 v186, v29
    v_mov_b32 v187, v30
    ds_write_b128 v56, v[184:187] offset:20800
    s_nop 1
    v_mov_b32 v184, v179
    v_mov_b32 v185, v180
    v_mov_b32 v186, v181
    v_mov_b32 v187, v182
    ds_write_b128 v56, v[184:187] offset:24960
    s_nop 1
    ds_write_b128 v56, v[28:31] offset:29120
    ds_write_b128 v57, v[40:43]
    v_lshlrev_b32 v3, 16, v46
    v_or_b32 v3, v3, v46
    v_and_b32 v188, v60, v3
    v_and_b32 v189, v61, v3
    v_and_b32 v190, v62, v3
    v_and_b32 v191, v63, v3
    v_and_b32 v192, v64, v3
    v_and_b32 v193, v65, v3
    v_and_b32 v194, v66, v3
    v_and_b32 v195, v67, v3
    s_waitcnt lgkmcnt(0)
    s_barrier
    s_bitcmp1_b32 s2, 0
    s_cbranch_scc1 c_halfL_26
    s_cmp_lg_u32 s34, 0
    s_cbranch_scc1 c_pw_29
    ds_read_b128 v[104:107], v58 offset:0
    ds_read_b128 v[152:155], v59 offset:5152
    ds_read_b128 v[108:111], v58 offset:32
    ds_read_b128 v[156:159], v59 offset:5120
    ds_read_b128 v[112:115], v58 offset:64
    ds_read_b128 v[160:163], v59 offset:5072
    ds_read_b128 v[116:119], v58 offset:96
    ds_read_b128 v[164:167], v59 offset:5040
    ds_read_b128 v[120:123], v58 offset:128
    ds_read_b128 v[168:171], v59 offset:4992
    s_waitcnt lgkmcnt(8)
    v_mfma_f32_32x32x16_bf16 v[88:103], v[104:107], v[152:155], 0
    v_mfma_f32_32x32x16_bf16 v[88:103], v[192:195], v[152:155], v[88:103]
    ds_read_b128 v[124:127], v58 offset:160
    ds_read_b128 v[172:175], v59 offset:4960
    s_waitcnt lgkmcnt(8)
    v_mfma_f32_32x32x16_bf16 v[88:103], v[108:111], v[156:159], v[88:103]
    v_mfma_f32_32x32x16_bf16 v[88:103], v[188:191], v[156:159], v[88:103]
    ds_read_b128 v[104:107], v58 offset:192
    ds_read_b128 v[152:155], v59 offset:4912
    s_waitcnt lgkmcnt(8)
    v_mfma_f32_32x32x16_bf16 v[88:103], v[112:115], v[160:163], v[88:103]
    ds_read_b128 v[108:111], v58 offset:224
    ds_read_b128 v[156:159], v59 offset:4880
    s_waitcnt lgkmcnt(8)
    v_mfma_f32_32x32x16_bf16 v[88:103], v[116:119], v[164:167], v[88:103]
    ds_read_b128 v[112:115], v58 offset:256
    ds_read_b128 v[160:163], v59 offset:4832
    s_waitcnt lgkmcnt(8)
    v_mfma_f32_32x32x16_bf16 v[88:103], v[120:123], v[168:171], v[88:103]
    ds_read_b128 v[116:119], v58 offset:288
    ds_read_b128 v[164:167], v59 offset:4800
    s_waitcnt lgkmcnt(8)
    v_mfma_f32_32x32x16_bf16 v[88:103], v[124:127], v[172:175], v[88:103]
    ds_read_b128 v[120:123], v58 offset:320
    ds_read_b128 v[168:171], v59 offset:4752
    s_waitcnt lgkmcnt(8)
    v_mfma_f32_32x32x16_bf16 v[88:103], v[104:107], v[152:155], v[88:103]
    ds_read_b128 v[124:127], v58 offset:352
    ds_read_b128 v[172:175], v59 offset:4720
    s_waitcnt lgkmcnt(8)
    v_mfma_f32_32x32x16_bf16 v[88:103], v[108:111], v[156:159], v[88:103]
    ds_read_b128 v[104:107], v58 offset:384
    ds_read_b128 v[152:155], v59 offset:4672
    s_waitcnt lgkmcnt(8)
    v_mfma_f32_32x32x16_bf16 v[88:103], v[112:115], v[160:163], v[88:103]
    ds_read_b128 v[108:111], v58 offset:416
    ds_read_b128 v[156:159], v59 offset:4640
    s_waitcnt lgkmcnt(8)
    v_mfma_f32_32x32x16_bf16 v[88:103], v[116:119], v[164:167], v[88:103]
    ds_read_b128 v[112:115], v58 offset:448
    ds_read_b128 v[160:163], v59 offset:4592
    s_waitcnt lgkmcnt(8)
    v_mfma_f32_32x32x16_bf16 v[88:103], v[120:123], v[168:171], v[88:103]
    ds_read_b128 v[116:119], v58 offset:480
    ds_read_b128 v[164:167], v59 offset:4560
    s_waitcnt lgkmcnt(8)
    v_mfma_f32_32x32x16_bf16 v[88:103], v[124:127], v[172:175], v[88:103]
    ds_read_b128 v[120:123], v58 offset:512
    ds_read_b128 v[168:171], v59 offset:4512
    s_waitcnt lgkmcnt(8)
    v_mfma_f32_32x32x16_bf16 v[88:103], v[104:107], v[152:155], v[88:103]
    ds_read_b128 v[124:127], v58 offset:544
    ds_read_b128 v[172:175], v59 offset:4480
    s_waitcnt lgkmcnt(8)
    v_mfma_f32_32x32x16_bf16 v[88:103], v[108:111], v[156:159], v[88:103]
    ds_read_b128 v[104:107], v58 offset:576
    ds_read_b128 v[152:155], v59 offset:4432
    s_waitcnt lgkmcnt(8)
    v_mfma_f32_32x32x16_bf16 v[88:103], v[112:115], v[160:163], v[88:103]
    ds_read_b128 v[108:111], v58 offset:608
    ds_read_b128 v[156:159], v59 offset:4400
    s_waitcnt lgkmcnt(8)
    v_mfma_f32_32x32x16_bf16 v[88:103], v[116:119], v[164:167], v[88:103]
    ds_read_b128 v[112:115], v58 offset:640
    ds_read_b128 v[160:163], v59 offset:4352
    s_waitcnt lgkmcnt(8)
    v_mfma_f32_32x32x16_bf16 v[88:103], v[120:123], v[168:171], v[88:103]
    ds_read_b128 v[116:119], v58 offset:672
    ds_read_b128 v[164:167], v59 offset:4320
    s_waitcnt lgkmcnt(8)
    v_mfma_f32_32x32x16_bf16 v[88:103], v[124:127], v[172:175], v[88:103]
    ds_read_b128 v[120:123], v58 offset:704
    ds_read_b128 v[168:171], v59 offset:4272
    s_waitcnt lgkmcnt(8)
    v_mfma_f32_32x32x16_bf16 v[88:103], v[104:107], v[152:155], v[88:103]
    ds_read_b128 v[124:127], v58 offset:736
    ds_read_b128 v[172:175], v59 offset:4240
    s_waitcnt lgkmcnt(8)
    v_mfma_f32_32x32x16_bf16 v[88:103], v[108:111], v[156:159], v[88:103]
    ds_read_b128 v[104:107], v58 offset:768
    ds_read_b128 v[152:155], v59 offset:4192
    s_waitcnt lgkmcnt(8)
    v_mfma_f32_32x32x16_bf16 v[88:103], v[112:115], v[160:163], v[88:103]
    ds_read_b128 v[108:111], v58 offset:800
    ds_read_b128 v[156:159], v59 offset:4160
    s_waitcnt lgkmcnt(8)
    v_mfma_f32_32x32x16_bf16 v[88:103], v[116:119], v[164:167], v[88:103]
    ds_read_b128 v[112:115], v58 offset:832
    ds_read_b128 v[160:163], v59 offset:4112
    s_waitcnt lgkmcnt(8)
    v_mfma_f32_32x32x16_bf16 v[88:103], v[120:123], v[168:171], v[88:103]
    ds_read_b128 v[116:119], v58 offset:864
    ds_read_b128 v[164:167], v59 offset:4080
    s_waitcnt lgkmcnt(8)
    v_mfma_f32_32x32x16_bf16 v[88:103], v[124:127], v[172:175], v[88:103]
    ds_read_b128 v[120:123], v58 offset:896
    ds_read_b128 v[168:171], v59 offset:4032
    s_waitcnt lgkmcnt(8)
    v_mfma_f32_32x32x16_bf16 v[88:103], v[104:107], v[152:155], v[88:103]
    ds_read_b128 v[124:127], v58 offset:928
    ds_read_b128 v[172:175], v59 offset:4000
    s_waitcnt lgkmcnt(8)
    v_mfma_f32_32x32x16_bf16 v[88:103], v[108:111], v[156:159], v[88:103]
    ds_read_b128 v[104:107], v58 offset:960
    ds_read_b128 v[152:155], v59 offset:3952
    s_waitcnt lgkmcnt(8)
    v_mfma_f32_32x32x16_bf16 v[88:103], v[112:115], v[160:163], v[88:103]
    ds_read_b128 v[108:111], v58 offset:992
    ds_read_b128 v[156:159], v59 offset:3920
    s_waitcnt lgkmcnt(8)
    v_mfma_f32_32x32x16_bf16 v[88:103], v[116:119], v[164:167], v[88:103]
    s_waitcnt lgkmcnt(6)
    v_mfma_f32_32x32x16_bf16 v[88:103], v[120:123], v[168:171], v[88:103]
    s_waitcnt lgkmcnt(4)
    v_mfma_f32_32x32x16_bf16 v[88:103], v[124:127], v[172:175], v[88:103]
    s_waitcnt lgkmcnt(2)
    v_mfma_f32_32x32x16_bf16 v[88:103], v[104:107], v[152:155], v[88:103]
    s_waitcnt lgkmcnt(0)
    v_mfma_f32_32x32x16_bf16 v[88:103], v[108:111], v[156:159], v[88:103]
    s_nop 11
    ds_write_b128 v70, v[88:91] offset:13824
    ds_write_b128 v70, v[92:95] offset:13856
    ds_write_b128 v70, v[96:99] offset:13888
    ds_write_b128 v70, v[100:103] offset:13920
    s_branch c_pw_end_28
c_pw_29:
    s_cmp_lg_u32 s34, 1
    s_cbranch_scc1 c_pw_30
    ds_read_b128 v[104:107], v58 offset:1024
    ds_read_b128 v[152:155], v59 offset:3872
    ds_read_b128 v[108:111], v58 offset:1056
    ds_read_b128 v[156:159], v59 offset:3840
    ds_read_b128 v[112:115], v58 offset:1088
    ds_read_b128 v[160:163], v59 offset:3792
    ds_read_b128 v[116:119], v58 offset:1120
    ds_read_b128 v[164:167], v59 offset:3760
    ds_read_b128 v[120:123], v58 offset:1152
    ds_read_b128 v[168:171], v59 offset:3712
    s_waitcnt lgkmcnt(8)
    v_mfma_f32_32x32x16_bf16 v[88:103], v[104:107], v[152:155], 0
    ds_read_b128 v[124:127], v58 offset:1184
    ds_read_b128 v[172:175], v59 offset:3680
    s_waitcnt lgkmcnt(8)
    v_mfma_f32_32x32x16_bf16 v[88:103], v[108:111], v[156:159], v[88:103]
    ds_read_b128 v[104:107], v58 offset:1216
    ds_read_b128 v[152:155], v59 offset:3632
    s_waitcnt lgkmcnt(8)
    v_mfma_f32_32x32x16_bf16 v[88:103], v[112:115], v[160:163], v[88:103]
    ds_read_b128 v[108:111], v58 offset:1248
    ds_read_b128 v[156:159], v59 offset:3600
    s_waitcnt lgkmcnt(8)
    v_mfma_f32_32x32x16_bf16 v[88:103], v[116:119], v[164:167], v[88:103]
    ds_read_b128 v[112:115], v58 offset:1280
    ds_read_b128 v[160:163], v59 offset:3552
    s_waitcnt lgkmcnt(8)
    v_mfma_f32_32x32x16_bf16 v[88:103], v[120:123], v[168:171], v[88:103]
    ds_read_b128 v[116:119], v58 offset:1312
    ds_read_b128 v[164:167], v59 offset:3520
    s_waitcnt lgkmcnt(8)
    v_mfma_f32_32x32x16_bf16 v[88:103], v[124:127], v[172:175], v[88:103]
    ds_read_b128 v[120:123], v58 offset:1344
    ds_read_b128 v[168:171], v59 offset:3472
    s_waitcnt lgkmcnt(8)
    v_mfma_f32_32x32x16_bf16 v[88:103], v[104:107], v[152:155], v[88:103]
    ds_read_b128 v[124:127], v58 offset:1376
    ds_read_b128 v[172:175], v59 offset:3440
    s_waitcnt lgkmcnt(8)
    v_mfma_f32_32x32x16_bf16 v[88:103], v[108:111], v[156:159], v[88:103]
    ds_read_b128 v[104:107], v58 offset:1408
    ds_read_b128 v[152:155], v59 offset:3392
    s_waitcnt lgkmcnt(8)
    v_mfma_f32_32x32x16_bf16 v[88:103], v[112:115], v[160:163], v[88:103]
    ds_read_b128 v[108:111], v58 offset:1440
    ds_read_b128 v[156:159], v59 offset:3360
    s_waitcnt lgkmcnt(8)
    v_mfma_f32_32x32x16_bf16 v[88:103], v[116:119], v[164:167], v[88:103]
    ds_read_b128 v[112:115], v58 offset:1472
    ds_read_b128 v[160:163], v59 offset:3312
    s_waitcnt lgkmcnt(8)
    v_mfma_f32_32x32x16_bf16 v[88:103], v[120:123], v[168:171], v[88:103]
    ds_read_b128 v[116:119], v58 offset:1504
    ds_read_b128 v[164:167], v59 offset:3280
    s_waitcnt lgkmcnt(8)
    v_mfma_f32_32x32x16_bf16 v[88:103], v[124:127], v[172:175], v[88:103]
    ds_read_b128 v[120:123], v58 offset:1536
    ds_read_b128 v[168:171], v59 offset:3232
    s_waitcnt lgkmcnt(8)
    v_mfma_f32_32x32x16_bf16 v[88:103], v[104:107], v[152:155], v[88:103]
    ds_read_b128 v[124:127], v58 offset:1568
    ds_read_b128 v[172:175], v59 offset:3200
    s_waitcnt lgkmcnt(8)
    v_mfma_f32_32x32x16_bf16 v[88:103], v[108:111], v[156:159], v[88:103]
    ds_read_b128 v[104:107], v58 offset:1600
    ds_read_b128 v[152:155], v59 offset:3152
    s_waitcnt lgkmcnt(8)
    v_mfma_f32_32x32x16_bf16 v[88:103], v[112:115], v[160:163], v[88:103]
    ds_read_b128 v[108:111], v58 offset:1632
    ds_read_b128 v[156:159], v59 offset:3120
    s_waitcnt lgkmcnt(8)
    v_mfma_f32_32x32x16_bf16 v[88:103], v[116:119], v[164:167], v[88:103]
    ds_read_b128 v[112:115], v58 offset:1664
    ds_read_b128 v[160:163], v59 offset:3072
    s_waitcnt lgkmcnt(8)
    v_mfma_f32_32x32x16_bf16 v[88:103], v[120:123], v[168:171], v[88:103]
    ds_read_b128 v[116:119], v58 offset:1696
    ds_read_b128 v[164:167], v59 offset:3040
    s_waitcnt lgkmcnt(8)
    v_mfma_f32_32x32x16_bf16 v[88:103], v[124:127], v[172:175], v[88:103]
    ds_read_b128 v[120:123], v58 offset:1728
    ds_read_b128 v[168:171], v59 offset:2992
    s_waitcnt lgkmcnt(8)
    v_mfma_f32_32x32x16_bf16 v[88:103], v[104:107], v[152:155], v[88:103]
    ds_read_b128 v[124:127], v58 offset:1760
    ds_read_b128 v[172:175], v59 offset:2960
    s_waitcnt lgkmcnt(8)
    v_mfma_f32_32x32x16_bf16 v[88:103], v[108:111], v[156:159], v[88:103]
    ds_read_b128 v[104:107], v58 offset:1792
    ds_read_b128 v[152:155], v59 offset:2912
    s_waitcnt lgkmcnt(8)
    v_mfma_f32_32x32x16_bf16 v[88:103], v[112:115], v[160:163], v[88:103]
    ds_read_b128 v[108:111], v58 offset:1824
    ds_read_b128 v[156:159], v59 offset:2880
    s_waitcnt lgkmcnt(8)
    v_mfma_f32_32x32x16_bf16 v[88:103], v[116:119], v[164:167], v[88:103]
    ds_read_b128 v[112:115], v58 offset:1856
    ds_read_b128 v[160:163], v59 offset:2832
    s_waitcnt lgkmcnt(8)
    v_mfma_f32_32x32x16_bf16 v[88:103], v[120:123], v[168:171], v[88:103]
    ds_read_b128 v[116:119], v58 offset:1888
    ds_read_b128 v[164:167], v59 offset:2800
    s_waitcnt lgkmcnt(8)
    v_mfma_f32_32x32x16_bf16 v[88:103], v[124:127], v[172:175], v[88:103]
    ds_read_b128 v[120:123], v58 offset:1920
    ds_read_b128 v[168:171], v59 offset:2752
    s_waitcnt lgkmcnt(8)
    v_mfma_f32_32x32x16_bf16 v[88:103], v[104:107], v[152:155], v[88:103]
    ds_read_b128 v[124:127], v58 offset:1952
    ds_read_b128 v[172:175], v59 offset:2720
    s_waitcnt lgkmcnt(8)
    v_mfma_f32_32x32x16_bf16 v[88:103], v[108:111], v[156:159], v[88:103]
    ds_read_b128 v[104:107], v58 offset:1984
    ds_read_b128 v[152:155], v59 offset:2672
    s_waitcnt lgkmcnt(8)
    v_mfma_f32_32x32x16_bf16 v[88:103], v[112:115], v[160:163], v[88:103]
    ds_read_b128 v[108:111], v58 offset:2016
    ds_read_b128 v[156:159], v59 offset:2640
    s_waitcnt lgkmcnt(8)
    v_mfma_f32_32x32x16_bf16 v[88:103], v[116:119], v[164:167], v[88:103]
    s_waitcnt lgkmcnt(6)
    v_mfma_f32_32x32x16_bf16 v[88:103], v[120:123], v[168:171], v[88:103]
    s_waitcnt lgkmcnt(4)
    v_mfma_f32_32x32x16_bf16 v[88:103], v[124:127], v[172:175], v[88:103]
    s_waitcnt lgkmcnt(2)
    v_mfma_f32_32x32x16_bf16 v[88:103], v[104:107], v[152:155], v[88:103]
    s_waitcnt lgkmcnt(0)
    v_mfma_f32_32x32x16_bf16 v[88:103], v[108:111], v[156:159], v[88:103]
    s_nop 11
    ds_write_b128 v70, v[88:91] offset:18432
    ds_write_b128 v70, v[92:95] offset:18464
    ds_write_b128 v70, v[96:99] offset:18496
    ds_write_b128 v70, v[100:103] offset:18528
    s_branch c_pw_end_28
c_pw_30:
    s_cmp_lg_u32 s34, 2
    s_cbranch_scc1 c_pw_31
    ds_read_b128 v[104:107], v58 offset:2048
    ds_read_b128 v[152:155], v59 offset:2592
    ds_read_b128 v[108:111], v58 offset:2080
    ds_read_b128 v[156:159], v59 offset:2560
    ds_read_b128 v[112:115], v58 offset:2112
    ds_read_b128 v[160:163], v59 offset:2512
    ds_read_b128 v[116:119], v58 offset:2144
    ds_read_b128 v[164:167], v59 offset:2480
    ds_read_b128 v[120:123], v58 offset:2176
    ds_read_b128 v[168:171], v59 offset:2432
    s_waitcnt lgkmcnt(8)
    v_mfma_f32_32x32x16_bf16 v[88:103], v[104:107], v[152:155], 0
    ds_read_b128 v[124:127], v58 offset:2208
    ds_read_b128 v[172:175], v59 offset:2400
    s_waitcnt lgkmcnt(8)
    v_mfma_f32_32x32x16_bf16 v[88:103], v[108:111], v[156:159], v[88:103]
    ds_read_b128 v[104:107], v58 offset:2240
    ds_read_b128 v[152:155], v59 offset:2352
    s_waitcnt lgkmcnt(8)
    v_mfma_f32_32x32x16_bf16 v[88:103], v[112:115], v[160:163], v[88:103]
    ds_read_b128 v[108:111], v58 offset:2272
    ds_read_b128 v[156:159], v59 offset:2320
    s_waitcnt lgkmcnt(8)
    v_mfma_f32_32x32x16_bf16 v[88:103], v[116:119], v[164:167], v[88:103]
    ds_read_b128 v[112:115], v58 offset:2304
    ds_read_b128 v[160:163], v59 offset:2272
    s_waitcnt lgkmcnt(8)
    v_mfma_f32_32x32x16_bf16 v[88:103], v[120:123], v[168:171], v[88:103]
    ds_read_b128 v[116:119], v58 offset:2336
    ds_read_b128 v[164:167], v59 offset:2240
    s_waitcnt lgkmcnt(8)
    v_mfma_f32_32x32x16_bf16 v[88:103], v[124:127], v[172:175], v[88:103]
    ds_read_b128 v[120:123], v58 offset:2368
    ds_read_b128 v[168:171], v59 offset:2192
    s_waitcnt lgkmcnt(8)
    v_mfma_f32_32x32x16_bf16 v[88:103], v[104:107], v[152:155], v[88:103]
    ds_read_b128 v[124:127], v58 offset:2400
    ds_read_b128 v[172:175], v59 offset:2160
    s_waitcnt lgkmcnt(8)
    v_mfma_f32_32x32x16_bf16 v[88:103], v[108:111], v[156:159], v[88:103]
    ds_read_b128 v[104:107], v58 offset:2432
    ds_read_b128 v[152:155], v59 offset:2112
    s_waitcnt lgkmcnt(8)
    v_mfma_f32_32x32x16_bf16 v[88:103], v[112:115], v[160:163], v[88:103]
    ds_read_b128 v[108:111], v58 offset:2464
    ds_read_b128 v[156:159], v59 offset:2080
    s_waitcnt lgkmcnt(8)
    v_mfma_f32_32x32x16_bf16 v[88:103], v[116:119], v[164:167], v[88:103]
    ds_read_b128 v[112:115], v58 offset:2496
    ds_read_b128 v[160:163], v59 offset:2032
    s_waitcnt lgkmcnt(8)
    v_mfma_f32_32x32x16_bf16 v[88:103], v[120:123], v[168:171], v[88:103]
    ds_read_b128 v[116:119], v58 offset:2528
    ds_read_b128 v[164:167], v59 offset:2000
    s_waitcnt lgkmcnt(8)
    v_mfma_f32_32x32x16_bf16 v[88:103], v[124:127], v[172:175], v[88:103]
    ds_read_b128 v[120:123], v58 offset:2560
    ds_read_b128 v[168:171], v59 offset:1952
    s_waitcnt lgkmcnt(8)
    v_mfma_f32_32x32x16_bf16 v[88:103], v[104:107], v[152:155], v[88:103]
    ds_read_b128 v[124:127], v58 offset:2592
    ds_read_b128 v[172:175], v59 offset:1920
    s_waitcnt lgkmcnt(8)
    v_mfma_f32_32x32x16_bf16 v[88:103], v[108:111], v[156:159], v[88:103]
    ds_read_b128 v[104:107], v58 offset:2624
    ds_read_b128 v[152:155], v59 offset:1872
    s_waitcnt lgkmcnt(8)
    v_mfma_f32_32x32x16_bf16 v[88:103], v[112:115], v[160:163], v[88:103]
    ds_read_b128 v[108:111], v58 offset:2656
    ds_read_b128 v[156:159], v59 offset:1840
    s_waitcnt lgkmcnt(8)
    v_mfma_f32_32x32x16_bf16 v[88:103], v[116:119], v[164:167], v[88:103]
    ds_read_b128 v[112:115], v58 offset:2688
    ds_read_b128 v[160:163], v59 offset:1792
    s_waitcnt lgkmcnt(8)
    v_mfma_f32_32x32x16_bf16 v[88:103], v[120:123], v[168:171], v[88:103]
    ds_read_b128 v[116:119], v58 offset:2720
    ds_read_b128 v[164:167], v59 offset:1760
    s_waitcnt lgkmcnt(8)
    v_mfma_f32_32x32x16_bf16 v[88:103], v[124:127], v[172:175], v[88:103]
    ds_read_b128 v[120:123], v58 offset:2752
    ds_read_b128 v[168:171], v59 offset:1712
    s_waitcnt lgkmcnt(8)
    v_mfma_f32_32x32x16_bf16 v[88:103], v[104:107], v[152:155], v[88:103]
    ds_read_b128 v[124:127], v58 offset:2784
    ds_read_b128 v[172:175], v59 offset:1680
    s_waitcnt lgkmcnt(8)
    v_mfma_f32_32x32x16_bf16 v[88:103], v[108:111], v[156:159], v[88:103]
    ds_read_b128 v[104:107], v58 offset:2816
    ds_read_b128 v[152:155], v59 offset:1632
    s_waitcnt lgkmcnt(8)
    v_mfma_f32_32x32x16_bf16 v[88:103], v[112:115], v[160:163], v[88:103]
    ds_read_b128 v[108:111], v58 offset:2848
    ds_read_b128 v[156:159], v59 offset:1600
    s_waitcnt lgkmcnt(8)
    v_mfma_f32_32x32x16_bf16 v[88:103], v[116:119], v[164:167], v[88:103]
    ds_read_b128 v[112:115], v58 offset:2880
    ds_read_b128 v[160:163], v59 offset:1552
    s_waitcnt lgkmcnt(8)
    v_mfma_f32_32x32x16_bf16 v[88:103], v[120:123], v[168:171], v[88:103]
    ds_read_b128 v[116:119], v58 offset:2912
    ds_read_b128 v[164:167], v59 offset:1520
    s_waitcnt lgkmcnt(8)
    v_mfma_f32_32x32x16_bf16 v[88:103], v[124:127], v[172:175], v[88:103]
    ds_read_b128 v[120:123], v58 offset:2944
    ds_read_b128 v[168:171], v59 offset:1472
    s_waitcnt lgkmcnt(8)
    v_mfma_f32_32x32x16_bf16 v[88:103], v[104:107], v[152:155], v[88:103]
    ds_read_b128 v[124:127], v58 offset:2976
    ds_read_b128 v[172:175], v59 offset:1440
    s_waitcnt lgkmcnt(8)
    v_mfma_f32_32x32x16_bf16 v[88:103], v[108:111], v[156:159], v[88:103]
    ds_read_b128 v[104:107], v58 offset:3008
    ds_read_b128 v[152:155], v59 offset:1392
    s_waitcnt lgkmcnt(8)
    v_mfma_f32_32x32x16_bf16 v[88:103], v[112:115], v[160:163], v[88:103]
    ds_read_b128 v[108:111], v58 offset:3040
    ds_read_b128 v[156:159], v59 offset:1360
    s_waitcnt lgkmcnt(8)
    v_mfma_f32_32x32x16_bf16 v[88:103], v[116:119], v[164:167], v[88:103]
    s_waitcnt lgkmcnt(6)
    v_mfma_f32_32x32x16_bf16 v[88:103], v[120:123], v[168:171], v[88:103]
    s_waitcnt lgkmcnt(4)
    v_mfma_f32_32x32x16_bf16 v[88:103], v[124:127], v[172:175], v[88:103]
    s_waitcnt lgkmcnt(2)
    v_mfma_f32_32x32x16_bf16 v[88:103], v[104:107], v[152:155], v[88:103]
    s_waitcnt lgkmcnt(0)
    v_mfma_f32_32x32x16_bf16 v[88:103], v[108:111], v[156:159], v[88:103]
    s_nop 11
    ds_write_b128 v70, v[88:91] offset:23040
    ds_write_b128 v70, v[92:95] offset:23072
    ds_write_b128 v70, v[96:99] offset:23104
    ds_write_b128 v70, v[100:103] offset:23136
    s_branch c_pw_end_28
c_pw_31:
    ds_read_b128 v[104:107], v58 offset:3072
    ds_read_b128 v[152:155], v59 offset:1312
    ds_read_b128 v[108:111], v58 offset:3104
    ds_read_b128 v[156:159], v59 offset:1280
    ds_read_b128 v[112:115], v58 offset:3136
    ds_read_b128 v[160:163], v59 offset:1232
    ds_read_b128 v[116:119], v58 offset:3168
    ds_read_b128 v[164:167], v59 offset:1200
    ds_read_b128 v[120:123], v58 offset:3200
    ds_read_b128 v[168:171], v59 offset:1152
    s_waitcnt lgkmcnt(8)
    v_mfma_f32_32x32x16_bf16 v[88:103], v[104:107], v[152:155], 0
    ds_read_b128 v[124:127], v58 offset:3232
    ds_read_b128 v[172:175], v59 offset:1120
    s_waitcnt lgkmcnt(8)
    v_mfma_f32_32x32x16_bf16 v[88:103], v[108:111], v[156:159], v[88:103]
    ds_read_b128 v[104:107], v58 offset:3264
    ds_read_b128 v[152:155], v59 offset:1072
    s_waitcnt lgkmcnt(8)
    v_mfma_f32_32x32x16_bf16 v[88:103], v[112:115], v[160:163], v[88:103]
    ds_read_b128 v[108:111], v58 offset:3296
    ds_read_b128 v[156:159], v59 offset:1040
    s_waitcnt lgkmcnt(8)
    v_mfma_f32_32x32x16_bf16 v[88:103], v[116:119], v[164:167], v[88:103]
    ds_read_b128 v[112:115], v58 offset:3328
    ds_read_b128 v[160:163], v59 offset:992
    s_waitcnt lgkmcnt(8)
    v_mfma_f32_32x32x16_bf16 v[88:103], v[120:123], v[168:171], v[88:103]
    ds_read_b128 v[116:119], v58 offset:3360
    ds_read_b128 v[164:167], v59 offset:960
    s_waitcnt lgkmcnt(8)
    v_mfma_f32_32x32x16_bf16 v[88:103], v[124:127], v[172:175], v[88:103]
    ds_read_b128 v[120:123], v58 offset:3392
    ds_read_b128 v[168:171], v59 offset:912
    s_waitcnt lgkmcnt(8)
    v_mfma_f32_32x32x16_bf16 v[88:103], v[104:107], v[152:155], v[88:103]
    ds_read_b128 v[124:127], v58 offset:3424
    ds_read_b128 v[172:175], v59 offset:880
    s_waitcnt lgkmcnt(8)
    v_mfma_f32_32x32x16_bf16 v[88:103], v[108:111], v[156:159], v[88:103]
    ds_read_b128 v[104:107], v58 offset:3456
    ds_read_b128 v[152:155], v59 offset:832
    s_waitcnt lgkmcnt(8)
    v_mfma_f32_32x32x16_bf16 v[88:103], v[112:115], v[160:163], v[88:103]
    ds_read_b128 v[108:111], v58 offset:3488
    ds_read_b128 v[156:159], v59 offset:800
    s_waitcnt lgkmcnt(8)
    v_mfma_f32_32x32x16_bf16 v[88:103], v[116:119], v[164:167], v[88:103]
    ds_read_b128 v[112:115], v58 offset:3520
    ds_read_b128 v[160:163], v59 offset:752
    s_waitcnt lgkmcnt(8)
    v_mfma_f32_32x32x16_bf16 v[88:103], v[120:123], v[168:171], v[88:103]
    ds_read_b128 v[116:119], v58 offset:3552
    ds_read_b128 v[164:167], v59 offset:720
    s_waitcnt lgkmcnt(8)
    v_mfma_f32_32x32x16_bf16 v[88:103], v[124:127], v[172:175], v[88:103]
    ds_read_b128 v[120:123], v58 offset:3584
    ds_read_b128 v[168:171], v59 offset:672
    s_waitcnt lgkmcnt(8)
    v_mfma_f32_32x32x16_bf16 v[88:103], v[104:107], v[152:155], v[88:103]
    ds_read_b128 v[124:127], v58 offset:3616
    ds_read_b128 v[172:175], v59 offset:640
    s_waitcnt lgkmcnt(8)
    v_mfma_f32_32x32x16_bf16 v[88:103], v[108:111], v[156:159], v[88:103]
    ds_read_b128 v[104:107], v58 offset:3648
    ds_read_b128 v[152:155], v59 offset:592
    s_waitcnt lgkmcnt(8)
    v_mfma_f32_32x32x16_bf16 v[88:103], v[112:115], v[160:163], v[88:103]
    ds_read_b128 v[108:111], v58 offset:3680
    ds_read_b128 v[156:159], v59 offset:560
    s_waitcnt lgkmcnt(8)
    v_mfma_f32_32x32x16_bf16 v[88:103], v[116:119], v[164:167], v[88:103]
    ds_read_b128 v[112:115], v58 offset:3712
    ds_read_b128 v[160:163], v59 offset:512
    s_waitcnt lgkmcnt(8)
    v_mfma_f32_32x32x16_bf16 v[88:103], v[120:123], v[168:171], v[88:103]
    ds_read_b128 v[116:119], v58 offset:3744
    ds_read_b128 v[164:167], v59 offset:480
    s_waitcnt lgkmcnt(8)
    v_mfma_f32_32x32x16_bf16 v[88:103], v[124:127], v[172:175], v[88:103]
    ds_read_b128 v[120:123], v58 offset:3776
    ds_read_b128 v[168:171], v59 offset:432
    s_waitcnt lgkmcnt(8)
    v_mfma_f32_32x32x16_bf16 v[88:103], v[104:107], v[152:155], v[88:103]
    ds_read_b128 v[124:127], v58 offset:3808
    ds_read_b128 v[172:175], v59 offset:400
    s_waitcnt lgkmcnt(8)
    v_mfma_f32_32x32x16_bf16 v[88:103], v[108:111], v[156:159], v[88:103]
    ds_read_b128 v[104:107], v58 offset:3840
    ds_read_b128 v[152:155], v59 offset:352
    s_waitcnt lgkmcnt(8)
    v_mfma_f32_32x32x16_bf16 v[88:103], v[112:115], v[160:163], v[88:103]
    ds_read_b128 v[108:111], v58 offset:3872
    ds_read_b128 v[156:159], v59 offset:320
    s_waitcnt lgkmcnt(8)
    v_mfma_f32_32x32x16_bf16 v[88:103], v[116:119], v[164:167], v[88:103]
    ds_read_b128 v[112:115], v58 offset:3904
    ds_read_b128 v[160:163], v59 offset:272
    s_waitcnt lgkmcnt(8)
    v_mfma_f32_32x32x16_bf16 v[88:103], v[120:123], v[168:171], v[88:103]
    ds_read_b128 v[116:119], v58 offset:3936
    ds_read_b128 v[164:167], v59 offset:240
    s_waitcnt lgkmcnt(8)
    v_mfma_f32_32x32x16_bf16 v[88:103], v[124:127], v[172:175], v[88:103]
    ds_read_b128 v[120:123], v58 offset:3968
    ds_read_b128 v[168:171], v59 offset:192
    s_waitcnt lgkmcnt(8)
    v_mfma_f32_32x32x16_bf16 v[88:103], v[104:107], v[152:155], v[88:103]
    ds_read_b128 v[124:127], v58 offset:4000
    ds_read_b128 v[172:175], v59 offset:160
    s_waitcnt lgkmcnt(8)
    v_mfma_f32_32x32x16_bf16 v[88:103], v[108:111], v[156:159], v[88:103]
    ds_read_b128 v[104:107], v58 offset:4032
    ds_read_b128 v[152:155], v59 offset:112
    s_waitcnt lgkmcnt(8)
    v_mfma_f32_32x32x16_bf16 v[88:103], v[112:115], v[160:163], v[88:103]
    ds_read_b128 v[108:111], v58 offset:4064
    ds_read_b128 v[156:159], v59 offset:80
    s_waitcnt lgkmcnt(8)
    v_mfma_f32_32x32x16_bf16 v[88:103], v[116:119], v[164:167], v[88:103]
    s_waitcnt lgkmcnt(6)
    v_mfma_f32_32x32x16_bf16 v[88:103], v[120:123], v[168:171], v[88:103]
    s_waitcnt lgkmcnt(4)
    v_mfma_f32_32x32x16_bf16 v[88:103], v[124:127], v[172:175], v[88:103]
    s_waitcnt lgkmcnt(2)
    v_mfma_f32_32x32x16_bf16 v[88:103], v[104:107], v[152:155], v[88:103]
    s_waitcnt lgkmcnt(0)
    v_mfma_f32_32x32x16_bf16 v[88:103], v[108:111], v[156:159], v[88:103]
    s_nop 11
    ds_write_b128 v70, v[88:91] offset:27648
    ds_write_b128 v70, v[92:95] offset:27680
    ds_write_b128 v70, v[96:99] offset:27712
    ds_write_b128 v70, v[100:103] offset:27744
c_pw_end_28:
    s_waitcnt lgkmcnt(0)
    s_barrier
    s_cmp_ge_u32 s34, 2
    s_cbranch_scc1 c_hf_33
    ds_read_b128 v[104:107], v71 offset:13824
    ds_read_b128 v[108:111], v71 offset:13840
    ds_read_b128 v[112:115], v71 offset:18432
    ds_read_b128 v[116:119], v71 offset:18448
    ds_read_b128 v[120:123], v71 offset:23040
    ds_read_b128 v[124:127], v71 offset:23056
    ds_read_b128 v[128:131], v71 offset:27648
    ds_read_b128 v[132:135], v71 offset:27664
    s_waitcnt lgkmcnt(0)
    v_pk_add_f32 v[104:105], v[104:105], v[112:113]
    v_pk_add_f32 v[106:107], v[106:107], v[114:115]
    v_pk_add_f32 v[108:109], v[108:109], v[116:117]
    v_pk_add_f32 v[110:111], v[110:111], v[118:119]
    v_pk_add_f32 v[104:105], v[104:105], v[120:121]
    v_pk_add_f32 v[106:107], v[106:107], v[122:123]
    v_pk_add_f32 v[108:109], v[108:109], v[124:125]
    v_pk_add_f32 v[110:111], v[110:111], v[126:127]
    v_pk_add_f32 v[104:105], v[104:105], v[128:129]
    v_pk_add_f32 v[106:107], v[106:107], v[130:131]
    v_pk_add_f32 v[108:109], v[108:109], v[132:133]
    v_pk_add_f32 v[110:111], v[110:111], v[134:135]
    v_cvt_pk_bf16_f32 v184, v104, v105
    v_cvt_pk_bf16_f32 v185, v106, v107
    v_cvt_pk_bf16_f32 v186, v108, v109
    v_cvt_pk_bf16_f32 v187, v110, v111
    s_lshl_b32 s40, s58, 12
    s_add_u32 s40, s40, 8914944
    v_and_b32 v3, 127, v0
    v_lshlrev_b32 v3, 4, v3
    buffer_store_dwordx4 v[184:187], v3, s[8:11], s40 offen
    s_nop 1
c_hf_33:
    s_branch c_halfE_27
c_halfL_26:
    s_cmp_lg_u32 s34, 0
    s_cbranch_scc1 c_pw_35
    ds_read_b128 v[104:107], v58 offset:0
    ds_read_b128 v[128:131], v59 offset:2592
    ds_read_b128 v[108:111], v58 offset:32
    ds_read_b128 v[132:135], v59 offset:2560
    ds_read_b128 v[112:115], v58 offset:64
    ds_read_b128 v[136:139], v59 offset:2512
    ds_read_b128 v[116:119], v58 offset:96
    ds_read_b128 v[140:143], v59 offset:2480
    ds_read_b128 v[120:123], v58 offset:128
    ds_read_b128 v[144:147], v59 offset:2432
    s_waitcnt lgkmcnt(8)
    v_mfma_f32_32x32x16_bf16 v[72:87], v[104:107], v[128:131], 0
    v_mfma_f32_32x32x16_bf16 v[72:87], v[192:195], v[128:131], v[72:87]
    ds_read_b128 v[124:127], v58 offset:160
    ds_read_b128 v[148:151], v59 offset:2400
    s_waitcnt lgkmcnt(8)
    v_mfma_f32_32x32x16_bf16 v[72:87], v[108:111], v[132:135], v[72:87]
    v_mfma_f32_32x32x16_bf16 v[72:87], v[188:191], v[132:135], v[72:87]
    ds_read_b128 v[104:107], v58 offset:192
    ds_read_b128 v[128:131], v59 offset:2352
    s_waitcnt lgkmcnt(8)
    v_mfma_f32_32x32x16_bf16 v[72:87], v[112:115], v[136:139], v[72:87]
    ds_read_b128 v[108:111], v58 offset:224
    ds_read_b128 v[132:135], v59 offset:2320
    s_waitcnt lgkmcnt(8)
    v_mfma_f32_32x32x16_bf16 v[72:87], v[116:119], v[140:143], v[72:87]
    ds_read_b128 v[112:115], v58 offset:256
    ds_read_b128 v[136:139], v59 offset:2272
    s_waitcnt lgkmcnt(8)
    v_mfma_f32_32x32x16_bf16 v[72:87], v[120:123], v[144:147], v[72:87]
    ds_read_b128 v[116:119], v58 offset:288
    ds_read_b128 v[140:143], v59 offset:2240
    s_waitcnt lgkmcnt(8)
    v_mfma_f32_32x32x16_bf16 v[72:87], v[124:127], v[148:151], v[72:87]
    ds_read_b128 v[120:123], v58 offset:320
    ds_read_b128 v[144:147], v59 offset:2192
    s_waitcnt lgkmcnt(8)
    v_mfma_f32_32x32x16_bf16 v[72:87], v[104:107], v[128:131], v[72:87]
    ds_read_b128 v[124:127], v58 offset:352
    ds_read_b128 v[148:151], v59 offset:2160
    s_waitcnt lgkmcnt(8)
    v_mfma_f32_32x32x16_bf16 v[72:87], v[108:111], v[132:135], v[72:87]
    ds_read_b128 v[104:107], v58 offset:384
    ds_read_b128 v[128:131], v59 offset:2112
    s_waitcnt lgkmcnt(8)
    v_mfma_f32_32x32x16_bf16 v[72:87], v[112:115], v[136:139], v[72:87]
    ds_read_b128 v[108:111], v58 offset:416
    ds_read_b128 v[132:135], v59 offset:2080
    s_waitcnt lgkmcnt(8)
    v_mfma_f32_32x32x16_bf16 v[72:87], v[116:119], v[140:143], v[72:87]
    ds_read_b128 v[112:115], v58 offset:448
    ds_read_b128 v[136:139], v59 offset:2032
    s_waitcnt lgkmcnt(8)
    v_mfma_f32_32x32x16_bf16 v[72:87], v[120:123], v[144:147], v[72:87]
    ds_read_b128 v[116:119], v58 offset:480
    ds_read_b128 v[140:143], v59 offset:2000
    s_waitcnt lgkmcnt(8)
    v_mfma_f32_32x32x16_bf16 v[72:87], v[124:127], v[148:151], v[72:87]
    s_waitcnt lgkmcnt(6)
    v_mfma_f32_32x32x16_bf16 v[72:87], v[104:107], v[128:131], v[72:87]
    s_waitcnt lgkmcnt(4)
    v_mfma_f32_32x32x16_bf16 v[72:87], v[108:111], v[132:135], v[72:87]
    s_waitcnt lgkmcnt(2)
    v_mfma_f32_32x32x16_bf16 v[72:87], v[112:115], v[136:139], v[72:87]
    s_waitcnt lgkmcnt(0)
    v_mfma_f32_32x32x16_bf16 v[72:87], v[116:119], v[140:143], v[72:87]
    s_nop 11
    ds_write_b128 v70, v[72:75] offset:13824
    ds_write_b128 v70, v[76:79] offset:13856
    ds_write_b128 v70, v[80:83] offset:13888
    ds_write_b128 v70, v[84:87] offset:13920
    s_branch c_pw_end_34
c_pw_35:
    s_cmp_lg_u32 s34, 1
    s_cbranch_scc1 c_pw_36
    ds_read_b128 v[104:107], v58 offset:512
    ds_read_b128 v[128:131], v59 offset:1952
    ds_read_b128 v[108:111], v58 offset:544
    ds_read_b128 v[132:135], v59 offset:1920
    ds_read_b128 v[112:115], v58 offset:576
    ds_read_b128 v[136:139], v59 offset:1872
    ds_read_b128 v[116:119], v58 offset:608
    ds_read_b128 v[140:143], v59 offset:1840
    ds_read_b128 v[120:123], v58 offset:640
    ds_read_b128 v[144:147], v59 offset:1792
    s_waitcnt lgkmcnt(8)
    v_mfma_f32_32x32x16_bf16 v[72:87], v[104:107], v[128:131], 0
    ds_read_b128 v[124:127], v58 offset:672
    ds_read_b128 v[148:151], v59 offset:1760
    s_waitcnt lgkmcnt(8)
    v_mfma_f32_32x32x16_bf16 v[72:87], v[108:111], v[132:135], v[72:87]
    ds_read_b128 v[104:107], v58 offset:704
    ds_read_b128 v[128:131], v59 offset:1712
    s_waitcnt lgkmcnt(8)
    v_mfma_f32_32x32x16_bf16 v[72:87], v[112:115], v[136:139], v[72:87]
    ds_read_b128 v[108:111], v58 offset:736
    ds_read_b128 v[132:135], v59 offset:1680
    s_waitcnt lgkmcnt(8)
    v_mfma_f32_32x32x16_bf16 v[72:87], v[116:119], v[140:143], v[72:87]
    ds_read_b128 v[112:115], v58 offset:768
    ds_read_b128 v[136:139], v59 offset:1632
    s_waitcnt lgkmcnt(8)
    v_mfma_f32_32x32x16_bf16 v[72:87], v[120:123], v[144:147], v[72:87]
    ds_read_b128 v[116:119], v58 offset:800
    ds_read_b128 v[140:143], v59 offset:1600
    s_waitcnt lgkmcnt(8)
    v_mfma_f32_32x32x16_bf16 v[72:87], v[124:127], v[148:151], v[72:87]
    ds_read_b128 v[120:123], v58 offset:832
    ds_read_b128 v[144:147], v59 offset:1552
    s_waitcnt lgkmcnt(8)
    v_mfma_f32_32x32x16_bf16 v[72:87], v[104:107], v[128:131], v[72:87]
    ds_read_b128 v[124:127], v58 offset:864
    ds_read_b128 v[148:151], v59 offset:1520
    s_waitcnt lgkmcnt(8)
    v_mfma_f32_32x32x16_bf16 v[72:87], v[108:111], v[132:135], v[72:87]
    ds_read_b128 v[104:107], v58 offset:896
    ds_read_b128 v[128:131], v59 offset:1472
    s_waitcnt lgkmcnt(8)
    v_mfma_f32_32x32x16_bf16 v[72:87], v[112:115], v[136:139], v[72:87]
    ds_read_b128 v[108:111], v58 offset:928
    ds_read_b128 v[132:135], v59 offset:1440
    s_waitcnt lgkmcnt(8)
    v_mfma_f32_32x32x16_bf16 v[72:87], v[116:119], v[140:143], v[72:87]
    ds_read_b128 v[112:115], v58 offset:960
    ds_read_b128 v[136:139], v59 offset:1392
    s_waitcnt lgkmcnt(8)
    v_mfma_f32_32x32x16_bf16 v[72:87], v[120:123], v[144:147], v[72:87]
    ds_read_b128 v[116:119], v58 offset:992
    ds_read_b128 v[140:143], v59 offset:1360
    s_waitcnt lgkmcnt(8)
    v_mfma_f32_32x32x16_bf16 v[72:87], v[124:127], v[148:151], v[72:87]
    s_waitcnt lgkmcnt(6)
    v_mfma_f32_32x32x16_bf16 v[72:87], v[104:107], v[128:131], v[72:87]
    s_waitcnt lgkmcnt(4)
    v_mfma_f32_32x32x16_bf16 v[72:87], v[108:111], v[132:135], v[72:87]
    s_waitcnt lgkmcnt(2)
    v_mfma_f32_32x32x16_bf16 v[72:87], v[112:115], v[136:139], v[72:87]
    s_waitcnt lgkmcnt(0)
    v_mfma_f32_32x32x16_bf16 v[72:87], v[116:119], v[140:143], v[72:87]
    s_nop 11
    ds_write_b128 v70, v[72:75] offset:18432
    ds_write_b128 v70, v[76:79] offset:18464
    ds_write_b128 v70, v[80:83] offset:18496
    ds_write_b128 v70, v[84:87] offset:18528
    s_branch c_pw_end_34
c_pw_36:
    s_cmp_lg_u32 s34, 2
    s_cbranch_scc1 c_pw_37
    ds_read_b128 v[104:107], v58 offset:1024
    ds_read_b128 v[128:131], v59 offset:1312
    ds_read_b128 v[108:111], v58 offset:1056
    ds_read_b128 v[132:135], v59 offset:1280
    ds_read_b128 v[112:115], v58 offset:1088
    ds_read_b128 v[136:139], v59 offset:1232
    ds_read_b128 v[116:119], v58 offset:1120
    ds_read_b128 v[140:143], v59 offset:1200
    ds_read_b128 v[120:123], v58 offset:1152
    ds_read_b128 v[144:147], v59 offset:1152
    s_waitcnt lgkmcnt(8)
    v_mfma_f32_32x32x16_bf16 v[72:87], v[104:107], v[128:131], 0
    ds_read_b128 v[124:127], v58 offset:1184
    ds_read_b128 v[148:151], v59 offset:1120
    s_waitcnt lgkmcnt(8)
    v_mfma_f32_32x32x16_bf16 v[72:87], v[108:111], v[132:135], v[72:87]
    ds_read_b128 v[104:107], v58 offset:1216
    ds_read_b128 v[128:131], v59 offset:1072
    s_waitcnt lgkmcnt(8)
    v_mfma_f32_32x32x16_bf16 v[72:87], v[112:115], v[136:139], v[72:87]
    ds_read_b128 v[108:111], v58 offset:1248
    ds_read_b128 v[132:135], v59 offset:1040
    s_waitcnt lgkmcnt(8)
    v_mfma_f32_32x32x16_bf16 v[72:87], v[116:119], v[140:143], v[72:87]
    ds_read_b128 v[112:115], v58 offset:1280
    ds_read_b128 v[136:139], v59 offset:992
    s_waitcnt lgkmcnt(8)
    v_mfma_f32_32x32x16_bf16 v[72:87], v[120:123], v[144:147], v[72:87]
    ds_read_b128 v[116:119], v58 offset:1312
    ds_read_b128 v[140:143], v59 offset:960
    s_waitcnt lgkmcnt(8)
    v_mfma_f32_32x32x16_bf16 v[72:87], v[124:127], v[148:151], v[72:87]
    ds_read_b128 v[120:123], v58 offset:1344
    ds_read_b128 v[144:147], v59 offset:912
    s_waitcnt lgkmcnt(8)
    v_mfma_f32_32x32x16_bf16 v[72:87], v[104:107], v[128:131], v[72:87]
    ds_read_b128 v[124:127], v58 offset:1376
    ds_read_b128 v[148:151], v59 offset:880
    s_waitcnt lgkmcnt(8)
    v_mfma_f32_32x32x16_bf16 v[72:87], v[108:111], v[132:135], v[72:87]
    ds_read_b128 v[104:107], v58 offset:1408
    ds_read_b128 v[128:131], v59 offset:832
    s_waitcnt lgkmcnt(8)
    v_mfma_f32_32x32x16_bf16 v[72:87], v[112:115], v[136:139], v[72:87]
    ds_read_b128 v[108:111], v58 offset:1440
    ds_read_b128 v[132:135], v59 offset:800
    s_waitcnt lgkmcnt(8)
    v_mfma_f32_32x32x16_bf16 v[72:87], v[116:119], v[140:143], v[72:87]
    ds_read_b128 v[112:115], v58 offset:1472
    ds_read_b128 v[136:139], v59 offset:752
    s_waitcnt lgkmcnt(8)
    v_mfma_f32_32x32x16_bf16 v[72:87], v[120:123], v[144:147], v[72:87]
    ds_read_b128 v[116:119], v58 offset:1504
    ds_read_b128 v[140:143], v59 offset:720
    s_waitcnt lgkmcnt(8)
    v_mfma_f32_32x32x16_bf16 v[72:87], v[124:127], v[148:151], v[72:87]
    s_waitcnt lgkmcnt(6)
    v_mfma_f32_32x32x16_bf16 v[72:87], v[104:107], v[128:131], v[72:87]
    s_waitcnt lgkmcnt(4)
    v_mfma_f32_32x32x16_bf16 v[72:87], v[108:111], v[132:135], v[72:87]
    s_waitcnt lgkmcnt(2)
    v_mfma_f32_32x32x16_bf16 v[72:87], v[112:115], v[136:139], v[72:87]
    s_waitcnt lgkmcnt(0)
    v_mfma_f32_32x32x16_bf16 v[72:87], v[116:119], v[140:143], v[72:87]
    s_nop 11
    ds_write_b128 v70, v[72:75] offset:23040
    ds_write_b128 v70, v[76:79] offset:23072
    ds_write_b128 v70, v[80:83] offset:23104
    ds_write_b128 v70, v[84:87] offset:23136
    s_branch c_pw_end_34
c_pw_37:
    ds_read_b128 v[104:107], v58 offset:1536
    ds_read_b128 v[128:131], v59 offset:672
    ds_read_b128 v[108:111], v58 offset:1568
    ds_read_b128 v[132:135], v59 offset:640
    ds_read_b128 v[112:115], v58 offset:1600
    ds_read_b128 v[136:139], v59 offset:592
    ds_read_b128 v[116:119], v58 offset:1632
    ds_read_b128 v[140:143], v59 offset:560
    ds_read_b128 v[120:123], v58 offset:1664
    ds_read_b128 v[144:147], v59 offset:512
    s_waitcnt lgkmcnt(8)
    v_mfma_f32_32x32x16_bf16 v[72:87], v[104:107], v[128:131], 0
    ds_read_b128 v[124:127], v58 offset:1696
    ds_read_b128 v[148:151], v59 offset:480
    s_waitcnt lgkmcnt(8)
    v_mfma_f32_32x32x16_bf16 v[72:87], v[108:111], v[132:135], v[72:87]
    ds_read_b128 v[104:107], v58 offset:1728
    ds_read_b128 v[128:131], v59 offset:432
    s_waitcnt lgkmcnt(8)
    v_mfma_f32_32x32x16_bf16 v[72:87], v[112:115], v[136:139], v[72:87]
    ds_read_b128 v[108:111], v58 offset:1760
    ds_read_b128 v[132:135], v59 offset:400
    s_waitcnt lgkmcnt(8)
    v_mfma_f32_32x32x16_bf16 v[72:87], v[116:119], v[140:143], v[72:87]
    ds_read_b128 v[112:115], v58 offset:1792
    ds_read_b128 v[136:139], v59 offset:352
    s_waitcnt lgkmcnt(8)
    v_mfma_f32_32x32x16_bf16 v[72:87], v[120:123], v[144:147], v[72:87]
    ds_read_b128 v[116:119], v58 offset:1824
    ds_read_b128 v[140:143], v59 offset:320
    s_waitcnt lgkmcnt(8)
    v_mfma_f32_32x32x16_bf16 v[72:87], v[124:127], v[148:151], v[72:87]
    ds_read_b128 v[120:123], v58 offset:1856
    ds_read_b128 v[144:147], v59 offset:272
    s_waitcnt lgkmcnt(8)
    v_mfma_f32_32x32x16_bf16 v[72:87], v[104:107], v[128:131], v[72:87]
    ds_read_b128 v[124:127], v58 offset:1888
    ds_read_b128 v[148:151], v59 offset:240
    s_waitcnt lgkmcnt(8)
    v_mfma_f32_32x32x16_bf16 v[72:87], v[108:111], v[132:135], v[72:87]
    ds_read_b128 v[104:107], v58 offset:1920
    ds_read_b128 v[128:131], v59 offset:192
    s_waitcnt lgkmcnt(8)
    v_mfma_f32_32x32x16_bf16 v[72:87], v[112:115], v[136:139], v[72:87]
    ds_read_b128 v[108:111], v58 offset:1952
    ds_read_b128 v[132:135], v59 offset:160
    s_waitcnt lgkmcnt(8)
    v_mfma_f32_32x32x16_bf16 v[72:87], v[116:119], v[140:143], v[72:87]
    ds_read_b128 v[112:115], v58 offset:1984
    ds_read_b128 v[136:139], v59 offset:112
    s_waitcnt lgkmcnt(8)
    v_mfma_f32_32x32x16_bf16 v[72:87], v[120:123], v[144:147], v[72:87]
    ds_read_b128 v[116:119], v58 offset:2016
    ds_read_b128 v[140:143], v59 offset:80
    s_waitcnt lgkmcnt(8)
    v_mfma_f32_32x32x16_bf16 v[72:87], v[124:127], v[148:151], v[72:87]
    s_waitcnt lgkmcnt(6)
    v_mfma_f32_32x32x16_bf16 v[72:87], v[104:107], v[128:131], v[72:87]
    s_waitcnt lgkmcnt(4)
    v_mfma_f32_32x32x16_bf16 v[72:87], v[108:111], v[132:135], v[72:87]
    s_waitcnt lgkmcnt(2)
    v_mfma_f32_32x32x16_bf16 v[72:87], v[112:115], v[136:139], v[72:87]
    s_waitcnt lgkmcnt(0)
    v_mfma_f32_32x32x16_bf16 v[72:87], v[116:119], v[140:143], v[72:87]
    s_nop 11
    ds_write_b128 v70, v[72:75] offset:27648
    ds_write_b128 v70, v[76:79] offset:27680
    ds_write_b128 v70, v[80:83] offset:27712
    ds_write_b128 v70, v[84:87] offset:27744
c_pw_end_34:
    s_waitcnt lgkmcnt(0)
    s_barrier
    s_cmp_ge_u32 s34, 2
    s_cbranch_scc1 c_hf_39
    ds_read_b128 v[104:107], v71 offset:13824
    ds_read_b128 v[108:111], v71 offset:13840
    ds_read_b128 v[112:115], v71 offset:18432
    ds_read_b128 v[116:119], v71 offset:18448
    ds_read_b128 v[120:123], v71 offset:23040
    ds_read_b128 v[124:127], v71 offset:23056
    ds_read_b128 v[128:131], v71 offset:27648
    ds_read_b128 v[132:135], v71 offset:27664
    s_waitcnt lgkmcnt(0)
    v_pk_add_f32 v[104:105], v[104:105], v[112:113]
    v_pk_add_f32 v[106:107], v[106:107], v[114:115]
    v_pk_add_f32 v[108:109], v[108:109], v[116:117]
    v_pk_add_f32 v[110:111], v[110:111], v[118:119]
    v_pk_add_f32 v[104:105], v[104:105], v[120:121]
    v_pk_add_f32 v[106:107], v[106:107], v[122:123]
    v_pk_add_f32 v[108:109], v[108:109], v[124:125]
    v_pk_add_f32 v[110:111], v[110:111], v[126:127]
    v_pk_add_f32 v[104:105], v[104:105], v[128:129]
    v_pk_add_f32 v[106:107], v[106:107], v[130:131]
    v_pk_add_f32 v[108:109], v[108:109], v[132:133]
    v_pk_add_f32 v[110:111], v[110:111], v[134:135]
    v_cvt_pk_bf16_f32 v184, v104, v105
    v_cvt_pk_bf16_f32 v185, v106, v107
    v_cvt_pk_bf16_f32 v186, v108, v109
    v_cvt_pk_bf16_f32 v187, v110, v111
    s_lshl_b32 s40, s58, 12
    s_add_u32 s40, s40, 8912896
    v_and_b32 v3, 127, v0
    v_lshlrev_b32 v3, 4, v3
    buffer_store_dwordx4 v[184:187], v3, s[8:11], s40 offen
    s_nop 1
c_hf_39:
c_halfE_27:
k2_kernel_end:
    s_endpgm

.globl k3_kernel
.p2align 8
.type k3_kernel,@function
k3_kernel:
    s_cmp_ge_u32 s2, 256
    s_cbranch_scc1 k3_kernel_end
    s_load_dwordx2 s[12:13], s[0:1], 104
    s_load_dwordx2 s[8:9], s[0:1], 0
    s_load_dwordx2 s[16:17], s[0:1], 88
    s_mov_b32 s10, 2621440
    s_mov_b32 s11, 0x20000
    s_mov_b32 s14, 15990784
    s_mov_b32 s15, 0x20000
    s_mov_b32 s18, 2621440
    s_mov_b32 s19, 0x20000
    v_lshrrev_b32 v4, 6, v0
    v_and_b32 v1, 63, v0
    v_readfirstlane_b32 s34, v4
    v_lshlrev_b32 v7, 4, v1
    s_and_b32 s40, s2, 7
    s_lshr_b32 s41, s2, 3
    s_lshr_b32 s32, s40, 1
    s_lshl_b32 s32, s32, 3
    s_and_b32 s42, s41, 7
    s_add_u32 s32, s32, s42
    s_and_b32 s33, s40, 1
    s_lshl_b32 s33, s33, 2
    s_lshr_b32 s42, s41, 3
    s_add_u32 s33, s33, s42
    s_add_u32 s40, s32, s33
    s_mul_i32 s41, s40, 43
    s_lshr_b32 s41, s41, 8
    s_mul_i32 s41, s41, 6
    s_sub_u32 s48, s40, s41
    s_mul_i32 s46, s33, 122880
    s_add_u32 s46, s46, 15007744
    s_mul_i32 s40, s34, 5120
    s_add_u32 s46, s46, s40
    s_mul_i32 s47, s32, 98304
    s_mul_i32 s41, s34, 24576
    s_add_u32 s47, s47, s41
    s_add_u32 s47, s47, 11534336
    s_add_u32 s40, s48, 0
    s_sub_u32 s41, s40, 6
    s_cmp_ge_u32 s40, 6
    s_cselect_b32 s50, s41, s40
    s_add_u32 s40, s48, 1
    s_sub_u32 s41, s40, 6
    s_cmp_ge_u32 s40, 6
    s_cselect_b32 s51, s41, s40
    s_add_u32 s40, s48, 2
    s_sub_u32 s41, s40, 6
    s_cmp_ge_u32 s40, 6
    s_cselect_b32 s52, s41, s40
    s_add_u32 s40, s48, 3
    s_sub_u32 s41, s40, 6
    s_cmp_ge_u32 s40, 6
    s_cselect_b32 s53, s41, s40
    s_add_u32 s40, s48, 4
    s_sub_u32 s41, s40, 6
    s_cmp_ge_u32 s40, 6
    s_cselect_b32 s54, s41, s40
    s_add_u32 s40, s48, 5
    s_sub_u32 s41, s40, 6
    s_cmp_ge_u32 s40, 6
    s_cselect_b32 s55, s41, s40
    s_waitcnt lgkmcnt(0)
    s_mul_i32 s40, s50, 20480
    s_add_u32 s40, s40, s46
    s_add_u32 s40, s40, 0
    s_mul_i32 s41, s34, 5120
    s_add_u32 m0, s41, 0
    s_nop 0
    buffer_load_dwordx4 v7, s[12:15], s40 offen lds
    s_mul_i32 s40, s50, 20480
    s_add_u32 s40, s40, s46
    s_add_u32 s40, s40, 1024
    s_mul_i32 s41, s34, 5120
    s_add_u32 m0, s41, 1024
    s_nop 0
    buffer_load_dwordx4 v7, s[12:15], s40 offen lds
    s_mul_i32 s40, s50, 20480
    s_add_u32 s40, s40, s46
    s_add_u32 s40, s40, 2048
    s_mul_i32 s41, s34, 5120
    s_add_u32 m0, s41, 2048
    s_nop 0
    buffer_load_dwordx4 v7, s[12:15], s40 offen lds
    s_mul_i32 s40, s50, 20480
    s_add_u32 s40, s40, s46
    s_add_u32 s40, s40, 3072
    s_mul_i32 s41, s34, 5120
    s_add_u32 m0, s41, 3072
    s_nop 0
    buffer_load_dwordx4 v7, s[12:15], s40 offen lds
    s_mul_i32 s40, s50, 20480
    s_add_u32 s40, s40, s46
    s_add_u32 s40, s40, 4096
    s_mul_i32 s41, s34, 5120
    s_add_u32 m0, s41, 4096
    s_nop 0
    buffer_load_dwordx4 v7, s[12:15], s40 offen lds
    s_lshl_b32 s42, s50, 12
    s_add_u32 s42, s42, s47
    buffer_load_dwordx4 v[8:11], v7, s[12:15], s42 offen offset:0
    s_lshl_b32 s42, s50, 12
    s_add_u32 s42, s42, s47
    buffer_load_dwordx4 v[12:15], v7, s[12:15], s42 offen offset:1024
    s_lshl_b32 s42, s50, 12
    s_add_u32 s42, s42, s47
    buffer_load_dwordx4 v[16:19], v7, s[12:15], s42 offen offset:2048
    s_lshl_b32 s42, s50, 12
    s_add_u32 s42, s42, s47
    buffer_load_dwordx4 v[20:23], v7, s[12:15], s42 offen offset:3072
    s_barrier
    s_mul_i32 s40, s51, 20480
    s_add_u32 s40, s40, s46
    s_add_u32 s40, s40, 0
    s_mul_i32 s41, s34, 5120
    s_add_u32 m0, s41, 20480
    s_nop 0
    buffer_load_dwordx4 v7, s[12:15], s40 offen lds
    s_mul_i32 s40, s51, 20480
    s_add_u32 s40, s40, s46
    s_add_u32 s40, s40, 1024
    s_mul_i32 s41, s34, 5120
    s_add_u32 m0, s41, 21504
    s_nop 0
    buffer_load_dwordx4 v7, s[12:15], s40 offen lds
    s_mul_i32 s40, s51, 20480
    s_add_u32 s40, s40, s46
    s_add_u32 s40, s40, 2048
    s_mul_i32 s41, s34, 5120
    s_add_u32 m0, s41, 22528
    s_nop 0
    buffer_load_dwordx4 v7, s[12:15], s40 offen lds
    s_mul_i32 s40, s51, 20480
    s_add_u32 s40, s40, s46
    s_add_u32 s40, s40, 3072
    s_mul_i32 s41, s34, 5120
    s_add_u32 m0, s41, 23552
    s_nop 0
    buffer_load_dwordx4 v7, s[12:15], s40 offen lds
    s_mul_i32 s40, s51, 20480
    s_add_u32 s40, s40, s46
    s_add_u32 s40, s40, 4096
    s_mul_i32 s41, s34, 5120
    s_add_u32 m0, s41, 24576
    s_nop 0
    buffer_load_dwordx4 v7, s[12:15], s40 offen lds
    s_lshl_b32 s42, s51, 12
    s_add_u32 s42, s42, s47
    buffer_load_dwordx4 v[24:27], v7, s[12:15], s42 offen offset:0
    s_lshl_b32 s42, s51, 12
    s_add_u32 s42, s42, s47
    buffer_load_dwordx4 v[28:31], v7, s[12:15], s42 offen offset:1024
    s_lshl_b32 s42, s51, 12
    s_add_u32 s42, s42, s47
    buffer_load_dwordx4 v[32:35], v7, s[12:15], s42 offen offset:2048
    s_lshl_b32 s42, s51, 12
    s_add_u32 s42, s42, s47
    buffer_load_dwordx4 v[36:39], v7, s[12:15], s42 offen offset:3072
    s_mul_i32 s44, s33, 160
    s_mul_i32 s45, s32, 81920
    s_add_u32 s45, s45, s44
    v_add_u32 v4, 0, v1
    v_mul_u32_u24 v5, 6554, v4
    v_lshrrev_b32 v5, 16, v5
    v_mul_u32_u24 v6, 10, v5
    v_sub_u32 v4, v4, v6
    v_lshlrev_b32 v4, 4, v4
    v_mul_u32_u24 v5, 1280, v5
    v_add_u32 v104, v4, v5
    v_add_u32 v4, 64, v1
    v_mul_u32_u24 v5, 6554, v4
    v_lshrrev_b32 v5, 16, v5
    v_mul_u32_u24 v6, 10, v5
    v_sub_u32 v4, v4, v6
    v_lshlrev_b32 v4, 4, v4
    v_mul_u32_u24 v5, 1280, v5
    v_add_u32 v105, v4, v5
    v_add_u32 v4, 128, v1
    v_mul_u32_u24 v5, 6554, v4
    v_lshrrev_b32 v5, 16, v5
    v_mul_u32_u24 v6, 10, v5
    v_sub_u32 v4, v4, v6
    v_lshlrev_b32 v4, 4, v4
    v_mul_u32_u24 v5, 1280, v5
    v_add_u32 v106, v4, v5
    v_add_u32 v4, 192, v1
    v_mul_u32_u24 v5, 6554, v4
    v_lshrrev_b32 v5, 16, v5
    v_mul_u32_u24 v6, 10, v5
    v_sub_u32 v4, v4, v6
    v_lshlrev_b32 v4, 4, v4
    v_mul_u32_u24 v5, 1280, v5
    v_add_u32 v107, v4, v5
    v_add_u32 v4, 256, v1
    v_mul_u32_u24 v5, 6554, v4
    v_lshrrev_b32 v5, 16, v5
    v_mul_u32_u24 v6, 10, v5
    v_sub_u32 v4, v4, v6
    v_lshlrev_b32 v4, 4, v4
    v_mul_u32_u24 v5, 1280, v5
    v_add_u32 v108, v4, v5
    v_lshrrev_b32 v2, 4, v1
    v_and_b32 v3, 15, v1
    v_mov_b32 v113, v7
    v_add_u32 v114, 61440, v7
    s_waitcnt vmcnt(13)
    s_barrier
    ds_read_b128 v[136:139], v113 offset:0
    ds_read_b128 v[140:143], v113 offset:1024
    ds_read_b128 v[144:147], v113 offset:2048
    ds_read_b128 v[148:151], v113 offset:3072
    ds_read_b128 v[152:155], v113 offset:4096
    ds_read_b128 v[156:159], v113 offset:5120
    ds_read_b128 v[160:163], v113 offset:6144
    ds_read_b128 v[164:167], v113 offset:7168
    ds_read_b128 v[168:171], v113 offset:8192
    ds_read_b128 v[172:175], v113 offset:9216
    s_waitcnt vmcnt(12)
    s_waitcnt lgkmcnt(9)
    v_mfma_f32_16x16x32_bf16 v[116:119], v[136:139], v[8:11], 0
    s_mul_i32 s40, s52, 20480
    s_add_u32 s40, s40, s46
    s_add_u32 s40, s40, 0
    s_mul_i32 s41, s34, 5120
    s_add_u32 m0, s41, 40960
    s_nop 0
    buffer_load_dwordx4 v7, s[12:15], s40 offen lds
    s_waitcnt lgkmcnt(8)
    v_mfma_f32_16x16x32_bf16 v[120:123], v[140:143], v[8:11], 0
    s_waitcnt lgkmcnt(7)
    v_mfma_f32_16x16x32_bf16 v[124:127], v[144:147], v[8:11], 0
    s_mul_i32 s40, s52, 20480
    s_add_u32 s40, s40, s46
    s_add_u32 s40, s40, 1024
    s_mul_i32 s41, s34, 5120
    s_add_u32 m0, s41, 41984
    s_nop 0
    buffer_load_dwordx4 v7, s[12:15], s40 offen lds
    s_waitcnt lgkmcnt(6)
    v_mfma_f32_16x16x32_bf16 v[128:131], v[148:151], v[8:11], 0
    s_waitcnt lgkmcnt(5)
    v_mfma_f32_16x16x32_bf16 v[132:135], v[152:155], v[8:11], 0
    s_mul_i32 s40, s52, 20480
    s_add_u32 s40, s40, s46
    s_add_u32 s40, s40, 2048
    s_mul_i32 s41, s34, 5120
    s_add_u32 m0, s41, 43008
    s_nop 0
    buffer_load_dwordx4 v7, s[12:15], s40 offen lds
    ds_read_b128 v[136:139], v113 offset:10240
    ds_read_b128 v[140:143], v113 offset:11264
    ds_read_b128 v[144:147], v113 offset:12288
    ds_read_b128 v[148:151], v113 offset:13312
    ds_read_b128 v[152:155], v113 offset:14336
    s_waitcnt vmcnt(14)
    s_waitcnt lgkmcnt(9)
    v_mfma_f32_16x16x32_bf16 v[116:119], v[156:159], v[12:15], v[116:119]
    s_mul_i32 s40, s52, 20480
    s_add_u32 s40, s40, s46
    s_add_u32 s40, s40, 3072
    s_mul_i32 s41, s34, 5120
    s_add_u32 m0, s41, 44032
    s_nop 0
    buffer_load_dwordx4 v7, s[12:15], s40 offen lds
    s_waitcnt lgkmcnt(8)
    v_mfma_f32_16x16x32_bf16 v[120:123], v[160:163], v[12:15], v[120:123]
    s_waitcnt lgkmcnt(7)
    v_mfma_f32_16x16x32_bf16 v[124:127], v[164:167], v[12:15], v[124:127]
    s_mul_i32 s40, s52, 20480
    s_add_u32 s40, s40, s46
    s_add_u32 s40, s40, 4096
    s_mul_i32 s41, s34, 5120
    s_add_u32 m0, s41, 45056
    s_nop 0
    buffer_load_dwordx4 v7, s[12:15], s40 offen lds
    s_waitcnt lgkmcnt(6)
    v_mfma_f32_16x16x32_bf16 v[128:131], v[168:171], v[12:15], v[128:131]
    s_waitcnt lgkmcnt(5)
    v_mfma_f32_16x16x32_bf16 v[132:135], v[172:175], v[12:15], v[132:135]
    s_lshl_b32 s42, s52, 12
    s_add_u32 s42, s42, s47
    buffer_load_dwordx4 v[40:43], v7, s[12:15], s42 offen offset:0
    ds_read_b128 v[156:159], v113 offset:15360
    ds_read_b128 v[160:163], v113 offset:16384
    ds_read_b128 v[164:167], v113 offset:17408
    ds_read_b128 v[168:171], v113 offset:18432
    ds_read_b128 v[172:175], v113 offset:19456
    s_waitcnt vmcnt(16)
    s_waitcnt lgkmcnt(9)
    v_mfma_f32_16x16x32_bf16 v[116:119], v[136:139], v[16:19], v[116:119]
    s_lshl_b32 s42, s52, 12
    s_add_u32 s42, s42, s47
    buffer_load_dwordx4 v[44:47], v7, s[12:15], s42 offen offset:1024
    s_waitcnt lgkmcnt(8)
    v_mfma_f32_16x16x32_bf16 v[120:123], v[140:143], v[16:19], v[120:123]
    s_waitcnt lgkmcnt(7)
    v_mfma_f32_16x16x32_bf16 v[124:127], v[144:147], v[16:19], v[124:127]
    s_lshl_b32 s42, s52, 12
    s_add_u32 s42, s42, s47
    buffer_load_dwordx4 v[48:51], v7, s[12:15], s42 offen offset:2048
    s_waitcnt lgkmcnt(6)
    v_mfma_f32_16x16x32_bf16 v[128:131], v[148:151], v[16:19], v[128:131]
    s_waitcnt lgkmcnt(5)
    v_mfma_f32_16x16x32_bf16 v[132:135], v[152:155], v[16:19], v[132:135]
    s_lshl_b32 s42, s52, 12
    s_add_u32 s42, s42, s47
    buffer_load_dwordx4 v[52:55], v7, s[12:15], s42 offen offset:3072
    s_waitcnt vmcnt(18)
    s_waitcnt lgkmcnt(4)
    v_mfma_f32_16x16x32_bf16 v[116:119], v[156:159], v[20:23], v[116:119]
    s_waitcnt lgkmcnt(3)
    v_mfma_f32_16x16x32_bf16 v[120:123], v[160:163], v[20:23], v[120:123]
    s_waitcnt lgkmcnt(2)
    v_mfma_f32_16x16x32_bf16 v[124:127], v[164:167], v[20:23], v[124:127]
    s_waitcnt lgkmcnt(1)
    v_mfma_f32_16x16x32_bf16 v[128:131], v[168:171], v[20:23], v[128:131]
    s_waitcnt lgkmcnt(0)
    v_mfma_f32_16x16x32_bf16 v[132:135], v[172:175], v[20:23], v[132:135]
    s_waitcnt vmcnt(13)
    s_barrier
    ds_read_b128 v[136:139], v113 offset:20480
    ds_read_b128 v[140:143], v113 offset:21504
    ds_read_b128 v[144:147], v113 offset:22528
    ds_read_b128 v[148:151], v113 offset:23552
    ds_read_b128 v[152:155], v113 offset:24576
    ds_read_b128 v[156:159], v113 offset:25600
    ds_read_b128 v[160:163], v113 offset:26624
    ds_read_b128 v[164:167], v113 offset:27648
    ds_read_b128 v[168:171], v113 offset:28672
    ds_read_b128 v[172:175], v113 offset:29696
    s_waitcnt vmcnt(12)
    s_waitcnt lgkmcnt(9)
    v_mfma_f32_16x16x32_bf16 v[116:119], v[136:139], v[24:27], v[116:119]
    s_mul_i32 s40, s53, 20480
    s_add_u32 s40, s40, s46
    s_add_u32 s40, s40, 0
    s_mul_i32 s41, s34, 5120
    s_add_u32 m0, s41, 61440
    s_nop 0
    buffer_load_dwordx4 v7, s[12:15], s40 offen lds
    s_waitcnt lgkmcnt(8)
    v_mfma_f32_16x16x32_bf16 v[120:123], v[140:143], v[24:27], v[120:123]
    s_waitcnt lgkmcnt(7)
    v_mfma_f32_16x16x32_bf16 v[124:127], v[144:147], v[24:27], v[124:127]
    s_mul_i32 s40, s53, 20480
    s_add_u32 s40, s40, s46
    s_add_u32 s40, s40, 1024
    s_mul_i32 s41, s34, 5120
    s_add_u32 m0, s41, 62464
    s_nop 0
    buffer_load_dwordx4 v7, s[12:15], s40 offen lds
    s_waitcnt lgkmcnt(6)
    v_mfma_f32_16x16x32_bf16 v[128:131], v[148:151], v[24:27], v[128:131]
    s_waitcnt lgkmcnt(5)
    v_mfma_f32_16x16x32_bf16 v[132:135], v[152:155], v[24:27], v[132:135]
    s_mul_i32 s40, s53, 20480
    s_add_u32 s40, s40, s46
    s_add_u32 s40, s40, 2048
    s_mul_i32 s41, s34, 5120
    s_add_u32 m0, s41, 63488
    s_nop 0
    buffer_load_dwordx4 v7, s[12:15], s40 offen lds
    ds_read_b128 v[136:139], v113 offset:30720
    ds_read_b128 v[140:143], v113 offset:31744
    ds_read_b128 v[144:147], v113 offset:32768
    ds_read_b128 v[148:151], v113 offset:33792
    ds_read_b128 v[152:155], v113 offset:34816
    s_waitcnt vmcnt(14)
    s_waitcnt lgkmcnt(9)
    v_mfma_f32_16x16x32_bf16 v[116:119], v[156:159], v[28:31], v[116:119]
    s_mul_i32 s40, s53, 20480
    s_add_u32 s40, s40, s46
    s_add_u32 s40, s40, 3072
    s_mul_i32 s41, s34, 5120
    s_add_u32 m0, s41, 64512
    s_nop 0
    buffer_load_dwordx4 v7, s[12:15], s40 offen lds
    s_waitcnt lgkmcnt(8)
    v_mfma_f32_16x16x32_bf16 v[120:123], v[160:163], v[28:31], v[120:123]
    s_waitcnt lgkmcnt(7)
    v_mfma_f32_16x16x32_bf16 v[124:127], v[164:167], v[28:31], v[124:127]
    s_mul_i32 s40, s53, 20480
    s_add_u32 s40, s40, s46
    s_add_u32 s40, s40, 4096
    s_mul_i32 s41, s34, 5120
    s_add_u32 m0, s41, 65536
    s_nop 0
    buffer_load_dwordx4 v7, s[12:15], s40 offen lds
    s_waitcnt lgkmcnt(6)
    v_mfma_f32_16x16x32_bf16 v[128:131], v[168:171], v[28:31], v[128:131]
    s_waitcnt lgkmcnt(5)
    v_mfma_f32_16x16x32_bf16 v[132:135], v[172:175], v[28:31], v[132:135]
    s_lshl_b32 s42, s53, 12
    s_add_u32 s42, s42, s47
    buffer_load_dwordx4 v[56:59], v7, s[12:15], s42 offen offset:0
    ds_read_b128 v[156:159], v113 offset:35840
    ds_read_b128 v[160:163], v113 offset:36864
    ds_read_b128 v[164:167], v113 offset:37888
    ds_read_b128 v[168:171], v113 offset:38912
    ds_read_b128 v[172:175], v113 offset:39936
    s_waitcnt vmcnt(16)
    s_waitcnt lgkmcnt(9)
    v_mfma_f32_16x16x32_bf16 v[116:119], v[136:139], v[32:35], v[116:119]
    s_lshl_b32 s42, s53, 12
    s_add_u32 s42, s42, s47
    buffer_load_dwordx4 v[60:63], v7, s[12:15], s42 offen offset:1024
    s_waitcnt lgkmcnt(8)
    v_mfma_f32_16x16x32_bf16 v[120:123], v[140:143], v[32:35], v[120:123]
    s_waitcnt lgkmcnt(7)
    v_mfma_f32_16x16x32_bf16 v[124:127], v[144:147], v[32:35], v[124:127]
    s_lshl_b32 s42, s53, 12
    s_add_u32 s42, s42, s47
    buffer_load_dwordx4 v[64:67], v7, s[12:15], s42 offen offset:2048
    s_waitcnt lgkmcnt(6)
    v_mfma_f32_16x16x32_bf16 v[128:131], v[148:151], v[32:35], v[128:131]
    s_waitcnt lgkmcnt(5)
    v_mfma_f32_16x16x32_bf16 v[132:135], v[152:155], v[32:35], v[132:135]
    s_lshl_b32 s42, s53, 12
    s_add_u32 s42, s42, s47
    buffer_load_dwordx4 v[68:71], v7, s[12:15], s42 offen offset:3072
    s_waitcnt vmcnt(18)
    s_waitcnt lgkmcnt(4)
    v_mfma_f32_16x16x32_bf16 v[116:119], v[156:159], v[36:39], v[116:119]
    s_waitcnt lgkmcnt(3)
    v_mfma_f32_16x16x32_bf16 v[120:123], v[160:163], v[36:39], v[120:123]
    s_waitcnt lgkmcnt(2)
    v_mfma_f32_16x16x32_bf16 v[124:127], v[164:167], v[36:39], v[124:127]
    s_waitcnt lgkmcnt(1)
    v_mfma_f32_16x16x32_bf16 v[128:131], v[168:171], v[36:39], v[128:131]
    s_waitcnt lgkmcnt(0)
    v_mfma_f32_16x16x32_bf16 v[132:135], v[172:175], v[36:39], v[132:135]
    s_waitcnt vmcnt(13)
    s_barrier
    ds_read_b128 v[136:139], v113 offset:40960
    ds_read_b128 v[140:143], v113 offset:41984
    ds_read_b128 v[144:147], v113 offset:43008
    ds_read_b128 v[148:151], v113 offset:44032
    ds_read_b128 v[152:155], v113 offset:45056
    ds_read_b128 v[156:159], v113 offset:46080
    ds_read_b128 v[160:163], v113 offset:47104
    ds_read_b128 v[164:167], v113 offset:48128
    ds_read_b128 v[168:171], v113 offset:49152
    ds_read_b128 v[172:175], v113 offset:50176
    s_waitcnt vmcnt(12)
    s_waitcnt lgkmcnt(9)
    v_mfma_f32_16x16x32_bf16 v[116:119], v[136:139], v[40:43], v[116:119]
    s_mul_i32 s40, s54, 20480
    s_add_u32 s40, s40, s46
    s_add_u32 s40, s40, 0
    s_mul_i32 s41, s34, 5120
    s_add_u32 m0, s41, 81920
    s_nop 0
    buffer_load_dwordx4 v7, s[12:15], s40 offen lds
    s_waitcnt lgkmcnt(8)
    v_mfma_f32_16x16x32_bf16 v[120:123], v[140:143], v[40:43], v[120:123]
    s_waitcnt lgkmcnt(7)
    v_mfma_f32_16x16x32_bf16 v[124:127], v[144:147], v[40:43], v[124:127]
    s_mul_i32 s40, s54, 20480
    s_add_u32 s40, s40, s46
    s_add_u32 s40, s40, 1024
    s_mul_i32 s41, s34, 5120
    s_add_u32 m0, s41, 82944
    s_nop 0
    buffer_load_dwordx4 v7, s[12:15], s40 offen lds
    s_waitcnt lgkmcnt(6)
    v_mfma_f32_16x16x32_bf16 v[128:131], v[148:151], v[40:43], v[128:131]
    s_waitcnt lgkmcnt(5)
    v_mfma_f32_16x16x32_bf16 v[132:135], v[152:155], v[40:43], v[132:135]
    s_mul_i32 s40, s54, 20480
    s_add_u32 s40, s40, s46
    s_add_u32 s40, s40, 2048
    s_mul_i32 s41, s34, 5120
    s_add_u32 m0, s41, 83968
    s_nop 0
    buffer_load_dwordx4 v7, s[12:15], s40 offen lds
    ds_read_b128 v[136:139], v113 offset:51200
    ds_read_b128 v[140:143], v113 offset:52224
    ds_read_b128 v[144:147], v113 offset:53248
    ds_read_b128 v[148:151], v113 offset:54272
    ds_read_b128 v[152:155], v113 offset:55296
    s_waitcnt vmcnt(14)
    s_waitcnt lgkmcnt(9)
    v_mfma_f32_16x16x32_bf16 v[116:119], v[156:159], v[44:47], v[116:119]
    s_mul_i32 s40, s54, 20480
    s_add_u32 s40, s40, s46
    s_add_u32 s40, s40, 3072
    s_mul_i32 s41, s34, 5120
    s_add_u32 m0, s41, 84992
    s_nop 0
    buffer_load_dwordx4 v7, s[12:15], s40 offen lds
    s_waitcnt lgkmcnt(8)
    v_mfma_f32_16x16x32_bf16 v[120:123], v[160:163], v[44:47], v[120:123]
    s_waitcnt lgkmcnt(7)
    v_mfma_f32_16x16x32_bf16 v[124:127], v[164:167], v[44:47], v[124:127]
    s_mul_i32 s40, s54, 20480
    s_add_u32 s40, s40, s46
    s_add_u32 s40, s40, 4096
    s_mul_i32 s41, s34, 5120
    s_add_u32 m0, s41, 86016
    s_nop 0
    buffer_load_dwordx4 v7, s[12:15], s40 offen lds
    s_waitcnt lgkmcnt(6)
    v_mfma_f32_16x16x32_bf16 v[128:131], v[168:171], v[44:47], v[128:131]
    s_waitcnt lgkmcnt(5)
    v_mfma_f32_16x16x32_bf16 v[132:135], v[172:175], v[44:47], v[132:135]
    s_lshl_b32 s42, s54, 12
    s_add_u32 s42, s42, s47
    buffer_load_dwordx4 v[72:75], v7, s[12:15], s42 offen offset:0
    ds_read_b128 v[156:159], v113 offset:56320
    ds_read_b128 v[160:163], v113 offset:57344
    ds_read_b128 v[164:167], v113 offset:58368
    ds_read_b128 v[168:171], v113 offset:59392
    ds_read_b128 v[172:175], v113 offset:60416
    s_waitcnt vmcnt(16)
    s_waitcnt lgkmcnt(9)
    v_mfma_f32_16x16x32_bf16 v[116:119], v[136:139], v[48:51], v[116:119]
    s_lshl_b32 s42, s54, 12
    s_add_u32 s42, s42, s47
    buffer_load_dwordx4 v[76:79], v7, s[12:15], s42 offen offset:1024
    s_waitcnt lgkmcnt(8)
    v_mfma_f32_16x16x32_bf16 v[120:123], v[140:143], v[48:51], v[120:123]
    s_waitcnt lgkmcnt(7)
    v_mfma_f32_16x16x32_bf16 v[124:127], v[144:147], v[48:51], v[124:127]
    s_lshl_b32 s42, s54, 12
    s_add_u32 s42, s42, s47
    buffer_load_dwordx4 v[80:83], v7, s[12:15], s42 offen offset:2048
    s_waitcnt lgkmcnt(6)
    v_mfma_f32_16x16x32_bf16 v[128:131], v[148:151], v[48:51], v[128:131]
    s_waitcnt lgkmcnt(5)
    v_mfma_f32_16x16x32_bf16 v[132:135], v[152:155], v[48:51], v[132:135]
    s_lshl_b32 s42, s54, 12
    s_add_u32 s42, s42, s47
    buffer_load_dwordx4 v[84:87], v7, s[12:15], s42 offen offset:3072
    s_waitcnt vmcnt(18)
    s_waitcnt lgkmcnt(4)
    v_mfma_f32_16x16x32_bf16 v[116:119], v[156:159], v[52:55], v[116:119]
    s_waitcnt lgkmcnt(3)
    v_mfma_f32_16x16x32_bf16 v[120:123], v[160:163], v[52:55], v[120:123]
    s_waitcnt lgkmcnt(2)
    v_mfma_f32_16x16x32_bf16 v[124:127], v[164:167], v[52:55], v[124:127]
    s_waitcnt lgkmcnt(1)
    v_mfma_f32_16x16x32_bf16 v[128:131], v[168:171], v[52:55], v[128:131]
    s_waitcnt lgkmcnt(0)
    v_mfma_f32_16x16x32_bf16 v[132:135], v[172:175], v[52:55], v[132:135]
    s_waitcnt vmcnt(13)
    s_barrier
    ds_read_b128 v[136:139], v114 offset:0
    ds_read_b128 v[140:143], v114 offset:1024
    ds_read_b128 v[144:147], v114 offset:2048
    ds_read_b128 v[148:151], v114 offset:3072
    ds_read_b128 v[152:155], v114 offset:4096
    ds_read_b128 v[156:159], v114 offset:5120
    ds_read_b128 v[160:163], v114 offset:6144
    ds_read_b128 v[164:167], v114 offset:7168
    ds_read_b128 v[168:171], v114 offset:8192
    ds_read_b128 v[172:175], v114 offset:9216
    s_waitcnt vmcnt(12)
    s_waitcnt lgkmcnt(9)
    v_mfma_f32_16x16x32_bf16 v[116:119], v[136:139], v[56:59], v[116:119]
    s_mul_i32 s40, s55, 20480
    s_add_u32 s40, s40, s46
    s_add_u32 s40, s40, 0
    s_mul_i32 s41, s34, 5120
    s_add_u32 m0, s41, 102400
    s_nop 0
    buffer_load_dwordx4 v7, s[12:15], s40 offen lds
    s_waitcnt lgkmcnt(8)
    v_mfma_f32_16x16x32_bf16 v[120:123], v[140:143], v[56:59], v[120:123]
    s_waitcnt lgkmcnt(7)
    v_mfma_f32_16x16x32_bf16 v[124:127], v[144:147], v[56:59], v[124:127]
    s_mul_i32 s40, s55, 20480
    s_add_u32 s40, s40, s46
    s_add_u32 s40, s40, 1024
    s_mul_i32 s41, s34, 5120
    s_add_u32 m0, s41, 103424
    s_nop 0
    buffer_load_dwordx4 v7, s[12:15], s40 offen lds
    s_waitcnt lgkmcnt(6)
    v_mfma_f32_16x16x32_bf16 v[128:131], v[148:151], v[56:59], v[128:131]
    s_waitcnt lgkmcnt(5)
    v_mfma_f32_16x16x32_bf16 v[132:135], v[152:155], v[56:59], v[132:135]
    s_mul_i32 s40, s55, 20480
    s_add_u32 s40, s40, s46
    s_add_u32 s40, s40, 2048
    s_mul_i32 s41, s34, 5120
    s_add_u32 m0, s41, 104448
    s_nop 0
    buffer_load_dwordx4 v7, s[12:15], s40 offen lds
    ds_read_b128 v[136:139], v114 offset:10240
    ds_read_b128 v[140:143], v114 offset:11264
    ds_read_b128 v[144:147], v114 offset:12288
    ds_read_b128 v[148:151], v114 offset:13312
    ds_read_b128 v[152:155], v114 offset:14336
    s_waitcnt vmcnt(14)
    s_waitcnt lgkmcnt(9)
    v_mfma_f32_16x16x32_bf16 v[116:119], v[156:159], v[60:63], v[116:119]
    s_mul_i32 s40, s55, 20480
    s_add_u32 s40, s40, s46
    s_add_u32 s40, s40, 3072
    s_mul_i32 s41, s34, 5120
    s_add_u32 m0, s41, 105472
    s_nop 0
    buffer_load_dwordx4 v7, s[12:15], s40 offen lds
    s_waitcnt lgkmcnt(8)
    v_mfma_f32_16x16x32_bf16 v[120:123], v[160:163], v[60:63], v[120:123]
    s_waitcnt lgkmcnt(7)
    v_mfma_f32_16x16x32_bf16 v[124:127], v[164:167], v[60:63], v[124:127]
    s_mul_i32 s40, s55, 20480
    s_add_u32 s40, s40, s46
    s_add_u32 s40, s40, 4096
    s_mul_i32 s41, s34, 5120
    s_add_u32 m0, s41, 106496
    s_nop 0
    buffer_load_dwordx4 v7, s[12:15], s40 offen lds
    s_waitcnt lgkmcnt(6)
    v_mfma_f32_16x16x32_bf16 v[128:131], v[168:171], v[60:63], v[128:131]
    s_waitcnt lgkmcnt(5)
    v_mfma_f32_16x16x32_bf16 v[132:135], v[172:175], v[60:63], v[132:135]
    s_lshl_b32 s42, s55, 12
    s_add_u32 s42, s42, s47
    buffer_load_dwordx4 v[88:91], v7, s[12:15], s42 offen offset:0
    ds_read_b128 v[156:159], v114 offset:15360
    ds_read_b128 v[160:163], v114 offset:16384
    ds_read_b128 v[164:167], v114 offset:17408
    ds_read_b128 v[168:171], v114 offset:18432
    ds_read_b128 v[172:175], v114 offset:19456
    s_waitcnt vmcnt(16)
    s_waitcnt lgkmcnt(9)
    v_mfma_f32_16x16x32_bf16 v[116:119], v[136:139], v[64:67], v[116:119]
    s_lshl_b32 s42, s55, 12
    s_add_u32 s42, s42, s47
    buffer_load_dwordx4 v[92:95], v7, s[12:15], s42 offen offset:1024
    s_waitcnt lgkmcnt(8)
    v_mfma_f32_16x16x32_bf16 v[120:123], v[140:143], v[64:67], v[120:123]
    s_waitcnt lgkmcnt(7)
    v_mfma_f32_16x16x32_bf16 v[124:127], v[144:147], v[64:67], v[124:127]
    s_lshl_b32 s42, s55, 12
    s_add_u32 s42, s42, s47
    buffer_load_dwordx4 v[96:99], v7, s[12:15], s42 offen offset:2048
    s_waitcnt lgkmcnt(6)
    v_mfma_f32_16x16x32_bf16 v[128:131], v[148:151], v[64:67], v[128:131]
    s_waitcnt lgkmcnt(5)
    v_mfma_f32_16x16x32_bf16 v[132:135], v[152:155], v[64:67], v[132:135]
    s_lshl_b32 s42, s55, 12
    s_add_u32 s42, s42, s47
    buffer_load_dwordx4 v[100:103], v7, s[12:15], s42 offen offset:3072
    s_waitcnt vmcnt(18)
    s_waitcnt lgkmcnt(4)
    v_mfma_f32_16x16x32_bf16 v[116:119], v[156:159], v[68:71], v[116:119]
    s_cmp_ge_u32 s34, 2
    s_cbranch_scc1 k3_y_1
    s_mul_i32 s40, s34, 40960
    s_add_u32 s40, s40, s45
    s_mul_i32 s41, s34, 5120
    s_add_u32 m0, s41, 122880
    s_nop 0
    buffer_load_dwordx4 v104, s[8:11], s40 offen lds
    s_add_u32 m0, s41, 123904
    s_nop 0
    buffer_load_dwordx4 v105, s[8:11], s40 offen lds
    s_add_u32 m0, s41, 124928
    s_nop 0
    buffer_load_dwordx4 v106, s[8:11], s40 offen lds
    s_add_u32 m0, s41, 125952
    s_nop 0
    buffer_load_dwordx4 v107, s[8:11], s40 offen lds
    s_add_u32 m0, s41, 126976
    s_nop 0
    buffer_load_dwordx4 v108, s[8:11], s40 offen lds
    s_branch k3_xy_2
k3_y_1:
    v_lshrrev_b32 v4, 3, v1
    v_lshlrev_b32 v4, 12, v4
    v_and_b32 v5, 7, v1
    v_lshl_add_u32 v112, v5, 4, v4
    s_sub_u32 s42, s34, 2
    s_mul_i32 s40, s42, 40
    s_mul_i32 s41, s33, 80
    s_add_u32 s40, s40, s41
    s_lshl_b32 s40, s40, 12
    s_lshl_b32 s41, s32, 7
    s_add_u32 s40, s40, s41
    s_add_u32 s40, s40, 8912896
    s_mul_i32 s41, s42, 5120
    s_add_u32 m0, s41, 133120
    s_nop 0
    buffer_load_dwordx4 v112, s[12:15], s40 offen lds
    s_add_u32 s40, s40, 32768
    s_add_u32 m0, s41, 134144
    s_nop 0
    buffer_load_dwordx4 v112, s[12:15], s40 offen lds
    s_add_u32 s40, s40, 32768
    s_add_u32 m0, s41, 135168
    s_nop 0
    buffer_load_dwordx4 v112, s[12:15], s40 offen lds
    s_add_u32 s40, s40, 32768
    s_add_u32 m0, s41, 136192
    s_nop 0
    buffer_load_dwordx4 v112, s[12:15], s40 offen lds
    s_add_u32 s40, s40, 32768
    s_add_u32 m0, s41, 137216
    s_nop 0
    buffer_load_dwordx4 v112, s[12:15], s40 offen lds
    s_add_u32 s40, s40, 32768
k3_xy_2:
    s_lshl_b32 s40, s32, 9
    s_lshl_b32 s41, s34, 7
    s_add_u32 s40, s40, s41
    s_add_u32 s40, s40, 14680064
    v_lshlrev_b32 v4, 3, v3
    buffer_load_dwordx2 v[110:111], v4, s[12:15], s40 offen
    s_waitcnt lgkmcnt(3)
    v_mfma_f32_16x16x32_bf16 v[120:123], v[160:163], v[68:71], v[120:123]
    s_waitcnt lgkmcnt(2)
    v_mfma_f32_16x16x32_bf16 v[124:127], v[164:167], v[68:71], v[124:127]
    s_waitcnt lgkmcnt(1)
    v_mfma_f32_16x16x32_bf16 v[128:131], v[168:171], v[68:71], v[128:131]
    s_waitcnt lgkmcnt(0)
    v_mfma_f32_16x16x32_bf16 v[132:135], v[172:175], v[68:71], v[132:135]
    s_waitcnt vmcnt(19)
    s_barrier
    ds_read_b128 v[136:139], v114 offset:20480
    ds_read_b128 v[140:143], v114 offset:21504
    ds_read_b128 v[144:147], v114 offset:22528
    ds_read_b128 v[148:151], v114 offset:23552
    ds_read_b128 v[152:155], v114 offset:24576
    ds_read_b128 v[156:159], v114 offset:25600
    ds_read_b128 v[160:163], v114 offset:26624
    ds_read_b128 v[164:167], v114 offset:27648
    ds_read_b128 v[168:171], v114 offset:28672
    ds_read_b128 v[172:175], v114 offset:29696
    s_waitcnt vmcnt(18)
    s_waitcnt lgkmcnt(9)
    v_mfma_f32_16x16x32_bf16 v[116:119], v[136:139], v[72:75], v[116:119]
    s_waitcnt lgkmcnt(8)
    v_mfma_f32_16x16x32_bf16 v[120:123], v[140:143], v[72:75], v[120:123]
    s_waitcnt lgkmcnt(7)
    v_mfma_f32_16x16x32_bf16 v[124:127], v[144:147], v[72:75], v[124:127]
    s_waitcnt lgkmcnt(6)
    v_mfma_f32_16x16x32_bf16 v[128:131], v[148:151], v[72:75], v[128:131]
    s_waitcnt lgkmcnt(5)
    v_mfma_f32_16x16x32_bf16 v[132:135], v[152:155], v[72:75], v[132:135]
    ds_read_b128 v[136:139], v114 offset:30720
    ds_read_b128 v[140:143], v114 offset:31744
    ds_read_b128 v[144:147], v114 offset:32768
    ds_read_b128 v[148:151], v114 offset:33792
    ds_read_b128 v[152:155], v114 offset:34816
    s_waitcnt vmcnt(17)
    s_waitcnt lgkmcnt(9)
    v_mfma_f32_16x16x32_bf16 v[116:119], v[156:159], v[76:79], v[116:119]
    s_waitcnt lgkmcnt(8)
    v_mfma_f32_16x16x32_bf16 v[120:123], v[160:163], v[76:79], v[120:123]
    s_waitcnt lgkmcnt(7)
    v_mfma_f32_16x16x32_bf16 v[124:127], v[164:167], v[76:79], v[124:127]
    s_waitcnt lgkmcnt(6)
    v_mfma_f32_16x16x32_bf16 v[128:131], v[168:171], v[76:79], v[128:131]
    s_waitcnt lgkmcnt(5)
    v_mfma_f32_16x16x32_bf16 v[132:135], v[172:175], v[76:79], v[132:135]
    ds_read_b128 v[156:159], v114 offset:35840
    ds_read_b128 v[160:163], v114 offset:36864
    ds_read_b128 v[164:167], v114 offset:37888
    ds_read_b128 v[168:171], v114 offset:38912
    ds_read_b128 v[172:175], v114 offset:39936
    s_waitcnt vmcnt(16)
    s_waitcnt lgkmcnt(9)
    v_mfma_f32_16x16x32_bf16 v[116:119], v[136:139], v[80:83], v[116:119]
    s_waitcnt lgkmcnt(8)
    v_mfma_f32_16x16x32_bf16 v[120:123], v[140:143], v[80:83], v[120:123]
    s_waitcnt lgkmcnt(7)
    v_mfma_f32_16x16x32_bf16 v[124:127], v[144:147], v[80:83], v[124:127]
    s_waitcnt lgkmcnt(6)
    v_mfma_f32_16x16x32_bf16 v[128:131], v[148:151], v[80:83], v[128:131]
    s_waitcnt lgkmcnt(5)
    v_mfma_f32_16x16x32_bf16 v[132:135], v[152:155], v[80:83], v[132:135]
    s_waitcnt vmcnt(15)
    s_waitcnt lgkmcnt(4)
    v_mfma_f32_16x16x32_bf16 v[116:119], v[156:159], v[84:87], v[116:119]
    s_waitcnt lgkmcnt(3)
    v_mfma_f32_16x16x32_bf16 v[120:123], v[160:163], v[84:87], v[120:123]
    s_waitcnt lgkmcnt(2)
    v_mfma_f32_16x16x32_bf16 v[124:127], v[164:167], v[84:87], v[124:127]
    s_waitcnt lgkmcnt(1)
    v_mfma_f32_16x16x32_bf16 v[128:131], v[168:171], v[84:87], v[128:131]
    s_waitcnt lgkmcnt(0)
    v_mfma_f32_16x16x32_bf16 v[132:135], v[172:175], v[84:87], v[132:135]
    s_waitcnt vmcnt(10)
    s_barrier
    ds_read_b128 v[136:139], v114 offset:40960
    ds_read_b128 v[140:143], v114 offset:41984
    ds_read_b128 v[144:147], v114 offset:43008
    ds_read_b128 v[148:151], v114 offset:44032
    ds_read_b128 v[152:155], v114 offset:45056
    ds_read_b128 v[156:159], v114 offset:46080
    ds_read_b128 v[160:163], v114 offset:47104
    ds_read_b128 v[164:167], v114 offset:48128
    ds_read_b128 v[168:171], v114 offset:49152
    ds_read_b128 v[172:175], v114 offset:50176
    s_waitcnt vmcnt(9)
    s_waitcnt lgkmcnt(9)
    v_mfma_f32_16x16x32_bf16 v[116:119], v[136:139], v[88:91], v[116:119]
    s_waitcnt lgkmcnt(8)
    v_mfma_f32_16x16x32_bf16 v[120:123], v[140:143], v[88:91], v[120:123]
    s_waitcnt lgkmcnt(7)
    v_mfma_f32_16x16x32_bf16 v[124:127], v[144:147], v[88:91], v[124:127]
    s_waitcnt lgkmcnt(6)
    v_mfma_f32_16x16x32_bf16 v[128:131], v[148:151], v[88:91], v[128:131]
    s_waitcnt lgkmcnt(5)
    v_mfma_f32_16x16x32_bf16 v[132:135], v[152:155], v[88:91], v[132:135]
    ds_read_b128 v[136:139], v114 offset:51200
    ds_read_b128 v[140:143], v114 offset:52224
    ds_read_b128 v[144:147], v114 offset:53248
    ds_read_b128 v[148:151], v114 offset:54272
    ds_read_b128 v[152:155], v114 offset:55296
    s_waitcnt vmcnt(8)
    s_waitcnt lgkmcnt(9)
    v_mfma_f32_16x16x32_bf16 v[116:119], v[156:159], v[92:95], v[116:119]
    s_waitcnt lgkmcnt(8)
    v_mfma_f32_16x16x32_bf16 v[120:123], v[160:163], v[92:95], v[120:123]
    s_waitcnt lgkmcnt(7)
    v_mfma_f32_16x16x32_bf16 v[124:127], v[164:167], v[92:95], v[124:127]
    s_waitcnt lgkmcnt(6)
    v_mfma_f32_16x16x32_bf16 v[128:131], v[168:171], v[92:95], v[128:131]
    s_waitcnt lgkmcnt(5)
    v_mfma_f32_16x16x32_bf16 v[132:135], v[172:175], v[92:95], v[132:135]
    ds_read_b128 v[156:159], v114 offset:56320
    ds_read_b128 v[160:163], v114 offset:57344
    ds_read_b128 v[164:167], v114 offset:58368
    ds_read_b128 v[168:171], v114 offset:59392
    ds_read_b128 v[172:175], v114 offset:60416
    s_waitcnt vmcnt(7)
    s_waitcnt lgkmcnt(9)
    v_mfma_f32_16x16x32_bf16 v[116:119], v[136:139], v[96:99], v[116:119]
    s_waitcnt lgkmcnt(8)
    v_mfma_f32_16x16x32_bf16 v[120:123], v[140:143], v[96:99], v[120:123]
    s_waitcnt lgkmcnt(7)
    v_mfma_f32_16x16x32_bf16 v[124:127], v[144:147], v[96:99], v[124:127]
    s_waitcnt lgkmcnt(6)
    v_mfma_f32_16x16x32_bf16 v[128:131], v[148:151], v[96:99], v[128:131]
    s_waitcnt lgkmcnt(5)
    v_mfma_f32_16x16x32_bf16 v[132:135], v[152:155], v[96:99], v[132:135]
    s_waitcnt vmcnt(6)
    s_waitcnt lgkmcnt(4)
    v_mfma_f32_16x16x32_bf16 v[116:119], v[156:159], v[100:103], v[116:119]
    s_waitcnt lgkmcnt(3)
    v_mfma_f32_16x16x32_bf16 v[120:123], v[160:163], v[100:103], v[120:123]
    s_waitcnt lgkmcnt(2)
    v_mfma_f32_16x16x32_bf16 v[124:127], v[164:167], v[100:103], v[124:127]
    s_waitcnt lgkmcnt(1)
    v_mfma_f32_16x16x32_bf16 v[128:131], v[168:171], v[100:103], v[128:131]
    s_waitcnt lgkmcnt(0)
    v_mfma_f32_16x16x32_bf16 v[132:135], v[172:175], v[100:103], v[132:135]
    s_lshl_b32 s40, s34, 4
    v_add_u32 v4, s40, v3
    v_mul_u32_u24 v4, 160, v4
    v_lshl_add_u32 v176, v2, 3, v4
    v_add_u32 v177, 122880, v176
    v_lshrrev_b32 v5, 2, v3
    v_lshl_add_u32 v4, v2, 2, v5
    v_lshlrev_b32 v4, 7, v4
    v_and_b32 v5, 3, v3
    v_lshl_add_u32 v4, v5, 3, v4
    s_lshl_b32 s40, s34, 5
    s_add_u32 s40, s40, 133120
    v_add_u32 v178, s40, v4
    s_mov_b32 s46, 0xbfb8aa3b
    s_mov_b32 s47, 0xbfb8aa3b
    v_pk_mul_f32 v[8:9], v[116:117], s[46:47]
    v_pk_mul_f32 v[10:11], v[118:119], s[46:47]
    v_pk_mul_f32 v[12:13], v[120:121], s[46:47]
    v_pk_mul_f32 v[14:15], v[122:123], s[46:47]
    v_pk_mul_f32 v[16:17], v[124:125], s[46:47]
    v_pk_mul_f32 v[18:19], v[126:127], s[46:47]
    v_pk_mul_f32 v[20:21], v[128:129], s[46:47]
    v_pk_mul_f32 v[22:23], v[130:131], s[46:47]
    v_pk_mul_f32 v[24:25], v[132:133], s[46:47]
    v_pk_mul_f32 v[26:27], v[134:135], s[46:47]
    s_waitcnt vmcnt(0)
    s_barrier
    ds_read_b64 v[136:137], v177 offset:0
    ds_read_b64 v[138:139], v177 offset:32
    ds_read_b64 v[140:141], v177 offset:64
    ds_read_b64 v[142:143], v177 offset:96
    ds_read_b64 v[144:145], v177 offset:128
    ds_read_b64_tr_b16 v[146:147], v178 offset:0
    ds_read_b64_tr_b16 v[148:149], v178 offset:2048
    ds_read_b64_tr_b16 v[150:151], v178 offset:4096
    ds_read_b64_tr_b16 v[152:153], v178 offset:6144
    ds_read_b64_tr_b16 v[154:155], v178 offset:8192
    v_exp_f32 v8, v8
    v_exp_f32 v9, v9
    v_exp_f32 v10, v10
    v_exp_f32 v11, v11
    v_exp_f32 v12, v12
    v_exp_f32 v13, v13
    v_exp_f32 v14, v14
    v_exp_f32 v15, v15
    v_exp_f32 v16, v16
    v_exp_f32 v17, v17
    v_exp_f32 v18, v18
    v_exp_f32 v19, v19
    v_exp_f32 v20, v20
    v_exp_f32 v21, v21
    v_exp_f32 v22, v22
    v_exp_f32 v23, v23
    v_exp_f32 v24, v24
    v_exp_f32 v25, v25
    v_exp_f32 v26, v26
    v_exp_f32 v27, v27
    v_pk_add_f32 v[8:9], v[8:9], 1.0 op_sel_hi:[1,0]
    v_pk_add_f32 v[10:11], v[10:11], 1.0 op_sel_hi:[1,0]
    v_pk_add_f32 v[12:13], v[12:13], 1.0 op_sel_hi:[1,0]
    v_pk_add_f32 v[14:15], v[14:15], 1.0 op_sel_hi:[1,0]
    v_pk_add_f32 v[16:17], v[16:17], 1.0 op_sel_hi:[1,0]
    v_pk_add_f32 v[18:19], v[18:19], 1.0 op_sel_hi:[1,0]
    v_pk_add_f32 v[20:21], v[20:21], 1.0 op_sel_hi:[1,0]
    v_pk_add_f32 v[22:23], v[22:23], 1.0 op_sel_hi:[1,0]
    v_pk_add_f32 v[24:25], v[24:25], 1.0 op_sel_hi:[1,0]
    v_pk_add_f32 v[26:27], v[26:27], 1.0 op_sel_hi:[1,0]
    v_rcp_f32 v8, v8
    v_rcp_f32 v9, v9
    v_rcp_f32 v10, v10
    v_rcp_f32 v11, v11
    v_rcp_f32 v12, v12
    v_rcp_f32 v13, v13
    v_rcp_f32 v14, v14
    v_rcp_f32 v15, v15
    v_rcp_f32 v16, v16
    v_rcp_f32 v17, v17
    v_rcp_f32 v18, v18
    v_rcp_f32 v19, v19
    v_rcp_f32 v20, v20
    v_rcp_f32 v21, v21
    v_rcp_f32 v22, v22
    v_rcp_f32 v23, v23
    v_rcp_f32 v24, v24
    v_rcp_f32 v25, v25
    v_rcp_f32 v26, v26
    v_rcp_f32 v27, v27
    v_pk_mul_f32 v[8:9], v[8:9], v[116:117]
    v_pk_mul_f32 v[10:11], v[10:11], v[118:119]
    v_pk_mul_f32 v[12:13], v[12:13], v[120:121]
    v_pk_mul_f32 v[14:15], v[14:15], v[122:123]
    v_pk_mul_f32 v[16:17], v[16:17], v[124:125]
    v_pk_mul_f32 v[18:19], v[18:19], v[126:127]
    v_pk_mul_f32 v[20:21], v[20:21], v[128:129]
    v_pk_mul_f32 v[22:23], v[22:23], v[130:131]
    v_pk_mul_f32 v[24:25], v[24:25], v[132:133]
    v_pk_mul_f32 v[26:27], v[26:27], v[134:135]
    s_waitcnt lgkmcnt(0)
    v_lshlrev_b32 v28, 16, v136
    v_and_b32 v29, 0xffff0000, v136
    v_lshlrev_b32 v48, 16, v146
    v_and_b32 v49, 0xffff0000, v146
    v_lshlrev_b32 v30, 16, v137
    v_and_b32 v31, 0xffff0000, v137
    v_lshlrev_b32 v50, 16, v147
    v_and_b32 v51, 0xffff0000, v147
    v_lshlrev_b32 v32, 16, v138
    v_and_b32 v33, 0xffff0000, v138
    v_lshlrev_b32 v52, 16, v148
    v_and_b32 v53, 0xffff0000, v148
    v_lshlrev_b32 v34, 16, v139
    v_and_b32 v35, 0xffff0000, v139
    v_lshlrev_b32 v54, 16, v149
    v_and_b32 v55, 0xffff0000, v149
    v_lshlrev_b32 v36, 16, v140
    v_and_b32 v37, 0xffff0000, v140
    v_lshlrev_b32 v56, 16, v150
    v_and_b32 v57, 0xffff0000, v150
    v_lshlrev_b32 v38, 16, v141
    v_and_b32 v39, 0xffff0000, v141
    v_lshlrev_b32 v58, 16, v151
    v_and_b32 v59, 0xffff0000, v151
    v_lshlrev_b32 v40, 16, v142
    v_and_b32 v41, 0xffff0000, v142
    v_lshlrev_b32 v60, 16, v152
    v_and_b32 v61, 0xffff0000, v152
    v_lshlrev_b32 v42, 16, v143
    v_and_b32 v43, 0xffff0000, v143
    v_lshlrev_b32 v62, 16, v153
    v_and_b32 v63, 0xffff0000, v153
    v_lshlrev_b32 v44, 16, v144
    v_and_b32 v45, 0xffff0000, v144
    v_lshlrev_b32 v64, 16, v154
    v_and_b32 v65, 0xffff0000, v154
    v_lshlrev_b32 v46, 16, v145
    v_and_b32 v47, 0xffff0000, v145
    v_lshlrev_b32 v66, 16, v155
    v_and_b32 v67, 0xffff0000, v155
    v_mov_b32 v180, v111
    v_pk_add_f32 v[68:69], v[28:29], v[110:111] op_sel_hi:[1,0] neg_lo:[0,1] neg_hi:[0,1]
    v_pk_add_f32 v[70:71], v[30:31], v[110:111] op_sel_hi:[1,0] neg_lo:[0,1] neg_hi:[0,1]
    v_pk_add_f32 v[72:73], v[32:33], v[110:111] op_sel_hi:[1,0] neg_lo:[0,1] neg_hi:[0,1]
    v_pk_add_f32 v[74:75], v[34:35], v[110:111] op_sel_hi:[1,0] neg_lo:[0,1] neg_hi:[0,1]
    v_pk_add_f32 v[76:77], v[36:37], v[110:111] op_sel_hi:[1,0] neg_lo:[0,1] neg_hi:[0,1]
    v_pk_add_f32 v[78:79], v[38:39], v[110:111] op_sel_hi:[1,0] neg_lo:[0,1] neg_hi:[0,1]
    v_pk_add_f32 v[80:81], v[40:41], v[110:111] op_sel_hi:[1,0] neg_lo:[0,1] neg_hi:[0,1]
    v_pk_add_f32 v[82:83], v[42:43], v[110:111] op_sel_hi:[1,0] neg_lo:[0,1] neg_hi:[0,1]
    v_pk_add_f32 v[84:85], v[44:45], v[110:111] op_sel_hi:[1,0] neg_lo:[0,1] neg_hi:[0,1]
    v_pk_add_f32 v[86:87], v[46:47], v[110:111] op_sel_hi:[1,0] neg_lo:[0,1] neg_hi:[0,1]
    v_pk_mul_f32 v[68:69], v[68:69], v[180:181] op_sel_hi:[1,0]
    v_pk_mul_f32 v[70:71], v[70:71], v[180:181] op_sel_hi:[1,0]
    v_pk_mul_f32 v[72:73], v[72:73], v[180:181] op_sel_hi:[1,0]
    v_pk_mul_f32 v[74:75], v[74:75], v[180:181] op_sel_hi:[1,0]
    v_pk_mul_f32 v[76:77], v[76:77], v[180:181] op_sel_hi:[1,0]
    v_pk_mul_f32 v[78:79], v[78:79], v[180:181] op_sel_hi:[1,0]
    v_pk_mul_f32 v[80:81], v[80:81], v[180:181] op_sel_hi:[1,0]
    v_pk_mul_f32 v[82:83], v[82:83], v[180:181] op_sel_hi:[1,0]
    v_pk_mul_f32 v[84:85], v[84:85], v[180:181] op_sel_hi:[1,0]
    v_pk_mul_f32 v[86:87], v[86:87], v[180:181] op_sel_hi:[1,0]
    v_pk_mul_f32 v[68:69], v[68:69], v[48:49]
    v_pk_mul_f32 v[70:71], v[70:71], v[50:51]
    v_pk_mul_f32 v[72:73], v[72:73], v[52:53]
    v_pk_mul_f32 v[74:75], v[74:75], v[54:55]
    v_pk_mul_f32 v[76:77], v[76:77], v[56:57]
    v_pk_mul_f32 v[78:79], v[78:79], v[58:59]
    v_pk_mul_f32 v[80:81], v[80:81], v[60:61]
    v_pk_mul_f32 v[82:83], v[82:83], v[62:63]
    v_pk_mul_f32 v[84:85], v[84:85], v[64:65]
    v_pk_mul_f32 v[86:87], v[86:87], v[66:67]
    v_pk_fma_f32 v[68:69], v[68:69], v[8:9], v[28:29]
    v_pk_fma_f32 v[70:71], v[70:71], v[10:11], v[30:31]
    v_pk_fma_f32 v[72:73], v[72:73], v[12:13], v[32:33]
    v_pk_fma_f32 v[74:75], v[74:75], v[14:15], v[34:35]
    v_pk_fma_f32 v[76:77], v[76:77], v[16:17], v[36:37]
    v_pk_fma_f32 v[78:79], v[78:79], v[18:19], v[38:39]
    v_pk_fma_f32 v[80:81], v[80:81], v[20:21], v[40:41]
    v_pk_fma_f32 v[82:83], v[82:83], v[22:23], v[42:43]
    v_pk_fma_f32 v[84:85], v[84:85], v[24:25], v[44:45]
    v_pk_fma_f32 v[86:87], v[86:87], v[26:27], v[46:47]
    v_cvt_pk_bf16_f32 v136, v68, v69
    v_cvt_pk_bf16_f32 v137, v70, v71
    v_cvt_pk_bf16_f32 v138, v72, v73
    v_cvt_pk_bf16_f32 v139, v74, v75
    v_cvt_pk_bf16_f32 v140, v76, v77
    v_cvt_pk_bf16_f32 v141, v78, v79
    v_cvt_pk_bf16_f32 v142, v80, v81
    v_cvt_pk_bf16_f32 v143, v82, v83
    v_cvt_pk_bf16_f32 v144, v84, v85
    v_cvt_pk_bf16_f32 v145, v86, v87
    v_add_u32 v182, 143360, v176
    ds_write_b64 v182, v[136:137] offset:0
    ds_write_b64 v182, v[138:139] offset:32
    ds_write_b64 v182, v[140:141] offset:64
    ds_write_b64 v182, v[142:143] offset:96
    ds_write_b64 v182, v[144:145] offset:128
    s_mul_i32 s40, s34, 2560
    s_add_u32 s40, s40, 143360
    v_add_u32 v4, s40, v7
    s_waitcnt lgkmcnt(0)
    ds_read_b128 v[8:11], v4 offset:0
    ds_read_b128 v[12:15], v4 offset:1024
    ds_read_b128 v[16:19], v4 offset:2048
    s_mul_i32 s40, s34, 20480
    s_add_u32 s40, s40, s45
    s_waitcnt lgkmcnt(0)
    buffer_store_dwordx4 v[8:11], v104, s[16:19], s40 offen
    buffer_store_dwordx4 v[12:15], v105, s[16:19], s40 offen
    s_mov_b32 exec_hi, 0
    buffer_store_dwordx4 v[16:19], v106, s[16:19], s40 offen
    s_mov_b64 exec, -1
k3_kernel_end:
    s_endpgm
.section .rodata,"a"
.p2align 6
.amdhsa_kernel k1_kernel
  .amdhsa_next_free_vgpr 256
  .amdhsa_next_free_sgpr 102
  .amdhsa_accum_offset 256
  .amdhsa_group_segment_fixed_size 0
  .amdhsa_kernarg_size 112
  .amdhsa_user_sgpr_count 2
  .amdhsa_user_sgpr_kernarg_segment_ptr 1
  .amdhsa_system_sgpr_workgroup_id_x 1
.end_amdhsa_kernel
.p2align 6
.amdhsa_kernel k2_kernel
  .amdhsa_next_free_vgpr 197
  .amdhsa_next_free_sgpr 102
  .amdhsa_accum_offset 200
  .amdhsa_group_segment_fixed_size 0
  .amdhsa_kernarg_size 112
  .amdhsa_user_sgpr_count 2
  .amdhsa_user_sgpr_kernarg_segment_ptr 1
  .amdhsa_system_sgpr_workgroup_id_x 1
.end_amdhsa_kernel
.p2align 6
.amdhsa_kernel k3_kernel
  .amdhsa_next_free_vgpr 183
  .amdhsa_next_free_sgpr 102
  .amdhsa_accum_offset 184
  .amdhsa_group_segment_fixed_size 0
  .amdhsa_kernarg_size 112
  .amdhsa_user_sgpr_count 2
  .amdhsa_user_sgpr_kernarg_segment_ptr 1
  .amdhsa_system_sgpr_workgroup_id_x 1
.end_amdhsa_kernel
```

```asm
; @launch kernel=k1_kernel grid=(256,1,1) block=(512,1,1) lds=163840
; @launch kernel=k2_kernel grid=(512,1,1) block=(256,1,1) lds=81920
; @launch kernel=k3_kernel grid=(256,1,1) block=(256,1,1) lds=153600
.amdgcn_target "amdgcn-amd-amdhsa--gfx950"
.text
.globl k1_kernel
.p2align 8
.type k1_kernel,@function
k1_kernel:
    s_cmp_ge_u32 s2, 256
    s_cbranch_scc1 k1_kernel_end
    s_load_dwordx2 s[4:5], s[0:1], 0
    s_load_dwordx2 s[8:9], s[0:1], 56
    s_load_dwordx2 s[12:13], s[0:1], 8
    s_load_dwordx2 s[16:17], s[0:1], 16
    s_load_dwordx2 s[20:21], s[0:1], 24
    s_load_dwordx2 s[24:25], s[0:1], 104
    s_load_dwordx2 s[28:29], s[0:1], 96
    s_load_dwordx2 s[32:33], s[0:1], 64
    s_load_dwordx2 s[36:37], s[0:1], 32
    v_lshrrev_b32 v2, 6, v0
    v_and_b32 v1, 63, v0
    v_readfirstlane_b32 s42, v2
    v_lshrrev_b32 v2, 4, v1
    v_and_b32 v3, 15, v1
    s_and_b32 s48, s2, 7
    s_lshr_b32 s49, s2, 3
    s_lshr_b32 s66, s48, 1
    s_and_b32 s67, s48, 1
    s_lshl_b32 s40, s66, 3
    s_and_b32 s48, s49, 7
    s_add_u32 s40, s40, s48
    s_lshl_b32 s41, s67, 2
    s_lshr_b32 s48, s49, 3
    s_add_u32 s41, s41, s48
    s_mul_i32 s52, s40, 81920
    s_mul_i32 s54, s41, 192
    s_add_u32 s53, s54, 1536
    s_lshl_b32 s60, s42, 11
    s_mul_i32 s61, s42, 3072
    s_mov_b32 s6, 2621440
    s_mov_b32 s7, 0x20000
    s_mov_b32 s10, 1966080
    s_mov_b32 s11, 0x20000
    s_lshl_b32 s48, s42, 3
    v_add_u32 v4, s48, v2
    v_and_b32 v5, 15, v4
    v_xor_b32 v5, v5, v3
    v_mul_u32_u24 v4, 1280, v4
    v_lshl_add_u32 v38, v5, 4, v4
    v_add_u32 v4, s48, v2
    v_add_u32 v4, 4, v4
    v_and_b32 v5, 15, v4
    v_xor_b32 v5, v5, v3
    v_mul_u32_u24 v4, 1280, v4
    v_lshl_add_u32 v39, v5, 4, v4
    s_mul_i32 s48, s42, 192
    v_add_u32 v4, s48, v1
    v_mul_u32_u24 v5, 43691, v4
    v_lshrrev_b32 v5, 19, v5
    v_mul_u32_u24 v6, 12, v5
    v_sub_u32 v4, v4, v6
    v_lshrrev_b32 v6, 2, v5
    v_and_b32 v6, 2, v6
    v_xor_b32 v4, v4, v6
    v_mul_u32_u24 v5, 3072, v5
    v_lshl_add_u32 v40, v4, 4, v5
    v_add_u32 v4, s48, v1
    v_add_u32 v4, 64, v4
    v_mul_u32_u24 v5, 43691, v4
    v_lshrrev_b32 v5, 19, v5
    v_mul_u32_u24 v6, 12, v5
    v_sub_u32 v4, v4, v6
    v_lshrrev_b32 v6, 2, v5
    v_and_b32 v6, 2, v6
    v_xor_b32 v4, v4, v6
    v_mul_u32_u24 v5, 3072, v5
    v_lshl_add_u32 v41, v4, 4, v5
    v_add_u32 v4, s48, v1
    v_add_u32 v4, 128, v4
    v_mul_u32_u24 v5, 43691, v4
    v_lshrrev_b32 v5, 19, v5
    v_mul_u32_u24 v6, 12, v5
    v_sub_u32 v4, v4, v6
    v_lshrrev_b32 v6, 2, v5
    v_and_b32 v6, 2, v6
    v_xor_b32 v4, v4, v6
    v_mul_u32_u24 v5, 3072, v5
    v_lshl_add_u32 v42, v4, 4, v5
    s_add_u32 s48, s40, s41
    s_mul_i32 s49, s48, 52
    s_lshr_b32 s49, s49, 8
    s_mul_i32 s49, s49, 5
    s_sub_u32 s51, s48, s49
    s_add_u32 s49, s51, 0
    s_sub_u32 s50, s49, 5
    s_cmp_ge_u32 s49, 5
    s_cselect_b32 s49, s50, s49
    s_lshl_b32 s90, s49, 8
    s_mul_i32 s95, s49, 393216
    s_add_u32 s49, s51, 1
    s_sub_u32 s50, s49, 5
    s_cmp_ge_u32 s49, 5
    s_cselect_b32 s49, s50, s49
    s_lshl_b32 s91, s49, 8
    s_mul_i32 s96, s49, 393216
    s_waitcnt lgkmcnt(0)
    s_add_u32 s65, s52, s90
    s_add_u32 m0, s60, 0
    s_nop 0
    buffer_load_dwordx4 v38, s[4:7], s65 offen lds
    s_add_u32 s65, s52, s90
    s_add_u32 m0, s60, 1024
    s_nop 0
    buffer_load_dwordx4 v39, s[4:7], s65 offen lds
    s_add_u32 s65, s53, s95
    s_add_u32 m0, s61, 81920
    s_nop 0
    buffer_load_dwordx4 v40, s[8:11], s65 offen lds
    s_add_u32 s65, s53, s95
    s_add_u32 m0, s61, 82944
    s_nop 0
    buffer_load_dwordx4 v41, s[8:11], s65 offen lds
    s_add_u32 s65, s53, s95
    s_add_u32 m0, s61, 83968
    s_nop 0
    buffer_load_dwordx4 v42, s[8:11], s65 offen lds
    s_add_u32 s49, s51, 2
    s_sub_u32 s50, s49, 5
    s_cmp_ge_u32 s49, 5
    s_cselect_b32 s49, s50, s49
    s_lshl_b32 s92, s49, 8
    s_mul_i32 s97, s49, 393216
    s_add_u32 s49, s51, 3
    s_sub_u32 s50, s49, 5
    s_cmp_ge_u32 s49, 5
    s_cselect_b32 s49, s50, s49
    s_lshl_b32 s93, s49, 8
    s_mul_i32 s98, s49, 393216
    s_add_u32 s49, s51, 4
    s_sub_u32 s50, s49, 5
    s_cmp_ge_u32 s49, 5
    s_cselect_b32 s49, s50, s49
    s_lshl_b32 s94, s49, 8
    s_mul_i32 s99, s49, 393216
    s_mov_b32 s14, 2621440
    s_mov_b32 s15, 0x20000
    s_mov_b32 s18, 2621440
    s_mov_b32 s19, 0x20000
    s_mov_b32 s22, 5120
    s_mov_b32 s23, 0x20000
    s_mov_b32 s26, 15990784
    s_mov_b32 s27, 0x20000
    s_mov_b32 s30, 256
    s_mov_b32 s31, 0x20000
    s_mov_b32 s34, 8388608
    s_mov_b32 s35, 0x20000
    s_mov_b32 s38, 2621440
    s_mov_b32 s39, 0x20000
    v_lshlrev_b32 v36, 7, v1
    s_barrier
    s_add_u32 s65, s52, s91
    s_add_u32 m0, s60, 16384
    s_nop 0
    buffer_load_dwordx4 v38, s[4:7], s65 offen lds
    s_add_u32 s65, s52, s91
    s_add_u32 m0, s60, 17408
    s_nop 0
    buffer_load_dwordx4 v39, s[4:7], s65 offen lds
    s_add_u32 s65, s53, s96
    s_add_u32 m0, s61, 106496
    s_nop 0
    buffer_load_dwordx4 v40, s[8:11], s65 offen lds
    s_add_u32 s65, s53, s96
    s_add_u32 m0, s61, 107520
    s_nop 0
    buffer_load_dwordx4 v41, s[8:11], s65 offen lds
    s_add_u32 s65, s53, s96
    s_add_u32 m0, s61, 108544
    s_nop 0
    buffer_load_dwordx4 v42, s[8:11], s65 offen lds
    s_cmp_lg_u32 s42, 7
    s_cbranch_scc1 k1_shk_1
    v_lshlrev_b32 v4, 4, v1
    s_mul_i32 s48, s41, 640
    s_mov_b32 m0, 160768
    s_mov_b32 exec_lo, -1
    s_mov_b32 exec_hi, 0xff
    buffer_load_dwordx4 v4, s[20:23], s48 offen lds
    s_mov_b64 exec, -1
k1_shk_1:
    s_and_b32 s43, s42, 1
    s_lshr_b32 s44, s42, 1
    s_and_b32 s44, s44, 1
    s_lshr_b32 s45, s42, 2
    s_xor_b32 s46, s43, s45
    s_lshl_b32 s47, s44, 1
    s_add_u32 s47, s47, s46
    s_mov_b32 s55, 0x3727c5ac
    s_mov_b32 s56, 0x3f803f80
    s_mov_b32 s58, 0xbdd2d3e8
    s_mov_b32 s59, 0xbdd2d3e8
    s_lshl_b32 s48, s45, 1
    s_add_u32 s63, s48, s44
    s_xor_b32 s64, s63, 1
    v_xor_b32 v4, v2, v3
    v_lshlrev_b32 v6, 8, v3
    s_lshl_b32 s48, s44, 13
    s_lshl_b32 s49, s46, 12
    s_add_u32 s50, s48, s49
    s_xor_b32 s49, s49, 4096
    s_add_u32 s51, s48, s49
    s_lshl_b32 s48, s63, 2
    v_xor_b32 v5, s48, v4
    v_lshl_add_u32 v5, v5, 4, v6
    v_add_u32 v45, s50, v5
    v_add_u32 v46, s51, v5
    s_lshl_b32 s48, s64, 2
    v_xor_b32 v5, s48, v4
    v_lshl_add_u32 v5, v5, 4, v6
    v_add_u32 v47, s50, v5
    v_add_u32 v216, s51, v5
    v_lshrrev_b32 v5, 2, v3
    v_lshl_add_u32 v4, v2, 3, v5
    v_mul_u32_u24 v4, 192, v4
    v_and_b32 v5, 3, v3
    v_lshl_add_u32 v4, v5, 3, v4
    v_and_b32 v5, 1, v2
    s_mul_i32 s51, s43, 3
    s_mul_i32 s49, s63, 6144
    s_add_u32 s49, s49, 81920
    s_mul_i32 s50, s64, 6144
    s_add_u32 s50, s50, 81920
    s_add_u32 s48, s51, 0
    v_xor_b32 v6, s48, v5
    v_lshl_add_u32 v6, v6, 5, v4
    v_add_u32 v217, s49, v6
    v_add_u32 v220, s50, v6
    s_add_u32 s48, s51, 1
    v_xor_b32 v6, s48, v5
    v_lshl_add_u32 v6, v6, 5, v4
    v_add_u32 v218, s49, v6
    v_add_u32 v221, s50, v6
    s_add_u32 s48, s51, 2
    v_xor_b32 v6, s48, v5
    v_lshl_add_u32 v6, v6, 5, v4
    v_add_u32 v219, s49, v6
    v_add_u32 v222, s50, v6
    v_mov_b32 v244, s56
    v_mov_b32 v245, s56
    v_mov_b32 v246, s56
    v_mov_b32 v247, s56
    v_mul_u32_u24 v43, 205, v1
    v_lshrrev_b32 v43, 11, v43
    v_mul_u32_u24 v4, 10, v43
    v_sub_u32 v44, v1, v4
    s_lshl_b32 s48, s42, 3
    v_lshl_add_u32 v4, v43, 1, s48
    v_min_u32 v4, 62, v4
    v_mul_u32_u24 v4, 160, v4
    v_lshl_add_u32 v7, v44, 4, v4
    v_lshlrev_b32 v215, 10, v1
    s_lshl_b32 s89, s2, 3
    s_add_u32 s89, s89, s42
    s_waitcnt vmcnt(5)
    s_barrier
    ds_read_b128 v[48:51], v45 offset:0
    ds_read_b128 v[52:55], v46 offset:0
    ds_read_b128 v[56:59], v47 offset:0
    ds_read_b128 v[60:63], v216 offset:0
    ds_read_b64_tr_b16 v[128:129], v217 offset:0
    ds_read_b64_tr_b16 v[130:131], v217 offset:768
    ds_read_b64_tr_b16 v[132:133], v218 offset:0
    ds_read_b64_tr_b16 v[134:135], v218 offset:768
    ds_read_b64_tr_b16 v[136:137], v219 offset:0
    ds_read_b64_tr_b16 v[138:139], v219 offset:768
    ds_read_b64_tr_b16 v[140:141], v220 offset:0
    ds_read_b64_tr_b16 v[142:143], v220 offset:768
    ds_read_b64_tr_b16 v[144:145], v221 offset:0
    ds_read_b64_tr_b16 v[146:147], v221 offset:768
    ds_read_b64_tr_b16 v[148:149], v222 offset:0
    ds_read_b64_tr_b16 v[150:151], v222 offset:768
    s_add_u32 s65, s52, s92
    s_add_u32 m0, s60, 32768
    s_nop 0
    buffer_load_dwordx4 v38, s[4:7], s65 offen lds
    s_add_u32 s65, s52, s92
    s_add_u32 m0, s60, 33792
    s_nop 0
    buffer_load_dwordx4 v39, s[4:7], s65 offen lds
    s_add_u32 s65, s53, s97
    s_add_u32 m0, s61, 131072
    s_nop 0
    buffer_load_dwordx4 v40, s[8:11], s65 offen lds
    s_add_u32 s65, s53, s97
    s_add_u32 m0, s61, 132096
    s_nop 0
    buffer_load_dwordx4 v41, s[8:11], s65 offen lds
    s_add_u32 s65, s53, s97
    s_add_u32 m0, s61, 133120
    s_nop 0
    buffer_load_dwordx4 v42, s[8:11], s65 offen lds
    s_waitcnt vmcnt(5)
    s_waitcnt lgkmcnt(0)
    s_barrier
    ds_read_b128 v[64:67], v45 offset:16384
    ds_read_b128 v[68:71], v46 offset:16384
    ds_read_b128 v[72:75], v47 offset:16384
    ds_read_b128 v[76:79], v216 offset:16384
    ds_read_b64_tr_b16 v[152:153], v217 offset:24576
    ds_read_b64_tr_b16 v[154:155], v217 offset:25344
    ds_read_b64_tr_b16 v[156:157], v218 offset:24576
    ds_read_b64_tr_b16 v[158:159], v218 offset:25344
    ds_read_b64_tr_b16 v[160:161], v219 offset:24576
    ds_read_b64_tr_b16 v[162:163], v219 offset:25344
    ds_read_b64_tr_b16 v[164:165], v220 offset:24576
    ds_read_b64_tr_b16 v[166:167], v220 offset:25344
    ds_read_b64_tr_b16 v[168:169], v221 offset:24576
    ds_read_b64_tr_b16 v[170:171], v221 offset:25344
    ds_read_b64_tr_b16 v[172:173], v222 offset:24576
    ds_read_b64_tr_b16 v[174:175], v222 offset:25344
    v_mfma_f32_16x16x32_bf16 v[176:179], v[128:131], v[48:51], 0
    v_mfma_f32_16x16x32_bf16 v[180:183], v[128:131], v[52:55], 0
    s_add_u32 s65, s52, s93
    s_add_u32 m0, s60, 49152
    s_nop 0
    buffer_load_dwordx4 v38, s[4:7], s65 offen lds
    v_mfma_f32_16x16x32_bf16 v[224:227], v[128:131], v[244:247], 0
    v_mfma_f32_16x16x32_bf16 v[184:187], v[132:135], v[48:51], 0
    v_mfma_f32_16x16x32_bf16 v[188:191], v[132:135], v[52:55], 0
    s_add_u32 s65, s52, s93
    s_add_u32 m0, s60, 50176
    s_nop 0
    buffer_load_dwordx4 v39, s[4:7], s65 offen lds
    v_mfma_f32_16x16x32_bf16 v[228:231], v[132:135], v[244:247], 0
    v_mfma_f32_16x16x32_bf16 v[192:195], v[136:139], v[48:51], 0
    v_mfma_f32_16x16x32_bf16 v[196:199], v[136:139], v[52:55], 0
    s_add_u32 s65, s53, s98
    s_add_u32 m0, s61, 81920
    s_nop 0
    buffer_load_dwordx4 v40, s[8:11], s65 offen lds
    v_mfma_f32_16x16x32_bf16 v[232:235], v[136:139], v[244:247], 0
    v_mfma_f32_16x16x32_bf16 v[236:239], v[244:247], v[48:51], 0
    v_mfma_f32_16x16x32_bf16 v[240:243], v[48:51], v[48:51], 0
    s_add_u32 s65, s53, s98
    s_add_u32 m0, s61, 82944
    s_nop 0
    buffer_load_dwordx4 v41, s[8:11], s65 offen lds
    v_mfma_f32_16x16x32_bf16 v[176:179], v[140:143], v[56:59], v[176:179]
    v_mfma_f32_16x16x32_bf16 v[180:183], v[140:143], v[60:63], v[180:183]
    v_mfma_f32_16x16x32_bf16 v[184:187], v[144:147], v[56:59], v[184:187]
    s_add_u32 s65, s53, s98
    s_add_u32 m0, s61, 83968
    s_nop 0
    buffer_load_dwordx4 v42, s[8:11], s65 offen lds
    v_mfma_f32_16x16x32_bf16 v[188:191], v[144:147], v[60:63], v[188:191]
    v_mfma_f32_16x16x32_bf16 v[192:195], v[148:151], v[56:59], v[192:195]
    v_mfma_f32_16x16x32_bf16 v[196:199], v[148:151], v[60:63], v[196:199]
    v_mfma_f32_16x16x32_bf16 v[236:239], v[244:247], v[56:59], v[236:239]
    v_mfma_f32_16x16x32_bf16 v[240:243], v[56:59], v[56:59], v[240:243]
    s_waitcnt vmcnt(5)
    s_waitcnt lgkmcnt(0)
    s_barrier
    ds_read_b128 v[80:83], v45 offset:32768
    ds_read_b128 v[84:87], v46 offset:32768
    ds_read_b128 v[88:91], v47 offset:32768
    ds_read_b128 v[92:95], v216 offset:32768
    ds_read_b64_tr_b16 v[128:129], v217 offset:49152
    ds_read_b64_tr_b16 v[130:131], v217 offset:49920
    ds_read_b64_tr_b16 v[132:133], v218 offset:49152
    ds_read_b64_tr_b16 v[134:135], v218 offset:49920
    ds_read_b64_tr_b16 v[136:137], v219 offset:49152
    ds_read_b64_tr_b16 v[138:139], v219 offset:49920
    ds_read_b64_tr_b16 v[140:141], v220 offset:49152
    ds_read_b64_tr_b16 v[142:143], v220 offset:49920
    ds_read_b64_tr_b16 v[144:145], v221 offset:49152
    ds_read_b64_tr_b16 v[146:147], v221 offset:49920
    ds_read_b64_tr_b16 v[148:149], v222 offset:49152
    ds_read_b64_tr_b16 v[150:151], v222 offset:49920
    v_mfma_f32_16x16x32_bf16 v[176:179], v[152:155], v[64:67], v[176:179]
    v_mfma_f32_16x16x32_bf16 v[180:183], v[152:155], v[68:71], v[180:183]
    s_add_u32 s65, s52, s94
    s_add_u32 m0, s60, 65536
    s_nop 0
    buffer_load_dwordx4 v38, s[4:7], s65 offen lds
    v_mfma_f32_16x16x32_bf16 v[224:227], v[152:155], v[244:247], v[224:227]
    v_mfma_f32_16x16x32_bf16 v[184:187], v[156:159], v[64:67], v[184:187]
    v_mfma_f32_16x16x32_bf16 v[188:191], v[156:159], v[68:71], v[188:191]
    s_add_u32 s65, s52, s94
    s_add_u32 m0, s60, 66560
    s_nop 0
    buffer_load_dwordx4 v39, s[4:7], s65 offen lds
    v_mfma_f32_16x16x32_bf16 v[228:231], v[156:159], v[244:247], v[228:231]
    v_mfma_f32_16x16x32_bf16 v[192:195], v[160:163], v[64:67], v[192:195]
    v_mfma_f32_16x16x32_bf16 v[196:199], v[160:163], v[68:71], v[196:199]
    s_add_u32 s65, s53, s99
    s_add_u32 m0, s61, 106496
    s_nop 0
    buffer_load_dwordx4 v40, s[8:11], s65 offen lds
    v_mfma_f32_16x16x32_bf16 v[232:235], v[160:163], v[244:247], v[232:235]
    v_mfma_f32_16x16x32_bf16 v[236:239], v[244:247], v[64:67], v[236:239]
    v_mfma_f32_16x16x32_bf16 v[240:243], v[64:67], v[64:67], v[240:243]
    s_add_u32 s65, s53, s99
    s_add_u32 m0, s61, 107520
    s_nop 0
    buffer_load_dwordx4 v41, s[8:11], s65 offen lds
    v_mfma_f32_16x16x32_bf16 v[176:179], v[164:167], v[72:75], v[176:179]
    v_mfma_f32_16x16x32_bf16 v[180:183], v[164:167], v[76:79], v[180:183]
    v_mfma_f32_16x16x32_bf16 v[184:187], v[168:171], v[72:75], v[184:187]
    s_add_u32 s65, s53, s99
    s_add_u32 m0, s61, 108544
    s_nop 0
    buffer_load_dwordx4 v42, s[8:11], s65 offen lds
    v_mfma_f32_16x16x32_bf16 v[188:191], v[168:171], v[76:79], v[188:191]
    v_mfma_f32_16x16x32_bf16 v[192:195], v[172:175], v[72:75], v[192:195]
    v_mfma_f32_16x16x32_bf16 v[196:199], v[172:175], v[76:79], v[196:199]
    s_lshr_b32 s48, s2, 3
    s_lshl_b32 s48, s48, 3
    s_add_u32 s48, s48, s42
    s_lshl_b32 s48, s48, 13
    s_lshl_b32 s49, s66, 21
    s_add_u32 s48, s48, s49
    s_add_u32 s48, s48, 0
    s_mov_b64 exec, 0xff
    buffer_load_dword v37, v215, s[32:35], s48 offen
    s_mov_b64 exec, -1
    v_mfma_f32_16x16x32_bf16 v[236:239], v[244:247], v[72:75], v[236:239]
    v_mfma_f32_16x16x32_bf16 v[240:243], v[72:75], v[72:75], v[240:243]
    s_waitcnt vmcnt(6)
    s_waitcnt lgkmcnt(0)
    s_barrier
    ds_read_b128 v[96:99], v45 offset:49152
    ds_read_b128 v[100:103], v46 offset:49152
    ds_read_b128 v[104:107], v47 offset:49152
    ds_read_b128 v[108:111], v216 offset:49152
    ds_read_b64_tr_b16 v[152:153], v217 offset:0
    ds_read_b64_tr_b16 v[154:155], v217 offset:768
    ds_read_b64_tr_b16 v[156:157], v218 offset:0
    ds_read_b64_tr_b16 v[158:159], v218 offset:768
    ds_read_b64_tr_b16 v[160:161], v219 offset:0
    ds_read_b64_tr_b16 v[162:163], v219 offset:768
    ds_read_b64_tr_b16 v[164:165], v220 offset:0
    ds_read_b64_tr_b16 v[166:167], v220 offset:768
    ds_read_b64_tr_b16 v[168:169], v221 offset:0
    ds_read_b64_tr_b16 v[170:171], v221 offset:768
    ds_read_b64_tr_b16 v[172:173], v222 offset:0
    ds_read_b64_tr_b16 v[174:175], v222 offset:768
    v_mfma_f32_16x16x32_bf16 v[176:179], v[128:131], v[80:83], v[176:179]
    v_mfma_f32_16x16x32_bf16 v[180:183], v[128:131], v[84:87], v[180:183]
    s_add_u32 s65, s54, s95
    s_add_u32 m0, s61, 131072
    s_nop 0
    buffer_load_dwordx4 v40, s[8:11], s65 offen lds
    v_mfma_f32_16x16x32_bf16 v[224:227], v[128:131], v[244:247], v[224:227]
    v_mfma_f32_16x16x32_bf16 v[184:187], v[132:135], v[80:83], v[184:187]
    v_mfma_f32_16x16x32_bf16 v[188:191], v[132:135], v[84:87], v[188:191]
    s_add_u32 s65, s54, s95
    s_add_u32 m0, s61, 132096
    s_nop 0
    buffer_load_dwordx4 v41, s[8:11], s65 offen lds
    v_mfma_f32_16x16x32_bf16 v[228:231], v[132:135], v[244:247], v[228:231]
    v_mfma_f32_16x16x32_bf16 v[192:195], v[136:139], v[80:83], v[192:195]
    v_mfma_f32_16x16x32_bf16 v[196:199], v[136:139], v[84:87], v[196:199]
    s_add_u32 s65, s54, s95
    s_add_u32 m0, s61, 133120
    s_nop 0
    buffer_load_dwordx4 v42, s[8:11], s65 offen lds
    v_mfma_f32_16x16x32_bf16 v[232:235], v[136:139], v[244:247], v[232:235]
    v_mfma_f32_16x16x32_bf16 v[236:239], v[244:247], v[80:83], v[236:239]
    v_mfma_f32_16x16x32_bf16 v[240:243], v[80:83], v[80:83], v[240:243]
    s_lshr_b32 s48, s2, 3
    s_lshl_b32 s48, s48, 3
    s_add_u32 s48, s48, s42
    s_lshl_b32 s48, s48, 13
    s_lshl_b32 s49, s66, 21
    s_add_u32 s48, s48, s49
    s_add_u32 s48, s48, 128
    s_mov_b64 exec, 0xff
    buffer_load_dword v37, v215, s[32:35], s48 offen
    s_mov_b64 exec, -1
    v_mfma_f32_16x16x32_bf16 v[176:179], v[140:143], v[88:91], v[176:179]
    v_mfma_f32_16x16x32_bf16 v[180:183], v[140:143], v[92:95], v[180:183]
    v_mfma_f32_16x16x32_bf16 v[184:187], v[144:147], v[88:91], v[184:187]
    s_mul_i32 s48, s89, 1280
    s_add_u32 s48, s48, 0
    s_mov_b64 exec, 0x1f
    buffer_load_dword v37, v36, s[36:39], s48 offen
    s_mov_b64 exec, -1
    v_mfma_f32_16x16x32_bf16 v[188:191], v[144:147], v[92:95], v[188:191]
    v_mfma_f32_16x16x32_bf16 v[192:195], v[148:151], v[88:91], v[192:195]
    v_mfma_f32_16x16x32_bf16 v[196:199], v[148:151], v[92:95], v[196:199]
    v_mfma_f32_16x16x32_bf16 v[236:239], v[244:247], v[88:91], v[236:239]
    v_mfma_f32_16x16x32_bf16 v[240:243], v[88:91], v[88:91], v[240:243]
    s_waitcnt vmcnt(6)
    s_waitcnt lgkmcnt(0)
    s_barrier
    v_add_u32 v45, 0x10000, v45
    v_add_u32 v46, 0x10000, v46
    v_add_u32 v47, 0x10000, v47
    v_add_u32 v216, 0x10000, v216
    ds_read_b128 v[112:115], v45 offset:0
    ds_read_b128 v[116:119], v46 offset:0
    ds_read_b128 v[120:123], v47 offset:0
    ds_read_b128 v[124:127], v216 offset:0
    ds_read_b64_tr_b16 v[128:129], v217 offset:24576
    ds_read_b64_tr_b16 v[130:131], v217 offset:25344
    ds_read_b64_tr_b16 v[132:133], v218 offset:24576
    ds_read_b64_tr_b16 v[134:135], v218 offset:25344
    ds_read_b64_tr_b16 v[136:137], v219 offset:24576
    ds_read_b64_tr_b16 v[138:139], v219 offset:25344
    ds_read_b64_tr_b16 v[140:141], v220 offset:24576
    ds_read_b64_tr_b16 v[142:143], v220 offset:25344
    ds_read_b64_tr_b16 v[144:145], v221 offset:24576
    ds_read_b64_tr_b16 v[146:147], v221 offset:25344
    ds_read_b64_tr_b16 v[148:149], v222 offset:24576
    ds_read_b64_tr_b16 v[150:151], v222 offset:25344
    v_mfma_f32_16x16x32_bf16 v[176:179], v[152:155], v[96:99], v[176:179]
    v_mfma_f32_16x16x32_bf16 v[180:183], v[152:155], v[100:103], v[180:183]
    s_add_u32 s65, s54, s96
    s_add_u32 m0, s61, 81920
    s_nop 0
    buffer_load_dwordx4 v40, s[8:11], s65 offen lds
    v_mfma_f32_16x16x32_bf16 v[224:227], v[152:155], v[244:247], v[224:227]
    v_mfma_f32_16x16x32_bf16 v[184:187], v[156:159], v[96:99], v[184:187]
    v_mfma_f32_16x16x32_bf16 v[188:191], v[156:159], v[100:103], v[188:191]
    s_add_u32 s65, s54, s96
    s_add_u32 m0, s61, 82944
    s_nop 0
    buffer_load_dwordx4 v41, s[8:11], s65 offen lds
    v_mfma_f32_16x16x32_bf16 v[228:231], v[156:159], v[244:247], v[228:231]
    v_mfma_f32_16x16x32_bf16 v[192:195], v[160:163], v[96:99], v[192:195]
    v_mfma_f32_16x16x32_bf16 v[196:199], v[160:163], v[100:103], v[196:199]
    s_add_u32 s65, s54, s96
    s_add_u32 m0, s61, 83968
    s_nop 0
    buffer_load_dwordx4 v42, s[8:11], s65 offen lds
    v_mfma_f32_16x16x32_bf16 v[232:235], v[160:163], v[244:247], v[232:235]
    v_mfma_f32_16x16x32_bf16 v[236:239], v[244:247], v[96:99], v[236:239]
    v_mfma_f32_16x16x32_bf16 v[240:243], v[96:99], v[96:99], v[240:243]
    v_mov_b32 v214, 14712832
    buffer_load_dwordx2 v[212:213], v214, s[24:27], 0 offen sc1
    v_mfma_f32_16x16x32_bf16 v[176:179], v[164:167], v[104:107], v[176:179]
    v_mfma_f32_16x16x32_bf16 v[180:183], v[164:167], v[108:111], v[180:183]
    v_mfma_f32_16x16x32_bf16 v[184:187], v[168:171], v[104:107], v[184:187]
    s_lshr_b32 s48, s2, 3
    s_lshl_b32 s48, s48, 3
    s_add_u32 s48, s48, s42
    s_lshl_b32 s48, s48, 13
    s_lshl_b32 s49, s66, 21
    s_add_u32 s48, s48, s49
    s_add_u32 s48, s48, 256
    s_mov_b64 exec, 0xff
    buffer_load_dword v37, v215, s[32:35], s48 offen
    s_mov_b64 exec, -1
    v_mfma_f32_16x16x32_bf16 v[188:191], v[168:171], v[108:111], v[188:191]
    v_mfma_f32_16x16x32_bf16 v[192:195], v[172:175], v[104:107], v[192:195]
    v_mfma_f32_16x16x32_bf16 v[196:199], v[172:175], v[108:111], v[196:199]
    v_mfma_f32_16x16x32_bf16 v[236:239], v[244:247], v[104:107], v[236:239]
    v_mfma_f32_16x16x32_bf16 v[240:243], v[104:107], v[104:107], v[240:243]
    s_waitcnt vmcnt(7)
    s_waitcnt lgkmcnt(0)
    s_barrier
    ds_read_b64_tr_b16 v[152:153], v217 offset:49152
    ds_read_b64_tr_b16 v[154:155], v217 offset:49920
    ds_read_b64_tr_b16 v[156:157], v218 offset:49152
    ds_read_b64_tr_b16 v[158:159], v218 offset:49920
    ds_read_b64_tr_b16 v[160:161], v219 offset:49152
    ds_read_b64_tr_b16 v[162:163], v219 offset:49920
    ds_read_b64_tr_b16 v[164:165], v220 offset:49152
    ds_read_b64_tr_b16 v[166:167], v220 offset:49920
    ds_read_b64_tr_b16 v[168:169], v221 offset:49152
    ds_read_b64_tr_b16 v[170:171], v221 offset:49920
    ds_read_b64_tr_b16 v[172:173], v222 offset:49152
    ds_read_b64_tr_b16 v[174:175], v222 offset:49920
    v_mfma_f32_16x16x32_bf16 v[176:179], v[128:131], v[112:115], v[176:179]
    v_mfma_f32_16x16x32_bf16 v[180:183], v[128:131], v[116:119], v[180:183]
    s_add_u32 s65, s54, s97
    s_add_u32 m0, s61, 106496
    s_nop 0
    buffer_load_dwordx4 v40, s[8:11], s65 offen lds
    v_mfma_f32_16x16x32_bf16 v[224:227], v[128:131], v[244:247], v[224:227]
    v_mfma_f32_16x16x32_bf16 v[184:187], v[132:135], v[112:115], v[184:187]
    v_mfma_f32_16x16x32_bf16 v[188:191], v[132:135], v[116:119], v[188:191]
    s_add_u32 s65, s54, s97
    s_add_u32 m0, s61, 107520
    s_nop 0
    buffer_load_dwordx4 v41, s[8:11], s65 offen lds
    v_mfma_f32_16x16x32_bf16 v[228:231], v[132:135], v[244:247], v[228:231]
    v_mfma_f32_16x16x32_bf16 v[192:195], v[136:139], v[112:115], v[192:195]
    v_mfma_f32_16x16x32_bf16 v[196:199], v[136:139], v[116:119], v[196:199]
    s_add_u32 s65, s54, s97
    s_add_u32 m0, s61, 108544
    s_nop 0
    buffer_load_dwordx4 v42, s[8:11], s65 offen lds
    v_mfma_f32_16x16x32_bf16 v[232:235], v[136:139], v[244:247], v[232:235]
    v_mfma_f32_16x16x32_bf16 v[236:239], v[244:247], v[112:115], v[236:239]
    v_mfma_f32_16x16x32_bf16 v[240:243], v[112:115], v[112:115], v[240:243]
    s_lshr_b32 s48, s2, 3
    s_lshl_b32 s48, s48, 3
    s_add_u32 s48, s48, s42
    s_lshl_b32 s48, s48, 13
    s_lshl_b32 s49, s66, 21
    s_add_u32 s48, s48, s49
    s_add_u32 s48, s48, 384
    s_mov_b64 exec, 0xff
    buffer_load_dword v37, v215, s[32:35], s48 offen
    s_mov_b64 exec, -1
    v_mfma_f32_16x16x32_bf16 v[176:179], v[140:143], v[120:123], v[176:179]
    v_mfma_f32_16x16x32_bf16 v[180:183], v[140:143], v[124:127], v[180:183]
    v_mfma_f32_16x16x32_bf16 v[184:187], v[144:147], v[120:123], v[184:187]
    v_mfma_f32_16x16x32_bf16 v[188:191], v[144:147], v[124:127], v[188:191]
    v_mfma_f32_16x16x32_bf16 v[192:195], v[148:151], v[120:123], v[192:195]
    v_mfma_f32_16x16x32_bf16 v[196:199], v[148:151], v[124:127], v[196:199]
    v_mfma_f32_16x16x32_bf16 v[236:239], v[244:247], v[120:123], v[236:239]
    v_mfma_f32_16x16x32_bf16 v[240:243], v[120:123], v[120:123], v[240:243]
    s_mul_i32 s48, s42, 3072
    s_add_u32 s48, s48, 16384
    v_lshl_add_u32 v4, v1, 4, s48
    s_lshl_b32 s48, s43, 2
    s_lshl_b32 s49, s44, 1
    s_add_u32 s48, s48, s49
    s_add_u32 s48, s48, s45
    s_mul_i32 s48, s48, 192
    s_add_u32 s48, s48, 155648
    v_lshl_add_u32 v5, v2, 4, s48
    ds_write_b128 v4, v[180:183] offset:0
    ds_write_b128 v4, v[188:191] offset:1024
    ds_write_b128 v4, v[196:199] offset:2048
    s_mov_b32 exec_lo, 0x00010001
    s_mov_b32 exec_hi, 0x00010001
    ds_write_b128 v5, v[224:227] offset:0
    ds_write_b128 v5, v[228:231] offset:64
    ds_write_b128 v5, v[232:235] offset:128
    s_mov_b64 exec, -1
    v_and_b32 v8, 3, v3
    v_cmp_eq_u32 vcc, 1, v8
    s_nop 1
    v_cndmask_b32 v237, v240, v241, vcc
    v_cmp_eq_u32 vcc, 2, v8
    s_nop 1
    v_cndmask_b32 v237, v237, v242, vcc
    v_cmp_eq_u32 vcc, 3, v8
    s_nop 1
    v_cndmask_b32 v237, v237, v243, vcc
    s_lshl_b32 s48, s47, 1
    s_add_u32 s48, s48, s45
    s_lshl_b32 s48, s48, 7
    s_add_u32 s48, s48, 158720
    v_lshl_add_u32 v6, v3, 3, s48
    s_mov_b32 exec_lo, 0x00F0000F
    s_mov_b32 exec_hi, 0xF0000F00
    ds_write_b64 v6, v[236:237]
    s_mov_b64 exec, -1
    v_pk_add_f32 v[200:201], v[176:177], 0
    v_pk_add_f32 v[202:203], v[178:179], 0
    v_pk_add_f32 v[204:205], v[184:185], 0
    v_pk_add_f32 v[206:207], v[186:187], 0
    v_pk_add_f32 v[208:209], v[192:193], 0
    v_pk_add_f32 v[210:211], v[194:195], 0
    v_mov_b32 v238, 0xc0135761
    v_mov_b32 v239, 0xc0135761
    s_waitcnt vmcnt(6)
    s_waitcnt lgkmcnt(0)
    s_barrier
    ds_read_b64_tr_b16 v[128:129], v217 offset:0
    ds_read_b64_tr_b16 v[130:131], v217 offset:768
    ds_read_b64_tr_b16 v[132:133], v218 offset:0
    ds_read_b64_tr_b16 v[134:135], v218 offset:768
    ds_read_b64_tr_b16 v[136:137], v219 offset:0
    ds_read_b64_tr_b16 v[138:139], v219 offset:768
    ds_read_b64_tr_b16 v[140:141], v220 offset:0
    ds_read_b64_tr_b16 v[142:143], v220 offset:768
    ds_read_b64_tr_b16 v[144:145], v221 offset:0
    ds_read_b64_tr_b16 v[146:147], v221 offset:768
    ds_read_b64_tr_b16 v[148:149], v222 offset:0
    ds_read_b64_tr_b16 v[150:151], v222 offset:768
    s_waitcnt vmcnt(5)
    v_readfirstlane_b32 s100, v212
    v_readfirstlane_b32 s101, v213
    s_add_u32 s100, s100, 1
    s_addc_u32 s101, s101, 0
    s_xor_b32 s48, s42, 4
    s_mul_i32 s48, s48, 3072
    s_add_u32 s48, s48, 16384
    v_lshl_add_u32 v4, v1, 4, s48
    s_lshl_b32 s48, s47, 8
    s_add_u32 s48, s48, 158720
    v_lshl_add_u32 v5, v3, 3, s48
    ds_read_b64 v[20:21], v5
    ds_read_b64 v[22:23], v5 offset:128
    ds_read_b128 v[8:11], v4 offset:0
    ds_read_b128 v[12:15], v4 offset:1024
    ds_read_b128 v[16:19], v4 offset:2048
    s_mul_i32 s48, s43, 768
    s_add_u32 s48, s48, 155648
    v_lshl_add_u32 v6, v2, 4, s48
    ds_read_b128 v[24:27], v6 offset:0
    ds_read_b128 v[28:31], v6 offset:64
    ds_read_b128 v[32:35], v6 offset:128
    ds_read_b128 v[176:179], v6 offset:192
    ds_read_b128 v[180:183], v6 offset:256
    ds_read_b128 v[184:187], v6 offset:320
    ds_read_b128 v[188:191], v6 offset:384
    ds_read_b128 v[192:195], v6 offset:448
    ds_read_b128 v[196:199], v6 offset:512
    ds_read_b128 v[224:227], v6 offset:576
    ds_read_b128 v[228:231], v6 offset:640
    ds_read_b128 v[232:235], v6 offset:704
    s_waitcnt lgkmcnt(15)
    v_pk_add_f32 v[240:241], v[20:21], v[22:23]
    v_mul_f32 v240, 0x3acccccd, v240
    v_mul_f32 v241, 0x3acccccd, v241
    v_fma_f32 v241, -v240, v240, v241
    v_max_f32 v241, 0, v241
    v_cvt_pk_bf16_f32 v241, v241, v240
    v_and_b32 v240, 0xffff0000, v241
    v_lshlrev_b32 v241, 16, v241
    v_add_f32 v241, s55, v241
    v_cvt_pk_bf16_f32 v241, v241, v241
    v_and_b32 v241, 0xffff0000, v241
    v_sqrt_f32 v241, v241
    s_nop 0
    v_cvt_pk_bf16_f32 v241, v241, v241
    v_and_b32 v241, 0xffff0000, v241
    v_rcp_f32 v241, v241
    s_nop 0
    v_mov_b32 v242, v241
    s_waitcnt lgkmcnt(12)
    v_pk_add_f32 v[200:201], v[200:201], v[8:9]
    v_pk_add_f32 v[202:203], v[202:203], v[10:11]
    v_pk_add_f32 v[204:205], v[204:205], v[12:13]
    v_pk_add_f32 v[206:207], v[206:207], v[14:15]
    v_pk_add_f32 v[208:209], v[208:209], v[16:17]
    v_pk_add_f32 v[210:211], v[210:211], v[18:19]
    s_waitcnt lgkmcnt(6)
    v_pk_add_f32 v[24:25], v[24:25], v[176:177]
    v_pk_add_f32 v[26:27], v[26:27], v[178:179]
    v_pk_add_f32 v[28:29], v[28:29], v[180:181]
    v_pk_add_f32 v[30:31], v[30:31], v[182:183]
    v_pk_add_f32 v[32:33], v[32:33], v[184:185]
    v_pk_add_f32 v[34:35], v[34:35], v[186:187]
    s_waitcnt lgkmcnt(0)
    v_pk_add_f32 v[188:189], v[188:189], v[224:225]
    v_pk_add_f32 v[190:191], v[190:191], v[226:227]
    v_pk_add_f32 v[192:193], v[192:193], v[228:229]
    v_pk_add_f32 v[194:195], v[194:195], v[230:231]
    v_pk_add_f32 v[196:197], v[196:197], v[232:233]
    v_pk_add_f32 v[198:199], v[198:199], v[234:235]
    v_pk_add_f32 v[24:25], v[24:25], v[188:189]
    v_pk_add_f32 v[26:27], v[26:27], v[190:191]
    v_pk_add_f32 v[28:29], v[28:29], v[192:193]
    v_pk_add_f32 v[30:31], v[30:31], v[194:195]
    v_pk_add_f32 v[32:33], v[32:33], v[196:197]
    v_pk_add_f32 v[34:35], v[34:35], v[198:199]
    v_pk_fma_f32 v[200:201], v[24:25], v[240:241], v[200:201] op_sel_hi:[1,0,1] neg_lo:[0,1,0] neg_hi:[0,1,0]
    v_pk_fma_f32 v[202:203], v[26:27], v[240:241], v[202:203] op_sel_hi:[1,0,1] neg_lo:[0,1,0] neg_hi:[0,1,0]
    v_pk_fma_f32 v[204:205], v[28:29], v[240:241], v[204:205] op_sel_hi:[1,0,1] neg_lo:[0,1,0] neg_hi:[0,1,0]
    v_pk_fma_f32 v[206:207], v[30:31], v[240:241], v[206:207] op_sel_hi:[1,0,1] neg_lo:[0,1,0] neg_hi:[0,1,0]
    v_pk_fma_f32 v[208:209], v[32:33], v[240:241], v[208:209] op_sel_hi:[1,0,1] neg_lo:[0,1,0] neg_hi:[0,1,0]
    v_pk_fma_f32 v[210:211], v[34:35], v[240:241], v[210:211] op_sel_hi:[1,0,1] neg_lo:[0,1,0] neg_hi:[0,1,0]
    v_pk_mul_f32 v[200:201], v[200:201], v[242:243] op_sel_hi:[1,0]
    v_pk_mul_f32 v[202:203], v[202:203], v[242:243] op_sel_hi:[1,0]
    v_pk_mul_f32 v[204:205], v[204:205], v[242:243] op_sel_hi:[1,0]
    v_pk_mul_f32 v[206:207], v[206:207], v[242:243] op_sel_hi:[1,0]
    v_pk_mul_f32 v[208:209], v[208:209], v[242:243] op_sel_hi:[1,0]
    v_pk_mul_f32 v[210:211], v[210:211], v[242:243] op_sel_hi:[1,0]
    v_pk_mul_f32 v[8:9], v[200:201], v[200:201]
    v_pk_mul_f32 v[10:11], v[202:203], v[202:203]
    v_pk_mul_f32 v[12:13], v[204:205], v[204:205]
    v_pk_mul_f32 v[14:15], v[206:207], v[206:207]
    v_pk_mul_f32 v[16:17], v[208:209], v[208:209]
    v_pk_mul_f32 v[18:19], v[210:211], v[210:211]
    v_pk_fma_f32 v[8:9], v[8:9], s[58:59], v[238:239]
    v_pk_fma_f32 v[10:11], v[10:11], s[58:59], v[238:239]
    v_pk_fma_f32 v[12:13], v[12:13], s[58:59], v[238:239]
    v_pk_fma_f32 v[14:15], v[14:15], s[58:59], v[238:239]
    v_pk_fma_f32 v[16:17], v[16:17], s[58:59], v[238:239]
    v_pk_fma_f32 v[18:19], v[18:19], s[58:59], v[238:239]
    v_pk_mul_f32 v[8:9], v[8:9], v[200:201]
    v_pk_mul_f32 v[10:11], v[10:11], v[202:203]
    v_pk_mul_f32 v[12:13], v[12:13], v[204:205]
    v_pk_mul_f32 v[14:15], v[14:15], v[206:207]
    v_pk_mul_f32 v[16:17], v[16:17], v[208:209]
    v_pk_mul_f32 v[18:19], v[18:19], v[210:211]
    v_exp_f32 v8, v8
    v_exp_f32 v9, v9
    v_exp_f32 v10, v10
    v_exp_f32 v11, v11
    v_exp_f32 v12, v12
    v_exp_f32 v13, v13
    v_exp_f32 v14, v14
    v_exp_f32 v15, v15
    v_exp_f32 v16, v16
    v_exp_f32 v17, v17
    v_exp_f32 v18, v18
    v_exp_f32 v19, v19
    v_pk_add_f32 v[8:9], v[8:9], 1.0 op_sel_hi:[1,0]
    v_pk_add_f32 v[10:11], v[10:11], 1.0 op_sel_hi:[1,0]
    v_pk_add_f32 v[12:13], v[12:13], 1.0 op_sel_hi:[1,0]
    v_pk_add_f32 v[14:15], v[14:15], 1.0 op_sel_hi:[1,0]
    v_pk_add_f32 v[16:17], v[16:17], 1.0 op_sel_hi:[1,0]
    v_pk_add_f32 v[18:19], v[18:19], 1.0 op_sel_hi:[1,0]
    v_rcp_f32 v8, v8
    v_rcp_f32 v9, v9
    v_rcp_f32 v10, v10
    v_rcp_f32 v11, v11
    v_rcp_f32 v12, v12
    v_rcp_f32 v13, v13
    v_rcp_f32 v14, v14
    v_rcp_f32 v15, v15
    v_rcp_f32 v16, v16
    v_rcp_f32 v17, v17
    v_rcp_f32 v18, v18
    v_rcp_f32 v19, v19
    v_pk_mul_f32 v[200:201], v[200:201], v[8:9]
    v_pk_mul_f32 v[202:203], v[202:203], v[10:11]
    v_pk_mul_f32 v[204:205], v[204:205], v[12:13]
    v_pk_mul_f32 v[206:207], v[206:207], v[14:15]
    v_pk_mul_f32 v[208:209], v[208:209], v[16:17]
    v_pk_mul_f32 v[210:211], v[210:211], v[18:19]
    v_pk_add_f32 v[14:15], v[200:201], v[202:203]
    v_pk_mul_f32 v[16:17], v[200:201], v[200:201]
    v_pk_add_f32 v[18:19], v[204:205], v[206:207]
    v_pk_fma_f32 v[16:17], v[202:203], v[202:203], v[16:17]
    v_pk_add_f32 v[20:21], v[208:209], v[210:211]
    v_pk_fma_f32 v[16:17], v[204:205], v[204:205], v[16:17]
    v_pk_add_f32 v[14:15], v[14:15], v[18:19]
    v_pk_fma_f32 v[16:17], v[206:207], v[206:207], v[16:17]
    v_pk_add_f32 v[14:15], v[14:15], v[20:21]
    v_pk_fma_f32 v[16:17], v[208:209], v[208:209], v[16:17]
    v_pk_fma_f32 v[16:17], v[210:211], v[210:211], v[16:17]
    v_add_f32 v8, v14, v15
    v_add_f32 v9, v16, v17
    v_mov_b32 v10, 0
    v_mov_b32 v11, 0
    s_lshl_b32 s48, s47, 7
    s_lshl_b32 s49, s43, 9
    s_add_u32 s48, s48, s49
    s_add_u32 s48, s48, 159744
    v_lshl_add_u32 v4, v3, 3, s48
    v_add_f32 v8, v8, v10
    v_add_f32 v9, v9, v11
    v_mov_b32 v12, v8
    v_mov_b32 v13, v9
    s_nop 0
    v_permlane16_swap_b32 v8, v12
    v_permlane16_swap_b32 v9, v13
    v_add_f32 v8, v8, v12
    v_add_f32 v9, v9, v13
    v_mov_b32 v12, v8
    v_mov_b32 v13, v9
    s_nop 0
    v_permlane32_swap_b32 v8, v12
    v_permlane32_swap_b32 v9, v13
    v_add_f32 v8, v8, v12
    v_add_f32 v9, v9, v13
    s_mov_b64 exec, 0xffff
    ds_write_b64 v4, v[8:9]
    s_mov_b64 exec, -1
    s_or_b32 s48, s41, s43
    s_cmp_lg_u32 s48, 0
    s_cbranch_scc1 k1_xst_2
    s_lshl_b32 s48, s40, 9
    s_lshl_b32 s49, s47, 7
    s_add_u32 s48, s48, s49
    s_add_u32 s48, s48, 14680064
    v_lshlrev_b32 v4, 3, v3
    s_mov_b64 exec, 0xffff
    buffer_store_dwordx2 v[240:241], v4, s[24:27], s48 offen
    s_mov_b64 exec, -1
k1_xst_2:
    v_mfma_f32_16x16x32_bf16 v[176:179], v[152:155], v[48:51], 0
    v_mfma_f32_16x16x32_bf16 v[180:183], v[152:155], v[52:55], 0
    s_add_u32 s65, s54, s98
    s_add_u32 m0, s61, 131072
    s_nop 0
    buffer_load_dwordx4 v40, s[8:11], s65 offen lds
    v_mfma_f32_16x16x32_bf16 v[224:227], v[152:155], v[244:247], 0
    v_mfma_f32_16x16x32_bf16 v[184:187], v[156:159], v[48:51], 0
    v_mfma_f32_16x16x32_bf16 v[188:191], v[156:159], v[52:55], 0
    s_add_u32 s65, s54, s98
    s_add_u32 m0, s61, 132096
    s_nop 0
    buffer_load_dwordx4 v41, s[8:11], s65 offen lds
    v_mfma_f32_16x16x32_bf16 v[228:231], v[156:159], v[244:247], 0
    v_mfma_f32_16x16x32_bf16 v[192:195], v[160:163], v[48:51], 0
    v_mfma_f32_16x16x32_bf16 v[196:199], v[160:163], v[52:55], 0
    s_add_u32 s65, s54, s98
    s_add_u32 m0, s61, 133120
    s_nop 0
    buffer_load_dwordx4 v42, s[8:11], s65 offen lds
    v_mfma_f32_16x16x32_bf16 v[232:235], v[160:163], v[244:247], 0
    v_mfma_f32_16x16x32_bf16 v[176:179], v[164:167], v[56:59], v[176:179]
    v_mfma_f32_16x16x32_bf16 v[180:183], v[164:167], v[60:63], v[180:183]
    s_add_u32 s48, s42, 0
    s_cmp_ge_u32 s48, 21
    s_cbranch_scc1 k1_kvde_5
    s_sub_u32 s49, s48, 11
    s_cmp_ge_u32 s48, 11
    s_cselect_b32 s50, s49, s48
    s_lshl_b32 s50, s50, 6
    v_add_u32 v4, s50, v1
    v_mul_u32_u24 v5, 6554, v4
    v_lshrrev_b32 v5, 16, v5
    v_mul_u32_u24 v6, 10, v5
    v_sub_u32 v4, v4, v6
    v_mul_u32_u24 v5, 1280, v5
    v_lshl_add_u32 v4, v4, 4, v5
    s_mul_i32 s49, s41, 160
    s_add_u32 s49, s49, s52
    s_lshl_b32 s50, s50, 4
    s_cmp_ge_u32 s48, 11
    s_cbranch_scc1 k1_kvdv_4
    v_add_u32 v4, s49, v4
    v_subrev_u32 v4, 3840, v4
    s_add_u32 m0, s50, 65536
    s_nop 0
    buffer_load_dwordx4 v4, s[12:15], 0 offen lds
    s_branch k1_kvde_5
k1_kvdv_4:
    s_add_u32 m0, s50, 49152
    s_nop 0
    buffer_load_dwordx4 v4, s[16:19], s49 offen lds
k1_kvde_5:
    v_mfma_f32_16x16x32_bf16 v[184:187], v[168:171], v[56:59], v[184:187]
    v_mfma_f32_16x16x32_bf16 v[188:191], v[168:171], v[60:63], v[188:191]
    v_mfma_f32_16x16x32_bf16 v[192:195], v[172:175], v[56:59], v[192:195]
    s_add_u32 s48, s42, 8
    s_cmp_ge_u32 s48, 21
    s_cbranch_scc1 k1_kvde_8
    s_sub_u32 s49, s48, 11
    s_cmp_ge_u32 s48, 11
    s_cselect_b32 s50, s49, s48
    s_lshl_b32 s50, s50, 6
    v_add_u32 v4, s50, v1
    v_mul_u32_u24 v5, 6554, v4
    v_lshrrev_b32 v5, 16, v5
    v_mul_u32_u24 v6, 10, v5
    v_sub_u32 v4, v4, v6
    v_mul_u32_u24 v5, 1280, v5
    v_lshl_add_u32 v4, v4, 4, v5
    s_mul_i32 s49, s41, 160
    s_add_u32 s49, s49, s52
    s_lshl_b32 s50, s50, 4
    s_cmp_ge_u32 s48, 11
    s_cbranch_scc1 k1_kvdv_7
    v_add_u32 v4, s49, v4
    v_subrev_u32 v4, 3840, v4
    s_add_u32 m0, s50, 65536
    s_nop 0
    buffer_load_dwordx4 v4, s[12:15], 0 offen lds
    s_branch k1_kvde_8
k1_kvdv_7:
    s_add_u32 m0, s50, 49152
    s_nop 0
    buffer_load_dwordx4 v4, s[16:19], s49 offen lds
k1_kvde_8:
    v_mfma_f32_16x16x32_bf16 v[196:199], v[172:175], v[60:63], v[196:199]
    s_add_u32 s48, s42, 16
    s_cmp_ge_u32 s48, 21
    s_cbranch_scc1 k1_kvde_11
    s_sub_u32 s49, s48, 11
    s_cmp_ge_u32 s48, 11
    s_cselect_b32 s50, s49, s48
    s_lshl_b32 s50, s50, 6
    v_add_u32 v4, s50, v1
    v_mul_u32_u24 v5, 6554, v4
    v_lshrrev_b32 v5, 16, v5
    v_mul_u32_u24 v6, 10, v5
    v_sub_u32 v4, v4, v6
    v_mul_u32_u24 v5, 1280, v5
    v_lshl_add_u32 v4, v4, 4, v5
    s_mul_i32 s49, s41, 160
    s_add_u32 s49, s49, s52
    s_lshl_b32 s50, s50, 4
    s_cmp_ge_u32 s48, 11
    s_cbranch_scc1 k1_kvdv_10
    v_add_u32 v4, s49, v4
    v_subrev_u32 v4, 3840, v4
    s_add_u32 m0, s50, 65536
    s_nop 0
    buffer_load_dwordx4 v4, s[12:15], 0 offen lds
    s_branch k1_kvde_11
k1_kvdv_10:
    s_add_u32 m0, s50, 49152
    s_nop 0
    buffer_load_dwordx4 v4, s[16:19], s49 offen lds
k1_kvde_11:
    s_lshr_b32 s48, s2, 3
    s_lshl_b32 s48, s48, 3
    s_add_u32 s48, s48, s42
    s_lshl_b32 s48, s48, 13
    s_lshl_b32 s49, s66, 21
    s_add_u32 s48, s48, s49
    s_add_u32 s48, s48, 512
    s_mov_b64 exec, 0xff
    buffer_load_dword v37, v215, s[32:35], s48 offen
    s_mov_b64 exec, -1
    s_mul_i32 s48, s89, 1280
    s_add_u32 s48, s48, 640
    s_mov_b64 exec, 0x1f
    buffer_load_dword v37, v36, s[36:39], s48 offen
    s_mov_b64 exec, -1
    s_waitcnt vmcnt(6)
    s_waitcnt lgkmcnt(0)
    s_barrier
    s_cmp_lg_u32 s42, 0
    s_cbranch_scc1 k1_pub_12
    v_lshlrev_b32 v4, 3, v1
    v_add_u32 v5, 159744, v4
    ds_read_b64 v[8:9], v5
    ds_read_b64 v[12:13], v5 offset:512
    s_lshl_b32 s48, s40, 3
    s_add_u32 s48, s48, s41
    s_lshl_b32 s48, s48, 10
    s_add_u32 s48, s48, 14745600
    v_lshlrev_b32 v4, 4, v1
    v_mov_b32 v10, s100
    v_mov_b32 v11, s101
    s_waitcnt lgkmcnt(0)
    v_pk_add_f32 v[8:9], v[8:9], v[12:13]
    buffer_store_dwordx4 v[8:11], v4, s[24:27], s48 offen sc1
k1_pub_12:
    ds_read_b64_tr_b16 v[152:153], v217 offset:24576
    ds_read_b64_tr_b16 v[154:155], v217 offset:25344
    ds_read_b64_tr_b16 v[156:157], v218 offset:24576
    ds_read_b64_tr_b16 v[158:159], v218 offset:25344
    ds_read_b64_tr_b16 v[160:161], v219 offset:24576
    ds_read_b64_tr_b16 v[162:163], v219 offset:25344
    ds_read_b64_tr_b16 v[164:165], v220 offset:24576
    ds_read_b64_tr_b16 v[166:167], v220 offset:25344
    ds_read_b64_tr_b16 v[168:169], v221 offset:24576
    ds_read_b64_tr_b16 v[170:171], v221 offset:25344
    ds_read_b64_tr_b16 v[172:173], v222 offset:24576
    ds_read_b64_tr_b16 v[174:175], v222 offset:25344
    v_mfma_f32_16x16x32_bf16 v[176:179], v[128:131], v[64:67], v[176:179]
    v_mfma_f32_16x16x32_bf16 v[180:183], v[128:131], v[68:71], v[180:183]
    s_add_u32 s65, s54, s99
    s_add_u32 m0, s61, 81920
    s_nop 0
    buffer_load_dwordx4 v40, s[8:11], s65 offen lds
    v_mfma_f32_16x16x32_bf16 v[224:227], v[128:131], v[244:247], v[224:227]
    v_mfma_f32_16x16x32_bf16 v[184:187], v[132:135], v[64:67], v[184:187]
    v_mfma_f32_16x16x32_bf16 v[188:191], v[132:135], v[68:71], v[188:191]
    s_add_u32 s65, s54, s99
    s_add_u32 m0, s61, 82944
    s_nop 0
    buffer_load_dwordx4 v41, s[8:11], s65 offen lds
    v_mfma_f32_16x16x32_bf16 v[228:231], v[132:135], v[244:247], v[228:231]
    v_mfma_f32_16x16x32_bf16 v[192:195], v[136:139], v[64:67], v[192:195]
    v_mfma_f32_16x16x32_bf16 v[196:199], v[136:139], v[68:71], v[196:199]
    s_add_u32 s65, s54, s99
    s_add_u32 m0, s61, 83968
    s_nop 0
    buffer_load_dwordx4 v42, s[8:11], s65 offen lds
    v_mfma_f32_16x16x32_bf16 v[232:235], v[136:139], v[244:247], v[232:235]
    v_mfma_f32_16x16x32_bf16 v[176:179], v[140:143], v[72:75], v[176:179]
    v_mfma_f32_16x16x32_bf16 v[180:183], v[140:143], v[76:79], v[180:183]
    s_lshr_b32 s48, s2, 3
    s_lshl_b32 s48, s48, 3
    s_add_u32 s48, s48, s42
    s_lshl_b32 s48, s48, 13
    s_lshl_b32 s49, s66, 21
    s_add_u32 s48, s48, s49
    s_add_u32 s48, s48, 640
    s_mov_b64 exec, 0xff
    buffer_load_dword v37, v215, s[32:35], s48 offen
    s_mov_b64 exec, -1
    v_mfma_f32_16x16x32_bf16 v[184:187], v[144:147], v[72:75], v[184:187]
    v_mfma_f32_16x16x32_bf16 v[188:191], v[144:147], v[76:79], v[188:191]
    v_mfma_f32_16x16x32_bf16 v[192:195], v[148:151], v[72:75], v[192:195]
    v_mfma_f32_16x16x32_bf16 v[196:199], v[148:151], v[76:79], v[196:199]
    s_waitcnt vmcnt(6)
    s_waitcnt lgkmcnt(0)
    s_barrier
    ds_read_b64_tr_b16 v[128:129], v217 offset:49152
    ds_read_b64_tr_b16 v[130:131], v217 offset:49920
    ds_read_b64_tr_b16 v[132:133], v218 offset:49152
    ds_read_b64_tr_b16 v[134:135], v218 offset:49920
    ds_read_b64_tr_b16 v[136:137], v219 offset:49152
    ds_read_b64_tr_b16 v[138:139], v219 offset:49920
    ds_read_b64_tr_b16 v[140:141], v220 offset:49152
    ds_read_b64_tr_b16 v[142:143], v220 offset:49920
    ds_read_b64_tr_b16 v[144:145], v221 offset:49152
    ds_read_b64_tr_b16 v[146:147], v221 offset:49920
    ds_read_b64_tr_b16 v[148:149], v222 offset:49152
    ds_read_b64_tr_b16 v[150:151], v222 offset:49920
    v_mfma_f32_16x16x32_bf16 v[176:179], v[152:155], v[80:83], v[176:179]
    v_mfma_f32_16x16x32_bf16 v[180:183], v[152:155], v[84:87], v[180:183]
    s_lshr_b32 s48, s2, 3
    s_lshl_b32 s48, s48, 3
    s_add_u32 s48, s48, s42
    s_lshl_b32 s48, s48, 13
    s_lshl_b32 s49, s66, 21
    s_add_u32 s48, s48, s49
    s_add_u32 s48, s48, 768
    s_mov_b64 exec, 0xff
    buffer_load_dword v37, v215, s[32:35], s48 offen
    s_mov_b64 exec, -1
    v_mfma_f32_16x16x32_bf16 v[224:227], v[152:155], v[244:247], v[224:227]
    v_mfma_f32_16x16x32_bf16 v[184:187], v[156:159], v[80:83], v[184:187]
    v_mfma_f32_16x16x32_bf16 v[188:191], v[156:159], v[84:87], v[188:191]
    v_mfma_f32_16x16x32_bf16 v[228:231], v[156:159], v[244:247], v[228:231]
    v_mfma_f32_16x16x32_bf16 v[192:195], v[160:163], v[80:83], v[192:195]
    v_mfma_f32_16x16x32_bf16 v[196:199], v[160:163], v[84:87], v[196:199]
    v_mfma_f32_16x16x32_bf16 v[232:235], v[160:163], v[244:247], v[232:235]
    v_mfma_f32_16x16x32_bf16 v[176:179], v[164:167], v[88:91], v[176:179]
    v_mfma_f32_16x16x32_bf16 v[180:183], v[164:167], v[92:95], v[180:183]
    v_mfma_f32_16x16x32_bf16 v[184:187], v[168:171], v[88:91], v[184:187]
    v_mfma_f32_16x16x32_bf16 v[188:191], v[168:171], v[92:95], v[188:191]
    v_mfma_f32_16x16x32_bf16 v[192:195], v[172:175], v[88:91], v[192:195]
    v_mfma_f32_16x16x32_bf16 v[196:199], v[172:175], v[92:95], v[196:199]
    s_waitcnt vmcnt(2)
    s_waitcnt lgkmcnt(0)
    s_barrier
    ds_read_b64_tr_b16 v[152:153], v217 offset:0
    ds_read_b64_tr_b16 v[154:155], v217 offset:768
    ds_read_b64_tr_b16 v[156:157], v218 offset:0
    ds_read_b64_tr_b16 v[158:159], v218 offset:768
    ds_read_b64_tr_b16 v[160:161], v219 offset:0
    ds_read_b64_tr_b16 v[162:163], v219 offset:768
    ds_read_b64_tr_b16 v[164:165], v220 offset:0
    ds_read_b64_tr_b16 v[166:167], v220 offset:768
    ds_read_b64_tr_b16 v[168:169], v221 offset:0
    ds_read_b64_tr_b16 v[170:171], v221 offset:768
    ds_read_b64_tr_b16 v[172:173], v222 offset:0
    ds_read_b64_tr_b16 v[174:175], v222 offset:768
    v_mfma_f32_16x16x32_bf16 v[176:179], v[128:131], v[96:99], v[176:179]
    v_mfma_f32_16x16x32_bf16 v[180:183], v[128:131], v[100:103], v[180:183]
    s_lshr_b32 s48, s2, 3
    s_lshl_b32 s48, s48, 3
    s_add_u32 s48, s48, s42
    s_lshl_b32 s48, s48, 13
    s_lshl_b32 s49, s66, 21
    s_add_u32 s48, s48, s49
    s_add_u32 s48, s48, 896
    s_mov_b64 exec, 0xff
    buffer_load_dword v37, v215, s[32:35], s48 offen
    s_mov_b64 exec, -1
    v_mfma_f32_16x16x32_bf16 v[224:227], v[128:131], v[244:247], v[224:227]
    v_mfma_f32_16x16x32_bf16 v[184:187], v[132:135], v[96:99], v[184:187]
    v_mfma_f32_16x16x32_bf16 v[188:191], v[132:135], v[100:103], v[188:191]
    v_mfma_f32_16x16x32_bf16 v[228:231], v[132:135], v[244:247], v[228:231]
    v_mfma_f32_16x16x32_bf16 v[192:195], v[136:139], v[96:99], v[192:195]
    v_mfma_f32_16x16x32_bf16 v[196:199], v[136:139], v[100:103], v[196:199]
    v_mfma_f32_16x16x32_bf16 v[232:235], v[136:139], v[244:247], v[232:235]
    v_mfma_f32_16x16x32_bf16 v[176:179], v[140:143], v[104:107], v[176:179]
    v_mfma_f32_16x16x32_bf16 v[180:183], v[140:143], v[108:111], v[180:183]
    v_mfma_f32_16x16x32_bf16 v[184:187], v[144:147], v[104:107], v[184:187]
    v_mfma_f32_16x16x32_bf16 v[188:191], v[144:147], v[108:111], v[188:191]
    v_mfma_f32_16x16x32_bf16 v[192:195], v[148:151], v[104:107], v[192:195]
    v_mfma_f32_16x16x32_bf16 v[196:199], v[148:151], v[108:111], v[196:199]
    s_waitcnt lgkmcnt(0)
    s_barrier
    s_lshl_b32 s48, s40, 13
    s_lshl_b32 s49, s47, 8
    s_add_u32 s48, s48, s49
    s_add_u32 s62, s48, 14745600
    v_lshlrev_b32 v38, 4, v3
    v_lshl_add_u32 v38, v2, 11, v38
    buffer_load_dwordx4 v[28:31], v38, s[24:27], s62 offen sc1
    buffer_load_dwordx4 v[32:35], v38, s[24:27], s62 offen offset:1024 sc1
    v_mfma_f32_16x16x32_bf16 v[176:179], v[152:155], v[112:115], v[176:179]
    v_mfma_f32_16x16x32_bf16 v[180:183], v[152:155], v[116:119], v[180:183]
    v_mfma_f32_16x16x32_bf16 v[224:227], v[152:155], v[244:247], v[224:227]
    v_mfma_f32_16x16x32_bf16 v[184:187], v[156:159], v[112:115], v[184:187]
    v_mfma_f32_16x16x32_bf16 v[188:191], v[156:159], v[116:119], v[188:191]
    v_mfma_f32_16x16x32_bf16 v[228:231], v[156:159], v[244:247], v[228:231]
    v_mfma_f32_16x16x32_bf16 v[192:195], v[160:163], v[112:115], v[192:195]
    v_mfma_f32_16x16x32_bf16 v[196:199], v[160:163], v[116:119], v[196:199]
    v_mfma_f32_16x16x32_bf16 v[232:235], v[160:163], v[244:247], v[232:235]
    v_mfma_f32_16x16x32_bf16 v[176:179], v[164:167], v[120:123], v[176:179]
    v_mfma_f32_16x16x32_bf16 v[180:183], v[164:167], v[124:127], v[180:183]
    v_mfma_f32_16x16x32_bf16 v[184:187], v[168:171], v[120:123], v[184:187]
    v_mfma_f32_16x16x32_bf16 v[188:191], v[168:171], v[124:127], v[188:191]
    v_mfma_f32_16x16x32_bf16 v[192:195], v[172:175], v[120:123], v[192:195]
    v_mfma_f32_16x16x32_bf16 v[196:199], v[172:175], v[124:127], v[196:199]
    s_mul_i32 s48, s42, 3072
    s_add_u32 s48, s48, 16384
    v_lshl_add_u32 v4, v1, 4, s48
    s_lshl_b32 s48, s43, 2
    s_lshl_b32 s49, s44, 1
    s_add_u32 s48, s48, s49
    s_add_u32 s48, s48, s45
    s_mul_i32 s48, s48, 192
    s_add_u32 s48, s48, 157184
    v_lshl_add_u32 v5, v2, 4, s48
    ds_write_b128 v4, v[180:183] offset:0
    ds_write_b128 v4, v[188:191] offset:1024
    ds_write_b128 v4, v[196:199] offset:2048
    s_mov_b32 exec_lo, 0x00010001
    s_mov_b32 exec_hi, 0x00010001
    ds_write_b128 v5, v[224:227] offset:0
    ds_write_b128 v5, v[228:231] offset:64
    ds_write_b128 v5, v[232:235] offset:128
    s_mov_b64 exec, -1
    v_pk_add_f32 v[128:129], v[176:177], 0
    v_pk_add_f32 v[130:131], v[178:179], 0
    v_pk_add_f32 v[132:133], v[184:185], 0
    v_pk_add_f32 v[134:135], v[186:187], 0
    v_pk_add_f32 v[136:137], v[192:193], 0
    v_pk_add_f32 v[138:139], v[194:195], 0
    v_add_u32 v4, 65536, v7
    ds_read_b128 v[48:51], v4 offset:0
    ds_read_b128 v[52:55], v4 offset:160
    ds_read_b128 v[56:59], v4 offset:320
    ds_read_b128 v[60:63], v4 offset:480
    ds_read_b128 v[64:67], v4 offset:640
    v_add_u32 v4, 49152, v7
    ds_read_b128 v[68:71], v4
    ds_read_b128 v[72:75], v4 offset:160
    s_waitcnt lgkmcnt(0)
    v_mul_u32_u24 v7, 1152, v44
    v_lshlrev_b32 v106, 2, v43
    v_sub_u32 v7, v7, v106
    s_lshl_b32 s48, s42, 4
    s_add_u32 s48, s48, 106508
    v_add_u32 v7, s48, v7
    v_lshlrev_b32 v44, 6, v44
    v_add_u32 v44, 160768, v44
    ds_read_b128 v[108:111], v44 offset:0
    ds_read_b128 v[112:115], v44 offset:16
    v_lshlrev_b32 v80, 16, v48
    v_and_b32 v81, 0xffff0000, v48
    v_lshlrev_b32 v82, 16, v52
    v_and_b32 v83, 0xffff0000, v52
    v_lshlrev_b32 v84, 16, v56
    v_and_b32 v85, 0xffff0000, v56
    v_lshlrev_b32 v86, 16, v60
    v_and_b32 v87, 0xffff0000, v60
    v_lshlrev_b32 v88, 16, v64
    v_and_b32 v89, 0xffff0000, v64
    s_waitcnt lgkmcnt(0)
    v_lshlrev_b32 v90, 16, v108
    v_lshlrev_b32 v91, 16, v110
    v_and_b32 v92, 0xffff0000, v108
    v_and_b32 v93, 0xffff0000, v110
    v_lshlrev_b32 v94, 16, v109
    v_lshlrev_b32 v95, 16, v111
    v_and_b32 v96, 0xffff0000, v109
    v_and_b32 v97, 0xffff0000, v111
    v_pk_mul_f32 v[98:99], v[86:87], v[90:91]
    v_pk_mul_f32 v[100:101], v[88:89], v[90:91]
    v_pk_fma_f32 v[98:99], v[84:85], v[92:93], v[98:99]
    v_pk_fma_f32 v[100:101], v[86:87], v[92:93], v[100:101]
    v_pk_fma_f32 v[98:99], v[82:83], v[94:95], v[98:99]
    v_pk_fma_f32 v[100:101], v[84:85], v[94:95], v[100:101]
    v_pk_fma_f32 v[98:99], v[80:81], v[96:97], v[98:99]
    v_pk_fma_f32 v[100:101], v[82:83], v[96:97], v[100:101]
    v_lshlrev_b32 v102, 16, v68
    v_and_b32 v103, 0xffff0000, v68
    v_lshlrev_b32 v104, 16, v72
    v_and_b32 v105, 0xffff0000, v72
    v_pk_mul_f32 v[98:99], v[98:99], v[102:103]
    v_pk_mul_f32 v[100:101], v[100:101], v[104:105]
    v_cvt_pk_bf16_f32 v106, v100, v98
    v_cvt_pk_bf16_f32 v107, v101, v99
    s_mov_b32 exec_hi, 0xff
    ds_write_b32 v7, v106 offset:0
    ds_write_b32 v7, v107 offset:144
    s_mov_b32 exec_hi, -1
    v_lshlrev_b32 v80, 16, v49
    v_and_b32 v81, 0xffff0000, v49
    v_lshlrev_b32 v82, 16, v53
    v_and_b32 v83, 0xffff0000, v53
    v_lshlrev_b32 v84, 16, v57
    v_and_b32 v85, 0xffff0000, v57
    v_lshlrev_b32 v86, 16, v61
    v_and_b32 v87, 0xffff0000, v61
    v_lshlrev_b32 v88, 16, v65
    v_and_b32 v89, 0xffff0000, v65
    v_lshlrev_b32 v90, 16, v112
    v_lshlrev_b32 v91, 16, v114
    v_and_b32 v92, 0xffff0000, v112
    v_and_b32 v93, 0xffff0000, v114
    v_lshlrev_b32 v94, 16, v113
    v_lshlrev_b32 v95, 16, v115
    v_and_b32 v96, 0xffff0000, v113
    v_and_b32 v97, 0xffff0000, v115
    v_pk_mul_f32 v[98:99], v[86:87], v[90:91]
    v_pk_mul_f32 v[100:101], v[88:89], v[90:91]
    v_pk_fma_f32 v[98:99], v[84:85], v[92:93], v[98:99]
    v_pk_fma_f32 v[100:101], v[86:87], v[92:93], v[100:101]
    v_pk_fma_f32 v[98:99], v[82:83], v[94:95], v[98:99]
    v_pk_fma_f32 v[100:101], v[84:85], v[94:95], v[100:101]
    v_pk_fma_f32 v[98:99], v[80:81], v[96:97], v[98:99]
    v_pk_fma_f32 v[100:101], v[82:83], v[96:97], v[100:101]
    v_lshlrev_b32 v102, 16, v69
    v_and_b32 v103, 0xffff0000, v69
    v_lshlrev_b32 v104, 16, v73
    v_and_b32 v105, 0xffff0000, v73
    v_pk_mul_f32 v[98:99], v[98:99], v[102:103]
    v_pk_mul_f32 v[100:101], v[100:101], v[104:105]
    v_cvt_pk_bf16_f32 v106, v100, v98
    v_cvt_pk_bf16_f32 v107, v101, v99
    s_mov_b32 exec_hi, 0xff
    ds_write_b32 v7, v106 offset:288
    ds_write_b32 v7, v107 offset:432
    s_mov_b32 exec_hi, -1
    ds_read_b128 v[108:111], v44 offset:32
    ds_read_b128 v[112:115], v44 offset:48
    v_lshlrev_b32 v80, 16, v50
    v_and_b32 v81, 0xffff0000, v50
    v_lshlrev_b32 v82, 16, v54
    v_and_b32 v83, 0xffff0000, v54
    v_lshlrev_b32 v84, 16, v58
    v_and_b32 v85, 0xffff0000, v58
    v_lshlrev_b32 v86, 16, v62
    v_and_b32 v87, 0xffff0000, v62
    v_lshlrev_b32 v88, 16, v66
    v_and_b32 v89, 0xffff0000, v66
    s_waitcnt lgkmcnt(0)
    v_lshlrev_b32 v90, 16, v108
    v_lshlrev_b32 v91, 16, v110
    v_and_b32 v92, 0xffff0000, v108
    v_and_b32 v93, 0xffff0000, v110
    v_lshlrev_b32 v94, 16, v109
    v_lshlrev_b32 v95, 16, v111
    v_and_b32 v96, 0xffff0000, v109
    v_and_b32 v97, 0xffff0000, v111
    v_pk_mul_f32 v[98:99], v[86:87], v[90:91]
    v_pk_mul_f32 v[100:101], v[88:89], v[90:91]
    v_pk_fma_f32 v[98:99], v[84:85], v[92:93], v[98:99]
    v_pk_fma_f32 v[100:101], v[86:87], v[92:93], v[100:101]
    v_pk_fma_f32 v[98:99], v[82:83], v[94:95], v[98:99]
    v_pk_fma_f32 v[100:101], v[84:85], v[94:95], v[100:101]
    v_pk_fma_f32 v[98:99], v[80:81], v[96:97], v[98:99]
    v_pk_fma_f32 v[100:101], v[82:83], v[96:97], v[100:101]
    v_lshlrev_b32 v102, 16, v70
    v_and_b32 v103, 0xffff0000, v70
    v_lshlrev_b32 v104, 16, v74
    v_and_b32 v105, 0xffff0000, v74
    v_pk_mul_f32 v[98:99], v[98:99], v[102:103]
    v_pk_mul_f32 v[100:101], v[100:101], v[104:105]
    v_cvt_pk_bf16_f32 v106, v100, v98
    v_cvt_pk_bf16_f32 v107, v101, v99
    s_mov_b32 exec_hi, 0xff
    ds_write_b32 v7, v106 offset:576
    ds_write_b32 v7, v107 offset:720
    s_mov_b32 exec_hi, -1
    v_lshlrev_b32 v80, 16, v51
    v_and_b32 v81, 0xffff0000, v51
    v_lshlrev_b32 v82, 16, v55
    v_and_b32 v83, 0xffff0000, v55
    v_lshlrev_b32 v84, 16, v59
    v_and_b32 v85, 0xffff0000, v59
    v_lshlrev_b32 v86, 16, v63
    v_and_b32 v87, 0xffff0000, v63
    v_lshlrev_b32 v88, 16, v67
    v_and_b32 v89, 0xffff0000, v67
    v_lshlrev_b32 v90, 16, v112
    v_lshlrev_b32 v91, 16, v114
    v_and_b32 v92, 0xffff0000, v112
    v_and_b32 v93, 0xffff0000, v114
    v_lshlrev_b32 v94, 16, v113
    v_lshlrev_b32 v95, 16, v115
    v_and_b32 v96, 0xffff0000, v113
    v_and_b32 v97, 0xffff0000, v115
    v_pk_mul_f32 v[98:99], v[86:87], v[90:91]
    v_pk_mul_f32 v[100:101], v[88:89], v[90:91]
    v_pk_fma_f32 v[98:99], v[84:85], v[92:93], v[98:99]
    v_pk_fma_f32 v[100:101], v[86:87], v[92:93], v[100:101]
    v_pk_fma_f32 v[98:99], v[82:83], v[94:95], v[98:99]
    v_pk_fma_f32 v[100:101], v[84:85], v[94:95], v[100:101]
    v_pk_fma_f32 v[98:99], v[80:81], v[96:97], v[98:99]
    v_pk_fma_f32 v[100:101], v[82:83], v[96:97], v[100:101]
    v_lshlrev_b32 v102, 16, v71
    v_and_b32 v103, 0xffff0000, v71
    v_lshlrev_b32 v104, 16, v75
    v_and_b32 v105, 0xffff0000, v75
    v_pk_mul_f32 v[98:99], v[98:99], v[102:103]
    v_pk_mul_f32 v[100:101], v[100:101], v[104:105]
    v_cvt_pk_bf16_f32 v106, v100, v98
    v_cvt_pk_bf16_f32 v107, v101, v99
    s_mov_b32 exec_hi, 0xff
    ds_write_b32 v7, v106 offset:864
    ds_write_b32 v7, v107 offset:1008
    s_mov_b32 exec_hi, -1
    s_lshl_b32 s48, s47, 4
    v_add_u32 v43, s48, v3
    v_mul_u32_u24 v43, 200, v43
    v_lshl_add_u32 v43, v2, 3, v43
    s_mul_i32 s48, s43, 96
    s_add_u32 s48, s48, 0
    v_add_u32 v43, s48, v43
    s_waitcnt vmcnt(0)
    s_mov_b32 s65, 0
k1_poll_13:
    s_add_u32 s65, s65, 1
    s_cmp_gt_u32 s65, 100000
    s_cbranch_scc1 k1_polled_14
    v_cmp_ne_u32 vcc, s100, v30
    v_cmp_ne_u32 s[50:51], s101, v31
    s_nop 0
    s_or_b64 vcc, vcc, s[50:51]
    v_cmp_ne_u32 s[50:51], s100, v34
    s_nop 0
    s_or_b64 vcc, vcc, s[50:51]
    v_cmp_ne_u32 s[50:51], s101, v35
    s_nop 0
    s_or_b64 vcc, vcc, s[50:51]
    s_cmp_eq_u64 vcc, 0
    s_cbranch_scc1 k1_polled_14
    s_sleep 4
    buffer_load_dwordx4 v[28:31], v38, s[24:27], s62 offen sc1
    buffer_load_dwordx4 v[32:35], v38, s[24:27], s62 offen offset:1024 sc1
    s_waitcnt vmcnt(0)
    s_branch k1_poll_13
k1_polled_14:
    s_xor_b32 s48, s42, 1
    s_or_b32 s48, s48, s41
    s_cmp_lg_u32 s48, 0
    s_cbranch_scc1 k1_ep_15
    v_mov_b32 v4, 0
    v_mov_b32 v44, 1
    s_mov_b64 exec, 1
    buffer_atomic_add v44, v4, s[28:31], 0 offen sc0
    s_mov_b64 exec, -1
k1_ep_15:
    v_pk_add_f32 v[8:9], v[28:29], v[32:33]
    v_mov_b32 v10, v8
    v_mov_b32 v11, v9
    s_nop 0
    v_permlane16_swap_b32 v8, v10
    v_permlane16_swap_b32 v9, v11
    v_add_f32 v8, v8, v10
    v_add_f32 v9, v9, v11
    v_mov_b32 v10, v8
    v_mov_b32 v11, v9
    s_nop 0
    v_permlane32_swap_b32 v8, v10
    v_permlane32_swap_b32 v9, v11
    v_add_f32 v8, v8, v10
    v_add_f32 v9, v9, v11
    v_mul_f32 v8, 0x3aaaaaab, v8
    v_mul_f32 v9, 0x3aaaaaab, v9
    v_fma_f32 v9, -v8, v8, v9
    v_max_f32 v9, 0, v9
    v_cvt_pk_bf16_f32 v9, v9, v8
    v_and_b32 v8, 0xffff0000, v9
    v_lshlrev_b32 v9, 16, v9
    v_add_f32 v9, s55, v9
    v_cvt_pk_bf16_f32 v9, v9, v9
    v_and_b32 v9, 0xffff0000, v9
    v_sqrt_f32 v9, v9
    s_nop 0
    v_cvt_pk_bf16_f32 v9, v9, v9
    v_and_b32 v9, 0xffff0000, v9
    v_rcp_f32 v9, v9
    s_nop 0
    v_mov_b32 v10, v9
    v_pk_add_f32 v[200:201], v[200:201], v[8:9] op_sel_hi:[1,0] neg_lo:[0,1] neg_hi:[0,1]
    v_pk_add_f32 v[202:203], v[202:203], v[8:9] op_sel_hi:[1,0] neg_lo:[0,1] neg_hi:[0,1]
    v_pk_add_f32 v[204:205], v[204:205], v[8:9] op_sel_hi:[1,0] neg_lo:[0,1] neg_hi:[0,1]
    v_pk_add_f32 v[206:207], v[206:207], v[8:9] op_sel_hi:[1,0] neg_lo:[0,1] neg_hi:[0,1]
    v_pk_add_f32 v[208:209], v[208:209], v[8:9] op_sel_hi:[1,0] neg_lo:[0,1] neg_hi:[0,1]
    v_pk_add_f32 v[210:211], v[210:211], v[8:9] op_sel_hi:[1,0] neg_lo:[0,1] neg_hi:[0,1]
    v_pk_mul_f32 v[200:201], v[200:201], v[10:11] op_sel_hi:[1,0]
    v_pk_mul_f32 v[202:203], v[202:203], v[10:11] op_sel_hi:[1,0]
    v_pk_mul_f32 v[204:205], v[204:205], v[10:11] op_sel_hi:[1,0]
    v_pk_mul_f32 v[206:207], v[206:207], v[10:11] op_sel_hi:[1,0]
    v_pk_mul_f32 v[208:209], v[208:209], v[10:11] op_sel_hi:[1,0]
    v_pk_mul_f32 v[210:211], v[210:211], v[10:11] op_sel_hi:[1,0]
    v_cvt_pk_bf16_f32 v16, v200, v201
    v_cvt_pk_bf16_f32 v17, v202, v203
    ds_write_b64 v43, v[16:17] offset:0
    v_cvt_pk_bf16_f32 v18, v204, v205
    v_cvt_pk_bf16_f32 v19, v206, v207
    ds_write_b64 v43, v[18:19] offset:32
    v_cvt_pk_bf16_f32 v20, v208, v209
    v_cvt_pk_bf16_f32 v21, v210, v211
    ds_write_b64 v43, v[20:21] offset:64
    v_lshrrev_b32 v218, 1, v2
    v_lshrrev_b32 v5, 2, v3
    v_lshl_add_u32 v218, v218, 3, v5
    v_mul_u32_u24 v218, 200, v218
    v_and_b32 v5, 1, v2
    v_lshl_add_u32 v218, v5, 5, v218
    v_and_b32 v5, 3, v3
    v_lshl_add_u32 v218, v5, 3, v218
    v_lshlrev_b32 v219, 4, v1
    s_waitcnt lgkmcnt(0)
    s_barrier
    s_add_u32 s48, s42, 0
    s_mul_i32 s49, s48, 43
    s_lshr_b32 s49, s49, 7
    s_mul_i32 s50, s49, 3
    s_sub_u32 s50, s48, s50
    s_mul_i32 s49, s49, 3200
    s_lshl_b32 s50, s50, 6
    s_add_u32 s49, s49, s50
    s_add_u32 s49, s49, 0
    v_add_u32 v5, s49, v218
    ds_read_b64_tr_b16 v[8:9], v5
    ds_read_b64_tr_b16 v[10:11], v5 offset:800
    s_lshl_b32 s49, s41, 7
    s_lshl_b32 s50, s40, 2
    s_add_u32 s49, s49, s50
    s_mul_i32 s49, s49, 3
    s_add_u32 s49, s49, s48
    s_lshl_b32 s49, s49, 10
    s_add_u32 s49, s49, 0
    s_waitcnt lgkmcnt(0)
    buffer_store_dwordx4 v[8:11], v219, s[24:27], s49 offen
    s_cmp_ge_u32 s42, 4
    s_cbranch_scc1 k1_fr_16
    s_add_u32 s48, s42, 8
    s_mul_i32 s49, s48, 43
    s_lshr_b32 s49, s49, 7
    s_mul_i32 s50, s49, 3
    s_sub_u32 s50, s48, s50
    s_mul_i32 s49, s49, 3200
    s_lshl_b32 s50, s50, 6
    s_add_u32 s49, s49, s50
    s_add_u32 s49, s49, 0
    v_add_u32 v5, s49, v218
    ds_read_b64_tr_b16 v[12:13], v5
    ds_read_b64_tr_b16 v[14:15], v5 offset:800
    s_lshl_b32 s49, s41, 7
    s_lshl_b32 s50, s40, 2
    s_add_u32 s49, s49, s50
    s_mul_i32 s49, s49, 3
    s_add_u32 s49, s49, s48
    s_lshl_b32 s49, s49, 10
    s_add_u32 s49, s49, 0
    s_waitcnt lgkmcnt(0)
    buffer_store_dwordx4 v[12:15], v219, s[24:27], s49 offen
k1_fr_16:
    s_lshl_b32 s48, s42, 3
    v_lshrrev_b32 v4, 3, v1
    v_add_u32 v4, s48, v4
    v_and_b32 v5, 7, v1
    v_lshlrev_b32 v5, 4, v5
    v_mul_u32_u24 v6, 144, v4
    v_add_u32 v6, v6, v5
    v_add_u32 v6, 106496, v6
    ds_read_b128 v[120:123], v6
    v_lshlrev_b32 v4, 12, v4
    v_add_u32 v4, v4, v5
    s_mul_i32 s48, s41, 327680
    s_lshl_b32 s49, s40, 7
    s_add_u32 s48, s48, s49
    s_add_u32 s48, s48, 6291456
    s_waitcnt lgkmcnt(0)
    buffer_store_dwordx4 v[120:123], v4, s[24:27], s48 offen
    s_lshl_b32 s48, s42, 3
    s_add_u32 s48, s48, 64
    v_lshrrev_b32 v4, 3, v1
    v_add_u32 v4, s48, v4
    v_and_b32 v5, 7, v1
    v_lshlrev_b32 v5, 4, v5
    v_mul_u32_u24 v6, 144, v4
    v_add_u32 v6, v6, v5
    v_add_u32 v6, 106496, v6
    ds_read_b128 v[124:127], v6
    v_lshlrev_b32 v4, 12, v4
    v_add_u32 v4, v4, v5
    s_mul_i32 s48, s41, 327680
    s_lshl_b32 s49, s40, 7
    s_add_u32 s48, s48, s49
    s_add_u32 s48, s48, 6291456
    s_waitcnt lgkmcnt(0)
    s_cmp_ge_u32 s42, 2
    s_cbranch_scc1 k1_kvskip_17
    buffer_store_dwordx4 v[124:127], v4, s[24:27], s48 offen
k1_kvskip_17:
    s_xor_b32 s48, s42, 4
    s_mul_i32 s48, s48, 3072
    s_add_u32 s48, s48, 16384
    v_lshl_add_u32 v4, v1, 4, s48
    ds_read_b128 v[48:51], v4 offset:0
    ds_read_b128 v[52:55], v4 offset:1024
    ds_read_b128 v[56:59], v4 offset:2048
    s_mul_i32 s48, s43, 768
    s_add_u32 s48, s48, 157184
    v_lshl_add_u32 v6, v2, 4, s48
    ds_read_b128 v[64:67], v6 offset:0
    ds_read_b128 v[68:71], v6 offset:64
    ds_read_b128 v[72:75], v6 offset:128
    ds_read_b128 v[76:79], v6 offset:192
    ds_read_b128 v[80:83], v6 offset:256
    ds_read_b128 v[84:87], v6 offset:320
    ds_read_b128 v[88:91], v6 offset:384
    ds_read_b128 v[92:95], v6 offset:448
    ds_read_b128 v[96:99], v6 offset:512
    ds_read_b128 v[100:103], v6 offset:576
    ds_read_b128 v[104:107], v6 offset:640
    ds_read_b128 v[108:111], v6 offset:704
    s_waitcnt lgkmcnt(12)
    v_pk_add_f32 v[128:129], v[128:129], v[48:49]
    v_pk_add_f32 v[130:131], v[130:131], v[50:51]
    v_pk_add_f32 v[132:133], v[132:133], v[52:53]
    v_pk_add_f32 v[134:135], v[134:135], v[54:55]
    v_pk_add_f32 v[136:137], v[136:137], v[56:57]
    v_pk_add_f32 v[138:139], v[138:139], v[58:59]
    s_waitcnt lgkmcnt(6)
    v_pk_add_f32 v[64:65], v[64:65], v[76:77]
    v_pk_add_f32 v[66:67], v[66:67], v[78:79]
    v_pk_add_f32 v[68:69], v[68:69], v[80:81]
    v_pk_add_f32 v[70:71], v[70:71], v[82:83]
    v_pk_add_f32 v[72:73], v[72:73], v[84:85]
    v_pk_add_f32 v[74:75], v[74:75], v[86:87]
    s_waitcnt lgkmcnt(0)
    v_pk_add_f32 v[88:89], v[88:89], v[100:101]
    v_pk_add_f32 v[90:91], v[90:91], v[102:103]
    v_pk_add_f32 v[92:93], v[92:93], v[104:105]
    v_pk_add_f32 v[94:95], v[94:95], v[106:107]
    v_pk_add_f32 v[96:97], v[96:97], v[108:109]
    v_pk_add_f32 v[98:99], v[98:99], v[110:111]
    v_pk_add_f32 v[64:65], v[64:65], v[88:89]
    v_pk_add_f32 v[66:67], v[66:67], v[90:91]
    v_pk_add_f32 v[68:69], v[68:69], v[92:93]
    v_pk_add_f32 v[70:71], v[70:71], v[94:95]
    v_pk_add_f32 v[72:73], v[72:73], v[96:97]
    v_pk_add_f32 v[74:75], v[74:75], v[98:99]
    v_pk_fma_f32 v[128:129], v[64:65], v[240:241], v[128:129] op_sel_hi:[1,0,1] neg_lo:[0,1,0] neg_hi:[0,1,0]
    v_pk_fma_f32 v[130:131], v[66:67], v[240:241], v[130:131] op_sel_hi:[1,0,1] neg_lo:[0,1,0] neg_hi:[0,1,0]
    v_pk_fma_f32 v[132:133], v[68:69], v[240:241], v[132:133] op_sel_hi:[1,0,1] neg_lo:[0,1,0] neg_hi:[0,1,0]
    v_pk_fma_f32 v[134:135], v[70:71], v[240:241], v[134:135] op_sel_hi:[1,0,1] neg_lo:[0,1,0] neg_hi:[0,1,0]
    v_pk_fma_f32 v[136:137], v[72:73], v[240:241], v[136:137] op_sel_hi:[1,0,1] neg_lo:[0,1,0] neg_hi:[0,1,0]
    v_pk_fma_f32 v[138:139], v[74:75], v[240:241], v[138:139] op_sel_hi:[1,0,1] neg_lo:[0,1,0] neg_hi:[0,1,0]
    v_pk_mul_f32 v[128:129], v[128:129], v[242:243] op_sel_hi:[1,0]
    v_pk_mul_f32 v[130:131], v[130:131], v[242:243] op_sel_hi:[1,0]
    v_pk_mul_f32 v[132:133], v[132:133], v[242:243] op_sel_hi:[1,0]
    v_pk_mul_f32 v[134:135], v[134:135], v[242:243] op_sel_hi:[1,0]
    v_pk_mul_f32 v[136:137], v[136:137], v[242:243] op_sel_hi:[1,0]
    v_pk_mul_f32 v[138:139], v[138:139], v[242:243] op_sel_hi:[1,0]
    v_pk_mul_f32 v[48:49], v[128:129], v[128:129]
    v_pk_mul_f32 v[50:51], v[130:131], v[130:131]
    v_pk_mul_f32 v[52:53], v[132:133], v[132:133]
    v_pk_mul_f32 v[54:55], v[134:135], v[134:135]
    v_pk_mul_f32 v[56:57], v[136:137], v[136:137]
    v_pk_mul_f32 v[58:59], v[138:139], v[138:139]
    v_pk_fma_f32 v[48:49], v[48:49], s[58:59], v[238:239]
    v_pk_fma_f32 v[50:51], v[50:51], s[58:59], v[238:239]
    v_pk_fma_f32 v[52:53], v[52:53], s[58:59], v[238:239]
    v_pk_fma_f32 v[54:55], v[54:55], s[58:59], v[238:239]
    v_pk_fma_f32 v[56:57], v[56:57], s[58:59], v[238:239]
    v_pk_fma_f32 v[58:59], v[58:59], s[58:59], v[238:239]
    v_pk_mul_f32 v[48:49], v[48:49], v[128:129]
    v_pk_mul_f32 v[50:51], v[50:51], v[130:131]
    v_pk_mul_f32 v[52:53], v[52:53], v[132:133]
    v_pk_mul_f32 v[54:55], v[54:55], v[134:135]
    v_pk_mul_f32 v[56:57], v[56:57], v[136:137]
    v_pk_mul_f32 v[58:59], v[58:59], v[138:139]
    v_exp_f32 v48, v48
    v_exp_f32 v49, v49
    v_exp_f32 v50, v50
    v_exp_f32 v51, v51
    v_exp_f32 v52, v52
    v_exp_f32 v53, v53
    v_exp_f32 v54, v54
    v_exp_f32 v55, v55
    v_exp_f32 v56, v56
    v_exp_f32 v57, v57
    v_exp_f32 v58, v58
    v_exp_f32 v59, v59
    v_pk_add_f32 v[48:49], v[48:49], 1.0 op_sel_hi:[1,0]
    v_pk_add_f32 v[50:51], v[50:51], 1.0 op_sel_hi:[1,0]
    v_pk_add_f32 v[52:53], v[52:53], 1.0 op_sel_hi:[1,0]
    v_pk_add_f32 v[54:55], v[54:55], 1.0 op_sel_hi:[1,0]
    v_pk_add_f32 v[56:57], v[56:57], 1.0 op_sel_hi:[1,0]
    v_pk_add_f32 v[58:59], v[58:59], 1.0 op_sel_hi:[1,0]
    v_rcp_f32 v48, v48
    v_rcp_f32 v49, v49
    v_rcp_f32 v50, v50
    v_rcp_f32 v51, v51
    v_rcp_f32 v52, v52
    v_rcp_f32 v53, v53
    v_rcp_f32 v54, v54
    v_rcp_f32 v55, v55
    v_rcp_f32 v56, v56
    v_rcp_f32 v57, v57
    v_rcp_f32 v58, v58
    v_rcp_f32 v59, v59
    v_pk_mul_f32 v[128:129], v[128:129], v[48:49]
    v_pk_mul_f32 v[130:131], v[130:131], v[50:51]
    v_pk_mul_f32 v[132:133], v[132:133], v[52:53]
    v_pk_mul_f32 v[134:135], v[134:135], v[54:55]
    v_pk_mul_f32 v[136:137], v[136:137], v[56:57]
    v_pk_mul_f32 v[138:139], v[138:139], v[58:59]
    v_lshrrev_b32 v4, 1, v2
    v_mul_u32_u24 v4, 3072, v4
    v_and_b32 v5, 1, v2
    v_lshlrev_b32 v5, 5, v5
    v_add_u32 v5, v5, v3
    v_lshl_add_u32 v4, v5, 4, v4
    s_lshl_b32 s48, s40, 3
    s_add_u32 s48, s48, s41
    s_mul_i32 s62, s48, 12288
    s_lshr_b32 s48, s47, 1
    s_mul_i32 s48, s48, 6144
    s_add_u32 s62, s62, s48
    s_and_b32 s48, s47, 1
    s_lshl_b32 s48, s48, 8
    s_add_u32 s62, s62, s48
    s_add_u32 s62, s62, 3145728
    s_mul_i32 s51, s43, 3
    v_cvt_pk_bf16_f32 v48, v128, v129
    v_cvt_pk_bf16_f32 v49, v130, v131
    s_add_u32 s48, s51, 0
    s_lshr_b32 s49, s48, 1
    s_lshl_b32 s49, s49, 10
    s_and_b32 s48, s48, 1
    s_lshl_b32 s48, s48, 3
    s_add_u32 s48, s48, s49
    s_add_u32 s48, s48, s62
    buffer_store_dwordx2 v[48:49], v4, s[24:27], s48 offen
    v_cvt_pk_bf16_f32 v50, v132, v133
    v_cvt_pk_bf16_f32 v51, v134, v135
    s_add_u32 s48, s51, 1
    s_lshr_b32 s49, s48, 1
    s_lshl_b32 s49, s49, 10
    s_and_b32 s48, s48, 1
    s_lshl_b32 s48, s48, 3
    s_add_u32 s48, s48, s49
    s_add_u32 s48, s48, s62
    buffer_store_dwordx2 v[50:51], v4, s[24:27], s48 offen
    v_cvt_pk_bf16_f32 v52, v136, v137
    v_cvt_pk_bf16_f32 v53, v138, v139
    s_add_u32 s48, s51, 2
    s_lshr_b32 s49, s48, 1
    s_lshl_b32 s49, s49, 10
    s_and_b32 s48, s48, 1
    s_lshl_b32 s48, s48, 3
    s_add_u32 s48, s48, s49
    s_add_u32 s48, s48, s62
    buffer_store_dwordx2 v[52:53], v4, s[24:27], s48 offen
    s_xor_b32 s48, s42, 1
    s_or_b32 s48, s48, s41
    s_cmp_lg_u32 s48, 0
    s_cbranch_scc1 k1_ep2_18
    s_waitcnt vmcnt(0)
    v_readfirstlane_b32 s48, v44
    s_nop 0
    s_cmp_lg_u32 s48, 31
    s_cbranch_scc1 k1_ep2_18
    v_mov_b32 v8, s100
    v_mov_b32 v9, s101
    v_mov_b32 v4, 14712832
    s_mov_b64 exec, 1
    buffer_store_dwordx2 v[8:9], v4, s[24:27], 0 offen sc1
    s_mov_b64 exec, -1
k1_ep2_18:
k1_kernel_end:
    s_endpgm

.globl k2_kernel
.p2align 8
.type k2_kernel,@function
k2_kernel:
    s_cmp_ge_u32 s2, 512
    s_cbranch_scc1 k2_kernel_end
    s_cmp_lt_u32 s2, 256
    s_cbranch_scc1 k2_kernel_conv
    s_load_dwordx2 s[4:5], s[0:1], 64
    s_load_dwordx2 s[8:9], s[0:1], 104
    s_load_dwordx2 s[12:13], s[0:1], 72
    v_lshrrev_b32 v2, 6, v0
    v_and_b32 v1, 63, v0
    v_readfirstlane_b32 s34, v2
    s_mov_b32 s6, 8388608
    s_mov_b32 s7, 0x20000
    s_mov_b32 s10, 15990784
    s_mov_b32 s11, 0x20000
    s_mov_b32 s14, 4096
    s_mov_b32 s15, 0x20000
    s_and_b32 s40, s2, 7
    s_lshr_b32 s41, s2, 3
    s_and_b32 s41, s41, 31
    s_lshr_b32 s32, s40, 1
    s_lshl_b32 s32, s32, 3
    s_and_b32 s42, s41, 7
    s_add_u32 s32, s32, s42
    s_and_b32 s33, s40, 1
    s_lshl_b32 s33, s33, 2
    s_lshr_b32 s42, s41, 3
    s_add_u32 s33, s33, s42
    s_lshl_b32 s44, s33, 7
    s_lshl_b32 s40, s34, 5
    s_add_u32 s44, s44, s40
    s_mul_i32 s44, s44, 3072
    s_add_u32 s44, s44, 0
    s_lshl_b32 s45, s32, 18
    s_lshl_b32 s40, s34, 10
    s_add_u32 s45, s45, s40
    s_lshl_b32 s46, s34, 14
    v_lshlrev_b32 v5, 4, v1
    v_lshrrev_b32 v2, 3, v1
    v_lshlrev_b32 v2, 12, v2
    v_and_b32 v3, 7, v1
    v_lshrrev_b32 v4, 4, v1
    v_xor_b32 v3, v3, v4
    v_lshl_add_u32 v6, v3, 4, v2
    v_xor_b32 v7, 64, v6
    s_mov_b32 s50, 0
    s_waitcnt lgkmcnt(0)
    s_add_u32 s52, s50, 0
    s_and_b32 s52, s52, 7
    s_mul_i32 s52, s52, 12288
    s_add_u32 s52, s52, s44
    buffer_load_dwordx4 v[104:107], v5, s[8:11], s52 offen offset:0
    buffer_load_dwordx4 v[108:111], v5, s[8:11], s52 offen offset:1024
    buffer_load_dwordx4 v[112:115], v5, s[8:11], s52 offen offset:2048
    s_add_u32 s54, s50, 0
    s_and_b32 s54, s54, 7
    s_lshl_b32 s54, s54, 7
    s_add_u32 s54, s54, s45
    s_add_u32 s42, s54, 0
    s_add_u32 m0, s46, 0
    s_nop 0
    buffer_load_dwordx4 v6, s[4:7], s42 offen lds
    s_add_u32 s42, s54, 32768
    s_add_u32 m0, s46, 1024
    s_nop 0
    buffer_load_dwordx4 v7, s[4:7], s42 offen lds
    s_add_u32 s42, s54, 65536
    s_add_u32 m0, s46, 2048
    s_nop 0
    buffer_load_dwordx4 v6, s[4:7], s42 offen lds
    s_add_u32 s42, s54, 98304
    s_add_u32 m0, s46, 3072
    s_nop 0
    buffer_load_dwordx4 v7, s[4:7], s42 offen lds
    s_add_u32 s42, s54, 131072
    s_add_u32 m0, s46, 4096
    s_nop 0
    buffer_load_dwordx4 v6, s[4:7], s42 offen lds
    s_add_u32 s42, s54, 163840
    s_add_u32 m0, s46, 5120
    s_nop 0
    buffer_load_dwordx4 v7, s[4:7], s42 offen lds
    s_add_u32 s42, s54, 196608
    s_add_u32 m0, s46, 6144
    s_nop 0
    buffer_load_dwordx4 v6, s[4:7], s42 offen lds
    s_add_u32 s42, s54, 229376
    s_add_u32 m0, s46, 7168
    s_nop 0
    buffer_load_dwordx4 v7, s[4:7], s42 offen lds
    s_add_u32 s41, s52, 3072
    buffer_load_dwordx4 v[116:119], v5, s[8:11], s41 offen offset:0
    s_add_u32 s41, s52, 3072
    buffer_load_dwordx4 v[120:123], v5, s[8:11], s41 offen offset:1024
    s_add_u32 s41, s52, 3072
    buffer_load_dwordx4 v[124:127], v5, s[8:11], s41 offen offset:2048
    s_add_u32 s41, s52, 6144
    buffer_load_dwordx4 v[128:131], v5, s[8:11], s41 offen offset:0
    s_add_u32 s41, s52, 6144
    buffer_load_dwordx4 v[132:135], v5, s[8:11], s41 offen offset:1024
    s_add_u32 s41, s52, 6144
    buffer_load_dwordx4 v[136:139], v5, s[8:11], s41 offen offset:2048
    s_add_u32 s41, s52, 9216
    buffer_load_dwordx4 v[140:143], v5, s[8:11], s41 offen offset:0
    s_add_u32 s41, s52, 9216
    buffer_load_dwordx4 v[144:147], v5, s[8:11], s41 offen offset:1024
    s_add_u32 s41, s52, 9216
    buffer_load_dwordx4 v[148:151], v5, s[8:11], s41 offen offset:2048
    v_and_b32 v2, 31, v1
    v_lshrrev_b32 v3, 1, v2
    v_and_b32 v3, 7, v3
    v_lshrrev_b32 v4, 5, v1
    v_xor_b32 v3, v3, v4
    v_lshl_add_u32 v2, v2, 7, s46
    v_xor_b32 v4, 0, v3
    v_lshl_add_u32 v180, v4, 4, v2
    v_xor_b32 v4, 2, v3
    v_lshl_add_u32 v181, v4, 4, v2
    v_xor_b32 v4, 4, v3
    v_lshl_add_u32 v182, v4, 4, v2
    v_xor_b32 v4, 6, v3
    v_lshl_add_u32 v183, v4, 4, v2
    s_waitcnt vmcnt(9)
    s_setprio 2
    ds_read_b128 v[164:167], v180 offset:0
    ds_read_b128 v[168:171], v180 offset:4096
    s_waitcnt vmcnt(17)
    s_waitcnt lgkmcnt(0)
    v_mfma_f32_32x32x16_bf16 v[8:23], v[104:107], v[164:167], 0
    ds_read_b128 v[172:175], v181 offset:0
    ds_read_b128 v[176:179], v181 offset:4096
    v_mfma_f32_32x32x16_bf16 v[24:39], v[104:107], v[168:171], 0
    s_add_u32 s53, s50, 1
    s_and_b32 s53, s53, 7
    s_mul_i32 s53, s53, 12288
    s_add_u32 s53, s53, s44
    buffer_load_dwordx4 v[152:155], v5, s[8:11], s53 offen offset:0
    v_mfma_f32_32x32x16_bf16 v[40:55], v[108:111], v[164:167], 0
    buffer_load_dwordx4 v[156:159], v5, s[8:11], s53 offen offset:1024
    v_mfma_f32_32x32x16_bf16 v[56:71], v[108:111], v[168:171], 0
    buffer_load_dwordx4 v[160:163], v5, s[8:11], s53 offen offset:2048
    v_mfma_f32_32x32x16_bf16 v[72:87], v[112:115], v[164:167], 0
    s_add_u32 s55, s50, 1
    s_and_b32 s55, s55, 7
    s_lshl_b32 s55, s55, 7
    s_add_u32 s55, s55, s45
    s_add_u32 s42, s55, 0
    s_add_u32 m0, s46, 8192
    s_nop 0
    buffer_load_dwordx4 v6, s[4:7], s42 offen lds
    v_mfma_f32_32x32x16_bf16 v[88:103], v[112:115], v[168:171], 0
    s_add_u32 s42, s55, 32768
    s_add_u32 m0, s46, 9216
    s_nop 0
    buffer_load_dwordx4 v7, s[4:7], s42 offen lds
    s_add_u32 s42, s55, 65536
    s_add_u32 m0, s46, 10240
    s_nop 0
    buffer_load_dwordx4 v6, s[4:7], s42 offen lds
    s_add_u32 s42, s55, 98304
    s_add_u32 m0, s46, 11264
    s_nop 0
    buffer_load_dwordx4 v7, s[4:7], s42 offen lds
    s_waitcnt vmcnt(13)
    s_waitcnt lgkmcnt(0)
    v_mfma_f32_32x32x16_bf16 v[8:23], v[116:119], v[172:175], v[8:23]
    ds_read_b128 v[164:167], v182 offset:0
    ds_read_b128 v[168:171], v182 offset:4096
    v_mfma_f32_32x32x16_bf16 v[24:39], v[116:119], v[176:179], v[24:39]
    s_add_u32 s41, s53, 3072
    buffer_load_dwordx4 v[104:107], v5, s[8:11], s41 offen offset:0
    v_mfma_f32_32x32x16_bf16 v[40:55], v[120:123], v[172:175], v[40:55]
    s_add_u32 s41, s53, 3072
    buffer_load_dwordx4 v[108:111], v5, s[8:11], s41 offen offset:1024
    v_mfma_f32_32x32x16_bf16 v[56:71], v[120:123], v[176:179], v[56:71]
    s_add_u32 s41, s53, 3072
    buffer_load_dwordx4 v[112:115], v5, s[8:11], s41 offen offset:2048
    v_mfma_f32_32x32x16_bf16 v[72:87], v[124:127], v[172:175], v[72:87]
    s_add_u32 s42, s55, 131072
    s_add_u32 m0, s46, 12288
    s_nop 0
    buffer_load_dwordx4 v6, s[4:7], s42 offen lds
    v_mfma_f32_32x32x16_bf16 v[88:103], v[124:127], v[176:179], v[88:103]
    s_add_u32 s42, s55, 163840
    s_add_u32 m0, s46, 13312
    s_nop 0
    buffer_load_dwordx4 v7, s[4:7], s42 offen lds
    s_add_u32 s42, s55, 196608
    s_add_u32 m0, s46, 14336
    s_nop 0
    buffer_load_dwordx4 v6, s[4:7], s42 offen lds
    s_add_u32 s42, s55, 229376
    s_add_u32 m0, s46, 15360
    s_nop 0
    buffer_load_dwordx4 v7, s[4:7], s42 offen lds
    s_waitcnt vmcnt(17)
    s_waitcnt lgkmcnt(0)
    v_mfma_f32_32x32x16_bf16 v[8:23], v[128:131], v[164:167], v[8:23]
    ds_read_b128 v[172:175], v183 offset:0
    ds_read_b128 v[176:179], v183 offset:4096
    v_mfma_f32_32x32x16_bf16 v[24:39], v[128:131], v[168:171], v[24:39]
    s_add_u32 s41, s53, 6144
    buffer_load_dwordx4 v[116:119], v5, s[8:11], s41 offen offset:0
    v_mfma_f32_32x32x16_bf16 v[40:55], v[132:135], v[164:167], v[40:55]
    s_add_u32 s41, s53, 6144
    buffer_load_dwordx4 v[120:123], v5, s[8:11], s41 offen offset:1024
    v_mfma_f32_32x32x16_bf16 v[56:71], v[132:135], v[168:171], v[56:71]
    s_add_u32 s41, s53, 6144
    buffer_load_dwordx4 v[124:127], v5, s[8:11], s41 offen offset:2048
    v_mfma_f32_32x32x16_bf16 v[72:87], v[136:139], v[164:167], v[72:87]
    v_mfma_f32_32x32x16_bf16 v[88:103], v[136:139], v[168:171], v[88:103]
    s_waitcnt vmcnt(17)
    s_waitcnt lgkmcnt(0)
    v_mfma_f32_32x32x16_bf16 v[8:23], v[140:143], v[172:175], v[8:23]
    s_waitcnt vmcnt(3)
    ds_read_b128 v[164:167], v180 offset:8192
    ds_read_b128 v[168:171], v180 offset:12288
    v_mfma_f32_32x32x16_bf16 v[24:39], v[140:143], v[176:179], v[24:39]
    s_add_u32 s41, s53, 9216
    buffer_load_dwordx4 v[128:131], v5, s[8:11], s41 offen offset:0
    v_mfma_f32_32x32x16_bf16 v[40:55], v[144:147], v[172:175], v[40:55]
    s_add_u32 s41, s53, 9216
    buffer_load_dwordx4 v[132:135], v5, s[8:11], s41 offen offset:1024
    v_mfma_f32_32x32x16_bf16 v[56:71], v[144:147], v[176:179], v[56:71]
    s_add_u32 s41, s53, 9216
    buffer_load_dwordx4 v[136:139], v5, s[8:11], s41 offen offset:2048
    v_mfma_f32_32x32x16_bf16 v[72:87], v[148:151], v[172:175], v[72:87]
    s_add_u32 s54, s50, 2
    s_and_b32 s54, s54, 7
    s_lshl_b32 s54, s54, 7
    s_add_u32 s54, s54, s45
    s_add_u32 s42, s54, 0
    s_add_u32 m0, s46, 0
    s_nop 0
    buffer_load_dwordx4 v6, s[4:7], s42 offen lds
    v_mfma_f32_32x32x16_bf16 v[88:103], v[148:151], v[176:179], v[88:103]
    s_add_u32 s42, s54, 32768
    s_add_u32 m0, s46, 1024
    s_nop 0
    buffer_load_dwordx4 v7, s[4:7], s42 offen lds
    s_waitcnt vmcnt(19)
    s_waitcnt lgkmcnt(0)
    v_mfma_f32_32x32x16_bf16 v[8:23], v[152:155], v[164:167], v[8:23]
    ds_read_b128 v[172:175], v181 offset:8192
    ds_read_b128 v[176:179], v181 offset:12288
    v_mfma_f32_32x32x16_bf16 v[24:39], v[152:155], v[168:171], v[24:39]
    s_add_u32 s52, s50, 2
    s_and_b32 s52, s52, 7
    s_mul_i32 s52, s52, 12288
    s_add_u32 s52, s52, s44
    buffer_load_dwordx4 v[140:143], v5, s[8:11], s52 offen offset:0
    v_mfma_f32_32x32x16_bf16 v[40:55], v[156:159], v[164:167], v[40:55]
    buffer_load_dwordx4 v[144:147], v5, s[8:11], s52 offen offset:1024
    v_mfma_f32_32x32x16_bf16 v[56:71], v[156:159], v[168:171], v[56:71]
    buffer_load_dwordx4 v[148:151], v5, s[8:11], s52 offen offset:2048
    v_mfma_f32_32x32x16_bf16 v[72:87], v[160:163], v[164:167], v[72:87]
    s_add_u32 s42, s54, 65536
    s_add_u32 m0, s46, 2048
    s_nop 0
    buffer_load_dwordx4 v6, s[4:7], s42 offen lds
    v_mfma_f32_32x32x16_bf16 v[88:103], v[160:163], v[168:171], v[88:103]
    s_add_u32 s42, s54, 98304
    s_add_u32 m0, s46, 3072
    s_nop 0
    buffer_load_dwordx4 v7, s[4:7], s42 offen lds
    s_add_u32 s42, s54, 131072
    s_add_u32 m0, s46, 4096
    s_nop 0
    buffer_load_dwordx4 v6, s[4:7], s42 offen lds
    s_waitcnt vmcnt(18)
    s_waitcnt lgkmcnt(0)
    v_mfma_f32_32x32x16_bf16 v[8:23], v[104:107], v[172:175], v[8:23]
    ds_read_b128 v[164:167], v182 offset:8192
    ds_read_b128 v[168:171], v182 offset:12288
    v_mfma_f32_32x32x16_bf16 v[24:39], v[104:107], v[176:179], v[24:39]
    s_add_u32 s41, s52, 3072
    buffer_load_dwordx4 v[152:155], v5, s[8:11], s41 offen offset:0
    v_mfma_f32_32x32x16_bf16 v[40:55], v[108:111], v[172:175], v[40:55]
    s_add_u32 s41, s52, 3072
    buffer_load_dwordx4 v[156:159], v5, s[8:11], s41 offen offset:1024
    v_mfma_f32_32x32x16_bf16 v[56:71], v[108:111], v[176:179], v[56:71]
    s_add_u32 s41, s52, 3072
    buffer_load_dwordx4 v[160:163], v5, s[8:11], s41 offen offset:2048
    v_mfma_f32_32x32x16_bf16 v[72:87], v[112:115], v[172:175], v[72:87]
    s_add_u32 s42, s54, 163840
    s_add_u32 m0, s46, 5120
    s_nop 0
    buffer_load_dwordx4 v7, s[4:7], s42 offen lds
    v_mfma_f32_32x32x16_bf16 v[88:103], v[112:115], v[176:179], v[88:103]
    s_add_u32 s42, s54, 196608
    s_add_u32 m0, s46, 6144
    s_nop 0
    buffer_load_dwordx4 v6, s[4:7], s42 offen lds
    s_add_u32 s42, s54, 229376
    s_add_u32 m0, s46, 7168
    s_nop 0
    buffer_load_dwordx4 v7, s[4:7], s42 offen lds
    s_waitcnt vmcnt(17)
    s_waitcnt lgkmcnt(0)
    v_mfma_f32_32x32x16_bf16 v[8:23], v[116:119], v[164:167], v[8:23]
    ds_read_b128 v[172:175], v183 offset:8192
    ds_read_b128 v[176:179], v183 offset:12288
    v_mfma_f32_32x32x16_bf16 v[24:39], v[116:119], v[168:171], v[24:39]
    s_add_u32 s41, s52, 6144
    buffer_load_dwordx4 v[104:107], v5, s[8:11], s41 offen offset:0
    v_mfma_f32_32x32x16_bf16 v[40:55], v[120:123], v[164:167], v[40:55]
    s_add_u32 s41, s52, 6144
    buffer_load_dwordx4 v[108:111], v5, s[8:11], s41 offen offset:1024
    v_mfma_f32_32x32x16_bf16 v[56:71], v[120:123], v[168:171], v[56:71]
    s_add_u32 s41, s52, 6144
    buffer_load_dwordx4 v[112:115], v5, s[8:11], s41 offen offset:2048
    v_mfma_f32_32x32x16_bf16 v[72:87], v[124:127], v[164:167], v[72:87]
    v_mfma_f32_32x32x16_bf16 v[88:103], v[124:127], v[168:171], v[88:103]
    s_waitcnt vmcnt(17)
    s_waitcnt lgkmcnt(0)
    v_mfma_f32_32x32x16_bf16 v[8:23], v[128:131], v[172:175], v[8:23]
    s_waitcnt vmcnt(3)
    ds_read_b128 v[164:167], v180 offset:0
    ds_read_b128 v[168:171], v180 offset:4096
    v_mfma_f32_32x32x16_bf16 v[24:39], v[128:131], v[176:179], v[24:39]
    s_add_u32 s41, s52, 9216
    buffer_load_dwordx4 v[116:119], v5, s[8:11], s41 offen offset:0
    v_mfma_f32_32x32x16_bf16 v[40:55], v[132:135], v[172:175], v[40:55]
    s_add_u32 s41, s52, 9216
    buffer_load_dwordx4 v[120:123], v5, s[8:11], s41 offen offset:1024
    v_mfma_f32_32x32x16_bf16 v[56:71], v[132:135], v[176:179], v[56:71]
    s_add_u32 s41, s52, 9216
    buffer_load_dwordx4 v[124:127], v5, s[8:11], s41 offen offset:2048
    v_mfma_f32_32x32x16_bf16 v[72:87], v[136:139], v[172:175], v[72:87]
    s_add_u32 s55, s50, 3
    s_and_b32 s55, s55, 7
    s_lshl_b32 s55, s55, 7
    s_add_u32 s55, s55, s45
    s_add_u32 s42, s55, 0
    s_add_u32 m0, s46, 8192
    s_nop 0
    buffer_load_dwordx4 v6, s[4:7], s42 offen lds
    v_mfma_f32_32x32x16_bf16 v[88:103], v[136:139], v[176:179], v[88:103]
    s_add_u32 s42, s55, 32768
    s_add_u32 m0, s46, 9216
    s_nop 0
    buffer_load_dwordx4 v7, s[4:7], s42 offen lds
    s_waitcnt vmcnt(17)
    s_waitcnt lgkmcnt(0)
    v_mfma_f32_32x32x16_bf16 v[8:23], v[140:143], v[164:167], v[8:23]
    ds_read_b128 v[172:175], v181 offset:0
    ds_read_b128 v[176:179], v181 offset:4096
    v_mfma_f32_32x32x16_bf16 v[24:39], v[140:143], v[168:171], v[24:39]
    s_add_u32 s53, s50, 3
    s_and_b32 s53, s53, 7
    s_mul_i32 s53, s53, 12288
    s_add_u32 s53, s53, s44
    buffer_load_dwordx4 v[128:131], v5, s[8:11], s53 offen offset:0
    v_mfma_f32_32x32x16_bf16 v[40:55], v[144:147], v[164:167], v[40:55]
    buffer_load_dwordx4 v[132:135], v5, s[8:11], s53 offen offset:1024
    v_mfma_f32_32x32x16_bf16 v[56:71], v[144:147], v[168:171], v[56:71]
    buffer_load_dwordx4 v[136:139], v5, s[8:11], s53 offen offset:2048
    v_mfma_f32_32x32x16_bf16 v[72:87], v[148:151], v[164:167], v[72:87]
    s_add_u32 s42, s55, 65536
    s_add_u32 m0, s46, 10240
    s_nop 0
    buffer_load_dwordx4 v6, s[4:7], s42 offen lds
    v_mfma_f32_32x32x16_bf16 v[88:103], v[148:151], v[168:171], v[88:103]
    s_add_u32 s42, s55, 98304
    s_add_u32 m0, s46, 11264
    s_nop 0
    buffer_load_dwordx4 v7, s[4:7], s42 offen lds
    s_add_u32 s42, s55, 131072
    s_add_u32 m0, s46, 12288
    s_nop 0
    buffer_load_dwordx4 v6, s[4:7], s42 offen lds
    s_waitcnt vmcnt(17)
    s_waitcnt lgkmcnt(0)
    v_mfma_f32_32x32x16_bf16 v[8:23], v[152:155], v[172:175], v[8:23]
    ds_read_b128 v[164:167], v182 offset:0
    ds_read_b128 v[168:171], v182 offset:4096
    v_mfma_f32_32x32x16_bf16 v[24:39], v[152:155], v[176:179], v[24:39]
    s_add_u32 s41, s53, 3072
    buffer_load_dwordx4 v[140:143], v5, s[8:11], s41 offen offset:0
    v_mfma_f32_32x32x16_bf16 v[40:55], v[156:159], v[172:175], v[40:55]
    s_add_u32 s41, s53, 3072
    buffer_load_dwordx4 v[144:147], v5, s[8:11], s41 offen offset:1024
    v_mfma_f32_32x32x16_bf16 v[56:71], v[156:159], v[176:179], v[56:71]
    s_add_u32 s41, s53, 3072
    buffer_load_dwordx4 v[148:151], v5, s[8:11], s41 offen offset:2048
    v_mfma_f32_32x32x16_bf16 v[72:87], v[160:163], v[172:175], v[72:87]
    s_add_u32 s42, s55, 163840
    s_add_u32 m0, s46, 13312
    s_nop 0
    buffer_load_dwordx4 v7, s[4:7], s42 offen lds
    v_mfma_f32_32x32x16_bf16 v[88:103], v[160:163], v[176:179], v[88:103]
    s_add_u32 s42, s55, 196608
    s_add_u32 m0, s46, 14336
    s_nop 0
    buffer_load_dwordx4 v6, s[4:7], s42 offen lds
    s_add_u32 s42, s55, 229376
    s_add_u32 m0, s46, 15360
    s_nop 0
    buffer_load_dwordx4 v7, s[4:7], s42 offen lds
    s_waitcnt vmcnt(17)
    s_waitcnt lgkmcnt(0)
    v_mfma_f32_32x32x16_bf16 v[8:23], v[104:107], v[164:167], v[8:23]
    ds_read_b128 v[172:175], v183 offset:0
    ds_read_b128 v[176:179], v183 offset:4096
    v_mfma_f32_32x32x16_bf16 v[24:39], v[104:107], v[168:171], v[24:39]
    s_add_u32 s41, s53, 6144
    buffer_load_dwordx4 v[152:155], v5, s[8:11], s41 offen offset:0
    v_mfma_f32_32x32x16_bf16 v[40:55], v[108:111], v[164:167], v[40:55]
    s_add_u32 s41, s53, 6144
    buffer_load_dwordx4 v[156:159], v5, s[8:11], s41 offen offset:1024
    v_mfma_f32_32x32x16_bf16 v[56:71], v[108:111], v[168:171], v[56:71]
    s_add_u32 s41, s53, 6144
    buffer_load_dwordx4 v[160:163], v5, s[8:11], s41 offen offset:2048
    v_mfma_f32_32x32x16_bf16 v[72:87], v[112:115], v[164:167], v[72:87]
    v_mfma_f32_32x32x16_bf16 v[88:103], v[112:115], v[168:171], v[88:103]
    s_waitcnt vmcnt(17)
    s_waitcnt lgkmcnt(0)
    v_mfma_f32_32x32x16_bf16 v[8:23], v[116:119], v[172:175], v[8:23]
    s_waitcnt vmcnt(3)
    ds_read_b128 v[164:167], v180 offset:8192
    ds_read_b128 v[168:171], v180 offset:12288
    v_mfma_f32_32x32x16_bf16 v[24:39], v[116:119], v[176:179], v[24:39]
    s_add_u32 s41, s53, 9216
    buffer_load_dwordx4 v[104:107], v5, s[8:11], s41 offen offset:0
    v_mfma_f32_32x32x16_bf16 v[40:55], v[120:123], v[172:175], v[40:55]
    s_add_u32 s41, s53, 9216
    buffer_load_dwordx4 v[108:111], v5, s[8:11], s41 offen offset:1024
    v_mfma_f32_32x32x16_bf16 v[56:71], v[120:123], v[176:179], v[56:71]
    s_add_u32 s41, s53, 9216
    buffer_load_dwordx4 v[112:115], v5, s[8:11], s41 offen offset:2048
    v_mfma_f32_32x32x16_bf16 v[72:87], v[124:127], v[172:175], v[72:87]
    s_add_u32 s54, s50, 4
    s_and_b32 s54, s54, 7
    s_lshl_b32 s54, s54, 7
    s_add_u32 s54, s54, s45
    s_add_u32 s42, s54, 0
    s_add_u32 m0, s46, 0
    s_nop 0
    buffer_load_dwordx4 v6, s[4:7], s42 offen lds
    v_mfma_f32_32x32x16_bf16 v[88:103], v[124:127], v[176:179], v[88:103]
    s_add_u32 s42, s54, 32768
    s_add_u32 m0, s46, 1024
    s_nop 0
    buffer_load_dwordx4 v7, s[4:7], s42 offen lds
    s_waitcnt vmcnt(17)
    s_waitcnt lgkmcnt(0)
    v_mfma_f32_32x32x16_bf16 v[8:23], v[128:131], v[164:167], v[8:23]
    ds_read_b128 v[172:175], v181 offset:8192
    ds_read_b128 v[176:179], v181 offset:12288
    v_mfma_f32_32x32x16_bf16 v[24:39], v[128:131], v[168:171], v[24:39]
    s_add_u32 s52, s50, 4
    s_and_b32 s52, s52, 7
    s_mul_i32 s52, s52, 12288
    s_add_u32 s52, s52, s44
    buffer_load_dwordx4 v[116:119], v5, s[8:11], s52 offen offset:0
    v_mfma_f32_32x32x16_bf16 v[40:55], v[132:135], v[164:167], v[40:55]
    buffer_load_dwordx4 v[120:123], v5, s[8:11], s52 offen offset:1024
    v_mfma_f32_32x32x16_bf16 v[56:71], v[132:135], v[168:171], v[56:71]
    buffer_load_dwordx4 v[124:127], v5, s[8:11], s52 offen offset:2048
    v_mfma_f32_32x32x16_bf16 v[72:87], v[136:139], v[164:167], v[72:87]
    s_add_u32 s42, s54, 65536
    s_add_u32 m0, s46, 2048
    s_nop 0
    buffer_load_dwordx4 v6, s[4:7], s42 offen lds
    v_mfma_f32_32x32x16_bf16 v[88:103], v[136:139], v[168:171], v[88:103]
    s_add_u32 s42, s54, 98304
    s_add_u32 m0, s46, 3072
    s_nop 0
    buffer_load_dwordx4 v7, s[4:7], s42 offen lds
    s_add_u32 s42, s54, 131072
    s_add_u32 m0, s46, 4096
    s_nop 0
    buffer_load_dwordx4 v6, s[4:7], s42 offen lds
    s_waitcnt vmcnt(17)
    s_waitcnt lgkmcnt(0)
    v_mfma_f32_32x32x16_bf16 v[8:23], v[140:143], v[172:175], v[8:23]
    ds_read_b128 v[164:167], v182 offset:8192
    ds_read_b128 v[168:171], v182 offset:12288
    v_mfma_f32_32x32x16_bf16 v[24:39], v[140:143], v[176:179], v[24:39]
    s_add_u32 s41, s52, 3072
    buffer_load_dwordx4 v[128:131], v5, s[8:11], s41 offen offset:0
    v_mfma_f32_32x32x16_bf16 v[40:55], v[144:147], v[172:175], v[40:55]
    s_add_u32 s41, s52, 3072
    buffer_load_dwordx4 v[132:135], v5, s[8:11], s41 offen offset:1024
    v_mfma_f32_32x32x16_bf16 v[56:71], v[144:147], v[176:179], v[56:71]
    s_add_u32 s41, s52, 3072
    buffer_load_dwordx4 v[136:139], v5, s[8:11], s41 offen offset:2048
    v_mfma_f32_32x32x16_bf16 v[72:87], v[148:151], v[172:175], v[72:87]
    s_add_u32 s42, s54, 163840
    s_add_u32 m0, s46, 5120
    s_nop 0
    buffer_load_dwordx4 v7, s[4:7], s42 offen lds
    v_mfma_f32_32x32x16_bf16 v[88:103], v[148:151], v[176:179], v[88:103]
    s_add_u32 s42, s54, 196608
    s_add_u32 m0, s46, 6144
    s_nop 0
    buffer_load_dwordx4 v6, s[4:7], s42 offen lds
    s_add_u32 s42, s54, 229376
    s_add_u32 m0, s46, 7168
    s_nop 0
    buffer_load_dwordx4 v7, s[4:7], s42 offen lds
    s_waitcnt vmcnt(17)
    s_waitcnt lgkmcnt(0)
    v_mfma_f32_32x32x16_bf16 v[8:23], v[152:155], v[164:167], v[8:23]
    ds_read_b128 v[172:175], v183 offset:8192
    ds_read_b128 v[176:179], v183 offset:12288
    v_mfma_f32_32x32x16_bf16 v[24:39], v[152:155], v[168:171], v[24:39]
    s_add_u32 s41, s52, 6144
    buffer_load_dwordx4 v[140:143], v5, s[8:11], s41 offen offset:0
    v_mfma_f32_32x32x16_bf16 v[40:55], v[156:159], v[164:167], v[40:55]
    s_add_u32 s41, s52, 6144
    buffer_load_dwordx4 v[144:147], v5, s[8:11], s41 offen offset:1024
    v_mfma_f32_32x32x16_bf16 v[56:71], v[156:159], v[168:171], v[56:71]
    s_add_u32 s41, s52, 6144
    buffer_load_dwordx4 v[148:151], v5, s[8:11], s41 offen offset:2048
    v_mfma_f32_32x32x16_bf16 v[72:87], v[160:163], v[164:167], v[72:87]
    v_mfma_f32_32x32x16_bf16 v[88:103], v[160:163], v[168:171], v[88:103]
    s_waitcnt vmcnt(17)
    s_waitcnt lgkmcnt(0)
    v_mfma_f32_32x32x16_bf16 v[8:23], v[104:107], v[172:175], v[8:23]
    s_waitcnt vmcnt(3)
    ds_read_b128 v[164:167], v180 offset:0
    ds_read_b128 v[168:171], v180 offset:4096
    v_mfma_f32_32x32x16_bf16 v[24:39], v[104:107], v[176:179], v[24:39]
    s_add_u32 s41, s52, 9216
    buffer_load_dwordx4 v[152:155], v5, s[8:11], s41 offen offset:0
    v_mfma_f32_32x32x16_bf16 v[40:55], v[108:111], v[172:175], v[40:55]
    s_add_u32 s41, s52, 9216
    buffer_load_dwordx4 v[156:159], v5, s[8:11], s41 offen offset:1024
    v_mfma_f32_32x32x16_bf16 v[56:71], v[108:111], v[176:179], v[56:71]
    s_add_u32 s41, s52, 9216
    buffer_load_dwordx4 v[160:163], v5, s[8:11], s41 offen offset:2048
    v_mfma_f32_32x32x16_bf16 v[72:87], v[112:115], v[172:175], v[72:87]
    s_add_u32 s55, s50, 5
    s_and_b32 s55, s55, 7
    s_lshl_b32 s55, s55, 7
    s_add_u32 s55, s55, s45
    s_add_u32 s42, s55, 0
    s_add_u32 m0, s46, 8192
    s_nop 0
    buffer_load_dwordx4 v6, s[4:7], s42 offen lds
    v_mfma_f32_32x32x16_bf16 v[88:103], v[112:115], v[176:179], v[88:103]
    s_add_u32 s42, s55, 32768
    s_add_u32 m0, s46, 9216
    s_nop 0
    buffer_load_dwordx4 v7, s[4:7], s42 offen lds
    s_waitcnt vmcnt(17)
    s_waitcnt lgkmcnt(0)
    v_mfma_f32_32x32x16_bf16 v[8:23], v[116:119], v[164:167], v[8:23]
    ds_read_b128 v[172:175], v181 offset:0
    ds_read_b128 v[176:179], v181 offset:4096
    v_mfma_f32_32x32x16_bf16 v[24:39], v[116:119], v[168:171], v[24:39]
    s_add_u32 s53, s50, 5
    s_and_b32 s53, s53, 7
    s_mul_i32 s53, s53, 12288
    s_add_u32 s53, s53, s44
    buffer_load_dwordx4 v[104:107], v5, s[8:11], s53 offen offset:0
    v_mfma_f32_32x32x16_bf16 v[40:55], v[120:123], v[164:167], v[40:55]
    buffer_load_dwordx4 v[108:111], v5, s[8:11], s53 offen offset:1024
    v_mfma_f32_32x32x16_bf16 v[56:71], v[120:123], v[168:171], v[56:71]
    buffer_load_dwordx4 v[112:115], v5, s[8:11], s53 offen offset:2048
    v_mfma_f32_32x32x16_bf16 v[72:87], v[124:127], v[164:167], v[72:87]
    s_add_u32 s42, s55, 65536
    s_add_u32 m0, s46, 10240
    s_nop 0
    buffer_load_dwordx4 v6, s[4:7], s42 offen lds
    v_mfma_f32_32x32x16_bf16 v[88:103], v[124:127], v[168:171], v[88:103]
    s_add_u32 s42, s55, 98304
    s_add_u32 m0, s46, 11264
    s_nop 0
    buffer_load_dwordx4 v7, s[4:7], s42 offen lds
    s_add_u32 s42, s55, 131072
    s_add_u32 m0, s46, 12288
    s_nop 0
    buffer_load_dwordx4 v6, s[4:7], s42 offen lds
    s_waitcnt vmcnt(17)
    s_waitcnt lgkmcnt(0)
    v_mfma_f32_32x32x16_bf16 v[8:23], v[128:131], v[172:175], v[8:23]
    ds_read_b128 v[164:167], v182 offset:0
    ds_read_b128 v[168:171], v182 offset:4096
    v_mfma_f32_32x32x16_bf16 v[24:39], v[128:131], v[176:179], v[24:39]
    s_add_u32 s41, s53, 3072
    buffer_load_dwordx4 v[116:119], v5, s[8:11], s41 offen offset:0
    v_mfma_f32_32x32x16_bf16 v[40:55], v[132:135], v[172:175], v[40:55]
    s_add_u32 s41, s53, 3072
    buffer_load_dwordx4 v[120:123], v5, s[8:11], s41 offen offset:1024
    v_mfma_f32_32x32x16_bf16 v[56:71], v[132:135], v[176:179], v[56:71]
    s_add_u32 s41, s53, 3072
    buffer_load_dwordx4 v[124:127], v5, s[8:11], s41 offen offset:2048
    v_mfma_f32_32x32x16_bf16 v[72:87], v[136:139], v[172:175], v[72:87]
    s_add_u32 s42, s55, 163840
    s_add_u32 m0, s46, 13312
    s_nop 0
    buffer_load_dwordx4 v7, s[4:7], s42 offen lds
    v_mfma_f32_32x32x16_bf16 v[88:103], v[136:139], v[176:179], v[88:103]
    s_add_u32 s42, s55, 196608
    s_add_u32 m0, s46, 14336
    s_nop 0
    buffer_load_dwordx4 v6, s[4:7], s42 offen lds
    s_add_u32 s42, s55, 229376
    s_add_u32 m0, s46, 15360
    s_nop 0
    buffer_load_dwordx4 v7, s[4:7], s42 offen lds
    s_waitcnt vmcnt(17)
    s_waitcnt lgkmcnt(0)
    v_mfma_f32_32x32x16_bf16 v[8:23], v[140:143], v[164:167], v[8:23]
    ds_read_b128 v[172:175], v183 offset:0
    ds_read_b128 v[176:179], v183 offset:4096
    v_mfma_f32_32x32x16_bf16 v[24:39], v[140:143], v[168:171], v[24:39]
    s_add_u32 s41, s53, 6144
    buffer_load_dwordx4 v[128:131], v5, s[8:11], s41 offen offset:0
    v_mfma_f32_32x32x16_bf16 v[40:55], v[144:147], v[164:167], v[40:55]
    s_add_u32 s41, s53, 6144
    buffer_load_dwordx4 v[132:135], v5, s[8:11], s41 offen offset:1024
    v_mfma_f32_32x32x16_bf16 v[56:71], v[144:147], v[168:171], v[56:71]
    s_add_u32 s41, s53, 6144
    buffer_load_dwordx4 v[136:139], v5, s[8:11], s41 offen offset:2048
    v_mfma_f32_32x32x16_bf16 v[72:87], v[148:151], v[164:167], v[72:87]
    v_mfma_f32_32x32x16_bf16 v[88:103], v[148:151], v[168:171], v[88:103]
    s_waitcnt vmcnt(17)
    s_waitcnt lgkmcnt(0)
    v_mfma_f32_32x32x16_bf16 v[8:23], v[152:155], v[172:175], v[8:23]
    s_waitcnt vmcnt(3)
    ds_read_b128 v[164:167], v180 offset:8192
    ds_read_b128 v[168:171], v180 offset:12288
    v_mfma_f32_32x32x16_bf16 v[24:39], v[152:155], v[176:179], v[24:39]
    s_add_u32 s41, s53, 9216
    buffer_load_dwordx4 v[140:143], v5, s[8:11], s41 offen offset:0
    v_mfma_f32_32x32x16_bf16 v[40:55], v[156:159], v[172:175], v[40:55]
    s_add_u32 s41, s53, 9216
    buffer_load_dwordx4 v[144:147], v5, s[8:11], s41 offen offset:1024
    v_mfma_f32_32x32x16_bf16 v[56:71], v[156:159], v[176:179], v[56:71]
    s_add_u32 s41, s53, 9216
    buffer_load_dwordx4 v[148:151], v5, s[8:11], s41 offen offset:2048
    v_mfma_f32_32x32x16_bf16 v[72:87], v[160:163], v[172:175], v[72:87]
    s_add_u32 s54, s50, 6
    s_and_b32 s54, s54, 7
    s_lshl_b32 s54, s54, 7
    s_add_u32 s54, s54, s45
    s_add_u32 s42, s54, 0
    s_add_u32 m0, s46, 0
    s_nop 0
    buffer_load_dwordx4 v6, s[4:7], s42 offen lds
    v_mfma_f32_32x32x16_bf16 v[88:103], v[160:163], v[176:179], v[88:103]
    s_add_u32 s42, s54, 32768
    s_add_u32 m0, s46, 1024
    s_nop 0
    buffer_load_dwordx4 v7, s[4:7], s42 offen lds
    s_waitcnt vmcnt(17)
    s_waitcnt lgkmcnt(0)
    v_mfma_f32_32x32x16_bf16 v[8:23], v[104:107], v[164:167], v[8:23]
    ds_read_b128 v[172:175], v181 offset:8192
    ds_read_b128 v[176:179], v181 offset:12288
    v_mfma_f32_32x32x16_bf16 v[24:39], v[104:107], v[168:171], v[24:39]
    s_add_u32 s52, s50, 6
    s_and_b32 s52, s52, 7
    s_mul_i32 s52, s52, 12288
    s_add_u32 s52, s52, s44
    buffer_load_dwordx4 v[152:155], v5, s[8:11], s52 offen offset:0
    v_mfma_f32_32x32x16_bf16 v[40:55], v[108:111], v[164:167], v[40:55]
    buffer_load_dwordx4 v[156:159], v5, s[8:11], s52 offen offset:1024
    v_mfma_f32_32x32x16_bf16 v[56:71], v[108:111], v[168:171], v[56:71]
    buffer_load_dwordx4 v[160:163], v5, s[8:11], s52 offen offset:2048
    v_mfma_f32_32x32x16_bf16 v[72:87], v[112:115], v[164:167], v[72:87]
    s_add_u32 s42, s54, 65536
    s_add_u32 m0, s46, 2048
    s_nop 0
    buffer_load_dwordx4 v6, s[4:7], s42 offen lds
    v_mfma_f32_32x32x16_bf16 v[88:103], v[112:115], v[168:171], v[88:103]
    s_add_u32 s42, s54, 98304
    s_add_u32 m0, s46, 3072
    s_nop 0
    buffer_load_dwordx4 v7, s[4:7], s42 offen lds
    s_add_u32 s42, s54, 131072
    s_add_u32 m0, s46, 4096
    s_nop 0
    buffer_load_dwordx4 v6, s[4:7], s42 offen lds
    s_waitcnt vmcnt(17)
    s_waitcnt lgkmcnt(0)
    v_mfma_f32_32x32x16_bf16 v[8:23], v[116:119], v[172:175], v[8:23]
    ds_read_b128 v[164:167], v182 offset:8192
    ds_read_b128 v[168:171], v182 offset:12288
    v_mfma_f32_32x32x16_bf16 v[24:39], v[116:119], v[176:179], v[24:39]
    s_add_u32 s41, s52, 3072
    buffer_load_dwordx4 v[104:107], v5, s[8:11], s41 offen offset:0
    v_mfma_f32_32x32x16_bf16 v[40:55], v[120:123], v[172:175], v[40:55]
    s_add_u32 s41, s52, 3072
    buffer_load_dwordx4 v[108:111], v5, s[8:11], s41 offen offset:1024
    v_mfma_f32_32x32x16_bf16 v[56:71], v[120:123], v[176:179], v[56:71]
    s_add_u32 s41, s52, 3072
    buffer_load_dwordx4 v[112:115], v5, s[8:11], s41 offen offset:2048
    v_mfma_f32_32x32x16_bf16 v[72:87], v[124:127], v[172:175], v[72:87]
    s_add_u32 s42, s54, 163840
    s_add_u32 m0, s46, 5120
    s_nop 0
    buffer_load_dwordx4 v7, s[4:7], s42 offen lds
    v_mfma_f32_32x32x16_bf16 v[88:103], v[124:127], v[176:179], v[88:103]
    s_add_u32 s42, s54, 196608
    s_add_u32 m0, s46, 6144
    s_nop 0
    buffer_load_dwordx4 v6, s[4:7], s42 offen lds
    s_add_u32 s42, s54, 229376
    s_add_u32 m0, s46, 7168
    s_nop 0
    buffer_load_dwordx4 v7, s[4:7], s42 offen lds
    s_waitcnt vmcnt(17)
    s_waitcnt lgkmcnt(0)
    v_mfma_f32_32x32x16_bf16 v[8:23], v[128:131], v[164:167], v[8:23]
    ds_read_b128 v[172:175], v183 offset:8192
    ds_read_b128 v[176:179], v183 offset:12288
    v_mfma_f32_32x32x16_bf16 v[24:39], v[128:131], v[168:171], v[24:39]
    s_add_u32 s41, s52, 6144
    buffer_load_dwordx4 v[116:119], v5, s[8:11], s41 offen offset:0
    v_mfma_f32_32x32x16_bf16 v[40:55], v[132:135], v[164:167], v[40:55]
    s_add_u32 s41, s52, 6144
    buffer_load_dwordx4 v[120:123], v5, s[8:11], s41 offen offset:1024
    v_mfma_f32_32x32x16_bf16 v[56:71], v[132:135], v[168:171], v[56:71]
    s_add_u32 s41, s52, 6144
    buffer_load_dwordx4 v[124:127], v5, s[8:11], s41 offen offset:2048
    v_mfma_f32_32x32x16_bf16 v[72:87], v[136:139], v[164:167], v[72:87]
    v_mfma_f32_32x32x16_bf16 v[88:103], v[136:139], v[168:171], v[88:103]
    s_waitcnt vmcnt(17)
    s_waitcnt lgkmcnt(0)
    v_mfma_f32_32x32x16_bf16 v[8:23], v[140:143], v[172:175], v[8:23]
    s_waitcnt vmcnt(3)
    ds_read_b128 v[164:167], v180 offset:0
    ds_read_b128 v[168:171], v180 offset:4096
    v_mfma_f32_32x32x16_bf16 v[24:39], v[140:143], v[176:179], v[24:39]
    s_add_u32 s41, s52, 9216
    buffer_load_dwordx4 v[128:131], v5, s[8:11], s41 offen offset:0
    v_mfma_f32_32x32x16_bf16 v[40:55], v[144:147], v[172:175], v[40:55]
    s_add_u32 s41, s52, 9216
    buffer_load_dwordx4 v[132:135], v5, s[8:11], s41 offen offset:1024
    v_mfma_f32_32x32x16_bf16 v[56:71], v[144:147], v[176:179], v[56:71]
    s_add_u32 s41, s52, 9216
    buffer_load_dwordx4 v[136:139], v5, s[8:11], s41 offen offset:2048
    v_mfma_f32_32x32x16_bf16 v[72:87], v[148:151], v[172:175], v[72:87]
    s_add_u32 s55, s50, 7
    s_and_b32 s55, s55, 7
    s_lshl_b32 s55, s55, 7
    s_add_u32 s55, s55, s45
    s_add_u32 s42, s55, 0
    s_add_u32 m0, s46, 8192
    s_nop 0
    buffer_load_dwordx4 v6, s[4:7], s42 offen lds
    v_mfma_f32_32x32x16_bf16 v[88:103], v[148:151], v[176:179], v[88:103]
    s_add_u32 s42, s55, 32768
    s_add_u32 m0, s46, 9216
    s_nop 0
    buffer_load_dwordx4 v7, s[4:7], s42 offen lds
    s_waitcnt vmcnt(17)
    s_waitcnt lgkmcnt(0)
    v_mfma_f32_32x32x16_bf16 v[8:23], v[152:155], v[164:167], v[8:23]
    ds_read_b128 v[172:175], v181 offset:0
    ds_read_b128 v[176:179], v181 offset:4096
    v_mfma_f32_32x32x16_bf16 v[24:39], v[152:155], v[168:171], v[24:39]
    s_add_u32 s53, s50, 7
    s_and_b32 s53, s53, 7
    s_mul_i32 s53, s53, 12288
    s_add_u32 s53, s53, s44
    buffer_load_dwordx4 v[140:143], v5, s[8:11], s53 offen offset:0
    v_mfma_f32_32x32x16_bf16 v[40:55], v[156:159], v[164:167], v[40:55]
    buffer_load_dwordx4 v[144:147], v5, s[8:11], s53 offen offset:1024
    v_mfma_f32_32x32x16_bf16 v[56:71], v[156:159], v[168:171], v[56:71]
    buffer_load_dwordx4 v[148:151], v5, s[8:11], s53 offen offset:2048
    v_mfma_f32_32x32x16_bf16 v[72:87], v[160:163], v[164:167], v[72:87]
    s_add_u32 s42, s55, 65536
    s_add_u32 m0, s46, 10240
    s_nop 0
    buffer_load_dwordx4 v6, s[4:7], s42 offen lds
    v_mfma_f32_32x32x16_bf16 v[88:103], v[160:163], v[168:171], v[88:103]
    s_add_u32 s42, s55, 98304
    s_add_u32 m0, s46, 11264
    s_nop 0
    buffer_load_dwordx4 v7, s[4:7], s42 offen lds
    s_add_u32 s42, s55, 131072
    s_add_u32 m0, s46, 12288
    s_nop 0
    buffer_load_dwordx4 v6, s[4:7], s42 offen lds
    s_waitcnt vmcnt(17)
    s_waitcnt lgkmcnt(0)
    v_mfma_f32_32x32x16_bf16 v[8:23], v[104:107], v[172:175], v[8:23]
    ds_read_b128 v[164:167], v182 offset:0
    ds_read_b128 v[168:171], v182 offset:4096
    v_mfma_f32_32x32x16_bf16 v[24:39], v[104:107], v[176:179], v[24:39]
    s_add_u32 s41, s53, 3072
    buffer_load_dwordx4 v[152:155], v5, s[8:11], s41 offen offset:0
    v_mfma_f32_32x32x16_bf16 v[40:55], v[108:111], v[172:175], v[40:55]
    s_add_u32 s41, s53, 3072
    buffer_load_dwordx4 v[156:159], v5, s[8:11], s41 offen offset:1024
    v_mfma_f32_32x32x16_bf16 v[56:71], v[108:111], v[176:179], v[56:71]
    s_add_u32 s41, s53, 3072
    buffer_load_dwordx4 v[160:163], v5, s[8:11], s41 offen offset:2048
    v_mfma_f32_32x32x16_bf16 v[72:87], v[112:115], v[172:175], v[72:87]
    s_add_u32 s42, s55, 163840
    s_add_u32 m0, s46, 13312
    s_nop 0
    buffer_load_dwordx4 v7, s[4:7], s42 offen lds
    v_mfma_f32_32x32x16_bf16 v[88:103], v[112:115], v[176:179], v[88:103]
    s_add_u32 s42, s55, 196608
    s_add_u32 m0, s46, 14336
    s_nop 0
    buffer_load_dwordx4 v6, s[4:7], s42 offen lds
    s_add_u32 s42, s55, 229376
    s_add_u32 m0, s46, 15360
    s_nop 0
    buffer_load_dwordx4 v7, s[4:7], s42 offen lds
    s_waitcnt vmcnt(17)
    s_waitcnt lgkmcnt(0)
    v_mfma_f32_32x32x16_bf16 v[8:23], v[116:119], v[164:167], v[8:23]
    ds_read_b128 v[172:175], v183 offset:0
    ds_read_b128 v[176:179], v183 offset:4096
    v_mfma_f32_32x32x16_bf16 v[24:39], v[116:119], v[168:171], v[24:39]
    s_add_u32 s41, s53, 6144
    buffer_load_dwordx4 v[104:107], v5, s[8:11], s41 offen offset:0
    v_mfma_f32_32x32x16_bf16 v[40:55], v[120:123], v[164:167], v[40:55]
    s_add_u32 s41, s53, 6144
    buffer_load_dwordx4 v[108:111], v5, s[8:11], s41 offen offset:1024
    v_mfma_f32_32x32x16_bf16 v[56:71], v[120:123], v[168:171], v[56:71]
    s_add_u32 s41, s53, 6144
    buffer_load_dwordx4 v[112:115], v5, s[8:11], s41 offen offset:2048
    v_mfma_f32_32x32x16_bf16 v[72:87], v[124:127], v[164:167], v[72:87]
    v_mfma_f32_32x32x16_bf16 v[88:103], v[124:127], v[168:171], v[88:103]
    s_waitcnt vmcnt(17)
    s_waitcnt lgkmcnt(0)
    v_mfma_f32_32x32x16_bf16 v[8:23], v[128:131], v[172:175], v[8:23]
    s_waitcnt vmcnt(3)
    ds_read_b128 v[164:167], v180 offset:8192
    ds_read_b128 v[168:171], v180 offset:12288
    v_mfma_f32_32x32x16_bf16 v[24:39], v[128:131], v[176:179], v[24:39]
    s_add_u32 s41, s53, 9216
    buffer_load_dwordx4 v[116:119], v5, s[8:11], s41 offen offset:0
    v_mfma_f32_32x32x16_bf16 v[40:55], v[132:135], v[172:175], v[40:55]
    s_add_u32 s41, s53, 9216
    buffer_load_dwordx4 v[120:123], v5, s[8:11], s41 offen offset:1024
    v_mfma_f32_32x32x16_bf16 v[56:71], v[132:135], v[176:179], v[56:71]
    s_add_u32 s41, s53, 9216
    buffer_load_dwordx4 v[124:127], v5, s[8:11], s41 offen offset:2048
    v_mfma_f32_32x32x16_bf16 v[72:87], v[136:139], v[172:175], v[72:87]
    v_mfma_f32_32x32x16_bf16 v[88:103], v[136:139], v[176:179], v[88:103]
    s_waitcnt vmcnt(15)
    s_waitcnt lgkmcnt(0)
    v_mfma_f32_32x32x16_bf16 v[8:23], v[140:143], v[164:167], v[8:23]
    ds_read_b128 v[172:175], v181 offset:8192
    ds_read_b128 v[176:179], v181 offset:12288
    v_mfma_f32_32x32x16_bf16 v[24:39], v[140:143], v[168:171], v[24:39]
    v_mfma_f32_32x32x16_bf16 v[40:55], v[144:147], v[164:167], v[40:55]
    v_mfma_f32_32x32x16_bf16 v[56:71], v[144:147], v[168:171], v[56:71]
    v_mfma_f32_32x32x16_bf16 v[72:87], v[148:151], v[164:167], v[72:87]
    v_mfma_f32_32x32x16_bf16 v[88:103], v[148:151], v[168:171], v[88:103]
    s_waitcnt vmcnt(9)
    s_waitcnt lgkmcnt(0)
    v_mfma_f32_32x32x16_bf16 v[8:23], v[152:155], v[172:175], v[8:23]
    ds_read_b128 v[164:167], v182 offset:8192
    ds_read_b128 v[168:171], v182 offset:12288
    v_mfma_f32_32x32x16_bf16 v[24:39], v[152:155], v[176:179], v[24:39]
    v_mfma_f32_32x32x16_bf16 v[40:55], v[156:159], v[172:175], v[40:55]
    v_mfma_f32_32x32x16_bf16 v[56:71], v[156:159], v[176:179], v[56:71]
    v_mfma_f32_32x32x16_bf16 v[72:87], v[160:163], v[172:175], v[72:87]
    v_mfma_f32_32x32x16_bf16 v[88:103], v[160:163], v[176:179], v[88:103]
    s_waitcnt vmcnt(3)
    s_waitcnt lgkmcnt(0)
    v_mfma_f32_32x32x16_bf16 v[8:23], v[104:107], v[164:167], v[8:23]
    ds_read_b128 v[172:175], v183 offset:8192
    ds_read_b128 v[176:179], v183 offset:12288
    v_mfma_f32_32x32x16_bf16 v[24:39], v[104:107], v[168:171], v[24:39]
    s_lshl_b32 s40, s32, 3
    s_add_u32 s40, s40, s33
    s_lshl_b32 s40, s40, 2
    s_add_u32 s40, s40, s34
    s_mul_i32 s40, s40, 3072
    s_add_u32 s40, s40, 3145728
    buffer_load_dwordx4 v[184:187], v5, s[8:11], s40 offen offset:0
    v_mfma_f32_32x32x16_bf16 v[40:55], v[108:111], v[164:167], v[40:55]
    buffer_load_dwordx4 v[188:191], v5, s[8:11], s40 offen offset:1024
    v_mfma_f32_32x32x16_bf16 v[56:71], v[108:111], v[168:171], v[56:71]
    buffer_load_dwordx4 v[192:195], v5, s[8:11], s40 offen offset:2048
    v_mfma_f32_32x32x16_bf16 v[72:87], v[112:115], v[164:167], v[72:87]
    v_and_b32 v2, 31, v1
    v_lshlrev_b32 v2, 1, v2
    s_lshr_b32 s40, s34, 1
    s_lshl_b32 s40, s40, 6
    s_lshl_b32 s43, s32, 7
    s_add_u32 s40, s40, s43
    buffer_load_ushort v196, v2, s[12:15], s40 offen
    v_mfma_f32_32x32x16_bf16 v[88:103], v[112:115], v[168:171], v[88:103]
    s_waitcnt vmcnt(4)
    s_waitcnt lgkmcnt(0)
    v_mfma_f32_32x32x16_bf16 v[8:23], v[116:119], v[172:175], v[8:23]
    v_mfma_f32_32x32x16_bf16 v[24:39], v[116:119], v[176:179], v[24:39]
    v_mfma_f32_32x32x16_bf16 v[40:55], v[120:123], v[172:175], v[40:55]
    v_mfma_f32_32x32x16_bf16 v[56:71], v[120:123], v[176:179], v[56:71]
    v_mfma_f32_32x32x16_bf16 v[72:87], v[124:127], v[172:175], v[72:87]
    v_mfma_f32_32x32x16_bf16 v[88:103], v[124:127], v[176:179], v[88:103]
    s_setprio 0
    v_add_u32 v4, 0x10000, v5
    s_nop 15
    s_barrier
    s_cmp_lg_u32 s34, 0
    s_cbranch_scc1 g_epi_2
    ds_write_b128 v5, v[12:15] offset:30720
    ds_write_b128 v5, v[20:23] offset:31744
    ds_write_b128 v5, v[44:47] offset:32768
    ds_write_b128 v5, v[52:55] offset:33792
    ds_write_b128 v5, v[76:79] offset:34816
    ds_write_b128 v5, v[84:87] offset:35840
    ds_write_b128 v5, v[24:27] offset:43008
    ds_write_b128 v5, v[32:35] offset:44032
    ds_write_b128 v5, v[56:59] offset:45056
    ds_write_b128 v5, v[64:67] offset:46080
    ds_write_b128 v5, v[88:91] offset:47104
    ds_write_b128 v5, v[96:99] offset:48128
    ds_write_b128 v5, v[28:31] offset:55296
    ds_write_b128 v5, v[36:39] offset:56320
    ds_write_b128 v5, v[60:63] offset:57344
    ds_write_b128 v5, v[68:71] offset:58368
    ds_write_b128 v5, v[92:95] offset:59392
    ds_write_b128 v5, v[100:103] offset:60416
    v_pk_add_f32 v[104:105], v[8:9], 0
    v_pk_add_f32 v[106:107], v[10:11], 0
    v_pk_add_f32 v[108:109], v[16:17], 0
    v_pk_add_f32 v[110:111], v[18:19], 0
    v_pk_add_f32 v[112:113], v[40:41], 0
    v_pk_add_f32 v[114:115], v[42:43], 0
    v_pk_add_f32 v[116:117], v[48:49], 0
    v_pk_add_f32 v[118:119], v[50:51], 0
    v_pk_add_f32 v[120:121], v[72:73], 0
    v_pk_add_f32 v[122:123], v[74:75], 0
    v_pk_add_f32 v[124:125], v[80:81], 0
    v_pk_add_f32 v[126:127], v[82:83], 0
    s_branch g_epi_end_1
g_epi_2:
    s_cmp_lg_u32 s34, 1
    s_cbranch_scc1 g_epi_3
    ds_write_b128 v5, v[8:11] offset:0
    ds_write_b128 v5, v[16:19] offset:1024
    ds_write_b128 v5, v[40:43] offset:2048
    ds_write_b128 v5, v[48:51] offset:3072
    ds_write_b128 v5, v[72:75] offset:4096
    ds_write_b128 v5, v[80:83] offset:5120
    ds_write_b128 v5, v[24:27] offset:49152
    ds_write_b128 v5, v[32:35] offset:50176
    ds_write_b128 v5, v[56:59] offset:51200
    ds_write_b128 v5, v[64:67] offset:52224
    ds_write_b128 v5, v[88:91] offset:53248
    ds_write_b128 v5, v[96:99] offset:54272
    ds_write_b128 v5, v[28:31] offset:61440
    ds_write_b128 v5, v[36:39] offset:62464
    ds_write_b128 v5, v[60:63] offset:63488
    ds_write_b128 v5, v[68:71] offset:64512
    ds_write_b128 v4, v[92:95] offset:0
    ds_write_b128 v4, v[100:103] offset:1024
    v_pk_add_f32 v[104:105], v[12:13], 0
    v_pk_add_f32 v[106:107], v[14:15], 0
    v_pk_add_f32 v[108:109], v[20:21], 0
    v_pk_add_f32 v[110:111], v[22:23], 0
    v_pk_add_f32 v[112:113], v[44:45], 0
    v_pk_add_f32 v[114:115], v[46:47], 0
    v_pk_add_f32 v[116:117], v[52:53], 0
    v_pk_add_f32 v[118:119], v[54:55], 0
    v_pk_add_f32 v[120:121], v[76:77], 0
    v_pk_add_f32 v[122:123], v[78:79], 0
    v_pk_add_f32 v[124:125], v[84:85], 0
    v_pk_add_f32 v[126:127], v[86:87], 0
    s_branch g_epi_end_1
g_epi_3:
    s_cmp_lg_u32 s34, 2
    s_cbranch_scc1 g_epi_4
    ds_write_b128 v5, v[8:11] offset:6144
    ds_write_b128 v5, v[16:19] offset:7168
    ds_write_b128 v5, v[40:43] offset:8192
    ds_write_b128 v5, v[48:51] offset:9216
    ds_write_b128 v5, v[72:75] offset:10240
    ds_write_b128 v5, v[80:83] offset:11264
    ds_write_b128 v5, v[12:15] offset:18432
    ds_write_b128 v5, v[20:23] offset:19456
    ds_write_b128 v5, v[44:47] offset:20480
    ds_write_b128 v5, v[52:55] offset:21504
    ds_write_b128 v5, v[76:79] offset:22528
    ds_write_b128 v5, v[84:87] offset:23552
    ds_write_b128 v4, v[28:31] offset:2048
    ds_write_b128 v4, v[36:39] offset:3072
    ds_write_b128 v4, v[60:63] offset:4096
    ds_write_b128 v4, v[68:71] offset:5120
    ds_write_b128 v4, v[92:95] offset:6144
    ds_write_b128 v4, v[100:103] offset:7168
    v_pk_add_f32 v[104:105], v[24:25], 0
    v_pk_add_f32 v[106:107], v[26:27], 0
    v_pk_add_f32 v[108:109], v[32:33], 0
    v_pk_add_f32 v[110:111], v[34:35], 0
    v_pk_add_f32 v[112:113], v[56:57], 0
    v_pk_add_f32 v[114:115], v[58:59], 0
    v_pk_add_f32 v[116:117], v[64:65], 0
    v_pk_add_f32 v[118:119], v[66:67], 0
    v_pk_add_f32 v[120:121], v[88:89], 0
    v_pk_add_f32 v[122:123], v[90:91], 0
    v_pk_add_f32 v[124:125], v[96:97], 0
    v_pk_add_f32 v[126:127], v[98:99], 0
    s_branch g_epi_end_1
g_epi_4:
    ds_write_b128 v5, v[8:11] offset:12288
    ds_write_b128 v5, v[16:19] offset:13312
    ds_write_b128 v5, v[40:43] offset:14336
    ds_write_b128 v5, v[48:51] offset:15360
    ds_write_b128 v5, v[72:75] offset:16384
    ds_write_b128 v5, v[80:83] offset:17408
    ds_write_b128 v5, v[12:15] offset:24576
    ds_write_b128 v5, v[20:23] offset:25600
    ds_write_b128 v5, v[44:47] offset:26624
    ds_write_b128 v5, v[52:55] offset:27648
    ds_write_b128 v5, v[76:79] offset:28672
    ds_write_b128 v5, v[84:87] offset:29696
    ds_write_b128 v5, v[24:27] offset:36864
    ds_write_b128 v5, v[32:35] offset:37888
    ds_write_b128 v5, v[56:59] offset:38912
    ds_write_b128 v5, v[64:67] offset:39936
    ds_write_b128 v5, v[88:91] offset:40960
    ds_write_b128 v5, v[96:99] offset:41984
    v_pk_add_f32 v[104:105], v[28:29], 0
    v_pk_add_f32 v[106:107], v[30:31], 0
    v_pk_add_f32 v[108:109], v[36:37], 0
    v_pk_add_f32 v[110:111], v[38:39], 0
    v_pk_add_f32 v[112:113], v[60:61], 0
    v_pk_add_f32 v[114:115], v[62:63], 0
    v_pk_add_f32 v[116:117], v[68:69], 0
    v_pk_add_f32 v[118:119], v[70:71], 0
    v_pk_add_f32 v[120:121], v[92:93], 0
    v_pk_add_f32 v[122:123], v[94:95], 0
    v_pk_add_f32 v[124:125], v[100:101], 0
    v_pk_add_f32 v[126:127], v[102:103], 0
g_epi_end_1:
    s_waitcnt lgkmcnt(0)
    s_barrier
    s_mul_i32 s40, s34, 18432
    v_add_u32 v2, s40, v5
    ds_read_b128 v[8:11], v2 offset:0
    ds_read_b128 v[12:15], v2 offset:1024
    ds_read_b128 v[16:19], v2 offset:2048
    ds_read_b128 v[20:23], v2 offset:3072
    ds_read_b128 v[24:27], v2 offset:4096
    ds_read_b128 v[28:31], v2 offset:5120
    ds_read_b128 v[32:35], v2 offset:6144
    ds_read_b128 v[36:39], v2 offset:7168
    ds_read_b128 v[40:43], v2 offset:8192
    ds_read_b128 v[44:47], v2 offset:9216
    ds_read_b128 v[48:51], v2 offset:10240
    ds_read_b128 v[52:55], v2 offset:11264
    ds_read_b128 v[56:59], v2 offset:12288
    ds_read_b128 v[60:63], v2 offset:13312
    ds_read_b128 v[64:67], v2 offset:14336
    ds_read_b128 v[68:71], v2 offset:15360
    ds_read_b128 v[72:75], v2 offset:16384
    ds_read_b128 v[76:79], v2 offset:17408
    v_lshrrev_b32 v6, 4, v1
    v_and_b32 v6, 1, v6
    v_mul_u32_u24 v6, 24576, v6
    v_and_b32 v3, 15, v1
    v_lshrrev_b32 v4, 5, v1
    v_lshl_add_u32 v3, v4, 4, v3
    v_lshl_add_u32 v6, v3, 4, v6
    s_mul_i32 s40, s32, 98304
    s_lshr_b32 s41, s34, 1
    s_mul_i32 s41, s41, 49152
    s_add_u32 s40, s40, s41
    s_mul_i32 s41, s33, 3072
    s_add_u32 s40, s40, s41
    s_and_b32 s41, s34, 1
    s_lshl_b32 s41, s41, 9
    s_add_u32 s40, s40, s41
    s_add_u32 s40, s40, 11534336
    s_waitcnt vmcnt(0)
    v_lshlrev_b32 v180, 16, v196
    v_lshlrev_b32 v80, 16, v184
    v_and_b32 v81, 0xffff0000, v184
    v_lshlrev_b32 v82, 16, v185
    v_and_b32 v83, 0xffff0000, v185
    v_lshlrev_b32 v84, 16, v186
    v_and_b32 v85, 0xffff0000, v186
    v_lshlrev_b32 v86, 16, v187
    v_and_b32 v87, 0xffff0000, v187
    v_lshlrev_b32 v88, 16, v188
    v_and_b32 v89, 0xffff0000, v188
    v_lshlrev_b32 v90, 16, v189
    v_and_b32 v91, 0xffff0000, v189
    v_lshlrev_b32 v92, 16, v190
    v_and_b32 v93, 0xffff0000, v190
    v_lshlrev_b32 v94, 16, v191
    v_and_b32 v95, 0xffff0000, v191
    v_lshlrev_b32 v96, 16, v192
    v_and_b32 v97, 0xffff0000, v192
    v_lshlrev_b32 v98, 16, v193
    v_and_b32 v99, 0xffff0000, v193
    v_lshlrev_b32 v100, 16, v194
    v_and_b32 v101, 0xffff0000, v194
    v_lshlrev_b32 v102, 16, v195
    v_and_b32 v103, 0xffff0000, v195
    s_waitcnt lgkmcnt(12)
    v_pk_add_f32 v[104:105], v[104:105], v[8:9]
    v_pk_add_f32 v[106:107], v[106:107], v[10:11]
    v_pk_add_f32 v[108:109], v[108:109], v[12:13]
    v_pk_add_f32 v[110:111], v[110:111], v[14:15]
    v_pk_add_f32 v[112:113], v[112:113], v[16:17]
    v_pk_add_f32 v[114:115], v[114:115], v[18:19]
    v_pk_add_f32 v[116:117], v[116:117], v[20:21]
    v_pk_add_f32 v[118:119], v[118:119], v[22:23]
    v_pk_add_f32 v[120:121], v[120:121], v[24:25]
    v_pk_add_f32 v[122:123], v[122:123], v[26:27]
    v_pk_add_f32 v[124:125], v[124:125], v[28:29]
    v_pk_add_f32 v[126:127], v[126:127], v[30:31]
    s_waitcnt lgkmcnt(6)
    v_pk_add_f32 v[104:105], v[104:105], v[32:33]
    v_pk_add_f32 v[106:107], v[106:107], v[34:35]
    v_pk_add_f32 v[108:109], v[108:109], v[36:37]
    v_pk_add_f32 v[110:111], v[110:111], v[38:39]
    v_pk_add_f32 v[112:113], v[112:113], v[40:41]
    v_pk_add_f32 v[114:115], v[114:115], v[42:43]
    v_pk_add_f32 v[116:117], v[116:117], v[44:45]
    v_pk_add_f32 v[118:119], v[118:119], v[46:47]
    v_pk_add_f32 v[120:121], v[120:121], v[48:49]
    v_pk_add_f32 v[122:123], v[122:123], v[50:51]
    v_pk_add_f32 v[124:125], v[124:125], v[52:53]
    v_pk_add_f32 v[126:127], v[126:127], v[54:55]
    s_waitcnt lgkmcnt(0)
    v_pk_add_f32 v[104:105], v[104:105], v[56:57]
    v_pk_add_f32 v[106:107], v[106:107], v[58:59]
    v_pk_add_f32 v[108:109], v[108:109], v[60:61]
    v_pk_add_f32 v[110:111], v[110:111], v[62:63]
    v_pk_add_f32 v[112:113], v[112:113], v[64:65]
    v_pk_add_f32 v[114:115], v[114:115], v[66:67]
    v_pk_add_f32 v[116:117], v[116:117], v[68:69]
    v_pk_add_f32 v[118:119], v[118:119], v[70:71]
    v_pk_add_f32 v[120:121], v[120:121], v[72:73]
    v_pk_add_f32 v[122:123], v[122:123], v[74:75]
    v_pk_add_f32 v[124:125], v[124:125], v[76:77]
    v_pk_add_f32 v[126:127], v[126:127], v[78:79]
    v_pk_add_f32 v[104:105], v[104:105], v[180:181] op_sel_hi:[1,0]
    v_pk_add_f32 v[106:107], v[106:107], v[180:181] op_sel_hi:[1,0]
    v_pk_add_f32 v[108:109], v[108:109], v[180:181] op_sel_hi:[1,0]
    v_pk_add_f32 v[110:111], v[110:111], v[180:181] op_sel_hi:[1,0]
    v_pk_add_f32 v[112:113], v[112:113], v[180:181] op_sel_hi:[1,0]
    v_pk_add_f32 v[114:115], v[114:115], v[180:181] op_sel_hi:[1,0]
    v_pk_add_f32 v[116:117], v[116:117], v[180:181] op_sel_hi:[1,0]
    v_pk_add_f32 v[118:119], v[118:119], v[180:181] op_sel_hi:[1,0]
    v_pk_add_f32 v[120:121], v[120:121], v[180:181] op_sel_hi:[1,0]
    v_pk_add_f32 v[122:123], v[122:123], v[180:181] op_sel_hi:[1,0]
    v_pk_add_f32 v[124:125], v[124:125], v[180:181] op_sel_hi:[1,0]
    v_pk_add_f32 v[126:127], v[126:127], v[180:181] op_sel_hi:[1,0]
    v_pk_mul_f32 v[104:105], v[104:105], v[80:81]
    v_pk_mul_f32 v[106:107], v[106:107], v[82:83]
    v_pk_mul_f32 v[108:109], v[108:109], v[84:85]
    v_pk_mul_f32 v[110:111], v[110:111], v[86:87]
    v_pk_mul_f32 v[112:113], v[112:113], v[88:89]
    v_pk_mul_f32 v[114:115], v[114:115], v[90:91]
    v_pk_mul_f32 v[116:117], v[116:117], v[92:93]
    v_pk_mul_f32 v[118:119], v[118:119], v[94:95]
    v_pk_mul_f32 v[120:121], v[120:121], v[96:97]
    v_pk_mul_f32 v[122:123], v[122:123], v[98:99]
    v_pk_mul_f32 v[124:125], v[124:125], v[100:101]
    v_pk_mul_f32 v[126:127], v[126:127], v[102:103]
    v_cvt_pk_bf16_f32 v8, v104, v105
    v_cvt_pk_bf16_f32 v9, v106, v107
    v_cvt_pk_bf16_f32 v10, v108, v109
    v_cvt_pk_bf16_f32 v11, v110, v111
    buffer_store_dwordx4 v[8:11], v6, s[8:11], s40 offen offset:0
    v_cvt_pk_bf16_f32 v12, v112, v113
    v_cvt_pk_bf16_f32 v13, v114, v115
    v_cvt_pk_bf16_f32 v14, v116, v117
    v_cvt_pk_bf16_f32 v15, v118, v119
    buffer_store_dwordx4 v[12:15], v6, s[8:11], s40 offen offset:1024
    v_cvt_pk_bf16_f32 v16, v120, v121
    v_cvt_pk_bf16_f32 v17, v122, v123
    v_cvt_pk_bf16_f32 v18, v124, v125
    v_cvt_pk_bf16_f32 v19, v126, v127
    buffer_store_dwordx4 v[16:19], v6, s[8:11], s40 offen offset:2048
    s_endpgm
k2_kernel_conv:
    s_load_dwordx2 s[4:5], s[0:1], 32
    s_load_dwordx2 s[8:9], s[0:1], 104
    s_load_dwordx2 s[12:13], s[0:1], 40
    s_load_dwordx2 s[16:17], s[0:1], 64
    s_load_dwordx2 s[20:21], s[0:1], 80
    v_lshrrev_b32 v3, 6, v0
    v_and_b32 v1, 63, v0
    v_readfirstlane_b32 s34, v3
    s_mov_b32 s6, 2621440
    s_mov_b32 s7, 0x20000
    s_mov_b32 s10, 15990784
    s_mov_b32 s11, 0x20000
    s_mov_b32 s14, 1280
    s_mov_b32 s15, 0x20000
    s_mov_b32 s18, 8388608
    s_mov_b32 s19, 0x20000
    s_mov_b32 s22, 983040
    s_mov_b32 s23, 0x20000
    s_mov_b32 s32, s2
    v_lshlrev_b32 v2, 4, v0
    v_subrev_u32 v47, 16, v2
    s_mov_b32 s56, s2
    s_add_u32 s57, s2, 256
    s_lshr_b32 s58, s2, 1
    s_add_u32 s58, s58, 512
    s_waitcnt lgkmcnt(0)
    s_lshl_b32 s40, s56, 12
    buffer_load_dwordx4 v[12:15], v2, s[4:7], s40 offen
    buffer_load_dwordx4 v[8:11], v47, s[4:7], s40 offen
    s_add_u32 s40, s40, 6291456
    buffer_load_dwordx4 v[32:35], v2, s[8:11], s40 offen
    s_lshl_b32 s40, s56, 1
    v_mov_b32 v3, 0
    buffer_load_ushort v44, v3, s[12:15], s40 offen
    s_lshr_b32 s47, s2, 3
    s_lshl_b32 s47, s47, 2
    s_add_u32 s47, s47, s34
    s_mul_i32 s40, s47, 12
    v_add_u32 v3, s40, v1
    v_mul_u32_u24 v4, 43691, v3
    v_lshrrev_b32 v4, 22, v4
    v_mul_u32_u24 v5, 96, v4
    v_sub_u32 v3, v3, v5
    v_mul_u32_u24 v4, 98304, v4
    v_lshl_add_u32 v49, v3, 7, v4
    s_and_b32 s40, s2, 7
    s_lshr_b32 s52, s40, 1
    s_lshl_b32 s52, s52, 21
    s_and_b32 s53, s40, 1
    s_mul_i32 s53, s53, 1572864
    s_add_u32 s53, s53, 0
    s_lshl_b32 s40, s47, 4
    v_add_u32 v3, s40, v1
    v_lshrrev_b32 v4, 2, v3
    v_lshlrev_b32 v4, 12, v4
    v_and_b32 v3, 3, v3
    v_lshl_add_u32 v48, v3, 10, v4
    s_cmp_ge_u32 s2, 192
    s_cbranch_scc1 c_wj_6
    s_mul_i32 s40, s2, 2731
    s_lshr_b32 s40, s40, 16
    s_mul_i32 s41, s40, 24
    s_sub_u32 s41, s2, s41
    s_mul_i32 s41, s41, 40960
    s_mul_i32 s40, s40, 160
    s_add_u32 s54, s40, s41
    v_mov_b32 v3, v0
    v_mul_u32_u24 v4, 6554, v3
    v_lshrrev_b32 v4, 16, v4
    v_mul_u32_u24 v5, 10, v4
    v_sub_u32 v3, v3, v5
    v_lshlrev_b32 v3, 4, v3
    v_mul_u32_u24 v4, 1280, v4
    v_add_u32 v3, v3, v4
    s_lshl_b32 s40, s34, 10
    s_add_u32 m0, s40, 73216
    s_nop 0
    buffer_load_dwordx4 v3, s[20:23], s54 offen lds
    s_cmp_lg_u32 s34, 0
    s_cbranch_scc1 c_wj2_7
    v_add_u32 v3, 256, v1
    v_mul_u32_u24 v4, 6554, v3
    v_lshrrev_b32 v4, 16, v4
    v_mul_u32_u24 v5, 10, v4
    v_sub_u32 v3, v3, v5
    v_lshlrev_b32 v3, 4, v3
    v_mul_u32_u24 v4, 1280, v4
    v_add_u32 v3, v3, v4
    s_mov_b32 m0, 77312
    s_nop 0
    buffer_load_dwordx4 v3, s[20:23], s54 offen lds
c_wj2_7:
c_wj_6:
    s_lshl_b32 s40, s57, 12
    buffer_load_dwordx4 v[20:23], v2, s[4:7], s40 offen
    buffer_load_dwordx4 v[16:19], v47, s[4:7], s40 offen
    s_add_u32 s40, s40, 6291456
    buffer_load_dwordx4 v[36:39], v2, s[8:11], s40 offen
    s_lshl_b32 s40, s57, 1
    v_mov_b32 v3, 0
    buffer_load_ushort v45, v3, s[12:15], s40 offen
    s_lshl_b32 s40, s58, 12
    buffer_load_dwordx4 v[28:31], v2, s[4:7], s40 offen
    buffer_load_dwordx4 v[24:27], v47, s[4:7], s40 offen
    s_add_u32 s40, s40, 6291456
    buffer_load_dwordx4 v[40:43], v2, s[8:11], s40 offen
    s_lshl_b32 s40, s58, 1
    v_mov_b32 v3, 0
    buffer_load_ushort v46, v3, s[12:15], s40 offen
    v_mov_b32 v52, 0
    v_mov_b32 v53, 0
    v_mov_b32 v54, 0
    v_mov_b32 v55, 0
    v_lshrrev_b32 v3, 2, v0
    v_mul_u32_u24 v3, 4160, v3
    v_and_b32 v4, 3, v0
    v_lshl_add_u32 v3, v4, 4, v3
    v_cmp_gt_u32 vcc, 160, v0
    s_nop 0
    s_and_saveexec_b64 s[50:51], vcc
    s_cbranch_execz c_z_8
    ds_write_b128 v2, v[52:55] offset:33280
    v_cmp_gt_u32 vcc, 32, v0
    s_nop 0
    s_and_b64 exec, exec, vcc
    s_cbranch_execz c_z2_9
    ds_write_b128 v3, v[52:55] offset:0
c_z2_9:
c_z_8:
    s_mov_b64 exec, s[50:51]
    v_add_u32 v56, 48, v2
    v_lshrrev_b32 v3, 2, v0
    v_lshl_add_u32 v57, v3, 4, v2
    v_add_u32 v57, 35840, v57
    v_and_b32 v3, 7, v1
    v_mul_u32_u24 v3, 4160, v3
    v_and_b32 v4, 31, v1
    v_lshrrev_b32 v4, 3, v4
    v_lshrrev_b32 v5, 5, v1
    v_sub_u32 v4, v4, v5
    v_lshl_add_u32 v3, v4, 4, v3
    v_add_u32 v58, 16, v3
    v_and_b32 v3, 31, v1
    v_mul_u32_u24 v3, 80, v3
    v_lshl_add_u32 v59, v5, 4, v3
    v_add_u32 v59, 33280, v59
    v_and_b32 v3, 31, v1
    v_lshlrev_b32 v4, 3, v5
    v_add_u32 v4, 7, v4
    v_sub_u32 v4, v4, v3
    v_mov_b32 v68, 0xffff
    v_mov_b32 v69, 0xffff0000
    v_cmp_eq_u32 vcc, 0, v4
    s_nop 1
    v_cndmask_b32 v60, 0, v68, vcc
    v_cmp_eq_u32 vcc, 1, v4
    s_nop 1
    v_cndmask_b32 v60, v60, v69, vcc
    v_cmp_eq_u32 vcc, 2, v4
    s_nop 1
    v_cndmask_b32 v61, 0, v68, vcc
    v_cmp_eq_u32 vcc, 3, v4
    s_nop 1
    v_cndmask_b32 v61, v61, v69, vcc
    v_cmp_eq_u32 vcc, 4, v4
    s_nop 1
    v_cndmask_b32 v62, 0, v68, vcc
    v_cmp_eq_u32 vcc, 5, v4
    s_nop 1
    v_cndmask_b32 v62, v62, v69, vcc
    v_cmp_eq_u32 vcc, 6, v4
    s_nop 1
    v_cndmask_b32 v63, 0, v68, vcc
    v_cmp_eq_u32 vcc, 7, v4
    s_nop 1
    v_cndmask_b32 v63, v63, v69, vcc
    v_cmp_eq_u32 vcc, -16, v4
    s_nop 1
    v_cndmask_b32 v64, 0, v68, vcc
    v_cmp_eq_u32 vcc, -15, v4
    s_nop 1
    v_cndmask_b32 v64, v64, v69, vcc
    v_cmp_eq_u32 vcc, -14, v4
    s_nop 1
    v_cndmask_b32 v65, 0, v68, vcc
    v_cmp_eq_u32 vcc, -13, v4
    s_nop 1
    v_cndmask_b32 v65, v65, v69, vcc
    v_cmp_eq_u32 vcc, -12, v4
    s_nop 1
    v_cndmask_b32 v66, 0, v68, vcc
    v_cmp_eq_u32 vcc, -11, v4
    s_nop 1
    v_cndmask_b32 v66, v66, v69, vcc
    v_cmp_eq_u32 vcc, -10, v4
    s_nop 1
    v_cndmask_b32 v67, 0, v68, vcc
    v_cmp_eq_u32 vcc, -9, v4
    s_nop 1
    v_cndmask_b32 v67, v67, v69, vcc
    v_and_b32 v3, 31, v1
    v_mul_u32_u24 v3, 144, v3
    v_lshl_add_u32 v70, v5, 4, v3
    v_add_u32 v70, 40960, v70
    v_and_b32 v3, 127, v0
    v_lshrrev_b32 v3, 2, v3
    v_mul_u32_u24 v3, 144, v3
    v_and_b32 v4, 3, v0
    v_lshl_add_u32 v71, v4, 5, v3
    v_add_u32 v71, 40960, v71
    s_waitcnt vmcnt(8)
    v_cmp_ne_u32 vcc, 0, v0
    s_nop 1
    v_cndmask_b32 v8, 0, v8, vcc
    v_cndmask_b32 v9, 0, v9, vcc
    v_cndmask_b32 v10, 0, v10, vcc
    v_cndmask_b32 v11, 0, v11, vcc
    v_alignbit_b32 v176, v9, v8, 16
    v_alignbit_b32 v177, v10, v9, 16
    v_alignbit_b32 v178, v11, v10, 16
    v_alignbit_b32 v179, v12, v11, 16
    v_alignbit_b32 v180, v13, v12, 16
    v_alignbit_b32 v181, v14, v13, 16
    v_alignbit_b32 v182, v15, v14, 16
    ds_write_b128 v56, v[176:179] offset:0
    v_mov_b32 v184, v9
    v_mov_b32 v185, v10
    v_mov_b32 v186, v11
    v_mov_b32 v187, v12
    ds_write_b128 v56, v[184:187] offset:4160
    s_nop 1
    v_mov_b32 v184, v177
    v_mov_b32 v185, v178
    v_mov_b32 v186, v179
    v_mov_b32 v187, v180
    ds_write_b128 v56, v[184:187] offset:8320
    s_nop 1
    ds_write_b128 v56, v[10:13] offset:12480
    ds_write_b128 v56, v[178:181] offset:16640
    v_mov_b32 v184, v11
    v_mov_b32 v185, v12
    v_mov_b32 v186, v13
    v_mov_b32 v187, v14
    ds_write_b128 v56, v[184:187] offset:20800
    s_nop 1
    v_mov_b32 v184, v179
    v_mov_b32 v185, v180
    v_mov_b32 v186, v181
    v_mov_b32 v187, v182
    ds_write_b128 v56, v[184:187] offset:24960
    s_nop 1
    ds_write_b128 v56, v[12:15] offset:29120
    ds_write_b128 v57, v[32:35]
    v_lshlrev_b32 v3, 16, v44
    v_or_b32 v3, v3, v44
    v_and_b32 v188, v60, v3
    v_and_b32 v189, v61, v3
    v_and_b32 v190, v62, v3
    v_and_b32 v191, v63, v3
    v_and_b32 v192, v64, v3
    v_and_b32 v193, v65, v3
    v_and_b32 v194, v66, v3
    v_and_b32 v195, v67, v3
    s_waitcnt vmcnt(4)
    s_waitcnt lgkmcnt(0)
    s_barrier
    s_cmp_ge_u32 s2, 192
    s_cbranch_scc1 c_wj3_10
    v_lshrrev_b32 v3, 4, v1
    v_and_b32 v5, 15, v1
    v_lshrrev_b32 v4, 2, v5
    v_lshl_add_u32 v3, v3, 2, v4
    v_mul_u32_u24 v3, 160, v3
    v_and_b32 v4, 3, v5
    v_lshl_add_u32 v3, v4, 3, v3
    v_lshlrev_b32 v5, 4, v1
    s_lshl_b32 s40, s34, 5
    s_add_u32 s41, s40, 73216
    v_add_u32 v4, s41, v3
    ds_read_b64_tr_b16 v[184:185], v4
    ds_read_b64_tr_b16 v[186:187], v4 offset:2560
    s_mul_i32 s41, s2, 5120
    s_lshl_b32 s40, s40, 5
    s_add_u32 s41, s41, s40
    s_add_u32 s41, s41, 15007744
    s_waitcnt lgkmcnt(0)
    buffer_store_dwordx4 v[184:187], v5, s[8:11], s41 offen
    s_nop 1
    s_cmp_lg_u32 s34, 0
    s_cbranch_scc1 c_wj4_11
    s_mov_b32 s40, 128
    s_add_u32 s41, s40, 73216
    v_add_u32 v4, s41, v3
    ds_read_b64_tr_b16 v[184:185], v4
    ds_read_b64_tr_b16 v[186:187], v4 offset:2560
    s_mul_i32 s41, s2, 5120
    s_lshl_b32 s40, s40, 5
    s_add_u32 s41, s41, s40
    s_add_u32 s41, s41, 15007744
    s_waitcnt lgkmcnt(0)
    buffer_store_dwordx4 v[184:187], v5, s[8:11], s41 offen
    s_nop 1
c_wj4_11:
c_wj3_10:
    s_cmp_lg_u32 s34, 0
    s_cbranch_scc1 c_pw_13
    ds_read_b128 v[104:107], v58 offset:0
    ds_read_b128 v[128:131], v59 offset:2592
    ds_read_b128 v[152:155], v59 offset:5152
    ds_read_b128 v[108:111], v58 offset:32
    ds_read_b128 v[132:135], v59 offset:2560
    ds_read_b128 v[156:159], v59 offset:5120
    ds_read_b128 v[112:115], v58 offset:64
    ds_read_b128 v[136:139], v59 offset:2512
    ds_read_b128 v[160:163], v59 offset:5072
    ds_read_b128 v[116:119], v58 offset:96
    ds_read_b128 v[140:143], v59 offset:2480
    ds_read_b128 v[164:167], v59 offset:5040
    ds_read_b128 v[120:123], v58 offset:128
    ds_read_b128 v[144:147], v59 offset:2432
    ds_read_b128 v[168:171], v59 offset:4992
    s_waitcnt lgkmcnt(12)
    v_mfma_f32_32x32x16_bf16 v[72:87], v[104:107], v[128:131], 0
    v_mfma_f32_32x32x16_bf16 v[88:103], v[104:107], v[152:155], 0
    v_mfma_f32_32x32x16_bf16 v[72:87], v[192:195], v[128:131], v[72:87]
    v_mfma_f32_32x32x16_bf16 v[88:103], v[192:195], v[152:155], v[88:103]
    ds_read_b128 v[124:127], v58 offset:160
    ds_read_b128 v[148:151], v59 offset:2400
    ds_read_b128 v[172:175], v59 offset:4960
    s_waitcnt lgkmcnt(12)
    v_mfma_f32_32x32x16_bf16 v[72:87], v[108:111], v[132:135], v[72:87]
    v_mfma_f32_32x32x16_bf16 v[88:103], v[108:111], v[156:159], v[88:103]
    v_mfma_f32_32x32x16_bf16 v[72:87], v[188:191], v[132:135], v[72:87]
    v_mfma_f32_32x32x16_bf16 v[88:103], v[188:191], v[156:159], v[88:103]
    ds_read_b128 v[104:107], v58 offset:192
    ds_read_b128 v[128:131], v59 offset:2352
    ds_read_b128 v[152:155], v59 offset:4912
    s_waitcnt lgkmcnt(12)
    v_mfma_f32_32x32x16_bf16 v[72:87], v[112:115], v[136:139], v[72:87]
    v_mfma_f32_32x32x16_bf16 v[88:103], v[112:115], v[160:163], v[88:103]
    ds_read_b128 v[108:111], v58 offset:224
    ds_read_b128 v[132:135], v59 offset:2320
    ds_read_b128 v[156:159], v59 offset:4880
    s_waitcnt lgkmcnt(12)
    v_mfma_f32_32x32x16_bf16 v[72:87], v[116:119], v[140:143], v[72:87]
    v_mfma_f32_32x32x16_bf16 v[88:103], v[116:119], v[164:167], v[88:103]
    ds_read_b128 v[112:115], v58 offset:256
    ds_read_b128 v[136:139], v59 offset:2272
    ds_read_b128 v[160:163], v59 offset:4832
    s_waitcnt lgkmcnt(12)
    v_mfma_f32_32x32x16_bf16 v[72:87], v[120:123], v[144:147], v[72:87]
    v_mfma_f32_32x32x16_bf16 v[88:103], v[120:123], v[168:171], v[88:103]
    ds_read_b128 v[116:119], v58 offset:288
    ds_read_b128 v[140:143], v59 offset:2240
    ds_read_b128 v[164:167], v59 offset:4800
    s_waitcnt lgkmcnt(12)
    v_mfma_f32_32x32x16_bf16 v[72:87], v[124:127], v[148:151], v[72:87]
    v_mfma_f32_32x32x16_bf16 v[88:103], v[124:127], v[172:175], v[88:103]
    ds_read_b128 v[120:123], v58 offset:320
    ds_read_b128 v[144:147], v59 offset:2192
    ds_read_b128 v[168:171], v59 offset:4752
    s_waitcnt lgkmcnt(12)
    v_mfma_f32_32x32x16_bf16 v[72:87], v[104:107], v[128:131], v[72:87]
    v_mfma_f32_32x32x16_bf16 v[88:103], v[104:107], v[152:155], v[88:103]
    ds_read_b128 v[124:127], v58 offset:352
    ds_read_b128 v[148:151], v59 offset:2160
    ds_read_b128 v[172:175], v59 offset:4720
    s_waitcnt lgkmcnt(12)
    v_mfma_f32_32x32x16_bf16 v[72:87], v[108:111], v[132:135], v[72:87]
    v_mfma_f32_32x32x16_bf16 v[88:103], v[108:111], v[156:159], v[88:103]
    ds_read_b128 v[104:107], v58 offset:384
    ds_read_b128 v[128:131], v59 offset:2112
    ds_read_b128 v[152:155], v59 offset:4672
    s_waitcnt lgkmcnt(12)
    v_mfma_f32_32x32x16_bf16 v[72:87], v[112:115], v[136:139], v[72:87]
    v_mfma_f32_32x32x16_bf16 v[88:103], v[112:115], v[160:163], v[88:103]
    ds_read_b128 v[108:111], v58 offset:416
    ds_read_b128 v[132:135], v59 offset:2080
    ds_read_b128 v[156:159], v59 offset:4640
    s_waitcnt lgkmcnt(12)
    v_mfma_f32_32x32x16_bf16 v[72:87], v[116:119], v[140:143], v[72:87]
    v_mfma_f32_32x32x16_bf16 v[88:103], v[116:119], v[164:167], v[88:103]
    ds_read_b128 v[112:115], v58 offset:448
    ds_read_b128 v[136:139], v59 offset:2032
    ds_read_b128 v[160:163], v59 offset:4592
    s_waitcnt lgkmcnt(12)
    v_mfma_f32_32x32x16_bf16 v[72:87], v[120:123], v[144:147], v[72:87]
    v_mfma_f32_32x32x16_bf16 v[88:103], v[120:123], v[168:171], v[88:103]
    ds_read_b128 v[116:119], v58 offset:480
    ds_read_b128 v[140:143], v59 offset:2000
    ds_read_b128 v[164:167], v59 offset:4560
    s_waitcnt lgkmcnt(12)
    v_mfma_f32_32x32x16_bf16 v[72:87], v[124:127], v[148:151], v[72:87]
    v_mfma_f32_32x32x16_bf16 v[88:103], v[124:127], v[172:175], v[88:103]
    ds_read_b128 v[120:123], v58 offset:512
    ds_read_b128 v[144:147], v59 offset:1952
    ds_read_b128 v[168:171], v59 offset:4512
    s_waitcnt lgkmcnt(12)
    v_mfma_f32_32x32x16_bf16 v[72:87], v[104:107], v[128:131], v[72:87]
    v_mfma_f32_32x32x16_bf16 v[88:103], v[104:107], v[152:155], v[88:103]
    ds_read_b128 v[124:127], v58 offset:544
    ds_read_b128 v[148:151], v59 offset:1920
    ds_read_b128 v[172:175], v59 offset:4480
    s_waitcnt lgkmcnt(12)
    v_mfma_f32_32x32x16_bf16 v[72:87], v[108:111], v[132:135], v[72:87]
    v_mfma_f32_32x32x16_bf16 v[88:103], v[108:111], v[156:159], v[88:103]
    ds_read_b128 v[104:107], v58 offset:576
    ds_read_b128 v[128:131], v59 offset:1872
    ds_read_b128 v[152:155], v59 offset:4432
    s_waitcnt lgkmcnt(12)
    v_mfma_f32_32x32x16_bf16 v[72:87], v[112:115], v[136:139], v[72:87]
    v_mfma_f32_32x32x16_bf16 v[88:103], v[112:115], v[160:163], v[88:103]
    ds_read_b128 v[108:111], v58 offset:608
    ds_read_b128 v[132:135], v59 offset:1840
    ds_read_b128 v[156:159], v59 offset:4400
    s_waitcnt lgkmcnt(12)
    v_mfma_f32_32x32x16_bf16 v[72:87], v[116:119], v[140:143], v[72:87]
    v_mfma_f32_32x32x16_bf16 v[88:103], v[116:119], v[164:167], v[88:103]
    ds_read_b128 v[112:115], v58 offset:640
    ds_read_b128 v[136:139], v59 offset:1792
    ds_read_b128 v[160:163], v59 offset:4352
    s_waitcnt lgkmcnt(12)
    v_mfma_f32_32x32x16_bf16 v[72:87], v[120:123], v[144:147], v[72:87]
    v_mfma_f32_32x32x16_bf16 v[88:103], v[120:123], v[168:171], v[88:103]
    ds_read_b128 v[116:119], v58 offset:672
    ds_read_b128 v[140:143], v59 offset:1760
    ds_read_b128 v[164:167], v59 offset:4320
    s_waitcnt lgkmcnt(12)
    v_mfma_f32_32x32x16_bf16 v[72:87], v[124:127], v[148:151], v[72:87]
    v_mfma_f32_32x32x16_bf16 v[88:103], v[124:127], v[172:175], v[88:103]
    ds_read_b128 v[120:123], v58 offset:704
    ds_read_b128 v[144:147], v59 offset:1712
    ds_read_b128 v[168:171], v59 offset:4272
    s_waitcnt lgkmcnt(12)
    v_mfma_f32_32x32x16_bf16 v[72:87], v[104:107], v[128:131], v[72:87]
    v_mfma_f32_32x32x16_bf16 v[88:103], v[104:107], v[152:155], v[88:103]
    s_waitcnt lgkmcnt(9)
    v_mfma_f32_32x32x16_bf16 v[72:87], v[108:111], v[132:135], v[72:87]
    v_mfma_f32_32x32x16_bf16 v[88:103], v[108:111], v[156:159], v[88:103]
    s_waitcnt lgkmcnt(6)
    v_mfma_f32_32x32x16_bf16 v[72:87], v[112:115], v[136:139], v[72:87]
    v_mfma_f32_32x32x16_bf16 v[88:103], v[112:115], v[160:163], v[88:103]
    s_waitcnt lgkmcnt(3)
    v_mfma_f32_32x32x16_bf16 v[72:87], v[116:119], v[140:143], v[72:87]
    v_mfma_f32_32x32x16_bf16 v[88:103], v[116:119], v[164:167], v[88:103]
    s_waitcnt lgkmcnt(0)
    v_mfma_f32_32x32x16_bf16 v[72:87], v[120:123], v[144:147], v[72:87]
    v_mfma_f32_32x32x16_bf16 v[88:103], v[120:123], v[168:171], v[88:103]
    s_nop 10
    ds_write_b128 v70, v[72:75] offset:0
    ds_write_b128 v70, v[76:79] offset:32
    ds_write_b128 v70, v[80:83] offset:64
    ds_write_b128 v70, v[84:87] offset:96
    ds_write_b128 v70, v[88:91] offset:13824
    ds_write_b128 v70, v[92:95] offset:13856
    ds_write_b128 v70, v[96:99] offset:13888
    ds_write_b128 v70, v[100:103] offset:13920
    s_branch c_pw_end_12
c_pw_13:
    s_cmp_lg_u32 s34, 1
    s_cbranch_scc1 c_pw_14
    ds_read_b128 v[104:107], v58 offset:736
    ds_read_b128 v[128:131], v59 offset:1680
    ds_read_b128 v[152:155], v59 offset:4240
    ds_read_b128 v[108:111], v58 offset:768
    ds_read_b128 v[132:135], v59 offset:1632
    ds_read_b128 v[156:159], v59 offset:4192
    ds_read_b128 v[112:115], v58 offset:800
    ds_read_b128 v[136:139], v59 offset:1600
    ds_read_b128 v[160:163], v59 offset:4160
    ds_read_b128 v[116:119], v58 offset:832
    ds_read_b128 v[140:143], v59 offset:1552
    ds_read_b128 v[164:167], v59 offset:4112
    ds_read_b128 v[120:123], v58 offset:864
    ds_read_b128 v[144:147], v59 offset:1520
    ds_read_b128 v[168:171], v59 offset:4080
    s_waitcnt lgkmcnt(12)
    v_mfma_f32_32x32x16_bf16 v[72:87], v[104:107], v[128:131], 0
    v_mfma_f32_32x32x16_bf16 v[88:103], v[104:107], v[152:155], 0
    ds_read_b128 v[124:127], v58 offset:896
    ds_read_b128 v[148:151], v59 offset:1472
    ds_read_b128 v[172:175], v59 offset:4032
    s_waitcnt lgkmcnt(12)
    v_mfma_f32_32x32x16_bf16 v[72:87], v[108:111], v[132:135], v[72:87]
    v_mfma_f32_32x32x16_bf16 v[88:103], v[108:111], v[156:159], v[88:103]
    ds_read_b128 v[104:107], v58 offset:928
    ds_read_b128 v[128:131], v59 offset:1440
    ds_read_b128 v[152:155], v59 offset:4000
    s_waitcnt lgkmcnt(12)
    v_mfma_f32_32x32x16_bf16 v[72:87], v[112:115], v[136:139], v[72:87]
    v_mfma_f32_32x32x16_bf16 v[88:103], v[112:115], v[160:163], v[88:103]
    ds_read_b128 v[108:111], v58 offset:960
    ds_read_b128 v[132:135], v59 offset:1392
    ds_read_b128 v[156:159], v59 offset:3952
    s_waitcnt lgkmcnt(12)
    v_mfma_f32_32x32x16_bf16 v[72:87], v[116:119], v[140:143], v[72:87]
    v_mfma_f32_32x32x16_bf16 v[88:103], v[116:119], v[164:167], v[88:103]
    ds_read_b128 v[112:115], v58 offset:992
    ds_read_b128 v[136:139], v59 offset:1360
    ds_read_b128 v[160:163], v59 offset:3920
    s_waitcnt lgkmcnt(12)
    v_mfma_f32_32x32x16_bf16 v[72:87], v[120:123], v[144:147], v[72:87]
    v_mfma_f32_32x32x16_bf16 v[88:103], v[120:123], v[168:171], v[88:103]
    ds_read_b128 v[116:119], v58 offset:1024
    ds_read_b128 v[140:143], v59 offset:1312
    ds_read_b128 v[164:167], v59 offset:3872
    s_waitcnt lgkmcnt(12)
    v_mfma_f32_32x32x16_bf16 v[72:87], v[124:127], v[148:151], v[72:87]
    v_mfma_f32_32x32x16_bf16 v[88:103], v[124:127], v[172:175], v[88:103]
    ds_read_b128 v[120:123], v58 offset:1056
    ds_read_b128 v[144:147], v59 offset:1280
    ds_read_b128 v[168:171], v59 offset:3840
    s_waitcnt lgkmcnt(12)
    v_mfma_f32_32x32x16_bf16 v[72:87], v[104:107], v[128:131], v[72:87]
    v_mfma_f32_32x32x16_bf16 v[88:103], v[104:107], v[152:155], v[88:103]
    ds_read_b128 v[124:127], v58 offset:1088
    ds_read_b128 v[148:151], v59 offset:1232
    ds_read_b128 v[172:175], v59 offset:3792
    s_waitcnt lgkmcnt(12)
    v_mfma_f32_32x32x16_bf16 v[72:87], v[108:111], v[132:135], v[72:87]
    v_mfma_f32_32x32x16_bf16 v[88:103], v[108:111], v[156:159], v[88:103]
    ds_read_b128 v[104:107], v58 offset:1120
    ds_read_b128 v[128:131], v59 offset:1200
    ds_read_b128 v[152:155], v59 offset:3760
    s_waitcnt lgkmcnt(12)
    v_mfma_f32_32x32x16_bf16 v[72:87], v[112:115], v[136:139], v[72:87]
    v_mfma_f32_32x32x16_bf16 v[88:103], v[112:115], v[160:163], v[88:103]
    ds_read_b128 v[108:111], v58 offset:1152
    ds_read_b128 v[132:135], v59 offset:1152
    ds_read_b128 v[156:159], v59 offset:3712
    s_waitcnt lgkmcnt(12)
    v_mfma_f32_32x32x16_bf16 v[72:87], v[116:119], v[140:143], v[72:87]
    v_mfma_f32_32x32x16_bf16 v[88:103], v[116:119], v[164:167], v[88:103]
    ds_read_b128 v[112:115], v58 offset:1184
    ds_read_b128 v[136:139], v59 offset:1120
    ds_read_b128 v[160:163], v59 offset:3680
    s_waitcnt lgkmcnt(12)
    v_mfma_f32_32x32x16_bf16 v[72:87], v[120:123], v[144:147], v[72:87]
    v_mfma_f32_32x32x16_bf16 v[88:103], v[120:123], v[168:171], v[88:103]
    ds_read_b128 v[116:119], v58 offset:1216
    ds_read_b128 v[140:143], v59 offset:1072
    ds_read_b128 v[164:167], v59 offset:3632
    s_waitcnt lgkmcnt(12)
    v_mfma_f32_32x32x16_bf16 v[72:87], v[124:127], v[148:151], v[72:87]
    v_mfma_f32_32x32x16_bf16 v[88:103], v[124:127], v[172:175], v[88:103]
    ds_read_b128 v[120:123], v58 offset:1248
    ds_read_b128 v[144:147], v59 offset:1040
    ds_read_b128 v[168:171], v59 offset:3600
    s_waitcnt lgkmcnt(12)
    v_mfma_f32_32x32x16_bf16 v[72:87], v[104:107], v[128:131], v[72:87]
    v_mfma_f32_32x32x16_bf16 v[88:103], v[104:107], v[152:155], v[88:103]
    ds_read_b128 v[124:127], v58 offset:1280
    ds_read_b128 v[148:151], v59 offset:992
    ds_read_b128 v[172:175], v59 offset:3552
    s_waitcnt lgkmcnt(12)
    v_mfma_f32_32x32x16_bf16 v[72:87], v[108:111], v[132:135], v[72:87]
    v_mfma_f32_32x32x16_bf16 v[88:103], v[108:111], v[156:159], v[88:103]
    ds_read_b128 v[104:107], v58 offset:1312
    ds_read_b128 v[128:131], v59 offset:960
    ds_read_b128 v[152:155], v59 offset:3520
    s_waitcnt lgkmcnt(12)
    v_mfma_f32_32x32x16_bf16 v[72:87], v[112:115], v[136:139], v[72:87]
    v_mfma_f32_32x32x16_bf16 v[88:103], v[112:115], v[160:163], v[88:103]
    ds_read_b128 v[108:111], v58 offset:1344
    ds_read_b128 v[132:135], v59 offset:912
    ds_read_b128 v[156:159], v59 offset:3472
    s_waitcnt lgkmcnt(12)
    v_mfma_f32_32x32x16_bf16 v[72:87], v[116:119], v[140:143], v[72:87]
    v_mfma_f32_32x32x16_bf16 v[88:103], v[116:119], v[164:167], v[88:103]
    ds_read_b128 v[112:115], v58 offset:1376
    ds_read_b128 v[136:139], v59 offset:880
    ds_read_b128 v[160:163], v59 offset:3440
    s_waitcnt lgkmcnt(12)
    v_mfma_f32_32x32x16_bf16 v[72:87], v[120:123], v[144:147], v[72:87]
    v_mfma_f32_32x32x16_bf16 v[88:103], v[120:123], v[168:171], v[88:103]
    ds_read_b128 v[116:119], v58 offset:1408
    ds_read_b128 v[140:143], v59 offset:832
    ds_read_b128 v[164:167], v59 offset:3392
    s_waitcnt lgkmcnt(12)
    v_mfma_f32_32x32x16_bf16 v[72:87], v[124:127], v[148:151], v[72:87]
    v_mfma_f32_32x32x16_bf16 v[88:103], v[124:127], v[172:175], v[88:103]
    ds_read_b128 v[120:123], v58 offset:1440
    ds_read_b128 v[144:147], v59 offset:800
    ds_read_b128 v[168:171], v59 offset:3360
    s_waitcnt lgkmcnt(12)
    v_mfma_f32_32x32x16_bf16 v[72:87], v[104:107], v[128:131], v[72:87]
    v_mfma_f32_32x32x16_bf16 v[88:103], v[104:107], v[152:155], v[88:103]
    ds_read_b128 v[124:127], v58 offset:1472
    ds_read_b128 v[148:151], v59 offset:752
    ds_read_b128 v[172:175], v59 offset:3312
    s_waitcnt lgkmcnt(12)
    v_mfma_f32_32x32x16_bf16 v[72:87], v[108:111], v[132:135], v[72:87]
    v_mfma_f32_32x32x16_bf16 v[88:103], v[108:111], v[156:159], v[88:103]
    s_waitcnt lgkmcnt(9)
    v_mfma_f32_32x32x16_bf16 v[72:87], v[112:115], v[136:139], v[72:87]
    v_mfma_f32_32x32x16_bf16 v[88:103], v[112:115], v[160:163], v[88:103]
    s_waitcnt lgkmcnt(6)
    v_mfma_f32_32x32x16_bf16 v[72:87], v[116:119], v[140:143], v[72:87]
    v_mfma_f32_32x32x16_bf16 v[88:103], v[116:119], v[164:167], v[88:103]
    s_waitcnt lgkmcnt(3)
    v_mfma_f32_32x32x16_bf16 v[72:87], v[120:123], v[144:147], v[72:87]
    v_mfma_f32_32x32x16_bf16 v[88:103], v[120:123], v[168:171], v[88:103]
    s_waitcnt lgkmcnt(0)
    v_mfma_f32_32x32x16_bf16 v[72:87], v[124:127], v[148:151], v[72:87]
    v_mfma_f32_32x32x16_bf16 v[88:103], v[124:127], v[172:175], v[88:103]
    s_nop 10
    ds_write_b128 v70, v[72:75] offset:4608
    ds_write_b128 v70, v[76:79] offset:4640
    ds_write_b128 v70, v[80:83] offset:4672
    ds_write_b128 v70, v[84:87] offset:4704
    ds_write_b128 v70, v[88:91] offset:18432
    ds_write_b128 v70, v[92:95] offset:18464
    ds_write_b128 v70, v[96:99] offset:18496
    ds_write_b128 v70, v[100:103] offset:18528
    s_branch c_pw_end_12
c_pw_14:
    s_cmp_lg_u32 s34, 2
    s_cbranch_scc1 c_pw_15
    ds_read_b128 v[104:107], v58 offset:1504
    ds_read_b128 v[128:131], v59 offset:720
    ds_read_b128 v[152:155], v59 offset:3280
    ds_read_b128 v[108:111], v58 offset:1536
    ds_read_b128 v[132:135], v59 offset:672
    ds_read_b128 v[156:159], v59 offset:3232
    ds_read_b128 v[112:115], v58 offset:1568
    ds_read_b128 v[136:139], v59 offset:640
    ds_read_b128 v[160:163], v59 offset:3200
    ds_read_b128 v[116:119], v58 offset:1600
    ds_read_b128 v[140:143], v59 offset:592
    ds_read_b128 v[164:167], v59 offset:3152
    ds_read_b128 v[120:123], v58 offset:1632
    ds_read_b128 v[144:147], v59 offset:560
    ds_read_b128 v[168:171], v59 offset:3120
    s_waitcnt lgkmcnt(12)
    v_mfma_f32_32x32x16_bf16 v[72:87], v[104:107], v[128:131], 0
    v_mfma_f32_32x32x16_bf16 v[88:103], v[104:107], v[152:155], 0
    ds_read_b128 v[124:127], v58 offset:1664
    ds_read_b128 v[148:151], v59 offset:512
    ds_read_b128 v[172:175], v59 offset:3072
    s_waitcnt lgkmcnt(12)
    v_mfma_f32_32x32x16_bf16 v[72:87], v[108:111], v[132:135], v[72:87]
    v_mfma_f32_32x32x16_bf16 v[88:103], v[108:111], v[156:159], v[88:103]
    ds_read_b128 v[104:107], v58 offset:1696
    ds_read_b128 v[128:131], v59 offset:480
    ds_read_b128 v[152:155], v59 offset:3040
    s_waitcnt lgkmcnt(12)
    v_mfma_f32_32x32x16_bf16 v[72:87], v[112:115], v[136:139], v[72:87]
    v_mfma_f32_32x32x16_bf16 v[88:103], v[112:115], v[160:163], v[88:103]
    ds_read_b128 v[108:111], v58 offset:1728
    ds_read_b128 v[132:135], v59 offset:432
    ds_read_b128 v[156:159], v59 offset:2992
    s_waitcnt lgkmcnt(12)
    v_mfma_f32_32x32x16_bf16 v[72:87], v[116:119], v[140:143], v[72:87]
    v_mfma_f32_32x32x16_bf16 v[88:103], v[116:119], v[164:167], v[88:103]
    ds_read_b128 v[112:115], v58 offset:1760
    ds_read_b128 v[136:139], v59 offset:400
    ds_read_b128 v[160:163], v59 offset:2960
    s_waitcnt lgkmcnt(12)
    v_mfma_f32_32x32x16_bf16 v[72:87], v[120:123], v[144:147], v[72:87]
    v_mfma_f32_32x32x16_bf16 v[88:103], v[120:123], v[168:171], v[88:103]
    ds_read_b128 v[116:119], v58 offset:1792
    ds_read_b128 v[140:143], v59 offset:352
    ds_read_b128 v[164:167], v59 offset:2912
    s_waitcnt lgkmcnt(12)
    v_mfma_f32_32x32x16_bf16 v[72:87], v[124:127], v[148:151], v[72:87]
    v_mfma_f32_32x32x16_bf16 v[88:103], v[124:127], v[172:175], v[88:103]
    ds_read_b128 v[120:123], v58 offset:1824
    ds_read_b128 v[144:147], v59 offset:320
    ds_read_b128 v[168:171], v59 offset:2880
    s_waitcnt lgkmcnt(12)
    v_mfma_f32_32x32x16_bf16 v[72:87], v[104:107], v[128:131], v[72:87]
    v_mfma_f32_32x32x16_bf16 v[88:103], v[104:107], v[152:155], v[88:103]
    ds_read_b128 v[124:127], v58 offset:1856
    ds_read_b128 v[148:151], v59 offset:272
    ds_read_b128 v[172:175], v59 offset:2832
    s_waitcnt lgkmcnt(12)
    v_mfma_f32_32x32x16_bf16 v[72:87], v[108:111], v[132:135], v[72:87]
    v_mfma_f32_32x32x16_bf16 v[88:103], v[108:111], v[156:159], v[88:103]
    ds_read_b128 v[104:107], v58 offset:1888
    ds_read_b128 v[128:131], v59 offset:240
    ds_read_b128 v[152:155], v59 offset:2800
    s_waitcnt lgkmcnt(12)
    v_mfma_f32_32x32x16_bf16 v[72:87], v[112:115], v[136:139], v[72:87]
    v_mfma_f32_32x32x16_bf16 v[88:103], v[112:115], v[160:163], v[88:103]
    ds_read_b128 v[108:111], v58 offset:1920
    ds_read_b128 v[132:135], v59 offset:192
    ds_read_b128 v[156:159], v59 offset:2752
    s_waitcnt lgkmcnt(12)
    v_mfma_f32_32x32x16_bf16 v[72:87], v[116:119], v[140:143], v[72:87]
    v_mfma_f32_32x32x16_bf16 v[88:103], v[116:119], v[164:167], v[88:103]
    ds_read_b128 v[112:115], v58 offset:1952
    ds_read_b128 v[136:139], v59 offset:160
    ds_read_b128 v[160:163], v59 offset:2720
    s_waitcnt lgkmcnt(12)
    v_mfma_f32_32x32x16_bf16 v[72:87], v[120:123], v[144:147], v[72:87]
    v_mfma_f32_32x32x16_bf16 v[88:103], v[120:123], v[168:171], v[88:103]
    ds_read_b128 v[116:119], v58 offset:1984
    ds_read_b128 v[140:143], v59 offset:112
    ds_read_b128 v[164:167], v59 offset:2672
    s_waitcnt lgkmcnt(12)
    v_mfma_f32_32x32x16_bf16 v[72:87], v[124:127], v[148:151], v[72:87]
    v_mfma_f32_32x32x16_bf16 v[88:103], v[124:127], v[172:175], v[88:103]
    ds_read_b128 v[120:123], v58 offset:2016
    ds_read_b128 v[144:147], v59 offset:80
    ds_read_b128 v[168:171], v59 offset:2640
    s_waitcnt lgkmcnt(12)
    v_mfma_f32_32x32x16_bf16 v[72:87], v[104:107], v[128:131], v[72:87]
    v_mfma_f32_32x32x16_bf16 v[88:103], v[104:107], v[152:155], v[88:103]
    ds_read_b128 v[124:127], v58 offset:2048
    ds_read_b128 v[172:175], v59 offset:2592
    s_waitcnt lgkmcnt(11)
    v_mfma_f32_32x32x16_bf16 v[72:87], v[108:111], v[132:135], v[72:87]
    v_mfma_f32_32x32x16_bf16 v[88:103], v[108:111], v[156:159], v[88:103]
    ds_read_b128 v[104:107], v58 offset:2080
    ds_read_b128 v[152:155], v59 offset:2560
    s_waitcnt lgkmcnt(10)
    v_mfma_f32_32x32x16_bf16 v[72:87], v[112:115], v[136:139], v[72:87]
    v_mfma_f32_32x32x16_bf16 v[88:103], v[112:115], v[160:163], v[88:103]
    ds_read_b128 v[108:111], v58 offset:2112
    ds_read_b128 v[156:159], v59 offset:2512
    s_waitcnt lgkmcnt(9)
    v_mfma_f32_32x32x16_bf16 v[72:87], v[116:119], v[140:143], v[72:87]
    v_mfma_f32_32x32x16_bf16 v[88:103], v[116:119], v[164:167], v[88:103]
    ds_read_b128 v[112:115], v58 offset:2144
    ds_read_b128 v[160:163], v59 offset:2480
    s_waitcnt lgkmcnt(8)
    v_mfma_f32_32x32x16_bf16 v[72:87], v[120:123], v[144:147], v[72:87]
    v_mfma_f32_32x32x16_bf16 v[88:103], v[120:123], v[168:171], v[88:103]
    ds_read_b128 v[116:119], v58 offset:2176
    ds_read_b128 v[164:167], v59 offset:2432
    s_waitcnt lgkmcnt(8)
    v_mfma_f32_32x32x16_bf16 v[88:103], v[124:127], v[172:175], v[88:103]
    ds_read_b128 v[120:123], v58 offset:2208
    ds_read_b128 v[168:171], v59 offset:2400
    s_waitcnt lgkmcnt(8)
    v_mfma_f32_32x32x16_bf16 v[88:103], v[104:107], v[152:155], v[88:103]
    ds_read_b128 v[124:127], v58 offset:2240
    ds_read_b128 v[172:175], v59 offset:2352
    s_waitcnt lgkmcnt(8)
    v_mfma_f32_32x32x16_bf16 v[88:103], v[108:111], v[156:159], v[88:103]
    ds_read_b128 v[104:107], v58 offset:2272
    ds_read_b128 v[152:155], v59 offset:2320
    s_waitcnt lgkmcnt(8)
    v_mfma_f32_32x32x16_bf16 v[88:103], v[112:115], v[160:163], v[88:103]
    ds_read_b128 v[108:111], v58 offset:2304
    ds_read_b128 v[156:159], v59 offset:2272
    s_waitcnt lgkmcnt(8)
    v_mfma_f32_32x32x16_bf16 v[88:103], v[116:119], v[164:167], v[88:103]
    ds_read_b128 v[112:115], v58 offset:2336
    ds_read_b128 v[160:163], v59 offset:2240
    s_waitcnt lgkmcnt(8)
    v_mfma_f32_32x32x16_bf16 v[88:103], v[120:123], v[168:171], v[88:103]
    ds_read_b128 v[116:119], v58 offset:2368
    ds_read_b128 v[164:167], v59 offset:2192
    s_waitcnt lgkmcnt(8)
    v_mfma_f32_32x32x16_bf16 v[88:103], v[124:127], v[172:175], v[88:103]
    ds_read_b128 v[120:123], v58 offset:2400
    ds_read_b128 v[168:171], v59 offset:2160
    s_waitcnt lgkmcnt(8)
    v_mfma_f32_32x32x16_bf16 v[88:103], v[104:107], v[152:155], v[88:103]
    ds_read_b128 v[124:127], v58 offset:2432
    ds_read_b128 v[172:175], v59 offset:2112
    s_waitcnt lgkmcnt(8)
    v_mfma_f32_32x32x16_bf16 v[88:103], v[108:111], v[156:159], v[88:103]
    ds_read_b128 v[104:107], v58 offset:2464
    ds_read_b128 v[152:155], v59 offset:2080
    s_waitcnt lgkmcnt(8)
    v_mfma_f32_32x32x16_bf16 v[88:103], v[112:115], v[160:163], v[88:103]
    ds_read_b128 v[108:111], v58 offset:2496
    ds_read_b128 v[156:159], v59 offset:2032
    s_waitcnt lgkmcnt(8)
    v_mfma_f32_32x32x16_bf16 v[88:103], v[116:119], v[164:167], v[88:103]
    s_waitcnt lgkmcnt(6)
    v_mfma_f32_32x32x16_bf16 v[88:103], v[120:123], v[168:171], v[88:103]
    s_waitcnt lgkmcnt(4)
    v_mfma_f32_32x32x16_bf16 v[88:103], v[124:127], v[172:175], v[88:103]
    s_waitcnt lgkmcnt(2)
    v_mfma_f32_32x32x16_bf16 v[88:103], v[104:107], v[152:155], v[88:103]
    s_waitcnt lgkmcnt(0)
    v_mfma_f32_32x32x16_bf16 v[88:103], v[108:111], v[156:159], v[88:103]
    ds_write_b128 v70, v[72:75] offset:9216
    ds_write_b128 v70, v[76:79] offset:9248
    ds_write_b128 v70, v[80:83] offset:9280
    ds_write_b128 v70, v[84:87] offset:9312
    s_nop 7
    ds_write_b128 v70, v[88:91] offset:23040
    ds_write_b128 v70, v[92:95] offset:23072
    ds_write_b128 v70, v[96:99] offset:23104
    ds_write_b128 v70, v[100:103] offset:23136
    s_branch c_pw_end_12
c_pw_15:
    ds_read_b128 v[104:107], v58 offset:2528
    ds_read_b128 v[152:155], v59 offset:2000
    ds_read_b128 v[108:111], v58 offset:2560
    ds_read_b128 v[156:159], v59 offset:1952
    ds_read_b128 v[112:115], v58 offset:2592
    ds_read_b128 v[160:163], v59 offset:1920
    ds_read_b128 v[116:119], v58 offset:2624
    ds_read_b128 v[164:167], v59 offset:1872
    ds_read_b128 v[120:123], v58 offset:2656
    ds_read_b128 v[168:171], v59 offset:1840
    s_waitcnt lgkmcnt(8)
    v_mfma_f32_32x32x16_bf16 v[88:103], v[104:107], v[152:155], 0
    ds_read_b128 v[124:127], v58 offset:2688
    ds_read_b128 v[172:175], v59 offset:1792
    s_waitcnt lgkmcnt(8)
    v_mfma_f32_32x32x16_bf16 v[88:103], v[108:111], v[156:159], v[88:103]
    ds_read_b128 v[104:107], v58 offset:2720
    ds_read_b128 v[152:155], v59 offset:1760
    s_waitcnt lgkmcnt(8)
    v_mfma_f32_32x32x16_bf16 v[88:103], v[112:115], v[160:163], v[88:103]
    ds_read_b128 v[108:111], v58 offset:2752
    ds_read_b128 v[156:159], v59 offset:1712
    s_waitcnt lgkmcnt(8)
    v_mfma_f32_32x32x16_bf16 v[88:103], v[116:119], v[164:167], v[88:103]
    ds_read_b128 v[112:115], v58 offset:2784
    ds_read_b128 v[160:163], v59 offset:1680
    s_waitcnt lgkmcnt(8)
    v_mfma_f32_32x32x16_bf16 v[88:103], v[120:123], v[168:171], v[88:103]
    ds_read_b128 v[116:119], v58 offset:2816
    ds_read_b128 v[164:167], v59 offset:1632
    s_waitcnt lgkmcnt(8)
    v_mfma_f32_32x32x16_bf16 v[88:103], v[124:127], v[172:175], v[88:103]
    ds_read_b128 v[120:123], v58 offset:2848
    ds_read_b128 v[168:171], v59 offset:1600
    s_waitcnt lgkmcnt(8)
    v_mfma_f32_32x32x16_bf16 v[88:103], v[104:107], v[152:155], v[88:103]
    ds_read_b128 v[124:127], v58 offset:2880
    ds_read_b128 v[172:175], v59 offset:1552
    s_waitcnt lgkmcnt(8)
    v_mfma_f32_32x32x16_bf16 v[88:103], v[108:111], v[156:159], v[88:103]
    ds_read_b128 v[104:107], v58 offset:2912
    ds_read_b128 v[152:155], v59 offset:1520
    s_waitcnt lgkmcnt(8)
    v_mfma_f32_32x32x16_bf16 v[88:103], v[112:115], v[160:163], v[88:103]
    ds_read_b128 v[108:111], v58 offset:2944
    ds_read_b128 v[156:159], v59 offset:1472
    s_waitcnt lgkmcnt(8)
    v_mfma_f32_32x32x16_bf16 v[88:103], v[116:119], v[164:167], v[88:103]
    ds_read_b128 v[112:115], v58 offset:2976
    ds_read_b128 v[160:163], v59 offset:1440
    s_waitcnt lgkmcnt(8)
    v_mfma_f32_32x32x16_bf16 v[88:103], v[120:123], v[168:171], v[88:103]
    ds_read_b128 v[116:119], v58 offset:3008
    ds_read_b128 v[164:167], v59 offset:1392
    s_waitcnt lgkmcnt(8)
    v_mfma_f32_32x32x16_bf16 v[88:103], v[124:127], v[172:175], v[88:103]
    ds_read_b128 v[120:123], v58 offset:3040
    ds_read_b128 v[168:171], v59 offset:1360
    s_waitcnt lgkmcnt(8)
    v_mfma_f32_32x32x16_bf16 v[88:103], v[104:107], v[152:155], v[88:103]
    ds_read_b128 v[124:127], v58 offset:3072
    ds_read_b128 v[172:175], v59 offset:1312
    s_waitcnt lgkmcnt(8)
    v_mfma_f32_32x32x16_bf16 v[88:103], v[108:111], v[156:159], v[88:103]
    ds_read_b128 v[104:107], v58 offset:3104
    ds_read_b128 v[152:155], v59 offset:1280
    s_waitcnt lgkmcnt(8)
    v_mfma_f32_32x32x16_bf16 v[88:103], v[112:115], v[160:163], v[88:103]
    ds_read_b128 v[108:111], v58 offset:3136
    ds_read_b128 v[156:159], v59 offset:1232
    s_waitcnt lgkmcnt(8)
    v_mfma_f32_32x32x16_bf16 v[88:103], v[116:119], v[164:167], v[88:103]
    ds_read_b128 v[112:115], v58 offset:3168
    ds_read_b128 v[160:163], v59 offset:1200
    s_waitcnt lgkmcnt(8)
    v_mfma_f32_32x32x16_bf16 v[88:103], v[120:123], v[168:171], v[88:103]
    ds_read_b128 v[116:119], v58 offset:3200
    ds_read_b128 v[164:167], v59 offset:1152
    s_waitcnt lgkmcnt(8)
    v_mfma_f32_32x32x16_bf16 v[88:103], v[124:127], v[172:175], v[88:103]
    ds_read_b128 v[120:123], v58 offset:3232
    ds_read_b128 v[168:171], v59 offset:1120
    s_waitcnt lgkmcnt(8)
    v_mfma_f32_32x32x16_bf16 v[88:103], v[104:107], v[152:155], v[88:103]
    ds_read_b128 v[124:127], v58 offset:3264
    ds_read_b128 v[172:175], v59 offset:1072
    s_waitcnt lgkmcnt(8)
    v_mfma_f32_32x32x16_bf16 v[88:103], v[108:111], v[156:159], v[88:103]
    ds_read_b128 v[104:107], v58 offset:3296
    ds_read_b128 v[152:155], v59 offset:1040
    s_waitcnt lgkmcnt(8)
    v_mfma_f32_32x32x16_bf16 v[88:103], v[112:115], v[160:163], v[88:103]
    ds_read_b128 v[108:111], v58 offset:3328
    ds_read_b128 v[156:159], v59 offset:992
    s_waitcnt lgkmcnt(8)
    v_mfma_f32_32x32x16_bf16 v[88:103], v[116:119], v[164:167], v[88:103]
    ds_read_b128 v[112:115], v58 offset:3360
    ds_read_b128 v[160:163], v59 offset:960
    s_waitcnt lgkmcnt(8)
    v_mfma_f32_32x32x16_bf16 v[88:103], v[120:123], v[168:171], v[88:103]
    ds_read_b128 v[116:119], v58 offset:3392
    ds_read_b128 v[164:167], v59 offset:912
    s_waitcnt lgkmcnt(8)
    v_mfma_f32_32x32x16_bf16 v[88:103], v[124:127], v[172:175], v[88:103]
    ds_read_b128 v[120:123], v58 offset:3424
    ds_read_b128 v[168:171], v59 offset:880
    s_waitcnt lgkmcnt(8)
    v_mfma_f32_32x32x16_bf16 v[88:103], v[104:107], v[152:155], v[88:103]
    ds_read_b128 v[124:127], v58 offset:3456
    ds_read_b128 v[172:175], v59 offset:832
    s_waitcnt lgkmcnt(8)
    v_mfma_f32_32x32x16_bf16 v[88:103], v[108:111], v[156:159], v[88:103]
    ds_read_b128 v[104:107], v58 offset:3488
    ds_read_b128 v[152:155], v59 offset:800
    s_waitcnt lgkmcnt(8)
    v_mfma_f32_32x32x16_bf16 v[88:103], v[112:115], v[160:163], v[88:103]
    ds_read_b128 v[108:111], v58 offset:3520
    ds_read_b128 v[156:159], v59 offset:752
    s_waitcnt lgkmcnt(8)
    v_mfma_f32_32x32x16_bf16 v[88:103], v[116:119], v[164:167], v[88:103]
    ds_read_b128 v[112:115], v58 offset:3552
    ds_read_b128 v[160:163], v59 offset:720
    s_waitcnt lgkmcnt(8)
    v_mfma_f32_32x32x16_bf16 v[88:103], v[120:123], v[168:171], v[88:103]
    ds_read_b128 v[116:119], v58 offset:3584
    ds_read_b128 v[164:167], v59 offset:672
    s_waitcnt lgkmcnt(8)
    v_mfma_f32_32x32x16_bf16 v[88:103], v[124:127], v[172:175], v[88:103]
    ds_read_b128 v[120:123], v58 offset:3616
    ds_read_b128 v[168:171], v59 offset:640
    s_waitcnt lgkmcnt(8)
    v_mfma_f32_32x32x16_bf16 v[88:103], v[104:107], v[152:155], v[88:103]
    ds_read_b128 v[124:127], v58 offset:3648
    ds_read_b128 v[172:175], v59 offset:592
    s_waitcnt lgkmcnt(8)
    v_mfma_f32_32x32x16_bf16 v[88:103], v[108:111], v[156:159], v[88:103]
    ds_read_b128 v[104:107], v58 offset:3680
    ds_read_b128 v[152:155], v59 offset:560
    s_waitcnt lgkmcnt(8)
    v_mfma_f32_32x32x16_bf16 v[88:103], v[112:115], v[160:163], v[88:103]
    ds_read_b128 v[108:111], v58 offset:3712
    ds_read_b128 v[156:159], v59 offset:512
    s_waitcnt lgkmcnt(8)
    v_mfma_f32_32x32x16_bf16 v[88:103], v[116:119], v[164:167], v[88:103]
    ds_read_b128 v[112:115], v58 offset:3744
    ds_read_b128 v[160:163], v59 offset:480
    s_waitcnt lgkmcnt(8)
    v_mfma_f32_32x32x16_bf16 v[88:103], v[120:123], v[168:171], v[88:103]
    ds_read_b128 v[116:119], v58 offset:3776
    ds_read_b128 v[164:167], v59 offset:432
    s_waitcnt lgkmcnt(8)
    v_mfma_f32_32x32x16_bf16 v[88:103], v[124:127], v[172:175], v[88:103]
    ds_read_b128 v[120:123], v58 offset:3808
    ds_read_b128 v[168:171], v59 offset:400
    s_waitcnt lgkmcnt(8)
    v_mfma_f32_32x32x16_bf16 v[88:103], v[104:107], v[152:155], v[88:103]
    ds_read_b128 v[124:127], v58 offset:3840
    ds_read_b128 v[172:175], v59 offset:352
    s_waitcnt lgkmcnt(8)
    v_mfma_f32_32x32x16_bf16 v[88:103], v[108:111], v[156:159], v[88:103]
    ds_read_b128 v[104:107], v58 offset:3872
    ds_read_b128 v[152:155], v59 offset:320
    s_waitcnt lgkmcnt(8)
    v_mfma_f32_32x32x16_bf16 v[88:103], v[112:115], v[160:163], v[88:103]
    ds_read_b128 v[108:111], v58 offset:3904
    ds_read_b128 v[156:159], v59 offset:272
    s_waitcnt lgkmcnt(8)
    v_mfma_f32_32x32x16_bf16 v[88:103], v[116:119], v[164:167], v[88:103]
    ds_read_b128 v[112:115], v58 offset:3936
    ds_read_b128 v[160:163], v59 offset:240
    s_waitcnt lgkmcnt(8)
    v_mfma_f32_32x32x16_bf16 v[88:103], v[120:123], v[168:171], v[88:103]
    ds_read_b128 v[116:119], v58 offset:3968
    ds_read_b128 v[164:167], v59 offset:192
    s_waitcnt lgkmcnt(8)
    v_mfma_f32_32x32x16_bf16 v[88:103], v[124:127], v[172:175], v[88:103]
    ds_read_b128 v[120:123], v58 offset:4000
    ds_read_b128 v[168:171], v59 offset:160
    s_waitcnt lgkmcnt(8)
    v_mfma_f32_32x32x16_bf16 v[88:103], v[104:107], v[152:155], v[88:103]
    ds_read_b128 v[124:127], v58 offset:4032
    ds_read_b128 v[172:175], v59 offset:112
    s_waitcnt lgkmcnt(8)
    v_mfma_f32_32x32x16_bf16 v[88:103], v[108:111], v[156:159], v[88:103]
    ds_read_b128 v[104:107], v58 offset:4064
    ds_read_b128 v[152:155], v59 offset:80
    s_waitcnt lgkmcnt(8)
    v_mfma_f32_32x32x16_bf16 v[88:103], v[112:115], v[160:163], v[88:103]
    s_waitcnt lgkmcnt(6)
    v_mfma_f32_32x32x16_bf16 v[88:103], v[116:119], v[164:167], v[88:103]
    s_waitcnt lgkmcnt(4)
    v_mfma_f32_32x32x16_bf16 v[88:103], v[120:123], v[168:171], v[88:103]
    s_waitcnt lgkmcnt(2)
    v_mfma_f32_32x32x16_bf16 v[88:103], v[124:127], v[172:175], v[88:103]
    s_waitcnt lgkmcnt(0)
    v_mfma_f32_32x32x16_bf16 v[88:103], v[104:107], v[152:155], v[88:103]
    s_nop 11
    ds_write_b128 v70, v[88:91] offset:27648
    ds_write_b128 v70, v[92:95] offset:27680
    ds_write_b128 v70, v[96:99] offset:27712
    ds_write_b128 v70, v[100:103] offset:27744
c_pw_end_12:
    s_waitcnt lgkmcnt(0)
    s_barrier
    s_cmp_ge_u32 s34, 2
    s_cbranch_scc1 c_finH_17
    ds_read_b128 v[104:107], v71 offset:0
    ds_read_b128 v[108:111], v71 offset:16
    ds_read_b128 v[112:115], v71 offset:4608
    ds_read_b128 v[116:119], v71 offset:4624
    ds_read_b128 v[120:123], v71 offset:9216
    ds_read_b128 v[124:127], v71 offset:9232
    s_waitcnt lgkmcnt(0)
    v_pk_add_f32 v[104:105], v[104:105], v[112:113]
    v_pk_add_f32 v[106:107], v[106:107], v[114:115]
    v_pk_add_f32 v[108:109], v[108:109], v[116:117]
    v_pk_add_f32 v[110:111], v[110:111], v[118:119]
    v_pk_add_f32 v[104:105], v[104:105], v[120:121]
    v_pk_add_f32 v[106:107], v[106:107], v[122:123]
    v_pk_add_f32 v[108:109], v[108:109], v[124:125]
    v_pk_add_f32 v[110:111], v[110:111], v[126:127]
    v_cvt_pk_bf16_f32 v184, v104, v105
    v_cvt_pk_bf16_f32 v185, v106, v107
    v_cvt_pk_bf16_f32 v186, v108, v109
    v_cvt_pk_bf16_f32 v187, v110, v111
    s_lshl_b32 s40, s56, 12
    s_add_u32 s40, s40, 8912896
    v_and_b32 v3, 127, v0
    v_lshlrev_b32 v3, 4, v3
    buffer_store_dwordx4 v[184:187], v3, s[8:11], s40 offen
    s_nop 1
    s_branch c_fin_end_18
c_finH_17:
    ds_read_b128 v[104:107], v71 offset:13824
    ds_read_b128 v[108:111], v71 offset:13840
    ds_read_b128 v[112:115], v71 offset:18432
    ds_read_b128 v[116:119], v71 offset:18448
    ds_read_b128 v[120:123], v71 offset:23040
    ds_read_b128 v[124:127], v71 offset:23056
    ds_read_b128 v[128:131], v71 offset:27648
    ds_read_b128 v[132:135], v71 offset:27664
    s_waitcnt lgkmcnt(0)
    v_pk_add_f32 v[104:105], v[104:105], v[112:113]
    v_pk_add_f32 v[106:107], v[106:107], v[114:115]
    v_pk_add_f32 v[108:109], v[108:109], v[116:117]
    v_pk_add_f32 v[110:111], v[110:111], v[118:119]
    v_pk_add_f32 v[104:105], v[104:105], v[120:121]
    v_pk_add_f32 v[106:107], v[106:107], v[122:123]
    v_pk_add_f32 v[108:109], v[108:109], v[124:125]
    v_pk_add_f32 v[110:111], v[110:111], v[126:127]
    v_pk_add_f32 v[104:105], v[104:105], v[128:129]
    v_pk_add_f32 v[106:107], v[106:107], v[130:131]
    v_pk_add_f32 v[108:109], v[108:109], v[132:133]
    v_pk_add_f32 v[110:111], v[110:111], v[134:135]
    v_cvt_pk_bf16_f32 v184, v104, v105
    v_cvt_pk_bf16_f32 v185, v106, v107
    v_cvt_pk_bf16_f32 v186, v108, v109
    v_cvt_pk_bf16_f32 v187, v110, v111
    s_lshl_b32 s40, s56, 12
    s_add_u32 s40, s40, 8914944
    v_and_b32 v3, 127, v0
    v_lshlrev_b32 v3, 4, v3
    buffer_store_dwordx4 v[184:187], v3, s[8:11], s40 offen
    s_nop 1
c_fin_end_18:
    s_waitcnt vmcnt(4)
    v_cmp_ne_u32 vcc, 0, v0
    s_nop 1
    v_cndmask_b32 v16, 0, v16, vcc
    v_cndmask_b32 v17, 0, v17, vcc
    v_cndmask_b32 v18, 0, v18, vcc
    v_cndmask_b32 v19, 0, v19, vcc
    v_alignbit_b32 v176, v17, v16, 16
    v_alignbit_b32 v177, v18, v17, 16
    v_alignbit_b32 v178, v19, v18, 16
    v_alignbit_b32 v179, v20, v19, 16
    v_alignbit_b32 v180, v21, v20, 16
    v_alignbit_b32 v181, v22, v21, 16
    v_alignbit_b32 v182, v23, v22, 16
    ds_write_b128 v56, v[176:179] offset:0
    v_mov_b32 v184, v17
    v_mov_b32 v185, v18
    v_mov_b32 v186, v19
    v_mov_b32 v187, v20
    ds_write_b128 v56, v[184:187] offset:4160
    s_nop 1
    v_mov_b32 v184, v177
    v_mov_b32 v185, v178
    v_mov_b32 v186, v179
    v_mov_b32 v187, v180
    ds_write_b128 v56, v[184:187] offset:8320
    s_nop 1
    ds_write_b128 v56, v[18:21] offset:12480
    ds_write_b128 v56, v[178:181] offset:16640
    v_mov_b32 v184, v19
    v_mov_b32 v185, v20
    v_mov_b32 v186, v21
    v_mov_b32 v187, v22
    ds_write_b128 v56, v[184:187] offset:20800
    s_nop 1
    v_mov_b32 v184, v179
    v_mov_b32 v185, v180
    v_mov_b32 v186, v181
    v_mov_b32 v187, v182
    ds_write_b128 v56, v[184:187] offset:24960
    s_nop 1
    ds_write_b128 v56, v[20:23] offset:29120
    ds_write_b128 v57, v[36:39]
    v_lshlrev_b32 v3, 16, v45
    v_or_b32 v3, v3, v45
    v_and_b32 v188, v60, v3
    v_and_b32 v189, v61, v3
    v_and_b32 v190, v62, v3
    v_and_b32 v191, v63, v3
    v_and_b32 v192, v64, v3
    v_and_b32 v193, v65, v3
    v_and_b32 v194, v66, v3
    v_and_b32 v195, v67, v3
    s_waitcnt lgkmcnt(0)
    s_barrier
    s_cmp_lg_u32 s34, 0
    s_cbranch_scc1 c_pw_20
    ds_read_b128 v[104:107], v58 offset:0
    ds_read_b128 v[128:131], v59 offset:2592
    ds_read_b128 v[152:155], v59 offset:5152
    ds_read_b128 v[108:111], v58 offset:32
    ds_read_b128 v[132:135], v59 offset:2560
    ds_read_b128 v[156:159], v59 offset:5120
    ds_read_b128 v[112:115], v58 offset:64
    ds_read_b128 v[136:139], v59 offset:2512
    ds_read_b128 v[160:163], v59 offset:5072
    ds_read_b128 v[116:119], v58 offset:96
    ds_read_b128 v[140:143], v59 offset:2480
    ds_read_b128 v[164:167], v59 offset:5040
    ds_read_b128 v[120:123], v58 offset:128
    ds_read_b128 v[144:147], v59 offset:2432
    ds_read_b128 v[168:171], v59 offset:4992
    s_waitcnt lgkmcnt(12)
    v_mfma_f32_32x32x16_bf16 v[72:87], v[104:107], v[128:131], 0
    v_mfma_f32_32x32x16_bf16 v[88:103], v[104:107], v[152:155], 0
    v_mfma_f32_32x32x16_bf16 v[72:87], v[192:195], v[128:131], v[72:87]
    v_mfma_f32_32x32x16_bf16 v[88:103], v[192:195], v[152:155], v[88:103]
    ds_read_b128 v[124:127], v58 offset:160
    ds_read_b128 v[148:151], v59 offset:2400
    ds_read_b128 v[172:175], v59 offset:4960
    s_waitcnt lgkmcnt(12)
    v_mfma_f32_32x32x16_bf16 v[72:87], v[108:111], v[132:135], v[72:87]
    v_mfma_f32_32x32x16_bf16 v[88:103], v[108:111], v[156:159], v[88:103]
    v_mfma_f32_32x32x16_bf16 v[72:87], v[188:191], v[132:135], v[72:87]
    v_mfma_f32_32x32x16_bf16 v[88:103], v[188:191], v[156:159], v[88:103]
    ds_read_b128 v[104:107], v58 offset:192
    ds_read_b128 v[128:131], v59 offset:2352
    ds_read_b128 v[152:155], v59 offset:4912
    s_waitcnt lgkmcnt(12)
    v_mfma_f32_32x32x16_bf16 v[72:87], v[112:115], v[136:139], v[72:87]
    v_mfma_f32_32x32x16_bf16 v[88:103], v[112:115], v[160:163], v[88:103]
    ds_read_b128 v[108:111], v58 offset:224
    ds_read_b128 v[132:135], v59 offset:2320
    ds_read_b128 v[156:159], v59 offset:4880
    s_waitcnt lgkmcnt(12)
    v_mfma_f32_32x32x16_bf16 v[72:87], v[116:119], v[140:143], v[72:87]
    v_mfma_f32_32x32x16_bf16 v[88:103], v[116:119], v[164:167], v[88:103]
    ds_read_b128 v[112:115], v58 offset:256
    ds_read_b128 v[136:139], v59 offset:2272
    ds_read_b128 v[160:163], v59 offset:4832
    s_waitcnt lgkmcnt(12)
    v_mfma_f32_32x32x16_bf16 v[72:87], v[120:123], v[144:147], v[72:87]
    v_mfma_f32_32x32x16_bf16 v[88:103], v[120:123], v[168:171], v[88:103]
    ds_read_b128 v[116:119], v58 offset:288
    ds_read_b128 v[140:143], v59 offset:2240
    ds_read_b128 v[164:167], v59 offset:4800
    s_waitcnt lgkmcnt(12)
    v_mfma_f32_32x32x16_bf16 v[72:87], v[124:127], v[148:151], v[72:87]
    v_mfma_f32_32x32x16_bf16 v[88:103], v[124:127], v[172:175], v[88:103]
    ds_read_b128 v[120:123], v58 offset:320
    ds_read_b128 v[144:147], v59 offset:2192
    ds_read_b128 v[168:171], v59 offset:4752
    s_waitcnt lgkmcnt(12)
    v_mfma_f32_32x32x16_bf16 v[72:87], v[104:107], v[128:131], v[72:87]
    v_mfma_f32_32x32x16_bf16 v[88:103], v[104:107], v[152:155], v[88:103]
    ds_read_b128 v[124:127], v58 offset:352
    ds_read_b128 v[148:151], v59 offset:2160
    ds_read_b128 v[172:175], v59 offset:4720
    s_waitcnt lgkmcnt(12)
    v_mfma_f32_32x32x16_bf16 v[72:87], v[108:111], v[132:135], v[72:87]
    v_mfma_f32_32x32x16_bf16 v[88:103], v[108:111], v[156:159], v[88:103]
    ds_read_b128 v[104:107], v58 offset:384
    ds_read_b128 v[128:131], v59 offset:2112
    ds_read_b128 v[152:155], v59 offset:4672
    s_waitcnt lgkmcnt(12)
    v_mfma_f32_32x32x16_bf16 v[72:87], v[112:115], v[136:139], v[72:87]
    v_mfma_f32_32x32x16_bf16 v[88:103], v[112:115], v[160:163], v[88:103]
    ds_read_b128 v[108:111], v58 offset:416
    ds_read_b128 v[132:135], v59 offset:2080
    ds_read_b128 v[156:159], v59 offset:4640
    s_waitcnt lgkmcnt(12)
    v_mfma_f32_32x32x16_bf16 v[72:87], v[116:119], v[140:143], v[72:87]
    v_mfma_f32_32x32x16_bf16 v[88:103], v[116:119], v[164:167], v[88:103]
    ds_read_b128 v[112:115], v58 offset:448
    ds_read_b128 v[136:139], v59 offset:2032
    ds_read_b128 v[160:163], v59 offset:4592
    s_waitcnt lgkmcnt(12)
    v_mfma_f32_32x32x16_bf16 v[72:87], v[120:123], v[144:147], v[72:87]
    v_mfma_f32_32x32x16_bf16 v[88:103], v[120:123], v[168:171], v[88:103]
    ds_read_b128 v[116:119], v58 offset:480
    ds_read_b128 v[140:143], v59 offset:2000
    ds_read_b128 v[164:167], v59 offset:4560
    s_waitcnt lgkmcnt(12)
    v_mfma_f32_32x32x16_bf16 v[72:87], v[124:127], v[148:151], v[72:87]
    v_mfma_f32_32x32x16_bf16 v[88:103], v[124:127], v[172:175], v[88:103]
    ds_read_b128 v[120:123], v58 offset:512
    ds_read_b128 v[144:147], v59 offset:1952
    ds_read_b128 v[168:171], v59 offset:4512
    s_waitcnt lgkmcnt(12)
    v_mfma_f32_32x32x16_bf16 v[72:87], v[104:107], v[128:131], v[72:87]
    v_mfma_f32_32x32x16_bf16 v[88:103], v[104:107], v[152:155], v[88:103]
    ds_read_b128 v[124:127], v58 offset:544
    ds_read_b128 v[148:151], v59 offset:1920
    ds_read_b128 v[172:175], v59 offset:4480
    s_waitcnt lgkmcnt(12)
    v_mfma_f32_32x32x16_bf16 v[72:87], v[108:111], v[132:135], v[72:87]
    v_mfma_f32_32x32x16_bf16 v[88:103], v[108:111], v[156:159], v[88:103]
    ds_read_b128 v[104:107], v58 offset:576
    ds_read_b128 v[128:131], v59 offset:1872
    ds_read_b128 v[152:155], v59 offset:4432
    s_waitcnt lgkmcnt(12)
    v_mfma_f32_32x32x16_bf16 v[72:87], v[112:115], v[136:139], v[72:87]
    v_mfma_f32_32x32x16_bf16 v[88:103], v[112:115], v[160:163], v[88:103]
    ds_read_b128 v[108:111], v58 offset:608
    ds_read_b128 v[132:135], v59 offset:1840
    ds_read_b128 v[156:159], v59 offset:4400
    s_waitcnt lgkmcnt(12)
    v_mfma_f32_32x32x16_bf16 v[72:87], v[116:119], v[140:143], v[72:87]
    v_mfma_f32_32x32x16_bf16 v[88:103], v[116:119], v[164:167], v[88:103]
    ds_read_b128 v[112:115], v58 offset:640
    ds_read_b128 v[136:139], v59 offset:1792
    ds_read_b128 v[160:163], v59 offset:4352
    s_waitcnt lgkmcnt(12)
    v_mfma_f32_32x32x16_bf16 v[72:87], v[120:123], v[144:147], v[72:87]
    v_mfma_f32_32x32x16_bf16 v[88:103], v[120:123], v[168:171], v[88:103]
    ds_read_b128 v[116:119], v58 offset:672
    ds_read_b128 v[140:143], v59 offset:1760
    ds_read_b128 v[164:167], v59 offset:4320
    s_waitcnt lgkmcnt(12)
    v_mfma_f32_32x32x16_bf16 v[72:87], v[124:127], v[148:151], v[72:87]
    v_mfma_f32_32x32x16_bf16 v[88:103], v[124:127], v[172:175], v[88:103]
    ds_read_b128 v[120:123], v58 offset:704
    ds_read_b128 v[144:147], v59 offset:1712
    ds_read_b128 v[168:171], v59 offset:4272
    s_waitcnt lgkmcnt(12)
    v_mfma_f32_32x32x16_bf16 v[72:87], v[104:107], v[128:131], v[72:87]
    v_mfma_f32_32x32x16_bf16 v[88:103], v[104:107], v[152:155], v[88:103]
    s_waitcnt lgkmcnt(9)
    v_mfma_f32_32x32x16_bf16 v[72:87], v[108:111], v[132:135], v[72:87]
    v_mfma_f32_32x32x16_bf16 v[88:103], v[108:111], v[156:159], v[88:103]
    s_waitcnt lgkmcnt(6)
    v_mfma_f32_32x32x16_bf16 v[72:87], v[112:115], v[136:139], v[72:87]
    v_mfma_f32_32x32x16_bf16 v[88:103], v[112:115], v[160:163], v[88:103]
    s_waitcnt lgkmcnt(3)
    v_mfma_f32_32x32x16_bf16 v[72:87], v[116:119], v[140:143], v[72:87]
    v_mfma_f32_32x32x16_bf16 v[88:103], v[116:119], v[164:167], v[88:103]
    s_waitcnt lgkmcnt(0)
    v_mfma_f32_32x32x16_bf16 v[72:87], v[120:123], v[144:147], v[72:87]
    v_mfma_f32_32x32x16_bf16 v[88:103], v[120:123], v[168:171], v[88:103]
    s_nop 10
    ds_write_b128 v70, v[72:75] offset:0
    ds_write_b128 v70, v[76:79] offset:32
    ds_write_b128 v70, v[80:83] offset:64
    ds_write_b128 v70, v[84:87] offset:96
    ds_write_b128 v70, v[88:91] offset:13824
    ds_write_b128 v70, v[92:95] offset:13856
    ds_write_b128 v70, v[96:99] offset:13888
    ds_write_b128 v70, v[100:103] offset:13920
    s_branch c_pw_end_19
c_pw_20:
    s_cmp_lg_u32 s34, 1
    s_cbranch_scc1 c_pw_21
    ds_read_b128 v[104:107], v58 offset:736
    ds_read_b128 v[128:131], v59 offset:1680
    ds_read_b128 v[152:155], v59 offset:4240
    ds_read_b128 v[108:111], v58 offset:768
    ds_read_b128 v[132:135], v59 offset:1632
    ds_read_b128 v[156:159], v59 offset:4192
    ds_read_b128 v[112:115], v58 offset:800
    ds_read_b128 v[136:139], v59 offset:1600
    ds_read_b128 v[160:163], v59 offset:4160
    ds_read_b128 v[116:119], v58 offset:832
    ds_read_b128 v[140:143], v59 offset:1552
    ds_read_b128 v[164:167], v59 offset:4112
    ds_read_b128 v[120:123], v58 offset:864
    ds_read_b128 v[144:147], v59 offset:1520
    ds_read_b128 v[168:171], v59 offset:4080
    s_waitcnt lgkmcnt(12)
    v_mfma_f32_32x32x16_bf16 v[72:87], v[104:107], v[128:131], 0
    v_mfma_f32_32x32x16_bf16 v[88:103], v[104:107], v[152:155], 0
    ds_read_b128 v[124:127], v58 offset:896
    ds_read_b128 v[148:151], v59 offset:1472
    ds_read_b128 v[172:175], v59 offset:4032
    s_waitcnt lgkmcnt(12)
    v_mfma_f32_32x32x16_bf16 v[72:87], v[108:111], v[132:135], v[72:87]
    v_mfma_f32_32x32x16_bf16 v[88:103], v[108:111], v[156:159], v[88:103]
    ds_read_b128 v[104:107], v58 offset:928
    ds_read_b128 v[128:131], v59 offset:1440
    ds_read_b128 v[152:155], v59 offset:4000
    s_waitcnt lgkmcnt(12)
    v_mfma_f32_32x32x16_bf16 v[72:87], v[112:115], v[136:139], v[72:87]
    v_mfma_f32_32x32x16_bf16 v[88:103], v[112:115], v[160:163], v[88:103]
    ds_read_b128 v[108:111], v58 offset:960
    ds_read_b128 v[132:135], v59 offset:1392
    ds_read_b128 v[156:159], v59 offset:3952
    s_waitcnt lgkmcnt(12)
    v_mfma_f32_32x32x16_bf16 v[72:87], v[116:119], v[140:143], v[72:87]
    v_mfma_f32_32x32x16_bf16 v[88:103], v[116:119], v[164:167], v[88:103]
    ds_read_b128 v[112:115], v58 offset:992
    ds_read_b128 v[136:139], v59 offset:1360
    ds_read_b128 v[160:163], v59 offset:3920
    s_waitcnt lgkmcnt(12)
    v_mfma_f32_32x32x16_bf16 v[72:87], v[120:123], v[144:147], v[72:87]
    v_mfma_f32_32x32x16_bf16 v[88:103], v[120:123], v[168:171], v[88:103]
    ds_read_b128 v[116:119], v58 offset:1024
    ds_read_b128 v[140:143], v59 offset:1312
    ds_read_b128 v[164:167], v59 offset:3872
    s_waitcnt lgkmcnt(12)
    v_mfma_f32_32x32x16_bf16 v[72:87], v[124:127], v[148:151], v[72:87]
    v_mfma_f32_32x32x16_bf16 v[88:103], v[124:127], v[172:175], v[88:103]
    ds_read_b128 v[120:123], v58 offset:1056
    ds_read_b128 v[144:147], v59 offset:1280
    ds_read_b128 v[168:171], v59 offset:3840
    s_waitcnt lgkmcnt(12)
    v_mfma_f32_32x32x16_bf16 v[72:87], v[104:107], v[128:131], v[72:87]
    v_mfma_f32_32x32x16_bf16 v[88:103], v[104:107], v[152:155], v[88:103]
    ds_read_b128 v[124:127], v58 offset:1088
    ds_read_b128 v[148:151], v59 offset:1232
    ds_read_b128 v[172:175], v59 offset:3792
    s_waitcnt lgkmcnt(12)
    v_mfma_f32_32x32x16_bf16 v[72:87], v[108:111], v[132:135], v[72:87]
    v_mfma_f32_32x32x16_bf16 v[88:103], v[108:111], v[156:159], v[88:103]
    ds_read_b128 v[104:107], v58 offset:1120
    ds_read_b128 v[128:131], v59 offset:1200
    ds_read_b128 v[152:155], v59 offset:3760
    s_waitcnt lgkmcnt(12)
    v_mfma_f32_32x32x16_bf16 v[72:87], v[112:115], v[136:139], v[72:87]
    v_mfma_f32_32x32x16_bf16 v[88:103], v[112:115], v[160:163], v[88:103]
    ds_read_b128 v[108:111], v58 offset:1152
    ds_read_b128 v[132:135], v59 offset:1152
    ds_read_b128 v[156:159], v59 offset:3712
    s_waitcnt lgkmcnt(12)
    v_mfma_f32_32x32x16_bf16 v[72:87], v[116:119], v[140:143], v[72:87]
    v_mfma_f32_32x32x16_bf16 v[88:103], v[116:119], v[164:167], v[88:103]
    ds_read_b128 v[112:115], v58 offset:1184
    ds_read_b128 v[136:139], v59 offset:1120
    ds_read_b128 v[160:163], v59 offset:3680
    s_waitcnt lgkmcnt(12)
    v_mfma_f32_32x32x16_bf16 v[72:87], v[120:123], v[144:147], v[72:87]
    v_mfma_f32_32x32x16_bf16 v[88:103], v[120:123], v[168:171], v[88:103]
    ds_read_b128 v[116:119], v58 offset:1216
    ds_read_b128 v[140:143], v59 offset:1072
    ds_read_b128 v[164:167], v59 offset:3632
    s_waitcnt lgkmcnt(12)
    v_mfma_f32_32x32x16_bf16 v[72:87], v[124:127], v[148:151], v[72:87]
    v_mfma_f32_32x32x16_bf16 v[88:103], v[124:127], v[172:175], v[88:103]
    ds_read_b128 v[120:123], v58 offset:1248
    ds_read_b128 v[144:147], v59 offset:1040
    ds_read_b128 v[168:171], v59 offset:3600
    s_waitcnt lgkmcnt(12)
    v_mfma_f32_32x32x16_bf16 v[72:87], v[104:107], v[128:131], v[72:87]
    v_mfma_f32_32x32x16_bf16 v[88:103], v[104:107], v[152:155], v[88:103]
    ds_read_b128 v[124:127], v58 offset:1280
    ds_read_b128 v[148:151], v59 offset:992
    ds_read_b128 v[172:175], v59 offset:3552
    s_waitcnt lgkmcnt(12)
    v_mfma_f32_32x32x16_bf16 v[72:87], v[108:111], v[132:135], v[72:87]
    v_mfma_f32_32x32x16_bf16 v[88:103], v[108:111], v[156:159], v[88:103]
    ds_read_b128 v[104:107], v58 offset:1312
    ds_read_b128 v[128:131], v59 offset:960
    ds_read_b128 v[152:155], v59 offset:3520
    s_waitcnt lgkmcnt(12)
    v_mfma_f32_32x32x16_bf16 v[72:87], v[112:115], v[136:139], v[72:87]
    v_mfma_f32_32x32x16_bf16 v[88:103], v[112:115], v[160:163], v[88:103]
    ds_read_b128 v[108:111], v58 offset:1344
    ds_read_b128 v[132:135], v59 offset:912
    ds_read_b128 v[156:159], v59 offset:3472
    s_waitcnt lgkmcnt(12)
    v_mfma_f32_32x32x16_bf16 v[72:87], v[116:119], v[140:143], v[72:87]
    v_mfma_f32_32x32x16_bf16 v[88:103], v[116:119], v[164:167], v[88:103]
    ds_read_b128 v[112:115], v58 offset:1376
    ds_read_b128 v[136:139], v59 offset:880
    ds_read_b128 v[160:163], v59 offset:3440
    s_waitcnt lgkmcnt(12)
    v_mfma_f32_32x32x16_bf16 v[72:87], v[120:123], v[144:147], v[72:87]
    v_mfma_f32_32x32x16_bf16 v[88:103], v[120:123], v[168:171], v[88:103]
    ds_read_b128 v[116:119], v58 offset:1408
    ds_read_b128 v[140:143], v59 offset:832
    ds_read_b128 v[164:167], v59 offset:3392
    s_waitcnt lgkmcnt(12)
    v_mfma_f32_32x32x16_bf16 v[72:87], v[124:127], v[148:151], v[72:87]
    v_mfma_f32_32x32x16_bf16 v[88:103], v[124:127], v[172:175], v[88:103]
    ds_read_b128 v[120:123], v58 offset:1440
    ds_read_b128 v[144:147], v59 offset:800
    ds_read_b128 v[168:171], v59 offset:3360
    s_waitcnt lgkmcnt(12)
    v_mfma_f32_32x32x16_bf16 v[72:87], v[104:107], v[128:131], v[72:87]
    v_mfma_f32_32x32x16_bf16 v[88:103], v[104:107], v[152:155], v[88:103]
    ds_read_b128 v[124:127], v58 offset:1472
    ds_read_b128 v[148:151], v59 offset:752
    ds_read_b128 v[172:175], v59 offset:3312
    s_waitcnt lgkmcnt(12)
    v_mfma_f32_32x32x16_bf16 v[72:87], v[108:111], v[132:135], v[72:87]
    v_mfma_f32_32x32x16_bf16 v[88:103], v[108:111], v[156:159], v[88:103]
    s_waitcnt lgkmcnt(9)
    v_mfma_f32_32x32x16_bf16 v[72:87], v[112:115], v[136:139], v[72:87]
    v_mfma_f32_32x32x16_bf16 v[88:103], v[112:115], v[160:163], v[88:103]
    s_waitcnt lgkmcnt(6)
    v_mfma_f32_32x32x16_bf16 v[72:87], v[116:119], v[140:143], v[72:87]
    v_mfma_f32_32x32x16_bf16 v[88:103], v[116:119], v[164:167], v[88:103]
    s_waitcnt lgkmcnt(3)
    v_mfma_f32_32x32x16_bf16 v[72:87], v[120:123], v[144:147], v[72:87]
    v_mfma_f32_32x32x16_bf16 v[88:103], v[120:123], v[168:171], v[88:103]
    s_waitcnt lgkmcnt(0)
    v_mfma_f32_32x32x16_bf16 v[72:87], v[124:127], v[148:151], v[72:87]
    v_mfma_f32_32x32x16_bf16 v[88:103], v[124:127], v[172:175], v[88:103]
    s_nop 10
    ds_write_b128 v70, v[72:75] offset:4608
    ds_write_b128 v70, v[76:79] offset:4640
    ds_write_b128 v70, v[80:83] offset:4672
    ds_write_b128 v70, v[84:87] offset:4704
    ds_write_b128 v70, v[88:91] offset:18432
    ds_write_b128 v70, v[92:95] offset:18464
    ds_write_b128 v70, v[96:99] offset:18496
    ds_write_b128 v70, v[100:103] offset:18528
    s_branch c_pw_end_19
c_pw_21:
    s_cmp_lg_u32 s34, 2
    s_cbranch_scc1 c_pw_22
    ds_read_b128 v[104:107], v58 offset:1504
    ds_read_b128 v[128:131], v59 offset:720
    ds_read_b128 v[152:155], v59 offset:3280
    ds_read_b128 v[108:111], v58 offset:1536
    ds_read_b128 v[132:135], v59 offset:672
    ds_read_b128 v[156:159], v59 offset:3232
    ds_read_b128 v[112:115], v58 offset:1568
    ds_read_b128 v[136:139], v59 offset:640
    ds_read_b128 v[160:163], v59 offset:3200
    ds_read_b128 v[116:119], v58 offset:1600
    ds_read_b128 v[140:143], v59 offset:592
    ds_read_b128 v[164:167], v59 offset:3152
    ds_read_b128 v[120:123], v58 offset:1632
    ds_read_b128 v[144:147], v59 offset:560
    ds_read_b128 v[168:171], v59 offset:3120
    s_waitcnt lgkmcnt(12)
    v_mfma_f32_32x32x16_bf16 v[72:87], v[104:107], v[128:131], 0
    v_mfma_f32_32x32x16_bf16 v[88:103], v[104:107], v[152:155], 0
    ds_read_b128 v[124:127], v58 offset:1664
    ds_read_b128 v[148:151], v59 offset:512
    ds_read_b128 v[172:175], v59 offset:3072
    s_waitcnt lgkmcnt(12)
    v_mfma_f32_32x32x16_bf16 v[72:87], v[108:111], v[132:135], v[72:87]
    v_mfma_f32_32x32x16_bf16 v[88:103], v[108:111], v[156:159], v[88:103]
    ds_read_b128 v[104:107], v58 offset:1696
    ds_read_b128 v[128:131], v59 offset:480
    ds_read_b128 v[152:155], v59 offset:3040
    s_waitcnt lgkmcnt(12)
    v_mfma_f32_32x32x16_bf16 v[72:87], v[112:115], v[136:139], v[72:87]
    v_mfma_f32_32x32x16_bf16 v[88:103], v[112:115], v[160:163], v[88:103]
    ds_read_b128 v[108:111], v58 offset:1728
    ds_read_b128 v[132:135], v59 offset:432
    ds_read_b128 v[156:159], v59 offset:2992
    s_waitcnt lgkmcnt(12)
    v_mfma_f32_32x32x16_bf16 v[72:87], v[116:119], v[140:143], v[72:87]
    v_mfma_f32_32x32x16_bf16 v[88:103], v[116:119], v[164:167], v[88:103]
    ds_read_b128 v[112:115], v58 offset:1760
    ds_read_b128 v[136:139], v59 offset:400
    ds_read_b128 v[160:163], v59 offset:2960
    s_waitcnt lgkmcnt(12)
    v_mfma_f32_32x32x16_bf16 v[72:87], v[120:123], v[144:147], v[72:87]
    v_mfma_f32_32x32x16_bf16 v[88:103], v[120:123], v[168:171], v[88:103]
    ds_read_b128 v[116:119], v58 offset:1792
    ds_read_b128 v[140:143], v59 offset:352
    ds_read_b128 v[164:167], v59 offset:2912
    s_waitcnt lgkmcnt(12)
    v_mfma_f32_32x32x16_bf16 v[72:87], v[124:127], v[148:151], v[72:87]
    v_mfma_f32_32x32x16_bf16 v[88:103], v[124:127], v[172:175], v[88:103]
    ds_read_b128 v[120:123], v58 offset:1824
    ds_read_b128 v[144:147], v59 offset:320
    ds_read_b128 v[168:171], v59 offset:2880
    s_waitcnt lgkmcnt(12)
    v_mfma_f32_32x32x16_bf16 v[72:87], v[104:107], v[128:131], v[72:87]
    v_mfma_f32_32x32x16_bf16 v[88:103], v[104:107], v[152:155], v[88:103]
    ds_read_b128 v[124:127], v58 offset:1856
    ds_read_b128 v[148:151], v59 offset:272
    ds_read_b128 v[172:175], v59 offset:2832
    s_waitcnt lgkmcnt(12)
    v_mfma_f32_32x32x16_bf16 v[72:87], v[108:111], v[132:135], v[72:87]
    v_mfma_f32_32x32x16_bf16 v[88:103], v[108:111], v[156:159], v[88:103]
    ds_read_b128 v[104:107], v58 offset:1888
    ds_read_b128 v[128:131], v59 offset:240
    ds_read_b128 v[152:155], v59 offset:2800
    s_waitcnt lgkmcnt(12)
    v_mfma_f32_32x32x16_bf16 v[72:87], v[112:115], v[136:139], v[72:87]
    v_mfma_f32_32x32x16_bf16 v[88:103], v[112:115], v[160:163], v[88:103]
    ds_read_b128 v[108:111], v58 offset:1920
    ds_read_b128 v[132:135], v59 offset:192
    ds_read_b128 v[156:159], v59 offset:2752
    s_waitcnt lgkmcnt(12)
    v_mfma_f32_32x32x16_bf16 v[72:87], v[116:119], v[140:143], v[72:87]
    v_mfma_f32_32x32x16_bf16 v[88:103], v[116:119], v[164:167], v[88:103]
    ds_read_b128 v[112:115], v58 offset:1952
    ds_read_b128 v[136:139], v59 offset:160
    ds_read_b128 v[160:163], v59 offset:2720
    s_waitcnt lgkmcnt(12)
    v_mfma_f32_32x32x16_bf16 v[72:87], v[120:123], v[144:147], v[72:87]
    v_mfma_f32_32x32x16_bf16 v[88:103], v[120:123], v[168:171], v[88:103]
    ds_read_b128 v[116:119], v58 offset:1984
    ds_read_b128 v[140:143], v59 offset:112
    ds_read_b128 v[164:167], v59 offset:2672
    s_waitcnt lgkmcnt(12)
    v_mfma_f32_32x32x16_bf16 v[72:87], v[124:127], v[148:151], v[72:87]
    v_mfma_f32_32x32x16_bf16 v[88:103], v[124:127], v[172:175], v[88:103]
    ds_read_b128 v[120:123], v58 offset:2016
    ds_read_b128 v[144:147], v59 offset:80
    ds_read_b128 v[168:171], v59 offset:2640
    s_waitcnt lgkmcnt(12)
    v_mfma_f32_32x32x16_bf16 v[72:87], v[104:107], v[128:131], v[72:87]
    v_mfma_f32_32x32x16_bf16 v[88:103], v[104:107], v[152:155], v[88:103]
    ds_read_b128 v[124:127], v58 offset:2048
    ds_read_b128 v[172:175], v59 offset:2592
    s_waitcnt lgkmcnt(11)
    v_mfma_f32_32x32x16_bf16 v[72:87], v[108:111], v[132:135], v[72:87]
    v_mfma_f32_32x32x16_bf16 v[88:103], v[108:111], v[156:159], v[88:103]
    ds_read_b128 v[104:107], v58 offset:2080
    ds_read_b128 v[152:155], v59 offset:2560
    s_waitcnt lgkmcnt(10)
    v_mfma_f32_32x32x16_bf16 v[72:87], v[112:115], v[136:139], v[72:87]
    v_mfma_f32_32x32x16_bf16 v[88:103], v[112:115], v[160:163], v[88:103]
    ds_read_b128 v[108:111], v58 offset:2112
    ds_read_b128 v[156:159], v59 offset:2512
    s_waitcnt lgkmcnt(9)
    v_mfma_f32_32x32x16_bf16 v[72:87], v[116:119], v[140:143], v[72:87]
    v_mfma_f32_32x32x16_bf16 v[88:103], v[116:119], v[164:167], v[88:103]
    ds_read_b128 v[112:115], v58 offset:2144
    ds_read_b128 v[160:163], v59 offset:2480
    s_waitcnt lgkmcnt(8)
    v_mfma_f32_32x32x16_bf16 v[72:87], v[120:123], v[144:147], v[72:87]
    v_mfma_f32_32x32x16_bf16 v[88:103], v[120:123], v[168:171], v[88:103]
    ds_read_b128 v[116:119], v58 offset:2176
    ds_read_b128 v[164:167], v59 offset:2432
    s_waitcnt lgkmcnt(8)
    v_mfma_f32_32x32x16_bf16 v[88:103], v[124:127], v[172:175], v[88:103]
    ds_read_b128 v[120:123], v58 offset:2208
    ds_read_b128 v[168:171], v59 offset:2400
    s_waitcnt lgkmcnt(8)
    v_mfma_f32_32x32x16_bf16 v[88:103], v[104:107], v[152:155], v[88:103]
    ds_read_b128 v[124:127], v58 offset:2240
    ds_read_b128 v[172:175], v59 offset:2352
    s_waitcnt lgkmcnt(8)
    v_mfma_f32_32x32x16_bf16 v[88:103], v[108:111], v[156:159], v[88:103]
    ds_read_b128 v[104:107], v58 offset:2272
    ds_read_b128 v[152:155], v59 offset:2320
    s_waitcnt lgkmcnt(8)
    v_mfma_f32_32x32x16_bf16 v[88:103], v[112:115], v[160:163], v[88:103]
    ds_read_b128 v[108:111], v58 offset:2304
    ds_read_b128 v[156:159], v59 offset:2272
    s_waitcnt lgkmcnt(8)
    v_mfma_f32_32x32x16_bf16 v[88:103], v[116:119], v[164:167], v[88:103]
    ds_read_b128 v[112:115], v58 offset:2336
    ds_read_b128 v[160:163], v59 offset:2240
    s_waitcnt lgkmcnt(8)
    v_mfma_f32_32x32x16_bf16 v[88:103], v[120:123], v[168:171], v[88:103]
    ds_read_b128 v[116:119], v58 offset:2368
    ds_read_b128 v[164:167], v59 offset:2192
    s_waitcnt lgkmcnt(8)
    v_mfma_f32_32x32x16_bf16 v[88:103], v[124:127], v[172:175], v[88:103]
    ds_read_b128 v[120:123], v58 offset:2400
    ds_read_b128 v[168:171], v59 offset:2160
    s_waitcnt lgkmcnt(8)
    v_mfma_f32_32x32x16_bf16 v[88:103], v[104:107], v[152:155], v[88:103]
    ds_read_b128 v[124:127], v58 offset:2432
    ds_read_b128 v[172:175], v59 offset:2112
    s_waitcnt lgkmcnt(8)
    v_mfma_f32_32x32x16_bf16 v[88:103], v[108:111], v[156:159], v[88:103]
    ds_read_b128 v[104:107], v58 offset:2464
    ds_read_b128 v[152:155], v59 offset:2080
    s_waitcnt lgkmcnt(8)
    v_mfma_f32_32x32x16_bf16 v[88:103], v[112:115], v[160:163], v[88:103]
    ds_read_b128 v[108:111], v58 offset:2496
    ds_read_b128 v[156:159], v59 offset:2032
    s_waitcnt lgkmcnt(8)
    v_mfma_f32_32x32x16_bf16 v[88:103], v[116:119], v[164:167], v[88:103]
    s_waitcnt lgkmcnt(6)
    v_mfma_f32_32x32x16_bf16 v[88:103], v[120:123], v[168:171], v[88:103]
    s_waitcnt lgkmcnt(4)
    v_mfma_f32_32x32x16_bf16 v[88:103], v[124:127], v[172:175], v[88:103]
    s_waitcnt lgkmcnt(2)
    v_mfma_f32_32x32x16_bf16 v[88:103], v[104:107], v[152:155], v[88:103]
    s_waitcnt lgkmcnt(0)
    v_mfma_f32_32x32x16_bf16 v[88:103], v[108:111], v[156:159], v[88:103]
    ds_write_b128 v70, v[72:75] offset:9216
    ds_write_b128 v70, v[76:79] offset:9248
    ds_write_b128 v70, v[80:83] offset:9280
    ds_write_b128 v70, v[84:87] offset:9312
    s_nop 7
    ds_write_b128 v70, v[88:91] offset:23040
    ds_write_b128 v70, v[92:95] offset:23072
    ds_write_b128 v70, v[96:99] offset:23104
    ds_write_b128 v70, v[100:103] offset:23136
    s_branch c_pw_end_19
c_pw_22:
    ds_read_b128 v[104:107], v58 offset:2528
    ds_read_b128 v[152:155], v59 offset:2000
    ds_read_b128 v[108:111], v58 offset:2560
    ds_read_b128 v[156:159], v59 offset:1952
    ds_read_b128 v[112:115], v58 offset:2592
    ds_read_b128 v[160:163], v59 offset:1920
    ds_read_b128 v[116:119], v58 offset:2624
    ds_read_b128 v[164:167], v59 offset:1872
    ds_read_b128 v[120:123], v58 offset:2656
    ds_read_b128 v[168:171], v59 offset:1840
    s_waitcnt lgkmcnt(8)
    v_mfma_f32_32x32x16_bf16 v[88:103], v[104:107], v[152:155], 0
    ds_read_b128 v[124:127], v58 offset:2688
    ds_read_b128 v[172:175], v59 offset:1792
    s_waitcnt lgkmcnt(8)
    v_mfma_f32_32x32x16_bf16 v[88:103], v[108:111], v[156:159], v[88:103]
    ds_read_b128 v[104:107], v58 offset:2720
    ds_read_b128 v[152:155], v59 offset:1760
    s_waitcnt lgkmcnt(8)
    v_mfma_f32_32x32x16_bf16 v[88:103], v[112:115], v[160:163], v[88:103]
    ds_read_b128 v[108:111], v58 offset:2752
    ds_read_b128 v[156:159], v59 offset:1712
    s_waitcnt lgkmcnt(8)
    v_mfma_f32_32x32x16_bf16 v[88:103], v[116:119], v[164:167], v[88:103]
    ds_read_b128 v[112:115], v58 offset:2784
    ds_read_b128 v[160:163], v59 offset:1680
    s_waitcnt lgkmcnt(8)
    v_mfma_f32_32x32x16_bf16 v[88:103], v[120:123], v[168:171], v[88:103]
    ds_read_b128 v[116:119], v58 offset:2816
    ds_read_b128 v[164:167], v59 offset:1632
    s_waitcnt lgkmcnt(8)
    v_mfma_f32_32x32x16_bf16 v[88:103], v[124:127], v[172:175], v[88:103]
    ds_read_b128 v[120:123], v58 offset:2848
    ds_read_b128 v[168:171], v59 offset:1600
    s_waitcnt lgkmcnt(8)
    v_mfma_f32_32x32x16_bf16 v[88:103], v[104:107], v[152:155], v[88:103]
    ds_read_b128 v[124:127], v58 offset:2880
    ds_read_b128 v[172:175], v59 offset:1552
    s_waitcnt lgkmcnt(8)
    v_mfma_f32_32x32x16_bf16 v[88:103], v[108:111], v[156:159], v[88:103]
    ds_read_b128 v[104:107], v58 offset:2912
    ds_read_b128 v[152:155], v59 offset:1520
    s_waitcnt lgkmcnt(8)
    v_mfma_f32_32x32x16_bf16 v[88:103], v[112:115], v[160:163], v[88:103]
    ds_read_b128 v[108:111], v58 offset:2944
    ds_read_b128 v[156:159], v59 offset:1472
    s_waitcnt lgkmcnt(8)
    v_mfma_f32_32x32x16_bf16 v[88:103], v[116:119], v[164:167], v[88:103]
    ds_read_b128 v[112:115], v58 offset:2976
    ds_read_b128 v[160:163], v59 offset:1440
    s_waitcnt lgkmcnt(8)
    v_mfma_f32_32x32x16_bf16 v[88:103], v[120:123], v[168:171], v[88:103]
    ds_read_b128 v[116:119], v58 offset:3008
    ds_read_b128 v[164:167], v59 offset:1392
    s_waitcnt lgkmcnt(8)
    v_mfma_f32_32x32x16_bf16 v[88:103], v[124:127], v[172:175], v[88:103]
    ds_read_b128 v[120:123], v58 offset:3040
    ds_read_b128 v[168:171], v59 offset:1360
    s_waitcnt lgkmcnt(8)
    v_mfma_f32_32x32x16_bf16 v[88:103], v[104:107], v[152:155], v[88:103]
    ds_read_b128 v[124:127], v58 offset:3072
    ds_read_b128 v[172:175], v59 offset:1312
    s_waitcnt lgkmcnt(8)
    v_mfma_f32_32x32x16_bf16 v[88:103], v[108:111], v[156:159], v[88:103]
    ds_read_b128 v[104:107], v58 offset:3104
    ds_read_b128 v[152:155], v59 offset:1280
    s_waitcnt lgkmcnt(8)
    v_mfma_f32_32x32x16_bf16 v[88:103], v[112:115], v[160:163], v[88:103]
    ds_read_b128 v[108:111], v58 offset:3136
    ds_read_b128 v[156:159], v59 offset:1232
    s_waitcnt lgkmcnt(8)
    v_mfma_f32_32x32x16_bf16 v[88:103], v[116:119], v[164:167], v[88:103]
    ds_read_b128 v[112:115], v58 offset:3168
    ds_read_b128 v[160:163], v59 offset:1200
    s_waitcnt lgkmcnt(8)
    v_mfma_f32_32x32x16_bf16 v[88:103], v[120:123], v[168:171], v[88:103]
    ds_read_b128 v[116:119], v58 offset:3200
    ds_read_b128 v[164:167], v59 offset:1152
    s_waitcnt lgkmcnt(8)
    v_mfma_f32_32x32x16_bf16 v[88:103], v[124:127], v[172:175], v[88:103]
    ds_read_b128 v[120:123], v58 offset:3232
    ds_read_b128 v[168:171], v59 offset:1120
    s_waitcnt lgkmcnt(8)
    v_mfma_f32_32x32x16_bf16 v[88:103], v[104:107], v[152:155], v[88:103]
    ds_read_b128 v[124:127], v58 offset:3264
    ds_read_b128 v[172:175], v59 offset:1072
    s_waitcnt lgkmcnt(8)
    v_mfma_f32_32x32x16_bf16 v[88:103], v[108:111], v[156:159], v[88:103]
    ds_read_b128 v[104:107], v58 offset:3296
    ds_read_b128 v[152:155], v59 offset:1040
    s_waitcnt lgkmcnt(8)
    v_mfma_f32_32x32x16_bf16 v[88:103], v[112:115], v[160:163], v[88:103]
    ds_read_b128 v[108:111], v58 offset:3328
    ds_read_b128 v[156:159], v59 offset:992
    s_waitcnt lgkmcnt(8)
    v_mfma_f32_32x32x16_bf16 v[88:103], v[116:119], v[164:167], v[88:103]
    ds_read_b128 v[112:115], v58 offset:3360
    ds_read_b128 v[160:163], v59 offset:960
    s_waitcnt lgkmcnt(8)
    v_mfma_f32_32x32x16_bf16 v[88:103], v[120:123], v[168:171], v[88:103]
    ds_read_b128 v[116:119], v58 offset:3392
    ds_read_b128 v[164:167], v59 offset:912
    s_waitcnt lgkmcnt(8)
    v_mfma_f32_32x32x16_bf16 v[88:103], v[124:127], v[172:175], v[88:103]
    ds_read_b128 v[120:123], v58 offset:3424
    ds_read_b128 v[168:171], v59 offset:880
    s_waitcnt lgkmcnt(8)
    v_mfma_f32_32x32x16_bf16 v[88:103], v[104:107], v[152:155], v[88:103]
    ds_read_b128 v[124:127], v58 offset:3456
    ds_read_b128 v[172:175], v59 offset:832
    s_waitcnt lgkmcnt(8)
    v_mfma_f32_32x32x16_bf16 v[88:103], v[108:111], v[156:159], v[88:103]
    ds_read_b128 v[104:107], v58 offset:3488
    ds_read_b128 v[152:155], v59 offset:800
    s_waitcnt lgkmcnt(8)
    v_mfma_f32_32x32x16_bf16 v[88:103], v[112:115], v[160:163], v[88:103]
    ds_read_b128 v[108:111], v58 offset:3520
    ds_read_b128 v[156:159], v59 offset:752
    s_waitcnt lgkmcnt(8)
    v_mfma_f32_32x32x16_bf16 v[88:103], v[116:119], v[164:167], v[88:103]
    ds_read_b128 v[112:115], v58 offset:3552
    ds_read_b128 v[160:163], v59 offset:720
    s_waitcnt lgkmcnt(8)
    v_mfma_f32_32x32x16_bf16 v[88:103], v[120:123], v[168:171], v[88:103]
    ds_read_b128 v[116:119], v58 offset:3584
    ds_read_b128 v[164:167], v59 offset:672
    s_waitcnt lgkmcnt(8)
    v_mfma_f32_32x32x16_bf16 v[88:103], v[124:127], v[172:175], v[88:103]
    ds_read_b128 v[120:123], v58 offset:3616
    ds_read_b128 v[168:171], v59 offset:640
    s_waitcnt lgkmcnt(8)
    v_mfma_f32_32x32x16_bf16 v[88:103], v[104:107], v[152:155], v[88:103]
    ds_read_b128 v[124:127], v58 offset:3648
    ds_read_b128 v[172:175], v59 offset:592
    s_waitcnt lgkmcnt(8)
    v_mfma_f32_32x32x16_bf16 v[88:103], v[108:111], v[156:159], v[88:103]
    ds_read_b128 v[104:107], v58 offset:3680
    ds_read_b128 v[152:155], v59 offset:560
    s_waitcnt lgkmcnt(8)
    v_mfma_f32_32x32x16_bf16 v[88:103], v[112:115], v[160:163], v[88:103]
    ds_read_b128 v[108:111], v58 offset:3712
    ds_read_b128 v[156:159], v59 offset:512
    s_waitcnt lgkmcnt(8)
    v_mfma_f32_32x32x16_bf16 v[88:103], v[116:119], v[164:167], v[88:103]
    ds_read_b128 v[112:115], v58 offset:3744
    ds_read_b128 v[160:163], v59 offset:480
    s_waitcnt lgkmcnt(8)
    v_mfma_f32_32x32x16_bf16 v[88:103], v[120:123], v[168:171], v[88:103]
    ds_read_b128 v[116:119], v58 offset:3776
    ds_read_b128 v[164:167], v59 offset:432
    s_waitcnt lgkmcnt(8)
    v_mfma_f32_32x32x16_bf16 v[88:103], v[124:127], v[172:175], v[88:103]
    ds_read_b128 v[120:123], v58 offset:3808
    ds_read_b128 v[168:171], v59 offset:400
    s_waitcnt lgkmcnt(8)
    v_mfma_f32_32x32x16_bf16 v[88:103], v[104:107], v[152:155], v[88:103]
    ds_read_b128 v[124:127], v58 offset:3840
    ds_read_b128 v[172:175], v59 offset:352
    s_waitcnt lgkmcnt(8)
    v_mfma_f32_32x32x16_bf16 v[88:103], v[108:111], v[156:159], v[88:103]
    ds_read_b128 v[104:107], v58 offset:3872
    ds_read_b128 v[152:155], v59 offset:320
    s_waitcnt lgkmcnt(8)
    v_mfma_f32_32x32x16_bf16 v[88:103], v[112:115], v[160:163], v[88:103]
    ds_read_b128 v[108:111], v58 offset:3904
    ds_read_b128 v[156:159], v59 offset:272
    s_waitcnt lgkmcnt(8)
    v_mfma_f32_32x32x16_bf16 v[88:103], v[116:119], v[164:167], v[88:103]
    ds_read_b128 v[112:115], v58 offset:3936
    ds_read_b128 v[160:163], v59 offset:240
    s_waitcnt lgkmcnt(8)
    v_mfma_f32_32x32x16_bf16 v[88:103], v[120:123], v[168:171], v[88:103]
    ds_read_b128 v[116:119], v58 offset:3968
    ds_read_b128 v[164:167], v59 offset:192
    s_waitcnt lgkmcnt(8)
    v_mfma_f32_32x32x16_bf16 v[88:103], v[124:127], v[172:175], v[88:103]
    ds_read_b128 v[120:123], v58 offset:4000
    ds_read_b128 v[168:171], v59 offset:160
    s_waitcnt lgkmcnt(8)
    v_mfma_f32_32x32x16_bf16 v[88:103], v[104:107], v[152:155], v[88:103]
    ds_read_b128 v[124:127], v58 offset:4032
    ds_read_b128 v[172:175], v59 offset:112
    s_waitcnt lgkmcnt(8)
    v_mfma_f32_32x32x16_bf16 v[88:103], v[108:111], v[156:159], v[88:103]
    ds_read_b128 v[104:107], v58 offset:4064
    ds_read_b128 v[152:155], v59 offset:80
    s_waitcnt lgkmcnt(8)
    v_mfma_f32_32x32x16_bf16 v[88:103], v[112:115], v[160:163], v[88:103]
    s_waitcnt lgkmcnt(6)
    v_mfma_f32_32x32x16_bf16 v[88:103], v[116:119], v[164:167], v[88:103]
    s_waitcnt lgkmcnt(4)
    v_mfma_f32_32x32x16_bf16 v[88:103], v[120:123], v[168:171], v[88:103]
    s_waitcnt lgkmcnt(2)
    v_mfma_f32_32x32x16_bf16 v[88:103], v[124:127], v[172:175], v[88:103]
    s_waitcnt lgkmcnt(0)
    v_mfma_f32_32x32x16_bf16 v[88:103], v[104:107], v[152:155], v[88:103]
    s_nop 11
    ds_write_b128 v70, v[88:91] offset:27648
    ds_write_b128 v70, v[92:95] offset:27680
    ds_write_b128 v70, v[96:99] offset:27712
    ds_write_b128 v70, v[100:103] offset:27744
c_pw_end_19:
    s_waitcnt lgkmcnt(0)
    s_barrier
    s_cmp_ge_u32 s34, 2
    s_cbranch_scc1 c_finH_24
    ds_read_b128 v[104:107], v71 offset:0
    ds_read_b128 v[108:111], v71 offset:16
    ds_read_b128 v[112:115], v71 offset:4608
    ds_read_b128 v[116:119], v71 offset:4624
    ds_read_b128 v[120:123], v71 offset:9216
    ds_read_b128 v[124:127], v71 offset:9232
    s_waitcnt lgkmcnt(0)
    v_pk_add_f32 v[104:105], v[104:105], v[112:113]
    v_pk_add_f32 v[106:107], v[106:107], v[114:115]
    v_pk_add_f32 v[108:109], v[108:109], v[116:117]
    v_pk_add_f32 v[110:111], v[110:111], v[118:119]
    v_pk_add_f32 v[104:105], v[104:105], v[120:121]
    v_pk_add_f32 v[106:107], v[106:107], v[122:123]
    v_pk_add_f32 v[108:109], v[108:109], v[124:125]
    v_pk_add_f32 v[110:111], v[110:111], v[126:127]
    v_cvt_pk_bf16_f32 v184, v104, v105
    v_cvt_pk_bf16_f32 v185, v106, v107
    v_cvt_pk_bf16_f32 v186, v108, v109
    v_cvt_pk_bf16_f32 v187, v110, v111
    s_lshl_b32 s40, s57, 12
    s_add_u32 s40, s40, 8912896
    v_and_b32 v3, 127, v0
    v_lshlrev_b32 v3, 4, v3
    buffer_store_dwordx4 v[184:187], v3, s[8:11], s40 offen
    s_nop 1
    s_branch c_fin_end_25
c_finH_24:
    ds_read_b128 v[104:107], v71 offset:13824
    ds_read_b128 v[108:111], v71 offset:13840
    ds_read_b128 v[112:115], v71 offset:18432
    ds_read_b128 v[116:119], v71 offset:18448
    ds_read_b128 v[120:123], v71 offset:23040
    ds_read_b128 v[124:127], v71 offset:23056
    ds_read_b128 v[128:131], v71 offset:27648
    ds_read_b128 v[132:135], v71 offset:27664
    s_waitcnt lgkmcnt(0)
    v_pk_add_f32 v[104:105], v[104:105], v[112:113]
    v_pk_add_f32 v[106:107], v[106:107], v[114:115]
    v_pk_add_f32 v[108:109], v[108:109], v[116:117]
    v_pk_add_f32 v[110:111], v[110:111], v[118:119]
    v_pk_add_f32 v[104:105], v[104:105], v[120:121]
    v_pk_add_f32 v[106:107], v[106:107], v[122:123]
    v_pk_add_f32 v[108:109], v[108:109], v[124:125]
    v_pk_add_f32 v[110:111], v[110:111], v[126:127]
    v_pk_add_f32 v[104:105], v[104:105], v[128:129]
    v_pk_add_f32 v[106:107], v[106:107], v[130:131]
    v_pk_add_f32 v[108:109], v[108:109], v[132:133]
    v_pk_add_f32 v[110:111], v[110:111], v[134:135]
    v_cvt_pk_bf16_f32 v184, v104, v105
    v_cvt_pk_bf16_f32 v185, v106, v107
    v_cvt_pk_bf16_f32 v186, v108, v109
    v_cvt_pk_bf16_f32 v187, v110, v111
    s_lshl_b32 s40, s57, 12
    s_add_u32 s40, s40, 8914944
    v_and_b32 v3, 127, v0
    v_lshlrev_b32 v3, 4, v3
    buffer_store_dwordx4 v[184:187], v3, s[8:11], s40 offen
    s_nop 1
c_fin_end_25:
    s_waitcnt vmcnt(0)
    v_cmp_ne_u32 vcc, 0, v0
    s_nop 1
    v_cndmask_b32 v24, 0, v24, vcc
    v_cndmask_b32 v25, 0, v25, vcc
    v_cndmask_b32 v26, 0, v26, vcc
    v_cndmask_b32 v27, 0, v27, vcc
    v_alignbit_b32 v176, v25, v24, 16
    v_alignbit_b32 v177, v26, v25, 16
    v_alignbit_b32 v178, v27, v26, 16
    v_alignbit_b32 v179, v28, v27, 16
    v_alignbit_b32 v180, v29, v28, 16
    v_alignbit_b32 v181, v30, v29, 16
    v_alignbit_b32 v182, v31, v30, 16
    ds_write_b128 v56, v[176:179] offset:0
    v_mov_b32 v184, v25
    v_mov_b32 v185, v26
    v_mov_b32 v186, v27
    v_mov_b32 v187, v28
    ds_write_b128 v56, v[184:187] offset:4160
    s_nop 1
    v_mov_b32 v184, v177
    v_mov_b32 v185, v178
    v_mov_b32 v186, v179
    v_mov_b32 v187, v180
    ds_write_b128 v56, v[184:187] offset:8320
    s_nop 1
    ds_write_b128 v56, v[26:29] offset:12480
    ds_write_b128 v56, v[178:181] offset:16640
    v_mov_b32 v184, v27
    v_mov_b32 v185, v28
    v_mov_b32 v186, v29
    v_mov_b32 v187, v30
    ds_write_b128 v56, v[184:187] offset:20800
    s_nop 1
    v_mov_b32 v184, v179
    v_mov_b32 v185, v180
    v_mov_b32 v186, v181
    v_mov_b32 v187, v182
    ds_write_b128 v56, v[184:187] offset:24960
    s_nop 1
    ds_write_b128 v56, v[28:31] offset:29120
    ds_write_b128 v57, v[40:43]
    v_lshlrev_b32 v3, 16, v46
    v_or_b32 v3, v3, v46
    v_and_b32 v188, v60, v3
    v_and_b32 v189, v61, v3
    v_and_b32 v190, v62, v3
    v_and_b32 v191, v63, v3
    v_and_b32 v192, v64, v3
    v_and_b32 v193, v65, v3
    v_and_b32 v194, v66, v3
    v_and_b32 v195, v67, v3
    s_waitcnt lgkmcnt(0)
    s_barrier
    s_bitcmp1_b32 s2, 0
    s_cbranch_scc1 c_halfL_26
    s_cmp_lg_u32 s34, 0
    s_cbranch_scc1 c_pw_29
    ds_read_b128 v[104:107], v58 offset:0
    ds_read_b128 v[152:155], v59 offset:5152
    ds_read_b128 v[108:111], v58 offset:32
    ds_read_b128 v[156:159], v59 offset:5120
    ds_read_b128 v[112:115], v58 offset:64
    ds_read_b128 v[160:163], v59 offset:5072
    ds_read_b128 v[116:119], v58 offset:96
    ds_read_b128 v[164:167], v59 offset:5040
    ds_read_b128 v[120:123], v58 offset:128
    ds_read_b128 v[168:171], v59 offset:4992
    s_waitcnt lgkmcnt(8)
    v_mfma_f32_32x32x16_bf16 v[88:103], v[104:107], v[152:155], 0
    v_mfma_f32_32x32x16_bf16 v[88:103], v[192:195], v[152:155], v[88:103]
    ds_read_b128 v[124:127], v58 offset:160
    ds_read_b128 v[172:175], v59 offset:4960
    s_waitcnt lgkmcnt(8)
    v_mfma_f32_32x32x16_bf16 v[88:103], v[108:111], v[156:159], v[88:103]
    v_mfma_f32_32x32x16_bf16 v[88:103], v[188:191], v[156:159], v[88:103]
    ds_read_b128 v[104:107], v58 offset:192
    ds_read_b128 v[152:155], v59 offset:4912
    s_waitcnt lgkmcnt(8)
    v_mfma_f32_32x32x16_bf16 v[88:103], v[112:115], v[160:163], v[88:103]
    ds_read_b128 v[108:111], v58 offset:224
    ds_read_b128 v[156:159], v59 offset:4880
    s_waitcnt lgkmcnt(8)
    v_mfma_f32_32x32x16_bf16 v[88:103], v[116:119], v[164:167], v[88:103]
    ds_read_b128 v[112:115], v58 offset:256
    ds_read_b128 v[160:163], v59 offset:4832
    s_waitcnt lgkmcnt(8)
    v_mfma_f32_32x32x16_bf16 v[88:103], v[120:123], v[168:171], v[88:103]
    ds_read_b128 v[116:119], v58 offset:288
    ds_read_b128 v[164:167], v59 offset:4800
    s_waitcnt lgkmcnt(8)
    v_mfma_f32_32x32x16_bf16 v[88:103], v[124:127], v[172:175], v[88:103]
    ds_read_b128 v[120:123], v58 offset:320
    ds_read_b128 v[168:171], v59 offset:4752
    s_waitcnt lgkmcnt(8)
    v_mfma_f32_32x32x16_bf16 v[88:103], v[104:107], v[152:155], v[88:103]
    ds_read_b128 v[124:127], v58 offset:352
    ds_read_b128 v[172:175], v59 offset:4720
    s_waitcnt lgkmcnt(8)
    v_mfma_f32_32x32x16_bf16 v[88:103], v[108:111], v[156:159], v[88:103]
    ds_read_b128 v[104:107], v58 offset:384
    ds_read_b128 v[152:155], v59 offset:4672
    s_waitcnt lgkmcnt(8)
    v_mfma_f32_32x32x16_bf16 v[88:103], v[112:115], v[160:163], v[88:103]
    ds_read_b128 v[108:111], v58 offset:416
    ds_read_b128 v[156:159], v59 offset:4640
    s_waitcnt lgkmcnt(8)
    v_mfma_f32_32x32x16_bf16 v[88:103], v[116:119], v[164:167], v[88:103]
    ds_read_b128 v[112:115], v58 offset:448
    ds_read_b128 v[160:163], v59 offset:4592
    s_waitcnt lgkmcnt(8)
    v_mfma_f32_32x32x16_bf16 v[88:103], v[120:123], v[168:171], v[88:103]
    ds_read_b128 v[116:119], v58 offset:480
    ds_read_b128 v[164:167], v59 offset:4560
    s_waitcnt lgkmcnt(8)
    v_mfma_f32_32x32x16_bf16 v[88:103], v[124:127], v[172:175], v[88:103]
    ds_read_b128 v[120:123], v58 offset:512
    ds_read_b128 v[168:171], v59 offset:4512
    s_waitcnt lgkmcnt(8)
    v_mfma_f32_32x32x16_bf16 v[88:103], v[104:107], v[152:155], v[88:103]
    ds_read_b128 v[124:127], v58 offset:544
    ds_read_b128 v[172:175], v59 offset:4480
    s_waitcnt lgkmcnt(8)
    v_mfma_f32_32x32x16_bf16 v[88:103], v[108:111], v[156:159], v[88:103]
    ds_read_b128 v[104:107], v58 offset:576
    ds_read_b128 v[152:155], v59 offset:4432
    s_waitcnt lgkmcnt(8)
    v_mfma_f32_32x32x16_bf16 v[88:103], v[112:115], v[160:163], v[88:103]
    ds_read_b128 v[108:111], v58 offset:608
    ds_read_b128 v[156:159], v59 offset:4400
    s_waitcnt lgkmcnt(8)
    v_mfma_f32_32x32x16_bf16 v[88:103], v[116:119], v[164:167], v[88:103]
    ds_read_b128 v[112:115], v58 offset:640
    ds_read_b128 v[160:163], v59 offset:4352
    s_waitcnt lgkmcnt(8)
    v_mfma_f32_32x32x16_bf16 v[88:103], v[120:123], v[168:171], v[88:103]
    ds_read_b128 v[116:119], v58 offset:672
    ds_read_b128 v[164:167], v59 offset:4320
    s_waitcnt lgkmcnt(8)
    v_mfma_f32_32x32x16_bf16 v[88:103], v[124:127], v[172:175], v[88:103]
    ds_read_b128 v[120:123], v58 offset:704
    ds_read_b128 v[168:171], v59 offset:4272
    s_waitcnt lgkmcnt(8)
    v_mfma_f32_32x32x16_bf16 v[88:103], v[104:107], v[152:155], v[88:103]
    ds_read_b128 v[124:127], v58 offset:736
    ds_read_b128 v[172:175], v59 offset:4240
    s_waitcnt lgkmcnt(8)
    v_mfma_f32_32x32x16_bf16 v[88:103], v[108:111], v[156:159], v[88:103]
    ds_read_b128 v[104:107], v58 offset:768
    ds_read_b128 v[152:155], v59 offset:4192
    s_waitcnt lgkmcnt(8)
    v_mfma_f32_32x32x16_bf16 v[88:103], v[112:115], v[160:163], v[88:103]
    ds_read_b128 v[108:111], v58 offset:800
    ds_read_b128 v[156:159], v59 offset:4160
    s_waitcnt lgkmcnt(8)
    v_mfma_f32_32x32x16_bf16 v[88:103], v[116:119], v[164:167], v[88:103]
    ds_read_b128 v[112:115], v58 offset:832
    ds_read_b128 v[160:163], v59 offset:4112
    s_waitcnt lgkmcnt(8)
    v_mfma_f32_32x32x16_bf16 v[88:103], v[120:123], v[168:171], v[88:103]
    ds_read_b128 v[116:119], v58 offset:864
    ds_read_b128 v[164:167], v59 offset:4080
    s_waitcnt lgkmcnt(8)
    v_mfma_f32_32x32x16_bf16 v[88:103], v[124:127], v[172:175], v[88:103]
    ds_read_b128 v[120:123], v58 offset:896
    ds_read_b128 v[168:171], v59 offset:4032
    s_waitcnt lgkmcnt(8)
    v_mfma_f32_32x32x16_bf16 v[88:103], v[104:107], v[152:155], v[88:103]
    ds_read_b128 v[124:127], v58 offset:928
    ds_read_b128 v[172:175], v59 offset:4000
    s_waitcnt lgkmcnt(8)
    v_mfma_f32_32x32x16_bf16 v[88:103], v[108:111], v[156:159], v[88:103]
    ds_read_b128 v[104:107], v58 offset:960
    ds_read_b128 v[152:155], v59 offset:3952
    s_waitcnt lgkmcnt(8)
    v_mfma_f32_32x32x16_bf16 v[88:103], v[112:115], v[160:163], v[88:103]
    ds_read_b128 v[108:111], v58 offset:992
    ds_read_b128 v[156:159], v59 offset:3920
    s_waitcnt lgkmcnt(8)
    v_mfma_f32_32x32x16_bf16 v[88:103], v[116:119], v[164:167], v[88:103]
    s_waitcnt lgkmcnt(6)
    v_mfma_f32_32x32x16_bf16 v[88:103], v[120:123], v[168:171], v[88:103]
    s_waitcnt lgkmcnt(4)
    v_mfma_f32_32x32x16_bf16 v[88:103], v[124:127], v[172:175], v[88:103]
    s_waitcnt lgkmcnt(2)
    v_mfma_f32_32x32x16_bf16 v[88:103], v[104:107], v[152:155], v[88:103]
    s_waitcnt lgkmcnt(0)
    v_mfma_f32_32x32x16_bf16 v[88:103], v[108:111], v[156:159], v[88:103]
    s_nop 11
    ds_write_b128 v70, v[88:91] offset:13824
    ds_write_b128 v70, v[92:95] offset:13856
    ds_write_b128 v70, v[96:99] offset:13888
    ds_write_b128 v70, v[100:103] offset:13920
    s_branch c_pw_end_28
c_pw_29:
    s_cmp_lg_u32 s34, 1
    s_cbranch_scc1 c_pw_30
    ds_read_b128 v[104:107], v58 offset:1024
    ds_read_b128 v[152:155], v59 offset:3872
    ds_read_b128 v[108:111], v58 offset:1056
    ds_read_b128 v[156:159], v59 offset:3840
    ds_read_b128 v[112:115], v58 offset:1088
    ds_read_b128 v[160:163], v59 offset:3792
    ds_read_b128 v[116:119], v58 offset:1120
    ds_read_b128 v[164:167], v59 offset:3760
    ds_read_b128 v[120:123], v58 offset:1152
    ds_read_b128 v[168:171], v59 offset:3712
    s_waitcnt lgkmcnt(8)
    v_mfma_f32_32x32x16_bf16 v[88:103], v[104:107], v[152:155], 0
    ds_read_b128 v[124:127], v58 offset:1184
    ds_read_b128 v[172:175], v59 offset:3680
    s_waitcnt lgkmcnt(8)
    v_mfma_f32_32x32x16_bf16 v[88:103], v[108:111], v[156:159], v[88:103]
    ds_read_b128 v[104:107], v58 offset:1216
    ds_read_b128 v[152:155], v59 offset:3632
    s_waitcnt lgkmcnt(8)
    v_mfma_f32_32x32x16_bf16 v[88:103], v[112:115], v[160:163], v[88:103]
    ds_read_b128 v[108:111], v58 offset:1248
    ds_read_b128 v[156:159], v59 offset:3600
    s_waitcnt lgkmcnt(8)
    v_mfma_f32_32x32x16_bf16 v[88:103], v[116:119], v[164:167], v[88:103]
    ds_read_b128 v[112:115], v58 offset:1280
    ds_read_b128 v[160:163], v59 offset:3552
    s_waitcnt lgkmcnt(8)
    v_mfma_f32_32x32x16_bf16 v[88:103], v[120:123], v[168:171], v[88:103]
    ds_read_b128 v[116:119], v58 offset:1312
    ds_read_b128 v[164:167], v59 offset:3520
    s_waitcnt lgkmcnt(8)
    v_mfma_f32_32x32x16_bf16 v[88:103], v[124:127], v[172:175], v[88:103]
    ds_read_b128 v[120:123], v58 offset:1344
    ds_read_b128 v[168:171], v59 offset:3472
    s_waitcnt lgkmcnt(8)
    v_mfma_f32_32x32x16_bf16 v[88:103], v[104:107], v[152:155], v[88:103]
    ds_read_b128 v[124:127], v58 offset:1376
    ds_read_b128 v[172:175], v59 offset:3440
    s_waitcnt lgkmcnt(8)
    v_mfma_f32_32x32x16_bf16 v[88:103], v[108:111], v[156:159], v[88:103]
    ds_read_b128 v[104:107], v58 offset:1408
    ds_read_b128 v[152:155], v59 offset:3392
    s_waitcnt lgkmcnt(8)
    v_mfma_f32_32x32x16_bf16 v[88:103], v[112:115], v[160:163], v[88:103]
    ds_read_b128 v[108:111], v58 offset:1440
    ds_read_b128 v[156:159], v59 offset:3360
    s_waitcnt lgkmcnt(8)
    v_mfma_f32_32x32x16_bf16 v[88:103], v[116:119], v[164:167], v[88:103]
    ds_read_b128 v[112:115], v58 offset:1472
    ds_read_b128 v[160:163], v59 offset:3312
    s_waitcnt lgkmcnt(8)
    v_mfma_f32_32x32x16_bf16 v[88:103], v[120:123], v[168:171], v[88:103]
    ds_read_b128 v[116:119], v58 offset:1504
    ds_read_b128 v[164:167], v59 offset:3280
    s_waitcnt lgkmcnt(8)
    v_mfma_f32_32x32x16_bf16 v[88:103], v[124:127], v[172:175], v[88:103]
    ds_read_b128 v[120:123], v58 offset:1536
    ds_read_b128 v[168:171], v59 offset:3232
    s_waitcnt lgkmcnt(8)
    v_mfma_f32_32x32x16_bf16 v[88:103], v[104:107], v[152:155], v[88:103]
    ds_read_b128 v[124:127], v58 offset:1568
    ds_read_b128 v[172:175], v59 offset:3200
    s_waitcnt lgkmcnt(8)
    v_mfma_f32_32x32x16_bf16 v[88:103], v[108:111], v[156:159], v[88:103]
    ds_read_b128 v[104:107], v58 offset:1600
    ds_read_b128 v[152:155], v59 offset:3152
    s_waitcnt lgkmcnt(8)
    v_mfma_f32_32x32x16_bf16 v[88:103], v[112:115], v[160:163], v[88:103]
    ds_read_b128 v[108:111], v58 offset:1632
    ds_read_b128 v[156:159], v59 offset:3120
    s_waitcnt lgkmcnt(8)
    v_mfma_f32_32x32x16_bf16 v[88:103], v[116:119], v[164:167], v[88:103]
    ds_read_b128 v[112:115], v58 offset:1664
    ds_read_b128 v[160:163], v59 offset:3072
    s_waitcnt lgkmcnt(8)
    v_mfma_f32_32x32x16_bf16 v[88:103], v[120:123], v[168:171], v[88:103]
    ds_read_b128 v[116:119], v58 offset:1696
    ds_read_b128 v[164:167], v59 offset:3040
    s_waitcnt lgkmcnt(8)
    v_mfma_f32_32x32x16_bf16 v[88:103], v[124:127], v[172:175], v[88:103]
    ds_read_b128 v[120:123], v58 offset:1728
    ds_read_b128 v[168:171], v59 offset:2992
    s_waitcnt lgkmcnt(8)
    v_mfma_f32_32x32x16_bf16 v[88:103], v[104:107], v[152:155], v[88:103]
    ds_read_b128 v[124:127], v58 offset:1760
    ds_read_b128 v[172:175], v59 offset:2960
    s_waitcnt lgkmcnt(8)
    v_mfma_f32_32x32x16_bf16 v[88:103], v[108:111], v[156:159], v[88:103]
    ds_read_b128 v[104:107], v58 offset:1792
    ds_read_b128 v[152:155], v59 offset:2912
    s_waitcnt lgkmcnt(8)
    v_mfma_f32_32x32x16_bf16 v[88:103], v[112:115], v[160:163], v[88:103]
    ds_read_b128 v[108:111], v58 offset:1824
    ds_read_b128 v[156:159], v59 offset:2880
    s_waitcnt lgkmcnt(8)
    v_mfma_f32_32x32x16_bf16 v[88:103], v[116:119], v[164:167], v[88:103]
    ds_read_b128 v[112:115], v58 offset:1856
    ds_read_b128 v[160:163], v59 offset:2832
    s_waitcnt lgkmcnt(8)
    v_mfma_f32_32x32x16_bf16 v[88:103], v[120:123], v[168:171], v[88:103]
    ds_read_b128 v[116:119], v58 offset:1888
    ds_read_b128 v[164:167], v59 offset:2800
    s_waitcnt lgkmcnt(8)
    v_mfma_f32_32x32x16_bf16 v[88:103], v[124:127], v[172:175], v[88:103]
    ds_read_b128 v[120:123], v58 offset:1920
    ds_read_b128 v[168:171], v59 offset:2752
    s_waitcnt lgkmcnt(8)
    v_mfma_f32_32x32x16_bf16 v[88:103], v[104:107], v[152:155], v[88:103]
    ds_read_b128 v[124:127], v58 offset:1952
    ds_read_b128 v[172:175], v59 offset:2720
    s_waitcnt lgkmcnt(8)
    v_mfma_f32_32x32x16_bf16 v[88:103], v[108:111], v[156:159], v[88:103]
    ds_read_b128 v[104:107], v58 offset:1984
    ds_read_b128 v[152:155], v59 offset:2672
    s_waitcnt lgkmcnt(8)
    v_mfma_f32_32x32x16_bf16 v[88:103], v[112:115], v[160:163], v[88:103]
    ds_read_b128 v[108:111], v58 offset:2016
    ds_read_b128 v[156:159], v59 offset:2640
    s_waitcnt lgkmcnt(8)
    v_mfma_f32_32x32x16_bf16 v[88:103], v[116:119], v[164:167], v[88:103]
    s_waitcnt lgkmcnt(6)
    v_mfma_f32_32x32x16_bf16 v[88:103], v[120:123], v[168:171], v[88:103]
    s_waitcnt lgkmcnt(4)
    v_mfma_f32_32x32x16_bf16 v[88:103], v[124:127], v[172:175], v[88:103]
    s_waitcnt lgkmcnt(2)
    v_mfma_f32_32x32x16_bf16 v[88:103], v[104:107], v[152:155], v[88:103]
    s_waitcnt lgkmcnt(0)
    v_mfma_f32_32x32x16_bf16 v[88:103], v[108:111], v[156:159], v[88:103]
    s_nop 11
    ds_write_b128 v70, v[88:91] offset:18432
    ds_write_b128 v70, v[92:95] offset:18464
    ds_write_b128 v70, v[96:99] offset:18496
    ds_write_b128 v70, v[100:103] offset:18528
    s_branch c_pw_end_28
c_pw_30:
    s_cmp_lg_u32 s34, 2
    s_cbranch_scc1 c_pw_31
    ds_read_b128 v[104:107], v58 offset:2048
    ds_read_b128 v[152:155], v59 offset:2592
    ds_read_b128 v[108:111], v58 offset:2080
    ds_read_b128 v[156:159], v59 offset:2560
    ds_read_b128 v[112:115], v58 offset:2112
    ds_read_b128 v[160:163], v59 offset:2512
    ds_read_b128 v[116:119], v58 offset:2144
    ds_read_b128 v[164:167], v59 offset:2480
    ds_read_b128 v[120:123], v58 offset:2176
    ds_read_b128 v[168:171], v59 offset:2432
    s_waitcnt lgkmcnt(8)
    v_mfma_f32_32x32x16_bf16 v[88:103], v[104:107], v[152:155], 0
    ds_read_b128 v[124:127], v58 offset:2208
    ds_read_b128 v[172:175], v59 offset:2400
    s_waitcnt lgkmcnt(8)
    v_mfma_f32_32x32x16_bf16 v[88:103], v[108:111], v[156:159], v[88:103]
    ds_read_b128 v[104:107], v58 offset:2240
    ds_read_b128 v[152:155], v59 offset:2352
    s_waitcnt lgkmcnt(8)
    v_mfma_f32_32x32x16_bf16 v[88:103], v[112:115], v[160:163], v[88:103]
    ds_read_b128 v[108:111], v58 offset:2272
    ds_read_b128 v[156:159], v59 offset:2320
    s_waitcnt lgkmcnt(8)
    v_mfma_f32_32x32x16_bf16 v[88:103], v[116:119], v[164:167], v[88:103]
    ds_read_b128 v[112:115], v58 offset:2304
    ds_read_b128 v[160:163], v59 offset:2272
    s_waitcnt lgkmcnt(8)
    v_mfma_f32_32x32x16_bf16 v[88:103], v[120:123], v[168:171], v[88:103]
    ds_read_b128 v[116:119], v58 offset:2336
    ds_read_b128 v[164:167], v59 offset:2240
    s_waitcnt lgkmcnt(8)
    v_mfma_f32_32x32x16_bf16 v[88:103], v[124:127], v[172:175], v[88:103]
    ds_read_b128 v[120:123], v58 offset:2368
    ds_read_b128 v[168:171], v59 offset:2192
    s_waitcnt lgkmcnt(8)
    v_mfma_f32_32x32x16_bf16 v[88:103], v[104:107], v[152:155], v[88:103]
    ds_read_b128 v[124:127], v58 offset:2400
    ds_read_b128 v[172:175], v59 offset:2160
    s_waitcnt lgkmcnt(8)
    v_mfma_f32_32x32x16_bf16 v[88:103], v[108:111], v[156:159], v[88:103]
    ds_read_b128 v[104:107], v58 offset:2432
    ds_read_b128 v[152:155], v59 offset:2112
    s_waitcnt lgkmcnt(8)
    v_mfma_f32_32x32x16_bf16 v[88:103], v[112:115], v[160:163], v[88:103]
    ds_read_b128 v[108:111], v58 offset:2464
    ds_read_b128 v[156:159], v59 offset:2080
    s_waitcnt lgkmcnt(8)
    v_mfma_f32_32x32x16_bf16 v[88:103], v[116:119], v[164:167], v[88:103]
    ds_read_b128 v[112:115], v58 offset:2496
    ds_read_b128 v[160:163], v59 offset:2032
    s_waitcnt lgkmcnt(8)
    v_mfma_f32_32x32x16_bf16 v[88:103], v[120:123], v[168:171], v[88:103]
    ds_read_b128 v[116:119], v58 offset:2528
    ds_read_b128 v[164:167], v59 offset:2000
    s_waitcnt lgkmcnt(8)
    v_mfma_f32_32x32x16_bf16 v[88:103], v[124:127], v[172:175], v[88:103]
    ds_read_b128 v[120:123], v58 offset:2560
    ds_read_b128 v[168:171], v59 offset:1952
    s_waitcnt lgkmcnt(8)
    v_mfma_f32_32x32x16_bf16 v[88:103], v[104:107], v[152:155], v[88:103]
    ds_read_b128 v[124:127], v58 offset:2592
    ds_read_b128 v[172:175], v59 offset:1920
    s_waitcnt lgkmcnt(8)
    v_mfma_f32_32x32x16_bf16 v[88:103], v[108:111], v[156:159], v[88:103]
    ds_read_b128 v[104:107], v58 offset:2624
    ds_read_b128 v[152:155], v59 offset:1872
    s_waitcnt lgkmcnt(8)
    v_mfma_f32_32x32x16_bf16 v[88:103], v[112:115], v[160:163], v[88:103]
    ds_read_b128 v[108:111], v58 offset:2656
    ds_read_b128 v[156:159], v59 offset:1840
    s_waitcnt lgkmcnt(8)
    v_mfma_f32_32x32x16_bf16 v[88:103], v[116:119], v[164:167], v[88:103]
    ds_read_b128 v[112:115], v58 offset:2688
    ds_read_b128 v[160:163], v59 offset:1792
    s_waitcnt lgkmcnt(8)
    v_mfma_f32_32x32x16_bf16 v[88:103], v[120:123], v[168:171], v[88:103]
    ds_read_b128 v[116:119], v58 offset:2720
    ds_read_b128 v[164:167], v59 offset:1760
    s_waitcnt lgkmcnt(8)
    v_mfma_f32_32x32x16_bf16 v[88:103], v[124:127], v[172:175], v[88:103]
    ds_read_b128 v[120:123], v58 offset:2752
    ds_read_b128 v[168:171], v59 offset:1712
    s_waitcnt lgkmcnt(8)
    v_mfma_f32_32x32x16_bf16 v[88:103], v[104:107], v[152:155], v[88:103]
    ds_read_b128 v[124:127], v58 offset:2784
    ds_read_b128 v[172:175], v59 offset:1680
    s_waitcnt lgkmcnt(8)
    v_mfma_f32_32x32x16_bf16 v[88:103], v[108:111], v[156:159], v[88:103]
    ds_read_b128 v[104:107], v58 offset:2816
    ds_read_b128 v[152:155], v59 offset:1632
    s_waitcnt lgkmcnt(8)
    v_mfma_f32_32x32x16_bf16 v[88:103], v[112:115], v[160:163], v[88:103]
    ds_read_b128 v[108:111], v58 offset:2848
    ds_read_b128 v[156:159], v59 offset:1600
    s_waitcnt lgkmcnt(8)
    v_mfma_f32_32x32x16_bf16 v[88:103], v[116:119], v[164:167], v[88:103]
    ds_read_b128 v[112:115], v58 offset:2880
    ds_read_b128 v[160:163], v59 offset:1552
    s_waitcnt lgkmcnt(8)
    v_mfma_f32_32x32x16_bf16 v[88:103], v[120:123], v[168:171], v[88:103]
    ds_read_b128 v[116:119], v58 offset:2912
    ds_read_b128 v[164:167], v59 offset:1520
    s_waitcnt lgkmcnt(8)
    v_mfma_f32_32x32x16_bf16 v[88:103], v[124:127], v[172:175], v[88:103]
    ds_read_b128 v[120:123], v58 offset:2944
    ds_read_b128 v[168:171], v59 offset:1472
    s_waitcnt lgkmcnt(8)
    v_mfma_f32_32x32x16_bf16 v[88:103], v[104:107], v[152:155], v[88:103]
    ds_read_b128 v[124:127], v58 offset:2976
    ds_read_b128 v[172:175], v59 offset:1440
    s_waitcnt lgkmcnt(8)
    v_mfma_f32_32x32x16_bf16 v[88:103], v[108:111], v[156:159], v[88:103]
    ds_read_b128 v[104:107], v58 offset:3008
    ds_read_b128 v[152:155], v59 offset:1392
    s_waitcnt lgkmcnt(8)
    v_mfma_f32_32x32x16_bf16 v[88:103], v[112:115], v[160:163], v[88:103]
    ds_read_b128 v[108:111], v58 offset:3040
    ds_read_b128 v[156:159], v59 offset:1360
    s_waitcnt lgkmcnt(8)
    v_mfma_f32_32x32x16_bf16 v[88:103], v[116:119], v[164:167], v[88:103]
    s_waitcnt lgkmcnt(6)
    v_mfma_f32_32x32x16_bf16 v[88:103], v[120:123], v[168:171], v[88:103]
    s_waitcnt lgkmcnt(4)
    v_mfma_f32_32x32x16_bf16 v[88:103], v[124:127], v[172:175], v[88:103]
    s_waitcnt lgkmcnt(2)
    v_mfma_f32_32x32x16_bf16 v[88:103], v[104:107], v[152:155], v[88:103]
    s_waitcnt lgkmcnt(0)
    v_mfma_f32_32x32x16_bf16 v[88:103], v[108:111], v[156:159], v[88:103]
    s_nop 11
    ds_write_b128 v70, v[88:91] offset:23040
    ds_write_b128 v70, v[92:95] offset:23072
    ds_write_b128 v70, v[96:99] offset:23104
    ds_write_b128 v70, v[100:103] offset:23136
    s_branch c_pw_end_28
c_pw_31:
    ds_read_b128 v[104:107], v58 offset:3072
    ds_read_b128 v[152:155], v59 offset:1312
    ds_read_b128 v[108:111], v58 offset:3104
    ds_read_b128 v[156:159], v59 offset:1280
    ds_read_b128 v[112:115], v58 offset:3136
    ds_read_b128 v[160:163], v59 offset:1232
    ds_read_b128 v[116:119], v58 offset:3168
    ds_read_b128 v[164:167], v59 offset:1200
    ds_read_b128 v[120:123], v58 offset:3200
    ds_read_b128 v[168:171], v59 offset:1152
    s_waitcnt lgkmcnt(8)
    v_mfma_f32_32x32x16_bf16 v[88:103], v[104:107], v[152:155], 0
    ds_read_b128 v[124:127], v58 offset:3232
    ds_read_b128 v[172:175], v59 offset:1120
    s_waitcnt lgkmcnt(8)
    v_mfma_f32_32x32x16_bf16 v[88:103], v[108:111], v[156:159], v[88:103]
    ds_read_b128 v[104:107], v58 offset:3264
    ds_read_b128 v[152:155], v59 offset:1072
    s_waitcnt lgkmcnt(8)
    v_mfma_f32_32x32x16_bf16 v[88:103], v[112:115], v[160:163], v[88:103]
    ds_read_b128 v[108:111], v58 offset:3296
    ds_read_b128 v[156:159], v59 offset:1040
    s_waitcnt lgkmcnt(8)
    v_mfma_f32_32x32x16_bf16 v[88:103], v[116:119], v[164:167], v[88:103]
    ds_read_b128 v[112:115], v58 offset:3328
    ds_read_b128 v[160:163], v59 offset:992
    s_waitcnt lgkmcnt(8)
    v_mfma_f32_32x32x16_bf16 v[88:103], v[120:123], v[168:171], v[88:103]
    ds_read_b128 v[116:119], v58 offset:3360
    ds_read_b128 v[164:167], v59 offset:960
    s_waitcnt lgkmcnt(8)
    v_mfma_f32_32x32x16_bf16 v[88:103], v[124:127], v[172:175], v[88:103]
    ds_read_b128 v[120:123], v58 offset:3392
    ds_read_b128 v[168:171], v59 offset:912
    s_waitcnt lgkmcnt(8)
    v_mfma_f32_32x32x16_bf16 v[88:103], v[104:107], v[152:155], v[88:103]
    ds_read_b128 v[124:127], v58 offset:3424
    ds_read_b128 v[172:175], v59 offset:880
    s_waitcnt lgkmcnt(8)
    v_mfma_f32_32x32x16_bf16 v[88:103], v[108:111], v[156:159], v[88:103]
    ds_read_b128 v[104:107], v58 offset:3456
    ds_read_b128 v[152:155], v59 offset:832
    s_waitcnt lgkmcnt(8)
    v_mfma_f32_32x32x16_bf16 v[88:103], v[112:115], v[160:163], v[88:103]
    ds_read_b128 v[108:111], v58 offset:3488
    ds_read_b128 v[156:159], v59 offset:800
    s_waitcnt lgkmcnt(8)
    v_mfma_f32_32x32x16_bf16 v[88:103], v[116:119], v[164:167], v[88:103]
    ds_read_b128 v[112:115], v58 offset:3520
    ds_read_b128 v[160:163], v59 offset:752
    s_waitcnt lgkmcnt(8)
    v_mfma_f32_32x32x16_bf16 v[88:103], v[120:123], v[168:171], v[88:103]
    ds_read_b128 v[116:119], v58 offset:3552
    ds_read_b128 v[164:167], v59 offset:720
    s_waitcnt lgkmcnt(8)
    v_mfma_f32_32x32x16_bf16 v[88:103], v[124:127], v[172:175], v[88:103]
    ds_read_b128 v[120:123], v58 offset:3584
    ds_read_b128 v[168:171], v59 offset:672
    s_waitcnt lgkmcnt(8)
    v_mfma_f32_32x32x16_bf16 v[88:103], v[104:107], v[152:155], v[88:103]
    ds_read_b128 v[124:127], v58 offset:3616
    ds_read_b128 v[172:175], v59 offset:640
    s_waitcnt lgkmcnt(8)
    v_mfma_f32_32x32x16_bf16 v[88:103], v[108:111], v[156:159], v[88:103]
    ds_read_b128 v[104:107], v58 offset:3648
    ds_read_b128 v[152:155], v59 offset:592
    s_waitcnt lgkmcnt(8)
    v_mfma_f32_32x32x16_bf16 v[88:103], v[112:115], v[160:163], v[88:103]
    ds_read_b128 v[108:111], v58 offset:3680
    ds_read_b128 v[156:159], v59 offset:560
    s_waitcnt lgkmcnt(8)
    v_mfma_f32_32x32x16_bf16 v[88:103], v[116:119], v[164:167], v[88:103]
    ds_read_b128 v[112:115], v58 offset:3712
    ds_read_b128 v[160:163], v59 offset:512
    s_waitcnt lgkmcnt(8)
    v_mfma_f32_32x32x16_bf16 v[88:103], v[120:123], v[168:171], v[88:103]
    ds_read_b128 v[116:119], v58 offset:3744
    ds_read_b128 v[164:167], v59 offset:480
    s_waitcnt lgkmcnt(8)
    v_mfma_f32_32x32x16_bf16 v[88:103], v[124:127], v[172:175], v[88:103]
    ds_read_b128 v[120:123], v58 offset:3776
    ds_read_b128 v[168:171], v59 offset:432
    s_waitcnt lgkmcnt(8)
    v_mfma_f32_32x32x16_bf16 v[88:103], v[104:107], v[152:155], v[88:103]
    ds_read_b128 v[124:127], v58 offset:3808
    ds_read_b128 v[172:175], v59 offset:400
    s_waitcnt lgkmcnt(8)
    v_mfma_f32_32x32x16_bf16 v[88:103], v[108:111], v[156:159], v[88:103]
    ds_read_b128 v[104:107], v58 offset:3840
    ds_read_b128 v[152:155], v59 offset:352
    s_waitcnt lgkmcnt(8)
    v_mfma_f32_32x32x16_bf16 v[88:103], v[112:115], v[160:163], v[88:103]
    ds_read_b128 v[108:111], v58 offset:3872
    ds_read_b128 v[156:159], v59 offset:320
    s_waitcnt lgkmcnt(8)
    v_mfma_f32_32x32x16_bf16 v[88:103], v[116:119], v[164:167], v[88:103]
    ds_read_b128 v[112:115], v58 offset:3904
    ds_read_b128 v[160:163], v59 offset:272
    s_waitcnt lgkmcnt(8)
    v_mfma_f32_32x32x16_bf16 v[88:103], v[120:123], v[168:171], v[88:103]
    ds_read_b128 v[116:119], v58 offset:3936
    ds_read_b128 v[164:167], v59 offset:240
    s_waitcnt lgkmcnt(8)
    v_mfma_f32_32x32x16_bf16 v[88:103], v[124:127], v[172:175], v[88:103]
    ds_read_b128 v[120:123], v58 offset:3968
    ds_read_b128 v[168:171], v59 offset:192
    s_waitcnt lgkmcnt(8)
    v_mfma_f32_32x32x16_bf16 v[88:103], v[104:107], v[152:155], v[88:103]
    ds_read_b128 v[124:127], v58 offset:4000
    ds_read_b128 v[172:175], v59 offset:160
    s_waitcnt lgkmcnt(8)
    v_mfma_f32_32x32x16_bf16 v[88:103], v[108:111], v[156:159], v[88:103]
    ds_read_b128 v[104:107], v58 offset:4032
    ds_read_b128 v[152:155], v59 offset:112
    s_waitcnt lgkmcnt(8)
    v_mfma_f32_32x32x16_bf16 v[88:103], v[112:115], v[160:163], v[88:103]
    ds_read_b128 v[108:111], v58 offset:4064
    ds_read_b128 v[156:159], v59 offset:80
    s_waitcnt lgkmcnt(8)
    v_mfma_f32_32x32x16_bf16 v[88:103], v[116:119], v[164:167], v[88:103]
    s_waitcnt lgkmcnt(6)
    v_mfma_f32_32x32x16_bf16 v[88:103], v[120:123], v[168:171], v[88:103]
    s_waitcnt lgkmcnt(4)
    v_mfma_f32_32x32x16_bf16 v[88:103], v[124:127], v[172:175], v[88:103]
    s_waitcnt lgkmcnt(2)
    v_mfma_f32_32x32x16_bf16 v[88:103], v[104:107], v[152:155], v[88:103]
    s_waitcnt lgkmcnt(0)
    v_mfma_f32_32x32x16_bf16 v[88:103], v[108:111], v[156:159], v[88:103]
    s_nop 11
    ds_write_b128 v70, v[88:91] offset:27648
    ds_write_b128 v70, v[92:95] offset:27680
    ds_write_b128 v70, v[96:99] offset:27712
    ds_write_b128 v70, v[100:103] offset:27744
c_pw_end_28:
    s_waitcnt lgkmcnt(0)
    s_barrier
    s_cmp_ge_u32 s34, 2
    s_cbranch_scc1 c_hf_33
    ds_read_b128 v[104:107], v71 offset:13824
    ds_read_b128 v[108:111], v71 offset:13840
    ds_read_b128 v[112:115], v71 offset:18432
    ds_read_b128 v[116:119], v71 offset:18448
    ds_read_b128 v[120:123], v71 offset:23040
    ds_read_b128 v[124:127], v71 offset:23056
    ds_read_b128 v[128:131], v71 offset:27648
    ds_read_b128 v[132:135], v71 offset:27664
    s_waitcnt lgkmcnt(0)
    v_pk_add_f32 v[104:105], v[104:105], v[112:113]
    v_pk_add_f32 v[106:107], v[106:107], v[114:115]
    v_pk_add_f32 v[108:109], v[108:109], v[116:117]
    v_pk_add_f32 v[110:111], v[110:111], v[118:119]
    v_pk_add_f32 v[104:105], v[104:105], v[120:121]
    v_pk_add_f32 v[106:107], v[106:107], v[122:123]
    v_pk_add_f32 v[108:109], v[108:109], v[124:125]
    v_pk_add_f32 v[110:111], v[110:111], v[126:127]
    v_pk_add_f32 v[104:105], v[104:105], v[128:129]
    v_pk_add_f32 v[106:107], v[106:107], v[130:131]
    v_pk_add_f32 v[108:109], v[108:109], v[132:133]
    v_pk_add_f32 v[110:111], v[110:111], v[134:135]
    v_cvt_pk_bf16_f32 v184, v104, v105
    v_cvt_pk_bf16_f32 v185, v106, v107
    v_cvt_pk_bf16_f32 v186, v108, v109
    v_cvt_pk_bf16_f32 v187, v110, v111
    s_lshl_b32 s40, s58, 12
    s_add_u32 s40, s40, 8914944
    v_and_b32 v3, 127, v0
    v_lshlrev_b32 v3, 4, v3
    buffer_store_dwordx4 v[184:187], v3, s[8:11], s40 offen
    s_nop 1
c_hf_33:
    s_branch c_halfE_27
c_halfL_26:
    s_cmp_lg_u32 s34, 0
    s_cbranch_scc1 c_pw_35
    ds_read_b128 v[104:107], v58 offset:0
    ds_read_b128 v[128:131], v59 offset:2592
    ds_read_b128 v[108:111], v58 offset:32
    ds_read_b128 v[132:135], v59 offset:2560
    ds_read_b128 v[112:115], v58 offset:64
    ds_read_b128 v[136:139], v59 offset:2512
    ds_read_b128 v[116:119], v58 offset:96
    ds_read_b128 v[140:143], v59 offset:2480
    ds_read_b128 v[120:123], v58 offset:128
    ds_read_b128 v[144:147], v59 offset:2432
    s_waitcnt lgkmcnt(8)
    v_mfma_f32_32x32x16_bf16 v[72:87], v[104:107], v[128:131], 0
    v_mfma_f32_32x32x16_bf16 v[72:87], v[192:195], v[128:131], v[72:87]
    ds_read_b128 v[124:127], v58 offset:160
    ds_read_b128 v[148:151], v59 offset:2400
    s_waitcnt lgkmcnt(8)
    v_mfma_f32_32x32x16_bf16 v[72:87], v[108:111], v[132:135], v[72:87]
    v_mfma_f32_32x32x16_bf16 v[72:87], v[188:191], v[132:135], v[72:87]
    ds_read_b128 v[104:107], v58 offset:192
    ds_read_b128 v[128:131], v59 offset:2352
    s_waitcnt lgkmcnt(8)
    v_mfma_f32_32x32x16_bf16 v[72:87], v[112:115], v[136:139], v[72:87]
    ds_read_b128 v[108:111], v58 offset:224
    ds_read_b128 v[132:135], v59 offset:2320
    s_waitcnt lgkmcnt(8)
    v_mfma_f32_32x32x16_bf16 v[72:87], v[116:119], v[140:143], v[72:87]
    ds_read_b128 v[112:115], v58 offset:256
    ds_read_b128 v[136:139], v59 offset:2272
    s_waitcnt lgkmcnt(8)
    v_mfma_f32_32x32x16_bf16 v[72:87], v[120:123], v[144:147], v[72:87]
    ds_read_b128 v[116:119], v58 offset:288
    ds_read_b128 v[140:143], v59 offset:2240
    s_waitcnt lgkmcnt(8)
    v_mfma_f32_32x32x16_bf16 v[72:87], v[124:127], v[148:151], v[72:87]
    ds_read_b128 v[120:123], v58 offset:320
    ds_read_b128 v[144:147], v59 offset:2192
    s_waitcnt lgkmcnt(8)
    v_mfma_f32_32x32x16_bf16 v[72:87], v[104:107], v[128:131], v[72:87]
    ds_read_b128 v[124:127], v58 offset:352
    ds_read_b128 v[148:151], v59 offset:2160
    s_waitcnt lgkmcnt(8)
    v_mfma_f32_32x32x16_bf16 v[72:87], v[108:111], v[132:135], v[72:87]
    ds_read_b128 v[104:107], v58 offset:384
    ds_read_b128 v[128:131], v59 offset:2112
    s_waitcnt lgkmcnt(8)
    v_mfma_f32_32x32x16_bf16 v[72:87], v[112:115], v[136:139], v[72:87]
    ds_read_b128 v[108:111], v58 offset:416
    ds_read_b128 v[132:135], v59 offset:2080
    s_waitcnt lgkmcnt(8)
    v_mfma_f32_32x32x16_bf16 v[72:87], v[116:119], v[140:143], v[72:87]
    ds_read_b128 v[112:115], v58 offset:448
    ds_read_b128 v[136:139], v59 offset:2032
    s_waitcnt lgkmcnt(8)
    v_mfma_f32_32x32x16_bf16 v[72:87], v[120:123], v[144:147], v[72:87]
    ds_read_b128 v[116:119], v58 offset:480
    ds_read_b128 v[140:143], v59 offset:2000
    s_waitcnt lgkmcnt(8)
    v_mfma_f32_32x32x16_bf16 v[72:87], v[124:127], v[148:151], v[72:87]
    s_waitcnt lgkmcnt(6)
    v_mfma_f32_32x32x16_bf16 v[72:87], v[104:107], v[128:131], v[72:87]
    s_waitcnt lgkmcnt(4)
    v_mfma_f32_32x32x16_bf16 v[72:87], v[108:111], v[132:135], v[72:87]
    s_waitcnt lgkmcnt(2)
    v_mfma_f32_32x32x16_bf16 v[72:87], v[112:115], v[136:139], v[72:87]
    s_waitcnt lgkmcnt(0)
    v_mfma_f32_32x32x16_bf16 v[72:87], v[116:119], v[140:143], v[72:87]
    s_nop 11
    ds_write_b128 v70, v[72:75] offset:13824
    ds_write_b128 v70, v[76:79] offset:13856
    ds_write_b128 v70, v[80:83] offset:13888
    ds_write_b128 v70, v[84:87] offset:13920
    s_branch c_pw_end_34
c_pw_35:
    s_cmp_lg_u32 s34, 1
    s_cbranch_scc1 c_pw_36
    ds_read_b128 v[104:107], v58 offset:512
    ds_read_b128 v[128:131], v59 offset:1952
    ds_read_b128 v[108:111], v58 offset:544
    ds_read_b128 v[132:135], v59 offset:1920
    ds_read_b128 v[112:115], v58 offset:576
    ds_read_b128 v[136:139], v59 offset:1872
    ds_read_b128 v[116:119], v58 offset:608
    ds_read_b128 v[140:143], v59 offset:1840
    ds_read_b128 v[120:123], v58 offset:640
    ds_read_b128 v[144:147], v59 offset:1792
    s_waitcnt lgkmcnt(8)
    v_mfma_f32_32x32x16_bf16 v[72:87], v[104:107], v[128:131], 0
    ds_read_b128 v[124:127], v58 offset:672
    ds_read_b128 v[148:151], v59 offset:1760
    s_waitcnt lgkmcnt(8)
    v_mfma_f32_32x32x16_bf16 v[72:87], v[108:111], v[132:135], v[72:87]
    ds_read_b128 v[104:107], v58 offset:704
    ds_read_b128 v[128:131], v59 offset:1712
    s_waitcnt lgkmcnt(8)
    v_mfma_f32_32x32x16_bf16 v[72:87], v[112:115], v[136:139], v[72:87]
    ds_read_b128 v[108:111], v58 offset:736
    ds_read_b128 v[132:135], v59 offset:1680
    s_waitcnt lgkmcnt(8)
    v_mfma_f32_32x32x16_bf16 v[72:87], v[116:119], v[140:143], v[72:87]
    ds_read_b128 v[112:115], v58 offset:768
    ds_read_b128 v[136:139], v59 offset:1632
    s_waitcnt lgkmcnt(8)
    v_mfma_f32_32x32x16_bf16 v[72:87], v[120:123], v[144:147], v[72:87]
    ds_read_b128 v[116:119], v58 offset:800
    ds_read_b128 v[140:143], v59 offset:1600
    s_waitcnt lgkmcnt(8)
    v_mfma_f32_32x32x16_bf16 v[72:87], v[124:127], v[148:151], v[72:87]
    ds_read_b128 v[120:123], v58 offset:832
    ds_read_b128 v[144:147], v59 offset:1552
    s_waitcnt lgkmcnt(8)
    v_mfma_f32_32x32x16_bf16 v[72:87], v[104:107], v[128:131], v[72:87]
    ds_read_b128 v[124:127], v58 offset:864
    ds_read_b128 v[148:151], v59 offset:1520
    s_waitcnt lgkmcnt(8)
    v_mfma_f32_32x32x16_bf16 v[72:87], v[108:111], v[132:135], v[72:87]
    ds_read_b128 v[104:107], v58 offset:896
    ds_read_b128 v[128:131], v59 offset:1472
    s_waitcnt lgkmcnt(8)
    v_mfma_f32_32x32x16_bf16 v[72:87], v[112:115], v[136:139], v[72:87]
    ds_read_b128 v[108:111], v58 offset:928
    ds_read_b128 v[132:135], v59 offset:1440
    s_waitcnt lgkmcnt(8)
    v_mfma_f32_32x32x16_bf16 v[72:87], v[116:119], v[140:143], v[72:87]
    ds_read_b128 v[112:115], v58 offset:960
    ds_read_b128 v[136:139], v59 offset:1392
    s_waitcnt lgkmcnt(8)
    v_mfma_f32_32x32x16_bf16 v[72:87], v[120:123], v[144:147], v[72:87]
    ds_read_b128 v[116:119], v58 offset:992
    ds_read_b128 v[140:143], v59 offset:1360
    s_waitcnt lgkmcnt(8)
    v_mfma_f32_32x32x16_bf16 v[72:87], v[124:127], v[148:151], v[72:87]
    s_waitcnt lgkmcnt(6)
    v_mfma_f32_32x32x16_bf16 v[72:87], v[104:107], v[128:131], v[72:87]
    s_waitcnt lgkmcnt(4)
    v_mfma_f32_32x32x16_bf16 v[72:87], v[108:111], v[132:135], v[72:87]
    s_waitcnt lgkmcnt(2)
    v_mfma_f32_32x32x16_bf16 v[72:87], v[112:115], v[136:139], v[72:87]
    s_waitcnt lgkmcnt(0)
    v_mfma_f32_32x32x16_bf16 v[72:87], v[116:119], v[140:143], v[72:87]
    s_nop 11
    ds_write_b128 v70, v[72:75] offset:18432
    ds_write_b128 v70, v[76:79] offset:18464
    ds_write_b128 v70, v[80:83] offset:18496
    ds_write_b128 v70, v[84:87] offset:18528
    s_branch c_pw_end_34
c_pw_36:
    s_cmp_lg_u32 s34, 2
    s_cbranch_scc1 c_pw_37
    ds_read_b128 v[104:107], v58 offset:1024
    ds_read_b128 v[128:131], v59 offset:1312
    ds_read_b128 v[108:111], v58 offset:1056
    ds_read_b128 v[132:135], v59 offset:1280
    ds_read_b128 v[112:115], v58 offset:1088
    ds_read_b128 v[136:139], v59 offset:1232
    ds_read_b128 v[116:119], v58 offset:1120
    ds_read_b128 v[140:143], v59 offset:1200
    ds_read_b128 v[120:123], v58 offset:1152
    ds_read_b128 v[144:147], v59 offset:1152
    s_waitcnt lgkmcnt(8)
    v_mfma_f32_32x32x16_bf16 v[72:87], v[104:107], v[128:131], 0
    ds_read_b128 v[124:127], v58 offset:1184
    ds_read_b128 v[148:151], v59 offset:1120
    s_waitcnt lgkmcnt(8)
    v_mfma_f32_32x32x16_bf16 v[72:87], v[108:111], v[132:135], v[72:87]
    ds_read_b128 v[104:107], v58 offset:1216
    ds_read_b128 v[128:131], v59 offset:1072
    s_waitcnt lgkmcnt(8)
    v_mfma_f32_32x32x16_bf16 v[72:87], v[112:115], v[136:139], v[72:87]
    ds_read_b128 v[108:111], v58 offset:1248
    ds_read_b128 v[132:135], v59 offset:1040
    s_waitcnt lgkmcnt(8)
    v_mfma_f32_32x32x16_bf16 v[72:87], v[116:119], v[140:143], v[72:87]
    ds_read_b128 v[112:115], v58 offset:1280
    ds_read_b128 v[136:139], v59 offset:992
    s_waitcnt lgkmcnt(8)
    v_mfma_f32_32x32x16_bf16 v[72:87], v[120:123], v[144:147], v[72:87]
    ds_read_b128 v[116:119], v58 offset:1312
    ds_read_b128 v[140:143], v59 offset:960
    s_waitcnt lgkmcnt(8)
    v_mfma_f32_32x32x16_bf16 v[72:87], v[124:127], v[148:151], v[72:87]
    ds_read_b128 v[120:123], v58 offset:1344
    ds_read_b128 v[144:147], v59 offset:912
    s_waitcnt lgkmcnt(8)
    v_mfma_f32_32x32x16_bf16 v[72:87], v[104:107], v[128:131], v[72:87]
    ds_read_b128 v[124:127], v58 offset:1376
    ds_read_b128 v[148:151], v59 offset:880
    s_waitcnt lgkmcnt(8)
    v_mfma_f32_32x32x16_bf16 v[72:87], v[108:111], v[132:135], v[72:87]
    ds_read_b128 v[104:107], v58 offset:1408
    ds_read_b128 v[128:131], v59 offset:832
    s_waitcnt lgkmcnt(8)
    v_mfma_f32_32x32x16_bf16 v[72:87], v[112:115], v[136:139], v[72:87]
    ds_read_b128 v[108:111], v58 offset:1440
    ds_read_b128 v[132:135], v59 offset:800
    s_waitcnt lgkmcnt(8)
    v_mfma_f32_32x32x16_bf16 v[72:87], v[116:119], v[140:143], v[72:87]
    ds_read_b128 v[112:115], v58 offset:1472
    ds_read_b128 v[136:139], v59 offset:752
    s_waitcnt lgkmcnt(8)
    v_mfma_f32_32x32x16_bf16 v[72:87], v[120:123], v[144:147], v[72:87]
    ds_read_b128 v[116:119], v58 offset:1504
    ds_read_b128 v[140:143], v59 offset:720
    s_waitcnt lgkmcnt(8)
    v_mfma_f32_32x32x16_bf16 v[72:87], v[124:127], v[148:151], v[72:87]
    s_waitcnt lgkmcnt(6)
    v_mfma_f32_32x32x16_bf16 v[72:87], v[104:107], v[128:131], v[72:87]
    s_waitcnt lgkmcnt(4)
    v_mfma_f32_32x32x16_bf16 v[72:87], v[108:111], v[132:135], v[72:87]
    s_waitcnt lgkmcnt(2)
    v_mfma_f32_32x32x16_bf16 v[72:87], v[112:115], v[136:139], v[72:87]
    s_waitcnt lgkmcnt(0)
    v_mfma_f32_32x32x16_bf16 v[72:87], v[116:119], v[140:143], v[72:87]
    s_nop 11
    ds_write_b128 v70, v[72:75] offset:23040
    ds_write_b128 v70, v[76:79] offset:23072
    ds_write_b128 v70, v[80:83] offset:23104
    ds_write_b128 v70, v[84:87] offset:23136
    s_branch c_pw_end_34
c_pw_37:
    ds_read_b128 v[104:107], v58 offset:1536
    ds_read_b128 v[128:131], v59 offset:672
    ds_read_b128 v[108:111], v58 offset:1568
    ds_read_b128 v[132:135], v59 offset:640
    ds_read_b128 v[112:115], v58 offset:1600
    ds_read_b128 v[136:139], v59 offset:592
    ds_read_b128 v[116:119], v58 offset:1632
    ds_read_b128 v[140:143], v59 offset:560
    ds_read_b128 v[120:123], v58 offset:1664
    ds_read_b128 v[144:147], v59 offset:512
    s_waitcnt lgkmcnt(8)
    v_mfma_f32_32x32x16_bf16 v[72:87], v[104:107], v[128:131], 0
    ds_read_b128 v[124:127], v58 offset:1696
    ds_read_b128 v[148:151], v59 offset:480
    s_waitcnt lgkmcnt(8)
    v_mfma_f32_32x32x16_bf16 v[72:87], v[108:111], v[132:135], v[72:87]
    ds_read_b128 v[104:107], v58 offset:1728
    ds_read_b128 v[128:131], v59 offset:432
    s_waitcnt lgkmcnt(8)
    v_mfma_f32_32x32x16_bf16 v[72:87], v[112:115], v[136:139], v[72:87]
    ds_read_b128 v[108:111], v58 offset:1760
    ds_read_b128 v[132:135], v59 offset:400
    s_waitcnt lgkmcnt(8)
    v_mfma_f32_32x32x16_bf16 v[72:87], v[116:119], v[140:143], v[72:87]
    ds_read_b128 v[112:115], v58 offset:1792
    ds_read_b128 v[136:139], v59 offset:352
    s_waitcnt lgkmcnt(8)
    v_mfma_f32_32x32x16_bf16 v[72:87], v[120:123], v[144:147], v[72:87]
    ds_read_b128 v[116:119], v58 offset:1824
    ds_read_b128 v[140:143], v59 offset:320
    s_waitcnt lgkmcnt(8)
    v_mfma_f32_32x32x16_bf16 v[72:87], v[124:127], v[148:151], v[72:87]
    ds_read_b128 v[120:123], v58 offset:1856
    ds_read_b128 v[144:147], v59 offset:272
    s_waitcnt lgkmcnt(8)
    v_mfma_f32_32x32x16_bf16 v[72:87], v[104:107], v[128:131], v[72:87]
    ds_read_b128 v[124:127], v58 offset:1888
    ds_read_b128 v[148:151], v59 offset:240
    s_waitcnt lgkmcnt(8)
    v_mfma_f32_32x32x16_bf16 v[72:87], v[108:111], v[132:135], v[72:87]
    ds_read_b128 v[104:107], v58 offset:1920
    ds_read_b128 v[128:131], v59 offset:192
    s_waitcnt lgkmcnt(8)
    v_mfma_f32_32x32x16_bf16 v[72:87], v[112:115], v[136:139], v[72:87]
    ds_read_b128 v[108:111], v58 offset:1952
    ds_read_b128 v[132:135], v59 offset:160
    s_waitcnt lgkmcnt(8)
    v_mfma_f32_32x32x16_bf16 v[72:87], v[116:119], v[140:143], v[72:87]
    ds_read_b128 v[112:115], v58 offset:1984
    ds_read_b128 v[136:139], v59 offset:112
    s_waitcnt lgkmcnt(8)
    v_mfma_f32_32x32x16_bf16 v[72:87], v[120:123], v[144:147], v[72:87]
    ds_read_b128 v[116:119], v58 offset:2016
    ds_read_b128 v[140:143], v59 offset:80
    s_waitcnt lgkmcnt(8)
    v_mfma_f32_32x32x16_bf16 v[72:87], v[124:127], v[148:151], v[72:87]
    s_waitcnt lgkmcnt(6)
    v_mfma_f32_32x32x16_bf16 v[72:87], v[104:107], v[128:131], v[72:87]
    s_waitcnt lgkmcnt(4)
    v_mfma_f32_32x32x16_bf16 v[72:87], v[108:111], v[132:135], v[72:87]
    s_waitcnt lgkmcnt(2)
    v_mfma_f32_32x32x16_bf16 v[72:87], v[112:115], v[136:139], v[72:87]
    s_waitcnt lgkmcnt(0)
    v_mfma_f32_32x32x16_bf16 v[72:87], v[116:119], v[140:143], v[72:87]
    s_nop 11
    ds_write_b128 v70, v[72:75] offset:27648
    ds_write_b128 v70, v[76:79] offset:27680
    ds_write_b128 v70, v[80:83] offset:27712
    ds_write_b128 v70, v[84:87] offset:27744
c_pw_end_34:
    s_waitcnt lgkmcnt(0)
    s_barrier
    s_cmp_ge_u32 s34, 2
    s_cbranch_scc1 c_hf_39
    ds_read_b128 v[104:107], v71 offset:13824
    ds_read_b128 v[108:111], v71 offset:13840
    ds_read_b128 v[112:115], v71 offset:18432
    ds_read_b128 v[116:119], v71 offset:18448
    ds_read_b128 v[120:123], v71 offset:23040
    ds_read_b128 v[124:127], v71 offset:23056
    ds_read_b128 v[128:131], v71 offset:27648
    ds_read_b128 v[132:135], v71 offset:27664
    s_waitcnt lgkmcnt(0)
    v_pk_add_f32 v[104:105], v[104:105], v[112:113]
    v_pk_add_f32 v[106:107], v[106:107], v[114:115]
    v_pk_add_f32 v[108:109], v[108:109], v[116:117]
    v_pk_add_f32 v[110:111], v[110:111], v[118:119]
    v_pk_add_f32 v[104:105], v[104:105], v[120:121]
    v_pk_add_f32 v[106:107], v[106:107], v[122:123]
    v_pk_add_f32 v[108:109], v[108:109], v[124:125]
    v_pk_add_f32 v[110:111], v[110:111], v[126:127]
    v_pk_add_f32 v[104:105], v[104:105], v[128:129]
    v_pk_add_f32 v[106:107], v[106:107], v[130:131]
    v_pk_add_f32 v[108:109], v[108:109], v[132:133]
    v_pk_add_f32 v[110:111], v[110:111], v[134:135]
    v_cvt_pk_bf16_f32 v184, v104, v105
    v_cvt_pk_bf16_f32 v185, v106, v107
    v_cvt_pk_bf16_f32 v186, v108, v109
    v_cvt_pk_bf16_f32 v187, v110, v111
    s_lshl_b32 s40, s58, 12
    s_add_u32 s40, s40, 8912896
    v_and_b32 v3, 127, v0
    v_lshlrev_b32 v3, 4, v3
    buffer_store_dwordx4 v[184:187], v3, s[8:11], s40 offen
    s_nop 1
c_hf_39:
c_halfE_27:
k2_kernel_end:
    s_endpgm

.globl k3_kernel
.p2align 8
.type k3_kernel,@function
k3_kernel:
    s_cmp_ge_u32 s2, 256
    s_cbranch_scc1 k3_kernel_end
    s_load_dwordx2 s[12:13], s[0:1], 104
    s_load_dwordx2 s[8:9], s[0:1], 0
    s_load_dwordx2 s[16:17], s[0:1], 88
    s_mov_b32 s10, 2621440
    s_mov_b32 s11, 0x20000
    s_mov_b32 s14, 15990784
    s_mov_b32 s15, 0x20000
    s_mov_b32 s18, 2621440
    s_mov_b32 s19, 0x20000
    v_lshrrev_b32 v4, 6, v0
    v_and_b32 v1, 63, v0
    v_readfirstlane_b32 s34, v4
    v_lshlrev_b32 v7, 4, v1
    s_and_b32 s40, s2, 7
    s_lshr_b32 s41, s2, 3
    s_lshr_b32 s32, s40, 1
    s_lshl_b32 s32, s32, 3
    s_and_b32 s42, s41, 7
    s_add_u32 s32, s32, s42
    s_and_b32 s33, s40, 1
    s_lshl_b32 s33, s33, 2
    s_lshr_b32 s42, s41, 3
    s_add_u32 s33, s33, s42
    s_add_u32 s40, s32, s33
    s_mul_i32 s41, s40, 43
    s_lshr_b32 s41, s41, 8
    s_mul_i32 s41, s41, 6
    s_sub_u32 s48, s40, s41
    s_mul_i32 s46, s33, 122880
    s_add_u32 s46, s46, 15007744
    s_mul_i32 s40, s34, 5120
    s_add_u32 s46, s46, s40
    s_mul_i32 s47, s32, 98304
    s_mul_i32 s41, s34, 24576
    s_add_u32 s47, s47, s41
    s_add_u32 s47, s47, 11534336
    s_add_u32 s40, s48, 0
    s_sub_u32 s41, s40, 6
    s_cmp_ge_u32 s40, 6
    s_cselect_b32 s50, s41, s40
    s_add_u32 s40, s48, 1
    s_sub_u32 s41, s40, 6
    s_cmp_ge_u32 s40, 6
    s_cselect_b32 s51, s41, s40
    s_add_u32 s40, s48, 2
    s_sub_u32 s41, s40, 6
    s_cmp_ge_u32 s40, 6
    s_cselect_b32 s52, s41, s40
    s_add_u32 s40, s48, 3
    s_sub_u32 s41, s40, 6
    s_cmp_ge_u32 s40, 6
    s_cselect_b32 s53, s41, s40
    s_add_u32 s40, s48, 4
    s_sub_u32 s41, s40, 6
    s_cmp_ge_u32 s40, 6
    s_cselect_b32 s54, s41, s40
    s_add_u32 s40, s48, 5
    s_sub_u32 s41, s40, 6
    s_cmp_ge_u32 s40, 6
    s_cselect_b32 s55, s41, s40
    s_waitcnt lgkmcnt(0)
    s_mul_i32 s40, s50, 20480
    s_add_u32 s40, s40, s46
    s_add_u32 s40, s40, 0
    s_mul_i32 s41, s34, 5120
    s_add_u32 m0, s41, 0
    s_nop 0
    buffer_load_dwordx4 v7, s[12:15], s40 offen lds
    s_mul_i32 s40, s50, 20480
    s_add_u32 s40, s40, s46
    s_add_u32 s40, s40, 1024
    s_mul_i32 s41, s34, 5120
    s_add_u32 m0, s41, 1024
    s_nop 0
    buffer_load_dwordx4 v7, s[12:15], s40 offen lds
    s_mul_i32 s40, s50, 20480
    s_add_u32 s40, s40, s46
    s_add_u32 s40, s40, 2048
    s_mul_i32 s41, s34, 5120
    s_add_u32 m0, s41, 2048
    s_nop 0
    buffer_load_dwordx4 v7, s[12:15], s40 offen lds
    s_mul_i32 s40, s50, 20480
    s_add_u32 s40, s40, s46
    s_add_u32 s40, s40, 3072
    s_mul_i32 s41, s34, 5120
    s_add_u32 m0, s41, 3072
    s_nop 0
    buffer_load_dwordx4 v7, s[12:15], s40 offen lds
    s_mul_i32 s40, s50, 20480
    s_add_u32 s40, s40, s46
    s_add_u32 s40, s40, 4096
    s_mul_i32 s41, s34, 5120
    s_add_u32 m0, s41, 4096
    s_nop 0
    buffer_load_dwordx4 v7, s[12:15], s40 offen lds
    s_lshl_b32 s42, s50, 12
    s_add_u32 s42, s42, s47
    buffer_load_dwordx4 v[8:11], v7, s[12:15], s42 offen offset:0
    s_lshl_b32 s42, s50, 12
    s_add_u32 s42, s42, s47
    buffer_load_dwordx4 v[12:15], v7, s[12:15], s42 offen offset:1024
    s_lshl_b32 s42, s50, 12
    s_add_u32 s42, s42, s47
    buffer_load_dwordx4 v[16:19], v7, s[12:15], s42 offen offset:2048
    s_lshl_b32 s42, s50, 12
    s_add_u32 s42, s42, s47
    buffer_load_dwordx4 v[20:23], v7, s[12:15], s42 offen offset:3072
    s_barrier
    s_mul_i32 s40, s51, 20480
    s_add_u32 s40, s40, s46
    s_add_u32 s40, s40, 0
    s_mul_i32 s41, s34, 5120
    s_add_u32 m0, s41, 20480
    s_nop 0
    buffer_load_dwordx4 v7, s[12:15], s40 offen lds
    s_mul_i32 s40, s51, 20480
    s_add_u32 s40, s40, s46
    s_add_u32 s40, s40, 1024
    s_mul_i32 s41, s34, 5120
    s_add_u32 m0, s41, 21504
    s_nop 0
    buffer_load_dwordx4 v7, s[12:15], s40 offen lds
    s_mul_i32 s40, s51, 20480
    s_add_u32 s40, s40, s46
    s_add_u32 s40, s40, 2048
    s_mul_i32 s41, s34, 5120
    s_add_u32 m0, s41, 22528
    s_nop 0
    buffer_load_dwordx4 v7, s[12:15], s40 offen lds
    s_mul_i32 s40, s51, 20480
    s_add_u32 s40, s40, s46
    s_add_u32 s40, s40, 3072
    s_mul_i32 s41, s34, 5120
    s_add_u32 m0, s41, 23552
    s_nop 0
    buffer_load_dwordx4 v7, s[12:15], s40 offen lds
    s_mul_i32 s40, s51, 20480
    s_add_u32 s40, s40, s46
    s_add_u32 s40, s40, 4096
    s_mul_i32 s41, s34, 5120
    s_add_u32 m0, s41, 24576
    s_nop 0
    buffer_load_dwordx4 v7, s[12:15], s40 offen lds
    s_lshl_b32 s42, s51, 12
    s_add_u32 s42, s42, s47
    buffer_load_dwordx4 v[24:27], v7, s[12:15], s42 offen offset:0
    s_lshl_b32 s42, s51, 12
    s_add_u32 s42, s42, s47
    buffer_load_dwordx4 v[28:31], v7, s[12:15], s42 offen offset:1024
    s_lshl_b32 s42, s51, 12
    s_add_u32 s42, s42, s47
    buffer_load_dwordx4 v[32:35], v7, s[12:15], s42 offen offset:2048
    s_lshl_b32 s42, s51, 12
    s_add_u32 s42, s42, s47
    buffer_load_dwordx4 v[36:39], v7, s[12:15], s42 offen offset:3072
    s_mul_i32 s44, s33, 160
    s_mul_i32 s45, s32, 81920
    s_add_u32 s45, s45, s44
    v_add_u32 v4, 0, v1
    v_mul_u32_u24 v5, 6554, v4
    v_lshrrev_b32 v5, 16, v5
    v_mul_u32_u24 v6, 10, v5
    v_sub_u32 v4, v4, v6
    v_lshlrev_b32 v4, 4, v4
    v_mul_u32_u24 v5, 1280, v5
    v_add_u32 v104, v4, v5
    v_add_u32 v4, 64, v1
    v_mul_u32_u24 v5, 6554, v4
    v_lshrrev_b32 v5, 16, v5
    v_mul_u32_u24 v6, 10, v5
    v_sub_u32 v4, v4, v6
    v_lshlrev_b32 v4, 4, v4
    v_mul_u32_u24 v5, 1280, v5
    v_add_u32 v105, v4, v5
    v_add_u32 v4, 128, v1
    v_mul_u32_u24 v5, 6554, v4
    v_lshrrev_b32 v5, 16, v5
    v_mul_u32_u24 v6, 10, v5
    v_sub_u32 v4, v4, v6
    v_lshlrev_b32 v4, 4, v4
    v_mul_u32_u24 v5, 1280, v5
    v_add_u32 v106, v4, v5
    v_add_u32 v4, 192, v1
    v_mul_u32_u24 v5, 6554, v4
    v_lshrrev_b32 v5, 16, v5
    v_mul_u32_u24 v6, 10, v5
    v_sub_u32 v4, v4, v6
    v_lshlrev_b32 v4, 4, v4
    v_mul_u32_u24 v5, 1280, v5
    v_add_u32 v107, v4, v5
    v_add_u32 v4, 256, v1
    v_mul_u32_u24 v5, 6554, v4
    v_lshrrev_b32 v5, 16, v5
    v_mul_u32_u24 v6, 10, v5
    v_sub_u32 v4, v4, v6
    v_lshlrev_b32 v4, 4, v4
    v_mul_u32_u24 v5, 1280, v5
    v_add_u32 v108, v4, v5
    v_lshrrev_b32 v2, 4, v1
    v_and_b32 v3, 15, v1
    v_mov_b32 v113, v7
    v_add_u32 v114, 61440, v7
    s_waitcnt vmcnt(13)
    s_barrier
    ds_read_b128 v[136:139], v113 offset:0
    ds_read_b128 v[140:143], v113 offset:1024
    ds_read_b128 v[144:147], v113 offset:2048
    ds_read_b128 v[148:151], v113 offset:3072
    ds_read_b128 v[152:155], v113 offset:4096
    ds_read_b128 v[156:159], v113 offset:5120
    ds_read_b128 v[160:163], v113 offset:6144
    ds_read_b128 v[164:167], v113 offset:7168
    ds_read_b128 v[168:171], v113 offset:8192
    ds_read_b128 v[172:175], v113 offset:9216
    s_waitcnt vmcnt(12)
    s_waitcnt lgkmcnt(9)
    v_mfma_f32_16x16x32_bf16 v[116:119], v[136:139], v[8:11], 0
    s_mul_i32 s40, s52, 20480
    s_add_u32 s40, s40, s46
    s_add_u32 s40, s40, 0
    s_mul_i32 s41, s34, 5120
    s_add_u32 m0, s41, 40960
    s_nop 0
    buffer_load_dwordx4 v7, s[12:15], s40 offen lds
    s_waitcnt lgkmcnt(8)
    v_mfma_f32_16x16x32_bf16 v[120:123], v[140:143], v[8:11], 0
    s_waitcnt lgkmcnt(7)
    v_mfma_f32_16x16x32_bf16 v[124:127], v[144:147], v[8:11], 0
    s_mul_i32 s40, s52, 20480
    s_add_u32 s40, s40, s46
    s_add_u32 s40, s40, 1024
    s_mul_i32 s41, s34, 5120
    s_add_u32 m0, s41, 41984
    s_nop 0
    buffer_load_dwordx4 v7, s[12:15], s40 offen lds
    s_waitcnt lgkmcnt(6)
    v_mfma_f32_16x16x32_bf16 v[128:131], v[148:151], v[8:11], 0
    s_waitcnt lgkmcnt(5)
    v_mfma_f32_16x16x32_bf16 v[132:135], v[152:155], v[8:11], 0
    s_mul_i32 s40, s52, 20480
    s_add_u32 s40, s40, s46
    s_add_u32 s40, s40, 2048
    s_mul_i32 s41, s34, 5120
    s_add_u32 m0, s41, 43008
    s_nop 0
    buffer_load_dwordx4 v7, s[12:15], s40 offen lds
    ds_read_b128 v[136:139], v113 offset:10240
    ds_read_b128 v[140:143], v113 offset:11264
    ds_read_b128 v[144:147], v113 offset:12288
    ds_read_b128 v[148:151], v113 offset:13312
    ds_read_b128 v[152:155], v113 offset:14336
    s_waitcnt vmcnt(14)
    s_waitcnt lgkmcnt(9)
    v_mfma_f32_16x16x32_bf16 v[116:119], v[156:159], v[12:15], v[116:119]
    s_mul_i32 s40, s52, 20480
    s_add_u32 s40, s40, s46
    s_add_u32 s40, s40, 3072
    s_mul_i32 s41, s34, 5120
    s_add_u32 m0, s41, 44032
    s_nop 0
    buffer_load_dwordx4 v7, s[12:15], s40 offen lds
    s_waitcnt lgkmcnt(8)
    v_mfma_f32_16x16x32_bf16 v[120:123], v[160:163], v[12:15], v[120:123]
    s_waitcnt lgkmcnt(7)
    v_mfma_f32_16x16x32_bf16 v[124:127], v[164:167], v[12:15], v[124:127]
    s_mul_i32 s40, s52, 20480
    s_add_u32 s40, s40, s46
    s_add_u32 s40, s40, 4096
    s_mul_i32 s41, s34, 5120
    s_add_u32 m0, s41, 45056
    s_nop 0
    buffer_load_dwordx4 v7, s[12:15], s40 offen lds
    s_waitcnt lgkmcnt(6)
    v_mfma_f32_16x16x32_bf16 v[128:131], v[168:171], v[12:15], v[128:131]
    s_waitcnt lgkmcnt(5)
    v_mfma_f32_16x16x32_bf16 v[132:135], v[172:175], v[12:15], v[132:135]
    s_lshl_b32 s42, s52, 12
    s_add_u32 s42, s42, s47
    buffer_load_dwordx4 v[40:43], v7, s[12:15], s42 offen offset:0
    ds_read_b128 v[156:159], v113 offset:15360
    ds_read_b128 v[160:163], v113 offset:16384
    ds_read_b128 v[164:167], v113 offset:17408
    ds_read_b128 v[168:171], v113 offset:18432
    ds_read_b128 v[172:175], v113 offset:19456
    s_waitcnt vmcnt(16)
    s_waitcnt lgkmcnt(9)
    v_mfma_f32_16x16x32_bf16 v[116:119], v[136:139], v[16:19], v[116:119]
    s_lshl_b32 s42, s52, 12
    s_add_u32 s42, s42, s47
    buffer_load_dwordx4 v[44:47], v7, s[12:15], s42 offen offset:1024
    s_waitcnt lgkmcnt(8)
    v_mfma_f32_16x16x32_bf16 v[120:123], v[140:143], v[16:19], v[120:123]
    s_waitcnt lgkmcnt(7)
    v_mfma_f32_16x16x32_bf16 v[124:127], v[144:147], v[16:19], v[124:127]
    s_lshl_b32 s42, s52, 12
    s_add_u32 s42, s42, s47
    buffer_load_dwordx4 v[48:51], v7, s[12:15], s42 offen offset:2048
    s_waitcnt lgkmcnt(6)
    v_mfma_f32_16x16x32_bf16 v[128:131], v[148:151], v[16:19], v[128:131]
    s_waitcnt lgkmcnt(5)
    v_mfma_f32_16x16x32_bf16 v[132:135], v[152:155], v[16:19], v[132:135]
    s_lshl_b32 s42, s52, 12
    s_add_u32 s42, s42, s47
    buffer_load_dwordx4 v[52:55], v7, s[12:15], s42 offen offset:3072
    s_waitcnt vmcnt(18)
    s_waitcnt lgkmcnt(4)
    v_mfma_f32_16x16x32_bf16 v[116:119], v[156:159], v[20:23], v[116:119]
    s_waitcnt lgkmcnt(3)
    v_mfma_f32_16x16x32_bf16 v[120:123], v[160:163], v[20:23], v[120:123]
    s_waitcnt lgkmcnt(2)
    v_mfma_f32_16x16x32_bf16 v[124:127], v[164:167], v[20:23], v[124:127]
    s_waitcnt lgkmcnt(1)
    v_mfma_f32_16x16x32_bf16 v[128:131], v[168:171], v[20:23], v[128:131]
    s_waitcnt lgkmcnt(0)
    v_mfma_f32_16x16x32_bf16 v[132:135], v[172:175], v[20:23], v[132:135]
    s_waitcnt vmcnt(13)
    s_barrier
    ds_read_b128 v[136:139], v113 offset:20480
    ds_read_b128 v[140:143], v113 offset:21504
    ds_read_b128 v[144:147], v113 offset:22528
    ds_read_b128 v[148:151], v113 offset:23552
    ds_read_b128 v[152:155], v113 offset:24576
    ds_read_b128 v[156:159], v113 offset:25600
    ds_read_b128 v[160:163], v113 offset:26624
    ds_read_b128 v[164:167], v113 offset:27648
    ds_read_b128 v[168:171], v113 offset:28672
    ds_read_b128 v[172:175], v113 offset:29696
    s_waitcnt vmcnt(12)
    s_waitcnt lgkmcnt(9)
    v_mfma_f32_16x16x32_bf16 v[116:119], v[136:139], v[24:27], v[116:119]
    s_mul_i32 s40, s53, 20480
    s_add_u32 s40, s40, s46
    s_add_u32 s40, s40, 0
    s_mul_i32 s41, s34, 5120
    s_add_u32 m0, s41, 61440
    s_nop 0
    buffer_load_dwordx4 v7, s[12:15], s40 offen lds
    s_waitcnt lgkmcnt(8)
    v_mfma_f32_16x16x32_bf16 v[120:123], v[140:143], v[24:27], v[120:123]
    s_waitcnt lgkmcnt(7)
    v_mfma_f32_16x16x32_bf16 v[124:127], v[144:147], v[24:27], v[124:127]
    s_mul_i32 s40, s53, 20480
    s_add_u32 s40, s40, s46
    s_add_u32 s40, s40, 1024
    s_mul_i32 s41, s34, 5120
    s_add_u32 m0, s41, 62464
    s_nop 0
    buffer_load_dwordx4 v7, s[12:15], s40 offen lds
    s_waitcnt lgkmcnt(6)
    v_mfma_f32_16x16x32_bf16 v[128:131], v[148:151], v[24:27], v[128:131]
    s_waitcnt lgkmcnt(5)
    v_mfma_f32_16x16x32_bf16 v[132:135], v[152:155], v[24:27], v[132:135]
    s_mul_i32 s40, s53, 20480
    s_add_u32 s40, s40, s46
    s_add_u32 s40, s40, 2048
    s_mul_i32 s41, s34, 5120
    s_add_u32 m0, s41, 63488
    s_nop 0
    buffer_load_dwordx4 v7, s[12:15], s40 offen lds
    ds_read_b128 v[136:139], v113 offset:30720
    ds_read_b128 v[140:143], v113 offset:31744
    ds_read_b128 v[144:147], v113 offset:32768
    ds_read_b128 v[148:151], v113 offset:33792
    ds_read_b128 v[152:155], v113 offset:34816
    s_waitcnt vmcnt(14)
    s_waitcnt lgkmcnt(9)
    v_mfma_f32_16x16x32_bf16 v[116:119], v[156:159], v[28:31], v[116:119]
    s_mul_i32 s40, s53, 20480
    s_add_u32 s40, s40, s46
    s_add_u32 s40, s40, 3072
    s_mul_i32 s41, s34, 5120
    s_add_u32 m0, s41, 64512
    s_nop 0
    buffer_load_dwordx4 v7, s[12:15], s40 offen lds
    s_waitcnt lgkmcnt(8)
    v_mfma_f32_16x16x32_bf16 v[120:123], v[160:163], v[28:31], v[120:123]
    s_waitcnt lgkmcnt(7)
    v_mfma_f32_16x16x32_bf16 v[124:127], v[164:167], v[28:31], v[124:127]
    s_mul_i32 s40, s53, 20480
    s_add_u32 s40, s40, s46
    s_add_u32 s40, s40, 4096
    s_mul_i32 s41, s34, 5120
    s_add_u32 m0, s41, 65536
    s_nop 0
    buffer_load_dwordx4 v7, s[12:15], s40 offen lds
    s_waitcnt lgkmcnt(6)
    v_mfma_f32_16x16x32_bf16 v[128:131], v[168:171], v[28:31], v[128:131]
    s_waitcnt lgkmcnt(5)
    v_mfma_f32_16x16x32_bf16 v[132:135], v[172:175], v[28:31], v[132:135]
    s_lshl_b32 s42, s53, 12
    s_add_u32 s42, s42, s47
    buffer_load_dwordx4 v[56:59], v7, s[12:15], s42 offen offset:0
    ds_read_b128 v[156:159], v113 offset:35840
    ds_read_b128 v[160:163], v113 offset:36864
    ds_read_b128 v[164:167], v113 offset:37888
    ds_read_b128 v[168:171], v113 offset:38912
    ds_read_b128 v[172:175], v113 offset:39936
    s_waitcnt vmcnt(16)
    s_waitcnt lgkmcnt(9)
    v_mfma_f32_16x16x32_bf16 v[116:119], v[136:139], v[32:35], v[116:119]
    s_lshl_b32 s42, s53, 12
    s_add_u32 s42, s42, s47
    buffer_load_dwordx4 v[60:63], v7, s[12:15], s42 offen offset:1024
    s_waitcnt lgkmcnt(8)
    v_mfma_f32_16x16x32_bf16 v[120:123], v[140:143], v[32:35], v[120:123]
    s_waitcnt lgkmcnt(7)
    v_mfma_f32_16x16x32_bf16 v[124:127], v[144:147], v[32:35], v[124:127]
    s_lshl_b32 s42, s53, 12
    s_add_u32 s42, s42, s47
    buffer_load_dwordx4 v[64:67], v7, s[12:15], s42 offen offset:2048
    s_waitcnt lgkmcnt(6)
    v_mfma_f32_16x16x32_bf16 v[128:131], v[148:151], v[32:35], v[128:131]
    s_waitcnt lgkmcnt(5)
    v_mfma_f32_16x16x32_bf16 v[132:135], v[152:155], v[32:35], v[132:135]
    s_lshl_b32 s42, s53, 12
    s_add_u32 s42, s42, s47
    buffer_load_dwordx4 v[68:71], v7, s[12:15], s42 offen offset:3072
    s_waitcnt vmcnt(18)
    s_waitcnt lgkmcnt(4)
    v_mfma_f32_16x16x32_bf16 v[116:119], v[156:159], v[36:39], v[116:119]
    s_waitcnt lgkmcnt(3)
    v_mfma_f32_16x16x32_bf16 v[120:123], v[160:163], v[36:39], v[120:123]
    s_waitcnt lgkmcnt(2)
    v_mfma_f32_16x16x32_bf16 v[124:127], v[164:167], v[36:39], v[124:127]
    s_waitcnt lgkmcnt(1)
    v_mfma_f32_16x16x32_bf16 v[128:131], v[168:171], v[36:39], v[128:131]
    s_waitcnt lgkmcnt(0)
    v_mfma_f32_16x16x32_bf16 v[132:135], v[172:175], v[36:39], v[132:135]
    s_waitcnt vmcnt(13)
    s_barrier
    ds_read_b128 v[136:139], v113 offset:40960
    ds_read_b128 v[140:143], v113 offset:41984
    ds_read_b128 v[144:147], v113 offset:43008
    ds_read_b128 v[148:151], v113 offset:44032
    ds_read_b128 v[152:155], v113 offset:45056
    ds_read_b128 v[156:159], v113 offset:46080
    ds_read_b128 v[160:163], v113 offset:47104
    ds_read_b128 v[164:167], v113 offset:48128
    ds_read_b128 v[168:171], v113 offset:49152
    ds_read_b128 v[172:175], v113 offset:50176
    s_waitcnt vmcnt(12)
    s_waitcnt lgkmcnt(9)
    v_mfma_f32_16x16x32_bf16 v[116:119], v[136:139], v[40:43], v[116:119]
    s_mul_i32 s40, s54, 20480
    s_add_u32 s40, s40, s46
    s_add_u32 s40, s40, 0
    s_mul_i32 s41, s34, 5120
    s_add_u32 m0, s41, 81920
    s_nop 0
    buffer_load_dwordx4 v7, s[12:15], s40 offen lds
    s_waitcnt lgkmcnt(8)
    v_mfma_f32_16x16x32_bf16 v[120:123], v[140:143], v[40:43], v[120:123]
    s_waitcnt lgkmcnt(7)
    v_mfma_f32_16x16x32_bf16 v[124:127], v[144:147], v[40:43], v[124:127]
    s_mul_i32 s40, s54, 20480
    s_add_u32 s40, s40, s46
    s_add_u32 s40, s40, 1024
    s_mul_i32 s41, s34, 5120
    s_add_u32 m0, s41, 82944
    s_nop 0
    buffer_load_dwordx4 v7, s[12:15], s40 offen lds
    s_waitcnt lgkmcnt(6)
    v_mfma_f32_16x16x32_bf16 v[128:131], v[148:151], v[40:43], v[128:131]
    s_waitcnt lgkmcnt(5)
    v_mfma_f32_16x16x32_bf16 v[132:135], v[152:155], v[40:43], v[132:135]
    s_mul_i32 s40, s54, 20480
    s_add_u32 s40, s40, s46
    s_add_u32 s40, s40, 2048
    s_mul_i32 s41, s34, 5120
    s_add_u32 m0, s41, 83968
    s_nop 0
    buffer_load_dwordx4 v7, s[12:15], s40 offen lds
    ds_read_b128 v[136:139], v113 offset:51200
    ds_read_b128 v[140:143], v113 offset:52224
    ds_read_b128 v[144:147], v113 offset:53248
    ds_read_b128 v[148:151], v113 offset:54272
    ds_read_b128 v[152:155], v113 offset:55296
    s_waitcnt vmcnt(14)
    s_waitcnt lgkmcnt(9)
    v_mfma_f32_16x16x32_bf16 v[116:119], v[156:159], v[44:47], v[116:119]
    s_mul_i32 s40, s54, 20480
    s_add_u32 s40, s40, s46
    s_add_u32 s40, s40, 3072
    s_mul_i32 s41, s34, 5120
    s_add_u32 m0, s41, 84992
    s_nop 0
    buffer_load_dwordx4 v7, s[12:15], s40 offen lds
    s_waitcnt lgkmcnt(8)
    v_mfma_f32_16x16x32_bf16 v[120:123], v[160:163], v[44:47], v[120:123]
    s_waitcnt lgkmcnt(7)
    v_mfma_f32_16x16x32_bf16 v[124:127], v[164:167], v[44:47], v[124:127]
    s_mul_i32 s40, s54, 20480
    s_add_u32 s40, s40, s46
    s_add_u32 s40, s40, 4096
    s_mul_i32 s41, s34, 5120
    s_add_u32 m0, s41, 86016
    s_nop 0
    buffer_load_dwordx4 v7, s[12:15], s40 offen lds
    s_waitcnt lgkmcnt(6)
    v_mfma_f32_16x16x32_bf16 v[128:131], v[168:171], v[44:47], v[128:131]
    s_waitcnt lgkmcnt(5)
    v_mfma_f32_16x16x32_bf16 v[132:135], v[172:175], v[44:47], v[132:135]
    s_lshl_b32 s42, s54, 12
    s_add_u32 s42, s42, s47
    buffer_load_dwordx4 v[72:75], v7, s[12:15], s42 offen offset:0
    ds_read_b128 v[156:159], v113 offset:56320
    ds_read_b128 v[160:163], v113 offset:57344
    ds_read_b128 v[164:167], v113 offset:58368
    ds_read_b128 v[168:171], v113 offset:59392
    ds_read_b128 v[172:175], v113 offset:60416
    s_waitcnt vmcnt(16)
    s_waitcnt lgkmcnt(9)
    v_mfma_f32_16x16x32_bf16 v[116:119], v[136:139], v[48:51], v[116:119]
    s_lshl_b32 s42, s54, 12
    s_add_u32 s42, s42, s47
    buffer_load_dwordx4 v[76:79], v7, s[12:15], s42 offen offset:1024
    s_waitcnt lgkmcnt(8)
    v_mfma_f32_16x16x32_bf16 v[120:123], v[140:143], v[48:51], v[120:123]
    s_waitcnt lgkmcnt(7)
    v_mfma_f32_16x16x32_bf16 v[124:127], v[144:147], v[48:51], v[124:127]
    s_lshl_b32 s42, s54, 12
    s_add_u32 s42, s42, s47
    buffer_load_dwordx4 v[80:83], v7, s[12:15], s42 offen offset:2048
    s_waitcnt lgkmcnt(6)
    v_mfma_f32_16x16x32_bf16 v[128:131], v[148:151], v[48:51], v[128:131]
    s_waitcnt lgkmcnt(5)
    v_mfma_f32_16x16x32_bf16 v[132:135], v[152:155], v[48:51], v[132:135]
    s_lshl_b32 s42, s54, 12
    s_add_u32 s42, s42, s47
    buffer_load_dwordx4 v[84:87], v7, s[12:15], s42 offen offset:3072
    s_waitcnt vmcnt(18)
    s_waitcnt lgkmcnt(4)
    v_mfma_f32_16x16x32_bf16 v[116:119], v[156:159], v[52:55], v[116:119]
    s_waitcnt lgkmcnt(3)
    v_mfma_f32_16x16x32_bf16 v[120:123], v[160:163], v[52:55], v[120:123]
    s_waitcnt lgkmcnt(2)
    v_mfma_f32_16x16x32_bf16 v[124:127], v[164:167], v[52:55], v[124:127]
    s_waitcnt lgkmcnt(1)
    v_mfma_f32_16x16x32_bf16 v[128:131], v[168:171], v[52:55], v[128:131]
    s_waitcnt lgkmcnt(0)
    v_mfma_f32_16x16x32_bf16 v[132:135], v[172:175], v[52:55], v[132:135]
    s_waitcnt vmcnt(13)
    s_barrier
    ds_read_b128 v[136:139], v114 offset:0
    ds_read_b128 v[140:143], v114 offset:1024
    ds_read_b128 v[144:147], v114 offset:2048
    ds_read_b128 v[148:151], v114 offset:3072
    ds_read_b128 v[152:155], v114 offset:4096
    ds_read_b128 v[156:159], v114 offset:5120
    ds_read_b128 v[160:163], v114 offset:6144
    ds_read_b128 v[164:167], v114 offset:7168
    ds_read_b128 v[168:171], v114 offset:8192
    ds_read_b128 v[172:175], v114 offset:9216
    s_waitcnt vmcnt(12)
    s_waitcnt lgkmcnt(9)
    v_mfma_f32_16x16x32_bf16 v[116:119], v[136:139], v[56:59], v[116:119]
    s_mul_i32 s40, s55, 20480
    s_add_u32 s40, s40, s46
    s_add_u32 s40, s40, 0
    s_mul_i32 s41, s34, 5120
    s_add_u32 m0, s41, 102400
    s_nop 0
    buffer_load_dwordx4 v7, s[12:15], s40 offen lds
    s_waitcnt lgkmcnt(8)
    v_mfma_f32_16x16x32_bf16 v[120:123], v[140:143], v[56:59], v[120:123]
    s_waitcnt lgkmcnt(7)
    v_mfma_f32_16x16x32_bf16 v[124:127], v[144:147], v[56:59], v[124:127]
    s_mul_i32 s40, s55, 20480
    s_add_u32 s40, s40, s46
    s_add_u32 s40, s40, 1024
    s_mul_i32 s41, s34, 5120
    s_add_u32 m0, s41, 103424
    s_nop 0
    buffer_load_dwordx4 v7, s[12:15], s40 offen lds
    s_waitcnt lgkmcnt(6)
    v_mfma_f32_16x16x32_bf16 v[128:131], v[148:151], v[56:59], v[128:131]
    s_waitcnt lgkmcnt(5)
    v_mfma_f32_16x16x32_bf16 v[132:135], v[152:155], v[56:59], v[132:135]
    s_mul_i32 s40, s55, 20480
    s_add_u32 s40, s40, s46
    s_add_u32 s40, s40, 2048
    s_mul_i32 s41, s34, 5120
    s_add_u32 m0, s41, 104448
    s_nop 0
    buffer_load_dwordx4 v7, s[12:15], s40 offen lds
    ds_read_b128 v[136:139], v114 offset:10240
    ds_read_b128 v[140:143], v114 offset:11264
    ds_read_b128 v[144:147], v114 offset:12288
    ds_read_b128 v[148:151], v114 offset:13312
    ds_read_b128 v[152:155], v114 offset:14336
    s_waitcnt vmcnt(14)
    s_waitcnt lgkmcnt(9)
    v_mfma_f32_16x16x32_bf16 v[116:119], v[156:159], v[60:63], v[116:119]
    s_mul_i32 s40, s55, 20480
    s_add_u32 s40, s40, s46
    s_add_u32 s40, s40, 3072
    s_mul_i32 s41, s34, 5120
    s_add_u32 m0, s41, 105472
    s_nop 0
    buffer_load_dwordx4 v7, s[12:15], s40 offen lds
    s_waitcnt lgkmcnt(8)
    v_mfma_f32_16x16x32_bf16 v[120:123], v[160:163], v[60:63], v[120:123]
    s_waitcnt lgkmcnt(7)
    v_mfma_f32_16x16x32_bf16 v[124:127], v[164:167], v[60:63], v[124:127]
    s_mul_i32 s40, s55, 20480
    s_add_u32 s40, s40, s46
    s_add_u32 s40, s40, 4096
    s_mul_i32 s41, s34, 5120
    s_add_u32 m0, s41, 106496
    s_nop 0
    buffer_load_dwordx4 v7, s[12:15], s40 offen lds
    s_waitcnt lgkmcnt(6)
    v_mfma_f32_16x16x32_bf16 v[128:131], v[168:171], v[60:63], v[128:131]
    s_waitcnt lgkmcnt(5)
    v_mfma_f32_16x16x32_bf16 v[132:135], v[172:175], v[60:63], v[132:135]
    s_lshl_b32 s42, s55, 12
    s_add_u32 s42, s42, s47
    buffer_load_dwordx4 v[88:91], v7, s[12:15], s42 offen offset:0
    ds_read_b128 v[156:159], v114 offset:15360
    ds_read_b128 v[160:163], v114 offset:16384
    ds_read_b128 v[164:167], v114 offset:17408
    ds_read_b128 v[168:171], v114 offset:18432
    ds_read_b128 v[172:175], v114 offset:19456
    s_waitcnt vmcnt(16)
    s_waitcnt lgkmcnt(9)
    v_mfma_f32_16x16x32_bf16 v[116:119], v[136:139], v[64:67], v[116:119]
    s_lshl_b32 s42, s55, 12
    s_add_u32 s42, s42, s47
    buffer_load_dwordx4 v[92:95], v7, s[12:15], s42 offen offset:1024
    s_waitcnt lgkmcnt(8)
    v_mfma_f32_16x16x32_bf16 v[120:123], v[140:143], v[64:67], v[120:123]
    s_waitcnt lgkmcnt(7)
    v_mfma_f32_16x16x32_bf16 v[124:127], v[144:147], v[64:67], v[124:127]
    s_lshl_b32 s42, s55, 12
    s_add_u32 s42, s42, s47
    buffer_load_dwordx4 v[96:99], v7, s[12:15], s42 offen offset:2048
    s_waitcnt lgkmcnt(6)
    v_mfma_f32_16x16x32_bf16 v[128:131], v[148:151], v[64:67], v[128:131]
    s_waitcnt lgkmcnt(5)
    v_mfma_f32_16x16x32_bf16 v[132:135], v[152:155], v[64:67], v[132:135]
    s_lshl_b32 s42, s55, 12
    s_add_u32 s42, s42, s47
    buffer_load_dwordx4 v[100:103], v7, s[12:15], s42 offen offset:3072
    s_waitcnt vmcnt(18)
    s_waitcnt lgkmcnt(4)
    v_mfma_f32_16x16x32_bf16 v[116:119], v[156:159], v[68:71], v[116:119]
    s_cmp_ge_u32 s34, 2
    s_cbranch_scc1 k3_y_1
    s_mul_i32 s40, s34, 40960
    s_add_u32 s40, s40, s45
    s_mul_i32 s41, s34, 5120
    s_add_u32 m0, s41, 122880
    s_nop 0
    buffer_load_dwordx4 v104, s[8:11], s40 offen lds
    s_add_u32 m0, s41, 123904
    s_nop 0
    buffer_load_dwordx4 v105, s[8:11], s40 offen lds
    s_add_u32 m0, s41, 124928
    s_nop 0
    buffer_load_dwordx4 v106, s[8:11], s40 offen lds
    s_add_u32 m0, s41, 125952
    s_nop 0
    buffer_load_dwordx4 v107, s[8:11], s40 offen lds
    s_add_u32 m0, s41, 126976
    s_nop 0
    buffer_load_dwordx4 v108, s[8:11], s40 offen lds
    s_branch k3_xy_2
k3_y_1:
    v_lshrrev_b32 v4, 3, v1
    v_lshlrev_b32 v4, 12, v4
    v_and_b32 v5, 7, v1
    v_lshl_add_u32 v112, v5, 4, v4
    s_sub_u32 s42, s34, 2
    s_mul_i32 s40, s42, 40
    s_mul_i32 s41, s33, 80
    s_add_u32 s40, s40, s41
    s_lshl_b32 s40, s40, 12
    s_lshl_b32 s41, s32, 7
    s_add_u32 s40, s40, s41
    s_add_u32 s40, s40, 8912896
    s_mul_i32 s41, s42, 5120
    s_add_u32 m0, s41, 133120
    s_nop 0
    buffer_load_dwordx4 v112, s[12:15], s40 offen lds
    s_add_u32 s40, s40, 32768
    s_add_u32 m0, s41, 134144
    s_nop 0
    buffer_load_dwordx4 v112, s[12:15], s40 offen lds
    s_add_u32 s40, s40, 32768
    s_add_u32 m0, s41, 135168
    s_nop 0
    buffer_load_dwordx4 v112, s[12:15], s40 offen lds
    s_add_u32 s40, s40, 32768
    s_add_u32 m0, s41, 136192
    s_nop 0
    buffer_load_dwordx4 v112, s[12:15], s40 offen lds
    s_add_u32 s40, s40, 32768
    s_add_u32 m0, s41, 137216
    s_nop 0
    buffer_load_dwordx4 v112, s[12:15], s40 offen lds
    s_add_u32 s40, s40, 32768
k3_xy_2:
    s_lshl_b32 s40, s32, 9
    s_lshl_b32 s41, s34, 7
    s_add_u32 s40, s40, s41
    s_add_u32 s40, s40, 14680064
    v_lshlrev_b32 v4, 3, v3
    buffer_load_dwordx2 v[110:111], v4, s[12:15], s40 offen
    s_waitcnt lgkmcnt(3)
    v_mfma_f32_16x16x32_bf16 v[120:123], v[160:163], v[68:71], v[120:123]
    s_waitcnt lgkmcnt(2)
    v_mfma_f32_16x16x32_bf16 v[124:127], v[164:167], v[68:71], v[124:127]
    s_waitcnt lgkmcnt(1)
    v_mfma_f32_16x16x32_bf16 v[128:131], v[168:171], v[68:71], v[128:131]
    s_waitcnt lgkmcnt(0)
    v_mfma_f32_16x16x32_bf16 v[132:135], v[172:175], v[68:71], v[132:135]
    s_waitcnt vmcnt(19)
    s_barrier
    ds_read_b128 v[136:139], v114 offset:20480
    ds_read_b128 v[140:143], v114 offset:21504
    ds_read_b128 v[144:147], v114 offset:22528
    ds_read_b128 v[148:151], v114 offset:23552
    ds_read_b128 v[152:155], v114 offset:24576
    ds_read_b128 v[156:159], v114 offset:25600
    ds_read_b128 v[160:163], v114 offset:26624
    ds_read_b128 v[164:167], v114 offset:27648
    ds_read_b128 v[168:171], v114 offset:28672
    ds_read_b128 v[172:175], v114 offset:29696
    s_waitcnt vmcnt(18)
    s_waitcnt lgkmcnt(9)
    v_mfma_f32_16x16x32_bf16 v[116:119], v[136:139], v[72:75], v[116:119]
    s_waitcnt lgkmcnt(8)
    v_mfma_f32_16x16x32_bf16 v[120:123], v[140:143], v[72:75], v[120:123]
    s_waitcnt lgkmcnt(7)
    v_mfma_f32_16x16x32_bf16 v[124:127], v[144:147], v[72:75], v[124:127]
    s_waitcnt lgkmcnt(6)
    v_mfma_f32_16x16x32_bf16 v[128:131], v[148:151], v[72:75], v[128:131]
    s_waitcnt lgkmcnt(5)
    v_mfma_f32_16x16x32_bf16 v[132:135], v[152:155], v[72:75], v[132:135]
    ds_read_b128 v[136:139], v114 offset:30720
    ds_read_b128 v[140:143], v114 offset:31744
    ds_read_b128 v[144:147], v114 offset:32768
    ds_read_b128 v[148:151], v114 offset:33792
    ds_read_b128 v[152:155], v114 offset:34816
    s_waitcnt vmcnt(17)
    s_waitcnt lgkmcnt(9)
    v_mfma_f32_16x16x32_bf16 v[116:119], v[156:159], v[76:79], v[116:119]
    s_waitcnt lgkmcnt(8)
    v_mfma_f32_16x16x32_bf16 v[120:123], v[160:163], v[76:79], v[120:123]
    s_waitcnt lgkmcnt(7)
    v_mfma_f32_16x16x32_bf16 v[124:127], v[164:167], v[76:79], v[124:127]
    s_waitcnt lgkmcnt(6)
    v_mfma_f32_16x16x32_bf16 v[128:131], v[168:171], v[76:79], v[128:131]
    s_waitcnt lgkmcnt(5)
    v_mfma_f32_16x16x32_bf16 v[132:135], v[172:175], v[76:79], v[132:135]
    ds_read_b128 v[156:159], v114 offset:35840
    ds_read_b128 v[160:163], v114 offset:36864
    ds_read_b128 v[164:167], v114 offset:37888
    ds_read_b128 v[168:171], v114 offset:38912
    ds_read_b128 v[172:175], v114 offset:39936
    s_waitcnt vmcnt(16)
    s_waitcnt lgkmcnt(9)
    v_mfma_f32_16x16x32_bf16 v[116:119], v[136:139], v[80:83], v[116:119]
    s_waitcnt lgkmcnt(8)
    v_mfma_f32_16x16x32_bf16 v[120:123], v[140:143], v[80:83], v[120:123]
    s_waitcnt lgkmcnt(7)
    v_mfma_f32_16x16x32_bf16 v[124:127], v[144:147], v[80:83], v[124:127]
    s_waitcnt lgkmcnt(6)
    v_mfma_f32_16x16x32_bf16 v[128:131], v[148:151], v[80:83], v[128:131]
    s_waitcnt lgkmcnt(5)
    v_mfma_f32_16x16x32_bf16 v[132:135], v[152:155], v[80:83], v[132:135]
    s_waitcnt vmcnt(15)
    s_waitcnt lgkmcnt(4)
    v_mfma_f32_16x16x32_bf16 v[116:119], v[156:159], v[84:87], v[116:119]
    s_waitcnt lgkmcnt(3)
    v_mfma_f32_16x16x32_bf16 v[120:123], v[160:163], v[84:87], v[120:123]
    s_waitcnt lgkmcnt(2)
    v_mfma_f32_16x16x32_bf16 v[124:127], v[164:167], v[84:87], v[124:127]
    s_waitcnt lgkmcnt(1)
    v_mfma_f32_16x16x32_bf16 v[128:131], v[168:171], v[84:87], v[128:131]
    s_waitcnt lgkmcnt(0)
    v_mfma_f32_16x16x32_bf16 v[132:135], v[172:175], v[84:87], v[132:135]
    s_waitcnt vmcnt(10)
    s_barrier
    ds_read_b128 v[136:139], v114 offset:40960
    ds_read_b128 v[140:143], v114 offset:41984
    ds_read_b128 v[144:147], v114 offset:43008
    ds_read_b128 v[148:151], v114 offset:44032
    ds_read_b128 v[152:155], v114 offset:45056
    ds_read_b128 v[156:159], v114 offset:46080
    ds_read_b128 v[160:163], v114 offset:47104
    ds_read_b128 v[164:167], v114 offset:48128
    ds_read_b128 v[168:171], v114 offset:49152
    ds_read_b128 v[172:175], v114 offset:50176
    s_waitcnt vmcnt(9)
    s_waitcnt lgkmcnt(9)
    v_mfma_f32_16x16x32_bf16 v[116:119], v[136:139], v[88:91], v[116:119]
    s_waitcnt lgkmcnt(8)
    v_mfma_f32_16x16x32_bf16 v[120:123], v[140:143], v[88:91], v[120:123]
    s_waitcnt lgkmcnt(7)
    v_mfma_f32_16x16x32_bf16 v[124:127], v[144:147], v[88:91], v[124:127]
    s_waitcnt lgkmcnt(6)
    v_mfma_f32_16x16x32_bf16 v[128:131], v[148:151], v[88:91], v[128:131]
    s_waitcnt lgkmcnt(5)
    v_mfma_f32_16x16x32_bf16 v[132:135], v[152:155], v[88:91], v[132:135]
    ds_read_b128 v[136:139], v114 offset:51200
    ds_read_b128 v[140:143], v114 offset:52224
    ds_read_b128 v[144:147], v114 offset:53248
    ds_read_b128 v[148:151], v114 offset:54272
    ds_read_b128 v[152:155], v114 offset:55296
    s_waitcnt vmcnt(8)
    s_waitcnt lgkmcnt(9)
    v_mfma_f32_16x16x32_bf16 v[116:119], v[156:159], v[92:95], v[116:119]
    s_waitcnt lgkmcnt(8)
    v_mfma_f32_16x16x32_bf16 v[120:123], v[160:163], v[92:95], v[120:123]
    s_waitcnt lgkmcnt(7)
    v_mfma_f32_16x16x32_bf16 v[124:127], v[164:167], v[92:95], v[124:127]
    s_waitcnt lgkmcnt(6)
    v_mfma_f32_16x16x32_bf16 v[128:131], v[168:171], v[92:95], v[128:131]
    s_waitcnt lgkmcnt(5)
    v_mfma_f32_16x16x32_bf16 v[132:135], v[172:175], v[92:95], v[132:135]
    ds_read_b128 v[156:159], v114 offset:56320
    ds_read_b128 v[160:163], v114 offset:57344
    ds_read_b128 v[164:167], v114 offset:58368
    ds_read_b128 v[168:171], v114 offset:59392
    ds_read_b128 v[172:175], v114 offset:60416
    s_waitcnt vmcnt(7)
    s_waitcnt lgkmcnt(9)
    v_mfma_f32_16x16x32_bf16 v[116:119], v[136:139], v[96:99], v[116:119]
    s_waitcnt lgkmcnt(8)
    v_mfma_f32_16x16x32_bf16 v[120:123], v[140:143], v[96:99], v[120:123]
    s_waitcnt lgkmcnt(7)
    v_mfma_f32_16x16x32_bf16 v[124:127], v[144:147], v[96:99], v[124:127]
    s_waitcnt lgkmcnt(6)
    v_mfma_f32_16x16x32_bf16 v[128:131], v[148:151], v[96:99], v[128:131]
    s_waitcnt lgkmcnt(5)
    v_mfma_f32_16x16x32_bf16 v[132:135], v[152:155], v[96:99], v[132:135]
    s_waitcnt vmcnt(6)
    s_waitcnt lgkmcnt(4)
    v_mfma_f32_16x16x32_bf16 v[116:119], v[156:159], v[100:103], v[116:119]
    s_waitcnt lgkmcnt(3)
    v_mfma_f32_16x16x32_bf16 v[120:123], v[160:163], v[100:103], v[120:123]
    s_waitcnt lgkmcnt(2)
    v_mfma_f32_16x16x32_bf16 v[124:127], v[164:167], v[100:103], v[124:127]
    s_waitcnt lgkmcnt(1)
    v_mfma_f32_16x16x32_bf16 v[128:131], v[168:171], v[100:103], v[128:131]
    s_waitcnt lgkmcnt(0)
    v_mfma_f32_16x16x32_bf16 v[132:135], v[172:175], v[100:103], v[132:135]
    s_lshl_b32 s40, s34, 4
    v_add_u32 v4, s40, v3
    v_mul_u32_u24 v4, 160, v4
    v_lshl_add_u32 v176, v2, 3, v4
    v_add_u32 v177, 122880, v176
    v_lshrrev_b32 v5, 2, v3
    v_lshl_add_u32 v4, v2, 2, v5
    v_lshlrev_b32 v4, 7, v4
    v_and_b32 v5, 3, v3
    v_lshl_add_u32 v4, v5, 3, v4
    s_lshl_b32 s40, s34, 5
    s_add_u32 s40, s40, 133120
    v_add_u32 v178, s40, v4
    s_mov_b32 s46, 0xbfb8aa3b
    s_mov_b32 s47, 0xbfb8aa3b
    v_pk_mul_f32 v[8:9], v[116:117], s[46:47]
    v_pk_mul_f32 v[10:11], v[118:119], s[46:47]
    v_pk_mul_f32 v[12:13], v[120:121], s[46:47]
    v_pk_mul_f32 v[14:15], v[122:123], s[46:47]
    v_pk_mul_f32 v[16:17], v[124:125], s[46:47]
    v_pk_mul_f32 v[18:19], v[126:127], s[46:47]
    v_pk_mul_f32 v[20:21], v[128:129], s[46:47]
    v_pk_mul_f32 v[22:23], v[130:131], s[46:47]
    v_pk_mul_f32 v[24:25], v[132:133], s[46:47]
    v_pk_mul_f32 v[26:27], v[134:135], s[46:47]
    s_waitcnt vmcnt(0)
    s_barrier
    ds_read_b64 v[136:137], v177 offset:0
    ds_read_b64 v[138:139], v177 offset:32
    ds_read_b64 v[140:141], v177 offset:64
    ds_read_b64 v[142:143], v177 offset:96
    ds_read_b64 v[144:145], v177 offset:128
    ds_read_b64_tr_b16 v[146:147], v178 offset:0
    ds_read_b64_tr_b16 v[148:149], v178 offset:2048
    ds_read_b64_tr_b16 v[150:151], v178 offset:4096
    ds_read_b64_tr_b16 v[152:153], v178 offset:6144
    ds_read_b64_tr_b16 v[154:155], v178 offset:8192
    v_exp_f32 v8, v8
    v_exp_f32 v9, v9
    v_exp_f32 v10, v10
    v_exp_f32 v11, v11
    v_exp_f32 v12, v12
    v_exp_f32 v13, v13
    v_exp_f32 v14, v14
    v_exp_f32 v15, v15
    v_exp_f32 v16, v16
    v_exp_f32 v17, v17
    v_exp_f32 v18, v18
    v_exp_f32 v19, v19
    v_exp_f32 v20, v20
    v_exp_f32 v21, v21
    v_exp_f32 v22, v22
    v_exp_f32 v23, v23
    v_exp_f32 v24, v24
    v_exp_f32 v25, v25
    v_exp_f32 v26, v26
    v_exp_f32 v27, v27
    v_pk_add_f32 v[8:9], v[8:9], 1.0 op_sel_hi:[1,0]
    v_pk_add_f32 v[10:11], v[10:11], 1.0 op_sel_hi:[1,0]
    v_pk_add_f32 v[12:13], v[12:13], 1.0 op_sel_hi:[1,0]
    v_pk_add_f32 v[14:15], v[14:15], 1.0 op_sel_hi:[1,0]
    v_pk_add_f32 v[16:17], v[16:17], 1.0 op_sel_hi:[1,0]
    v_pk_add_f32 v[18:19], v[18:19], 1.0 op_sel_hi:[1,0]
    v_pk_add_f32 v[20:21], v[20:21], 1.0 op_sel_hi:[1,0]
    v_pk_add_f32 v[22:23], v[22:23], 1.0 op_sel_hi:[1,0]
    v_pk_add_f32 v[24:25], v[24:25], 1.0 op_sel_hi:[1,0]
    v_pk_add_f32 v[26:27], v[26:27], 1.0 op_sel_hi:[1,0]
    v_rcp_f32 v8, v8
    v_rcp_f32 v9, v9
    v_rcp_f32 v10, v10
    v_rcp_f32 v11, v11
    v_rcp_f32 v12, v12
    v_rcp_f32 v13, v13
    v_rcp_f32 v14, v14
    v_rcp_f32 v15, v15
    v_rcp_f32 v16, v16
    v_rcp_f32 v17, v17
    v_rcp_f32 v18, v18
    v_rcp_f32 v19, v19
    v_rcp_f32 v20, v20
    v_rcp_f32 v21, v21
    v_rcp_f32 v22, v22
    v_rcp_f32 v23, v23
    v_rcp_f32 v24, v24
    v_rcp_f32 v25, v25
    v_rcp_f32 v26, v26
    v_rcp_f32 v27, v27
    v_pk_mul_f32 v[8:9], v[8:9], v[116:117]
    v_pk_mul_f32 v[10:11], v[10:11], v[118:119]
    v_pk_mul_f32 v[12:13], v[12:13], v[120:121]
    v_pk_mul_f32 v[14:15], v[14:15], v[122:123]
    v_pk_mul_f32 v[16:17], v[16:17], v[124:125]
    v_pk_mul_f32 v[18:19], v[18:19], v[126:127]
    v_pk_mul_f32 v[20:21], v[20:21], v[128:129]
    v_pk_mul_f32 v[22:23], v[22:23], v[130:131]
    v_pk_mul_f32 v[24:25], v[24:25], v[132:133]
    v_pk_mul_f32 v[26:27], v[26:27], v[134:135]
    s_waitcnt lgkmcnt(0)
    v_lshlrev_b32 v28, 16, v136
    v_and_b32 v29, 0xffff0000, v136
    v_lshlrev_b32 v48, 16, v146
    v_and_b32 v49, 0xffff0000, v146
    v_lshlrev_b32 v30, 16, v137
    v_and_b32 v31, 0xffff0000, v137
    v_lshlrev_b32 v50, 16, v147
    v_and_b32 v51, 0xffff0000, v147
    v_lshlrev_b32 v32, 16, v138
    v_and_b32 v33, 0xffff0000, v138
    v_lshlrev_b32 v52, 16, v148
    v_and_b32 v53, 0xffff0000, v148
    v_lshlrev_b32 v34, 16, v139
    v_and_b32 v35, 0xffff0000, v139
    v_lshlrev_b32 v54, 16, v149
    v_and_b32 v55, 0xffff0000, v149
    v_lshlrev_b32 v36, 16, v140
    v_and_b32 v37, 0xffff0000, v140
    v_lshlrev_b32 v56, 16, v150
    v_and_b32 v57, 0xffff0000, v150
    v_lshlrev_b32 v38, 16, v141
    v_and_b32 v39, 0xffff0000, v141
    v_lshlrev_b32 v58, 16, v151
    v_and_b32 v59, 0xffff0000, v151
    v_lshlrev_b32 v40, 16, v142
    v_and_b32 v41, 0xffff0000, v142
    v_lshlrev_b32 v60, 16, v152
    v_and_b32 v61, 0xffff0000, v152
    v_lshlrev_b32 v42, 16, v143
    v_and_b32 v43, 0xffff0000, v143
    v_lshlrev_b32 v62, 16, v153
    v_and_b32 v63, 0xffff0000, v153
    v_lshlrev_b32 v44, 16, v144
    v_and_b32 v45, 0xffff0000, v144
    v_lshlrev_b32 v64, 16, v154
    v_and_b32 v65, 0xffff0000, v154
    v_lshlrev_b32 v46, 16, v145
    v_and_b32 v47, 0xffff0000, v145
    v_lshlrev_b32 v66, 16, v155
    v_and_b32 v67, 0xffff0000, v155
    v_mov_b32 v180, v111
    v_pk_add_f32 v[68:69], v[28:29], v[110:111] op_sel_hi:[1,0] neg_lo:[0,1] neg_hi:[0,1]
    v_pk_add_f32 v[70:71], v[30:31], v[110:111] op_sel_hi:[1,0] neg_lo:[0,1] neg_hi:[0,1]
    v_pk_add_f32 v[72:73], v[32:33], v[110:111] op_sel_hi:[1,0] neg_lo:[0,1] neg_hi:[0,1]
    v_pk_add_f32 v[74:75], v[34:35], v[110:111] op_sel_hi:[1,0] neg_lo:[0,1] neg_hi:[0,1]
    v_pk_add_f32 v[76:77], v[36:37], v[110:111] op_sel_hi:[1,0] neg_lo:[0,1] neg_hi:[0,1]
    v_pk_add_f32 v[78:79], v[38:39], v[110:111] op_sel_hi:[1,0] neg_lo:[0,1] neg_hi:[0,1]
    v_pk_add_f32 v[80:81], v[40:41], v[110:111] op_sel_hi:[1,0] neg_lo:[0,1] neg_hi:[0,1]
    v_pk_add_f32 v[82:83], v[42:43], v[110:111] op_sel_hi:[1,0] neg_lo:[0,1] neg_hi:[0,1]
    v_pk_add_f32 v[84:85], v[44:45], v[110:111] op_sel_hi:[1,0] neg_lo:[0,1] neg_hi:[0,1]
    v_pk_add_f32 v[86:87], v[46:47], v[110:111] op_sel_hi:[1,0] neg_lo:[0,1] neg_hi:[0,1]
    v_pk_mul_f32 v[68:69], v[68:69], v[180:181] op_sel_hi:[1,0]
    v_pk_mul_f32 v[70:71], v[70:71], v[180:181] op_sel_hi:[1,0]
    v_pk_mul_f32 v[72:73], v[72:73], v[180:181] op_sel_hi:[1,0]
    v_pk_mul_f32 v[74:75], v[74:75], v[180:181] op_sel_hi:[1,0]
    v_pk_mul_f32 v[76:77], v[76:77], v[180:181] op_sel_hi:[1,0]
    v_pk_mul_f32 v[78:79], v[78:79], v[180:181] op_sel_hi:[1,0]
    v_pk_mul_f32 v[80:81], v[80:81], v[180:181] op_sel_hi:[1,0]
    v_pk_mul_f32 v[82:83], v[82:83], v[180:181] op_sel_hi:[1,0]
    v_pk_mul_f32 v[84:85], v[84:85], v[180:181] op_sel_hi:[1,0]
    v_pk_mul_f32 v[86:87], v[86:87], v[180:181] op_sel_hi:[1,0]
    v_pk_mul_f32 v[68:69], v[68:69], v[48:49]
    v_pk_mul_f32 v[70:71], v[70:71], v[50:51]
    v_pk_mul_f32 v[72:73], v[72:73], v[52:53]
    v_pk_mul_f32 v[74:75], v[74:75], v[54:55]
    v_pk_mul_f32 v[76:77], v[76:77], v[56:57]
    v_pk_mul_f32 v[78:79], v[78:79], v[58:59]
    v_pk_mul_f32 v[80:81], v[80:81], v[60:61]
    v_pk_mul_f32 v[82:83], v[82:83], v[62:63]
    v_pk_mul_f32 v[84:85], v[84:85], v[64:65]
    v_pk_mul_f32 v[86:87], v[86:87], v[66:67]
    v_pk_fma_f32 v[68:69], v[68:69], v[8:9], v[28:29]
    v_pk_fma_f32 v[70:71], v[70:71], v[10:11], v[30:31]
    v_pk_fma_f32 v[72:73], v[72:73], v[12:13], v[32:33]
    v_pk_fma_f32 v[74:75], v[74:75], v[14:15], v[34:35]
    v_pk_fma_f32 v[76:77], v[76:77], v[16:17], v[36:37]
    v_pk_fma_f32 v[78:79], v[78:79], v[18:19], v[38:39]
    v_pk_fma_f32 v[80:81], v[80:81], v[20:21], v[40:41]
    v_pk_fma_f32 v[82:83], v[82:83], v[22:23], v[42:43]
    v_pk_fma_f32 v[84:85], v[84:85], v[24:25], v[44:45]
    v_pk_fma_f32 v[86:87], v[86:87], v[26:27], v[46:47]
    v_cvt_pk_bf16_f32 v136, v68, v69
    v_cvt_pk_bf16_f32 v137, v70, v71
    v_cvt_pk_bf16_f32 v138, v72, v73
    v_cvt_pk_bf16_f32 v139, v74, v75
    v_cvt_pk_bf16_f32 v140, v76, v77
    v_cvt_pk_bf16_f32 v141, v78, v79
    v_cvt_pk_bf16_f32 v142, v80, v81
    v_cvt_pk_bf16_f32 v143, v82, v83
    v_cvt_pk_bf16_f32 v144, v84, v85
    v_cvt_pk_bf16_f32 v145, v86, v87
    v_add_u32 v182, 143360, v176
    ds_write_b64 v182, v[136:137] offset:0
    ds_write_b64 v182, v[138:139] offset:32
    ds_write_b64 v182, v[140:141] offset:64
    ds_write_b64 v182, v[142:143] offset:96
    ds_write_b64 v182, v[144:145] offset:128
    s_mul_i32 s40, s34, 2560
    s_add_u32 s40, s40, 143360
    v_add_u32 v4, s40, v7
    s_waitcnt lgkmcnt(0)
    ds_read_b128 v[8:11], v4 offset:0
    ds_read_b128 v[12:15], v4 offset:1024
    ds_read_b128 v[16:19], v4 offset:2048
    s_mul_i32 s40, s34, 20480
    s_add_u32 s40, s40, s45
    s_waitcnt lgkmcnt(0)
    buffer_store_dwordx4 v[8:11], v104, s[16:19], s40 offen
    buffer_store_dwordx4 v[12:15], v105, s[16:19], s40 offen
    s_mov_b32 exec_hi, 0
    buffer_store_dwordx4 v[16:19], v106, s[16:19], s40 offen
    s_mov_b64 exec, -1
k3_kernel_end:
    s_endpgm
.section .rodata,"a"
.p2align 6
.amdhsa_kernel k1_kernel
  .amdhsa_next_free_vgpr 248
  .amdhsa_next_free_sgpr 102
  .amdhsa_accum_offset 248
  .amdhsa_group_segment_fixed_size 0
  .amdhsa_kernarg_size 112
  .amdhsa_user_sgpr_count 2
  .amdhsa_user_sgpr_kernarg_segment_ptr 1
  .amdhsa_system_sgpr_workgroup_id_x 1
.end_amdhsa_kernel
.p2align 6
.amdhsa_kernel k2_kernel
  .amdhsa_next_free_vgpr 197
  .amdhsa_next_free_sgpr 102
  .amdhsa_accum_offset 200
  .amdhsa_group_segment_fixed_size 0
  .amdhsa_kernarg_size 112
  .amdhsa_user_sgpr_count 2
  .amdhsa_user_sgpr_kernarg_segment_ptr 1
  .amdhsa_system_sgpr_workgroup_id_x 1
.end_amdhsa_kernel
.p2align 6
.amdhsa_kernel k3_kernel
  .amdhsa_next_free_vgpr 183
  .amdhsa_next_free_sgpr 102
  .amdhsa_accum_offset 184
  .amdhsa_group_segment_fixed_size 0
  .amdhsa_kernarg_size 112
  .amdhsa_user_sgpr_count 2
  .amdhsa_user_sgpr_kernarg_segment_ptr 1
  .amdhsa_system_sgpr_workgroup_id_x 1
.end_amdhsa_kernel
```

```asm
; @launch kernel=k1_kernel grid=(256,1,1) block=(512,1,1) lds=163840
; @launch kernel=k2_kernel grid=(512,1,1) block=(256,1,1) lds=81920
; @launch kernel=k3_kernel grid=(256,1,1) block=(256,1,1) lds=153600
.amdgcn_target "amdgcn-amd-amdhsa--gfx950"
.text
.globl k1_kernel
.p2align 8
.type k1_kernel,@function
k1_kernel:
    s_cmp_ge_u32 s2, 256
    s_cbranch_scc1 k1_kernel_end
    s_load_dwordx2 s[4:5], s[0:1], 0
    s_load_dwordx2 s[8:9], s[0:1], 56
    s_load_dwordx2 s[12:13], s[0:1], 8
    s_load_dwordx2 s[16:17], s[0:1], 16
    s_load_dwordx2 s[20:21], s[0:1], 24
    s_load_dwordx2 s[24:25], s[0:1], 104
    s_load_dwordx2 s[28:29], s[0:1], 96
    s_load_dwordx2 s[32:33], s[0:1], 64
    s_load_dwordx2 s[36:37], s[0:1], 32
    v_lshrrev_b32 v2, 6, v0
    v_and_b32 v1, 63, v0
    v_readfirstlane_b32 s42, v2
    v_lshrrev_b32 v2, 4, v1
    v_and_b32 v3, 15, v1
    s_and_b32 s48, s2, 7
    s_lshr_b32 s49, s2, 3
    s_lshr_b32 s66, s48, 1
    s_and_b32 s67, s48, 1
    s_lshl_b32 s40, s66, 3
    s_and_b32 s48, s49, 7
    s_add_u32 s40, s40, s48
    s_lshl_b32 s41, s67, 2
    s_lshr_b32 s48, s49, 3
    s_add_u32 s41, s41, s48
    s_mul_i32 s52, s40, 81920
    s_mul_i32 s54, s41, 192
    s_add_u32 s53, s54, 1536
    s_lshl_b32 s60, s42, 11
    s_mul_i32 s61, s42, 3072
    s_mov_b32 s6, 2621440
    s_mov_b32 s7, 0x20000
    s_mov_b32 s10, 1966080
    s_mov_b32 s11, 0x20000
    s_lshl_b32 s48, s42, 3
    v_add_u32 v4, s48, v2
    v_and_b32 v5, 15, v4
    v_xor_b32 v5, v5, v3
    v_mul_u32_u24 v4, 1280, v4
    v_lshl_add_u32 v38, v5, 4, v4
    v_add_u32 v4, s48, v2
    v_add_u32 v4, 4, v4
    v_and_b32 v5, 15, v4
    v_xor_b32 v5, v5, v3
    v_mul_u32_u24 v4, 1280, v4
    v_lshl_add_u32 v39, v5, 4, v4
    s_mul_i32 s48, s42, 192
    v_add_u32 v4, s48, v1
    v_mul_u32_u24 v5, 43691, v4
    v_lshrrev_b32 v5, 19, v5
    v_mul_u32_u24 v6, 12, v5
    v_sub_u32 v4, v4, v6
    v_lshrrev_b32 v6, 2, v5
    v_and_b32 v6, 2, v6
    v_xor_b32 v4, v4, v6
    v_mul_u32_u24 v5, 3072, v5
    v_lshl_add_u32 v40, v4, 4, v5
    v_add_u32 v4, s48, v1
    v_add_u32 v4, 64, v4
    v_mul_u32_u24 v5, 43691, v4
    v_lshrrev_b32 v5, 19, v5
    v_mul_u32_u24 v6, 12, v5
    v_sub_u32 v4, v4, v6
    v_lshrrev_b32 v6, 2, v5
    v_and_b32 v6, 2, v6
    v_xor_b32 v4, v4, v6
    v_mul_u32_u24 v5, 3072, v5
    v_lshl_add_u32 v41, v4, 4, v5
    v_add_u32 v4, s48, v1
    v_add_u32 v4, 128, v4
    v_mul_u32_u24 v5, 43691, v4
    v_lshrrev_b32 v5, 19, v5
    v_mul_u32_u24 v6, 12, v5
    v_sub_u32 v4, v4, v6
    v_lshrrev_b32 v6, 2, v5
    v_and_b32 v6, 2, v6
    v_xor_b32 v4, v4, v6
    v_mul_u32_u24 v5, 3072, v5
    v_lshl_add_u32 v42, v4, 4, v5
    s_add_u32 s48, s40, s41
    s_mul_i32 s49, s48, 52
    s_lshr_b32 s49, s49, 8
    s_mul_i32 s49, s49, 5
    s_sub_u32 s51, s48, s49
    s_add_u32 s49, s51, 0
    s_sub_u32 s50, s49, 5
    s_cmp_ge_u32 s49, 5
    s_cselect_b32 s49, s50, s49
    s_lshl_b32 s90, s49, 8
    s_mul_i32 s95, s49, 393216
    s_add_u32 s49, s51, 1
    s_sub_u32 s50, s49, 5
    s_cmp_ge_u32 s49, 5
    s_cselect_b32 s49, s50, s49
    s_lshl_b32 s91, s49, 8
    s_mul_i32 s96, s49, 393216
    s_waitcnt lgkmcnt(0)
    s_add_u32 s65, s52, s90
    s_add_u32 m0, s60, 0
    s_nop 0
    buffer_load_dwordx4 v38, s[4:7], s65 offen lds
    s_add_u32 s65, s52, s90
    s_add_u32 m0, s60, 1024
    s_nop 0
    buffer_load_dwordx4 v39, s[4:7], s65 offen lds
    s_add_u32 s65, s53, s95
    s_add_u32 m0, s61, 81920
    s_nop 0
    buffer_load_dwordx4 v40, s[8:11], s65 offen lds
    s_add_u32 s65, s53, s95
    s_add_u32 m0, s61, 82944
    s_nop 0
    buffer_load_dwordx4 v41, s[8:11], s65 offen lds
    s_add_u32 s65, s53, s95
    s_add_u32 m0, s61, 83968
    s_nop 0
    buffer_load_dwordx4 v42, s[8:11], s65 offen lds
    s_add_u32 s49, s51, 2
    s_sub_u32 s50, s49, 5
    s_cmp_ge_u32 s49, 5
    s_cselect_b32 s49, s50, s49
    s_lshl_b32 s92, s49, 8
    s_mul_i32 s97, s49, 393216
    s_add_u32 s49, s51, 3
    s_sub_u32 s50, s49, 5
    s_cmp_ge_u32 s49, 5
    s_cselect_b32 s49, s50, s49
    s_lshl_b32 s93, s49, 8
    s_mul_i32 s98, s49, 393216
    s_add_u32 s49, s51, 4
    s_sub_u32 s50, s49, 5
    s_cmp_ge_u32 s49, 5
    s_cselect_b32 s49, s50, s49
    s_lshl_b32 s94, s49, 8
    s_mul_i32 s99, s49, 393216
    s_mov_b32 s14, 2621440
    s_mov_b32 s15, 0x20000
    s_mov_b32 s18, 2621440
    s_mov_b32 s19, 0x20000
    s_mov_b32 s22, 5120
    s_mov_b32 s23, 0x20000
    s_mov_b32 s26, 15990784
    s_mov_b32 s27, 0x20000
    s_mov_b32 s30, 256
    s_mov_b32 s31, 0x20000
    s_mov_b32 s34, 8388608
    s_mov_b32 s35, 0x20000
    s_mov_b32 s38, 2621440
    s_mov_b32 s39, 0x20000
    v_lshlrev_b32 v36, 7, v1
    s_barrier
    s_add_u32 s65, s52, s91
    s_add_u32 m0, s60, 16384
    s_nop 0
    buffer_load_dwordx4 v38, s[4:7], s65 offen lds
    s_add_u32 s65, s52, s91
    s_add_u32 m0, s60, 17408
    s_nop 0
    buffer_load_dwordx4 v39, s[4:7], s65 offen lds
    s_add_u32 s65, s53, s96
    s_add_u32 m0, s61, 106496
    s_nop 0
    buffer_load_dwordx4 v40, s[8:11], s65 offen lds
    s_add_u32 s65, s53, s96
    s_add_u32 m0, s61, 107520
    s_nop 0
    buffer_load_dwordx4 v41, s[8:11], s65 offen lds
    s_add_u32 s65, s53, s96
    s_add_u32 m0, s61, 108544
    s_nop 0
    buffer_load_dwordx4 v42, s[8:11], s65 offen lds
    s_cmp_lg_u32 s42, 7
    s_cbranch_scc1 k1_shk_1
    v_lshlrev_b32 v4, 4, v1
    s_mul_i32 s48, s41, 640
    s_mov_b32 m0, 160768
    s_mov_b32 exec_lo, -1
    s_mov_b32 exec_hi, 0xff
    buffer_load_dwordx4 v4, s[20:23], s48 offen lds
    s_mov_b64 exec, -1
k1_shk_1:
    s_and_b32 s43, s42, 1
    s_lshr_b32 s44, s42, 1
    s_and_b32 s44, s44, 1
    s_lshr_b32 s45, s42, 2
    s_xor_b32 s46, s43, s45
    s_lshl_b32 s47, s44, 1
    s_add_u32 s47, s47, s46
    s_mov_b32 s55, 0x3727c5ac
    s_mov_b32 s56, 0x3f803f80
    s_mov_b32 s58, 0xbdd2d3e8
    s_mov_b32 s59, 0xbdd2d3e8
    s_lshl_b32 s48, s45, 1
    s_add_u32 s63, s48, s44
    s_xor_b32 s64, s63, 1
    v_xor_b32 v4, v2, v3
    v_lshlrev_b32 v6, 8, v3
    s_lshl_b32 s48, s44, 13
    s_lshl_b32 s49, s46, 12
    s_add_u32 s50, s48, s49
    s_xor_b32 s49, s49, 4096
    s_add_u32 s51, s48, s49
    s_lshl_b32 s48, s63, 2
    v_xor_b32 v5, s48, v4
    v_lshl_add_u32 v5, v5, 4, v6
    v_add_u32 v45, s50, v5
    v_add_u32 v46, s51, v5
    s_lshl_b32 s48, s64, 2
    v_xor_b32 v5, s48, v4
    v_lshl_add_u32 v5, v5, 4, v6
    v_add_u32 v47, s50, v5
    v_add_u32 v216, s51, v5
    v_lshrrev_b32 v5, 2, v3
    v_lshl_add_u32 v4, v2, 3, v5
    v_mul_u32_u24 v4, 192, v4
    v_and_b32 v5, 3, v3
    v_lshl_add_u32 v4, v5, 3, v4
    v_and_b32 v5, 1, v2
    s_mul_i32 s51, s43, 3
    s_mul_i32 s49, s63, 6144
    s_add_u32 s49, s49, 81920
    s_mul_i32 s50, s64, 6144
    s_add_u32 s50, s50, 81920
    s_add_u32 s48, s51, 0
    v_xor_b32 v6, s48, v5
    v_lshl_add_u32 v6, v6, 5, v4
    v_add_u32 v217, s49, v6
    v_add_u32 v220, s50, v6
    s_add_u32 s48, s51, 1
    v_xor_b32 v6, s48, v5
    v_lshl_add_u32 v6, v6, 5, v4
    v_add_u32 v218, s49, v6
    v_add_u32 v221, s50, v6
    s_add_u32 s48, s51, 2
    v_xor_b32 v6, s48, v5
    v_lshl_add_u32 v6, v6, 5, v4
    v_add_u32 v219, s49, v6
    v_add_u32 v222, s50, v6
    v_mov_b32 v244, s56
    v_mov_b32 v245, s56
    v_mov_b32 v246, s56
    v_mov_b32 v247, s56
    v_mul_u32_u24 v43, 205, v1
    v_lshrrev_b32 v43, 11, v43
    v_mul_u32_u24 v4, 10, v43
    v_sub_u32 v44, v1, v4
    s_lshl_b32 s48, s42, 3
    v_lshl_add_u32 v4, v43, 1, s48
    v_min_u32 v4, 62, v4
    v_mul_u32_u24 v4, 160, v4
    v_lshl_add_u32 v7, v44, 4, v4
    v_lshlrev_b32 v215, 10, v1
    s_lshl_b32 s89, s2, 3
    s_add_u32 s89, s89, s42
    s_waitcnt vmcnt(5)
    s_barrier
    ds_read_b128 v[48:51], v45 offset:0
    ds_read_b128 v[52:55], v46 offset:0
    ds_read_b128 v[56:59], v47 offset:0
    ds_read_b128 v[60:63], v216 offset:0
    ds_read_b64_tr_b16 v[128:129], v217 offset:0
    ds_read_b64_tr_b16 v[130:131], v217 offset:768
    ds_read_b64_tr_b16 v[132:133], v218 offset:0
    ds_read_b64_tr_b16 v[134:135], v218 offset:768
    ds_read_b64_tr_b16 v[136:137], v219 offset:0
    ds_read_b64_tr_b16 v[138:139], v219 offset:768
    ds_read_b64_tr_b16 v[140:141], v220 offset:0
    ds_read_b64_tr_b16 v[142:143], v220 offset:768
    ds_read_b64_tr_b16 v[144:145], v221 offset:0
    ds_read_b64_tr_b16 v[146:147], v221 offset:768
    ds_read_b64_tr_b16 v[148:149], v222 offset:0
    ds_read_b64_tr_b16 v[150:151], v222 offset:768
    s_add_u32 s65, s52, s92
    s_add_u32 m0, s60, 32768
    s_nop 0
    buffer_load_dwordx4 v38, s[4:7], s65 offen lds
    s_add_u32 s65, s52, s92
    s_add_u32 m0, s60, 33792
    s_nop 0
    buffer_load_dwordx4 v39, s[4:7], s65 offen lds
    s_add_u32 s65, s53, s97
    s_add_u32 m0, s61, 131072
    s_nop 0
    buffer_load_dwordx4 v40, s[8:11], s65 offen lds
    s_add_u32 s65, s53, s97
    s_add_u32 m0, s61, 132096
    s_nop 0
    buffer_load_dwordx4 v41, s[8:11], s65 offen lds
    s_add_u32 s65, s53, s97
    s_add_u32 m0, s61, 133120
    s_nop 0
    buffer_load_dwordx4 v42, s[8:11], s65 offen lds
    s_waitcnt vmcnt(5)
    s_waitcnt lgkmcnt(0)
    s_barrier
    ds_read_b128 v[64:67], v45 offset:16384
    ds_read_b128 v[68:71], v46 offset:16384
    ds_read_b128 v[72:75], v47 offset:16384
    ds_read_b128 v[76:79], v216 offset:16384
    ds_read_b64_tr_b16 v[152:153], v217 offset:24576
    ds_read_b64_tr_b16 v[154:155], v217 offset:25344
    ds_read_b64_tr_b16 v[156:157], v218 offset:24576
    ds_read_b64_tr_b16 v[158:159], v218 offset:25344
    ds_read_b64_tr_b16 v[160:161], v219 offset:24576
    ds_read_b64_tr_b16 v[162:163], v219 offset:25344
    ds_read_b64_tr_b16 v[164:165], v220 offset:24576
    ds_read_b64_tr_b16 v[166:167], v220 offset:25344
    ds_read_b64_tr_b16 v[168:169], v221 offset:24576
    ds_read_b64_tr_b16 v[170:171], v221 offset:25344
    ds_read_b64_tr_b16 v[172:173], v222 offset:24576
    ds_read_b64_tr_b16 v[174:175], v222 offset:25344
    v_mfma_f32_16x16x32_bf16 v[176:179], v[128:131], v[48:51], 0
    v_mfma_f32_16x16x32_bf16 v[180:183], v[128:131], v[52:55], 0
    s_add_u32 s65, s52, s93
    s_add_u32 m0, s60, 49152
    s_nop 0
    buffer_load_dwordx4 v38, s[4:7], s65 offen lds
    v_mfma_f32_16x16x32_bf16 v[224:227], v[128:131], v[244:247], 0
    v_mfma_f32_16x16x32_bf16 v[184:187], v[132:135], v[48:51], 0
    v_mfma_f32_16x16x32_bf16 v[188:191], v[132:135], v[52:55], 0
    s_add_u32 s65, s52, s93
    s_add_u32 m0, s60, 50176
    s_nop 0
    buffer_load_dwordx4 v39, s[4:7], s65 offen lds
    v_mfma_f32_16x16x32_bf16 v[228:231], v[132:135], v[244:247], 0
    v_mfma_f32_16x16x32_bf16 v[192:195], v[136:139], v[48:51], 0
    v_mfma_f32_16x16x32_bf16 v[196:199], v[136:139], v[52:55], 0
    s_add_u32 s65, s53, s98
    s_add_u32 m0, s61, 81920
    s_nop 0
    buffer_load_dwordx4 v40, s[8:11], s65 offen lds
    v_mfma_f32_16x16x32_bf16 v[232:235], v[136:139], v[244:247], 0
    v_mfma_f32_16x16x32_bf16 v[236:239], v[244:247], v[48:51], 0
    v_mfma_f32_16x16x32_bf16 v[240:243], v[48:51], v[48:51], 0
    s_add_u32 s65, s53, s98
    s_add_u32 m0, s61, 82944
    s_nop 0
    buffer_load_dwordx4 v41, s[8:11], s65 offen lds
    v_mfma_f32_16x16x32_bf16 v[176:179], v[140:143], v[56:59], v[176:179]
    v_mfma_f32_16x16x32_bf16 v[180:183], v[140:143], v[60:63], v[180:183]
    v_mfma_f32_16x16x32_bf16 v[184:187], v[144:147], v[56:59], v[184:187]
    s_add_u32 s65, s53, s98
    s_add_u32 m0, s61, 83968
    s_nop 0
    buffer_load_dwordx4 v42, s[8:11], s65 offen lds
    v_mfma_f32_16x16x32_bf16 v[188:191], v[144:147], v[60:63], v[188:191]
    v_mfma_f32_16x16x32_bf16 v[192:195], v[148:151], v[56:59], v[192:195]
    v_mfma_f32_16x16x32_bf16 v[196:199], v[148:151], v[60:63], v[196:199]
    v_mfma_f32_16x16x32_bf16 v[236:239], v[244:247], v[56:59], v[236:239]
    v_mfma_f32_16x16x32_bf16 v[240:243], v[56:59], v[56:59], v[240:243]
    s_waitcnt vmcnt(5)
    s_waitcnt lgkmcnt(0)
    s_barrier
    ds_read_b128 v[80:83], v45 offset:32768
    ds_read_b128 v[84:87], v46 offset:32768
    ds_read_b128 v[88:91], v47 offset:32768
    ds_read_b128 v[92:95], v216 offset:32768
    ds_read_b64_tr_b16 v[128:129], v217 offset:49152
    ds_read_b64_tr_b16 v[130:131], v217 offset:49920
    ds_read_b64_tr_b16 v[132:133], v218 offset:49152
    ds_read_b64_tr_b16 v[134:135], v218 offset:49920
    ds_read_b64_tr_b16 v[136:137], v219 offset:49152
    ds_read_b64_tr_b16 v[138:139], v219 offset:49920
    ds_read_b64_tr_b16 v[140:141], v220 offset:49152
    ds_read_b64_tr_b16 v[142:143], v220 offset:49920
    ds_read_b64_tr_b16 v[144:145], v221 offset:49152
    ds_read_b64_tr_b16 v[146:147], v221 offset:49920
    ds_read_b64_tr_b16 v[148:149], v222 offset:49152
    ds_read_b64_tr_b16 v[150:151], v222 offset:49920
    v_mfma_f32_16x16x32_bf16 v[176:179], v[152:155], v[64:67], v[176:179]
    v_mfma_f32_16x16x32_bf16 v[180:183], v[152:155], v[68:71], v[180:183]
    s_add_u32 s65, s52, s94
    s_add_u32 m0, s60, 65536
    s_nop 0
    buffer_load_dwordx4 v38, s[4:7], s65 offen lds
    v_mfma_f32_16x16x32_bf16 v[224:227], v[152:155], v[244:247], v[224:227]
    v_mfma_f32_16x16x32_bf16 v[184:187], v[156:159], v[64:67], v[184:187]
    v_mfma_f32_16x16x32_bf16 v[188:191], v[156:159], v[68:71], v[188:191]
    s_add_u32 s65, s52, s94
    s_add_u32 m0, s60, 66560
    s_nop 0
    buffer_load_dwordx4 v39, s[4:7], s65 offen lds
    v_mfma_f32_16x16x32_bf16 v[228:231], v[156:159], v[244:247], v[228:231]
    v_mfma_f32_16x16x32_bf16 v[192:195], v[160:163], v[64:67], v[192:195]
    v_mfma_f32_16x16x32_bf16 v[196:199], v[160:163], v[68:71], v[196:199]
    s_add_u32 s65, s53, s99
    s_add_u32 m0, s61, 106496
    s_nop 0
    buffer_load_dwordx4 v40, s[8:11], s65 offen lds
    v_mfma_f32_16x16x32_bf16 v[232:235], v[160:163], v[244:247], v[232:235]
    v_mfma_f32_16x16x32_bf16 v[236:239], v[244:247], v[64:67], v[236:239]
    v_mfma_f32_16x16x32_bf16 v[240:243], v[64:67], v[64:67], v[240:243]
    s_add_u32 s65, s53, s99
    s_add_u32 m0, s61, 107520
    s_nop 0
    buffer_load_dwordx4 v41, s[8:11], s65 offen lds
    v_mfma_f32_16x16x32_bf16 v[176:179], v[164:167], v[72:75], v[176:179]
    v_mfma_f32_16x16x32_bf16 v[180:183], v[164:167], v[76:79], v[180:183]
    v_mfma_f32_16x16x32_bf16 v[184:187], v[168:171], v[72:75], v[184:187]
    s_add_u32 s65, s53, s99
    s_add_u32 m0, s61, 108544
    s_nop 0
    buffer_load_dwordx4 v42, s[8:11], s65 offen lds
    v_mfma_f32_16x16x32_bf16 v[188:191], v[168:171], v[76:79], v[188:191]
    v_mfma_f32_16x16x32_bf16 v[192:195], v[172:175], v[72:75], v[192:195]
    v_mfma_f32_16x16x32_bf16 v[196:199], v[172:175], v[76:79], v[196:199]
    s_lshr_b32 s48, s2, 3
    s_lshl_b32 s48, s48, 3
    s_add_u32 s48, s48, s42
    s_lshl_b32 s48, s48, 13
    s_lshl_b32 s49, s66, 21
    s_add_u32 s48, s48, s49
    s_add_u32 s48, s48, 0
    s_mov_b64 exec, 0xff
    buffer_load_dword v37, v215, s[32:35], s48 offen
    s_mov_b64 exec, -1
    v_mfma_f32_16x16x32_bf16 v[236:239], v[244:247], v[72:75], v[236:239]
    v_mfma_f32_16x16x32_bf16 v[240:243], v[72:75], v[72:75], v[240:243]
    s_waitcnt vmcnt(6)
    s_waitcnt lgkmcnt(0)
    s_barrier
    ds_read_b128 v[96:99], v45 offset:49152
    ds_read_b128 v[100:103], v46 offset:49152
    ds_read_b128 v[104:107], v47 offset:49152
    ds_read_b128 v[108:111], v216 offset:49152
    ds_read_b64_tr_b16 v[152:153], v217 offset:0
    ds_read_b64_tr_b16 v[154:155], v217 offset:768
    ds_read_b64_tr_b16 v[156:157], v218 offset:0
    ds_read_b64_tr_b16 v[158:159], v218 offset:768
    ds_read_b64_tr_b16 v[160:161], v219 offset:0
    ds_read_b64_tr_b16 v[162:163], v219 offset:768
    ds_read_b64_tr_b16 v[164:165], v220 offset:0
    ds_read_b64_tr_b16 v[166:167], v220 offset:768
    ds_read_b64_tr_b16 v[168:169], v221 offset:0
    ds_read_b64_tr_b16 v[170:171], v221 offset:768
    ds_read_b64_tr_b16 v[172:173], v222 offset:0
    ds_read_b64_tr_b16 v[174:175], v222 offset:768
    v_mfma_f32_16x16x32_bf16 v[176:179], v[128:131], v[80:83], v[176:179]
    v_mfma_f32_16x16x32_bf16 v[180:183], v[128:131], v[84:87], v[180:183]
    s_add_u32 s65, s54, s95
    s_add_u32 m0, s61, 131072
    s_nop 0
    buffer_load_dwordx4 v40, s[8:11], s65 offen lds
    v_mfma_f32_16x16x32_bf16 v[224:227], v[128:131], v[244:247], v[224:227]
    v_mfma_f32_16x16x32_bf16 v[184:187], v[132:135], v[80:83], v[184:187]
    v_mfma_f32_16x16x32_bf16 v[188:191], v[132:135], v[84:87], v[188:191]
    s_add_u32 s65, s54, s95
    s_add_u32 m0, s61, 132096
    s_nop 0
    buffer_load_dwordx4 v41, s[8:11], s65 offen lds
    v_mfma_f32_16x16x32_bf16 v[228:231], v[132:135], v[244:247], v[228:231]
    v_mfma_f32_16x16x32_bf16 v[192:195], v[136:139], v[80:83], v[192:195]
    v_mfma_f32_16x16x32_bf16 v[196:199], v[136:139], v[84:87], v[196:199]
    s_add_u32 s65, s54, s95
    s_add_u32 m0, s61, 133120
    s_nop 0
    buffer_load_dwordx4 v42, s[8:11], s65 offen lds
    v_mfma_f32_16x16x32_bf16 v[232:235], v[136:139], v[244:247], v[232:235]
    v_mfma_f32_16x16x32_bf16 v[236:239], v[244:247], v[80:83], v[236:239]
    v_mfma_f32_16x16x32_bf16 v[240:243], v[80:83], v[80:83], v[240:243]
    s_lshr_b32 s48, s2, 3
    s_lshl_b32 s48, s48, 3
    s_add_u32 s48, s48, s42
    s_lshl_b32 s48, s48, 13
    s_lshl_b32 s49, s66, 21
    s_add_u32 s48, s48, s49
    s_add_u32 s48, s48, 128
    s_mov_b64 exec, 0xff
    buffer_load_dword v37, v215, s[32:35], s48 offen
    s_mov_b64 exec, -1
    v_mfma_f32_16x16x32_bf16 v[176:179], v[140:143], v[88:91], v[176:179]
    v_mfma_f32_16x16x32_bf16 v[180:183], v[140:143], v[92:95], v[180:183]
    v_mfma_f32_16x16x32_bf16 v[184:187], v[144:147], v[88:91], v[184:187]
    s_mul_i32 s48, s89, 1280
    s_add_u32 s48, s48, 0
    s_mov_b64 exec, 0x1f
    buffer_load_dword v37, v36, s[36:39], s48 offen
    s_mov_b64 exec, -1
    v_mfma_f32_16x16x32_bf16 v[188:191], v[144:147], v[92:95], v[188:191]
    v_mfma_f32_16x16x32_bf16 v[192:195], v[148:151], v[88:91], v[192:195]
    v_mfma_f32_16x16x32_bf16 v[196:199], v[148:151], v[92:95], v[196:199]
    v_mfma_f32_16x16x32_bf16 v[236:239], v[244:247], v[88:91], v[236:239]
    v_mfma_f32_16x16x32_bf16 v[240:243], v[88:91], v[88:91], v[240:243]
    s_waitcnt vmcnt(6)
    s_waitcnt lgkmcnt(0)
    s_barrier
    v_add_u32 v45, 0x10000, v45
    v_add_u32 v46, 0x10000, v46
    v_add_u32 v47, 0x10000, v47
    v_add_u32 v216, 0x10000, v216
    ds_read_b128 v[112:115], v45 offset:0
    ds_read_b128 v[116:119], v46 offset:0
    ds_read_b128 v[120:123], v47 offset:0
    ds_read_b128 v[124:127], v216 offset:0
    ds_read_b64_tr_b16 v[128:129], v217 offset:24576
    ds_read_b64_tr_b16 v[130:131], v217 offset:25344
    ds_read_b64_tr_b16 v[132:133], v218 offset:24576
    ds_read_b64_tr_b16 v[134:135], v218 offset:25344
    ds_read_b64_tr_b16 v[136:137], v219 offset:24576
    ds_read_b64_tr_b16 v[138:139], v219 offset:25344
    ds_read_b64_tr_b16 v[140:141], v220 offset:24576
    ds_read_b64_tr_b16 v[142:143], v220 offset:25344
    ds_read_b64_tr_b16 v[144:145], v221 offset:24576
    ds_read_b64_tr_b16 v[146:147], v221 offset:25344
    ds_read_b64_tr_b16 v[148:149], v222 offset:24576
    ds_read_b64_tr_b16 v[150:151], v222 offset:25344
    v_mfma_f32_16x16x32_bf16 v[176:179], v[152:155], v[96:99], v[176:179]
    v_mfma_f32_16x16x32_bf16 v[180:183], v[152:155], v[100:103], v[180:183]
    s_add_u32 s65, s54, s96
    s_add_u32 m0, s61, 81920
    s_nop 0
    buffer_load_dwordx4 v40, s[8:11], s65 offen lds
    v_mfma_f32_16x16x32_bf16 v[224:227], v[152:155], v[244:247], v[224:227]
    v_mfma_f32_16x16x32_bf16 v[184:187], v[156:159], v[96:99], v[184:187]
    v_mfma_f32_16x16x32_bf16 v[188:191], v[156:159], v[100:103], v[188:191]
    s_add_u32 s65, s54, s96
    s_add_u32 m0, s61, 82944
    s_nop 0
    buffer_load_dwordx4 v41, s[8:11], s65 offen lds
    v_mfma_f32_16x16x32_bf16 v[228:231], v[156:159], v[244:247], v[228:231]
    v_mfma_f32_16x16x32_bf16 v[192:195], v[160:163], v[96:99], v[192:195]
    v_mfma_f32_16x16x32_bf16 v[196:199], v[160:163], v[100:103], v[196:199]
    s_add_u32 s65, s54, s96
    s_add_u32 m0, s61, 83968
    s_nop 0
    buffer_load_dwordx4 v42, s[8:11], s65 offen lds
    v_mfma_f32_16x16x32_bf16 v[232:235], v[160:163], v[244:247], v[232:235]
    v_mfma_f32_16x16x32_bf16 v[236:239], v[244:247], v[96:99], v[236:239]
    v_mfma_f32_16x16x32_bf16 v[240:243], v[96:99], v[96:99], v[240:243]
    v_mov_b32 v214, 14712832
    buffer_load_dwordx2 v[212:213], v214, s[24:27], 0 offen sc1
    v_mfma_f32_16x16x32_bf16 v[176:179], v[164:167], v[104:107], v[176:179]
    v_mfma_f32_16x16x32_bf16 v[180:183], v[164:167], v[108:111], v[180:183]
    v_mfma_f32_16x16x32_bf16 v[184:187], v[168:171], v[104:107], v[184:187]
    s_lshr_b32 s48, s2, 3
    s_lshl_b32 s48, s48, 3
    s_add_u32 s48, s48, s42
    s_lshl_b32 s48, s48, 13
    s_lshl_b32 s49, s66, 21
    s_add_u32 s48, s48, s49
    s_add_u32 s48, s48, 256
    s_mov_b64 exec, 0xff
    buffer_load_dword v37, v215, s[32:35], s48 offen
    s_mov_b64 exec, -1
    v_mfma_f32_16x16x32_bf16 v[188:191], v[168:171], v[108:111], v[188:191]
    v_mfma_f32_16x16x32_bf16 v[192:195], v[172:175], v[104:107], v[192:195]
    v_mfma_f32_16x16x32_bf16 v[196:199], v[172:175], v[108:111], v[196:199]
    v_mfma_f32_16x16x32_bf16 v[236:239], v[244:247], v[104:107], v[236:239]
    v_mfma_f32_16x16x32_bf16 v[240:243], v[104:107], v[104:107], v[240:243]
    s_waitcnt vmcnt(7)
    s_waitcnt lgkmcnt(0)
    s_barrier
    ds_read_b64_tr_b16 v[152:153], v217 offset:49152
    ds_read_b64_tr_b16 v[154:155], v217 offset:49920
    ds_read_b64_tr_b16 v[156:157], v218 offset:49152
    ds_read_b64_tr_b16 v[158:159], v218 offset:49920
    ds_read_b64_tr_b16 v[160:161], v219 offset:49152
    ds_read_b64_tr_b16 v[162:163], v219 offset:49920
    ds_read_b64_tr_b16 v[164:165], v220 offset:49152
    ds_read_b64_tr_b16 v[166:167], v220 offset:49920
    ds_read_b64_tr_b16 v[168:169], v221 offset:49152
    ds_read_b64_tr_b16 v[170:171], v221 offset:49920
    ds_read_b64_tr_b16 v[172:173], v222 offset:49152
    ds_read_b64_tr_b16 v[174:175], v222 offset:49920
    v_mfma_f32_16x16x32_bf16 v[176:179], v[128:131], v[112:115], v[176:179]
    v_mfma_f32_16x16x32_bf16 v[180:183], v[128:131], v[116:119], v[180:183]
    s_add_u32 s65, s54, s97
    s_add_u32 m0, s61, 106496
    s_nop 0
    buffer_load_dwordx4 v40, s[8:11], s65 offen lds
    v_mfma_f32_16x16x32_bf16 v[224:227], v[128:131], v[244:247], v[224:227]
    v_mfma_f32_16x16x32_bf16 v[184:187], v[132:135], v[112:115], v[184:187]
    v_mfma_f32_16x16x32_bf16 v[188:191], v[132:135], v[116:119], v[188:191]
    s_add_u32 s65, s54, s97
    s_add_u32 m0, s61, 107520
    s_nop 0
    buffer_load_dwordx4 v41, s[8:11], s65 offen lds
    v_mfma_f32_16x16x32_bf16 v[228:231], v[132:135], v[244:247], v[228:231]
    v_mfma_f32_16x16x32_bf16 v[192:195], v[136:139], v[112:115], v[192:195]
    v_mfma_f32_16x16x32_bf16 v[196:199], v[136:139], v[116:119], v[196:199]
    s_add_u32 s65, s54, s97
    s_add_u32 m0, s61, 108544
    s_nop 0
    buffer_load_dwordx4 v42, s[8:11], s65 offen lds
    v_mfma_f32_16x16x32_bf16 v[232:235], v[136:139], v[244:247], v[232:235]
    v_mfma_f32_16x16x32_bf16 v[236:239], v[244:247], v[112:115], v[236:239]
    v_mfma_f32_16x16x32_bf16 v[240:243], v[112:115], v[112:115], v[240:243]
    s_lshr_b32 s48, s2, 3
    s_lshl_b32 s48, s48, 3
    s_add_u32 s48, s48, s42
    s_lshl_b32 s48, s48, 13
    s_lshl_b32 s49, s66, 21
    s_add_u32 s48, s48, s49
    s_add_u32 s48, s48, 384
    s_mov_b64 exec, 0xff
    buffer_load_dword v37, v215, s[32:35], s48 offen
    s_mov_b64 exec, -1
    v_mfma_f32_16x16x32_bf16 v[176:179], v[140:143], v[120:123], v[176:179]
    v_mfma_f32_16x16x32_bf16 v[180:183], v[140:143], v[124:127], v[180:183]
    v_mfma_f32_16x16x32_bf16 v[184:187], v[144:147], v[120:123], v[184:187]
    v_mfma_f32_16x16x32_bf16 v[188:191], v[144:147], v[124:127], v[188:191]
    v_mfma_f32_16x16x32_bf16 v[192:195], v[148:151], v[120:123], v[192:195]
    v_mfma_f32_16x16x32_bf16 v[196:199], v[148:151], v[124:127], v[196:199]
    v_mfma_f32_16x16x32_bf16 v[236:239], v[244:247], v[120:123], v[236:239]
    v_mfma_f32_16x16x32_bf16 v[240:243], v[120:123], v[120:123], v[240:243]
    s_mul_i32 s48, s42, 3072
    s_add_u32 s48, s48, 16384
    v_lshl_add_u32 v4, v1, 4, s48
    s_lshl_b32 s48, s43, 2
    s_lshl_b32 s49, s44, 1
    s_add_u32 s48, s48, s49
    s_add_u32 s48, s48, s45
    s_mul_i32 s48, s48, 192
    s_add_u32 s48, s48, 155648
    v_lshl_add_u32 v5, v2, 4, s48
    ds_write_b128 v4, v[180:183] offset:0
    ds_write_b128 v4, v[188:191] offset:1024
    ds_write_b128 v4, v[196:199] offset:2048
    s_mov_b32 exec_lo, 0x00010001
    s_mov_b32 exec_hi, 0x00010001
    ds_write_b128 v5, v[224:227] offset:0
    ds_write_b128 v5, v[228:231] offset:64
    ds_write_b128 v5, v[232:235] offset:128
    s_mov_b64 exec, -1
    v_and_b32 v8, 3, v3
    v_cmp_eq_u32 vcc, 1, v8
    s_nop 1
    v_cndmask_b32 v237, v240, v241, vcc
    v_cmp_eq_u32 vcc, 2, v8
    s_nop 1
    v_cndmask_b32 v237, v237, v242, vcc
    v_cmp_eq_u32 vcc, 3, v8
    s_nop 1
    v_cndmask_b32 v237, v237, v243, vcc
    s_lshl_b32 s48, s47, 1
    s_add_u32 s48, s48, s45
    s_lshl_b32 s48, s48, 7
    s_add_u32 s48, s48, 158720
    v_lshl_add_u32 v6, v3, 3, s48
    s_mov_b32 exec_lo, 0x00F0000F
    s_mov_b32 exec_hi, 0xF0000F00
    ds_write_b64 v6, v[236:237]
    s_mov_b64 exec, -1
    v_pk_add_f32 v[200:201], v[176:177], 0
    v_pk_add_f32 v[202:203], v[178:179], 0
    v_pk_add_f32 v[204:205], v[184:185], 0
    v_pk_add_f32 v[206:207], v[186:187], 0
    v_pk_add_f32 v[208:209], v[192:193], 0
    v_pk_add_f32 v[210:211], v[194:195], 0
    v_mov_b32 v238, 0xc0135761
    v_mov_b32 v239, 0xc0135761
    s_waitcnt vmcnt(6)
    s_waitcnt lgkmcnt(0)
    s_barrier
    ds_read_b64_tr_b16 v[128:129], v217 offset:0
    ds_read_b64_tr_b16 v[130:131], v217 offset:768
    ds_read_b64_tr_b16 v[132:133], v218 offset:0
    ds_read_b64_tr_b16 v[134:135], v218 offset:768
    ds_read_b64_tr_b16 v[136:137], v219 offset:0
    ds_read_b64_tr_b16 v[138:139], v219 offset:768
    ds_read_b64_tr_b16 v[140:141], v220 offset:0
    ds_read_b64_tr_b16 v[142:143], v220 offset:768
    ds_read_b64_tr_b16 v[144:145], v221 offset:0
    ds_read_b64_tr_b16 v[146:147], v221 offset:768
    ds_read_b64_tr_b16 v[148:149], v222 offset:0
    ds_read_b64_tr_b16 v[150:151], v222 offset:768
    s_waitcnt vmcnt(5)
    v_readfirstlane_b32 s100, v212
    v_readfirstlane_b32 s101, v213
    s_add_u32 s100, s100, 1
    s_addc_u32 s101, s101, 0
    s_xor_b32 s48, s42, 4
    s_mul_i32 s48, s48, 3072
    s_add_u32 s48, s48, 16384
    v_lshl_add_u32 v4, v1, 4, s48
    s_lshl_b32 s48, s47, 8
    s_add_u32 s48, s48, 158720
    v_lshl_add_u32 v5, v3, 3, s48
    ds_read_b64 v[20:21], v5
    ds_read_b64 v[22:23], v5 offset:128
    ds_read_b128 v[8:11], v4 offset:0
    ds_read_b128 v[12:15], v4 offset:1024
    ds_read_b128 v[16:19], v4 offset:2048
    s_mul_i32 s48, s43, 768
    s_add_u32 s48, s48, 155648
    v_lshl_add_u32 v6, v2, 4, s48
    ds_read_b128 v[24:27], v6 offset:0
    ds_read_b128 v[28:31], v6 offset:64
    ds_read_b128 v[32:35], v6 offset:128
    ds_read_b128 v[176:179], v6 offset:192
    ds_read_b128 v[180:183], v6 offset:256
    ds_read_b128 v[184:187], v6 offset:320
    ds_read_b128 v[188:191], v6 offset:384
    ds_read_b128 v[192:195], v6 offset:448
    ds_read_b128 v[196:199], v6 offset:512
    ds_read_b128 v[224:227], v6 offset:576
    ds_read_b128 v[228:231], v6 offset:640
    ds_read_b128 v[232:235], v6 offset:704
    s_waitcnt lgkmcnt(15)
    v_pk_add_f32 v[240:241], v[20:21], v[22:23]
    v_mul_f32 v240, 0x3acccccd, v240
    v_mul_f32 v241, 0x3acccccd, v241
    v_fma_f32 v241, -v240, v240, v241
    v_max_f32 v241, 0, v241
    v_cvt_pk_bf16_f32 v241, v241, v240
    v_and_b32 v240, 0xffff0000, v241
    v_lshlrev_b32 v241, 16, v241
    v_add_f32 v241, s55, v241
    v_cvt_pk_bf16_f32 v241, v241, v241
    v_and_b32 v241, 0xffff0000, v241
    v_sqrt_f32 v241, v241
    s_nop 0
    v_cvt_pk_bf16_f32 v241, v241, v241
    v_and_b32 v241, 0xffff0000, v241
    v_rcp_f32 v241, v241
    s_nop 0
    v_mov_b32 v242, v241
    s_waitcnt lgkmcnt(12)
    v_pk_add_f32 v[200:201], v[200:201], v[8:9]
    v_pk_add_f32 v[202:203], v[202:203], v[10:11]
    v_pk_add_f32 v[204:205], v[204:205], v[12:13]
    v_pk_add_f32 v[206:207], v[206:207], v[14:15]
    v_pk_add_f32 v[208:209], v[208:209], v[16:17]
    v_pk_add_f32 v[210:211], v[210:211], v[18:19]
    s_waitcnt lgkmcnt(6)
    v_pk_add_f32 v[24:25], v[24:25], v[176:177]
    v_pk_add_f32 v[26:27], v[26:27], v[178:179]
    v_pk_add_f32 v[28:29], v[28:29], v[180:181]
    v_pk_add_f32 v[30:31], v[30:31], v[182:183]
    v_pk_add_f32 v[32:33], v[32:33], v[184:185]
    v_pk_add_f32 v[34:35], v[34:35], v[186:187]
    s_waitcnt lgkmcnt(0)
    v_pk_add_f32 v[188:189], v[188:189], v[224:225]
    v_pk_add_f32 v[190:191], v[190:191], v[226:227]
    v_pk_add_f32 v[192:193], v[192:193], v[228:229]
    v_pk_add_f32 v[194:195], v[194:195], v[230:231]
    v_pk_add_f32 v[196:197], v[196:197], v[232:233]
    v_pk_add_f32 v[198:199], v[198:199], v[234:235]
    v_pk_add_f32 v[24:25], v[24:25], v[188:189]
    v_pk_add_f32 v[26:27], v[26:27], v[190:191]
    v_pk_add_f32 v[28:29], v[28:29], v[192:193]
    v_pk_add_f32 v[30:31], v[30:31], v[194:195]
    v_pk_add_f32 v[32:33], v[32:33], v[196:197]
    v_pk_add_f32 v[34:35], v[34:35], v[198:199]
    v_pk_fma_f32 v[200:201], v[24:25], v[240:241], v[200:201] op_sel_hi:[1,0,1] neg_lo:[0,1,0] neg_hi:[0,1,0]
    v_pk_fma_f32 v[202:203], v[26:27], v[240:241], v[202:203] op_sel_hi:[1,0,1] neg_lo:[0,1,0] neg_hi:[0,1,0]
    v_pk_fma_f32 v[204:205], v[28:29], v[240:241], v[204:205] op_sel_hi:[1,0,1] neg_lo:[0,1,0] neg_hi:[0,1,0]
    v_pk_fma_f32 v[206:207], v[30:31], v[240:241], v[206:207] op_sel_hi:[1,0,1] neg_lo:[0,1,0] neg_hi:[0,1,0]
    v_pk_fma_f32 v[208:209], v[32:33], v[240:241], v[208:209] op_sel_hi:[1,0,1] neg_lo:[0,1,0] neg_hi:[0,1,0]
    v_pk_fma_f32 v[210:211], v[34:35], v[240:241], v[210:211] op_sel_hi:[1,0,1] neg_lo:[0,1,0] neg_hi:[0,1,0]
    v_pk_mul_f32 v[200:201], v[200:201], v[242:243] op_sel_hi:[1,0]
    v_pk_mul_f32 v[202:203], v[202:203], v[242:243] op_sel_hi:[1,0]
    v_pk_mul_f32 v[204:205], v[204:205], v[242:243] op_sel_hi:[1,0]
    v_pk_mul_f32 v[206:207], v[206:207], v[242:243] op_sel_hi:[1,0]
    v_pk_mul_f32 v[208:209], v[208:209], v[242:243] op_sel_hi:[1,0]
    v_pk_mul_f32 v[210:211], v[210:211], v[242:243] op_sel_hi:[1,0]
    v_pk_mul_f32 v[8:9], v[200:201], v[200:201]
    v_pk_mul_f32 v[10:11], v[202:203], v[202:203]
    v_pk_mul_f32 v[12:13], v[204:205], v[204:205]
    v_pk_mul_f32 v[14:15], v[206:207], v[206:207]
    v_pk_mul_f32 v[16:17], v[208:209], v[208:209]
    v_pk_mul_f32 v[18:19], v[210:211], v[210:211]
    v_pk_fma_f32 v[8:9], v[8:9], s[58:59], v[238:239]
    v_pk_fma_f32 v[10:11], v[10:11], s[58:59], v[238:239]
    v_pk_fma_f32 v[12:13], v[12:13], s[58:59], v[238:239]
    v_pk_fma_f32 v[14:15], v[14:15], s[58:59], v[238:239]
    v_pk_fma_f32 v[16:17], v[16:17], s[58:59], v[238:239]
    v_pk_fma_f32 v[18:19], v[18:19], s[58:59], v[238:239]
    v_pk_mul_f32 v[8:9], v[8:9], v[200:201]
    v_pk_mul_f32 v[10:11], v[10:11], v[202:203]
    v_pk_mul_f32 v[12:13], v[12:13], v[204:205]
    v_pk_mul_f32 v[14:15], v[14:15], v[206:207]
    v_pk_mul_f32 v[16:17], v[16:17], v[208:209]
    v_pk_mul_f32 v[18:19], v[18:19], v[210:211]
    v_exp_f32 v8, v8
    v_exp_f32 v9, v9
    v_exp_f32 v10, v10
    v_exp_f32 v11, v11
    v_exp_f32 v12, v12
    v_exp_f32 v13, v13
    v_exp_f32 v14, v14
    v_exp_f32 v15, v15
    v_exp_f32 v16, v16
    v_exp_f32 v17, v17
    v_exp_f32 v18, v18
    v_exp_f32 v19, v19
    v_pk_add_f32 v[8:9], v[8:9], 1.0 op_sel_hi:[1,0]
    v_pk_add_f32 v[10:11], v[10:11], 1.0 op_sel_hi:[1,0]
    v_pk_add_f32 v[12:13], v[12:13], 1.0 op_sel_hi:[1,0]
    v_pk_add_f32 v[14:15], v[14:15], 1.0 op_sel_hi:[1,0]
    v_pk_add_f32 v[16:17], v[16:17], 1.0 op_sel_hi:[1,0]
    v_pk_add_f32 v[18:19], v[18:19], 1.0 op_sel_hi:[1,0]
    v_rcp_f32 v8, v8
    v_rcp_f32 v9, v9
    v_rcp_f32 v10, v10
    v_rcp_f32 v11, v11
    v_rcp_f32 v12, v12
    v_rcp_f32 v13, v13
    v_rcp_f32 v14, v14
    v_rcp_f32 v15, v15
    v_rcp_f32 v16, v16
    v_rcp_f32 v17, v17
    v_rcp_f32 v18, v18
    v_rcp_f32 v19, v19
    v_pk_mul_f32 v[200:201], v[200:201], v[8:9]
    v_pk_mul_f32 v[202:203], v[202:203], v[10:11]
    v_pk_mul_f32 v[204:205], v[204:205], v[12:13]
    v_pk_mul_f32 v[206:207], v[206:207], v[14:15]
    v_pk_mul_f32 v[208:209], v[208:209], v[16:17]
    v_pk_mul_f32 v[210:211], v[210:211], v[18:19]
    v_pk_add_f32 v[14:15], v[200:201], v[202:203]
    v_pk_mul_f32 v[16:17], v[200:201], v[200:201]
    v_pk_add_f32 v[18:19], v[204:205], v[206:207]
    v_pk_fma_f32 v[16:17], v[202:203], v[202:203], v[16:17]
    v_pk_add_f32 v[20:21], v[208:209], v[210:211]
    v_pk_fma_f32 v[16:17], v[204:205], v[204:205], v[16:17]
    v_pk_add_f32 v[14:15], v[14:15], v[18:19]
    v_pk_fma_f32 v[16:17], v[206:207], v[206:207], v[16:17]
    v_pk_add_f32 v[14:15], v[14:15], v[20:21]
    v_pk_fma_f32 v[16:17], v[208:209], v[208:209], v[16:17]
    v_pk_fma_f32 v[16:17], v[210:211], v[210:211], v[16:17]
    v_add_f32 v8, v14, v15
    v_add_f32 v9, v16, v17
    v_mov_b32 v10, 0
    v_mov_b32 v11, 0
    s_lshl_b32 s48, s47, 7
    s_lshl_b32 s49, s43, 9
    s_add_u32 s48, s48, s49
    s_add_u32 s48, s48, 159744
    v_lshl_add_u32 v4, v3, 3, s48
    v_add_f32 v8, v8, v10
    v_add_f32 v9, v9, v11
    v_mov_b32 v12, v8
    v_mov_b32 v13, v9
    s_nop 0
    v_permlane16_swap_b32 v8, v12
    v_permlane16_swap_b32 v9, v13
    v_add_f32 v8, v8, v12
    v_add_f32 v9, v9, v13
    v_mov_b32 v12, v8
    v_mov_b32 v13, v9
    s_nop 0
    v_permlane32_swap_b32 v8, v12
    v_permlane32_swap_b32 v9, v13
    v_add_f32 v8, v8, v12
    v_add_f32 v9, v9, v13
    s_mov_b64 exec, 0xffff
    ds_write_b64 v4, v[8:9]
    s_mov_b64 exec, -1
    s_or_b32 s48, s41, s43
    s_cmp_lg_u32 s48, 0
    s_cbranch_scc1 k1_xst_2
    s_lshl_b32 s48, s40, 9
    s_lshl_b32 s49, s47, 7
    s_add_u32 s48, s48, s49
    s_add_u32 s48, s48, 14680064
    v_lshlrev_b32 v4, 3, v3
    s_mov_b64 exec, 0xffff
    buffer_store_dwordx2 v[240:241], v4, s[24:27], s48 offen
    s_mov_b64 exec, -1
k1_xst_2:
    v_mfma_f32_16x16x32_bf16 v[176:179], v[152:155], v[48:51], 0
    v_mfma_f32_16x16x32_bf16 v[180:183], v[152:155], v[52:55], 0
    s_add_u32 s65, s54, s98
    s_add_u32 m0, s61, 131072
    s_nop 0
    buffer_load_dwordx4 v40, s[8:11], s65 offen lds
    v_mfma_f32_16x16x32_bf16 v[224:227], v[152:155], v[244:247], 0
    v_mfma_f32_16x16x32_bf16 v[184:187], v[156:159], v[48:51], 0
    v_mfma_f32_16x16x32_bf16 v[188:191], v[156:159], v[52:55], 0
    s_add_u32 s65, s54, s98
    s_add_u32 m0, s61, 132096
    s_nop 0
    buffer_load_dwordx4 v41, s[8:11], s65 offen lds
    v_mfma_f32_16x16x32_bf16 v[228:231], v[156:159], v[244:247], 0
    v_mfma_f32_16x16x32_bf16 v[192:195], v[160:163], v[48:51], 0
    v_mfma_f32_16x16x32_bf16 v[196:199], v[160:163], v[52:55], 0
    s_add_u32 s65, s54, s98
    s_add_u32 m0, s61, 133120
    s_nop 0
    buffer_load_dwordx4 v42, s[8:11], s65 offen lds
    v_mfma_f32_16x16x32_bf16 v[232:235], v[160:163], v[244:247], 0
    v_mfma_f32_16x16x32_bf16 v[176:179], v[164:167], v[56:59], v[176:179]
    v_mfma_f32_16x16x32_bf16 v[180:183], v[164:167], v[60:63], v[180:183]
    s_add_u32 s48, s42, 0
    s_cmp_ge_u32 s48, 21
    s_cbranch_scc1 k1_kvde_5
    s_sub_u32 s49, s48, 11
    s_cmp_ge_u32 s48, 11
    s_cselect_b32 s50, s49, s48
    s_lshl_b32 s50, s50, 6
    v_add_u32 v4, s50, v1
    v_mul_u32_u24 v5, 6554, v4
    v_lshrrev_b32 v5, 16, v5
    v_mul_u32_u24 v6, 10, v5
    v_sub_u32 v4, v4, v6
    v_mul_u32_u24 v5, 1280, v5
    v_lshl_add_u32 v4, v4, 4, v5
    s_mul_i32 s49, s41, 160
    s_add_u32 s49, s49, s52
    s_lshl_b32 s50, s50, 4
    s_cmp_ge_u32 s48, 11
    s_cbranch_scc1 k1_kvdv_4
    v_add_u32 v4, s49, v4
    v_subrev_u32 v4, 3840, v4
    s_add_u32 m0, s50, 65536
    s_nop 0
    buffer_load_dwordx4 v4, s[12:15], 0 offen lds
    s_branch k1_kvde_5
k1_kvdv_4:
    s_add_u32 m0, s50, 49152
    s_nop 0
    buffer_load_dwordx4 v4, s[16:19], s49 offen lds
k1_kvde_5:
    v_mfma_f32_16x16x32_bf16 v[184:187], v[168:171], v[56:59], v[184:187]
    v_mfma_f32_16x16x32_bf16 v[188:191], v[168:171], v[60:63], v[188:191]
    v_mfma_f32_16x16x32_bf16 v[192:195], v[172:175], v[56:59], v[192:195]
    s_add_u32 s48, s42, 8
    s_cmp_ge_u32 s48, 21
    s_cbranch_scc1 k1_kvde_8
    s_sub_u32 s49, s48, 11
    s_cmp_ge_u32 s48, 11
    s_cselect_b32 s50, s49, s48
    s_lshl_b32 s50, s50, 6
    v_add_u32 v4, s50, v1
    v_mul_u32_u24 v5, 6554, v4
    v_lshrrev_b32 v5, 16, v5
    v_mul_u32_u24 v6, 10, v5
    v_sub_u32 v4, v4, v6
    v_mul_u32_u24 v5, 1280, v5
    v_lshl_add_u32 v4, v4, 4, v5
    s_mul_i32 s49, s41, 160
    s_add_u32 s49, s49, s52
    s_lshl_b32 s50, s50, 4
    s_cmp_ge_u32 s48, 11
    s_cbranch_scc1 k1_kvdv_7
    v_add_u32 v4, s49, v4
    v_subrev_u32 v4, 3840, v4
    s_add_u32 m0, s50, 65536
    s_nop 0
    buffer_load_dwordx4 v4, s[12:15], 0 offen lds
    s_branch k1_kvde_8
k1_kvdv_7:
    s_add_u32 m0, s50, 49152
    s_nop 0
    buffer_load_dwordx4 v4, s[16:19], s49 offen lds
k1_kvde_8:
    v_mfma_f32_16x16x32_bf16 v[196:199], v[172:175], v[60:63], v[196:199]
    s_add_u32 s48, s42, 16
    s_cmp_ge_u32 s48, 21
    s_cbranch_scc1 k1_kvde_11
    s_sub_u32 s49, s48, 11
    s_cmp_ge_u32 s48, 11
    s_cselect_b32 s50, s49, s48
    s_lshl_b32 s50, s50, 6
    v_add_u32 v4, s50, v1
    v_mul_u32_u24 v5, 6554, v4
    v_lshrrev_b32 v5, 16, v5
    v_mul_u32_u24 v6, 10, v5
    v_sub_u32 v4, v4, v6
    v_mul_u32_u24 v5, 1280, v5
    v_lshl_add_u32 v4, v4, 4, v5
    s_mul_i32 s49, s41, 160
    s_add_u32 s49, s49, s52
    s_lshl_b32 s50, s50, 4
    s_cmp_ge_u32 s48, 11
    s_cbranch_scc1 k1_kvdv_10
    v_add_u32 v4, s49, v4
    v_subrev_u32 v4, 3840, v4
    s_add_u32 m0, s50, 65536
    s_nop 0
    buffer_load_dwordx4 v4, s[12:15], 0 offen lds
    s_branch k1_kvde_11
k1_kvdv_10:
    s_add_u32 m0, s50, 49152
    s_nop 0
    buffer_load_dwordx4 v4, s[16:19], s49 offen lds
k1_kvde_11:
    s_lshr_b32 s48, s2, 3
    s_lshl_b32 s48, s48, 3
    s_add_u32 s48, s48, s42
    s_lshl_b32 s48, s48, 13
    s_lshl_b32 s49, s66, 21
    s_add_u32 s48, s48, s49
    s_add_u32 s48, s48, 512
    s_mov_b64 exec, 0xff
    buffer_load_dword v37, v215, s[32:35], s48 offen
    s_mov_b64 exec, -1
    s_mul_i32 s48, s89, 1280
    s_add_u32 s48, s48, 640
    s_mov_b64 exec, 0x1f
    buffer_load_dword v37, v36, s[36:39], s48 offen
    s_mov_b64 exec, -1
    s_waitcnt vmcnt(6)
    s_waitcnt lgkmcnt(0)
    s_barrier
    s_cmp_lg_u32 s42, 0
    s_cbranch_scc1 k1_pub_12
    v_lshlrev_b32 v4, 3, v1
    v_add_u32 v5, 159744, v4
    ds_read_b64 v[8:9], v5
    ds_read_b64 v[12:13], v5 offset:512
    s_lshl_b32 s48, s40, 3
    s_add_u32 s48, s48, s41
    s_lshl_b32 s48, s48, 10
    s_add_u32 s48, s48, 14745600
    v_lshlrev_b32 v4, 4, v1
    v_mov_b32 v10, s100
    v_mov_b32 v11, s101
    s_waitcnt lgkmcnt(0)
    v_pk_add_f32 v[8:9], v[8:9], v[12:13]
    buffer_store_dwordx4 v[8:11], v4, s[24:27], s48 offen sc1
k1_pub_12:
    ds_read_b64_tr_b16 v[152:153], v217 offset:24576
    ds_read_b64_tr_b16 v[154:155], v217 offset:25344
    ds_read_b64_tr_b16 v[156:157], v218 offset:24576
    ds_read_b64_tr_b16 v[158:159], v218 offset:25344
    ds_read_b64_tr_b16 v[160:161], v219 offset:24576
    ds_read_b64_tr_b16 v[162:163], v219 offset:25344
    ds_read_b64_tr_b16 v[164:165], v220 offset:24576
    ds_read_b64_tr_b16 v[166:167], v220 offset:25344
    ds_read_b64_tr_b16 v[168:169], v221 offset:24576
    ds_read_b64_tr_b16 v[170:171], v221 offset:25344
    ds_read_b64_tr_b16 v[172:173], v222 offset:24576
    ds_read_b64_tr_b16 v[174:175], v222 offset:25344
    v_mfma_f32_16x16x32_bf16 v[176:179], v[128:131], v[64:67], v[176:179]
    v_mfma_f32_16x16x32_bf16 v[180:183], v[128:131], v[68:71], v[180:183]
    s_add_u32 s65, s54, s99
    s_add_u32 m0, s61, 81920
    s_nop 0
    buffer_load_dwordx4 v40, s[8:11], s65 offen lds
    v_mfma_f32_16x16x32_bf16 v[224:227], v[128:131], v[244:247], v[224:227]
    v_mfma_f32_16x16x32_bf16 v[184:187], v[132:135], v[64:67], v[184:187]
    v_mfma_f32_16x16x32_bf16 v[188:191], v[132:135], v[68:71], v[188:191]
    s_add_u32 s65, s54, s99
    s_add_u32 m0, s61, 82944
    s_nop 0
    buffer_load_dwordx4 v41, s[8:11], s65 offen lds
    v_mfma_f32_16x16x32_bf16 v[228:231], v[132:135], v[244:247], v[228:231]
    v_mfma_f32_16x16x32_bf16 v[192:195], v[136:139], v[64:67], v[192:195]
    v_mfma_f32_16x16x32_bf16 v[196:199], v[136:139], v[68:71], v[196:199]
    s_add_u32 s65, s54, s99
    s_add_u32 m0, s61, 83968
    s_nop 0
    buffer_load_dwordx4 v42, s[8:11], s65 offen lds
    v_mfma_f32_16x16x32_bf16 v[232:235], v[136:139], v[244:247], v[232:235]
    v_mfma_f32_16x16x32_bf16 v[176:179], v[140:143], v[72:75], v[176:179]
    v_mfma_f32_16x16x32_bf16 v[180:183], v[140:143], v[76:79], v[180:183]
    s_lshr_b32 s48, s2, 3
    s_lshl_b32 s48, s48, 3
    s_add_u32 s48, s48, s42
    s_lshl_b32 s48, s48, 13
    s_lshl_b32 s49, s66, 21
    s_add_u32 s48, s48, s49
    s_add_u32 s48, s48, 640
    s_mov_b64 exec, 0xff
    buffer_load_dword v37, v215, s[32:35], s48 offen
    s_mov_b64 exec, -1
    v_mfma_f32_16x16x32_bf16 v[184:187], v[144:147], v[72:75], v[184:187]
    v_mfma_f32_16x16x32_bf16 v[188:191], v[144:147], v[76:79], v[188:191]
    v_mfma_f32_16x16x32_bf16 v[192:195], v[148:151], v[72:75], v[192:195]
    v_mfma_f32_16x16x32_bf16 v[196:199], v[148:151], v[76:79], v[196:199]
    s_waitcnt vmcnt(6)
    s_waitcnt lgkmcnt(0)
    s_barrier
    ds_read_b64_tr_b16 v[128:129], v217 offset:49152
    ds_read_b64_tr_b16 v[130:131], v217 offset:49920
    ds_read_b64_tr_b16 v[132:133], v218 offset:49152
    ds_read_b64_tr_b16 v[134:135], v218 offset:49920
    ds_read_b64_tr_b16 v[136:137], v219 offset:49152
    ds_read_b64_tr_b16 v[138:139], v219 offset:49920
    ds_read_b64_tr_b16 v[140:141], v220 offset:49152
    ds_read_b64_tr_b16 v[142:143], v220 offset:49920
    ds_read_b64_tr_b16 v[144:145], v221 offset:49152
    ds_read_b64_tr_b16 v[146:147], v221 offset:49920
    ds_read_b64_tr_b16 v[148:149], v222 offset:49152
    ds_read_b64_tr_b16 v[150:151], v222 offset:49920
    v_mfma_f32_16x16x32_bf16 v[176:179], v[152:155], v[80:83], v[176:179]
    v_mfma_f32_16x16x32_bf16 v[180:183], v[152:155], v[84:87], v[180:183]
    s_lshr_b32 s48, s2, 3
    s_lshl_b32 s48, s48, 3
    s_add_u32 s48, s48, s42
    s_lshl_b32 s48, s48, 13
    s_lshl_b32 s49, s66, 21
    s_add_u32 s48, s48, s49
    s_add_u32 s48, s48, 768
    s_mov_b64 exec, 0xff
    buffer_load_dword v37, v215, s[32:35], s48 offen
    s_mov_b64 exec, -1
    v_mfma_f32_16x16x32_bf16 v[224:227], v[152:155], v[244:247], v[224:227]
    v_mfma_f32_16x16x32_bf16 v[184:187], v[156:159], v[80:83], v[184:187]
    v_mfma_f32_16x16x32_bf16 v[188:191], v[156:159], v[84:87], v[188:191]
    v_mfma_f32_16x16x32_bf16 v[228:231], v[156:159], v[244:247], v[228:231]
    v_mfma_f32_16x16x32_bf16 v[192:195], v[160:163], v[80:83], v[192:195]
    v_mfma_f32_16x16x32_bf16 v[196:199], v[160:163], v[84:87], v[196:199]
    v_mfma_f32_16x16x32_bf16 v[232:235], v[160:163], v[244:247], v[232:235]
    v_mfma_f32_16x16x32_bf16 v[176:179], v[164:167], v[88:91], v[176:179]
    v_mfma_f32_16x16x32_bf16 v[180:183], v[164:167], v[92:95], v[180:183]
    v_mfma_f32_16x16x32_bf16 v[184:187], v[168:171], v[88:91], v[184:187]
    v_mfma_f32_16x16x32_bf16 v[188:191], v[168:171], v[92:95], v[188:191]
    v_mfma_f32_16x16x32_bf16 v[192:195], v[172:175], v[88:91], v[192:195]
    v_mfma_f32_16x16x32_bf16 v[196:199], v[172:175], v[92:95], v[196:199]
    s_waitcnt vmcnt(2)
    s_waitcnt lgkmcnt(0)
    s_barrier
    ds_read_b64_tr_b16 v[152:153], v217 offset:0
    ds_read_b64_tr_b16 v[154:155], v217 offset:768
    ds_read_b64_tr_b16 v[156:157], v218 offset:0
    ds_read_b64_tr_b16 v[158:159], v218 offset:768
    ds_read_b64_tr_b16 v[160:161], v219 offset:0
    ds_read_b64_tr_b16 v[162:163], v219 offset:768
    ds_read_b64_tr_b16 v[164:165], v220 offset:0
    ds_read_b64_tr_b16 v[166:167], v220 offset:768
    ds_read_b64_tr_b16 v[168:169], v221 offset:0
    ds_read_b64_tr_b16 v[170:171], v221 offset:768
    ds_read_b64_tr_b16 v[172:173], v222 offset:0
    ds_read_b64_tr_b16 v[174:175], v222 offset:768
    v_mfma_f32_16x16x32_bf16 v[176:179], v[128:131], v[96:99], v[176:179]
    v_mfma_f32_16x16x32_bf16 v[180:183], v[128:131], v[100:103], v[180:183]
    s_lshr_b32 s48, s2, 3
    s_lshl_b32 s48, s48, 3
    s_add_u32 s48, s48, s42
    s_lshl_b32 s48, s48, 13
    s_lshl_b32 s49, s66, 21
    s_add_u32 s48, s48, s49
    s_add_u32 s48, s48, 896
    s_mov_b64 exec, 0xff
    buffer_load_dword v37, v215, s[32:35], s48 offen
    s_mov_b64 exec, -1
    v_mfma_f32_16x16x32_bf16 v[224:227], v[128:131], v[244:247], v[224:227]
    v_mfma_f32_16x16x32_bf16 v[184:187], v[132:135], v[96:99], v[184:187]
    v_mfma_f32_16x16x32_bf16 v[188:191], v[132:135], v[100:103], v[188:191]
    v_mfma_f32_16x16x32_bf16 v[228:231], v[132:135], v[244:247], v[228:231]
    v_mfma_f32_16x16x32_bf16 v[192:195], v[136:139], v[96:99], v[192:195]
    v_mfma_f32_16x16x32_bf16 v[196:199], v[136:139], v[100:103], v[196:199]
    v_mfma_f32_16x16x32_bf16 v[232:235], v[136:139], v[244:247], v[232:235]
    v_mfma_f32_16x16x32_bf16 v[176:179], v[140:143], v[104:107], v[176:179]
    v_mfma_f32_16x16x32_bf16 v[180:183], v[140:143], v[108:111], v[180:183]
    v_mfma_f32_16x16x32_bf16 v[184:187], v[144:147], v[104:107], v[184:187]
    v_mfma_f32_16x16x32_bf16 v[188:191], v[144:147], v[108:111], v[188:191]
    v_mfma_f32_16x16x32_bf16 v[192:195], v[148:151], v[104:107], v[192:195]
    v_mfma_f32_16x16x32_bf16 v[196:199], v[148:151], v[108:111], v[196:199]
    s_waitcnt lgkmcnt(0)
    s_barrier
    s_lshl_b32 s48, s40, 13
    s_lshl_b32 s49, s47, 8
    s_add_u32 s48, s48, s49
    s_add_u32 s62, s48, 14745600
    v_lshlrev_b32 v38, 4, v3
    v_lshl_add_u32 v38, v2, 11, v38
    buffer_load_dwordx4 v[28:31], v38, s[24:27], s62 offen sc1
    buffer_load_dwordx4 v[32:35], v38, s[24:27], s62 offen offset:1024 sc1
    v_mfma_f32_16x16x32_bf16 v[176:179], v[152:155], v[112:115], v[176:179]
    v_mfma_f32_16x16x32_bf16 v[180:183], v[152:155], v[116:119], v[180:183]
    v_mfma_f32_16x16x32_bf16 v[224:227], v[152:155], v[244:247], v[224:227]
    v_mfma_f32_16x16x32_bf16 v[184:187], v[156:159], v[112:115], v[184:187]
    v_mfma_f32_16x16x32_bf16 v[188:191], v[156:159], v[116:119], v[188:191]
    v_mfma_f32_16x16x32_bf16 v[228:231], v[156:159], v[244:247], v[228:231]
    v_mfma_f32_16x16x32_bf16 v[192:195], v[160:163], v[112:115], v[192:195]
    v_mfma_f32_16x16x32_bf16 v[196:199], v[160:163], v[116:119], v[196:199]
    v_mfma_f32_16x16x32_bf16 v[232:235], v[160:163], v[244:247], v[232:235]
    v_mfma_f32_16x16x32_bf16 v[176:179], v[164:167], v[120:123], v[176:179]
    v_mfma_f32_16x16x32_bf16 v[180:183], v[164:167], v[124:127], v[180:183]
    v_mfma_f32_16x16x32_bf16 v[184:187], v[168:171], v[120:123], v[184:187]
    v_mfma_f32_16x16x32_bf16 v[188:191], v[168:171], v[124:127], v[188:191]
    v_mfma_f32_16x16x32_bf16 v[192:195], v[172:175], v[120:123], v[192:195]
    v_mfma_f32_16x16x32_bf16 v[196:199], v[172:175], v[124:127], v[196:199]
    s_mul_i32 s48, s42, 3072
    s_add_u32 s48, s48, 16384
    v_lshl_add_u32 v4, v1, 4, s48
    s_lshl_b32 s48, s43, 2
    s_lshl_b32 s49, s44, 1
    s_add_u32 s48, s48, s49
    s_add_u32 s48, s48, s45
    s_mul_i32 s48, s48, 192
    s_add_u32 s48, s48, 157184
    v_lshl_add_u32 v5, v2, 4, s48
    ds_write_b128 v4, v[180:183] offset:0
    ds_write_b128 v4, v[188:191] offset:1024
    ds_write_b128 v4, v[196:199] offset:2048
    s_mov_b32 exec_lo, 0x00010001
    s_mov_b32 exec_hi, 0x00010001
    ds_write_b128 v5, v[224:227] offset:0
    ds_write_b128 v5, v[228:231] offset:64
    ds_write_b128 v5, v[232:235] offset:128
    s_mov_b64 exec, -1
    v_pk_add_f32 v[128:129], v[176:177], 0
    v_pk_add_f32 v[130:131], v[178:179], 0
    v_pk_add_f32 v[132:133], v[184:185], 0
    v_pk_add_f32 v[134:135], v[186:187], 0
    v_pk_add_f32 v[136:137], v[192:193], 0
    v_pk_add_f32 v[138:139], v[194:195], 0
    v_add_u32 v4, 65536, v7
    ds_read_b128 v[48:51], v4 offset:0
    ds_read_b128 v[52:55], v4 offset:160
    ds_read_b128 v[56:59], v4 offset:320
    ds_read_b128 v[60:63], v4 offset:480
    ds_read_b128 v[64:67], v4 offset:640
    v_add_u32 v4, 49152, v7
    ds_read_b128 v[68:71], v4
    ds_read_b128 v[72:75], v4 offset:160
    s_waitcnt lgkmcnt(0)
    v_mul_u32_u24 v7, 1152, v44
    v_lshlrev_b32 v106, 2, v43
    v_sub_u32 v7, v7, v106
    s_lshl_b32 s48, s42, 4
    s_add_u32 s48, s48, 106508
    v_add_u32 v7, s48, v7
    v_lshlrev_b32 v44, 6, v44
    v_add_u32 v44, 160768, v44
    ds_read_b128 v[108:111], v44 offset:0
    ds_read_b128 v[112:115], v44 offset:16
    v_lshlrev_b32 v80, 16, v48
    v_and_b32 v81, 0xffff0000, v48
    v_lshlrev_b32 v82, 16, v52
    v_and_b32 v83, 0xffff0000, v52
    v_lshlrev_b32 v84, 16, v56
    v_and_b32 v85, 0xffff0000, v56
    v_lshlrev_b32 v86, 16, v60
    v_and_b32 v87, 0xffff0000, v60
    v_lshlrev_b32 v88, 16, v64
    v_and_b32 v89, 0xffff0000, v64
    s_waitcnt lgkmcnt(0)
    v_lshlrev_b32 v90, 16, v108
    v_lshlrev_b32 v91, 16, v110
    v_and_b32 v92, 0xffff0000, v108
    v_and_b32 v93, 0xffff0000, v110
    v_lshlrev_b32 v94, 16, v109
    v_lshlrev_b32 v95, 16, v111
    v_and_b32 v96, 0xffff0000, v109
    v_and_b32 v97, 0xffff0000, v111
    v_pk_mul_f32 v[98:99], v[86:87], v[90:91]
    v_pk_mul_f32 v[100:101], v[88:89], v[90:91]
    v_pk_fma_f32 v[98:99], v[84:85], v[92:93], v[98:99]
    v_pk_fma_f32 v[100:101], v[86:87], v[92:93], v[100:101]
    v_pk_fma_f32 v[98:99], v[82:83], v[94:95], v[98:99]
    v_pk_fma_f32 v[100:101], v[84:85], v[94:95], v[100:101]
    v_pk_fma_f32 v[98:99], v[80:81], v[96:97], v[98:99]
    v_pk_fma_f32 v[100:101], v[82:83], v[96:97], v[100:101]
    v_lshlrev_b32 v102, 16, v68
    v_and_b32 v103, 0xffff0000, v68
    v_lshlrev_b32 v104, 16, v72
    v_and_b32 v105, 0xffff0000, v72
    v_pk_mul_f32 v[98:99], v[98:99], v[102:103]
    v_pk_mul_f32 v[100:101], v[100:101], v[104:105]
    v_cvt_pk_bf16_f32 v106, v100, v98
    v_cvt_pk_bf16_f32 v107, v101, v99
    s_mov_b32 exec_hi, 0xff
    ds_write_b32 v7, v106 offset:0
    ds_write_b32 v7, v107 offset:144
    s_mov_b32 exec_hi, -1
    v_lshlrev_b32 v80, 16, v49
    v_and_b32 v81, 0xffff0000, v49
    v_lshlrev_b32 v82, 16, v53
    v_and_b32 v83, 0xffff0000, v53
    v_lshlrev_b32 v84, 16, v57
    v_and_b32 v85, 0xffff0000, v57
    v_lshlrev_b32 v86, 16, v61
    v_and_b32 v87, 0xffff0000, v61
    v_lshlrev_b32 v88, 16, v65
    v_and_b32 v89, 0xffff0000, v65
    v_lshlrev_b32 v90, 16, v112
    v_lshlrev_b32 v91, 16, v114
    v_and_b32 v92, 0xffff0000, v112
    v_and_b32 v93, 0xffff0000, v114
    v_lshlrev_b32 v94, 16, v113
    v_lshlrev_b32 v95, 16, v115
    v_and_b32 v96, 0xffff0000, v113
    v_and_b32 v97, 0xffff0000, v115
    v_pk_mul_f32 v[98:99], v[86:87], v[90:91]
    v_pk_mul_f32 v[100:101], v[88:89], v[90:91]
    v_pk_fma_f32 v[98:99], v[84:85], v[92:93], v[98:99]
    v_pk_fma_f32 v[100:101], v[86:87], v[92:93], v[100:101]
    v_pk_fma_f32 v[98:99], v[82:83], v[94:95], v[98:99]
    v_pk_fma_f32 v[100:101], v[84:85], v[94:95], v[100:101]
    v_pk_fma_f32 v[98:99], v[80:81], v[96:97], v[98:99]
    v_pk_fma_f32 v[100:101], v[82:83], v[96:97], v[100:101]
    v_lshlrev_b32 v102, 16, v69
    v_and_b32 v103, 0xffff0000, v69
    v_lshlrev_b32 v104, 16, v73
    v_and_b32 v105, 0xffff0000, v73
    v_pk_mul_f32 v[98:99], v[98:99], v[102:103]
    v_pk_mul_f32 v[100:101], v[100:101], v[104:105]
    v_cvt_pk_bf16_f32 v106, v100, v98
    v_cvt_pk_bf16_f32 v107, v101, v99
    s_mov_b32 exec_hi, 0xff
    ds_write_b32 v7, v106 offset:288
    ds_write_b32 v7, v107 offset:432
    s_mov_b32 exec_hi, -1
    ds_read_b128 v[108:111], v44 offset:32
    ds_read_b128 v[112:115], v44 offset:48
    v_lshlrev_b32 v80, 16, v50
    v_and_b32 v81, 0xffff0000, v50
    v_lshlrev_b32 v82, 16, v54
    v_and_b32 v83, 0xffff0000, v54
    v_lshlrev_b32 v84, 16, v58
    v_and_b32 v85, 0xffff0000, v58
    v_lshlrev_b32 v86, 16, v62
    v_and_b32 v87, 0xffff0000, v62
    v_lshlrev_b32 v88, 16, v66
    v_and_b32 v89, 0xffff0000, v66
    s_waitcnt lgkmcnt(0)
    v_lshlrev_b32 v90, 16, v108
    v_lshlrev_b32 v91, 16, v110
    v_and_b32 v92, 0xffff0000, v108
    v_and_b32 v93, 0xffff0000, v110
    v_lshlrev_b32 v94, 16, v109
    v_lshlrev_b32 v95, 16, v111
    v_and_b32 v96, 0xffff0000, v109
    v_and_b32 v97, 0xffff0000, v111
    v_pk_mul_f32 v[98:99], v[86:87], v[90:91]
    v_pk_mul_f32 v[100:101], v[88:89], v[90:91]
    v_pk_fma_f32 v[98:99], v[84:85], v[92:93], v[98:99]
    v_pk_fma_f32 v[100:101], v[86:87], v[92:93], v[100:101]
    v_pk_fma_f32 v[98:99], v[82:83], v[94:95], v[98:99]
    v_pk_fma_f32 v[100:101], v[84:85], v[94:95], v[100:101]
    v_pk_fma_f32 v[98:99], v[80:81], v[96:97], v[98:99]
    v_pk_fma_f32 v[100:101], v[82:83], v[96:97], v[100:101]
    v_lshlrev_b32 v102, 16, v70
    v_and_b32 v103, 0xffff0000, v70
    v_lshlrev_b32 v104, 16, v74
    v_and_b32 v105, 0xffff0000, v74
    v_pk_mul_f32 v[98:99], v[98:99], v[102:103]
    v_pk_mul_f32 v[100:101], v[100:101], v[104:105]
    v_cvt_pk_bf16_f32 v106, v100, v98
    v_cvt_pk_bf16_f32 v107, v101, v99
    s_mov_b32 exec_hi, 0xff
    ds_write_b32 v7, v106 offset:576
    ds_write_b32 v7, v107 offset:720
    s_mov_b32 exec_hi, -1
    v_lshlrev_b32 v80, 16, v51
    v_and_b32 v81, 0xffff0000, v51
    v_lshlrev_b32 v82, 16, v55
    v_and_b32 v83, 0xffff0000, v55
    v_lshlrev_b32 v84, 16, v59
    v_and_b32 v85, 0xffff0000, v59
    v_lshlrev_b32 v86, 16, v63
    v_and_b32 v87, 0xffff0000, v63
    v_lshlrev_b32 v88, 16, v67
    v_and_b32 v89, 0xffff0000, v67
    v_lshlrev_b32 v90, 16, v112
    v_lshlrev_b32 v91, 16, v114
    v_and_b32 v92, 0xffff0000, v112
    v_and_b32 v93, 0xffff0000, v114
    v_lshlrev_b32 v94, 16, v113
    v_lshlrev_b32 v95, 16, v115
    v_and_b32 v96, 0xffff0000, v113
    v_and_b32 v97, 0xffff0000, v115
    v_pk_mul_f32 v[98:99], v[86:87], v[90:91]
    v_pk_mul_f32 v[100:101], v[88:89], v[90:91]
    v_pk_fma_f32 v[98:99], v[84:85], v[92:93], v[98:99]
    v_pk_fma_f32 v[100:101], v[86:87], v[92:93], v[100:101]
    v_pk_fma_f32 v[98:99], v[82:83], v[94:95], v[98:99]
    v_pk_fma_f32 v[100:101], v[84:85], v[94:95], v[100:101]
    v_pk_fma_f32 v[98:99], v[80:81], v[96:97], v[98:99]
    v_pk_fma_f32 v[100:101], v[82:83], v[96:97], v[100:101]
    v_lshlrev_b32 v102, 16, v71
    v_and_b32 v103, 0xffff0000, v71
    v_lshlrev_b32 v104, 16, v75
    v_and_b32 v105, 0xffff0000, v75
    v_pk_mul_f32 v[98:99], v[98:99], v[102:103]
    v_pk_mul_f32 v[100:101], v[100:101], v[104:105]
    v_cvt_pk_bf16_f32 v106, v100, v98
    v_cvt_pk_bf16_f32 v107, v101, v99
    s_mov_b32 exec_hi, 0xff
    ds_write_b32 v7, v106 offset:864
    ds_write_b32 v7, v107 offset:1008
    s_mov_b32 exec_hi, -1
    s_lshl_b32 s48, s47, 4
    v_add_u32 v43, s48, v3
    v_mul_u32_u24 v43, 200, v43
    v_lshl_add_u32 v43, v2, 3, v43
    s_mul_i32 s48, s43, 96
    s_add_u32 s48, s48, 0
    v_add_u32 v43, s48, v43
    s_waitcnt vmcnt(0)
    s_mov_b32 s65, 0
k1_poll_13:
    s_add_u32 s65, s65, 1
    s_cmp_gt_u32 s65, 100000
    s_cbranch_scc1 k1_polled_14
    v_cmp_ne_u32 vcc, s100, v30
    v_cmp_ne_u32 s[50:51], s101, v31
    s_nop 0
    s_or_b64 vcc, vcc, s[50:51]
    v_cmp_ne_u32 s[50:51], s100, v34
    s_nop 0
    s_or_b64 vcc, vcc, s[50:51]
    v_cmp_ne_u32 s[50:51], s101, v35
    s_nop 0
    s_or_b64 vcc, vcc, s[50:51]
    s_cmp_eq_u64 vcc, 0
    s_cbranch_scc1 k1_polled_14
    s_sleep 4
    buffer_load_dwordx4 v[28:31], v38, s[24:27], s62 offen sc1
    buffer_load_dwordx4 v[32:35], v38, s[24:27], s62 offen offset:1024 sc1
    s_waitcnt vmcnt(0)
    s_branch k1_poll_13
k1_polled_14:
    s_xor_b32 s48, s42, 1
    s_or_b32 s48, s48, s41
    s_cmp_lg_u32 s48, 0
    s_cbranch_scc1 k1_ep_15
    v_mov_b32 v4, 0
    v_mov_b32 v44, 1
    s_mov_b64 exec, 1
    buffer_atomic_add v44, v4, s[28:31], 0 offen sc0
    s_mov_b64 exec, -1
k1_ep_15:
    v_pk_add_f32 v[8:9], v[28:29], v[32:33]
    v_mov_b32 v10, v8
    v_mov_b32 v11, v9
    s_nop 0
    v_permlane16_swap_b32 v8, v10
    v_permlane16_swap_b32 v9, v11
    v_add_f32 v8, v8, v10
    v_add_f32 v9, v9, v11
    v_mov_b32 v10, v8
    v_mov_b32 v11, v9
    s_nop 0
    v_permlane32_swap_b32 v8, v10
    v_permlane32_swap_b32 v9, v11
    v_add_f32 v8, v8, v10
    v_add_f32 v9, v9, v11
    v_mul_f32 v8, 0x3aaaaaab, v8
    v_mul_f32 v9, 0x3aaaaaab, v9
    v_fma_f32 v9, -v8, v8, v9
    v_max_f32 v9, 0, v9
    v_cvt_pk_bf16_f32 v9, v9, v8
    v_and_b32 v8, 0xffff0000, v9
    v_lshlrev_b32 v9, 16, v9
    v_add_f32 v9, s55, v9
    v_cvt_pk_bf16_f32 v9, v9, v9
    v_and_b32 v9, 0xffff0000, v9
    v_sqrt_f32 v9, v9
    s_nop 0
    v_cvt_pk_bf16_f32 v9, v9, v9
    v_and_b32 v9, 0xffff0000, v9
    v_rcp_f32 v9, v9
    s_nop 0
    v_mov_b32 v10, v9
    v_pk_add_f32 v[200:201], v[200:201], v[8:9] op_sel_hi:[1,0] neg_lo:[0,1] neg_hi:[0,1]
    v_pk_add_f32 v[202:203], v[202:203], v[8:9] op_sel_hi:[1,0] neg_lo:[0,1] neg_hi:[0,1]
    v_pk_add_f32 v[204:205], v[204:205], v[8:9] op_sel_hi:[1,0] neg_lo:[0,1] neg_hi:[0,1]
    v_pk_add_f32 v[206:207], v[206:207], v[8:9] op_sel_hi:[1,0] neg_lo:[0,1] neg_hi:[0,1]
    v_pk_add_f32 v[208:209], v[208:209], v[8:9] op_sel_hi:[1,0] neg_lo:[0,1] neg_hi:[0,1]
    v_pk_add_f32 v[210:211], v[210:211], v[8:9] op_sel_hi:[1,0] neg_lo:[0,1] neg_hi:[0,1]
    v_pk_mul_f32 v[200:201], v[200:201], v[10:11] op_sel_hi:[1,0]
    v_pk_mul_f32 v[202:203], v[202:203], v[10:11] op_sel_hi:[1,0]
    v_pk_mul_f32 v[204:205], v[204:205], v[10:11] op_sel_hi:[1,0]
    v_pk_mul_f32 v[206:207], v[206:207], v[10:11] op_sel_hi:[1,0]
    v_pk_mul_f32 v[208:209], v[208:209], v[10:11] op_sel_hi:[1,0]
    v_pk_mul_f32 v[210:211], v[210:211], v[10:11] op_sel_hi:[1,0]
    v_cvt_pk_bf16_f32 v16, v200, v201
    v_cvt_pk_bf16_f32 v17, v202, v203
    ds_write_b64 v43, v[16:17] offset:0
    v_cvt_pk_bf16_f32 v18, v204, v205
    v_cvt_pk_bf16_f32 v19, v206, v207
    ds_write_b64 v43, v[18:19] offset:32
    v_cvt_pk_bf16_f32 v20, v208, v209
    v_cvt_pk_bf16_f32 v21, v210, v211
    ds_write_b64 v43, v[20:21] offset:64
    v_lshrrev_b32 v218, 1, v2
    v_lshrrev_b32 v5, 2, v3
    v_lshl_add_u32 v218, v218, 3, v5
    v_mul_u32_u24 v218, 200, v218
    v_and_b32 v5, 1, v2
    v_lshl_add_u32 v218, v5, 5, v218
    v_and_b32 v5, 3, v3
    v_lshl_add_u32 v218, v5, 3, v218
    v_lshlrev_b32 v219, 4, v1
    s_waitcnt lgkmcnt(0)
    s_barrier
    s_add_u32 s48, s42, 0
    s_mul_i32 s49, s48, 43
    s_lshr_b32 s49, s49, 7
    s_mul_i32 s50, s49, 3
    s_sub_u32 s50, s48, s50
    s_mul_i32 s49, s49, 3200
    s_lshl_b32 s50, s50, 6
    s_add_u32 s49, s49, s50
    s_add_u32 s49, s49, 0
    v_add_u32 v5, s49, v218
    ds_read_b64_tr_b16 v[8:9], v5
    ds_read_b64_tr_b16 v[10:11], v5 offset:800
    s_lshl_b32 s49, s41, 7
    s_lshl_b32 s50, s40, 2
    s_add_u32 s49, s49, s50
    s_mul_i32 s49, s49, 3
    s_add_u32 s49, s49, s48
    s_lshl_b32 s49, s49, 10
    s_add_u32 s49, s49, 0
    s_waitcnt lgkmcnt(0)
    buffer_store_dwordx4 v[8:11], v219, s[24:27], s49 offen
    s_cmp_ge_u32 s42, 4
    s_cbranch_scc1 k1_fr_16
    s_add_u32 s48, s42, 8
    s_mul_i32 s49, s48, 43
    s_lshr_b32 s49, s49, 7
    s_mul_i32 s50, s49, 3
    s_sub_u32 s50, s48, s50
    s_mul_i32 s49, s49, 3200
    s_lshl_b32 s50, s50, 6
    s_add_u32 s49, s49, s50
    s_add_u32 s49, s49, 0
    v_add_u32 v5, s49, v218
    ds_read_b64_tr_b16 v[12:13], v5
    ds_read_b64_tr_b16 v[14:15], v5 offset:800
    s_lshl_b32 s49, s41, 7
    s_lshl_b32 s50, s40, 2
    s_add_u32 s49, s49, s50
    s_mul_i32 s49, s49, 3
    s_add_u32 s49, s49, s48
    s_lshl_b32 s49, s49, 10
    s_add_u32 s49, s49, 0
    s_waitcnt lgkmcnt(0)
    buffer_store_dwordx4 v[12:15], v219, s[24:27], s49 offen
k1_fr_16:
    s_lshl_b32 s48, s42, 3
    v_lshrrev_b32 v4, 3, v1
    v_add_u32 v4, s48, v4
    v_and_b32 v5, 7, v1
    v_lshlrev_b32 v5, 4, v5
    v_mul_u32_u24 v6, 144, v4
    v_add_u32 v6, v6, v5
    v_add_u32 v6, 106496, v6
    ds_read_b128 v[120:123], v6
    v_lshlrev_b32 v4, 12, v4
    v_add_u32 v4, v4, v5
    s_mul_i32 s48, s41, 327680
    s_lshl_b32 s49, s40, 7
    s_add_u32 s48, s48, s49
    s_add_u32 s48, s48, 6291456
    s_waitcnt lgkmcnt(0)
    buffer_store_dwordx4 v[120:123], v4, s[24:27], s48 offen
    s_lshl_b32 s48, s42, 3
    s_add_u32 s48, s48, 64
    v_lshrrev_b32 v4, 3, v1
    v_add_u32 v4, s48, v4
    v_and_b32 v5, 7, v1
    v_lshlrev_b32 v5, 4, v5
    v_mul_u32_u24 v6, 144, v4
    v_add_u32 v6, v6, v5
    v_add_u32 v6, 106496, v6
    ds_read_b128 v[124:127], v6
    v_lshlrev_b32 v4, 12, v4
    v_add_u32 v4, v4, v5
    s_mul_i32 s48, s41, 327680
    s_lshl_b32 s49, s40, 7
    s_add_u32 s48, s48, s49
    s_add_u32 s48, s48, 6291456
    s_waitcnt lgkmcnt(0)
    s_cmp_ge_u32 s42, 2
    s_cbranch_scc1 k1_kvskip_17
    buffer_store_dwordx4 v[124:127], v4, s[24:27], s48 offen
k1_kvskip_17:
    s_xor_b32 s48, s42, 4
    s_mul_i32 s48, s48, 3072
    s_add_u32 s48, s48, 16384
    v_lshl_add_u32 v4, v1, 4, s48
    ds_read_b128 v[48:51], v4 offset:0
    ds_read_b128 v[52:55], v4 offset:1024
    ds_read_b128 v[56:59], v4 offset:2048
    s_mul_i32 s48, s43, 768
    s_add_u32 s48, s48, 157184
    v_lshl_add_u32 v6, v2, 4, s48
    ds_read_b128 v[64:67], v6 offset:0
    ds_read_b128 v[68:71], v6 offset:64
    ds_read_b128 v[72:75], v6 offset:128
    ds_read_b128 v[76:79], v6 offset:192
    ds_read_b128 v[80:83], v6 offset:256
    ds_read_b128 v[84:87], v6 offset:320
    ds_read_b128 v[88:91], v6 offset:384
    ds_read_b128 v[92:95], v6 offset:448
    ds_read_b128 v[96:99], v6 offset:512
    ds_read_b128 v[100:103], v6 offset:576
    ds_read_b128 v[104:107], v6 offset:640
    ds_read_b128 v[108:111], v6 offset:704
    s_waitcnt lgkmcnt(12)
    v_pk_add_f32 v[128:129], v[128:129], v[48:49]
    v_pk_add_f32 v[130:131], v[130:131], v[50:51]
    v_pk_add_f32 v[132:133], v[132:133], v[52:53]
    v_pk_add_f32 v[134:135], v[134:135], v[54:55]
    v_pk_add_f32 v[136:137], v[136:137], v[56:57]
    v_pk_add_f32 v[138:139], v[138:139], v[58:59]
    s_waitcnt lgkmcnt(6)
    v_pk_add_f32 v[64:65], v[64:65], v[76:77]
    v_pk_add_f32 v[66:67], v[66:67], v[78:79]
    v_pk_add_f32 v[68:69], v[68:69], v[80:81]
    v_pk_add_f32 v[70:71], v[70:71], v[82:83]
    v_pk_add_f32 v[72:73], v[72:73], v[84:85]
    v_pk_add_f32 v[74:75], v[74:75], v[86:87]
    s_waitcnt lgkmcnt(0)
    v_pk_add_f32 v[88:89], v[88:89], v[100:101]
    v_pk_add_f32 v[90:91], v[90:91], v[102:103]
    v_pk_add_f32 v[92:93], v[92:93], v[104:105]
    v_pk_add_f32 v[94:95], v[94:95], v[106:107]
    v_pk_add_f32 v[96:97], v[96:97], v[108:109]
    v_pk_add_f32 v[98:99], v[98:99], v[110:111]
    v_pk_add_f32 v[64:65], v[64:65], v[88:89]
    v_pk_add_f32 v[66:67], v[66:67], v[90:91]
    v_pk_add_f32 v[68:69], v[68:69], v[92:93]
    v_pk_add_f32 v[70:71], v[70:71], v[94:95]
    v_pk_add_f32 v[72:73], v[72:73], v[96:97]
    v_pk_add_f32 v[74:75], v[74:75], v[98:99]
    v_pk_fma_f32 v[128:129], v[64:65], v[240:241], v[128:129] op_sel_hi:[1,0,1] neg_lo:[0,1,0] neg_hi:[0,1,0]
    v_pk_fma_f32 v[130:131], v[66:67], v[240:241], v[130:131] op_sel_hi:[1,0,1] neg_lo:[0,1,0] neg_hi:[0,1,0]
    v_pk_fma_f32 v[132:133], v[68:69], v[240:241], v[132:133] op_sel_hi:[1,0,1] neg_lo:[0,1,0] neg_hi:[0,1,0]
    v_pk_fma_f32 v[134:135], v[70:71], v[240:241], v[134:135] op_sel_hi:[1,0,1] neg_lo:[0,1,0] neg_hi:[0,1,0]
    v_pk_fma_f32 v[136:137], v[72:73], v[240:241], v[136:137] op_sel_hi:[1,0,1] neg_lo:[0,1,0] neg_hi:[0,1,0]
    v_pk_fma_f32 v[138:139], v[74:75], v[240:241], v[138:139] op_sel_hi:[1,0,1] neg_lo:[0,1,0] neg_hi:[0,1,0]
    v_pk_mul_f32 v[128:129], v[128:129], v[242:243] op_sel_hi:[1,0]
    v_pk_mul_f32 v[130:131], v[130:131], v[242:243] op_sel_hi:[1,0]
    v_pk_mul_f32 v[132:133], v[132:133], v[242:243] op_sel_hi:[1,0]
    v_pk_mul_f32 v[134:135], v[134:135], v[242:243] op_sel_hi:[1,0]
    v_pk_mul_f32 v[136:137], v[136:137], v[242:243] op_sel_hi:[1,0]
    v_pk_mul_f32 v[138:139], v[138:139], v[242:243] op_sel_hi:[1,0]
    v_pk_mul_f32 v[48:49], v[128:129], v[128:129]
    v_pk_mul_f32 v[50:51], v[130:131], v[130:131]
    v_pk_mul_f32 v[52:53], v[132:133], v[132:133]
    v_pk_mul_f32 v[54:55], v[134:135], v[134:135]
    v_pk_mul_f32 v[56:57], v[136:137], v[136:137]
    v_pk_mul_f32 v[58:59], v[138:139], v[138:139]
    v_pk_fma_f32 v[48:49], v[48:49], s[58:59], v[238:239]
    v_pk_fma_f32 v[50:51], v[50:51], s[58:59], v[238:239]
    v_pk_fma_f32 v[52:53], v[52:53], s[58:59], v[238:239]
    v_pk_fma_f32 v[54:55], v[54:55], s[58:59], v[238:239]
    v_pk_fma_f32 v[56:57], v[56:57], s[58:59], v[238:239]
    v_pk_fma_f32 v[58:59], v[58:59], s[58:59], v[238:239]
    v_pk_mul_f32 v[48:49], v[48:49], v[128:129]
    v_pk_mul_f32 v[50:51], v[50:51], v[130:131]
    v_pk_mul_f32 v[52:53], v[52:53], v[132:133]
    v_pk_mul_f32 v[54:55], v[54:55], v[134:135]
    v_pk_mul_f32 v[56:57], v[56:57], v[136:137]
    v_pk_mul_f32 v[58:59], v[58:59], v[138:139]
    v_exp_f32 v48, v48
    v_exp_f32 v49, v49
    v_exp_f32 v50, v50
    v_exp_f32 v51, v51
    v_exp_f32 v52, v52
    v_exp_f32 v53, v53
    v_exp_f32 v54, v54
    v_exp_f32 v55, v55
    v_exp_f32 v56, v56
    v_exp_f32 v57, v57
    v_exp_f32 v58, v58
    v_exp_f32 v59, v59
    v_pk_add_f32 v[48:49], v[48:49], 1.0 op_sel_hi:[1,0]
    v_pk_add_f32 v[50:51], v[50:51], 1.0 op_sel_hi:[1,0]
    v_pk_add_f32 v[52:53], v[52:53], 1.0 op_sel_hi:[1,0]
    v_pk_add_f32 v[54:55], v[54:55], 1.0 op_sel_hi:[1,0]
    v_pk_add_f32 v[56:57], v[56:57], 1.0 op_sel_hi:[1,0]
    v_pk_add_f32 v[58:59], v[58:59], 1.0 op_sel_hi:[1,0]
    v_rcp_f32 v48, v48
    v_rcp_f32 v49, v49
    v_rcp_f32 v50, v50
    v_rcp_f32 v51, v51
    v_rcp_f32 v52, v52
    v_rcp_f32 v53, v53
    v_rcp_f32 v54, v54
    v_rcp_f32 v55, v55
    v_rcp_f32 v56, v56
    v_rcp_f32 v57, v57
    v_rcp_f32 v58, v58
    v_rcp_f32 v59, v59
    v_pk_mul_f32 v[128:129], v[128:129], v[48:49]
    v_pk_mul_f32 v[130:131], v[130:131], v[50:51]
    v_pk_mul_f32 v[132:133], v[132:133], v[52:53]
    v_pk_mul_f32 v[134:135], v[134:135], v[54:55]
    v_pk_mul_f32 v[136:137], v[136:137], v[56:57]
    v_pk_mul_f32 v[138:139], v[138:139], v[58:59]
    v_lshrrev_b32 v4, 1, v2
    v_mul_u32_u24 v4, 3072, v4
    v_and_b32 v5, 1, v2
    v_lshlrev_b32 v5, 5, v5
    v_add_u32 v5, v5, v3
    v_lshl_add_u32 v4, v5, 4, v4
    s_lshl_b32 s48, s40, 3
    s_add_u32 s48, s48, s41
    s_mul_i32 s62, s48, 12288
    s_lshr_b32 s48, s47, 1
    s_mul_i32 s48, s48, 6144
    s_add_u32 s62, s62, s48
    s_and_b32 s48, s47, 1
    s_lshl_b32 s48, s48, 8
    s_add_u32 s62, s62, s48
    s_add_u32 s62, s62, 3145728
    s_mul_i32 s51, s43, 3
    v_cvt_pk_bf16_f32 v48, v128, v129
    v_cvt_pk_bf16_f32 v49, v130, v131
    s_add_u32 s48, s51, 0
    s_lshr_b32 s49, s48, 1
    s_lshl_b32 s49, s49, 10
    s_and_b32 s48, s48, 1
    s_lshl_b32 s48, s48, 3
    s_add_u32 s48, s48, s49
    s_add_u32 s48, s48, s62
    buffer_store_dwordx2 v[48:49], v4, s[24:27], s48 offen
    v_cvt_pk_bf16_f32 v50, v132, v133
    v_cvt_pk_bf16_f32 v51, v134, v135
    s_add_u32 s48, s51, 1
    s_lshr_b32 s49, s48, 1
    s_lshl_b32 s49, s49, 10
    s_and_b32 s48, s48, 1
    s_lshl_b32 s48, s48, 3
    s_add_u32 s48, s48, s49
    s_add_u32 s48, s48, s62
    buffer_store_dwordx2 v[50:51], v4, s[24:27], s48 offen
    v_cvt_pk_bf16_f32 v52, v136, v137
    v_cvt_pk_bf16_f32 v53, v138, v139
    s_add_u32 s48, s51, 2
    s_lshr_b32 s49, s48, 1
    s_lshl_b32 s49, s49, 10
    s_and_b32 s48, s48, 1
    s_lshl_b32 s48, s48, 3
    s_add_u32 s48, s48, s49
    s_add_u32 s48, s48, s62
    buffer_store_dwordx2 v[52:53], v4, s[24:27], s48 offen
    s_xor_b32 s48, s42, 1
    s_or_b32 s48, s48, s41
    s_cmp_lg_u32 s48, 0
    s_cbranch_scc1 k1_ep2_18
    s_waitcnt vmcnt(0)
    v_readfirstlane_b32 s48, v44
    s_nop 0
    s_cmp_lg_u32 s48, 31
    s_cbranch_scc1 k1_ep2_18
    v_mov_b32 v8, s100
    v_mov_b32 v9, s101
    v_mov_b32 v4, 14712832
    s_mov_b64 exec, 1
    buffer_store_dwordx2 v[8:9], v4, s[24:27], 0 offen sc1
    s_mov_b64 exec, -1
k1_ep2_18:
k1_kernel_end:
    s_endpgm

.globl k2_kernel
.p2align 8
.type k2_kernel,@function
k2_kernel:
    s_cmp_ge_u32 s2, 512
    s_cbranch_scc1 k2_kernel_end
    s_cmp_lt_u32 s2, 256
    s_cbranch_scc1 k2_kernel_conv
    s_load_dwordx2 s[4:5], s[0:1], 64
    s_load_dwordx2 s[8:9], s[0:1], 104
    s_load_dwordx2 s[12:13], s[0:1], 72
    v_lshrrev_b32 v2, 6, v0
    v_and_b32 v1, 63, v0
    v_readfirstlane_b32 s34, v2
    s_mov_b32 s6, 8388608
    s_mov_b32 s7, 0x20000
    s_mov_b32 s10, 15990784
    s_mov_b32 s11, 0x20000
    s_mov_b32 s14, 4096
    s_mov_b32 s15, 0x20000
    s_and_b32 s40, s2, 7
    s_lshr_b32 s41, s2, 3
    s_and_b32 s41, s41, 31
    s_lshr_b32 s32, s40, 1
    s_lshl_b32 s32, s32, 3
    s_and_b32 s42, s41, 7
    s_add_u32 s32, s32, s42
    s_and_b32 s33, s40, 1
    s_lshl_b32 s33, s33, 2
    s_lshr_b32 s42, s41, 3
    s_add_u32 s33, s33, s42
    s_lshl_b32 s44, s33, 7
    s_lshl_b32 s40, s34, 5
    s_add_u32 s44, s44, s40
    s_mul_i32 s44, s44, 3072
    s_add_u32 s44, s44, 0
    s_lshl_b32 s45, s32, 18
    s_lshl_b32 s40, s34, 10
    s_add_u32 s45, s45, s40
    s_lshl_b32 s46, s34, 14
    v_lshlrev_b32 v5, 4, v1
    v_lshrrev_b32 v2, 3, v1
    v_lshlrev_b32 v2, 12, v2
    v_and_b32 v3, 7, v1
    v_lshrrev_b32 v4, 4, v1
    v_xor_b32 v3, v3, v4
    v_lshl_add_u32 v6, v3, 4, v2
    v_xor_b32 v7, 64, v6
    s_mov_b32 s50, 0
    s_waitcnt lgkmcnt(0)
    s_add_u32 s52, s50, 0
    s_and_b32 s52, s52, 7
    s_mul_i32 s52, s52, 12288
    s_add_u32 s52, s52, s44
    buffer_load_dwordx4 v[104:107], v5, s[8:11], s52 offen offset:0
    buffer_load_dwordx4 v[108:111], v5, s[8:11], s52 offen offset:1024
    buffer_load_dwordx4 v[112:115], v5, s[8:11], s52 offen offset:2048
    s_add_u32 s54, s50, 0
    s_and_b32 s54, s54, 7
    s_lshl_b32 s54, s54, 7
    s_add_u32 s54, s54, s45
    s_add_u32 s42, s54, 0
    s_add_u32 m0, s46, 0
    s_nop 0
    buffer_load_dwordx4 v6, s[4:7], s42 offen lds
    s_add_u32 s42, s54, 32768
    s_add_u32 m0, s46, 1024
    s_nop 0
    buffer_load_dwordx4 v7, s[4:7], s42 offen lds
    s_add_u32 s42, s54, 65536
    s_add_u32 m0, s46, 2048
    s_nop 0
    buffer_load_dwordx4 v6, s[4:7], s42 offen lds
    s_add_u32 s42, s54, 98304
    s_add_u32 m0, s46, 3072
    s_nop 0
    buffer_load_dwordx4 v7, s[4:7], s42 offen lds
    s_add_u32 s42, s54, 131072
    s_add_u32 m0, s46, 4096
    s_nop 0
    buffer_load_dwordx4 v6, s[4:7], s42 offen lds
    s_add_u32 s42, s54, 163840
    s_add_u32 m0, s46, 5120
    s_nop 0
    buffer_load_dwordx4 v7, s[4:7], s42 offen lds
    s_add_u32 s42, s54, 196608
    s_add_u32 m0, s46, 6144
    s_nop 0
    buffer_load_dwordx4 v6, s[4:7], s42 offen lds
    s_add_u32 s42, s54, 229376
    s_add_u32 m0, s46, 7168
    s_nop 0
    buffer_load_dwordx4 v7, s[4:7], s42 offen lds
    s_add_u32 s41, s52, 3072
    buffer_load_dwordx4 v[116:119], v5, s[8:11], s41 offen offset:0
    s_add_u32 s41, s52, 3072
    buffer_load_dwordx4 v[120:123], v5, s[8:11], s41 offen offset:1024
    s_add_u32 s41, s52, 3072
    buffer_load_dwordx4 v[124:127], v5, s[8:11], s41 offen offset:2048
    s_add_u32 s41, s52, 6144
    buffer_load_dwordx4 v[128:131], v5, s[8:11], s41 offen offset:0
    s_add_u32 s41, s52, 6144
    buffer_load_dwordx4 v[132:135], v5, s[8:11], s41 offen offset:1024
    s_add_u32 s41, s52, 6144
    buffer_load_dwordx4 v[136:139], v5, s[8:11], s41 offen offset:2048
    s_add_u32 s41, s52, 9216
    buffer_load_dwordx4 v[140:143], v5, s[8:11], s41 offen offset:0
    s_add_u32 s41, s52, 9216
    buffer_load_dwordx4 v[144:147], v5, s[8:11], s41 offen offset:1024
    s_add_u32 s41, s52, 9216
    buffer_load_dwordx4 v[148:151], v5, s[8:11], s41 offen offset:2048
    v_and_b32 v2, 31, v1
    v_lshrrev_b32 v3, 1, v2
    v_and_b32 v3, 7, v3
    v_lshrrev_b32 v4, 5, v1
    v_xor_b32 v3, v3, v4
    v_lshl_add_u32 v2, v2, 7, s46
    v_xor_b32 v4, 0, v3
    v_lshl_add_u32 v180, v4, 4, v2
    v_xor_b32 v4, 2, v3
    v_lshl_add_u32 v181, v4, 4, v2
    v_xor_b32 v4, 4, v3
    v_lshl_add_u32 v182, v4, 4, v2
    v_xor_b32 v4, 6, v3
    v_lshl_add_u32 v183, v4, 4, v2
    s_waitcnt vmcnt(9)
    s_setprio 2
    ds_read_b128 v[164:167], v180 offset:0
    ds_read_b128 v[168:171], v180 offset:4096
    s_waitcnt vmcnt(17)
    s_waitcnt lgkmcnt(0)
    v_mfma_f32_32x32x16_bf16 v[8:23], v[104:107], v[164:167], 0
    ds_read_b128 v[172:175], v181 offset:0
    ds_read_b128 v[176:179], v181 offset:4096
    v_mfma_f32_32x32x16_bf16 v[24:39], v[104:107], v[168:171], 0
    s_add_u32 s53, s50, 1
    s_and_b32 s53, s53, 7
    s_mul_i32 s53, s53, 12288
    s_add_u32 s53, s53, s44
    buffer_load_dwordx4 v[152:155], v5, s[8:11], s53 offen offset:0
    v_mfma_f32_32x32x16_bf16 v[40:55], v[108:111], v[164:167], 0
    buffer_load_dwordx4 v[156:159], v5, s[8:11], s53 offen offset:1024
    v_mfma_f32_32x32x16_bf16 v[56:71], v[108:111], v[168:171], 0
    buffer_load_dwordx4 v[160:163], v5, s[8:11], s53 offen offset:2048
    v_mfma_f32_32x32x16_bf16 v[72:87], v[112:115], v[164:167], 0
    s_add_u32 s55, s50, 1
    s_and_b32 s55, s55, 7
    s_lshl_b32 s55, s55, 7
    s_add_u32 s55, s55, s45
    s_add_u32 s42, s55, 0
    s_add_u32 m0, s46, 8192
    s_nop 0
    buffer_load_dwordx4 v6, s[4:7], s42 offen lds
    v_mfma_f32_32x32x16_bf16 v[88:103], v[112:115], v[168:171], 0
    s_add_u32 s42, s55, 32768
    s_add_u32 m0, s46, 9216
    s_nop 0
    buffer_load_dwordx4 v7, s[4:7], s42 offen lds
    s_add_u32 s42, s55, 65536
    s_add_u32 m0, s46, 10240
    s_nop 0
    buffer_load_dwordx4 v6, s[4:7], s42 offen lds
    s_add_u32 s42, s55, 98304
    s_add_u32 m0, s46, 11264
    s_nop 0
    buffer_load_dwordx4 v7, s[4:7], s42 offen lds
    s_waitcnt vmcnt(13)
    s_waitcnt lgkmcnt(0)
    v_mfma_f32_32x32x16_bf16 v[8:23], v[116:119], v[172:175], v[8:23]
    ds_read_b128 v[164:167], v182 offset:0
    ds_read_b128 v[168:171], v182 offset:4096
    v_mfma_f32_32x32x16_bf16 v[24:39], v[116:119], v[176:179], v[24:39]
    s_add_u32 s41, s53, 3072
    buffer_load_dwordx4 v[104:107], v5, s[8:11], s41 offen offset:0
    v_mfma_f32_32x32x16_bf16 v[40:55], v[120:123], v[172:175], v[40:55]
    s_add_u32 s41, s53, 3072
    buffer_load_dwordx4 v[108:111], v5, s[8:11], s41 offen offset:1024
    v_mfma_f32_32x32x16_bf16 v[56:71], v[120:123], v[176:179], v[56:71]
    s_add_u32 s41, s53, 3072
    buffer_load_dwordx4 v[112:115], v5, s[8:11], s41 offen offset:2048
    v_mfma_f32_32x32x16_bf16 v[72:87], v[124:127], v[172:175], v[72:87]
    s_add_u32 s42, s55, 131072
    s_add_u32 m0, s46, 12288
    s_nop 0
    buffer_load_dwordx4 v6, s[4:7], s42 offen lds
    v_mfma_f32_32x32x16_bf16 v[88:103], v[124:127], v[176:179], v[88:103]
    s_add_u32 s42, s55, 163840
    s_add_u32 m0, s46, 13312
    s_nop 0
    buffer_load_dwordx4 v7, s[4:7], s42 offen lds
    s_add_u32 s42, s55, 196608
    s_add_u32 m0, s46, 14336
    s_nop 0
    buffer_load_dwordx4 v6, s[4:7], s42 offen lds
    s_add_u32 s42, s55, 229376
    s_add_u32 m0, s46, 15360
    s_nop 0
    buffer_load_dwordx4 v7, s[4:7], s42 offen lds
    s_waitcnt vmcnt(17)
    s_waitcnt lgkmcnt(0)
    v_mfma_f32_32x32x16_bf16 v[8:23], v[128:131], v[164:167], v[8:23]
    ds_read_b128 v[172:175], v183 offset:0
    ds_read_b128 v[176:179], v183 offset:4096
    v_mfma_f32_32x32x16_bf16 v[24:39], v[128:131], v[168:171], v[24:39]
    s_add_u32 s41, s53, 6144
    buffer_load_dwordx4 v[116:119], v5, s[8:11], s41 offen offset:0
    v_mfma_f32_32x32x16_bf16 v[40:55], v[132:135], v[164:167], v[40:55]
    s_add_u32 s41, s53, 6144
    buffer_load_dwordx4 v[120:123], v5, s[8:11], s41 offen offset:1024
    v_mfma_f32_32x32x16_bf16 v[56:71], v[132:135], v[168:171], v[56:71]
    s_add_u32 s41, s53, 6144
    buffer_load_dwordx4 v[124:127], v5, s[8:11], s41 offen offset:2048
    v_mfma_f32_32x32x16_bf16 v[72:87], v[136:139], v[164:167], v[72:87]
    v_mfma_f32_32x32x16_bf16 v[88:103], v[136:139], v[168:171], v[88:103]
    s_waitcnt vmcnt(17)
    s_waitcnt lgkmcnt(0)
    v_mfma_f32_32x32x16_bf16 v[8:23], v[140:143], v[172:175], v[8:23]
    s_waitcnt vmcnt(3)
    ds_read_b128 v[164:167], v180 offset:8192
    ds_read_b128 v[168:171], v180 offset:12288
    v_mfma_f32_32x32x16_bf16 v[24:39], v[140:143], v[176:179], v[24:39]
    s_add_u32 s41, s53, 9216
    buffer_load_dwordx4 v[128:131], v5, s[8:11], s41 offen offset:0
    v_mfma_f32_32x32x16_bf16 v[40:55], v[144:147], v[172:175], v[40:55]
    s_add_u32 s41, s53, 9216
    buffer_load_dwordx4 v[132:135], v5, s[8:11], s41 offen offset:1024
    v_mfma_f32_32x32x16_bf16 v[56:71], v[144:147], v[176:179], v[56:71]
    s_add_u32 s41, s53, 9216
    buffer_load_dwordx4 v[136:139], v5, s[8:11], s41 offen offset:2048
    v_mfma_f32_32x32x16_bf16 v[72:87], v[148:151], v[172:175], v[72:87]
    s_add_u32 s54, s50, 2
    s_and_b32 s54, s54, 7
    s_lshl_b32 s54, s54, 7
    s_add_u32 s54, s54, s45
    s_add_u32 s42, s54, 0
    s_add_u32 m0, s46, 0
    s_nop 0
    buffer_load_dwordx4 v6, s[4:7], s42 offen lds
    v_mfma_f32_32x32x16_bf16 v[88:103], v[148:151], v[176:179], v[88:103]
    s_add_u32 s42, s54, 32768
    s_add_u32 m0, s46, 1024
    s_nop 0
    buffer_load_dwordx4 v7, s[4:7], s42 offen lds
    s_waitcnt vmcnt(19)
    s_waitcnt lgkmcnt(0)
    v_mfma_f32_32x32x16_bf16 v[8:23], v[152:155], v[164:167], v[8:23]
    ds_read_b128 v[172:175], v181 offset:8192
    ds_read_b128 v[176:179], v181 offset:12288
    v_mfma_f32_32x32x16_bf16 v[24:39], v[152:155], v[168:171], v[24:39]
    s_add_u32 s52, s50, 2
    s_and_b32 s52, s52, 7
    s_mul_i32 s52, s52, 12288
    s_add_u32 s52, s52, s44
    buffer_load_dwordx4 v[140:143], v5, s[8:11], s52 offen offset:0
    v_mfma_f32_32x32x16_bf16 v[40:55], v[156:159], v[164:167], v[40:55]
    buffer_load_dwordx4 v[144:147], v5, s[8:11], s52 offen offset:1024
    v_mfma_f32_32x32x16_bf16 v[56:71], v[156:159], v[168:171], v[56:71]
    buffer_load_dwordx4 v[148:151], v5, s[8:11], s52 offen offset:2048
    v_mfma_f32_32x32x16_bf16 v[72:87], v[160:163], v[164:167], v[72:87]
    s_add_u32 s42, s54, 65536
    s_add_u32 m0, s46, 2048
    s_nop 0
    buffer_load_dwordx4 v6, s[4:7], s42 offen lds
    v_mfma_f32_32x32x16_bf16 v[88:103], v[160:163], v[168:171], v[88:103]
    s_add_u32 s42, s54, 98304
    s_add_u32 m0, s46, 3072
    s_nop 0
    buffer_load_dwordx4 v7, s[4:7], s42 offen lds
    s_add_u32 s42, s54, 131072
    s_add_u32 m0, s46, 4096
    s_nop 0
    buffer_load_dwordx4 v6, s[4:7], s42 offen lds
    s_waitcnt vmcnt(18)
    s_waitcnt lgkmcnt(0)
    v_mfma_f32_32x32x16_bf16 v[8:23], v[104:107], v[172:175], v[8:23]
    ds_read_b128 v[164:167], v182 offset:8192
    ds_read_b128 v[168:171], v182 offset:12288
    v_mfma_f32_32x32x16_bf16 v[24:39], v[104:107], v[176:179], v[24:39]
    s_add_u32 s41, s52, 3072
    buffer_load_dwordx4 v[152:155], v5, s[8:11], s41 offen offset:0
    v_mfma_f32_32x32x16_bf16 v[40:55], v[108:111], v[172:175], v[40:55]
    s_add_u32 s41, s52, 3072
    buffer_load_dwordx4 v[156:159], v5, s[8:11], s41 offen offset:1024
    v_mfma_f32_32x32x16_bf16 v[56:71], v[108:111], v[176:179], v[56:71]
    s_add_u32 s41, s52, 3072
    buffer_load_dwordx4 v[160:163], v5, s[8:11], s41 offen offset:2048
    v_mfma_f32_32x32x16_bf16 v[72:87], v[112:115], v[172:175], v[72:87]
    s_add_u32 s42, s54, 163840
    s_add_u32 m0, s46, 5120
    s_nop 0
    buffer_load_dwordx4 v7, s[4:7], s42 offen lds
    v_mfma_f32_32x32x16_bf16 v[88:103], v[112:115], v[176:179], v[88:103]
    s_add_u32 s42, s54, 196608
    s_add_u32 m0, s46, 6144
    s_nop 0
    buffer_load_dwordx4 v6, s[4:7], s42 offen lds
    s_add_u32 s42, s54, 229376
    s_add_u32 m0, s46, 7168
    s_nop 0
    buffer_load_dwordx4 v7, s[4:7], s42 offen lds
    s_waitcnt vmcnt(17)
    s_waitcnt lgkmcnt(0)
    v_mfma_f32_32x32x16_bf16 v[8:23], v[116:119], v[164:167], v[8:23]
    ds_read_b128 v[172:175], v183 offset:8192
    ds_read_b128 v[176:179], v183 offset:12288
    v_mfma_f32_32x32x16_bf16 v[24:39], v[116:119], v[168:171], v[24:39]
    s_add_u32 s41, s52, 6144
    buffer_load_dwordx4 v[104:107], v5, s[8:11], s41 offen offset:0
    v_mfma_f32_32x32x16_bf16 v[40:55], v[120:123], v[164:167], v[40:55]
    s_add_u32 s41, s52, 6144
    buffer_load_dwordx4 v[108:111], v5, s[8:11], s41 offen offset:1024
    v_mfma_f32_32x32x16_bf16 v[56:71], v[120:123], v[168:171], v[56:71]
    s_add_u32 s41, s52, 6144
    buffer_load_dwordx4 v[112:115], v5, s[8:11], s41 offen offset:2048
    v_mfma_f32_32x32x16_bf16 v[72:87], v[124:127], v[164:167], v[72:87]
    v_mfma_f32_32x32x16_bf16 v[88:103], v[124:127], v[168:171], v[88:103]
    s_waitcnt vmcnt(17)
    s_waitcnt lgkmcnt(0)
    v_mfma_f32_32x32x16_bf16 v[8:23], v[128:131], v[172:175], v[8:23]
    s_waitcnt vmcnt(3)
    ds_read_b128 v[164:167], v180 offset:0
    ds_read_b128 v[168:171], v180 offset:4096
    v_mfma_f32_32x32x16_bf16 v[24:39], v[128:131], v[176:179], v[24:39]
    s_add_u32 s41, s52, 9216
    buffer_load_dwordx4 v[116:119], v5, s[8:11], s41 offen offset:0
    v_mfma_f32_32x32x16_bf16 v[40:55], v[132:135], v[172:175], v[40:55]
    s_add_u32 s41, s52, 9216
    buffer_load_dwordx4 v[120:123], v5, s[8:11], s41 offen offset:1024
    v_mfma_f32_32x32x16_bf16 v[56:71], v[132:135], v[176:179], v[56:71]
    s_add_u32 s41, s52, 9216
    buffer_load_dwordx4 v[124:127], v5, s[8:11], s41 offen offset:2048
    v_mfma_f32_32x32x16_bf16 v[72:87], v[136:139], v[172:175], v[72:87]
    s_add_u32 s55, s50, 3
    s_and_b32 s55, s55, 7
    s_lshl_b32 s55, s55, 7
    s_add_u32 s55, s55, s45
    s_add_u32 s42, s55, 0
    s_add_u32 m0, s46, 8192
    s_nop 0
    buffer_load_dwordx4 v6, s[4:7], s42 offen lds
    v_mfma_f32_32x32x16_bf16 v[88:103], v[136:139], v[176:179], v[88:103]
    s_add_u32 s42, s55, 32768
    s_add_u32 m0, s46, 9216
    s_nop 0
    buffer_load_dwordx4 v7, s[4:7], s42 offen lds
    s_waitcnt vmcnt(17)
    s_waitcnt lgkmcnt(0)
    v_mfma_f32_32x32x16_bf16 v[8:23], v[140:143], v[164:167], v[8:23]
    ds_read_b128 v[172:175], v181 offset:0
    ds_read_b128 v[176:179], v181 offset:4096
    v_mfma_f32_32x32x16_bf16 v[24:39], v[140:143], v[168:171], v[24:39]
    s_add_u32 s53, s50, 3
    s_and_b32 s53, s53, 7
    s_mul_i32 s53, s53, 12288
    s_add_u32 s53, s53, s44
    buffer_load_dwordx4 v[128:131], v5, s[8:11], s53 offen offset:0
    v_mfma_f32_32x32x16_bf16 v[40:55], v[144:147], v[164:167], v[40:55]
    buffer_load_dwordx4 v[132:135], v5, s[8:11], s53 offen offset:1024
    v_mfma_f32_32x32x16_bf16 v[56:71], v[144:147], v[168:171], v[56:71]
    buffer_load_dwordx4 v[136:139], v5, s[8:11], s53 offen offset:2048
    v_mfma_f32_32x32x16_bf16 v[72:87], v[148:151], v[164:167], v[72:87]
    s_add_u32 s42, s55, 65536
    s_add_u32 m0, s46, 10240
    s_nop 0
    buffer_load_dwordx4 v6, s[4:7], s42 offen lds
    v_mfma_f32_32x32x16_bf16 v[88:103], v[148:151], v[168:171], v[88:103]
    s_add_u32 s42, s55, 98304
    s_add_u32 m0, s46, 11264
    s_nop 0
    buffer_load_dwordx4 v7, s[4:7], s42 offen lds
    s_add_u32 s42, s55, 131072
    s_add_u32 m0, s46, 12288
    s_nop 0
    buffer_load_dwordx4 v6, s[4:7], s42 offen lds
    s_waitcnt vmcnt(17)
    s_waitcnt lgkmcnt(0)
    v_mfma_f32_32x32x16_bf16 v[8:23], v[152:155], v[172:175], v[8:23]
    ds_read_b128 v[164:167], v182 offset:0
    ds_read_b128 v[168:171], v182 offset:4096
    v_mfma_f32_32x32x16_bf16 v[24:39], v[152:155], v[176:179], v[24:39]
    s_add_u32 s41, s53, 3072
    buffer_load_dwordx4 v[140:143], v5, s[8:11], s41 offen offset:0
    v_mfma_f32_32x32x16_bf16 v[40:55], v[156:159], v[172:175], v[40:55]
    s_add_u32 s41, s53, 3072
    buffer_load_dwordx4 v[144:147], v5, s[8:11], s41 offen offset:1024
    v_mfma_f32_32x32x16_bf16 v[56:71], v[156:159], v[176:179], v[56:71]
    s_add_u32 s41, s53, 3072
    buffer_load_dwordx4 v[148:151], v5, s[8:11], s41 offen offset:2048
    v_mfma_f32_32x32x16_bf16 v[72:87], v[160:163], v[172:175], v[72:87]
    s_add_u32 s42, s55, 163840
    s_add_u32 m0, s46, 13312
    s_nop 0
    buffer_load_dwordx4 v7, s[4:7], s42 offen lds
    v_mfma_f32_32x32x16_bf16 v[88:103], v[160:163], v[176:179], v[88:103]
    s_add_u32 s42, s55, 196608
    s_add_u32 m0, s46, 14336
    s_nop 0
    buffer_load_dwordx4 v6, s[4:7], s42 offen lds
    s_add_u32 s42, s55, 229376
    s_add_u32 m0, s46, 15360
    s_nop 0
    buffer_load_dwordx4 v7, s[4:7], s42 offen lds
    s_waitcnt vmcnt(17)
    s_waitcnt lgkmcnt(0)
    v_mfma_f32_32x32x16_bf16 v[8:23], v[104:107], v[164:167], v[8:23]
    ds_read_b128 v[172:175], v183 offset:0
    ds_read_b128 v[176:179], v183 offset:4096
    v_mfma_f32_32x32x16_bf16 v[24:39], v[104:107], v[168:171], v[24:39]
    s_add_u32 s41, s53, 6144
    buffer_load_dwordx4 v[152:155], v5, s[8:11], s41 offen offset:0
    v_mfma_f32_32x32x16_bf16 v[40:55], v[108:111], v[164:167], v[40:55]
    s_add_u32 s41, s53, 6144
    buffer_load_dwordx4 v[156:159], v5, s[8:11], s41 offen offset:1024
    v_mfma_f32_32x32x16_bf16 v[56:71], v[108:111], v[168:171], v[56:71]
    s_add_u32 s41, s53, 6144
    buffer_load_dwordx4 v[160:163], v5, s[8:11], s41 offen offset:2048
    v_mfma_f32_32x32x16_bf16 v[72:87], v[112:115], v[164:167], v[72:87]
    v_mfma_f32_32x32x16_bf16 v[88:103], v[112:115], v[168:171], v[88:103]
    s_waitcnt vmcnt(17)
    s_waitcnt lgkmcnt(0)
    v_mfma_f32_32x32x16_bf16 v[8:23], v[116:119], v[172:175], v[8:23]
    s_waitcnt vmcnt(3)
    ds_read_b128 v[164:167], v180 offset:8192
    ds_read_b128 v[168:171], v180 offset:12288
    v_mfma_f32_32x32x16_bf16 v[24:39], v[116:119], v[176:179], v[24:39]
    s_add_u32 s41, s53, 9216
    buffer_load_dwordx4 v[104:107], v5, s[8:11], s41 offen offset:0
    v_mfma_f32_32x32x16_bf16 v[40:55], v[120:123], v[172:175], v[40:55]
    s_add_u32 s41, s53, 9216
    buffer_load_dwordx4 v[108:111], v5, s[8:11], s41 offen offset:1024
    v_mfma_f32_32x32x16_bf16 v[56:71], v[120:123], v[176:179], v[56:71]
    s_add_u32 s41, s53, 9216
    buffer_load_dwordx4 v[112:115], v5, s[8:11], s41 offen offset:2048
    v_mfma_f32_32x32x16_bf16 v[72:87], v[124:127], v[172:175], v[72:87]
    s_add_u32 s54, s50, 4
    s_and_b32 s54, s54, 7
    s_lshl_b32 s54, s54, 7
    s_add_u32 s54, s54, s45
    s_add_u32 s42, s54, 0
    s_add_u32 m0, s46, 0
    s_nop 0
    buffer_load_dwordx4 v6, s[4:7], s42 offen lds
    v_mfma_f32_32x32x16_bf16 v[88:103], v[124:127], v[176:179], v[88:103]
    s_add_u32 s42, s54, 32768
    s_add_u32 m0, s46, 1024
    s_nop 0
    buffer_load_dwordx4 v7, s[4:7], s42 offen lds
    s_waitcnt vmcnt(17)
    s_waitcnt lgkmcnt(0)
    v_mfma_f32_32x32x16_bf16 v[8:23], v[128:131], v[164:167], v[8:23]
    ds_read_b128 v[172:175], v181 offset:8192
    ds_read_b128 v[176:179], v181 offset:12288
    v_mfma_f32_32x32x16_bf16 v[24:39], v[128:131], v[168:171], v[24:39]
    s_add_u32 s52, s50, 4
    s_and_b32 s52, s52, 7
    s_mul_i32 s52, s52, 12288
    s_add_u32 s52, s52, s44
    buffer_load_dwordx4 v[116:119], v5, s[8:11], s52 offen offset:0
    v_mfma_f32_32x32x16_bf16 v[40:55], v[132:135], v[164:167], v[40:55]
    buffer_load_dwordx4 v[120:123], v5, s[8:11], s52 offen offset:1024
    v_mfma_f32_32x32x16_bf16 v[56:71], v[132:135], v[168:171], v[56:71]
    buffer_load_dwordx4 v[124:127], v5, s[8:11], s52 offen offset:2048
    v_mfma_f32_32x32x16_bf16 v[72:87], v[136:139], v[164:167], v[72:87]
    s_add_u32 s42, s54, 65536
    s_add_u32 m0, s46, 2048
    s_nop 0
    buffer_load_dwordx4 v6, s[4:7], s42 offen lds
    v_mfma_f32_32x32x16_bf16 v[88:103], v[136:139], v[168:171], v[88:103]
    s_add_u32 s42, s54, 98304
    s_add_u32 m0, s46, 3072
    s_nop 0
    buffer_load_dwordx4 v7, s[4:7], s42 offen lds
    s_add_u32 s42, s54, 131072
    s_add_u32 m0, s46, 4096
    s_nop 0
    buffer_load_dwordx4 v6, s[4:7], s42 offen lds
    s_waitcnt vmcnt(17)
    s_waitcnt lgkmcnt(0)
    v_mfma_f32_32x32x16_bf16 v[8:23], v[140:143], v[172:175], v[8:23]
    ds_read_b128 v[164:167], v182 offset:8192
    ds_read_b128 v[168:171], v182 offset:12288
    v_mfma_f32_32x32x16_bf16 v[24:39], v[140:143], v[176:179], v[24:39]
    s_add_u32 s41, s52, 3072
    buffer_load_dwordx4 v[128:131], v5, s[8:11], s41 offen offset:0
    v_mfma_f32_32x32x16_bf16 v[40:55], v[144:147], v[172:175], v[40:55]
    s_add_u32 s41, s52, 3072
    buffer_load_dwordx4 v[132:135], v5, s[8:11], s41 offen offset:1024
    v_mfma_f32_32x32x16_bf16 v[56:71], v[144:147], v[176:179], v[56:71]
    s_add_u32 s41, s52, 3072
    buffer_load_dwordx4 v[136:139], v5, s[8:11], s41 offen offset:2048
    v_mfma_f32_32x32x16_bf16 v[72:87], v[148:151], v[172:175], v[72:87]
    s_add_u32 s42, s54, 163840
    s_add_u32 m0, s46, 5120
    s_nop 0
    buffer_load_dwordx4 v7, s[4:7], s42 offen lds
    v_mfma_f32_32x32x16_bf16 v[88:103], v[148:151], v[176:179], v[88:103]
    s_add_u32 s42, s54, 196608
    s_add_u32 m0, s46, 6144
    s_nop 0
    buffer_load_dwordx4 v6, s[4:7], s42 offen lds
    s_add_u32 s42, s54, 229376
    s_add_u32 m0, s46, 7168
    s_nop 0
    buffer_load_dwordx4 v7, s[4:7], s42 offen lds
    s_waitcnt vmcnt(17)
    s_waitcnt lgkmcnt(0)
    v_mfma_f32_32x32x16_bf16 v[8:23], v[152:155], v[164:167], v[8:23]
    ds_read_b128 v[172:175], v183 offset:8192
    ds_read_b128 v[176:179], v183 offset:12288
    v_mfma_f32_32x32x16_bf16 v[24:39], v[152:155], v[168:171], v[24:39]
    s_add_u32 s41, s52, 6144
    buffer_load_dwordx4 v[140:143], v5, s[8:11], s41 offen offset:0
    v_mfma_f32_32x32x16_bf16 v[40:55], v[156:159], v[164:167], v[40:55]
    s_add_u32 s41, s52, 6144
    buffer_load_dwordx4 v[144:147], v5, s[8:11], s41 offen offset:1024
    v_mfma_f32_32x32x16_bf16 v[56:71], v[156:159], v[168:171], v[56:71]
    s_add_u32 s41, s52, 6144
    buffer_load_dwordx4 v[148:151], v5, s[8:11], s41 offen offset:2048
    v_mfma_f32_32x32x16_bf16 v[72:87], v[160:163], v[164:167], v[72:87]
    v_mfma_f32_32x32x16_bf16 v[88:103], v[160:163], v[168:171], v[88:103]
    s_waitcnt vmcnt(17)
    s_waitcnt lgkmcnt(0)
    v_mfma_f32_32x32x16_bf16 v[8:23], v[104:107], v[172:175], v[8:23]
    s_waitcnt vmcnt(3)
    ds_read_b128 v[164:167], v180 offset:0
    ds_read_b128 v[168:171], v180 offset:4096
    v_mfma_f32_32x32x16_bf16 v[24:39], v[104:107], v[176:179], v[24:39]
    s_add_u32 s41, s52, 9216
    buffer_load_dwordx4 v[152:155], v5, s[8:11], s41 offen offset:0
    v_mfma_f32_32x32x16_bf16 v[40:55], v[108:111], v[172:175], v[40:55]
    s_add_u32 s41, s52, 9216
    buffer_load_dwordx4 v[156:159], v5, s[8:11], s41 offen offset:1024
    v_mfma_f32_32x32x16_bf16 v[56:71], v[108:111], v[176:179], v[56:71]
    s_add_u32 s41, s52, 9216
    buffer_load_dwordx4 v[160:163], v5, s[8:11], s41 offen offset:2048
    v_mfma_f32_32x32x16_bf16 v[72:87], v[112:115], v[172:175], v[72:87]
    s_add_u32 s55, s50, 5
    s_and_b32 s55, s55, 7
    s_lshl_b32 s55, s55, 7
    s_add_u32 s55, s55, s45
    s_add_u32 s42, s55, 0
    s_add_u32 m0, s46, 8192
    s_nop 0
    buffer_load_dwordx4 v6, s[4:7], s42 offen lds
    v_mfma_f32_32x32x16_bf16 v[88:103], v[112:115], v[176:179], v[88:103]
    s_add_u32 s42, s55, 32768
    s_add_u32 m0, s46, 9216
    s_nop 0
    buffer_load_dwordx4 v7, s[4:7], s42 offen lds
    s_waitcnt vmcnt(17)
    s_waitcnt lgkmcnt(0)
    v_mfma_f32_32x32x16_bf16 v[8:23], v[116:119], v[164:167], v[8:23]
    ds_read_b128 v[172:175], v181 offset:0
    ds_read_b128 v[176:179], v181 offset:4096
    v_mfma_f32_32x32x16_bf16 v[24:39], v[116:119], v[168:171], v[24:39]
    s_add_u32 s53, s50, 5
    s_and_b32 s53, s53, 7
    s_mul_i32 s53, s53, 12288
    s_add_u32 s53, s53, s44
    buffer_load_dwordx4 v[104:107], v5, s[8:11], s53 offen offset:0
    v_mfma_f32_32x32x16_bf16 v[40:55], v[120:123], v[164:167], v[40:55]
    buffer_load_dwordx4 v[108:111], v5, s[8:11], s53 offen offset:1024
    v_mfma_f32_32x32x16_bf16 v[56:71], v[120:123], v[168:171], v[56:71]
    buffer_load_dwordx4 v[112:115], v5, s[8:11], s53 offen offset:2048
    v_mfma_f32_32x32x16_bf16 v[72:87], v[124:127], v[164:167], v[72:87]
    s_add_u32 s42, s55, 65536
    s_add_u32 m0, s46, 10240
    s_nop 0
    buffer_load_dwordx4 v6, s[4:7], s42 offen lds
    v_mfma_f32_32x32x16_bf16 v[88:103], v[124:127], v[168:171], v[88:103]
    s_add_u32 s42, s55, 98304
    s_add_u32 m0, s46, 11264
    s_nop 0
    buffer_load_dwordx4 v7, s[4:7], s42 offen lds
    s_add_u32 s42, s55, 131072
    s_add_u32 m0, s46, 12288
    s_nop 0
    buffer_load_dwordx4 v6, s[4:7], s42 offen lds
    s_waitcnt vmcnt(17)
    s_waitcnt lgkmcnt(0)
    v_mfma_f32_32x32x16_bf16 v[8:23], v[128:131], v[172:175], v[8:23]
    ds_read_b128 v[164:167], v182 offset:0
    ds_read_b128 v[168:171], v182 offset:4096
    v_mfma_f32_32x32x16_bf16 v[24:39], v[128:131], v[176:179], v[24:39]
    s_add_u32 s41, s53, 3072
    buffer_load_dwordx4 v[116:119], v5, s[8:11], s41 offen offset:0
    v_mfma_f32_32x32x16_bf16 v[40:55], v[132:135], v[172:175], v[40:55]
    s_add_u32 s41, s53, 3072
    buffer_load_dwordx4 v[120:123], v5, s[8:11], s41 offen offset:1024
    v_mfma_f32_32x32x16_bf16 v[56:71], v[132:135], v[176:179], v[56:71]
    s_add_u32 s41, s53, 3072
    buffer_load_dwordx4 v[124:127], v5, s[8:11], s41 offen offset:2048
    v_mfma_f32_32x32x16_bf16 v[72:87], v[136:139], v[172:175], v[72:87]
    s_add_u32 s42, s55, 163840
    s_add_u32 m0, s46, 13312
    s_nop 0
    buffer_load_dwordx4 v7, s[4:7], s42 offen lds
    v_mfma_f32_32x32x16_bf16 v[88:103], v[136:139], v[176:179], v[88:103]
    s_add_u32 s42, s55, 196608
    s_add_u32 m0, s46, 14336
    s_nop 0
    buffer_load_dwordx4 v6, s[4:7], s42 offen lds
    s_add_u32 s42, s55, 229376
    s_add_u32 m0, s46, 15360
    s_nop 0
    buffer_load_dwordx4 v7, s[4:7], s42 offen lds
    s_waitcnt vmcnt(17)
    s_waitcnt lgkmcnt(0)
    v_mfma_f32_32x32x16_bf16 v[8:23], v[140:143], v[164:167], v[8:23]
    ds_read_b128 v[172:175], v183 offset:0
    ds_read_b128 v[176:179], v183 offset:4096
    v_mfma_f32_32x32x16_bf16 v[24:39], v[140:143], v[168:171], v[24:39]
    s_add_u32 s41, s53, 6144
    buffer_load_dwordx4 v[128:131], v5, s[8:11], s41 offen offset:0
    v_mfma_f32_32x32x16_bf16 v[40:55], v[144:147], v[164:167], v[40:55]
    s_add_u32 s41, s53, 6144
    buffer_load_dwordx4 v[132:135], v5, s[8:11], s41 offen offset:1024
    v_mfma_f32_32x32x16_bf16 v[56:71], v[144:147], v[168:171], v[56:71]
    s_add_u32 s41, s53, 6144
    buffer_load_dwordx4 v[136:139], v5, s[8:11], s41 offen offset:2048
    v_mfma_f32_32x32x16_bf16 v[72:87], v[148:151], v[164:167], v[72:87]
    v_mfma_f32_32x32x16_bf16 v[88:103], v[148:151], v[168:171], v[88:103]
    s_waitcnt vmcnt(17)
    s_waitcnt lgkmcnt(0)
    v_mfma_f32_32x32x16_bf16 v[8:23], v[152:155], v[172:175], v[8:23]
    s_waitcnt vmcnt(3)
    ds_read_b128 v[164:167], v180 offset:8192
    ds_read_b128 v[168:171], v180 offset:12288
    v_mfma_f32_32x32x16_bf16 v[24:39], v[152:155], v[176:179], v[24:39]
    s_add_u32 s41, s53, 9216
    buffer_load_dwordx4 v[140:143], v5, s[8:11], s41 offen offset:0
    v_mfma_f32_32x32x16_bf16 v[40:55], v[156:159], v[172:175], v[40:55]
    s_add_u32 s41, s53, 9216
    buffer_load_dwordx4 v[144:147], v5, s[8:11], s41 offen offset:1024
    v_mfma_f32_32x32x16_bf16 v[56:71], v[156:159], v[176:179], v[56:71]
    s_add_u32 s41, s53, 9216
    buffer_load_dwordx4 v[148:151], v5, s[8:11], s41 offen offset:2048
    v_mfma_f32_32x32x16_bf16 v[72:87], v[160:163], v[172:175], v[72:87]
    s_add_u32 s54, s50, 6
    s_and_b32 s54, s54, 7
    s_lshl_b32 s54, s54, 7
    s_add_u32 s54, s54, s45
    s_add_u32 s42, s54, 0
    s_add_u32 m0, s46, 0
    s_nop 0
    buffer_load_dwordx4 v6, s[4:7], s42 offen lds
    v_mfma_f32_32x32x16_bf16 v[88:103], v[160:163], v[176:179], v[88:103]
    s_add_u32 s42, s54, 32768
    s_add_u32 m0, s46, 1024
    s_nop 0
    buffer_load_dwordx4 v7, s[4:7], s42 offen lds
    s_waitcnt vmcnt(17)
    s_waitcnt lgkmcnt(0)
    v_mfma_f32_32x32x16_bf16 v[8:23], v[104:107], v[164:167], v[8:23]
    ds_read_b128 v[172:175], v181 offset:8192
    ds_read_b128 v[176:179], v181 offset:12288
    v_mfma_f32_32x32x16_bf16 v[24:39], v[104:107], v[168:171], v[24:39]
    s_add_u32 s52, s50, 6
    s_and_b32 s52, s52, 7
    s_mul_i32 s52, s52, 12288
    s_add_u32 s52, s52, s44
    buffer_load_dwordx4 v[152:155], v5, s[8:11], s52 offen offset:0
    v_mfma_f32_32x32x16_bf16 v[40:55], v[108:111], v[164:167], v[40:55]
    buffer_load_dwordx4 v[156:159], v5, s[8:11], s52 offen offset:1024
    v_mfma_f32_32x32x16_bf16 v[56:71], v[108:111], v[168:171], v[56:71]
    buffer_load_dwordx4 v[160:163], v5, s[8:11], s52 offen offset:2048
    v_mfma_f32_32x32x16_bf16 v[72:87], v[112:115], v[164:167], v[72:87]
    s_add_u32 s42, s54, 65536
    s_add_u32 m0, s46, 2048
    s_nop 0
    buffer_load_dwordx4 v6, s[4:7], s42 offen lds
    v_mfma_f32_32x32x16_bf16 v[88:103], v[112:115], v[168:171], v[88:103]
    s_add_u32 s42, s54, 98304
    s_add_u32 m0, s46, 3072
    s_nop 0
    buffer_load_dwordx4 v7, s[4:7], s42 offen lds
    s_add_u32 s42, s54, 131072
    s_add_u32 m0, s46, 4096
    s_nop 0
    buffer_load_dwordx4 v6, s[4:7], s42 offen lds
    s_waitcnt vmcnt(17)
    s_waitcnt lgkmcnt(0)
    v_mfma_f32_32x32x16_bf16 v[8:23], v[116:119], v[172:175], v[8:23]
    ds_read_b128 v[164:167], v182 offset:8192
    ds_read_b128 v[168:171], v182 offset:12288
    v_mfma_f32_32x32x16_bf16 v[24:39], v[116:119], v[176:179], v[24:39]
    s_add_u32 s41, s52, 3072
    buffer_load_dwordx4 v[104:107], v5, s[8:11], s41 offen offset:0
    v_mfma_f32_32x32x16_bf16 v[40:55], v[120:123], v[172:175], v[40:55]
    s_add_u32 s41, s52, 3072
    buffer_load_dwordx4 v[108:111], v5, s[8:11], s41 offen offset:1024
    v_mfma_f32_32x32x16_bf16 v[56:71], v[120:123], v[176:179], v[56:71]
    s_add_u32 s41, s52, 3072
    buffer_load_dwordx4 v[112:115], v5, s[8:11], s41 offen offset:2048
    v_mfma_f32_32x32x16_bf16 v[72:87], v[124:127], v[172:175], v[72:87]
    s_add_u32 s42, s54, 163840
    s_add_u32 m0, s46, 5120
    s_nop 0
    buffer_load_dwordx4 v7, s[4:7], s42 offen lds
    v_mfma_f32_32x32x16_bf16 v[88:103], v[124:127], v[176:179], v[88:103]
    s_add_u32 s42, s54, 196608
    s_add_u32 m0, s46, 6144
    s_nop 0
    buffer_load_dwordx4 v6, s[4:7], s42 offen lds
    s_add_u32 s42, s54, 229376
    s_add_u32 m0, s46, 7168
    s_nop 0
    buffer_load_dwordx4 v7, s[4:7], s42 offen lds
    s_waitcnt vmcnt(17)
    s_waitcnt lgkmcnt(0)
    v_mfma_f32_32x32x16_bf16 v[8:23], v[128:131], v[164:167], v[8:23]
    ds_read_b128 v[172:175], v183 offset:8192
    ds_read_b128 v[176:179], v183 offset:12288
    v_mfma_f32_32x32x16_bf16 v[24:39], v[128:131], v[168:171], v[24:39]
    s_add_u32 s41, s52, 6144
    buffer_load_dwordx4 v[116:119], v5, s[8:11], s41 offen offset:0
    v_mfma_f32_32x32x16_bf16 v[40:55], v[132:135], v[164:167], v[40:55]
    s_add_u32 s41, s52, 6144
    buffer_load_dwordx4 v[120:123], v5, s[8:11], s41 offen offset:1024
    v_mfma_f32_32x32x16_bf16 v[56:71], v[132:135], v[168:171], v[56:71]
    s_add_u32 s41, s52, 6144
    buffer_load_dwordx4 v[124:127], v5, s[8:11], s41 offen offset:2048
    v_mfma_f32_32x32x16_bf16 v[72:87], v[136:139], v[164:167], v[72:87]
    v_mfma_f32_32x32x16_bf16 v[88:103], v[136:139], v[168:171], v[88:103]
    s_waitcnt vmcnt(17)
    s_waitcnt lgkmcnt(0)
    v_mfma_f32_32x32x16_bf16 v[8:23], v[140:143], v[172:175], v[8:23]
    s_waitcnt vmcnt(3)
    ds_read_b128 v[164:167], v180 offset:0
    ds_read_b128 v[168:171], v180 offset:4096
    v_mfma_f32_32x32x16_bf16 v[24:39], v[140:143], v[176:179], v[24:39]
    s_add_u32 s41, s52, 9216
    buffer_load_dwordx4 v[128:131], v5, s[8:11], s41 offen offset:0
    v_mfma_f32_32x32x16_bf16 v[40:55], v[144:147], v[172:175], v[40:55]
    s_add_u32 s41, s52, 9216
    buffer_load_dwordx4 v[132:135], v5, s[8:11], s41 offen offset:1024
    v_mfma_f32_32x32x16_bf16 v[56:71], v[144:147], v[176:179], v[56:71]
    s_add_u32 s41, s52, 9216
    buffer_load_dwordx4 v[136:139], v5, s[8:11], s41 offen offset:2048
    v_mfma_f32_32x32x16_bf16 v[72:87], v[148:151], v[172:175], v[72:87]
    s_add_u32 s55, s50, 7
    s_and_b32 s55, s55, 7
    s_lshl_b32 s55, s55, 7
    s_add_u32 s55, s55, s45
    s_add_u32 s42, s55, 0
    s_add_u32 m0, s46, 8192
    s_nop 0
    buffer_load_dwordx4 v6, s[4:7], s42 offen lds
    v_mfma_f32_32x32x16_bf16 v[88:103], v[148:151], v[176:179], v[88:103]
    s_add_u32 s42, s55, 32768
    s_add_u32 m0, s46, 9216
    s_nop 0
    buffer_load_dwordx4 v7, s[4:7], s42 offen lds
    s_waitcnt vmcnt(17)
    s_waitcnt lgkmcnt(0)
    v_mfma_f32_32x32x16_bf16 v[8:23], v[152:155], v[164:167], v[8:23]
    ds_read_b128 v[172:175], v181 offset:0
    ds_read_b128 v[176:179], v181 offset:4096
    v_mfma_f32_32x32x16_bf16 v[24:39], v[152:155], v[168:171], v[24:39]
    s_add_u32 s53, s50, 7
    s_and_b32 s53, s53, 7
    s_mul_i32 s53, s53, 12288
    s_add_u32 s53, s53, s44
    buffer_load_dwordx4 v[140:143], v5, s[8:11], s53 offen offset:0
    v_mfma_f32_32x32x16_bf16 v[40:55], v[156:159], v[164:167], v[40:55]
    buffer_load_dwordx4 v[144:147], v5, s[8:11], s53 offen offset:1024
    v_mfma_f32_32x32x16_bf16 v[56:71], v[156:159], v[168:171], v[56:71]
    buffer_load_dwordx4 v[148:151], v5, s[8:11], s53 offen offset:2048
    v_mfma_f32_32x32x16_bf16 v[72:87], v[160:163], v[164:167], v[72:87]
    s_add_u32 s42, s55, 65536
    s_add_u32 m0, s46, 10240
    s_nop 0
    buffer_load_dwordx4 v6, s[4:7], s42 offen lds
    v_mfma_f32_32x32x16_bf16 v[88:103], v[160:163], v[168:171], v[88:103]
    s_add_u32 s42, s55, 98304
    s_add_u32 m0, s46, 11264
    s_nop 0
    buffer_load_dwordx4 v7, s[4:7], s42 offen lds
    s_add_u32 s42, s55, 131072
    s_add_u32 m0, s46, 12288
    s_nop 0
    buffer_load_dwordx4 v6, s[4:7], s42 offen lds
    s_waitcnt vmcnt(17)
    s_waitcnt lgkmcnt(0)
    v_mfma_f32_32x32x16_bf16 v[8:23], v[104:107], v[172:175], v[8:23]
    ds_read_b128 v[164:167], v182 offset:0
    ds_read_b128 v[168:171], v182 offset:4096
    v_mfma_f32_32x32x16_bf16 v[24:39], v[104:107], v[176:179], v[24:39]
    s_add_u32 s41, s53, 3072
    buffer_load_dwordx4 v[152:155], v5, s[8:11], s41 offen offset:0
    v_mfma_f32_32x32x16_bf16 v[40:55], v[108:111], v[172:175], v[40:55]
    s_add_u32 s41, s53, 3072
    buffer_load_dwordx4 v[156:159], v5, s[8:11], s41 offen offset:1024
    v_mfma_f32_32x32x16_bf16 v[56:71], v[108:111], v[176:179], v[56:71]
    s_add_u32 s41, s53, 3072
    buffer_load_dwordx4 v[160:163], v5, s[8:11], s41 offen offset:2048
    v_mfma_f32_32x32x16_bf16 v[72:87], v[112:115], v[172:175], v[72:87]
    s_add_u32 s42, s55, 163840
    s_add_u32 m0, s46, 13312
    s_nop 0
    buffer_load_dwordx4 v7, s[4:7], s42 offen lds
    v_mfma_f32_32x32x16_bf16 v[88:103], v[112:115], v[176:179], v[88:103]
    s_add_u32 s42, s55, 196608
    s_add_u32 m0, s46, 14336
    s_nop 0
    buffer_load_dwordx4 v6, s[4:7], s42 offen lds
    s_add_u32 s42, s55, 229376
    s_add_u32 m0, s46, 15360
    s_nop 0
    buffer_load_dwordx4 v7, s[4:7], s42 offen lds
    s_waitcnt vmcnt(17)
    s_waitcnt lgkmcnt(0)
    v_mfma_f32_32x32x16_bf16 v[8:23], v[116:119], v[164:167], v[8:23]
    ds_read_b128 v[172:175], v183 offset:0
    ds_read_b128 v[176:179], v183 offset:4096
    v_mfma_f32_32x32x16_bf16 v[24:39], v[116:119], v[168:171], v[24:39]
    s_add_u32 s41, s53, 6144
    buffer_load_dwordx4 v[104:107], v5, s[8:11], s41 offen offset:0
    v_mfma_f32_32x32x16_bf16 v[40:55], v[120:123], v[164:167], v[40:55]
    s_add_u32 s41, s53, 6144
    buffer_load_dwordx4 v[108:111], v5, s[8:11], s41 offen offset:1024
    v_mfma_f32_32x32x16_bf16 v[56:71], v[120:123], v[168:171], v[56:71]
    s_add_u32 s41, s53, 6144
    buffer_load_dwordx4 v[112:115], v5, s[8:11], s41 offen offset:2048
    v_mfma_f32_32x32x16_bf16 v[72:87], v[124:127], v[164:167], v[72:87]
    v_mfma_f32_32x32x16_bf16 v[88:103], v[124:127], v[168:171], v[88:103]
    s_waitcnt vmcnt(17)
    s_waitcnt lgkmcnt(0)
    v_mfma_f32_32x32x16_bf16 v[8:23], v[128:131], v[172:175], v[8:23]
    s_waitcnt vmcnt(3)
    ds_read_b128 v[164:167], v180 offset:8192
    ds_read_b128 v[168:171], v180 offset:12288
    v_mfma_f32_32x32x16_bf16 v[24:39], v[128:131], v[176:179], v[24:39]
    s_add_u32 s41, s53, 9216
    buffer_load_dwordx4 v[116:119], v5, s[8:11], s41 offen offset:0
    v_mfma_f32_32x32x16_bf16 v[40:55], v[132:135], v[172:175], v[40:55]
    s_add_u32 s41, s53, 9216
    buffer_load_dwordx4 v[120:123], v5, s[8:11], s41 offen offset:1024
    v_mfma_f32_32x32x16_bf16 v[56:71], v[132:135], v[176:179], v[56:71]
    s_add_u32 s41, s53, 9216
    buffer_load_dwordx4 v[124:127], v5, s[8:11], s41 offen offset:2048
    v_mfma_f32_32x32x16_bf16 v[72:87], v[136:139], v[172:175], v[72:87]
    v_mfma_f32_32x32x16_bf16 v[88:103], v[136:139], v[176:179], v[88:103]
    s_waitcnt vmcnt(15)
    s_waitcnt lgkmcnt(0)
    v_mfma_f32_32x32x16_bf16 v[8:23], v[140:143], v[164:167], v[8:23]
    ds_read_b128 v[172:175], v181 offset:8192
    ds_read_b128 v[176:179], v181 offset:12288
    v_mfma_f32_32x32x16_bf16 v[24:39], v[140:143], v[168:171], v[24:39]
    v_mfma_f32_32x32x16_bf16 v[40:55], v[144:147], v[164:167], v[40:55]
    v_mfma_f32_32x32x16_bf16 v[56:71], v[144:147], v[168:171], v[56:71]
    v_mfma_f32_32x32x16_bf16 v[72:87], v[148:151], v[164:167], v[72:87]
    v_mfma_f32_32x32x16_bf16 v[88:103], v[148:151], v[168:171], v[88:103]
    s_waitcnt vmcnt(9)
    s_waitcnt lgkmcnt(0)
    v_mfma_f32_32x32x16_bf16 v[8:23], v[152:155], v[172:175], v[8:23]
    ds_read_b128 v[164:167], v182 offset:8192
    ds_read_b128 v[168:171], v182 offset:12288
    v_mfma_f32_32x32x16_bf16 v[24:39], v[152:155], v[176:179], v[24:39]
    v_mfma_f32_32x32x16_bf16 v[40:55], v[156:159], v[172:175], v[40:55]
    v_mfma_f32_32x32x16_bf16 v[56:71], v[156:159], v[176:179], v[56:71]
    v_mfma_f32_32x32x16_bf16 v[72:87], v[160:163], v[172:175], v[72:87]
    v_mfma_f32_32x32x16_bf16 v[88:103], v[160:163], v[176:179], v[88:103]
    s_waitcnt vmcnt(3)
    s_waitcnt lgkmcnt(0)
    v_mfma_f32_32x32x16_bf16 v[8:23], v[104:107], v[164:167], v[8:23]
    ds_read_b128 v[172:175], v183 offset:8192
    ds_read_b128 v[176:179], v183 offset:12288
    v_mfma_f32_32x32x16_bf16 v[24:39], v[104:107], v[168:171], v[24:39]
    s_lshl_b32 s40, s32, 3
    s_add_u32 s40, s40, s33
    s_lshl_b32 s40, s40, 2
    s_add_u32 s40, s40, s34
    s_mul_i32 s40, s40, 3072
    s_add_u32 s40, s40, 3145728
    buffer_load_dwordx4 v[184:187], v5, s[8:11], s40 offen offset:0
    v_mfma_f32_32x32x16_bf16 v[40:55], v[108:111], v[164:167], v[40:55]
    buffer_load_dwordx4 v[188:191], v5, s[8:11], s40 offen offset:1024
    v_mfma_f32_32x32x16_bf16 v[56:71], v[108:111], v[168:171], v[56:71]
    buffer_load_dwordx4 v[192:195], v5, s[8:11], s40 offen offset:2048
    v_mfma_f32_32x32x16_bf16 v[72:87], v[112:115], v[164:167], v[72:87]
    v_and_b32 v2, 31, v1
    v_lshlrev_b32 v2, 1, v2
    s_lshr_b32 s40, s34, 1
    s_lshl_b32 s40, s40, 6
    s_lshl_b32 s43, s32, 7
    s_add_u32 s40, s40, s43
    buffer_load_ushort v196, v2, s[12:15], s40 offen
    v_mfma_f32_32x32x16_bf16 v[88:103], v[112:115], v[168:171], v[88:103]
    s_waitcnt vmcnt(4)
    s_waitcnt lgkmcnt(0)
    v_mfma_f32_32x32x16_bf16 v[8:23], v[116:119], v[172:175], v[8:23]
    v_mfma_f32_32x32x16_bf16 v[24:39], v[116:119], v[176:179], v[24:39]
    v_mfma_f32_32x32x16_bf16 v[40:55], v[120:123], v[172:175], v[40:55]
    v_mfma_f32_32x32x16_bf16 v[56:71], v[120:123], v[176:179], v[56:71]
    v_mfma_f32_32x32x16_bf16 v[72:87], v[124:127], v[172:175], v[72:87]
    v_mfma_f32_32x32x16_bf16 v[88:103], v[124:127], v[176:179], v[88:103]
    s_setprio 0
    v_add_u32 v4, 0x10000, v5
    s_nop 15
    s_barrier
    s_cmp_lg_u32 s34, 0
    s_cbranch_scc1 g_epi_2
    ds_write_b128 v5, v[12:15] offset:30720
    ds_write_b128 v5, v[20:23] offset:31744
    ds_write_b128 v5, v[44:47] offset:32768
    ds_write_b128 v5, v[52:55] offset:33792
    ds_write_b128 v5, v[76:79] offset:34816
    ds_write_b128 v5, v[84:87] offset:35840
    ds_write_b128 v5, v[24:27] offset:43008
    ds_write_b128 v5, v[32:35] offset:44032
    ds_write_b128 v5, v[56:59] offset:45056
    ds_write_b128 v5, v[64:67] offset:46080
    ds_write_b128 v5, v[88:91] offset:47104
    ds_write_b128 v5, v[96:99] offset:48128
    ds_write_b128 v5, v[28:31] offset:55296
    ds_write_b128 v5, v[36:39] offset:56320
    ds_write_b128 v5, v[60:63] offset:57344
    ds_write_b128 v5, v[68:71] offset:58368
    ds_write_b128 v5, v[92:95] offset:59392
    ds_write_b128 v5, v[100:103] offset:60416
    v_pk_add_f32 v[104:105], v[8:9], 0
    v_pk_add_f32 v[106:107], v[10:11], 0
    v_pk_add_f32 v[108:109], v[16:17], 0
    v_pk_add_f32 v[110:111], v[18:19], 0
    v_pk_add_f32 v[112:113], v[40:41], 0
    v_pk_add_f32 v[114:115], v[42:43], 0
    v_pk_add_f32 v[116:117], v[48:49], 0
    v_pk_add_f32 v[118:119], v[50:51], 0
    v_pk_add_f32 v[120:121], v[72:73], 0
    v_pk_add_f32 v[122:123], v[74:75], 0
    v_pk_add_f32 v[124:125], v[80:81], 0
    v_pk_add_f32 v[126:127], v[82:83], 0
    s_branch g_epi_end_1
g_epi_2:
    s_cmp_lg_u32 s34, 1
    s_cbranch_scc1 g_epi_3
    ds_write_b128 v5, v[8:11] offset:0
    ds_write_b128 v5, v[16:19] offset:1024
    ds_write_b128 v5, v[40:43] offset:2048
    ds_write_b128 v5, v[48:51] offset:3072
    ds_write_b128 v5, v[72:75] offset:4096
    ds_write_b128 v5, v[80:83] offset:5120
    ds_write_b128 v5, v[24:27] offset:49152
    ds_write_b128 v5, v[32:35] offset:50176
    ds_write_b128 v5, v[56:59] offset:51200
    ds_write_b128 v5, v[64:67] offset:52224
    ds_write_b128 v5, v[88:91] offset:53248
    ds_write_b128 v5, v[96:99] offset:54272
    ds_write_b128 v5, v[28:31] offset:61440
    ds_write_b128 v5, v[36:39] offset:62464
    ds_write_b128 v5, v[60:63] offset:63488
    ds_write_b128 v5, v[68:71] offset:64512
    ds_write_b128 v4, v[92:95] offset:0
    ds_write_b128 v4, v[100:103] offset:1024
    v_pk_add_f32 v[104:105], v[12:13], 0
    v_pk_add_f32 v[106:107], v[14:15], 0
    v_pk_add_f32 v[108:109], v[20:21], 0
    v_pk_add_f32 v[110:111], v[22:23], 0
    v_pk_add_f32 v[112:113], v[44:45], 0
    v_pk_add_f32 v[114:115], v[46:47], 0
    v_pk_add_f32 v[116:117], v[52:53], 0
    v_pk_add_f32 v[118:119], v[54:55], 0
    v_pk_add_f32 v[120:121], v[76:77], 0
    v_pk_add_f32 v[122:123], v[78:79], 0
    v_pk_add_f32 v[124:125], v[84:85], 0
    v_pk_add_f32 v[126:127], v[86:87], 0
    s_branch g_epi_end_1
g_epi_3:
    s_cmp_lg_u32 s34, 2
    s_cbranch_scc1 g_epi_4
    ds_write_b128 v5, v[8:11] offset:6144
    ds_write_b128 v5, v[16:19] offset:7168
    ds_write_b128 v5, v[40:43] offset:8192
    ds_write_b128 v5, v[48:51] offset:9216
    ds_write_b128 v5, v[72:75] offset:10240
    ds_write_b128 v5, v[80:83] offset:11264
    ds_write_b128 v5, v[12:15] offset:18432
    ds_write_b128 v5, v[20:23] offset:19456
    ds_write_b128 v5, v[44:47] offset:20480
    ds_write_b128 v5, v[52:55] offset:21504
    ds_write_b128 v5, v[76:79] offset:22528
    ds_write_b128 v5, v[84:87] offset:23552
    ds_write_b128 v4, v[28:31] offset:2048
    ds_write_b128 v4, v[36:39] offset:3072
    ds_write_b128 v4, v[60:63] offset:4096
    ds_write_b128 v4, v[68:71] offset:5120
    ds_write_b128 v4, v[92:95] offset:6144
    ds_write_b128 v4, v[100:103] offset:7168
    v_pk_add_f32 v[104:105], v[24:25], 0
    v_pk_add_f32 v[106:107], v[26:27], 0
    v_pk_add_f32 v[108:109], v[32:33], 0
    v_pk_add_f32 v[110:111], v[34:35], 0
    v_pk_add_f32 v[112:113], v[56:57], 0
    v_pk_add_f32 v[114:115], v[58:59], 0
    v_pk_add_f32 v[116:117], v[64:65], 0
    v_pk_add_f32 v[118:119], v[66:67], 0
    v_pk_add_f32 v[120:121], v[88:89], 0
    v_pk_add_f32 v[122:123], v[90:91], 0
    v_pk_add_f32 v[124:125], v[96:97], 0
    v_pk_add_f32 v[126:127], v[98:99], 0
    s_branch g_epi_end_1
g_epi_4:
    ds_write_b128 v5, v[8:11] offset:12288
    ds_write_b128 v5, v[16:19] offset:13312
    ds_write_b128 v5, v[40:43] offset:14336
    ds_write_b128 v5, v[48:51] offset:15360
    ds_write_b128 v5, v[72:75] offset:16384
    ds_write_b128 v5, v[80:83] offset:17408
    ds_write_b128 v5, v[12:15] offset:24576
    ds_write_b128 v5, v[20:23] offset:25600
    ds_write_b128 v5, v[44:47] offset:26624
    ds_write_b128 v5, v[52:55] offset:27648
    ds_write_b128 v5, v[76:79] offset:28672
    ds_write_b128 v5, v[84:87] offset:29696
    ds_write_b128 v5, v[24:27] offset:36864
    ds_write_b128 v5, v[32:35] offset:37888
    ds_write_b128 v5, v[56:59] offset:38912
    ds_write_b128 v5, v[64:67] offset:39936
    ds_write_b128 v5, v[88:91] offset:40960
    ds_write_b128 v5, v[96:99] offset:41984
    v_pk_add_f32 v[104:105], v[28:29], 0
    v_pk_add_f32 v[106:107], v[30:31], 0
    v_pk_add_f32 v[108:109], v[36:37], 0
    v_pk_add_f32 v[110:111], v[38:39], 0
    v_pk_add_f32 v[112:113], v[60:61], 0
    v_pk_add_f32 v[114:115], v[62:63], 0
    v_pk_add_f32 v[116:117], v[68:69], 0
    v_pk_add_f32 v[118:119], v[70:71], 0
    v_pk_add_f32 v[120:121], v[92:93], 0
    v_pk_add_f32 v[122:123], v[94:95], 0
    v_pk_add_f32 v[124:125], v[100:101], 0
    v_pk_add_f32 v[126:127], v[102:103], 0
g_epi_end_1:
    s_waitcnt lgkmcnt(0)
    s_barrier
    s_mul_i32 s40, s34, 18432
    v_add_u32 v2, s40, v5
    ds_read_b128 v[8:11], v2 offset:0
    ds_read_b128 v[12:15], v2 offset:1024
    ds_read_b128 v[16:19], v2 offset:2048
    ds_read_b128 v[20:23], v2 offset:3072
    ds_read_b128 v[24:27], v2 offset:4096
    ds_read_b128 v[28:31], v2 offset:5120
    ds_read_b128 v[32:35], v2 offset:6144
    ds_read_b128 v[36:39], v2 offset:7168
    ds_read_b128 v[40:43], v2 offset:8192
    ds_read_b128 v[44:47], v2 offset:9216
    ds_read_b128 v[48:51], v2 offset:10240
    ds_read_b128 v[52:55], v2 offset:11264
    ds_read_b128 v[56:59], v2 offset:12288
    ds_read_b128 v[60:63], v2 offset:13312
    ds_read_b128 v[64:67], v2 offset:14336
    ds_read_b128 v[68:71], v2 offset:15360
    ds_read_b128 v[72:75], v2 offset:16384
    ds_read_b128 v[76:79], v2 offset:17408
    v_lshrrev_b32 v6, 4, v1
    v_and_b32 v6, 1, v6
    v_mul_u32_u24 v6, 24576, v6
    v_and_b32 v3, 15, v1
    v_lshrrev_b32 v4, 5, v1
    v_lshl_add_u32 v3, v4, 4, v3
    v_lshl_add_u32 v6, v3, 4, v6
    s_mul_i32 s40, s32, 98304
    s_lshr_b32 s41, s34, 1
    s_mul_i32 s41, s41, 49152
    s_add_u32 s40, s40, s41
    s_mul_i32 s41, s33, 3072
    s_add_u32 s40, s40, s41
    s_and_b32 s41, s34, 1
    s_lshl_b32 s41, s41, 9
    s_add_u32 s40, s40, s41
    s_add_u32 s40, s40, 11534336
    s_waitcnt vmcnt(0)
    v_lshlrev_b32 v180, 16, v196
    v_lshlrev_b32 v80, 16, v184
    v_and_b32 v81, 0xffff0000, v184
    v_lshlrev_b32 v82, 16, v185
    v_and_b32 v83, 0xffff0000, v185
    v_lshlrev_b32 v84, 16, v186
    v_and_b32 v85, 0xffff0000, v186
    v_lshlrev_b32 v86, 16, v187
    v_and_b32 v87, 0xffff0000, v187
    v_lshlrev_b32 v88, 16, v188
    v_and_b32 v89, 0xffff0000, v188
    v_lshlrev_b32 v90, 16, v189
    v_and_b32 v91, 0xffff0000, v189
    v_lshlrev_b32 v92, 16, v190
    v_and_b32 v93, 0xffff0000, v190
    v_lshlrev_b32 v94, 16, v191
    v_and_b32 v95, 0xffff0000, v191
    v_lshlrev_b32 v96, 16, v192
    v_and_b32 v97, 0xffff0000, v192
    v_lshlrev_b32 v98, 16, v193
    v_and_b32 v99, 0xffff0000, v193
    v_lshlrev_b32 v100, 16, v194
    v_and_b32 v101, 0xffff0000, v194
    v_lshlrev_b32 v102, 16, v195
    v_and_b32 v103, 0xffff0000, v195
    s_waitcnt lgkmcnt(12)
    v_pk_add_f32 v[104:105], v[104:105], v[8:9]
    v_pk_add_f32 v[106:107], v[106:107], v[10:11]
    v_pk_add_f32 v[108:109], v[108:109], v[12:13]
    v_pk_add_f32 v[110:111], v[110:111], v[14:15]
    v_pk_add_f32 v[112:113], v[112:113], v[16:17]
    v_pk_add_f32 v[114:115], v[114:115], v[18:19]
    v_pk_add_f32 v[116:117], v[116:117], v[20:21]
    v_pk_add_f32 v[118:119], v[118:119], v[22:23]
    v_pk_add_f32 v[120:121], v[120:121], v[24:25]
    v_pk_add_f32 v[122:123], v[122:123], v[26:27]
    v_pk_add_f32 v[124:125], v[124:125], v[28:29]
    v_pk_add_f32 v[126:127], v[126:127], v[30:31]
    s_waitcnt lgkmcnt(6)
    v_pk_add_f32 v[104:105], v[104:105], v[32:33]
    v_pk_add_f32 v[106:107], v[106:107], v[34:35]
    v_pk_add_f32 v[108:109], v[108:109], v[36:37]
    v_pk_add_f32 v[110:111], v[110:111], v[38:39]
    v_pk_add_f32 v[112:113], v[112:113], v[40:41]
    v_pk_add_f32 v[114:115], v[114:115], v[42:43]
    v_pk_add_f32 v[116:117], v[116:117], v[44:45]
    v_pk_add_f32 v[118:119], v[118:119], v[46:47]
    v_pk_add_f32 v[120:121], v[120:121], v[48:49]
    v_pk_add_f32 v[122:123], v[122:123], v[50:51]
    v_pk_add_f32 v[124:125], v[124:125], v[52:53]
    v_pk_add_f32 v[126:127], v[126:127], v[54:55]
    s_waitcnt lgkmcnt(0)
    v_pk_add_f32 v[104:105], v[104:105], v[56:57]
    v_pk_add_f32 v[106:107], v[106:107], v[58:59]
    v_pk_add_f32 v[108:109], v[108:109], v[60:61]
    v_pk_add_f32 v[110:111], v[110:111], v[62:63]
    v_pk_add_f32 v[112:113], v[112:113], v[64:65]
    v_pk_add_f32 v[114:115], v[114:115], v[66:67]
    v_pk_add_f32 v[116:117], v[116:117], v[68:69]
    v_pk_add_f32 v[118:119], v[118:119], v[70:71]
    v_pk_add_f32 v[120:121], v[120:121], v[72:73]
    v_pk_add_f32 v[122:123], v[122:123], v[74:75]
    v_pk_add_f32 v[124:125], v[124:125], v[76:77]
    v_pk_add_f32 v[126:127], v[126:127], v[78:79]
    v_pk_add_f32 v[104:105], v[104:105], v[180:181] op_sel_hi:[1,0]
    v_pk_add_f32 v[106:107], v[106:107], v[180:181] op_sel_hi:[1,0]
    v_pk_add_f32 v[108:109], v[108:109], v[180:181] op_sel_hi:[1,0]
    v_pk_add_f32 v[110:111], v[110:111], v[180:181] op_sel_hi:[1,0]
    v_pk_add_f32 v[112:113], v[112:113], v[180:181] op_sel_hi:[1,0]
    v_pk_add_f32 v[114:115], v[114:115], v[180:181] op_sel_hi:[1,0]
    v_pk_add_f32 v[116:117], v[116:117], v[180:181] op_sel_hi:[1,0]
    v_pk_add_f32 v[118:119], v[118:119], v[180:181] op_sel_hi:[1,0]
    v_pk_add_f32 v[120:121], v[120:121], v[180:181] op_sel_hi:[1,0]
    v_pk_add_f32 v[122:123], v[122:123], v[180:181] op_sel_hi:[1,0]
    v_pk_add_f32 v[124:125], v[124:125], v[180:181] op_sel_hi:[1,0]
    v_pk_add_f32 v[126:127], v[126:127], v[180:181] op_sel_hi:[1,0]
    v_pk_mul_f32 v[104:105], v[104:105], v[80:81]
    v_pk_mul_f32 v[106:107], v[106:107], v[82:83]
    v_pk_mul_f32 v[108:109], v[108:109], v[84:85]
    v_pk_mul_f32 v[110:111], v[110:111], v[86:87]
    v_pk_mul_f32 v[112:113], v[112:113], v[88:89]
    v_pk_mul_f32 v[114:115], v[114:115], v[90:91]
    v_pk_mul_f32 v[116:117], v[116:117], v[92:93]
    v_pk_mul_f32 v[118:119], v[118:119], v[94:95]
    v_pk_mul_f32 v[120:121], v[120:121], v[96:97]
    v_pk_mul_f32 v[122:123], v[122:123], v[98:99]
    v_pk_mul_f32 v[124:125], v[124:125], v[100:101]
    v_pk_mul_f32 v[126:127], v[126:127], v[102:103]
    v_cvt_pk_bf16_f32 v8, v104, v105
    v_cvt_pk_bf16_f32 v9, v106, v107
    v_cvt_pk_bf16_f32 v10, v108, v109
    v_cvt_pk_bf16_f32 v11, v110, v111
    buffer_store_dwordx4 v[8:11], v6, s[8:11], s40 offen offset:0 sc1
    v_cvt_pk_bf16_f32 v12, v112, v113
    v_cvt_pk_bf16_f32 v13, v114, v115
    v_cvt_pk_bf16_f32 v14, v116, v117
    v_cvt_pk_bf16_f32 v15, v118, v119
    buffer_store_dwordx4 v[12:15], v6, s[8:11], s40 offen offset:1024 sc1
    v_cvt_pk_bf16_f32 v16, v120, v121
    v_cvt_pk_bf16_f32 v17, v122, v123
    v_cvt_pk_bf16_f32 v18, v124, v125
    v_cvt_pk_bf16_f32 v19, v126, v127
    buffer_store_dwordx4 v[16:19], v6, s[8:11], s40 offen offset:2048 sc1
    s_endpgm
k2_kernel_conv:
    s_load_dwordx2 s[4:5], s[0:1], 32
    s_load_dwordx2 s[8:9], s[0:1], 104
    s_load_dwordx2 s[12:13], s[0:1], 40
    s_load_dwordx2 s[16:17], s[0:1], 64
    s_load_dwordx2 s[20:21], s[0:1], 80
    v_lshrrev_b32 v3, 6, v0
    v_and_b32 v1, 63, v0
    v_readfirstlane_b32 s34, v3
    s_mov_b32 s6, 2621440
    s_mov_b32 s7, 0x20000
    s_mov_b32 s10, 15990784
    s_mov_b32 s11, 0x20000
    s_mov_b32 s14, 1280
    s_mov_b32 s15, 0x20000
    s_mov_b32 s18, 8388608
    s_mov_b32 s19, 0x20000
    s_mov_b32 s22, 983040
    s_mov_b32 s23, 0x20000
    s_mov_b32 s32, s2
    v_lshlrev_b32 v2, 4, v0
    v_subrev_u32 v47, 16, v2
    s_mov_b32 s56, s2
    s_add_u32 s57, s2, 256
    s_lshr_b32 s58, s2, 1
    s_add_u32 s58, s58, 512
    s_waitcnt lgkmcnt(0)
    s_lshl_b32 s40, s56, 12
    buffer_load_dwordx4 v[12:15], v2, s[4:7], s40 offen
    buffer_load_dwordx4 v[8:11], v47, s[4:7], s40 offen
    s_add_u32 s40, s40, 6291456
    buffer_load_dwordx4 v[32:35], v2, s[8:11], s40 offen
    s_lshl_b32 s40, s56, 1
    v_mov_b32 v3, 0
    buffer_load_ushort v44, v3, s[12:15], s40 offen
    s_lshr_b32 s47, s2, 3
    s_lshl_b32 s47, s47, 2
    s_add_u32 s47, s47, s34
    s_mul_i32 s40, s47, 12
    v_add_u32 v3, s40, v1
    v_mul_u32_u24 v4, 43691, v3
    v_lshrrev_b32 v4, 22, v4
    v_mul_u32_u24 v5, 96, v4
    v_sub_u32 v3, v3, v5
    v_mul_u32_u24 v4, 98304, v4
    v_lshl_add_u32 v49, v3, 7, v4
    s_and_b32 s40, s2, 7
    s_lshr_b32 s52, s40, 1
    s_lshl_b32 s52, s52, 21
    s_and_b32 s53, s40, 1
    s_mul_i32 s53, s53, 1572864
    s_add_u32 s53, s53, 0
    s_lshl_b32 s40, s47, 4
    v_add_u32 v3, s40, v1
    v_lshrrev_b32 v4, 2, v3
    v_lshlrev_b32 v4, 12, v4
    v_and_b32 v3, 3, v3
    v_lshl_add_u32 v48, v3, 10, v4
    s_cmp_ge_u32 s2, 192
    s_cbranch_scc1 c_wj_6
    s_mul_i32 s40, s2, 2731
    s_lshr_b32 s40, s40, 16
    s_mul_i32 s41, s40, 24
    s_sub_u32 s41, s2, s41
    s_mul_i32 s41, s41, 40960
    s_mul_i32 s40, s40, 160
    s_add_u32 s54, s40, s41
    v_mov_b32 v3, v0
    v_mul_u32_u24 v4, 6554, v3
    v_lshrrev_b32 v4, 16, v4
    v_mul_u32_u24 v5, 10, v4
    v_sub_u32 v3, v3, v5
    v_lshlrev_b32 v3, 4, v3
    v_mul_u32_u24 v4, 1280, v4
    v_add_u32 v3, v3, v4
    s_lshl_b32 s40, s34, 10
    s_add_u32 m0, s40, 73216
    s_nop 0
    buffer_load_dwordx4 v3, s[20:23], s54 offen lds
    s_cmp_lg_u32 s34, 0
    s_cbranch_scc1 c_wj2_7
    v_add_u32 v3, 256, v1
    v_mul_u32_u24 v4, 6554, v3
    v_lshrrev_b32 v4, 16, v4
    v_mul_u32_u24 v5, 10, v4
    v_sub_u32 v3, v3, v5
    v_lshlrev_b32 v3, 4, v3
    v_mul_u32_u24 v4, 1280, v4
    v_add_u32 v3, v3, v4
    s_mov_b32 m0, 77312
    s_nop 0
    buffer_load_dwordx4 v3, s[20:23], s54 offen lds
c_wj2_7:
c_wj_6:
    s_lshl_b32 s40, s57, 12
    buffer_load_dwordx4 v[20:23], v2, s[4:7], s40 offen
    buffer_load_dwordx4 v[16:19], v47, s[4:7], s40 offen
    s_add_u32 s40, s40, 6291456
    buffer_load_dwordx4 v[36:39], v2, s[8:11], s40 offen
    s_lshl_b32 s40, s57, 1
    v_mov_b32 v3, 0
    buffer_load_ushort v45, v3, s[12:15], s40 offen
    s_lshl_b32 s40, s58, 12
    buffer_load_dwordx4 v[28:31], v2, s[4:7], s40 offen
    buffer_load_dwordx4 v[24:27], v47, s[4:7], s40 offen
    s_add_u32 s40, s40, 6291456
    buffer_load_dwordx4 v[40:43], v2, s[8:11], s40 offen
    s_lshl_b32 s40, s58, 1
    v_mov_b32 v3, 0
    buffer_load_ushort v46, v3, s[12:15], s40 offen
    v_mov_b32 v52, 0
    v_mov_b32 v53, 0
    v_mov_b32 v54, 0
    v_mov_b32 v55, 0
    v_lshrrev_b32 v3, 2, v0
    v_mul_u32_u24 v3, 4160, v3
    v_and_b32 v4, 3, v0
    v_lshl_add_u32 v3, v4, 4, v3
    v_cmp_gt_u32 vcc, 160, v0
    s_nop 0
    s_and_saveexec_b64 s[50:51], vcc
    s_cbranch_execz c_z_8
    ds_write_b128 v2, v[52:55] offset:33280
    v_cmp_gt_u32 vcc, 32, v0
    s_nop 0
    s_and_b64 exec, exec, vcc
    s_cbranch_execz c_z2_9
    ds_write_b128 v3, v[52:55] offset:0
c_z2_9:
c_z_8:
    s_mov_b64 exec, s[50:51]
    v_add_u32 v56, 48, v2
    v_lshrrev_b32 v3, 2, v0
    v_lshl_add_u32 v57, v3, 4, v2
    v_add_u32 v57, 35840, v57
    v_and_b32 v3, 7, v1
    v_mul_u32_u24 v3, 4160, v3
    v_and_b32 v4, 31, v1
    v_lshrrev_b32 v4, 3, v4
    v_lshrrev_b32 v5, 5, v1
    v_sub_u32 v4, v4, v5
    v_lshl_add_u32 v3, v4, 4, v3
    v_add_u32 v58, 16, v3
    v_and_b32 v3, 31, v1
    v_mul_u32_u24 v3, 80, v3
    v_lshl_add_u32 v59, v5, 4, v3
    v_add_u32 v59, 33280, v59
    v_and_b32 v3, 31, v1
    v_lshlrev_b32 v4, 3, v5
    v_add_u32 v4, 7, v4
    v_sub_u32 v4, v4, v3
    v_mov_b32 v68, 0xffff
    v_mov_b32 v69, 0xffff0000
    v_cmp_eq_u32 vcc, 0, v4
    s_nop 1
    v_cndmask_b32 v60, 0, v68, vcc
    v_cmp_eq_u32 vcc, 1, v4
    s_nop 1
    v_cndmask_b32 v60, v60, v69, vcc
    v_cmp_eq_u32 vcc, 2, v4
    s_nop 1
    v_cndmask_b32 v61, 0, v68, vcc
    v_cmp_eq_u32 vcc, 3, v4
    s_nop 1
    v_cndmask_b32 v61, v61, v69, vcc
    v_cmp_eq_u32 vcc, 4, v4
    s_nop 1
    v_cndmask_b32 v62, 0, v68, vcc
    v_cmp_eq_u32 vcc, 5, v4
    s_nop 1
    v_cndmask_b32 v62, v62, v69, vcc
    v_cmp_eq_u32 vcc, 6, v4
    s_nop 1
    v_cndmask_b32 v63, 0, v68, vcc
    v_cmp_eq_u32 vcc, 7, v4
    s_nop 1
    v_cndmask_b32 v63, v63, v69, vcc
    v_cmp_eq_u32 vcc, -16, v4
    s_nop 1
    v_cndmask_b32 v64, 0, v68, vcc
    v_cmp_eq_u32 vcc, -15, v4
    s_nop 1
    v_cndmask_b32 v64, v64, v69, vcc
    v_cmp_eq_u32 vcc, -14, v4
    s_nop 1
    v_cndmask_b32 v65, 0, v68, vcc
    v_cmp_eq_u32 vcc, -13, v4
    s_nop 1
    v_cndmask_b32 v65, v65, v69, vcc
    v_cmp_eq_u32 vcc, -12, v4
    s_nop 1
    v_cndmask_b32 v66, 0, v68, vcc
    v_cmp_eq_u32 vcc, -11, v4
    s_nop 1
    v_cndmask_b32 v66, v66, v69, vcc
    v_cmp_eq_u32 vcc, -10, v4
    s_nop 1
    v_cndmask_b32 v67, 0, v68, vcc
    v_cmp_eq_u32 vcc, -9, v4
    s_nop 1
    v_cndmask_b32 v67, v67, v69, vcc
    v_and_b32 v3, 31, v1
    v_mul_u32_u24 v3, 144, v3
    v_lshl_add_u32 v70, v5, 4, v3
    v_add_u32 v70, 40960, v70
    v_and_b32 v3, 127, v0
    v_lshrrev_b32 v3, 2, v3
    v_mul_u32_u24 v3, 144, v3
    v_and_b32 v4, 3, v0
    v_lshl_add_u32 v71, v4, 5, v3
    v_add_u32 v71, 40960, v71
    s_waitcnt vmcnt(8)
    v_cmp_ne_u32 vcc, 0, v0
    s_nop 1
    v_cndmask_b32 v8, 0, v8, vcc
    v_cndmask_b32 v9, 0, v9, vcc
    v_cndmask_b32 v10, 0, v10, vcc
    v_cndmask_b32 v11, 0, v11, vcc
    v_alignbit_b32 v176, v9, v8, 16
    v_alignbit_b32 v177, v10, v9, 16
    v_alignbit_b32 v178, v11, v10, 16
    v_alignbit_b32 v179, v12, v11, 16
    v_alignbit_b32 v180, v13, v12, 16
    v_alignbit_b32 v181, v14, v13, 16
    v_alignbit_b32 v182, v15, v14, 16
    ds_write_b128 v56, v[176:179] offset:0
    v_mov_b32 v184, v9
    v_mov_b32 v185, v10
    v_mov_b32 v186, v11
    v_mov_b32 v187, v12
    ds_write_b128 v56, v[184:187] offset:4160
    s_nop 1
    v_mov_b32 v184, v177
    v_mov_b32 v185, v178
    v_mov_b32 v186, v179
    v_mov_b32 v187, v180
    ds_write_b128 v56, v[184:187] offset:8320
    s_nop 1
    ds_write_b128 v56, v[10:13] offset:12480
    ds_write_b128 v56, v[178:181] offset:16640
    v_mov_b32 v184, v11
    v_mov_b32 v185, v12
    v_mov_b32 v186, v13
    v_mov_b32 v187, v14
    ds_write_b128 v56, v[184:187] offset:20800
    s_nop 1
    v_mov_b32 v184, v179
    v_mov_b32 v185, v180
    v_mov_b32 v186, v181
    v_mov_b32 v187, v182
    ds_write_b128 v56, v[184:187] offset:24960
    s_nop 1
    ds_write_b128 v56, v[12:15] offset:29120
    ds_write_b128 v57, v[32:35]
    v_lshlrev_b32 v3, 16, v44
    v_or_b32 v3, v3, v44
    v_and_b32 v188, v60, v3
    v_and_b32 v189, v61, v3
    v_and_b32 v190, v62, v3
    v_and_b32 v191, v63, v3
    v_and_b32 v192, v64, v3
    v_and_b32 v193, v65, v3
    v_and_b32 v194, v66, v3
    v_and_b32 v195, v67, v3
    s_waitcnt vmcnt(4)
    s_waitcnt lgkmcnt(0)
    s_barrier
    s_cmp_ge_u32 s2, 192
    s_cbranch_scc1 c_wj3_10
    v_lshrrev_b32 v3, 4, v1
    v_and_b32 v5, 15, v1
    v_lshrrev_b32 v4, 2, v5
    v_lshl_add_u32 v3, v3, 2, v4
    v_mul_u32_u24 v3, 160, v3
    v_and_b32 v4, 3, v5
    v_lshl_add_u32 v3, v4, 3, v3
    v_lshlrev_b32 v5, 4, v1
    s_lshl_b32 s40, s34, 5
    s_add_u32 s41, s40, 73216
    v_add_u32 v4, s41, v3
    ds_read_b64_tr_b16 v[184:185], v4
    ds_read_b64_tr_b16 v[186:187], v4 offset:2560
    s_mul_i32 s41, s2, 5120
    s_lshl_b32 s40, s40, 5
    s_add_u32 s41, s41, s40
    s_add_u32 s41, s41, 15007744
    s_waitcnt lgkmcnt(0)
    buffer_store_dwordx4 v[184:187], v5, s[8:11], s41 offen sc1
    s_nop 1
    s_cmp_lg_u32 s34, 0
    s_cbranch_scc1 c_wj4_11
    s_mov_b32 s40, 128
    s_add_u32 s41, s40, 73216
    v_add_u32 v4, s41, v3
    ds_read_b64_tr_b16 v[184:185], v4
    ds_read_b64_tr_b16 v[186:187], v4 offset:2560
    s_mul_i32 s41, s2, 5120
    s_lshl_b32 s40, s40, 5
    s_add_u32 s41, s41, s40
    s_add_u32 s41, s41, 15007744
    s_waitcnt lgkmcnt(0)
    buffer_store_dwordx4 v[184:187], v5, s[8:11], s41 offen sc1
    s_nop 1
c_wj4_11:
c_wj3_10:
    s_cmp_lg_u32 s34, 0
    s_cbranch_scc1 c_pw_13
    ds_read_b128 v[104:107], v58 offset:0
    ds_read_b128 v[128:131], v59 offset:2592
    ds_read_b128 v[152:155], v59 offset:5152
    ds_read_b128 v[108:111], v58 offset:32
    ds_read_b128 v[132:135], v59 offset:2560
    ds_read_b128 v[156:159], v59 offset:5120
    ds_read_b128 v[112:115], v58 offset:64
    ds_read_b128 v[136:139], v59 offset:2512
    ds_read_b128 v[160:163], v59 offset:5072
    ds_read_b128 v[116:119], v58 offset:96
    ds_read_b128 v[140:143], v59 offset:2480
    ds_read_b128 v[164:167], v59 offset:5040
    ds_read_b128 v[120:123], v58 offset:128
    ds_read_b128 v[144:147], v59 offset:2432
    ds_read_b128 v[168:171], v59 offset:4992
    s_waitcnt lgkmcnt(12)
    v_mfma_f32_32x32x16_bf16 v[72:87], v[104:107], v[128:131], 0
    v_mfma_f32_32x32x16_bf16 v[88:103], v[104:107], v[152:155], 0
    v_mfma_f32_32x32x16_bf16 v[72:87], v[192:195], v[128:131], v[72:87]
    v_mfma_f32_32x32x16_bf16 v[88:103], v[192:195], v[152:155], v[88:103]
    ds_read_b128 v[124:127], v58 offset:160
    ds_read_b128 v[148:151], v59 offset:2400
    ds_read_b128 v[172:175], v59 offset:4960
    s_waitcnt lgkmcnt(12)
    v_mfma_f32_32x32x16_bf16 v[72:87], v[108:111], v[132:135], v[72:87]
    v_mfma_f32_32x32x16_bf16 v[88:103], v[108:111], v[156:159], v[88:103]
    v_mfma_f32_32x32x16_bf16 v[72:87], v[188:191], v[132:135], v[72:87]
    v_mfma_f32_32x32x16_bf16 v[88:103], v[188:191], v[156:159], v[88:103]
    ds_read_b128 v[104:107], v58 offset:192
    ds_read_b128 v[128:131], v59 offset:2352
    ds_read_b128 v[152:155], v59 offset:4912
    s_waitcnt lgkmcnt(12)
    v_mfma_f32_32x32x16_bf16 v[72:87], v[112:115], v[136:139], v[72:87]
    v_mfma_f32_32x32x16_bf16 v[88:103], v[112:115], v[160:163], v[88:103]
    ds_read_b128 v[108:111], v58 offset:224
    ds_read_b128 v[132:135], v59 offset:2320
    ds_read_b128 v[156:159], v59 offset:4880
    s_waitcnt lgkmcnt(12)
    v_mfma_f32_32x32x16_bf16 v[72:87], v[116:119], v[140:143], v[72:87]
    v_mfma_f32_32x32x16_bf16 v[88:103], v[116:119], v[164:167], v[88:103]
    ds_read_b128 v[112:115], v58 offset:256
    ds_read_b128 v[136:139], v59 offset:2272
    ds_read_b128 v[160:163], v59 offset:4832
    s_waitcnt lgkmcnt(12)
    v_mfma_f32_32x32x16_bf16 v[72:87], v[120:123], v[144:147], v[72:87]
    v_mfma_f32_32x32x16_bf16 v[88:103], v[120:123], v[168:171], v[88:103]
    ds_read_b128 v[116:119], v58 offset:288
    ds_read_b128 v[140:143], v59 offset:2240
    ds_read_b128 v[164:167], v59 offset:4800
    s_waitcnt lgkmcnt(12)
    v_mfma_f32_32x32x16_bf16 v[72:87], v[124:127], v[148:151], v[72:87]
    v_mfma_f32_32x32x16_bf16 v[88:103], v[124:127], v[172:175], v[88:103]
    ds_read_b128 v[120:123], v58 offset:320
    ds_read_b128 v[144:147], v59 offset:2192
    ds_read_b128 v[168:171], v59 offset:4752
    s_waitcnt lgkmcnt(12)
    v_mfma_f32_32x32x16_bf16 v[72:87], v[104:107], v[128:131], v[72:87]
    v_mfma_f32_32x32x16_bf16 v[88:103], v[104:107], v[152:155], v[88:103]
    ds_read_b128 v[124:127], v58 offset:352
    ds_read_b128 v[148:151], v59 offset:2160
    ds_read_b128 v[172:175], v59 offset:4720
    s_waitcnt lgkmcnt(12)
    v_mfma_f32_32x32x16_bf16 v[72:87], v[108:111], v[132:135], v[72:87]
    v_mfma_f32_32x32x16_bf16 v[88:103], v[108:111], v[156:159], v[88:103]
    ds_read_b128 v[104:107], v58 offset:384
    ds_read_b128 v[128:131], v59 offset:2112
    ds_read_b128 v[152:155], v59 offset:4672
    s_waitcnt lgkmcnt(12)
    v_mfma_f32_32x32x16_bf16 v[72:87], v[112:115], v[136:139], v[72:87]
    v_mfma_f32_32x32x16_bf16 v[88:103], v[112:115], v[160:163], v[88:103]
    ds_read_b128 v[108:111], v58 offset:416
    ds_read_b128 v[132:135], v59 offset:2080
    ds_read_b128 v[156:159], v59 offset:4640
    s_waitcnt lgkmcnt(12)
    v_mfma_f32_32x32x16_bf16 v[72:87], v[116:119], v[140:143], v[72:87]
    v_mfma_f32_32x32x16_bf16 v[88:103], v[116:119], v[164:167], v[88:103]
    ds_read_b128 v[112:115], v58 offset:448
    ds_read_b128 v[136:139], v59 offset:2032
    ds_read_b128 v[160:163], v59 offset:4592
    s_waitcnt lgkmcnt(12)
    v_mfma_f32_32x32x16_bf16 v[72:87], v[120:123], v[144:147], v[72:87]
    v_mfma_f32_32x32x16_bf16 v[88:103], v[120:123], v[168:171], v[88:103]
    ds_read_b128 v[116:119], v58 offset:480
    ds_read_b128 v[140:143], v59 offset:2000
    ds_read_b128 v[164:167], v59 offset:4560
    s_waitcnt lgkmcnt(12)
    v_mfma_f32_32x32x16_bf16 v[72:87], v[124:127], v[148:151], v[72:87]
    v_mfma_f32_32x32x16_bf16 v[88:103], v[124:127], v[172:175], v[88:103]
    ds_read_b128 v[120:123], v58 offset:512
    ds_read_b128 v[144:147], v59 offset:1952
    ds_read_b128 v[168:171], v59 offset:4512
    s_waitcnt lgkmcnt(12)
    v_mfma_f32_32x32x16_bf16 v[72:87], v[104:107], v[128:131], v[72:87]
    v_mfma_f32_32x32x16_bf16 v[88:103], v[104:107], v[152:155], v[88:103]
    ds_read_b128 v[124:127], v58 offset:544
    ds_read_b128 v[148:151], v59 offset:1920
    ds_read_b128 v[172:175], v59 offset:4480
    s_waitcnt lgkmcnt(12)
    v_mfma_f32_32x32x16_bf16 v[72:87], v[108:111], v[132:135], v[72:87]
    v_mfma_f32_32x32x16_bf16 v[88:103], v[108:111], v[156:159], v[88:103]
    ds_read_b128 v[104:107], v58 offset:576
    ds_read_b128 v[128:131], v59 offset:1872
    ds_read_b128 v[152:155], v59 offset:4432
    s_waitcnt lgkmcnt(12)
    v_mfma_f32_32x32x16_bf16 v[72:87], v[112:115], v[136:139], v[72:87]
    v_mfma_f32_32x32x16_bf16 v[88:103], v[112:115], v[160:163], v[88:103]
    ds_read_b128 v[108:111], v58 offset:608
    ds_read_b128 v[132:135], v59 offset:1840
    ds_read_b128 v[156:159], v59 offset:4400
    s_waitcnt lgkmcnt(12)
    v_mfma_f32_32x32x16_bf16 v[72:87], v[116:119], v[140:143], v[72:87]
    v_mfma_f32_32x32x16_bf16 v[88:103], v[116:119], v[164:167], v[88:103]
    ds_read_b128 v[112:115], v58 offset:640
    ds_read_b128 v[136:139], v59 offset:1792
    ds_read_b128 v[160:163], v59 offset:4352
    s_waitcnt lgkmcnt(12)
    v_mfma_f32_32x32x16_bf16 v[72:87], v[120:123], v[144:147], v[72:87]
    v_mfma_f32_32x32x16_bf16 v[88:103], v[120:123], v[168:171], v[88:103]
    ds_read_b128 v[116:119], v58 offset:672
    ds_read_b128 v[140:143], v59 offset:1760
    ds_read_b128 v[164:167], v59 offset:4320
    s_waitcnt lgkmcnt(12)
    v_mfma_f32_32x32x16_bf16 v[72:87], v[124:127], v[148:151], v[72:87]
    v_mfma_f32_32x32x16_bf16 v[88:103], v[124:127], v[172:175], v[88:103]
    ds_read_b128 v[120:123], v58 offset:704
    ds_read_b128 v[144:147], v59 offset:1712
    ds_read_b128 v[168:171], v59 offset:4272
    s_waitcnt lgkmcnt(12)
    v_mfma_f32_32x32x16_bf16 v[72:87], v[104:107], v[128:131], v[72:87]
    v_mfma_f32_32x32x16_bf16 v[88:103], v[104:107], v[152:155], v[88:103]
    s_waitcnt lgkmcnt(9)
    v_mfma_f32_32x32x16_bf16 v[72:87], v[108:111], v[132:135], v[72:87]
    v_mfma_f32_32x32x16_bf16 v[88:103], v[108:111], v[156:159], v[88:103]
    s_waitcnt lgkmcnt(6)
    v_mfma_f32_32x32x16_bf16 v[72:87], v[112:115], v[136:139], v[72:87]
    v_mfma_f32_32x32x16_bf16 v[88:103], v[112:115], v[160:163], v[88:103]
    s_waitcnt lgkmcnt(3)
    v_mfma_f32_32x32x16_bf16 v[72:87], v[116:119], v[140:143], v[72:87]
    v_mfma_f32_32x32x16_bf16 v[88:103], v[116:119], v[164:167], v[88:103]
    s_waitcnt lgkmcnt(0)
    v_mfma_f32_32x32x16_bf16 v[72:87], v[120:123], v[144:147], v[72:87]
    v_mfma_f32_32x32x16_bf16 v[88:103], v[120:123], v[168:171], v[88:103]
    s_nop 10
    ds_write_b128 v70, v[72:75] offset:0
    ds_write_b128 v70, v[76:79] offset:32
    ds_write_b128 v70, v[80:83] offset:64
    ds_write_b128 v70, v[84:87] offset:96
    ds_write_b128 v70, v[88:91] offset:13824
    ds_write_b128 v70, v[92:95] offset:13856
    ds_write_b128 v70, v[96:99] offset:13888
    ds_write_b128 v70, v[100:103] offset:13920
    s_branch c_pw_end_12
c_pw_13:
    s_cmp_lg_u32 s34, 1
    s_cbranch_scc1 c_pw_14
    ds_read_b128 v[104:107], v58 offset:736
    ds_read_b128 v[128:131], v59 offset:1680
    ds_read_b128 v[152:155], v59 offset:4240
    ds_read_b128 v[108:111], v58 offset:768
    ds_read_b128 v[132:135], v59 offset:1632
    ds_read_b128 v[156:159], v59 offset:4192
    ds_read_b128 v[112:115], v58 offset:800
    ds_read_b128 v[136:139], v59 offset:1600
    ds_read_b128 v[160:163], v59 offset:4160
    ds_read_b128 v[116:119], v58 offset:832
    ds_read_b128 v[140:143], v59 offset:1552
    ds_read_b128 v[164:167], v59 offset:4112
    ds_read_b128 v[120:123], v58 offset:864
    ds_read_b128 v[144:147], v59 offset:1520
    ds_read_b128 v[168:171], v59 offset:4080
    s_waitcnt lgkmcnt(12)
    v_mfma_f32_32x32x16_bf16 v[72:87], v[104:107], v[128:131], 0
    v_mfma_f32_32x32x16_bf16 v[88:103], v[104:107], v[152:155], 0
    ds_read_b128 v[124:127], v58 offset:896
    ds_read_b128 v[148:151], v59 offset:1472
    ds_read_b128 v[172:175], v59 offset:4032
    s_waitcnt lgkmcnt(12)
    v_mfma_f32_32x32x16_bf16 v[72:87], v[108:111], v[132:135], v[72:87]
    v_mfma_f32_32x32x16_bf16 v[88:103], v[108:111], v[156:159], v[88:103]
    ds_read_b128 v[104:107], v58 offset:928
    ds_read_b128 v[128:131], v59 offset:1440
    ds_read_b128 v[152:155], v59 offset:4000
    s_waitcnt lgkmcnt(12)
    v_mfma_f32_32x32x16_bf16 v[72:87], v[112:115], v[136:139], v[72:87]
    v_mfma_f32_32x32x16_bf16 v[88:103], v[112:115], v[160:163], v[88:103]
    ds_read_b128 v[108:111], v58 offset:960
    ds_read_b128 v[132:135], v59 offset:1392
    ds_read_b128 v[156:159], v59 offset:3952
    s_waitcnt lgkmcnt(12)
    v_mfma_f32_32x32x16_bf16 v[72:87], v[116:119], v[140:143], v[72:87]
    v_mfma_f32_32x32x16_bf16 v[88:103], v[116:119], v[164:167], v[88:103]
    ds_read_b128 v[112:115], v58 offset:992
    ds_read_b128 v[136:139], v59 offset:1360
    ds_read_b128 v[160:163], v59 offset:3920
    s_waitcnt lgkmcnt(12)
    v_mfma_f32_32x32x16_bf16 v[72:87], v[120:123], v[144:147], v[72:87]
    v_mfma_f32_32x32x16_bf16 v[88:103], v[120:123], v[168:171], v[88:103]
    ds_read_b128 v[116:119], v58 offset:1024
    ds_read_b128 v[140:143], v59 offset:1312
    ds_read_b128 v[164:167], v59 offset:3872
    s_waitcnt lgkmcnt(12)
    v_mfma_f32_32x32x16_bf16 v[72:87], v[124:127], v[148:151], v[72:87]
    v_mfma_f32_32x32x16_bf16 v[88:103], v[124:127], v[172:175], v[88:103]
    ds_read_b128 v[120:123], v58 offset:1056
    ds_read_b128 v[144:147], v59 offset:1280
    ds_read_b128 v[168:171], v59 offset:3840
    s_waitcnt lgkmcnt(12)
    v_mfma_f32_32x32x16_bf16 v[72:87], v[104:107], v[128:131], v[72:87]
    v_mfma_f32_32x32x16_bf16 v[88:103], v[104:107], v[152:155], v[88:103]
    ds_read_b128 v[124:127], v58 offset:1088
    ds_read_b128 v[148:151], v59 offset:1232
    ds_read_b128 v[172:175], v59 offset:3792
    s_waitcnt lgkmcnt(12)
    v_mfma_f32_32x32x16_bf16 v[72:87], v[108:111], v[132:135], v[72:87]
    v_mfma_f32_32x32x16_bf16 v[88:103], v[108:111], v[156:159], v[88:103]
    ds_read_b128 v[104:107], v58 offset:1120
    ds_read_b128 v[128:131], v59 offset:1200
    ds_read_b128 v[152:155], v59 offset:3760
    s_waitcnt lgkmcnt(12)
    v_mfma_f32_32x32x16_bf16 v[72:87], v[112:115], v[136:139], v[72:87]
    v_mfma_f32_32x32x16_bf16 v[88:103], v[112:115], v[160:163], v[88:103]
    ds_read_b128 v[108:111], v58 offset:1152
    ds_read_b128 v[132:135], v59 offset:1152
    ds_read_b128 v[156:159], v59 offset:3712
    s_waitcnt lgkmcnt(12)
    v_mfma_f32_32x32x16_bf16 v[72:87], v[116:119], v[140:143], v[72:87]
    v_mfma_f32_32x32x16_bf16 v[88:103], v[116:119], v[164:167], v[88:103]
    ds_read_b128 v[112:115], v58 offset:1184
    ds_read_b128 v[136:139], v59 offset:1120
    ds_read_b128 v[160:163], v59 offset:3680
    s_waitcnt lgkmcnt(12)
    v_mfma_f32_32x32x16_bf16 v[72:87], v[120:123], v[144:147], v[72:87]
    v_mfma_f32_32x32x16_bf16 v[88:103], v[120:123], v[168:171], v[88:103]
    ds_read_b128 v[116:119], v58 offset:1216
    ds_read_b128 v[140:143], v59 offset:1072
    ds_read_b128 v[164:167], v59 offset:3632
    s_waitcnt lgkmcnt(12)
    v_mfma_f32_32x32x16_bf16 v[72:87], v[124:127], v[148:151], v[72:87]
    v_mfma_f32_32x32x16_bf16 v[88:103], v[124:127], v[172:175], v[88:103]
    ds_read_b128 v[120:123], v58 offset:1248
    ds_read_b128 v[144:147], v59 offset:1040
    ds_read_b128 v[168:171], v59 offset:3600
    s_waitcnt lgkmcnt(12)
    v_mfma_f32_32x32x16_bf16 v[72:87], v[104:107], v[128:131], v[72:87]
    v_mfma_f32_32x32x16_bf16 v[88:103], v[104:107], v[152:155], v[88:103]
    ds_read_b128 v[124:127], v58 offset:1280
    ds_read_b128 v[148:151], v59 offset:992
    ds_read_b128 v[172:175], v59 offset:3552
    s_waitcnt lgkmcnt(12)
    v_mfma_f32_32x32x16_bf16 v[72:87], v[108:111], v[132:135], v[72:87]
    v_mfma_f32_32x32x16_bf16 v[88:103], v[108:111], v[156:159], v[88:103]
    ds_read_b128 v[104:107], v58 offset:1312
    ds_read_b128 v[128:131], v59 offset:960
    ds_read_b128 v[152:155], v59 offset:3520
    s_waitcnt lgkmcnt(12)
    v_mfma_f32_32x32x16_bf16 v[72:87], v[112:115], v[136:139], v[72:87]
    v_mfma_f32_32x32x16_bf16 v[88:103], v[112:115], v[160:163], v[88:103]
    ds_read_b128 v[108:111], v58 offset:1344
    ds_read_b128 v[132:135], v59 offset:912
    ds_read_b128 v[156:159], v59 offset:3472
    s_waitcnt lgkmcnt(12)
    v_mfma_f32_32x32x16_bf16 v[72:87], v[116:119], v[140:143], v[72:87]
    v_mfma_f32_32x32x16_bf16 v[88:103], v[116:119], v[164:167], v[88:103]
    ds_read_b128 v[112:115], v58 offset:1376
    ds_read_b128 v[136:139], v59 offset:880
    ds_read_b128 v[160:163], v59 offset:3440
    s_waitcnt lgkmcnt(12)
    v_mfma_f32_32x32x16_bf16 v[72:87], v[120:123], v[144:147], v[72:87]
    v_mfma_f32_32x32x16_bf16 v[88:103], v[120:123], v[168:171], v[88:103]
    ds_read_b128 v[116:119], v58 offset:1408
    ds_read_b128 v[140:143], v59 offset:832
    ds_read_b128 v[164:167], v59 offset:3392
    s_waitcnt lgkmcnt(12)
    v_mfma_f32_32x32x16_bf16 v[72:87], v[124:127], v[148:151], v[72:87]
    v_mfma_f32_32x32x16_bf16 v[88:103], v[124:127], v[172:175], v[88:103]
    ds_read_b128 v[120:123], v58 offset:1440
    ds_read_b128 v[144:147], v59 offset:800
    ds_read_b128 v[168:171], v59 offset:3360
    s_waitcnt lgkmcnt(12)
    v_mfma_f32_32x32x16_bf16 v[72:87], v[104:107], v[128:131], v[72:87]
    v_mfma_f32_32x32x16_bf16 v[88:103], v[104:107], v[152:155], v[88:103]
    ds_read_b128 v[124:127], v58 offset:1472
    ds_read_b128 v[148:151], v59 offset:752
    ds_read_b128 v[172:175], v59 offset:3312
    s_waitcnt lgkmcnt(12)
    v_mfma_f32_32x32x16_bf16 v[72:87], v[108:111], v[132:135], v[72:87]
    v_mfma_f32_32x32x16_bf16 v[88:103], v[108:111], v[156:159], v[88:103]
    s_waitcnt lgkmcnt(9)
    v_mfma_f32_32x32x16_bf16 v[72:87], v[112:115], v[136:139], v[72:87]
    v_mfma_f32_32x32x16_bf16 v[88:103], v[112:115], v[160:163], v[88:103]
    s_waitcnt lgkmcnt(6)
    v_mfma_f32_32x32x16_bf16 v[72:87], v[116:119], v[140:143], v[72:87]
    v_mfma_f32_32x32x16_bf16 v[88:103], v[116:119], v[164:167], v[88:103]
    s_waitcnt lgkmcnt(3)
    v_mfma_f32_32x32x16_bf16 v[72:87], v[120:123], v[144:147], v[72:87]
    v_mfma_f32_32x32x16_bf16 v[88:103], v[120:123], v[168:171], v[88:103]
    s_waitcnt lgkmcnt(0)
    v_mfma_f32_32x32x16_bf16 v[72:87], v[124:127], v[148:151], v[72:87]
    v_mfma_f32_32x32x16_bf16 v[88:103], v[124:127], v[172:175], v[88:103]
    s_nop 10
    ds_write_b128 v70, v[72:75] offset:4608
    ds_write_b128 v70, v[76:79] offset:4640
    ds_write_b128 v70, v[80:83] offset:4672
    ds_write_b128 v70, v[84:87] offset:4704
    ds_write_b128 v70, v[88:91] offset:18432
    ds_write_b128 v70, v[92:95] offset:18464
    ds_write_b128 v70, v[96:99] offset:18496
    ds_write_b128 v70, v[100:103] offset:18528
    s_branch c_pw_end_12
c_pw_14:
    s_cmp_lg_u32 s34, 2
    s_cbranch_scc1 c_pw_15
    ds_read_b128 v[104:107], v58 offset:1504
    ds_read_b128 v[128:131], v59 offset:720
    ds_read_b128 v[152:155], v59 offset:3280
    ds_read_b128 v[108:111], v58 offset:1536
    ds_read_b128 v[132:135], v59 offset:672
    ds_read_b128 v[156:159], v59 offset:3232
    ds_read_b128 v[112:115], v58 offset:1568
    ds_read_b128 v[136:139], v59 offset:640
    ds_read_b128 v[160:163], v59 offset:3200
    ds_read_b128 v[116:119], v58 offset:1600
    ds_read_b128 v[140:143], v59 offset:592
    ds_read_b128 v[164:167], v59 offset:3152
    ds_read_b128 v[120:123], v58 offset:1632
    ds_read_b128 v[144:147], v59 offset:560
    ds_read_b128 v[168:171], v59 offset:3120
    s_waitcnt lgkmcnt(12)
    v_mfma_f32_32x32x16_bf16 v[72:87], v[104:107], v[128:131], 0
    v_mfma_f32_32x32x16_bf16 v[88:103], v[104:107], v[152:155], 0
    ds_read_b128 v[124:127], v58 offset:1664
    ds_read_b128 v[148:151], v59 offset:512
    ds_read_b128 v[172:175], v59 offset:3072
    s_waitcnt lgkmcnt(12)
    v_mfma_f32_32x32x16_bf16 v[72:87], v[108:111], v[132:135], v[72:87]
    v_mfma_f32_32x32x16_bf16 v[88:103], v[108:111], v[156:159], v[88:103]
    ds_read_b128 v[104:107], v58 offset:1696
    ds_read_b128 v[128:131], v59 offset:480
    ds_read_b128 v[152:155], v59 offset:3040
    s_waitcnt lgkmcnt(12)
    v_mfma_f32_32x32x16_bf16 v[72:87], v[112:115], v[136:139], v[72:87]
    v_mfma_f32_32x32x16_bf16 v[88:103], v[112:115], v[160:163], v[88:103]
    ds_read_b128 v[108:111], v58 offset:1728
    ds_read_b128 v[132:135], v59 offset:432
    ds_read_b128 v[156:159], v59 offset:2992
    s_waitcnt lgkmcnt(12)
    v_mfma_f32_32x32x16_bf16 v[72:87], v[116:119], v[140:143], v[72:87]
    v_mfma_f32_32x32x16_bf16 v[88:103], v[116:119], v[164:167], v[88:103]
    ds_read_b128 v[112:115], v58 offset:1760
    ds_read_b128 v[136:139], v59 offset:400
    ds_read_b128 v[160:163], v59 offset:2960
    s_waitcnt lgkmcnt(12)
    v_mfma_f32_32x32x16_bf16 v[72:87], v[120:123], v[144:147], v[72:87]
    v_mfma_f32_32x32x16_bf16 v[88:103], v[120:123], v[168:171], v[88:103]
    ds_read_b128 v[116:119], v58 offset:1792
    ds_read_b128 v[140:143], v59 offset:352
    ds_read_b128 v[164:167], v59 offset:2912
    s_waitcnt lgkmcnt(12)
    v_mfma_f32_32x32x16_bf16 v[72:87], v[124:127], v[148:151], v[72:87]
    v_mfma_f32_32x32x16_bf16 v[88:103], v[124:127], v[172:175], v[88:103]
    ds_read_b128 v[120:123], v58 offset:1824
    ds_read_b128 v[144:147], v59 offset:320
    ds_read_b128 v[168:171], v59 offset:2880
    s_waitcnt lgkmcnt(12)
    v_mfma_f32_32x32x16_bf16 v[72:87], v[104:107], v[128:131], v[72:87]
    v_mfma_f32_32x32x16_bf16 v[88:103], v[104:107], v[152:155], v[88:103]
    ds_read_b128 v[124:127], v58 offset:1856
    ds_read_b128 v[148:151], v59 offset:272
    ds_read_b128 v[172:175], v59 offset:2832
    s_waitcnt lgkmcnt(12)
    v_mfma_f32_32x32x16_bf16 v[72:87], v[108:111], v[132:135], v[72:87]
    v_mfma_f32_32x32x16_bf16 v[88:103], v[108:111], v[156:159], v[88:103]
    ds_read_b128 v[104:107], v58 offset:1888
    ds_read_b128 v[128:131], v59 offset:240
    ds_read_b128 v[152:155], v59 offset:2800
    s_waitcnt lgkmcnt(12)
    v_mfma_f32_32x32x16_bf16 v[72:87], v[112:115], v[136:139], v[72:87]
    v_mfma_f32_32x32x16_bf16 v[88:103], v[112:115], v[160:163], v[88:103]
    ds_read_b128 v[108:111], v58 offset:1920
    ds_read_b128 v[132:135], v59 offset:192
    ds_read_b128 v[156:159], v59 offset:2752
    s_waitcnt lgkmcnt(12)
    v_mfma_f32_32x32x16_bf16 v[72:87], v[116:119], v[140:143], v[72:87]
    v_mfma_f32_32x32x16_bf16 v[88:103], v[116:119], v[164:167], v[88:103]
    ds_read_b128 v[112:115], v58 offset:1952
    ds_read_b128 v[136:139], v59 offset:160
    ds_read_b128 v[160:163], v59 offset:2720
    s_waitcnt lgkmcnt(12)
    v_mfma_f32_32x32x16_bf16 v[72:87], v[120:123], v[144:147], v[72:87]
    v_mfma_f32_32x32x16_bf16 v[88:103], v[120:123], v[168:171], v[88:103]
    ds_read_b128 v[116:119], v58 offset:1984
    ds_read_b128 v[140:143], v59 offset:112
    ds_read_b128 v[164:167], v59 offset:2672
    s_waitcnt lgkmcnt(12)
    v_mfma_f32_32x32x16_bf16 v[72:87], v[124:127], v[148:151], v[72:87]
    v_mfma_f32_32x32x16_bf16 v[88:103], v[124:127], v[172:175], v[88:103]
    ds_read_b128 v[120:123], v58 offset:2016
    ds_read_b128 v[144:147], v59 offset:80
    ds_read_b128 v[168:171], v59 offset:2640
    s_waitcnt lgkmcnt(12)
    v_mfma_f32_32x32x16_bf16 v[72:87], v[104:107], v[128:131], v[72:87]
    v_mfma_f32_32x32x16_bf16 v[88:103], v[104:107], v[152:155], v[88:103]
    ds_read_b128 v[124:127], v58 offset:2048
    ds_read_b128 v[172:175], v59 offset:2592
    s_waitcnt lgkmcnt(11)
    v_mfma_f32_32x32x16_bf16 v[72:87], v[108:111], v[132:135], v[72:87]
    v_mfma_f32_32x32x16_bf16 v[88:103], v[108:111], v[156:159], v[88:103]
    ds_read_b128 v[104:107], v58 offset:2080
    ds_read_b128 v[152:155], v59 offset:2560
    s_waitcnt lgkmcnt(10)
    v_mfma_f32_32x32x16_bf16 v[72:87], v[112:115], v[136:139], v[72:87]
    v_mfma_f32_32x32x16_bf16 v[88:103], v[112:115], v[160:163], v[88:103]
    ds_read_b128 v[108:111], v58 offset:2112
    ds_read_b128 v[156:159], v59 offset:2512
    s_waitcnt lgkmcnt(9)
    v_mfma_f32_32x32x16_bf16 v[72:87], v[116:119], v[140:143], v[72:87]
    v_mfma_f32_32x32x16_bf16 v[88:103], v[116:119], v[164:167], v[88:103]
    ds_read_b128 v[112:115], v58 offset:2144
    ds_read_b128 v[160:163], v59 offset:2480
    s_waitcnt lgkmcnt(8)
    v_mfma_f32_32x32x16_bf16 v[72:87], v[120:123], v[144:147], v[72:87]
    v_mfma_f32_32x32x16_bf16 v[88:103], v[120:123], v[168:171], v[88:103]
    ds_read_b128 v[116:119], v58 offset:2176
    ds_read_b128 v[164:167], v59 offset:2432
    s_waitcnt lgkmcnt(8)
    v_mfma_f32_32x32x16_bf16 v[88:103], v[124:127], v[172:175], v[88:103]
    ds_read_b128 v[120:123], v58 offset:2208
    ds_read_b128 v[168:171], v59 offset:2400
    s_waitcnt lgkmcnt(8)
    v_mfma_f32_32x32x16_bf16 v[88:103], v[104:107], v[152:155], v[88:103]
    ds_read_b128 v[124:127], v58 offset:2240
    ds_read_b128 v[172:175], v59 offset:2352
    s_waitcnt lgkmcnt(8)
    v_mfma_f32_32x32x16_bf16 v[88:103], v[108:111], v[156:159], v[88:103]
    ds_read_b128 v[104:107], v58 offset:2272
    ds_read_b128 v[152:155], v59 offset:2320
    s_waitcnt lgkmcnt(8)
    v_mfma_f32_32x32x16_bf16 v[88:103], v[112:115], v[160:163], v[88:103]
    ds_read_b128 v[108:111], v58 offset:2304
    ds_read_b128 v[156:159], v59 offset:2272
    s_waitcnt lgkmcnt(8)
    v_mfma_f32_32x32x16_bf16 v[88:103], v[116:119], v[164:167], v[88:103]
    ds_read_b128 v[112:115], v58 offset:2336
    ds_read_b128 v[160:163], v59 offset:2240
    s_waitcnt lgkmcnt(8)
    v_mfma_f32_32x32x16_bf16 v[88:103], v[120:123], v[168:171], v[88:103]
    ds_read_b128 v[116:119], v58 offset:2368
    ds_read_b128 v[164:167], v59 offset:2192
    s_waitcnt lgkmcnt(8)
    v_mfma_f32_32x32x16_bf16 v[88:103], v[124:127], v[172:175], v[88:103]
    ds_read_b128 v[120:123], v58 offset:2400
    ds_read_b128 v[168:171], v59 offset:2160
    s_waitcnt lgkmcnt(8)
    v_mfma_f32_32x32x16_bf16 v[88:103], v[104:107], v[152:155], v[88:103]
    ds_read_b128 v[124:127], v58 offset:2432
    ds_read_b128 v[172:175], v59 offset:2112
    s_waitcnt lgkmcnt(8)
    v_mfma_f32_32x32x16_bf16 v[88:103], v[108:111], v[156:159], v[88:103]
    ds_read_b128 v[104:107], v58 offset:2464
    ds_read_b128 v[152:155], v59 offset:2080
    s_waitcnt lgkmcnt(8)
    v_mfma_f32_32x32x16_bf16 v[88:103], v[112:115], v[160:163], v[88:103]
    ds_read_b128 v[108:111], v58 offset:2496
    ds_read_b128 v[156:159], v59 offset:2032
    s_waitcnt lgkmcnt(8)
    v_mfma_f32_32x32x16_bf16 v[88:103], v[116:119], v[164:167], v[88:103]
    s_waitcnt lgkmcnt(6)
    v_mfma_f32_32x32x16_bf16 v[88:103], v[120:123], v[168:171], v[88:103]
    s_waitcnt lgkmcnt(4)
    v_mfma_f32_32x32x16_bf16 v[88:103], v[124:127], v[172:175], v[88:103]
    s_waitcnt lgkmcnt(2)
    v_mfma_f32_32x32x16_bf16 v[88:103], v[104:107], v[152:155], v[88:103]
    s_waitcnt lgkmcnt(0)
    v_mfma_f32_32x32x16_bf16 v[88:103], v[108:111], v[156:159], v[88:103]
    ds_write_b128 v70, v[72:75] offset:9216
    ds_write_b128 v70, v[76:79] offset:9248
    ds_write_b128 v70, v[80:83] offset:9280
    ds_write_b128 v70, v[84:87] offset:9312
    s_nop 7
    ds_write_b128 v70, v[88:91] offset:23040
    ds_write_b128 v70, v[92:95] offset:23072
    ds_write_b128 v70, v[96:99] offset:23104
    ds_write_b128 v70, v[100:103] offset:23136
    s_branch c_pw_end_12
c_pw_15:
    ds_read_b128 v[104:107], v58 offset:2528
    ds_read_b128 v[152:155], v59 offset:2000
    ds_read_b128 v[108:111], v58 offset:2560
    ds_read_b128 v[156:159], v59 offset:1952
    ds_read_b128 v[112:115], v58 offset:2592
    ds_read_b128 v[160:163], v59 offset:1920
    ds_read_b128 v[116:119], v58 offset:2624
    ds_read_b128 v[164:167], v59 offset:1872
    ds_read_b128 v[120:123], v58 offset:2656
    ds_read_b128 v[168:171], v59 offset:1840
    s_waitcnt lgkmcnt(8)
    v_mfma_f32_32x32x16_bf16 v[88:103], v[104:107], v[152:155], 0
    ds_read_b128 v[124:127], v58 offset:2688
    ds_read_b128 v[172:175], v59 offset:1792
    s_waitcnt lgkmcnt(8)
    v_mfma_f32_32x32x16_bf16 v[88:103], v[108:111], v[156:159], v[88:103]
    ds_read_b128 v[104:107], v58 offset:2720
    ds_read_b128 v[152:155], v59 offset:1760
    s_waitcnt lgkmcnt(8)
    v_mfma_f32_32x32x16_bf16 v[88:103], v[112:115], v[160:163], v[88:103]
    ds_read_b128 v[108:111], v58 offset:2752
    ds_read_b128 v[156:159], v59 offset:1712
    s_waitcnt lgkmcnt(8)
    v_mfma_f32_32x32x16_bf16 v[88:103], v[116:119], v[164:167], v[88:103]
    ds_read_b128 v[112:115], v58 offset:2784
    ds_read_b128 v[160:163], v59 offset:1680
    s_waitcnt lgkmcnt(8)
    v_mfma_f32_32x32x16_bf16 v[88:103], v[120:123], v[168:171], v[88:103]
    ds_read_b128 v[116:119], v58 offset:2816
    ds_read_b128 v[164:167], v59 offset:1632
    s_waitcnt lgkmcnt(8)
    v_mfma_f32_32x32x16_bf16 v[88:103], v[124:127], v[172:175], v[88:103]
    ds_read_b128 v[120:123], v58 offset:2848
    ds_read_b128 v[168:171], v59 offset:1600
    s_waitcnt lgkmcnt(8)
    v_mfma_f32_32x32x16_bf16 v[88:103], v[104:107], v[152:155], v[88:103]
    ds_read_b128 v[124:127], v58 offset:2880
    ds_read_b128 v[172:175], v59 offset:1552
    s_waitcnt lgkmcnt(8)
    v_mfma_f32_32x32x16_bf16 v[88:103], v[108:111], v[156:159], v[88:103]
    ds_read_b128 v[104:107], v58 offset:2912
    ds_read_b128 v[152:155], v59 offset:1520
    s_waitcnt lgkmcnt(8)
    v_mfma_f32_32x32x16_bf16 v[88:103], v[112:115], v[160:163], v[88:103]
    ds_read_b128 v[108:111], v58 offset:2944
    ds_read_b128 v[156:159], v59 offset:1472
    s_waitcnt lgkmcnt(8)
    v_mfma_f32_32x32x16_bf16 v[88:103], v[116:119], v[164:167], v[88:103]
    ds_read_b128 v[112:115], v58 offset:2976
    ds_read_b128 v[160:163], v59 offset:1440
    s_waitcnt lgkmcnt(8)
    v_mfma_f32_32x32x16_bf16 v[88:103], v[120:123], v[168:171], v[88:103]
    ds_read_b128 v[116:119], v58 offset:3008
    ds_read_b128 v[164:167], v59 offset:1392
    s_waitcnt lgkmcnt(8)
    v_mfma_f32_32x32x16_bf16 v[88:103], v[124:127], v[172:175], v[88:103]
    ds_read_b128 v[120:123], v58 offset:3040
    ds_read_b128 v[168:171], v59 offset:1360
    s_waitcnt lgkmcnt(8)
    v_mfma_f32_32x32x16_bf16 v[88:103], v[104:107], v[152:155], v[88:103]
    ds_read_b128 v[124:127], v58 offset:3072
    ds_read_b128 v[172:175], v59 offset:1312
    s_waitcnt lgkmcnt(8)
    v_mfma_f32_32x32x16_bf16 v[88:103], v[108:111], v[156:159], v[88:103]
    ds_read_b128 v[104:107], v58 offset:3104
    ds_read_b128 v[152:155], v59 offset:1280
    s_waitcnt lgkmcnt(8)
    v_mfma_f32_32x32x16_bf16 v[88:103], v[112:115], v[160:163], v[88:103]
    ds_read_b128 v[108:111], v58 offset:3136
    ds_read_b128 v[156:159], v59 offset:1232
    s_waitcnt lgkmcnt(8)
    v_mfma_f32_32x32x16_bf16 v[88:103], v[116:119], v[164:167], v[88:103]
    ds_read_b128 v[112:115], v58 offset:3168
    ds_read_b128 v[160:163], v59 offset:1200
    s_waitcnt lgkmcnt(8)
    v_mfma_f32_32x32x16_bf16 v[88:103], v[120:123], v[168:171], v[88:103]
    ds_read_b128 v[116:119], v58 offset:3200
    ds_read_b128 v[164:167], v59 offset:1152
    s_waitcnt lgkmcnt(8)
    v_mfma_f32_32x32x16_bf16 v[88:103], v[124:127], v[172:175], v[88:103]
    ds_read_b128 v[120:123], v58 offset:3232
    ds_read_b128 v[168:171], v59 offset:1120
    s_waitcnt lgkmcnt(8)
    v_mfma_f32_32x32x16_bf16 v[88:103], v[104:107], v[152:155], v[88:103]
    ds_read_b128 v[124:127], v58 offset:3264
    ds_read_b128 v[172:175], v59 offset:1072
    s_waitcnt lgkmcnt(8)
    v_mfma_f32_32x32x16_bf16 v[88:103], v[108:111], v[156:159], v[88:103]
    ds_read_b128 v[104:107], v58 offset:3296
    ds_read_b128 v[152:155], v59 offset:1040
    s_waitcnt lgkmcnt(8)
    v_mfma_f32_32x32x16_bf16 v[88:103], v[112:115], v[160:163], v[88:103]
    ds_read_b128 v[108:111], v58 offset:3328
    ds_read_b128 v[156:159], v59 offset:992
    s_waitcnt lgkmcnt(8)
    v_mfma_f32_32x32x16_bf16 v[88:103], v[116:119], v[164:167], v[88:103]
    ds_read_b128 v[112:115], v58 offset:3360
    ds_read_b128 v[160:163], v59 offset:960
    s_waitcnt lgkmcnt(8)
    v_mfma_f32_32x32x16_bf16 v[88:103], v[120:123], v[168:171], v[88:103]
    ds_read_b128 v[116:119], v58 offset:3392
    ds_read_b128 v[164:167], v59 offset:912
    s_waitcnt lgkmcnt(8)
    v_mfma_f32_32x32x16_bf16 v[88:103], v[124:127], v[172:175], v[88:103]
    ds_read_b128 v[120:123], v58 offset:3424
    ds_read_b128 v[168:171], v59 offset:880
    s_waitcnt lgkmcnt(8)
    v_mfma_f32_32x32x16_bf16 v[88:103], v[104:107], v[152:155], v[88:103]
    ds_read_b128 v[124:127], v58 offset:3456
    ds_read_b128 v[172:175], v59 offset:832
    s_waitcnt lgkmcnt(8)
    v_mfma_f32_32x32x16_bf16 v[88:103], v[108:111], v[156:159], v[88:103]
    ds_read_b128 v[104:107], v58 offset:3488
    ds_read_b128 v[152:155], v59 offset:800
    s_waitcnt lgkmcnt(8)
    v_mfma_f32_32x32x16_bf16 v[88:103], v[112:115], v[160:163], v[88:103]
    ds_read_b128 v[108:111], v58 offset:3520
    ds_read_b128 v[156:159], v59 offset:752
    s_waitcnt lgkmcnt(8)
    v_mfma_f32_32x32x16_bf16 v[88:103], v[116:119], v[164:167], v[88:103]
    ds_read_b128 v[112:115], v58 offset:3552
    ds_read_b128 v[160:163], v59 offset:720
    s_waitcnt lgkmcnt(8)
    v_mfma_f32_32x32x16_bf16 v[88:103], v[120:123], v[168:171], v[88:103]
    ds_read_b128 v[116:119], v58 offset:3584
    ds_read_b128 v[164:167], v59 offset:672
    s_waitcnt lgkmcnt(8)
    v_mfma_f32_32x32x16_bf16 v[88:103], v[124:127], v[172:175], v[88:103]
    ds_read_b128 v[120:123], v58 offset:3616
    ds_read_b128 v[168:171], v59 offset:640
    s_waitcnt lgkmcnt(8)
    v_mfma_f32_32x32x16_bf16 v[88:103], v[104:107], v[152:155], v[88:103]
    ds_read_b128 v[124:127], v58 offset:3648
    ds_read_b128 v[172:175], v59 offset:592
    s_waitcnt lgkmcnt(8)
    v_mfma_f32_32x32x16_bf16 v[88:103], v[108:111], v[156:159], v[88:103]
    ds_read_b128 v[104:107], v58 offset:3680
    ds_read_b128 v[152:155], v59 offset:560
    s_waitcnt lgkmcnt(8)
    v_mfma_f32_32x32x16_bf16 v[88:103], v[112:115], v[160:163], v[88:103]
    ds_read_b128 v[108:111], v58 offset:3712
    ds_read_b128 v[156:159], v59 offset:512
    s_waitcnt lgkmcnt(8)
    v_mfma_f32_32x32x16_bf16 v[88:103], v[116:119], v[164:167], v[88:103]
    ds_read_b128 v[112:115], v58 offset:3744
    ds_read_b128 v[160:163], v59 offset:480
    s_waitcnt lgkmcnt(8)
    v_mfma_f32_32x32x16_bf16 v[88:103], v[120:123], v[168:171], v[88:103]
    ds_read_b128 v[116:119], v58 offset:3776
    ds_read_b128 v[164:167], v59 offset:432
    s_waitcnt lgkmcnt(8)
    v_mfma_f32_32x32x16_bf16 v[88:103], v[124:127], v[172:175], v[88:103]
    ds_read_b128 v[120:123], v58 offset:3808
    ds_read_b128 v[168:171], v59 offset:400
    s_waitcnt lgkmcnt(8)
    v_mfma_f32_32x32x16_bf16 v[88:103], v[104:107], v[152:155], v[88:103]
    ds_read_b128 v[124:127], v58 offset:3840
    ds_read_b128 v[172:175], v59 offset:352
    s_waitcnt lgkmcnt(8)
    v_mfma_f32_32x32x16_bf16 v[88:103], v[108:111], v[156:159], v[88:103]
    ds_read_b128 v[104:107], v58 offset:3872
    ds_read_b128 v[152:155], v59 offset:320
    s_waitcnt lgkmcnt(8)
    v_mfma_f32_32x32x16_bf16 v[88:103], v[112:115], v[160:163], v[88:103]
    ds_read_b128 v[108:111], v58 offset:3904
    ds_read_b128 v[156:159], v59 offset:272
    s_waitcnt lgkmcnt(8)
    v_mfma_f32_32x32x16_bf16 v[88:103], v[116:119], v[164:167], v[88:103]
    ds_read_b128 v[112:115], v58 offset:3936
    ds_read_b128 v[160:163], v59 offset:240
    s_waitcnt lgkmcnt(8)
    v_mfma_f32_32x32x16_bf16 v[88:103], v[120:123], v[168:171], v[88:103]
    ds_read_b128 v[116:119], v58 offset:3968
    ds_read_b128 v[164:167], v59 offset:192
    s_waitcnt lgkmcnt(8)
    v_mfma_f32_32x32x16_bf16 v[88:103], v[124:127], v[172:175], v[88:103]
    ds_read_b128 v[120:123], v58 offset:4000
    ds_read_b128 v[168:171], v59 offset:160
    s_waitcnt lgkmcnt(8)
    v_mfma_f32_32x32x16_bf16 v[88:103], v[104:107], v[152:155], v[88:103]
    ds_read_b128 v[124:127], v58 offset:4032
    ds_read_b128 v[172:175], v59 offset:112
    s_waitcnt lgkmcnt(8)
    v_mfma_f32_32x32x16_bf16 v[88:103], v[108:111], v[156:159], v[88:103]
    ds_read_b128 v[104:107], v58 offset:4064
    ds_read_b128 v[152:155], v59 offset:80
    s_waitcnt lgkmcnt(8)
    v_mfma_f32_32x32x16_bf16 v[88:103], v[112:115], v[160:163], v[88:103]
    s_waitcnt lgkmcnt(6)
    v_mfma_f32_32x32x16_bf16 v[88:103], v[116:119], v[164:167], v[88:103]
    s_waitcnt lgkmcnt(4)
    v_mfma_f32_32x32x16_bf16 v[88:103], v[120:123], v[168:171], v[88:103]
    s_waitcnt lgkmcnt(2)
    v_mfma_f32_32x32x16_bf16 v[88:103], v[124:127], v[172:175], v[88:103]
    s_waitcnt lgkmcnt(0)
    v_mfma_f32_32x32x16_bf16 v[88:103], v[104:107], v[152:155], v[88:103]
    s_nop 11
    ds_write_b128 v70, v[88:91] offset:27648
    ds_write_b128 v70, v[92:95] offset:27680
    ds_write_b128 v70, v[96:99] offset:27712
    ds_write_b128 v70, v[100:103] offset:27744
c_pw_end_12:
    s_waitcnt lgkmcnt(0)
    s_barrier
    s_cmp_ge_u32 s34, 2
    s_cbranch_scc1 c_finH_17
    ds_read_b128 v[104:107], v71 offset:0
    ds_read_b128 v[108:111], v71 offset:16
    ds_read_b128 v[112:115], v71 offset:4608
    ds_read_b128 v[116:119], v71 offset:4624
    ds_read_b128 v[120:123], v71 offset:9216
    ds_read_b128 v[124:127], v71 offset:9232
    s_waitcnt lgkmcnt(0)
    v_pk_add_f32 v[104:105], v[104:105], v[112:113]
    v_pk_add_f32 v[106:107], v[106:107], v[114:115]
    v_pk_add_f32 v[108:109], v[108:109], v[116:117]
    v_pk_add_f32 v[110:111], v[110:111], v[118:119]
    v_pk_add_f32 v[104:105], v[104:105], v[120:121]
    v_pk_add_f32 v[106:107], v[106:107], v[122:123]
    v_pk_add_f32 v[108:109], v[108:109], v[124:125]
    v_pk_add_f32 v[110:111], v[110:111], v[126:127]
    v_cvt_pk_bf16_f32 v184, v104, v105
    v_cvt_pk_bf16_f32 v185, v106, v107
    v_cvt_pk_bf16_f32 v186, v108, v109
    v_cvt_pk_bf16_f32 v187, v110, v111
    s_lshl_b32 s40, s56, 12
    s_add_u32 s40, s40, 8912896
    v_and_b32 v3, 127, v0
    v_lshlrev_b32 v3, 4, v3
    buffer_store_dwordx4 v[184:187], v3, s[8:11], s40 offen sc1
    s_nop 1
    s_branch c_fin_end_18
c_finH_17:
    ds_read_b128 v[104:107], v71 offset:13824
    ds_read_b128 v[108:111], v71 offset:13840
    ds_read_b128 v[112:115], v71 offset:18432
    ds_read_b128 v[116:119], v71 offset:18448
    ds_read_b128 v[120:123], v71 offset:23040
    ds_read_b128 v[124:127], v71 offset:23056
    ds_read_b128 v[128:131], v71 offset:27648
    ds_read_b128 v[132:135], v71 offset:27664
    s_waitcnt lgkmcnt(0)
    v_pk_add_f32 v[104:105], v[104:105], v[112:113]
    v_pk_add_f32 v[106:107], v[106:107], v[114:115]
    v_pk_add_f32 v[108:109], v[108:109], v[116:117]
    v_pk_add_f32 v[110:111], v[110:111], v[118:119]
    v_pk_add_f32 v[104:105], v[104:105], v[120:121]
    v_pk_add_f32 v[106:107], v[106:107], v[122:123]
    v_pk_add_f32 v[108:109], v[108:109], v[124:125]
    v_pk_add_f32 v[110:111], v[110:111], v[126:127]
    v_pk_add_f32 v[104:105], v[104:105], v[128:129]
    v_pk_add_f32 v[106:107], v[106:107], v[130:131]
    v_pk_add_f32 v[108:109], v[108:109], v[132:133]
    v_pk_add_f32 v[110:111], v[110:111], v[134:135]
    v_cvt_pk_bf16_f32 v184, v104, v105
    v_cvt_pk_bf16_f32 v185, v106, v107
    v_cvt_pk_bf16_f32 v186, v108, v109
    v_cvt_pk_bf16_f32 v187, v110, v111
    s_lshl_b32 s40, s56, 12
    s_add_u32 s40, s40, 8914944
    v_and_b32 v3, 127, v0
    v_lshlrev_b32 v3, 4, v3
    buffer_store_dwordx4 v[184:187], v3, s[8:11], s40 offen sc1
    s_nop 1
c_fin_end_18:
    s_waitcnt vmcnt(4)
    v_cmp_ne_u32 vcc, 0, v0
    s_nop 1
    v_cndmask_b32 v16, 0, v16, vcc
    v_cndmask_b32 v17, 0, v17, vcc
    v_cndmask_b32 v18, 0, v18, vcc
    v_cndmask_b32 v19, 0, v19, vcc
    v_alignbit_b32 v176, v17, v16, 16
    v_alignbit_b32 v177, v18, v17, 16
    v_alignbit_b32 v178, v19, v18, 16
    v_alignbit_b32 v179, v20, v19, 16
    v_alignbit_b32 v180, v21, v20, 16
    v_alignbit_b32 v181, v22, v21, 16
    v_alignbit_b32 v182, v23, v22, 16
    ds_write_b128 v56, v[176:179] offset:0
    v_mov_b32 v184, v17
    v_mov_b32 v185, v18
    v_mov_b32 v186, v19
    v_mov_b32 v187, v20
    ds_write_b128 v56, v[184:187] offset:4160
    s_nop 1
    v_mov_b32 v184, v177
    v_mov_b32 v185, v178
    v_mov_b32 v186, v179
    v_mov_b32 v187, v180
    ds_write_b128 v56, v[184:187] offset:8320
    s_nop 1
    ds_write_b128 v56, v[18:21] offset:12480
    ds_write_b128 v56, v[178:181] offset:16640
    v_mov_b32 v184, v19
    v_mov_b32 v185, v20
    v_mov_b32 v186, v21
    v_mov_b32 v187, v22
    ds_write_b128 v56, v[184:187] offset:20800
    s_nop 1
    v_mov_b32 v184, v179
    v_mov_b32 v185, v180
    v_mov_b32 v186, v181
    v_mov_b32 v187, v182
    ds_write_b128 v56, v[184:187] offset:24960
    s_nop 1
    ds_write_b128 v56, v[20:23] offset:29120
    ds_write_b128 v57, v[36:39]
    v_lshlrev_b32 v3, 16, v45
    v_or_b32 v3, v3, v45
    v_and_b32 v188, v60, v3
    v_and_b32 v189, v61, v3
    v_and_b32 v190, v62, v3
    v_and_b32 v191, v63, v3
    v_and_b32 v192, v64, v3
    v_and_b32 v193, v65, v3
    v_and_b32 v194, v66, v3
    v_and_b32 v195, v67, v3
    s_waitcnt lgkmcnt(0)
    s_barrier
    s_cmp_lg_u32 s34, 0
    s_cbranch_scc1 c_pw_20
    ds_read_b128 v[104:107], v58 offset:0
    ds_read_b128 v[128:131], v59 offset:2592
    ds_read_b128 v[152:155], v59 offset:5152
    ds_read_b128 v[108:111], v58 offset:32
    ds_read_b128 v[132:135], v59 offset:2560
    ds_read_b128 v[156:159], v59 offset:5120
    ds_read_b128 v[112:115], v58 offset:64
    ds_read_b128 v[136:139], v59 offset:2512
    ds_read_b128 v[160:163], v59 offset:5072
    ds_read_b128 v[116:119], v58 offset:96
    ds_read_b128 v[140:143], v59 offset:2480
    ds_read_b128 v[164:167], v59 offset:5040
    ds_read_b128 v[120:123], v58 offset:128
    ds_read_b128 v[144:147], v59 offset:2432
    ds_read_b128 v[168:171], v59 offset:4992
    s_waitcnt lgkmcnt(12)
    v_mfma_f32_32x32x16_bf16 v[72:87], v[104:107], v[128:131], 0
    v_mfma_f32_32x32x16_bf16 v[88:103], v[104:107], v[152:155], 0
    v_mfma_f32_32x32x16_bf16 v[72:87], v[192:195], v[128:131], v[72:87]
    v_mfma_f32_32x32x16_bf16 v[88:103], v[192:195], v[152:155], v[88:103]
    ds_read_b128 v[124:127], v58 offset:160
    ds_read_b128 v[148:151], v59 offset:2400
    ds_read_b128 v[172:175], v59 offset:4960
    s_waitcnt lgkmcnt(12)
    v_mfma_f32_32x32x16_bf16 v[72:87], v[108:111], v[132:135], v[72:87]
    v_mfma_f32_32x32x16_bf16 v[88:103], v[108:111], v[156:159], v[88:103]
    v_mfma_f32_32x32x16_bf16 v[72:87], v[188:191], v[132:135], v[72:87]
    v_mfma_f32_32x32x16_bf16 v[88:103], v[188:191], v[156:159], v[88:103]
    ds_read_b128 v[104:107], v58 offset:192
    ds_read_b128 v[128:131], v59 offset:2352
    ds_read_b128 v[152:155], v59 offset:4912
    s_waitcnt lgkmcnt(12)
    v_mfma_f32_32x32x16_bf16 v[72:87], v[112:115], v[136:139], v[72:87]
    v_mfma_f32_32x32x16_bf16 v[88:103], v[112:115], v[160:163], v[88:103]
    ds_read_b128 v[108:111], v58 offset:224
    ds_read_b128 v[132:135], v59 offset:2320
    ds_read_b128 v[156:159], v59 offset:4880
    s_waitcnt lgkmcnt(12)
    v_mfma_f32_32x32x16_bf16 v[72:87], v[116:119], v[140:143], v[72:87]
    v_mfma_f32_32x32x16_bf16 v[88:103], v[116:119], v[164:167], v[88:103]
    ds_read_b128 v[112:115], v58 offset:256
    ds_read_b128 v[136:139], v59 offset:2272
    ds_read_b128 v[160:163], v59 offset:4832
    s_waitcnt lgkmcnt(12)
    v_mfma_f32_32x32x16_bf16 v[72:87], v[120:123], v[144:147], v[72:87]
    v_mfma_f32_32x32x16_bf16 v[88:103], v[120:123], v[168:171], v[88:103]
    ds_read_b128 v[116:119], v58 offset:288
    ds_read_b128 v[140:143], v59 offset:2240
    ds_read_b128 v[164:167], v59 offset:4800
    s_waitcnt lgkmcnt(12)
    v_mfma_f32_32x32x16_bf16 v[72:87], v[124:127], v[148:151], v[72:87]
    v_mfma_f32_32x32x16_bf16 v[88:103], v[124:127], v[172:175], v[88:103]
    ds_read_b128 v[120:123], v58 offset:320
    ds_read_b128 v[144:147], v59 offset:2192
    ds_read_b128 v[168:171], v59 offset:4752
    s_waitcnt lgkmcnt(12)
    v_mfma_f32_32x32x16_bf16 v[72:87], v[104:107], v[128:131], v[72:87]
    v_mfma_f32_32x32x16_bf16 v[88:103], v[104:107], v[152:155], v[88:103]
    ds_read_b128 v[124:127], v58 offset:352
    ds_read_b128 v[148:151], v59 offset:2160
    ds_read_b128 v[172:175], v59 offset:4720
    s_waitcnt lgkmcnt(12)
    v_mfma_f32_32x32x16_bf16 v[72:87], v[108:111], v[132:135], v[72:87]
    v_mfma_f32_32x32x16_bf16 v[88:103], v[108:111], v[156:159], v[88:103]
    ds_read_b128 v[104:107], v58 offset:384
    ds_read_b128 v[128:131], v59 offset:2112
    ds_read_b128 v[152:155], v59 offset:4672
    s_waitcnt lgkmcnt(12)
    v_mfma_f32_32x32x16_bf16 v[72:87], v[112:115], v[136:139], v[72:87]
    v_mfma_f32_32x32x16_bf16 v[88:103], v[112:115], v[160:163], v[88:103]
    ds_read_b128 v[108:111], v58 offset:416
    ds_read_b128 v[132:135], v59 offset:2080
    ds_read_b128 v[156:159], v59 offset:4640
    s_waitcnt lgkmcnt(12)
    v_mfma_f32_32x32x16_bf16 v[72:87], v[116:119], v[140:143], v[72:87]
    v_mfma_f32_32x32x16_bf16 v[88:103], v[116:119], v[164:167], v[88:103]
    ds_read_b128 v[112:115], v58 offset:448
    ds_read_b128 v[136:139], v59 offset:2032
    ds_read_b128 v[160:163], v59 offset:4592
    s_waitcnt lgkmcnt(12)
    v_mfma_f32_32x32x16_bf16 v[72:87], v[120:123], v[144:147], v[72:87]
    v_mfma_f32_32x32x16_bf16 v[88:103], v[120:123], v[168:171], v[88:103]
    ds_read_b128 v[116:119], v58 offset:480
    ds_read_b128 v[140:143], v59 offset:2000
    ds_read_b128 v[164:167], v59 offset:4560
    s_waitcnt lgkmcnt(12)
    v_mfma_f32_32x32x16_bf16 v[72:87], v[124:127], v[148:151], v[72:87]
    v_mfma_f32_32x32x16_bf16 v[88:103], v[124:127], v[172:175], v[88:103]
    ds_read_b128 v[120:123], v58 offset:512
    ds_read_b128 v[144:147], v59 offset:1952
    ds_read_b128 v[168:171], v59 offset:4512
    s_waitcnt lgkmcnt(12)
    v_mfma_f32_32x32x16_bf16 v[72:87], v[104:107], v[128:131], v[72:87]
    v_mfma_f32_32x32x16_bf16 v[88:103], v[104:107], v[152:155], v[88:103]
    ds_read_b128 v[124:127], v58 offset:544
    ds_read_b128 v[148:151], v59 offset:1920
    ds_read_b128 v[172:175], v59 offset:4480
    s_waitcnt lgkmcnt(12)
    v_mfma_f32_32x32x16_bf16 v[72:87], v[108:111], v[132:135], v[72:87]
    v_mfma_f32_32x32x16_bf16 v[88:103], v[108:111], v[156:159], v[88:103]
    ds_read_b128 v[104:107], v58 offset:576
    ds_read_b128 v[128:131], v59 offset:1872
    ds_read_b128 v[152:155], v59 offset:4432
    s_waitcnt lgkmcnt(12)
    v_mfma_f32_32x32x16_bf16 v[72:87], v[112:115], v[136:139], v[72:87]
    v_mfma_f32_32x32x16_bf16 v[88:103], v[112:115], v[160:163], v[88:103]
    ds_read_b128 v[108:111], v58 offset:608
    ds_read_b128 v[132:135], v59 offset:1840
    ds_read_b128 v[156:159], v59 offset:4400
    s_waitcnt lgkmcnt(12)
    v_mfma_f32_32x32x16_bf16 v[72:87], v[116:119], v[140:143], v[72:87]
    v_mfma_f32_32x32x16_bf16 v[88:103], v[116:119], v[164:167], v[88:103]
    ds_read_b128 v[112:115], v58 offset:640
    ds_read_b128 v[136:139], v59 offset:1792
    ds_read_b128 v[160:163], v59 offset:4352
    s_waitcnt lgkmcnt(12)
    v_mfma_f32_32x32x16_bf16 v[72:87], v[120:123], v[144:147], v[72:87]
    v_mfma_f32_32x32x16_bf16 v[88:103], v[120:123], v[168:171], v[88:103]
    ds_read_b128 v[116:119], v58 offset:672
    ds_read_b128 v[140:143], v59 offset:1760
    ds_read_b128 v[164:167], v59 offset:4320
    s_waitcnt lgkmcnt(12)
    v_mfma_f32_32x32x16_bf16 v[72:87], v[124:127], v[148:151], v[72:87]
    v_mfma_f32_32x32x16_bf16 v[88:103], v[124:127], v[172:175], v[88:103]
    ds_read_b128 v[120:123], v58 offset:704
    ds_read_b128 v[144:147], v59 offset:1712
    ds_read_b128 v[168:171], v59 offset:4272
    s_waitcnt lgkmcnt(12)
    v_mfma_f32_32x32x16_bf16 v[72:87], v[104:107], v[128:131], v[72:87]
    v_mfma_f32_32x32x16_bf16 v[88:103], v[104:107], v[152:155], v[88:103]
    s_waitcnt lgkmcnt(9)
    v_mfma_f32_32x32x16_bf16 v[72:87], v[108:111], v[132:135], v[72:87]
    v_mfma_f32_32x32x16_bf16 v[88:103], v[108:111], v[156:159], v[88:103]
    s_waitcnt lgkmcnt(6)
    v_mfma_f32_32x32x16_bf16 v[72:87], v[112:115], v[136:139], v[72:87]
    v_mfma_f32_32x32x16_bf16 v[88:103], v[112:115], v[160:163], v[88:103]
    s_waitcnt lgkmcnt(3)
    v_mfma_f32_32x32x16_bf16 v[72:87], v[116:119], v[140:143], v[72:87]
    v_mfma_f32_32x32x16_bf16 v[88:103], v[116:119], v[164:167], v[88:103]
    s_waitcnt lgkmcnt(0)
    v_mfma_f32_32x32x16_bf16 v[72:87], v[120:123], v[144:147], v[72:87]
    v_mfma_f32_32x32x16_bf16 v[88:103], v[120:123], v[168:171], v[88:103]
    s_nop 10
    ds_write_b128 v70, v[72:75] offset:0
    ds_write_b128 v70, v[76:79] offset:32
    ds_write_b128 v70, v[80:83] offset:64
    ds_write_b128 v70, v[84:87] offset:96
    ds_write_b128 v70, v[88:91] offset:13824
    ds_write_b128 v70, v[92:95] offset:13856
    ds_write_b128 v70, v[96:99] offset:13888
    ds_write_b128 v70, v[100:103] offset:13920
    s_branch c_pw_end_19
c_pw_20:
    s_cmp_lg_u32 s34, 1
    s_cbranch_scc1 c_pw_21
    ds_read_b128 v[104:107], v58 offset:736
    ds_read_b128 v[128:131], v59 offset:1680
    ds_read_b128 v[152:155], v59 offset:4240
    ds_read_b128 v[108:111], v58 offset:768
    ds_read_b128 v[132:135], v59 offset:1632
    ds_read_b128 v[156:159], v59 offset:4192
    ds_read_b128 v[112:115], v58 offset:800
    ds_read_b128 v[136:139], v59 offset:1600
    ds_read_b128 v[160:163], v59 offset:4160
    ds_read_b128 v[116:119], v58 offset:832
    ds_read_b128 v[140:143], v59 offset:1552
    ds_read_b128 v[164:167], v59 offset:4112
    ds_read_b128 v[120:123], v58 offset:864
    ds_read_b128 v[144:147], v59 offset:1520
    ds_read_b128 v[168:171], v59 offset:4080
    s_waitcnt lgkmcnt(12)
    v_mfma_f32_32x32x16_bf16 v[72:87], v[104:107], v[128:131], 0
    v_mfma_f32_32x32x16_bf16 v[88:103], v[104:107], v[152:155], 0
    ds_read_b128 v[124:127], v58 offset:896
    ds_read_b128 v[148:151], v59 offset:1472
    ds_read_b128 v[172:175], v59 offset:4032
    s_waitcnt lgkmcnt(12)
    v_mfma_f32_32x32x16_bf16 v[72:87], v[108:111], v[132:135], v[72:87]
    v_mfma_f32_32x32x16_bf16 v[88:103], v[108:111], v[156:159], v[88:103]
    ds_read_b128 v[104:107], v58 offset:928
    ds_read_b128 v[128:131], v59 offset:1440
    ds_read_b128 v[152:155], v59 offset:4000
    s_waitcnt lgkmcnt(12)
    v_mfma_f32_32x32x16_bf16 v[72:87], v[112:115], v[136:139], v[72:87]
    v_mfma_f32_32x32x16_bf16 v[88:103], v[112:115], v[160:163], v[88:103]
    ds_read_b128 v[108:111], v58 offset:960
    ds_read_b128 v[132:135], v59 offset:1392
    ds_read_b128 v[156:159], v59 offset:3952
    s_waitcnt lgkmcnt(12)
    v_mfma_f32_32x32x16_bf16 v[72:87], v[116:119], v[140:143], v[72:87]
    v_mfma_f32_32x32x16_bf16 v[88:103], v[116:119], v[164:167], v[88:103]
    ds_read_b128 v[112:115], v58 offset:992
    ds_read_b128 v[136:139], v59 offset:1360
    ds_read_b128 v[160:163], v59 offset:3920
    s_waitcnt lgkmcnt(12)
    v_mfma_f32_32x32x16_bf16 v[72:87], v[120:123], v[144:147], v[72:87]
    v_mfma_f32_32x32x16_bf16 v[88:103], v[120:123], v[168:171], v[88:103]
    ds_read_b128 v[116:119], v58 offset:1024
    ds_read_b128 v[140:143], v59 offset:1312
    ds_read_b128 v[164:167], v59 offset:3872
    s_waitcnt lgkmcnt(12)
    v_mfma_f32_32x32x16_bf16 v[72:87], v[124:127], v[148:151], v[72:87]
    v_mfma_f32_32x32x16_bf16 v[88:103], v[124:127], v[172:175], v[88:103]
    ds_read_b128 v[120:123], v58 offset:1056
    ds_read_b128 v[144:147], v59 offset:1280
    ds_read_b128 v[168:171], v59 offset:3840
    s_waitcnt lgkmcnt(12)
    v_mfma_f32_32x32x16_bf16 v[72:87], v[104:107], v[128:131], v[72:87]
    v_mfma_f32_32x32x16_bf16 v[88:103], v[104:107], v[152:155], v[88:103]
    ds_read_b128 v[124:127], v58 offset:1088
    ds_read_b128 v[148:151], v59 offset:1232
    ds_read_b128 v[172:175], v59 offset:3792
    s_waitcnt lgkmcnt(12)
    v_mfma_f32_32x32x16_bf16 v[72:87], v[108:111], v[132:135], v[72:87]
    v_mfma_f32_32x32x16_bf16 v[88:103], v[108:111], v[156:159], v[88:103]
    ds_read_b128 v[104:107], v58 offset:1120
    ds_read_b128 v[128:131], v59 offset:1200
    ds_read_b128 v[152:155], v59 offset:3760
    s_waitcnt lgkmcnt(12)
    v_mfma_f32_32x32x16_bf16 v[72:87], v[112:115], v[136:139], v[72:87]
    v_mfma_f32_32x32x16_bf16 v[88:103], v[112:115], v[160:163], v[88:103]
    ds_read_b128 v[108:111], v58 offset:1152
    ds_read_b128 v[132:135], v59 offset:1152
    ds_read_b128 v[156:159], v59 offset:3712
    s_waitcnt lgkmcnt(12)
    v_mfma_f32_32x32x16_bf16 v[72:87], v[116:119], v[140:143], v[72:87]
    v_mfma_f32_32x32x16_bf16 v[88:103], v[116:119], v[164:167], v[88:103]
    ds_read_b128 v[112:115], v58 offset:1184
    ds_read_b128 v[136:139], v59 offset:1120
    ds_read_b128 v[160:163], v59 offset:3680
    s_waitcnt lgkmcnt(12)
    v_mfma_f32_32x32x16_bf16 v[72:87], v[120:123], v[144:147], v[72:87]
    v_mfma_f32_32x32x16_bf16 v[88:103], v[120:123], v[168:171], v[88:103]
    ds_read_b128 v[116:119], v58 offset:1216
    ds_read_b128 v[140:143], v59 offset:1072
    ds_read_b128 v[164:167], v59 offset:3632
    s_waitcnt lgkmcnt(12)
    v_mfma_f32_32x32x16_bf16 v[72:87], v[124:127], v[148:151], v[72:87]
    v_mfma_f32_32x32x16_bf16 v[88:103], v[124:127], v[172:175], v[88:103]
    ds_read_b128 v[120:123], v58 offset:1248
    ds_read_b128 v[144:147], v59 offset:1040
    ds_read_b128 v[168:171], v59 offset:3600
    s_waitcnt lgkmcnt(12)
    v_mfma_f32_32x32x16_bf16 v[72:87], v[104:107], v[128:131], v[72:87]
    v_mfma_f32_32x32x16_bf16 v[88:103], v[104:107], v[152:155], v[88:103]
    ds_read_b128 v[124:127], v58 offset:1280
    ds_read_b128 v[148:151], v59 offset:992
    ds_read_b128 v[172:175], v59 offset:3552
    s_waitcnt lgkmcnt(12)
    v_mfma_f32_32x32x16_bf16 v[72:87], v[108:111], v[132:135], v[72:87]
    v_mfma_f32_32x32x16_bf16 v[88:103], v[108:111], v[156:159], v[88:103]
    ds_read_b128 v[104:107], v58 offset:1312
    ds_read_b128 v[128:131], v59 offset:960
    ds_read_b128 v[152:155], v59 offset:3520
    s_waitcnt lgkmcnt(12)
    v_mfma_f32_32x32x16_bf16 v[72:87], v[112:115], v[136:139], v[72:87]
    v_mfma_f32_32x32x16_bf16 v[88:103], v[112:115], v[160:163], v[88:103]
    ds_read_b128 v[108:111], v58 offset:1344
    ds_read_b128 v[132:135], v59 offset:912
    ds_read_b128 v[156:159], v59 offset:3472
    s_waitcnt lgkmcnt(12)
    v_mfma_f32_32x32x16_bf16 v[72:87], v[116:119], v[140:143], v[72:87]
    v_mfma_f32_32x32x16_bf16 v[88:103], v[116:119], v[164:167], v[88:103]
    ds_read_b128 v[112:115], v58 offset:1376
    ds_read_b128 v[136:139], v59 offset:880
    ds_read_b128 v[160:163], v59 offset:3440
    s_waitcnt lgkmcnt(12)
    v_mfma_f32_32x32x16_bf16 v[72:87], v[120:123], v[144:147], v[72:87]
    v_mfma_f32_32x32x16_bf16 v[88:103], v[120:123], v[168:171], v[88:103]
    ds_read_b128 v[116:119], v58 offset:1408
    ds_read_b128 v[140:143], v59 offset:832
    ds_read_b128 v[164:167], v59 offset:3392
    s_waitcnt lgkmcnt(12)
    v_mfma_f32_32x32x16_bf16 v[72:87], v[124:127], v[148:151], v[72:87]
    v_mfma_f32_32x32x16_bf16 v[88:103], v[124:127], v[172:175], v[88:103]
    ds_read_b128 v[120:123], v58 offset:1440
    ds_read_b128 v[144:147], v59 offset:800
    ds_read_b128 v[168:171], v59 offset:3360
    s_waitcnt lgkmcnt(12)
    v_mfma_f32_32x32x16_bf16 v[72:87], v[104:107], v[128:131], v[72:87]
    v_mfma_f32_32x32x16_bf16 v[88:103], v[104:107], v[152:155], v[88:103]
    ds_read_b128 v[124:127], v58 offset:1472
    ds_read_b128 v[148:151], v59 offset:752
    ds_read_b128 v[172:175], v59 offset:3312
    s_waitcnt lgkmcnt(12)
    v_mfma_f32_32x32x16_bf16 v[72:87], v[108:111], v[132:135], v[72:87]
    v_mfma_f32_32x32x16_bf16 v[88:103], v[108:111], v[156:159], v[88:103]
    s_waitcnt lgkmcnt(9)
    v_mfma_f32_32x32x16_bf16 v[72:87], v[112:115], v[136:139], v[72:87]
    v_mfma_f32_32x32x16_bf16 v[88:103], v[112:115], v[160:163], v[88:103]
    s_waitcnt lgkmcnt(6)
    v_mfma_f32_32x32x16_bf16 v[72:87], v[116:119], v[140:143], v[72:87]
    v_mfma_f32_32x32x16_bf16 v[88:103], v[116:119], v[164:167], v[88:103]
    s_waitcnt lgkmcnt(3)
    v_mfma_f32_32x32x16_bf16 v[72:87], v[120:123], v[144:147], v[72:87]
    v_mfma_f32_32x32x16_bf16 v[88:103], v[120:123], v[168:171], v[88:103]
    s_waitcnt lgkmcnt(0)
    v_mfma_f32_32x32x16_bf16 v[72:87], v[124:127], v[148:151], v[72:87]
    v_mfma_f32_32x32x16_bf16 v[88:103], v[124:127], v[172:175], v[88:103]
    s_nop 10
    ds_write_b128 v70, v[72:75] offset:4608
    ds_write_b128 v70, v[76:79] offset:4640
    ds_write_b128 v70, v[80:83] offset:4672
    ds_write_b128 v70, v[84:87] offset:4704
    ds_write_b128 v70, v[88:91] offset:18432
    ds_write_b128 v70, v[92:95] offset:18464
    ds_write_b128 v70, v[96:99] offset:18496
    ds_write_b128 v70, v[100:103] offset:18528
    s_branch c_pw_end_19
c_pw_21:
    s_cmp_lg_u32 s34, 2
    s_cbranch_scc1 c_pw_22
    ds_read_b128 v[104:107], v58 offset:1504
    ds_read_b128 v[128:131], v59 offset:720
    ds_read_b128 v[152:155], v59 offset:3280
    ds_read_b128 v[108:111], v58 offset:1536
    ds_read_b128 v[132:135], v59 offset:672
    ds_read_b128 v[156:159], v59 offset:3232
    ds_read_b128 v[112:115], v58 offset:1568
    ds_read_b128 v[136:139], v59 offset:640
    ds_read_b128 v[160:163], v59 offset:3200
    ds_read_b128 v[116:119], v58 offset:1600
    ds_read_b128 v[140:143], v59 offset:592
    ds_read_b128 v[164:167], v59 offset:3152
    ds_read_b128 v[120:123], v58 offset:1632
    ds_read_b128 v[144:147], v59 offset:560
    ds_read_b128 v[168:171], v59 offset:3120
    s_waitcnt lgkmcnt(12)
    v_mfma_f32_32x32x16_bf16 v[72:87], v[104:107], v[128:131], 0
    v_mfma_f32_32x32x16_bf16 v[88:103], v[104:107], v[152:155], 0
    ds_read_b128 v[124:127], v58 offset:1664
    ds_read_b128 v[148:151], v59 offset:512
    ds_read_b128 v[172:175], v59 offset:3072
    s_waitcnt lgkmcnt(12)
    v_mfma_f32_32x32x16_bf16 v[72:87], v[108:111], v[132:135], v[72:87]
    v_mfma_f32_32x32x16_bf16 v[88:103], v[108:111], v[156:159], v[88:103]
    ds_read_b128 v[104:107], v58 offset:1696
    ds_read_b128 v[128:131], v59 offset:480
    ds_read_b128 v[152:155], v59 offset:3040
    s_waitcnt lgkmcnt(12)
    v_mfma_f32_32x32x16_bf16 v[72:87], v[112:115], v[136:139], v[72:87]
    v_mfma_f32_32x32x16_bf16 v[88:103], v[112:115], v[160:163], v[88:103]
    ds_read_b128 v[108:111], v58 offset:1728
    ds_read_b128 v[132:135], v59 offset:432
    ds_read_b128 v[156:159], v59 offset:2992
    s_waitcnt lgkmcnt(12)
    v_mfma_f32_32x32x16_bf16 v[72:87], v[116:119], v[140:143], v[72:87]
    v_mfma_f32_32x32x16_bf16 v[88:103], v[116:119], v[164:167], v[88:103]
    ds_read_b128 v[112:115], v58 offset:1760
    ds_read_b128 v[136:139], v59 offset:400
    ds_read_b128 v[160:163], v59 offset:2960
    s_waitcnt lgkmcnt(12)
    v_mfma_f32_32x32x16_bf16 v[72:87], v[120:123], v[144:147], v[72:87]
    v_mfma_f32_32x32x16_bf16 v[88:103], v[120:123], v[168:171], v[88:103]
    ds_read_b128 v[116:119], v58 offset:1792
    ds_read_b128 v[140:143], v59 offset:352
    ds_read_b128 v[164:167], v59 offset:2912
    s_waitcnt lgkmcnt(12)
    v_mfma_f32_32x32x16_bf16 v[72:87], v[124:127], v[148:151], v[72:87]
    v_mfma_f32_32x32x16_bf16 v[88:103], v[124:127], v[172:175], v[88:103]
    ds_read_b128 v[120:123], v58 offset:1824
    ds_read_b128 v[144:147], v59 offset:320
    ds_read_b128 v[168:171], v59 offset:2880
    s_waitcnt lgkmcnt(12)
    v_mfma_f32_32x32x16_bf16 v[72:87], v[104:107], v[128:131], v[72:87]
    v_mfma_f32_32x32x16_bf16 v[88:103], v[104:107], v[152:155], v[88:103]
    ds_read_b128 v[124:127], v58 offset:1856
    ds_read_b128 v[148:151], v59 offset:272
    ds_read_b128 v[172:175], v59 offset:2832
    s_waitcnt lgkmcnt(12)
    v_mfma_f32_32x32x16_bf16 v[72:87], v[108:111], v[132:135], v[72:87]
    v_mfma_f32_32x32x16_bf16 v[88:103], v[108:111], v[156:159], v[88:103]
    ds_read_b128 v[104:107], v58 offset:1888
    ds_read_b128 v[128:131], v59 offset:240
    ds_read_b128 v[152:155], v59 offset:2800
    s_waitcnt lgkmcnt(12)
    v_mfma_f32_32x32x16_bf16 v[72:87], v[112:115], v[136:139], v[72:87]
    v_mfma_f32_32x32x16_bf16 v[88:103], v[112:115], v[160:163], v[88:103]
    ds_read_b128 v[108:111], v58 offset:1920
    ds_read_b128 v[132:135], v59 offset:192
    ds_read_b128 v[156:159], v59 offset:2752
    s_waitcnt lgkmcnt(12)
    v_mfma_f32_32x32x16_bf16 v[72:87], v[116:119], v[140:143], v[72:87]
    v_mfma_f32_32x32x16_bf16 v[88:103], v[116:119], v[164:167], v[88:103]
    ds_read_b128 v[112:115], v58 offset:1952
    ds_read_b128 v[136:139], v59 offset:160
    ds_read_b128 v[160:163], v59 offset:2720
    s_waitcnt lgkmcnt(12)
    v_mfma_f32_32x32x16_bf16 v[72:87], v[120:123], v[144:147], v[72:87]
    v_mfma_f32_32x32x16_bf16 v[88:103], v[120:123], v[168:171], v[88:103]
    ds_read_b128 v[116:119], v58 offset:1984
    ds_read_b128 v[140:143], v59 offset:112
    ds_read_b128 v[164:167], v59 offset:2672
    s_waitcnt lgkmcnt(12)
    v_mfma_f32_32x32x16_bf16 v[72:87], v[124:127], v[148:151], v[72:87]
    v_mfma_f32_32x32x16_bf16 v[88:103], v[124:127], v[172:175], v[88:103]
    ds_read_b128 v[120:123], v58 offset:2016
    ds_read_b128 v[144:147], v59 offset:80
    ds_read_b128 v[168:171], v59 offset:2640
    s_waitcnt lgkmcnt(12)
    v_mfma_f32_32x32x16_bf16 v[72:87], v[104:107], v[128:131], v[72:87]
    v_mfma_f32_32x32x16_bf16 v[88:103], v[104:107], v[152:155], v[88:103]
    ds_read_b128 v[124:127], v58 offset:2048
    ds_read_b128 v[172:175], v59 offset:2592
    s_waitcnt lgkmcnt(11)
    v_mfma_f32_32x32x16_bf16 v[72:87], v[108:111], v[132:135], v[72:87]
    v_mfma_f32_32x32x16_bf16 v[88:103], v[108:111], v[156:159], v[88:103]
    ds_read_b128 v[104:107], v58 offset:2080
    ds_read_b128 v[152:155], v59 offset:2560
    s_waitcnt lgkmcnt(10)
    v_mfma_f32_32x32x16_bf16 v[72:87], v[112:115], v[136:139], v[72:87]
    v_mfma_f32_32x32x16_bf16 v[88:103], v[112:115], v[160:163], v[88:103]
    ds_read_b128 v[108:111], v58 offset:2112
    ds_read_b128 v[156:159], v59 offset:2512
    s_waitcnt lgkmcnt(9)
    v_mfma_f32_32x32x16_bf16 v[72:87], v[116:119], v[140:143], v[72:87]
    v_mfma_f32_32x32x16_bf16 v[88:103], v[116:119], v[164:167], v[88:103]
    ds_read_b128 v[112:115], v58 offset:2144
    ds_read_b128 v[160:163], v59 offset:2480
    s_waitcnt lgkmcnt(8)
    v_mfma_f32_32x32x16_bf16 v[72:87], v[120:123], v[144:147], v[72:87]
    v_mfma_f32_32x32x16_bf16 v[88:103], v[120:123], v[168:171], v[88:103]
    ds_read_b128 v[116:119], v58 offset:2176
    ds_read_b128 v[164:167], v59 offset:2432
    s_waitcnt lgkmcnt(8)
    v_mfma_f32_32x32x16_bf16 v[88:103], v[124:127], v[172:175], v[88:103]
    ds_read_b128 v[120:123], v58 offset:2208
    ds_read_b128 v[168:171], v59 offset:2400
    s_waitcnt lgkmcnt(8)
    v_mfma_f32_32x32x16_bf16 v[88:103], v[104:107], v[152:155], v[88:103]
    ds_read_b128 v[124:127], v58 offset:2240
    ds_read_b128 v[172:175], v59 offset:2352
    s_waitcnt lgkmcnt(8)
    v_mfma_f32_32x32x16_bf16 v[88:103], v[108:111], v[156:159], v[88:103]
    ds_read_b128 v[104:107], v58 offset:2272
    ds_read_b128 v[152:155], v59 offset:2320
    s_waitcnt lgkmcnt(8)
    v_mfma_f32_32x32x16_bf16 v[88:103], v[112:115], v[160:163], v[88:103]
    ds_read_b128 v[108:111], v58 offset:2304
    ds_read_b128 v[156:159], v59 offset:2272
    s_waitcnt lgkmcnt(8)
    v_mfma_f32_32x32x16_bf16 v[88:103], v[116:119], v[164:167], v[88:103]
    ds_read_b128 v[112:115], v58 offset:2336
    ds_read_b128 v[160:163], v59 offset:2240
    s_waitcnt lgkmcnt(8)
    v_mfma_f32_32x32x16_bf16 v[88:103], v[120:123], v[168:171], v[88:103]
    ds_read_b128 v[116:119], v58 offset:2368
    ds_read_b128 v[164:167], v59 offset:2192
    s_waitcnt lgkmcnt(8)
    v_mfma_f32_32x32x16_bf16 v[88:103], v[124:127], v[172:175], v[88:103]
    ds_read_b128 v[120:123], v58 offset:2400
    ds_read_b128 v[168:171], v59 offset:2160
    s_waitcnt lgkmcnt(8)
    v_mfma_f32_32x32x16_bf16 v[88:103], v[104:107], v[152:155], v[88:103]
    ds_read_b128 v[124:127], v58 offset:2432
    ds_read_b128 v[172:175], v59 offset:2112
    s_waitcnt lgkmcnt(8)
    v_mfma_f32_32x32x16_bf16 v[88:103], v[108:111], v[156:159], v[88:103]
    ds_read_b128 v[104:107], v58 offset:2464
    ds_read_b128 v[152:155], v59 offset:2080
    s_waitcnt lgkmcnt(8)
    v_mfma_f32_32x32x16_bf16 v[88:103], v[112:115], v[160:163], v[88:103]
    ds_read_b128 v[108:111], v58 offset:2496
    ds_read_b128 v[156:159], v59 offset:2032
    s_waitcnt lgkmcnt(8)
    v_mfma_f32_32x32x16_bf16 v[88:103], v[116:119], v[164:167], v[88:103]
    s_waitcnt lgkmcnt(6)
    v_mfma_f32_32x32x16_bf16 v[88:103], v[120:123], v[168:171], v[88:103]
    s_waitcnt lgkmcnt(4)
    v_mfma_f32_32x32x16_bf16 v[88:103], v[124:127], v[172:175], v[88:103]
    s_waitcnt lgkmcnt(2)
    v_mfma_f32_32x32x16_bf16 v[88:103], v[104:107], v[152:155], v[88:103]
    s_waitcnt lgkmcnt(0)
    v_mfma_f32_32x32x16_bf16 v[88:103], v[108:111], v[156:159], v[88:103]
    ds_write_b128 v70, v[72:75] offset:9216
    ds_write_b128 v70, v[76:79] offset:9248
    ds_write_b128 v70, v[80:83] offset:9280
    ds_write_b128 v70, v[84:87] offset:9312
    s_nop 7
    ds_write_b128 v70, v[88:91] offset:23040
    ds_write_b128 v70, v[92:95] offset:23072
    ds_write_b128 v70, v[96:99] offset:23104
    ds_write_b128 v70, v[100:103] offset:23136
    s_branch c_pw_end_19
c_pw_22:
    ds_read_b128 v[104:107], v58 offset:2528
    ds_read_b128 v[152:155], v59 offset:2000
    ds_read_b128 v[108:111], v58 offset:2560
    ds_read_b128 v[156:159], v59 offset:1952
    ds_read_b128 v[112:115], v58 offset:2592
    ds_read_b128 v[160:163], v59 offset:1920
    ds_read_b128 v[116:119], v58 offset:2624
    ds_read_b128 v[164:167], v59 offset:1872
    ds_read_b128 v[120:123], v58 offset:2656
    ds_read_b128 v[168:171], v59 offset:1840
    s_waitcnt lgkmcnt(8)
    v_mfma_f32_32x32x16_bf16 v[88:103], v[104:107], v[152:155], 0
    ds_read_b128 v[124:127], v58 offset:2688
    ds_read_b128 v[172:175], v59 offset:1792
    s_waitcnt lgkmcnt(8)
    v_mfma_f32_32x32x16_bf16 v[88:103], v[108:111], v[156:159], v[88:103]
    ds_read_b128 v[104:107], v58 offset:2720
    ds_read_b128 v[152:155], v59 offset:1760
    s_waitcnt lgkmcnt(8)
    v_mfma_f32_32x32x16_bf16 v[88:103], v[112:115], v[160:163], v[88:103]
    ds_read_b128 v[108:111], v58 offset:2752
    ds_read_b128 v[156:159], v59 offset:1712
    s_waitcnt lgkmcnt(8)
    v_mfma_f32_32x32x16_bf16 v[88:103], v[116:119], v[164:167], v[88:103]
    ds_read_b128 v[112:115], v58 offset:2784
    ds_read_b128 v[160:163], v59 offset:1680
    s_waitcnt lgkmcnt(8)
    v_mfma_f32_32x32x16_bf16 v[88:103], v[120:123], v[168:171], v[88:103]
    ds_read_b128 v[116:119], v58 offset:2816
    ds_read_b128 v[164:167], v59 offset:1632
    s_waitcnt lgkmcnt(8)
    v_mfma_f32_32x32x16_bf16 v[88:103], v[124:127], v[172:175], v[88:103]
    ds_read_b128 v[120:123], v58 offset:2848
    ds_read_b128 v[168:171], v59 offset:1600
    s_waitcnt lgkmcnt(8)
    v_mfma_f32_32x32x16_bf16 v[88:103], v[104:107], v[152:155], v[88:103]
    ds_read_b128 v[124:127], v58 offset:2880
    ds_read_b128 v[172:175], v59 offset:1552
    s_waitcnt lgkmcnt(8)
    v_mfma_f32_32x32x16_bf16 v[88:103], v[108:111], v[156:159], v[88:103]
    ds_read_b128 v[104:107], v58 offset:2912
    ds_read_b128 v[152:155], v59 offset:1520
    s_waitcnt lgkmcnt(8)
    v_mfma_f32_32x32x16_bf16 v[88:103], v[112:115], v[160:163], v[88:103]
    ds_read_b128 v[108:111], v58 offset:2944
    ds_read_b128 v[156:159], v59 offset:1472
    s_waitcnt lgkmcnt(8)
    v_mfma_f32_32x32x16_bf16 v[88:103], v[116:119], v[164:167], v[88:103]
    ds_read_b128 v[112:115], v58 offset:2976
    ds_read_b128 v[160:163], v59 offset:1440
    s_waitcnt lgkmcnt(8)
    v_mfma_f32_32x32x16_bf16 v[88:103], v[120:123], v[168:171], v[88:103]
    ds_read_b128 v[116:119], v58 offset:3008
    ds_read_b128 v[164:167], v59 offset:1392
    s_waitcnt lgkmcnt(8)
    v_mfma_f32_32x32x16_bf16 v[88:103], v[124:127], v[172:175], v[88:103]
    ds_read_b128 v[120:123], v58 offset:3040
    ds_read_b128 v[168:171], v59 offset:1360
    s_waitcnt lgkmcnt(8)
    v_mfma_f32_32x32x16_bf16 v[88:103], v[104:107], v[152:155], v[88:103]
    ds_read_b128 v[124:127], v58 offset:3072
    ds_read_b128 v[172:175], v59 offset:1312
    s_waitcnt lgkmcnt(8)
    v_mfma_f32_32x32x16_bf16 v[88:103], v[108:111], v[156:159], v[88:103]
    ds_read_b128 v[104:107], v58 offset:3104
    ds_read_b128 v[152:155], v59 offset:1280
    s_waitcnt lgkmcnt(8)
    v_mfma_f32_32x32x16_bf16 v[88:103], v[112:115], v[160:163], v[88:103]
    ds_read_b128 v[108:111], v58 offset:3136
    ds_read_b128 v[156:159], v59 offset:1232
    s_waitcnt lgkmcnt(8)
    v_mfma_f32_32x32x16_bf16 v[88:103], v[116:119], v[164:167], v[88:103]
    ds_read_b128 v[112:115], v58 offset:3168
    ds_read_b128 v[160:163], v59 offset:1200
    s_waitcnt lgkmcnt(8)
    v_mfma_f32_32x32x16_bf16 v[88:103], v[120:123], v[168:171], v[88:103]
    ds_read_b128 v[116:119], v58 offset:3200
    ds_read_b128 v[164:167], v59 offset:1152
    s_waitcnt lgkmcnt(8)
    v_mfma_f32_32x32x16_bf16 v[88:103], v[124:127], v[172:175], v[88:103]
    ds_read_b128 v[120:123], v58 offset:3232
    ds_read_b128 v[168:171], v59 offset:1120
    s_waitcnt lgkmcnt(8)
    v_mfma_f32_32x32x16_bf16 v[88:103], v[104:107], v[152:155], v[88:103]
    ds_read_b128 v[124:127], v58 offset:3264
    ds_read_b128 v[172:175], v59 offset:1072
    s_waitcnt lgkmcnt(8)
    v_mfma_f32_32x32x16_bf16 v[88:103], v[108:111], v[156:159], v[88:103]
    ds_read_b128 v[104:107], v58 offset:3296
    ds_read_b128 v[152:155], v59 offset:1040
    s_waitcnt lgkmcnt(8)
    v_mfma_f32_32x32x16_bf16 v[88:103], v[112:115], v[160:163], v[88:103]
    ds_read_b128 v[108:111], v58 offset:3328
    ds_read_b128 v[156:159], v59 offset:992
    s_waitcnt lgkmcnt(8)
    v_mfma_f32_32x32x16_bf16 v[88:103], v[116:119], v[164:167], v[88:103]
    ds_read_b128 v[112:115], v58 offset:3360
    ds_read_b128 v[160:163], v59 offset:960
    s_waitcnt lgkmcnt(8)
    v_mfma_f32_32x32x16_bf16 v[88:103], v[120:123], v[168:171], v[88:103]
    ds_read_b128 v[116:119], v58 offset:3392
    ds_read_b128 v[164:167], v59 offset:912
    s_waitcnt lgkmcnt(8)
    v_mfma_f32_32x32x16_bf16 v[88:103], v[124:127], v[172:175], v[88:103]
    ds_read_b128 v[120:123], v58 offset:3424
    ds_read_b128 v[168:171], v59 offset:880
    s_waitcnt lgkmcnt(8)
    v_mfma_f32_32x32x16_bf16 v[88:103], v[104:107], v[152:155], v[88:103]
    ds_read_b128 v[124:127], v58 offset:3456
    ds_read_b128 v[172:175], v59 offset:832
    s_waitcnt lgkmcnt(8)
    v_mfma_f32_32x32x16_bf16 v[88:103], v[108:111], v[156:159], v[88:103]
    ds_read_b128 v[104:107], v58 offset:3488
    ds_read_b128 v[152:155], v59 offset:800
    s_waitcnt lgkmcnt(8)
    v_mfma_f32_32x32x16_bf16 v[88:103], v[112:115], v[160:163], v[88:103]
    ds_read_b128 v[108:111], v58 offset:3520
    ds_read_b128 v[156:159], v59 offset:752
    s_waitcnt lgkmcnt(8)
    v_mfma_f32_32x32x16_bf16 v[88:103], v[116:119], v[164:167], v[88:103]
    ds_read_b128 v[112:115], v58 offset:3552
    ds_read_b128 v[160:163], v59 offset:720
    s_waitcnt lgkmcnt(8)
    v_mfma_f32_32x32x16_bf16 v[88:103], v[120:123], v[168:171], v[88:103]
    ds_read_b128 v[116:119], v58 offset:3584
    ds_read_b128 v[164:167], v59 offset:672
    s_waitcnt lgkmcnt(8)
    v_mfma_f32_32x32x16_bf16 v[88:103], v[124:127], v[172:175], v[88:103]
    ds_read_b128 v[120:123], v58 offset:3616
    ds_read_b128 v[168:171], v59 offset:640
    s_waitcnt lgkmcnt(8)
    v_mfma_f32_32x32x16_bf16 v[88:103], v[104:107], v[152:155], v[88:103]
    ds_read_b128 v[124:127], v58 offset:3648
    ds_read_b128 v[172:175], v59 offset:592
    s_waitcnt lgkmcnt(8)
    v_mfma_f32_32x32x16_bf16 v[88:103], v[108:111], v[156:159], v[88:103]
    ds_read_b128 v[104:107], v58 offset:3680
    ds_read_b128 v[152:155], v59 offset:560
    s_waitcnt lgkmcnt(8)
    v_mfma_f32_32x32x16_bf16 v[88:103], v[112:115], v[160:163], v[88:103]
    ds_read_b128 v[108:111], v58 offset:3712
    ds_read_b128 v[156:159], v59 offset:512
    s_waitcnt lgkmcnt(8)
    v_mfma_f32_32x32x16_bf16 v[88:103], v[116:119], v[164:167], v[88:103]
    ds_read_b128 v[112:115], v58 offset:3744
    ds_read_b128 v[160:163], v59 offset:480
    s_waitcnt lgkmcnt(8)
    v_mfma_f32_32x32x16_bf16 v[88:103], v[120:123], v[168:171], v[88:103]
    ds_read_b128 v[116:119], v58 offset:3776
    ds_read_b128 v[164:167], v59 offset:432
    s_waitcnt lgkmcnt(8)
    v_mfma_f32_32x32x16_bf16 v[88:103], v[124:127], v[172:175], v[88:103]
    ds_read_b128 v[120:123], v58 offset:3808
    ds_read_b128 v[168:171], v59 offset:400
    s_waitcnt lgkmcnt(8)
    v_mfma_f32_32x32x16_bf16 v[88:103], v[104:107], v[152:155], v[88:103]
    ds_read_b128 v[124:127], v58 offset:3840
    ds_read_b128 v[172:175], v59 offset:352
    s_waitcnt lgkmcnt(8)
    v_mfma_f32_32x32x16_bf16 v[88:103], v[108:111], v[156:159], v[88:103]
    ds_read_b128 v[104:107], v58 offset:3872
    ds_read_b128 v[152:155], v59 offset:320
    s_waitcnt lgkmcnt(8)
    v_mfma_f32_32x32x16_bf16 v[88:103], v[112:115], v[160:163], v[88:103]
    ds_read_b128 v[108:111], v58 offset:3904
    ds_read_b128 v[156:159], v59 offset:272
    s_waitcnt lgkmcnt(8)
    v_mfma_f32_32x32x16_bf16 v[88:103], v[116:119], v[164:167], v[88:103]
    ds_read_b128 v[112:115], v58 offset:3936
    ds_read_b128 v[160:163], v59 offset:240
    s_waitcnt lgkmcnt(8)
    v_mfma_f32_32x32x16_bf16 v[88:103], v[120:123], v[168:171], v[88:103]
    ds_read_b128 v[116:119], v58 offset:3968
    ds_read_b128 v[164:167], v59 offset:192
    s_waitcnt lgkmcnt(8)
    v_mfma_f32_32x32x16_bf16 v[88:103], v[124:127], v[172:175], v[88:103]
    ds_read_b128 v[120:123], v58 offset:4000
    ds_read_b128 v[168:171], v59 offset:160
    s_waitcnt lgkmcnt(8)
    v_mfma_f32_32x32x16_bf16 v[88:103], v[104:107], v[152:155], v[88:103]
    ds_read_b128 v[124:127], v58 offset:4032
    ds_read_b128 v[172:175], v59 offset:112
    s_waitcnt lgkmcnt(8)
    v_mfma_f32_32x32x16_bf16 v[88:103], v[108:111], v[156:159], v[88:103]
    ds_read_b128 v[104:107], v58 offset:4064
    ds_read_b128 v[152:155], v59 offset:80
    s_waitcnt lgkmcnt(8)
    v_mfma_f32_32x32x16_bf16 v[88:103], v[112:115], v[160:163], v[88:103]
    s_waitcnt lgkmcnt(6)
    v_mfma_f32_32x32x16_bf16 v[88:103], v[116:119], v[164:167], v[88:103]
    s_waitcnt lgkmcnt(4)
    v_mfma_f32_32x32x16_bf16 v[88:103], v[120:123], v[168:171], v[88:103]
    s_waitcnt lgkmcnt(2)
    v_mfma_f32_32x32x16_bf16 v[88:103], v[124:127], v[172:175], v[88:103]
    s_waitcnt lgkmcnt(0)
    v_mfma_f32_32x32x16_bf16 v[88:103], v[104:107], v[152:155], v[88:103]
    s_nop 11
    ds_write_b128 v70, v[88:91] offset:27648
    ds_write_b128 v70, v[92:95] offset:27680
    ds_write_b128 v70, v[96:99] offset:27712
    ds_write_b128 v70, v[100:103] offset:27744
c_pw_end_19:
    s_waitcnt lgkmcnt(0)
    s_barrier
    s_cmp_ge_u32 s34, 2
    s_cbranch_scc1 c_finH_24
    ds_read_b128 v[104:107], v71 offset:0
    ds_read_b128 v[108:111], v71 offset:16
    ds_read_b128 v[112:115], v71 offset:4608
    ds_read_b128 v[116:119], v71 offset:4624
    ds_read_b128 v[120:123], v71 offset:9216
    ds_read_b128 v[124:127], v71 offset:9232
    s_waitcnt lgkmcnt(0)
    v_pk_add_f32 v[104:105], v[104:105], v[112:113]
    v_pk_add_f32 v[106:107], v[106:107], v[114:115]
    v_pk_add_f32 v[108:109], v[108:109], v[116:117]
    v_pk_add_f32 v[110:111], v[110:111], v[118:119]
    v_pk_add_f32 v[104:105], v[104:105], v[120:121]
    v_pk_add_f32 v[106:107], v[106:107], v[122:123]
    v_pk_add_f32 v[108:109], v[108:109], v[124:125]
    v_pk_add_f32 v[110:111], v[110:111], v[126:127]
    v_cvt_pk_bf16_f32 v184, v104, v105
    v_cvt_pk_bf16_f32 v185, v106, v107
    v_cvt_pk_bf16_f32 v186, v108, v109
    v_cvt_pk_bf16_f32 v187, v110, v111
    s_lshl_b32 s40, s57, 12
    s_add_u32 s40, s40, 8912896
    v_and_b32 v3, 127, v0
    v_lshlrev_b32 v3, 4, v3
    buffer_store_dwordx4 v[184:187], v3, s[8:11], s40 offen sc1
    s_nop 1
    s_branch c_fin_end_25
c_finH_24:
    ds_read_b128 v[104:107], v71 offset:13824
    ds_read_b128 v[108:111], v71 offset:13840
    ds_read_b128 v[112:115], v71 offset:18432
    ds_read_b128 v[116:119], v71 offset:18448
    ds_read_b128 v[120:123], v71 offset:23040
    ds_read_b128 v[124:127], v71 offset:23056
    ds_read_b128 v[128:131], v71 offset:27648
    ds_read_b128 v[132:135], v71 offset:27664
    s_waitcnt lgkmcnt(0)
    v_pk_add_f32 v[104:105], v[104:105], v[112:113]
    v_pk_add_f32 v[106:107], v[106:107], v[114:115]
    v_pk_add_f32 v[108:109], v[108:109], v[116:117]
    v_pk_add_f32 v[110:111], v[110:111], v[118:119]
    v_pk_add_f32 v[104:105], v[104:105], v[120:121]
    v_pk_add_f32 v[106:107], v[106:107], v[122:123]
    v_pk_add_f32 v[108:109], v[108:109], v[124:125]
    v_pk_add_f32 v[110:111], v[110:111], v[126:127]
    v_pk_add_f32 v[104:105], v[104:105], v[128:129]
    v_pk_add_f32 v[106:107], v[106:107], v[130:131]
    v_pk_add_f32 v[108:109], v[108:109], v[132:133]
    v_pk_add_f32 v[110:111], v[110:111], v[134:135]
    v_cvt_pk_bf16_f32 v184, v104, v105
    v_cvt_pk_bf16_f32 v185, v106, v107
    v_cvt_pk_bf16_f32 v186, v108, v109
    v_cvt_pk_bf16_f32 v187, v110, v111
    s_lshl_b32 s40, s57, 12
    s_add_u32 s40, s40, 8914944
    v_and_b32 v3, 127, v0
    v_lshlrev_b32 v3, 4, v3
    buffer_store_dwordx4 v[184:187], v3, s[8:11], s40 offen sc1
    s_nop 1
c_fin_end_25:
    s_waitcnt vmcnt(0)
    v_cmp_ne_u32 vcc, 0, v0
    s_nop 1
    v_cndmask_b32 v24, 0, v24, vcc
    v_cndmask_b32 v25, 0, v25, vcc
    v_cndmask_b32 v26, 0, v26, vcc
    v_cndmask_b32 v27, 0, v27, vcc
    v_alignbit_b32 v176, v25, v24, 16
    v_alignbit_b32 v177, v26, v25, 16
    v_alignbit_b32 v178, v27, v26, 16
    v_alignbit_b32 v179, v28, v27, 16
    v_alignbit_b32 v180, v29, v28, 16
    v_alignbit_b32 v181, v30, v29, 16
    v_alignbit_b32 v182, v31, v30, 16
    ds_write_b128 v56, v[176:179] offset:0
    v_mov_b32 v184, v25
    v_mov_b32 v185, v26
    v_mov_b32 v186, v27
    v_mov_b32 v187, v28
    ds_write_b128 v56, v[184:187] offset:4160
    s_nop 1
    v_mov_b32 v184, v177
    v_mov_b32 v185, v178
    v_mov_b32 v186, v179
    v_mov_b32 v187, v180
    ds_write_b128 v56, v[184:187] offset:8320
    s_nop 1
    ds_write_b128 v56, v[26:29] offset:12480
    ds_write_b128 v56, v[178:181] offset:16640
    v_mov_b32 v184, v27
    v_mov_b32 v185, v28
    v_mov_b32 v186, v29
    v_mov_b32 v187, v30
    ds_write_b128 v56, v[184:187] offset:20800
    s_nop 1
    v_mov_b32 v184, v179
    v_mov_b32 v185, v180
    v_mov_b32 v186, v181
    v_mov_b32 v187, v182
    ds_write_b128 v56, v[184:187] offset:24960
    s_nop 1
    ds_write_b128 v56, v[28:31] offset:29120
    ds_write_b128 v57, v[40:43]
    v_lshlrev_b32 v3, 16, v46
    v_or_b32 v3, v3, v46
    v_and_b32 v188, v60, v3
    v_and_b32 v189, v61, v3
    v_and_b32 v190, v62, v3
    v_and_b32 v191, v63, v3
    v_and_b32 v192, v64, v3
    v_and_b32 v193, v65, v3
    v_and_b32 v194, v66, v3
    v_and_b32 v195, v67, v3
    s_waitcnt lgkmcnt(0)
    s_barrier
    s_bitcmp1_b32 s2, 0
    s_cbranch_scc1 c_halfL_26
    s_cmp_lg_u32 s34, 0
    s_cbranch_scc1 c_pw_29
    ds_read_b128 v[104:107], v58 offset:0
    ds_read_b128 v[152:155], v59 offset:5152
    ds_read_b128 v[108:111], v58 offset:32
    ds_read_b128 v[156:159], v59 offset:5120
    ds_read_b128 v[112:115], v58 offset:64
    ds_read_b128 v[160:163], v59 offset:5072
    ds_read_b128 v[116:119], v58 offset:96
    ds_read_b128 v[164:167], v59 offset:5040
    ds_read_b128 v[120:123], v58 offset:128
    ds_read_b128 v[168:171], v59 offset:4992
    s_waitcnt lgkmcnt(8)
    v_mfma_f32_32x32x16_bf16 v[88:103], v[104:107], v[152:155], 0
    v_mfma_f32_32x32x16_bf16 v[88:103], v[192:195], v[152:155], v[88:103]
    ds_read_b128 v[124:127], v58 offset:160
    ds_read_b128 v[172:175], v59 offset:4960
    s_waitcnt lgkmcnt(8)
    v_mfma_f32_32x32x16_bf16 v[88:103], v[108:111], v[156:159], v[88:103]
    v_mfma_f32_32x32x16_bf16 v[88:103], v[188:191], v[156:159], v[88:103]
    ds_read_b128 v[104:107], v58 offset:192
    ds_read_b128 v[152:155], v59 offset:4912
    s_waitcnt lgkmcnt(8)
    v_mfma_f32_32x32x16_bf16 v[88:103], v[112:115], v[160:163], v[88:103]
    ds_read_b128 v[108:111], v58 offset:224
    ds_read_b128 v[156:159], v59 offset:4880
    s_waitcnt lgkmcnt(8)
    v_mfma_f32_32x32x16_bf16 v[88:103], v[116:119], v[164:167], v[88:103]
    ds_read_b128 v[112:115], v58 offset:256
    ds_read_b128 v[160:163], v59 offset:4832
    s_waitcnt lgkmcnt(8)
    v_mfma_f32_32x32x16_bf16 v[88:103], v[120:123], v[168:171], v[88:103]
    ds_read_b128 v[116:119], v58 offset:288
    ds_read_b128 v[164:167], v59 offset:4800
    s_waitcnt lgkmcnt(8)
    v_mfma_f32_32x32x16_bf16 v[88:103], v[124:127], v[172:175], v[88:103]
    ds_read_b128 v[120:123], v58 offset:320
    ds_read_b128 v[168:171], v59 offset:4752
    s_waitcnt lgkmcnt(8)
    v_mfma_f32_32x32x16_bf16 v[88:103], v[104:107], v[152:155], v[88:103]
    ds_read_b128 v[124:127], v58 offset:352
    ds_read_b128 v[172:175], v59 offset:4720
    s_waitcnt lgkmcnt(8)
    v_mfma_f32_32x32x16_bf16 v[88:103], v[108:111], v[156:159], v[88:103]
    ds_read_b128 v[104:107], v58 offset:384
    ds_read_b128 v[152:155], v59 offset:4672
    s_waitcnt lgkmcnt(8)
    v_mfma_f32_32x32x16_bf16 v[88:103], v[112:115], v[160:163], v[88:103]
    ds_read_b128 v[108:111], v58 offset:416
    ds_read_b128 v[156:159], v59 offset:4640
    s_waitcnt lgkmcnt(8)
    v_mfma_f32_32x32x16_bf16 v[88:103], v[116:119], v[164:167], v[88:103]
    ds_read_b128 v[112:115], v58 offset:448
    ds_read_b128 v[160:163], v59 offset:4592
    s_waitcnt lgkmcnt(8)
    v_mfma_f32_32x32x16_bf16 v[88:103], v[120:123], v[168:171], v[88:103]
    ds_read_b128 v[116:119], v58 offset:480
    ds_read_b128 v[164:167], v59 offset:4560
    s_waitcnt lgkmcnt(8)
    v_mfma_f32_32x32x16_bf16 v[88:103], v[124:127], v[172:175], v[88:103]
    ds_read_b128 v[120:123], v58 offset:512
    ds_read_b128 v[168:171], v59 offset:4512
    s_waitcnt lgkmcnt(8)
    v_mfma_f32_32x32x16_bf16 v[88:103], v[104:107], v[152:155], v[88:103]
    ds_read_b128 v[124:127], v58 offset:544
    ds_read_b128 v[172:175], v59 offset:4480
    s_waitcnt lgkmcnt(8)
    v_mfma_f32_32x32x16_bf16 v[88:103], v[108:111], v[156:159], v[88:103]
    ds_read_b128 v[104:107], v58 offset:576
    ds_read_b128 v[152:155], v59 offset:4432
    s_waitcnt lgkmcnt(8)
    v_mfma_f32_32x32x16_bf16 v[88:103], v[112:115], v[160:163], v[88:103]
    ds_read_b128 v[108:111], v58 offset:608
    ds_read_b128 v[156:159], v59 offset:4400
    s_waitcnt lgkmcnt(8)
    v_mfma_f32_32x32x16_bf16 v[88:103], v[116:119], v[164:167], v[88:103]
    ds_read_b128 v[112:115], v58 offset:640
    ds_read_b128 v[160:163], v59 offset:4352
    s_waitcnt lgkmcnt(8)
    v_mfma_f32_32x32x16_bf16 v[88:103], v[120:123], v[168:171], v[88:103]
    ds_read_b128 v[116:119], v58 offset:672
    ds_read_b128 v[164:167], v59 offset:4320
    s_waitcnt lgkmcnt(8)
    v_mfma_f32_32x32x16_bf16 v[88:103], v[124:127], v[172:175], v[88:103]
    ds_read_b128 v[120:123], v58 offset:704
    ds_read_b128 v[168:171], v59 offset:4272
    s_waitcnt lgkmcnt(8)
    v_mfma_f32_32x32x16_bf16 v[88:103], v[104:107], v[152:155], v[88:103]
    ds_read_b128 v[124:127], v58 offset:736
    ds_read_b128 v[172:175], v59 offset:4240
    s_waitcnt lgkmcnt(8)
    v_mfma_f32_32x32x16_bf16 v[88:103], v[108:111], v[156:159], v[88:103]
    ds_read_b128 v[104:107], v58 offset:768
    ds_read_b128 v[152:155], v59 offset:4192
    s_waitcnt lgkmcnt(8)
    v_mfma_f32_32x32x16_bf16 v[88:103], v[112:115], v[160:163], v[88:103]
    ds_read_b128 v[108:111], v58 offset:800
    ds_read_b128 v[156:159], v59 offset:4160
    s_waitcnt lgkmcnt(8)
    v_mfma_f32_32x32x16_bf16 v[88:103], v[116:119], v[164:167], v[88:103]
    ds_read_b128 v[112:115], v58 offset:832
    ds_read_b128 v[160:163], v59 offset:4112
    s_waitcnt lgkmcnt(8)
    v_mfma_f32_32x32x16_bf16 v[88:103], v[120:123], v[168:171], v[88:103]
    ds_read_b128 v[116:119], v58 offset:864
    ds_read_b128 v[164:167], v59 offset:4080
    s_waitcnt lgkmcnt(8)
    v_mfma_f32_32x32x16_bf16 v[88:103], v[124:127], v[172:175], v[88:103]
    ds_read_b128 v[120:123], v58 offset:896
    ds_read_b128 v[168:171], v59 offset:4032
    s_waitcnt lgkmcnt(8)
    v_mfma_f32_32x32x16_bf16 v[88:103], v[104:107], v[152:155], v[88:103]
    ds_read_b128 v[124:127], v58 offset:928
    ds_read_b128 v[172:175], v59 offset:4000
    s_waitcnt lgkmcnt(8)
    v_mfma_f32_32x32x16_bf16 v[88:103], v[108:111], v[156:159], v[88:103]
    ds_read_b128 v[104:107], v58 offset:960
    ds_read_b128 v[152:155], v59 offset:3952
    s_waitcnt lgkmcnt(8)
    v_mfma_f32_32x32x16_bf16 v[88:103], v[112:115], v[160:163], v[88:103]
    ds_read_b128 v[108:111], v58 offset:992
    ds_read_b128 v[156:159], v59 offset:3920
    s_waitcnt lgkmcnt(8)
    v_mfma_f32_32x32x16_bf16 v[88:103], v[116:119], v[164:167], v[88:103]
    s_waitcnt lgkmcnt(6)
    v_mfma_f32_32x32x16_bf16 v[88:103], v[120:123], v[168:171], v[88:103]
    s_waitcnt lgkmcnt(4)
    v_mfma_f32_32x32x16_bf16 v[88:103], v[124:127], v[172:175], v[88:103]
    s_waitcnt lgkmcnt(2)
    v_mfma_f32_32x32x16_bf16 v[88:103], v[104:107], v[152:155], v[88:103]
    s_waitcnt lgkmcnt(0)
    v_mfma_f32_32x32x16_bf16 v[88:103], v[108:111], v[156:159], v[88:103]
    s_nop 11
    ds_write_b128 v70, v[88:91] offset:13824
    ds_write_b128 v70, v[92:95] offset:13856
    ds_write_b128 v70, v[96:99] offset:13888
    ds_write_b128 v70, v[100:103] offset:13920
    s_branch c_pw_end_28
c_pw_29:
    s_cmp_lg_u32 s34, 1
    s_cbranch_scc1 c_pw_30
    ds_read_b128 v[104:107], v58 offset:1024
    ds_read_b128 v[152:155], v59 offset:3872
    ds_read_b128 v[108:111], v58 offset:1056
    ds_read_b128 v[156:159], v59 offset:3840
    ds_read_b128 v[112:115], v58 offset:1088
    ds_read_b128 v[160:163], v59 offset:3792
    ds_read_b128 v[116:119], v58 offset:1120
    ds_read_b128 v[164:167], v59 offset:3760
    ds_read_b128 v[120:123], v58 offset:1152
    ds_read_b128 v[168:171], v59 offset:3712
    s_waitcnt lgkmcnt(8)
    v_mfma_f32_32x32x16_bf16 v[88:103], v[104:107], v[152:155], 0
    ds_read_b128 v[124:127], v58 offset:1184
    ds_read_b128 v[172:175], v59 offset:3680
    s_waitcnt lgkmcnt(8)
    v_mfma_f32_32x32x16_bf16 v[88:103], v[108:111], v[156:159], v[88:103]
    ds_read_b128 v[104:107], v58 offset:1216
    ds_read_b128 v[152:155], v59 offset:3632
    s_waitcnt lgkmcnt(8)
    v_mfma_f32_32x32x16_bf16 v[88:103], v[112:115], v[160:163], v[88:103]
    ds_read_b128 v[108:111], v58 offset:1248
    ds_read_b128 v[156:159], v59 offset:3600
    s_waitcnt lgkmcnt(8)
    v_mfma_f32_32x32x16_bf16 v[88:103], v[116:119], v[164:167], v[88:103]
    ds_read_b128 v[112:115], v58 offset:1280
    ds_read_b128 v[160:163], v59 offset:3552
    s_waitcnt lgkmcnt(8)
    v_mfma_f32_32x32x16_bf16 v[88:103], v[120:123], v[168:171], v[88:103]
    ds_read_b128 v[116:119], v58 offset:1312
    ds_read_b128 v[164:167], v59 offset:3520
    s_waitcnt lgkmcnt(8)
    v_mfma_f32_32x32x16_bf16 v[88:103], v[124:127], v[172:175], v[88:103]
    ds_read_b128 v[120:123], v58 offset:1344
    ds_read_b128 v[168:171], v59 offset:3472
    s_waitcnt lgkmcnt(8)
    v_mfma_f32_32x32x16_bf16 v[88:103], v[104:107], v[152:155], v[88:103]
    ds_read_b128 v[124:127], v58 offset:1376
    ds_read_b128 v[172:175], v59 offset:3440
    s_waitcnt lgkmcnt(8)
    v_mfma_f32_32x32x16_bf16 v[88:103], v[108:111], v[156:159], v[88:103]
    ds_read_b128 v[104:107], v58 offset:1408
    ds_read_b128 v[152:155], v59 offset:3392
    s_waitcnt lgkmcnt(8)
    v_mfma_f32_32x32x16_bf16 v[88:103], v[112:115], v[160:163], v[88:103]
    ds_read_b128 v[108:111], v58 offset:1440
    ds_read_b128 v[156:159], v59 offset:3360
    s_waitcnt lgkmcnt(8)
    v_mfma_f32_32x32x16_bf16 v[88:103], v[116:119], v[164:167], v[88:103]
    ds_read_b128 v[112:115], v58 offset:1472
    ds_read_b128 v[160:163], v59 offset:3312
    s_waitcnt lgkmcnt(8)
    v_mfma_f32_32x32x16_bf16 v[88:103], v[120:123], v[168:171], v[88:103]
    ds_read_b128 v[116:119], v58 offset:1504
    ds_read_b128 v[164:167], v59 offset:3280
    s_waitcnt lgkmcnt(8)
    v_mfma_f32_32x32x16_bf16 v[88:103], v[124:127], v[172:175], v[88:103]
    ds_read_b128 v[120:123], v58 offset:1536
    ds_read_b128 v[168:171], v59 offset:3232
    s_waitcnt lgkmcnt(8)
    v_mfma_f32_32x32x16_bf16 v[88:103], v[104:107], v[152:155], v[88:103]
    ds_read_b128 v[124:127], v58 offset:1568
    ds_read_b128 v[172:175], v59 offset:3200
    s_waitcnt lgkmcnt(8)
    v_mfma_f32_32x32x16_bf16 v[88:103], v[108:111], v[156:159], v[88:103]
    ds_read_b128 v[104:107], v58 offset:1600
    ds_read_b128 v[152:155], v59 offset:3152
    s_waitcnt lgkmcnt(8)
    v_mfma_f32_32x32x16_bf16 v[88:103], v[112:115], v[160:163], v[88:103]
    ds_read_b128 v[108:111], v58 offset:1632
    ds_read_b128 v[156:159], v59 offset:3120
    s_waitcnt lgkmcnt(8)
    v_mfma_f32_32x32x16_bf16 v[88:103], v[116:119], v[164:167], v[88:103]
    ds_read_b128 v[112:115], v58 offset:1664
    ds_read_b128 v[160:163], v59 offset:3072
    s_waitcnt lgkmcnt(8)
    v_mfma_f32_32x32x16_bf16 v[88:103], v[120:123], v[168:171], v[88:103]
    ds_read_b128 v[116:119], v58 offset:1696
    ds_read_b128 v[164:167], v59 offset:3040
    s_waitcnt lgkmcnt(8)
    v_mfma_f32_32x32x16_bf16 v[88:103], v[124:127], v[172:175], v[88:103]
    ds_read_b128 v[120:123], v58 offset:1728
    ds_read_b128 v[168:171], v59 offset:2992
    s_waitcnt lgkmcnt(8)
    v_mfma_f32_32x32x16_bf16 v[88:103], v[104:107], v[152:155], v[88:103]
    ds_read_b128 v[124:127], v58 offset:1760
    ds_read_b128 v[172:175], v59 offset:2960
    s_waitcnt lgkmcnt(8)
    v_mfma_f32_32x32x16_bf16 v[88:103], v[108:111], v[156:159], v[88:103]
    ds_read_b128 v[104:107], v58 offset:1792
    ds_read_b128 v[152:155], v59 offset:2912
    s_waitcnt lgkmcnt(8)
    v_mfma_f32_32x32x16_bf16 v[88:103], v[112:115], v[160:163], v[88:103]
    ds_read_b128 v[108:111], v58 offset:1824
    ds_read_b128 v[156:159], v59 offset:2880
    s_waitcnt lgkmcnt(8)
    v_mfma_f32_32x32x16_bf16 v[88:103], v[116:119], v[164:167], v[88:103]
    ds_read_b128 v[112:115], v58 offset:1856
    ds_read_b128 v[160:163], v59 offset:2832
    s_waitcnt lgkmcnt(8)
    v_mfma_f32_32x32x16_bf16 v[88:103], v[120:123], v[168:171], v[88:103]
    ds_read_b128 v[116:119], v58 offset:1888
    ds_read_b128 v[164:167], v59 offset:2800
    s_waitcnt lgkmcnt(8)
    v_mfma_f32_32x32x16_bf16 v[88:103], v[124:127], v[172:175], v[88:103]
    ds_read_b128 v[120:123], v58 offset:1920
    ds_read_b128 v[168:171], v59 offset:2752
    s_waitcnt lgkmcnt(8)
    v_mfma_f32_32x32x16_bf16 v[88:103], v[104:107], v[152:155], v[88:103]
    ds_read_b128 v[124:127], v58 offset:1952
    ds_read_b128 v[172:175], v59 offset:2720
    s_waitcnt lgkmcnt(8)
    v_mfma_f32_32x32x16_bf16 v[88:103], v[108:111], v[156:159], v[88:103]
    ds_read_b128 v[104:107], v58 offset:1984
    ds_read_b128 v[152:155], v59 offset:2672
    s_waitcnt lgkmcnt(8)
    v_mfma_f32_32x32x16_bf16 v[88:103], v[112:115], v[160:163], v[88:103]
    ds_read_b128 v[108:111], v58 offset:2016
    ds_read_b128 v[156:159], v59 offset:2640
    s_waitcnt lgkmcnt(8)
    v_mfma_f32_32x32x16_bf16 v[88:103], v[116:119], v[164:167], v[88:103]
    s_waitcnt lgkmcnt(6)
    v_mfma_f32_32x32x16_bf16 v[88:103], v[120:123], v[168:171], v[88:103]
    s_waitcnt lgkmcnt(4)
    v_mfma_f32_32x32x16_bf16 v[88:103], v[124:127], v[172:175], v[88:103]
    s_waitcnt lgkmcnt(2)
    v_mfma_f32_32x32x16_bf16 v[88:103], v[104:107], v[152:155], v[88:103]
    s_waitcnt lgkmcnt(0)
    v_mfma_f32_32x32x16_bf16 v[88:103], v[108:111], v[156:159], v[88:103]
    s_nop 11
    ds_write_b128 v70, v[88:91] offset:18432
    ds_write_b128 v70, v[92:95] offset:18464
    ds_write_b128 v70, v[96:99] offset:18496
    ds_write_b128 v70, v[100:103] offset:18528
    s_branch c_pw_end_28
c_pw_30:
    s_cmp_lg_u32 s34, 2
    s_cbranch_scc1 c_pw_31
    ds_read_b128 v[104:107], v58 offset:2048
    ds_read_b128 v[152:155], v59 offset:2592
    ds_read_b128 v[108:111], v58 offset:2080
    ds_read_b128 v[156:159], v59 offset:2560
    ds_read_b128 v[112:115], v58 offset:2112
    ds_read_b128 v[160:163], v59 offset:2512
    ds_read_b128 v[116:119], v58 offset:2144
    ds_read_b128 v[164:167], v59 offset:2480
    ds_read_b128 v[120:123], v58 offset:2176
    ds_read_b128 v[168:171], v59 offset:2432
    s_waitcnt lgkmcnt(8)
    v_mfma_f32_32x32x16_bf16 v[88:103], v[104:107], v[152:155], 0
    ds_read_b128 v[124:127], v58 offset:2208
    ds_read_b128 v[172:175], v59 offset:2400
    s_waitcnt lgkmcnt(8)
    v_mfma_f32_32x32x16_bf16 v[88:103], v[108:111], v[156:159], v[88:103]
    ds_read_b128 v[104:107], v58 offset:2240
    ds_read_b128 v[152:155], v59 offset:2352
    s_waitcnt lgkmcnt(8)
    v_mfma_f32_32x32x16_bf16 v[88:103], v[112:115], v[160:163], v[88:103]
    ds_read_b128 v[108:111], v58 offset:2272
    ds_read_b128 v[156:159], v59 offset:2320
    s_waitcnt lgkmcnt(8)
    v_mfma_f32_32x32x16_bf16 v[88:103], v[116:119], v[164:167], v[88:103]
    ds_read_b128 v[112:115], v58 offset:2304
    ds_read_b128 v[160:163], v59 offset:2272
    s_waitcnt lgkmcnt(8)
    v_mfma_f32_32x32x16_bf16 v[88:103], v[120:123], v[168:171], v[88:103]
    ds_read_b128 v[116:119], v58 offset:2336
    ds_read_b128 v[164:167], v59 offset:2240
    s_waitcnt lgkmcnt(8)
    v_mfma_f32_32x32x16_bf16 v[88:103], v[124:127], v[172:175], v[88:103]
    ds_read_b128 v[120:123], v58 offset:2368
    ds_read_b128 v[168:171], v59 offset:2192
    s_waitcnt lgkmcnt(8)
    v_mfma_f32_32x32x16_bf16 v[88:103], v[104:107], v[152:155], v[88:103]
    ds_read_b128 v[124:127], v58 offset:2400
    ds_read_b128 v[172:175], v59 offset:2160
    s_waitcnt lgkmcnt(8)
    v_mfma_f32_32x32x16_bf16 v[88:103], v[108:111], v[156:159], v[88:103]
    ds_read_b128 v[104:107], v58 offset:2432
    ds_read_b128 v[152:155], v59 offset:2112
    s_waitcnt lgkmcnt(8)
    v_mfma_f32_32x32x16_bf16 v[88:103], v[112:115], v[160:163], v[88:103]
    ds_read_b128 v[108:111], v58 offset:2464
    ds_read_b128 v[156:159], v59 offset:2080
    s_waitcnt lgkmcnt(8)
    v_mfma_f32_32x32x16_bf16 v[88:103], v[116:119], v[164:167], v[88:103]
    ds_read_b128 v[112:115], v58 offset:2496
    ds_read_b128 v[160:163], v59 offset:2032
    s_waitcnt lgkmcnt(8)
    v_mfma_f32_32x32x16_bf16 v[88:103], v[120:123], v[168:171], v[88:103]
    ds_read_b128 v[116:119], v58 offset:2528
    ds_read_b128 v[164:167], v59 offset:2000
    s_waitcnt lgkmcnt(8)
    v_mfma_f32_32x32x16_bf16 v[88:103], v[124:127], v[172:175], v[88:103]
    ds_read_b128 v[120:123], v58 offset:2560
    ds_read_b128 v[168:171], v59 offset:1952
    s_waitcnt lgkmcnt(8)
    v_mfma_f32_32x32x16_bf16 v[88:103], v[104:107], v[152:155], v[88:103]
    ds_read_b128 v[124:127], v58 offset:2592
    ds_read_b128 v[172:175], v59 offset:1920
    s_waitcnt lgkmcnt(8)
    v_mfma_f32_32x32x16_bf16 v[88:103], v[108:111], v[156:159], v[88:103]
    ds_read_b128 v[104:107], v58 offset:2624
    ds_read_b128 v[152:155], v59 offset:1872
    s_waitcnt lgkmcnt(8)
    v_mfma_f32_32x32x16_bf16 v[88:103], v[112:115], v[160:163], v[88:103]
    ds_read_b128 v[108:111], v58 offset:2656
    ds_read_b128 v[156:159], v59 offset:1840
    s_waitcnt lgkmcnt(8)
    v_mfma_f32_32x32x16_bf16 v[88:103], v[116:119], v[164:167], v[88:103]
    ds_read_b128 v[112:115], v58 offset:2688
    ds_read_b128 v[160:163], v59 offset:1792
    s_waitcnt lgkmcnt(8)
    v_mfma_f32_32x32x16_bf16 v[88:103], v[120:123], v[168:171], v[88:103]
    ds_read_b128 v[116:119], v58 offset:2720
    ds_read_b128 v[164:167], v59 offset:1760
    s_waitcnt lgkmcnt(8)
    v_mfma_f32_32x32x16_bf16 v[88:103], v[124:127], v[172:175], v[88:103]
    ds_read_b128 v[120:123], v58 offset:2752
    ds_read_b128 v[168:171], v59 offset:1712
    s_waitcnt lgkmcnt(8)
    v_mfma_f32_32x32x16_bf16 v[88:103], v[104:107], v[152:155], v[88:103]
    ds_read_b128 v[124:127], v58 offset:2784
    ds_read_b128 v[172:175], v59 offset:1680
    s_waitcnt lgkmcnt(8)
    v_mfma_f32_32x32x16_bf16 v[88:103], v[108:111], v[156:159], v[88:103]
    ds_read_b128 v[104:107], v58 offset:2816
    ds_read_b128 v[152:155], v59 offset:1632
    s_waitcnt lgkmcnt(8)
    v_mfma_f32_32x32x16_bf16 v[88:103], v[112:115], v[160:163], v[88:103]
    ds_read_b128 v[108:111], v58 offset:2848
    ds_read_b128 v[156:159], v59 offset:1600
    s_waitcnt lgkmcnt(8)
    v_mfma_f32_32x32x16_bf16 v[88:103], v[116:119], v[164:167], v[88:103]
    ds_read_b128 v[112:115], v58 offset:2880
    ds_read_b128 v[160:163], v59 offset:1552
    s_waitcnt lgkmcnt(8)
    v_mfma_f32_32x32x16_bf16 v[88:103], v[120:123], v[168:171], v[88:103]
    ds_read_b128 v[116:119], v58 offset:2912
    ds_read_b128 v[164:167], v59 offset:1520
    s_waitcnt lgkmcnt(8)
    v_mfma_f32_32x32x16_bf16 v[88:103], v[124:127], v[172:175], v[88:103]
    ds_read_b128 v[120:123], v58 offset:2944
    ds_read_b128 v[168:171], v59 offset:1472
    s_waitcnt lgkmcnt(8)
    v_mfma_f32_32x32x16_bf16 v[88:103], v[104:107], v[152:155], v[88:103]
    ds_read_b128 v[124:127], v58 offset:2976
    ds_read_b128 v[172:175], v59 offset:1440
    s_waitcnt lgkmcnt(8)
    v_mfma_f32_32x32x16_bf16 v[88:103], v[108:111], v[156:159], v[88:103]
    ds_read_b128 v[104:107], v58 offset:3008
    ds_read_b128 v[152:155], v59 offset:1392
    s_waitcnt lgkmcnt(8)
    v_mfma_f32_32x32x16_bf16 v[88:103], v[112:115], v[160:163], v[88:103]
    ds_read_b128 v[108:111], v58 offset:3040
    ds_read_b128 v[156:159], v59 offset:1360
    s_waitcnt lgkmcnt(8)
    v_mfma_f32_32x32x16_bf16 v[88:103], v[116:119], v[164:167], v[88:103]
    s_waitcnt lgkmcnt(6)
    v_mfma_f32_32x32x16_bf16 v[88:103], v[120:123], v[168:171], v[88:103]
    s_waitcnt lgkmcnt(4)
    v_mfma_f32_32x32x16_bf16 v[88:103], v[124:127], v[172:175], v[88:103]
    s_waitcnt lgkmcnt(2)
    v_mfma_f32_32x32x16_bf16 v[88:103], v[104:107], v[152:155], v[88:103]
    s_waitcnt lgkmcnt(0)
    v_mfma_f32_32x32x16_bf16 v[88:103], v[108:111], v[156:159], v[88:103]
    s_nop 11
    ds_write_b128 v70, v[88:91] offset:23040
    ds_write_b128 v70, v[92:95] offset:23072
    ds_write_b128 v70, v[96:99] offset:23104
    ds_write_b128 v70, v[100:103] offset:23136
    s_branch c_pw_end_28
c_pw_31:
    ds_read_b128 v[104:107], v58 offset:3072
    ds_read_b128 v[152:155], v59 offset:1312
    ds_read_b128 v[108:111], v58 offset:3104
    ds_read_b128 v[156:159], v59 offset:1280
    ds_read_b128 v[112:115], v58 offset:3136
    ds_read_b128 v[160:163], v59 offset:1232
    ds_read_b128 v[116:119], v58 offset:3168
    ds_read_b128 v[164:167], v59 offset:1200
    ds_read_b128 v[120:123], v58 offset:3200
    ds_read_b128 v[168:171], v59 offset:1152
    s_waitcnt lgkmcnt(8)
    v_mfma_f32_32x32x16_bf16 v[88:103], v[104:107], v[152:155], 0
    ds_read_b128 v[124:127], v58 offset:3232
    ds_read_b128 v[172:175], v59 offset:1120
    s_waitcnt lgkmcnt(8)
    v_mfma_f32_32x32x16_bf16 v[88:103], v[108:111], v[156:159], v[88:103]
    ds_read_b128 v[104:107], v58 offset:3264
    ds_read_b128 v[152:155], v59 offset:1072
    s_waitcnt lgkmcnt(8)
    v_mfma_f32_32x32x16_bf16 v[88:103], v[112:115], v[160:163], v[88:103]
    ds_read_b128 v[108:111], v58 offset:3296
    ds_read_b128 v[156:159], v59 offset:1040
    s_waitcnt lgkmcnt(8)
    v_mfma_f32_32x32x16_bf16 v[88:103], v[116:119], v[164:167], v[88:103]
    ds_read_b128 v[112:115], v58 offset:3328
    ds_read_b128 v[160:163], v59 offset:992
    s_waitcnt lgkmcnt(8)
    v_mfma_f32_32x32x16_bf16 v[88:103], v[120:123], v[168:171], v[88:103]
    ds_read_b128 v[116:119], v58 offset:3360
    ds_read_b128 v[164:167], v59 offset:960
    s_waitcnt lgkmcnt(8)
    v_mfma_f32_32x32x16_bf16 v[88:103], v[124:127], v[172:175], v[88:103]
    ds_read_b128 v[120:123], v58 offset:3392
    ds_read_b128 v[168:171], v59 offset:912
    s_waitcnt lgkmcnt(8)
    v_mfma_f32_32x32x16_bf16 v[88:103], v[104:107], v[152:155], v[88:103]
    ds_read_b128 v[124:127], v58 offset:3424
    ds_read_b128 v[172:175], v59 offset:880
    s_waitcnt lgkmcnt(8)
    v_mfma_f32_32x32x16_bf16 v[88:103], v[108:111], v[156:159], v[88:103]
    ds_read_b128 v[104:107], v58 offset:3456
    ds_read_b128 v[152:155], v59 offset:832
    s_waitcnt lgkmcnt(8)
    v_mfma_f32_32x32x16_bf16 v[88:103], v[112:115], v[160:163], v[88:103]
    ds_read_b128 v[108:111], v58 offset:3488
    ds_read_b128 v[156:159], v59 offset:800
    s_waitcnt lgkmcnt(8)
    v_mfma_f32_32x32x16_bf16 v[88:103], v[116:119], v[164:167], v[88:103]
    ds_read_b128 v[112:115], v58 offset:3520
    ds_read_b128 v[160:163], v59 offset:752
    s_waitcnt lgkmcnt(8)
    v_mfma_f32_32x32x16_bf16 v[88:103], v[120:123], v[168:171], v[88:103]
    ds_read_b128 v[116:119], v58 offset:3552
    ds_read_b128 v[164:167], v59 offset:720
    s_waitcnt lgkmcnt(8)
    v_mfma_f32_32x32x16_bf16 v[88:103], v[124:127], v[172:175], v[88:103]
    ds_read_b128 v[120:123], v58 offset:3584
    ds_read_b128 v[168:171], v59 offset:672
    s_waitcnt lgkmcnt(8)
    v_mfma_f32_32x32x16_bf16 v[88:103], v[104:107], v[152:155], v[88:103]
    ds_read_b128 v[124:127], v58 offset:3616
    ds_read_b128 v[172:175], v59 offset:640
    s_waitcnt lgkmcnt(8)
    v_mfma_f32_32x32x16_bf16 v[88:103], v[108:111], v[156:159], v[88:103]
    ds_read_b128 v[104:107], v58 offset:3648
    ds_read_b128 v[152:155], v59 offset:592
    s_waitcnt lgkmcnt(8)
    v_mfma_f32_32x32x16_bf16 v[88:103], v[112:115], v[160:163], v[88:103]
    ds_read_b128 v[108:111], v58 offset:3680
    ds_read_b128 v[156:159], v59 offset:560
    s_waitcnt lgkmcnt(8)
    v_mfma_f32_32x32x16_bf16 v[88:103], v[116:119], v[164:167], v[88:103]
    ds_read_b128 v[112:115], v58 offset:3712
    ds_read_b128 v[160:163], v59 offset:512
    s_waitcnt lgkmcnt(8)
    v_mfma_f32_32x32x16_bf16 v[88:103], v[120:123], v[168:171], v[88:103]
    ds_read_b128 v[116:119], v58 offset:3744
    ds_read_b128 v[164:167], v59 offset:480
    s_waitcnt lgkmcnt(8)
    v_mfma_f32_32x32x16_bf16 v[88:103], v[124:127], v[172:175], v[88:103]
    ds_read_b128 v[120:123], v58 offset:3776
    ds_read_b128 v[168:171], v59 offset:432
    s_waitcnt lgkmcnt(8)
    v_mfma_f32_32x32x16_bf16 v[88:103], v[104:107], v[152:155], v[88:103]
    ds_read_b128 v[124:127], v58 offset:3808
    ds_read_b128 v[172:175], v59 offset:400
    s_waitcnt lgkmcnt(8)
    v_mfma_f32_32x32x16_bf16 v[88:103], v[108:111], v[156:159], v[88:103]
    ds_read_b128 v[104:107], v58 offset:3840
    ds_read_b128 v[152:155], v59 offset:352
    s_waitcnt lgkmcnt(8)
    v_mfma_f32_32x32x16_bf16 v[88:103], v[112:115], v[160:163], v[88:103]
    ds_read_b128 v[108:111], v58 offset:3872
    ds_read_b128 v[156:159], v59 offset:320
    s_waitcnt lgkmcnt(8)
    v_mfma_f32_32x32x16_bf16 v[88:103], v[116:119], v[164:167], v[88:103]
    ds_read_b128 v[112:115], v58 offset:3904
    ds_read_b128 v[160:163], v59 offset:272
    s_waitcnt lgkmcnt(8)
    v_mfma_f32_32x32x16_bf16 v[88:103], v[120:123], v[168:171], v[88:103]
    ds_read_b128 v[116:119], v58 offset:3936
    ds_read_b128 v[164:167], v59 offset:240
    s_waitcnt lgkmcnt(8)
    v_mfma_f32_32x32x16_bf16 v[88:103], v[124:127], v[172:175], v[88:103]
    ds_read_b128 v[120:123], v58 offset:3968
    ds_read_b128 v[168:171], v59 offset:192
    s_waitcnt lgkmcnt(8)
    v_mfma_f32_32x32x16_bf16 v[88:103], v[104:107], v[152:155], v[88:103]
    ds_read_b128 v[124:127], v58 offset:4000
    ds_read_b128 v[172:175], v59 offset:160
    s_waitcnt lgkmcnt(8)
    v_mfma_f32_32x32x16_bf16 v[88:103], v[108:111], v[156:159], v[88:103]
    ds_read_b128 v[104:107], v58 offset:4032
    ds_read_b128 v[152:155], v59 offset:112
    s_waitcnt lgkmcnt(8)
    v_mfma_f32_32x32x16_bf16 v[88:103], v[112:115], v[160:163], v[88:103]
    ds_read_b128 v[108:111], v58 offset:4064
    ds_read_b128 v[156:159], v59 offset:80
    s_waitcnt lgkmcnt(8)
    v_mfma_f32_32x32x16_bf16 v[88:103], v[116:119], v[164:167], v[88:103]
    s_waitcnt lgkmcnt(6)
    v_mfma_f32_32x32x16_bf16 v[88:103], v[120:123], v[168:171], v[88:103]
    s_waitcnt lgkmcnt(4)
    v_mfma_f32_32x32x16_bf16 v[88:103], v[124:127], v[172:175], v[88:103]
    s_waitcnt lgkmcnt(2)
    v_mfma_f32_32x32x16_bf16 v[88:103], v[104:107], v[152:155], v[88:103]
    s_waitcnt lgkmcnt(0)
    v_mfma_f32_32x32x16_bf16 v[88:103], v[108:111], v[156:159], v[88:103]
    s_nop 11
    ds_write_b128 v70, v[88:91] offset:27648
    ds_write_b128 v70, v[92:95] offset:27680
    ds_write_b128 v70, v[96:99] offset:27712
    ds_write_b128 v70, v[100:103] offset:27744
c_pw_end_28:
    s_waitcnt lgkmcnt(0)
    s_barrier
    s_cmp_ge_u32 s34, 2
    s_cbranch_scc1 c_hf_33
    ds_read_b128 v[104:107], v71 offset:13824
    ds_read_b128 v[108:111], v71 offset:13840
    ds_read_b128 v[112:115], v71 offset:18432
    ds_read_b128 v[116:119], v71 offset:18448
    ds_read_b128 v[120:123], v71 offset:23040
    ds_read_b128 v[124:127], v71 offset:23056
    ds_read_b128 v[128:131], v71 offset:27648
    ds_read_b128 v[132:135], v71 offset:27664
    s_waitcnt lgkmcnt(0)
    v_pk_add_f32 v[104:105], v[104:105], v[112:113]
    v_pk_add_f32 v[106:107], v[106:107], v[114:115]
    v_pk_add_f32 v[108:109], v[108:109], v[116:117]
    v_pk_add_f32 v[110:111], v[110:111], v[118:119]
    v_pk_add_f32 v[104:105], v[104:105], v[120:121]
    v_pk_add_f32 v[106:107], v[106:107], v[122:123]
    v_pk_add_f32 v[108:109], v[108:109], v[124:125]
    v_pk_add_f32 v[110:111], v[110:111], v[126:127]
    v_pk_add_f32 v[104:105], v[104:105], v[128:129]
    v_pk_add_f32 v[106:107], v[106:107], v[130:131]
    v_pk_add_f32 v[108:109], v[108:109], v[132:133]
    v_pk_add_f32 v[110:111], v[110:111], v[134:135]
    v_cvt_pk_bf16_f32 v184, v104, v105
    v_cvt_pk_bf16_f32 v185, v106, v107
    v_cvt_pk_bf16_f32 v186, v108, v109
    v_cvt_pk_bf16_f32 v187, v110, v111
    s_lshl_b32 s40, s58, 12
    s_add_u32 s40, s40, 8914944
    v_and_b32 v3, 127, v0
    v_lshlrev_b32 v3, 4, v3
    buffer_store_dwordx4 v[184:187], v3, s[8:11], s40 offen sc1
    s_nop 1
c_hf_33:
    s_branch c_halfE_27
c_halfL_26:
    s_cmp_lg_u32 s34, 0
    s_cbranch_scc1 c_pw_35
    ds_read_b128 v[104:107], v58 offset:0
    ds_read_b128 v[128:131], v59 offset:2592
    ds_read_b128 v[108:111], v58 offset:32
    ds_read_b128 v[132:135], v59 offset:2560
    ds_read_b128 v[112:115], v58 offset:64
    ds_read_b128 v[136:139], v59 offset:2512
    ds_read_b128 v[116:119], v58 offset:96
    ds_read_b128 v[140:143], v59 offset:2480
    ds_read_b128 v[120:123], v58 offset:128
    ds_read_b128 v[144:147], v59 offset:2432
    s_waitcnt lgkmcnt(8)
    v_mfma_f32_32x32x16_bf16 v[72:87], v[104:107], v[128:131], 0
    v_mfma_f32_32x32x16_bf16 v[72:87], v[192:195], v[128:131], v[72:87]
    ds_read_b128 v[124:127], v58 offset:160
    ds_read_b128 v[148:151], v59 offset:2400
    s_waitcnt lgkmcnt(8)
    v_mfma_f32_32x32x16_bf16 v[72:87], v[108:111], v[132:135], v[72:87]
    v_mfma_f32_32x32x16_bf16 v[72:87], v[188:191], v[132:135], v[72:87]
    ds_read_b128 v[104:107], v58 offset:192
    ds_read_b128 v[128:131], v59 offset:2352
    s_waitcnt lgkmcnt(8)
    v_mfma_f32_32x32x16_bf16 v[72:87], v[112:115], v[136:139], v[72:87]
    ds_read_b128 v[108:111], v58 offset:224
    ds_read_b128 v[132:135], v59 offset:2320
    s_waitcnt lgkmcnt(8)
    v_mfma_f32_32x32x16_bf16 v[72:87], v[116:119], v[140:143], v[72:87]
    ds_read_b128 v[112:115], v58 offset:256
    ds_read_b128 v[136:139], v59 offset:2272
    s_waitcnt lgkmcnt(8)
    v_mfma_f32_32x32x16_bf16 v[72:87], v[120:123], v[144:147], v[72:87]
    ds_read_b128 v[116:119], v58 offset:288
    ds_read_b128 v[140:143], v59 offset:2240
    s_waitcnt lgkmcnt(8)
    v_mfma_f32_32x32x16_bf16 v[72:87], v[124:127], v[148:151], v[72:87]
    ds_read_b128 v[120:123], v58 offset:320
    ds_read_b128 v[144:147], v59 offset:2192
    s_waitcnt lgkmcnt(8)
    v_mfma_f32_32x32x16_bf16 v[72:87], v[104:107], v[128:131], v[72:87]
    ds_read_b128 v[124:127], v58 offset:352
    ds_read_b128 v[148:151], v59 offset:2160
    s_waitcnt lgkmcnt(8)
    v_mfma_f32_32x32x16_bf16 v[72:87], v[108:111], v[132:135], v[72:87]
    ds_read_b128 v[104:107], v58 offset:384
    ds_read_b128 v[128:131], v59 offset:2112
    s_waitcnt lgkmcnt(8)
    v_mfma_f32_32x32x16_bf16 v[72:87], v[112:115], v[136:139], v[72:87]
    ds_read_b128 v[108:111], v58 offset:416
    ds_read_b128 v[132:135], v59 offset:2080
    s_waitcnt lgkmcnt(8)
    v_mfma_f32_32x32x16_bf16 v[72:87], v[116:119], v[140:143], v[72:87]
    ds_read_b128 v[112:115], v58 offset:448
    ds_read_b128 v[136:139], v59 offset:2032
    s_waitcnt lgkmcnt(8)
    v_mfma_f32_32x32x16_bf16 v[72:87], v[120:123], v[144:147], v[72:87]
    ds_read_b128 v[116:119], v58 offset:480
    ds_read_b128 v[140:143], v59 offset:2000
    s_waitcnt lgkmcnt(8)
    v_mfma_f32_32x32x16_bf16 v[72:87], v[124:127], v[148:151], v[72:87]
    s_waitcnt lgkmcnt(6)
    v_mfma_f32_32x32x16_bf16 v[72:87], v[104:107], v[128:131], v[72:87]
    s_waitcnt lgkmcnt(4)
    v_mfma_f32_32x32x16_bf16 v[72:87], v[108:111], v[132:135], v[72:87]
    s_waitcnt lgkmcnt(2)
    v_mfma_f32_32x32x16_bf16 v[72:87], v[112:115], v[136:139], v[72:87]
    s_waitcnt lgkmcnt(0)
    v_mfma_f32_32x32x16_bf16 v[72:87], v[116:119], v[140:143], v[72:87]
    s_nop 11
    ds_write_b128 v70, v[72:75] offset:13824
    ds_write_b128 v70, v[76:79] offset:13856
    ds_write_b128 v70, v[80:83] offset:13888
    ds_write_b128 v70, v[84:87] offset:13920
    s_branch c_pw_end_34
c_pw_35:
    s_cmp_lg_u32 s34, 1
    s_cbranch_scc1 c_pw_36
    ds_read_b128 v[104:107], v58 offset:512
    ds_read_b128 v[128:131], v59 offset:1952
    ds_read_b128 v[108:111], v58 offset:544
    ds_read_b128 v[132:135], v59 offset:1920
    ds_read_b128 v[112:115], v58 offset:576
    ds_read_b128 v[136:139], v59 offset:1872
    ds_read_b128 v[116:119], v58 offset:608
    ds_read_b128 v[140:143], v59 offset:1840
    ds_read_b128 v[120:123], v58 offset:640
    ds_read_b128 v[144:147], v59 offset:1792
    s_waitcnt lgkmcnt(8)
    v_mfma_f32_32x32x16_bf16 v[72:87], v[104:107], v[128:131], 0
    ds_read_b128 v[124:127], v58 offset:672
    ds_read_b128 v[148:151], v59 offset:1760
    s_waitcnt lgkmcnt(8)
    v_mfma_f32_32x32x16_bf16 v[72:87], v[108:111], v[132:135], v[72:87]
    ds_read_b128 v[104:107], v58 offset:704
    ds_read_b128 v[128:131], v59 offset:1712
    s_waitcnt lgkmcnt(8)
    v_mfma_f32_32x32x16_bf16 v[72:87], v[112:115], v[136:139], v[72:87]
    ds_read_b128 v[108:111], v58 offset:736
    ds_read_b128 v[132:135], v59 offset:1680
    s_waitcnt lgkmcnt(8)
    v_mfma_f32_32x32x16_bf16 v[72:87], v[116:119], v[140:143], v[72:87]
    ds_read_b128 v[112:115], v58 offset:768
    ds_read_b128 v[136:139], v59 offset:1632
    s_waitcnt lgkmcnt(8)
    v_mfma_f32_32x32x16_bf16 v[72:87], v[120:123], v[144:147], v[72:87]
    ds_read_b128 v[116:119], v58 offset:800
    ds_read_b128 v[140:143], v59 offset:1600
    s_waitcnt lgkmcnt(8)
    v_mfma_f32_32x32x16_bf16 v[72:87], v[124:127], v[148:151], v[72:87]
    ds_read_b128 v[120:123], v58 offset:832
    ds_read_b128 v[144:147], v59 offset:1552
    s_waitcnt lgkmcnt(8)
    v_mfma_f32_32x32x16_bf16 v[72:87], v[104:107], v[128:131], v[72:87]
    ds_read_b128 v[124:127], v58 offset:864
    ds_read_b128 v[148:151], v59 offset:1520
    s_waitcnt lgkmcnt(8)
    v_mfma_f32_32x32x16_bf16 v[72:87], v[108:111], v[132:135], v[72:87]
    ds_read_b128 v[104:107], v58 offset:896
    ds_read_b128 v[128:131], v59 offset:1472
    s_waitcnt lgkmcnt(8)
    v_mfma_f32_32x32x16_bf16 v[72:87], v[112:115], v[136:139], v[72:87]
    ds_read_b128 v[108:111], v58 offset:928
    ds_read_b128 v[132:135], v59 offset:1440
    s_waitcnt lgkmcnt(8)
    v_mfma_f32_32x32x16_bf16 v[72:87], v[116:119], v[140:143], v[72:87]
    ds_read_b128 v[112:115], v58 offset:960
    ds_read_b128 v[136:139], v59 offset:1392
    s_waitcnt lgkmcnt(8)
    v_mfma_f32_32x32x16_bf16 v[72:87], v[120:123], v[144:147], v[72:87]
    ds_read_b128 v[116:119], v58 offset:992
    ds_read_b128 v[140:143], v59 offset:1360
    s_waitcnt lgkmcnt(8)
    v_mfma_f32_32x32x16_bf16 v[72:87], v[124:127], v[148:151], v[72:87]
    s_waitcnt lgkmcnt(6)
    v_mfma_f32_32x32x16_bf16 v[72:87], v[104:107], v[128:131], v[72:87]
    s_waitcnt lgkmcnt(4)
    v_mfma_f32_32x32x16_bf16 v[72:87], v[108:111], v[132:135], v[72:87]
    s_waitcnt lgkmcnt(2)
    v_mfma_f32_32x32x16_bf16 v[72:87], v[112:115], v[136:139], v[72:87]
    s_waitcnt lgkmcnt(0)
    v_mfma_f32_32x32x16_bf16 v[72:87], v[116:119], v[140:143], v[72:87]
    s_nop 11
    ds_write_b128 v70, v[72:75] offset:18432
    ds_write_b128 v70, v[76:79] offset:18464
    ds_write_b128 v70, v[80:83] offset:18496
    ds_write_b128 v70, v[84:87] offset:18528
    s_branch c_pw_end_34
c_pw_36:
    s_cmp_lg_u32 s34, 2
    s_cbranch_scc1 c_pw_37
    ds_read_b128 v[104:107], v58 offset:1024
    ds_read_b128 v[128:131], v59 offset:1312
    ds_read_b128 v[108:111], v58 offset:1056
    ds_read_b128 v[132:135], v59 offset:1280
    ds_read_b128 v[112:115], v58 offset:1088
    ds_read_b128 v[136:139], v59 offset:1232
    ds_read_b128 v[116:119], v58 offset:1120
    ds_read_b128 v[140:143], v59 offset:1200
    ds_read_b128 v[120:123], v58 offset:1152
    ds_read_b128 v[144:147], v59 offset:1152
    s_waitcnt lgkmcnt(8)
    v_mfma_f32_32x32x16_bf16 v[72:87], v[104:107], v[128:131], 0
    ds_read_b128 v[124:127], v58 offset:1184
    ds_read_b128 v[148:151], v59 offset:1120
    s_waitcnt lgkmcnt(8)
    v_mfma_f32_32x32x16_bf16 v[72:87], v[108:111], v[132:135], v[72:87]
    ds_read_b128 v[104:107], v58 offset:1216
    ds_read_b128 v[128:131], v59 offset:1072
    s_waitcnt lgkmcnt(8)
    v_mfma_f32_32x32x16_bf16 v[72:87], v[112:115], v[136:139], v[72:87]
    ds_read_b128 v[108:111], v58 offset:1248
    ds_read_b128 v[132:135], v59 offset:1040
    s_waitcnt lgkmcnt(8)
    v_mfma_f32_32x32x16_bf16 v[72:87], v[116:119], v[140:143], v[72:87]
    ds_read_b128 v[112:115], v58 offset:1280
    ds_read_b128 v[136:139], v59 offset:992
    s_waitcnt lgkmcnt(8)
    v_mfma_f32_32x32x16_bf16 v[72:87], v[120:123], v[144:147], v[72:87]
    ds_read_b128 v[116:119], v58 offset:1312
    ds_read_b128 v[140:143], v59 offset:960
    s_waitcnt lgkmcnt(8)
    v_mfma_f32_32x32x16_bf16 v[72:87], v[124:127], v[148:151], v[72:87]
    ds_read_b128 v[120:123], v58 offset:1344
    ds_read_b128 v[144:147], v59 offset:912
    s_waitcnt lgkmcnt(8)
    v_mfma_f32_32x32x16_bf16 v[72:87], v[104:107], v[128:131], v[72:87]
    ds_read_b128 v[124:127], v58 offset:1376
    ds_read_b128 v[148:151], v59 offset:880
    s_waitcnt lgkmcnt(8)
    v_mfma_f32_32x32x16_bf16 v[72:87], v[108:111], v[132:135], v[72:87]
    ds_read_b128 v[104:107], v58 offset:1408
    ds_read_b128 v[128:131], v59 offset:832
    s_waitcnt lgkmcnt(8)
    v_mfma_f32_32x32x16_bf16 v[72:87], v[112:115], v[136:139], v[72:87]
    ds_read_b128 v[108:111], v58 offset:1440
    ds_read_b128 v[132:135], v59 offset:800
    s_waitcnt lgkmcnt(8)
    v_mfma_f32_32x32x16_bf16 v[72:87], v[116:119], v[140:143], v[72:87]
    ds_read_b128 v[112:115], v58 offset:1472
    ds_read_b128 v[136:139], v59 offset:752
    s_waitcnt lgkmcnt(8)
    v_mfma_f32_32x32x16_bf16 v[72:87], v[120:123], v[144:147], v[72:87]
    ds_read_b128 v[116:119], v58 offset:1504
    ds_read_b128 v[140:143], v59 offset:720
    s_waitcnt lgkmcnt(8)
    v_mfma_f32_32x32x16_bf16 v[72:87], v[124:127], v[148:151], v[72:87]
    s_waitcnt lgkmcnt(6)
    v_mfma_f32_32x32x16_bf16 v[72:87], v[104:107], v[128:131], v[72:87]
    s_waitcnt lgkmcnt(4)
    v_mfma_f32_32x32x16_bf16 v[72:87], v[108:111], v[132:135], v[72:87]
    s_waitcnt lgkmcnt(2)
    v_mfma_f32_32x32x16_bf16 v[72:87], v[112:115], v[136:139], v[72:87]
    s_waitcnt lgkmcnt(0)
    v_mfma_f32_32x32x16_bf16 v[72:87], v[116:119], v[140:143], v[72:87]
    s_nop 11
    ds_write_b128 v70, v[72:75] offset:23040
    ds_write_b128 v70, v[76:79] offset:23072
    ds_write_b128 v70, v[80:83] offset:23104
    ds_write_b128 v70, v[84:87] offset:23136
    s_branch c_pw_end_34
c_pw_37:
    ds_read_b128 v[104:107], v58 offset:1536
    ds_read_b128 v[128:131], v59 offset:672
    ds_read_b128 v[108:111], v58 offset:1568
    ds_read_b128 v[132:135], v59 offset:640
    ds_read_b128 v[112:115], v58 offset:1600
    ds_read_b128 v[136:139], v59 offset:592
    ds_read_b128 v[116:119], v58 offset:1632
    ds_read_b128 v[140:143], v59 offset:560
    ds_read_b128 v[120:123], v58 offset:1664
    ds_read_b128 v[144:147], v59 offset:512
    s_waitcnt lgkmcnt(8)
    v_mfma_f32_32x32x16_bf16 v[72:87], v[104:107], v[128:131], 0
    ds_read_b128 v[124:127], v58 offset:1696
    ds_read_b128 v[148:151], v59 offset:480
    s_waitcnt lgkmcnt(8)
    v_mfma_f32_32x32x16_bf16 v[72:87], v[108:111], v[132:135], v[72:87]
    ds_read_b128 v[104:107], v58 offset:1728
    ds_read_b128 v[128:131], v59 offset:432
    s_waitcnt lgkmcnt(8)
    v_mfma_f32_32x32x16_bf16 v[72:87], v[112:115], v[136:139], v[72:87]
    ds_read_b128 v[108:111], v58 offset:1760
    ds_read_b128 v[132:135], v59 offset:400
    s_waitcnt lgkmcnt(8)
    v_mfma_f32_32x32x16_bf16 v[72:87], v[116:119], v[140:143], v[72:87]
    ds_read_b128 v[112:115], v58 offset:1792
    ds_read_b128 v[136:139], v59 offset:352
    s_waitcnt lgkmcnt(8)
    v_mfma_f32_32x32x16_bf16 v[72:87], v[120:123], v[144:147], v[72:87]
    ds_read_b128 v[116:119], v58 offset:1824
    ds_read_b128 v[140:143], v59 offset:320
    s_waitcnt lgkmcnt(8)
    v_mfma_f32_32x32x16_bf16 v[72:87], v[124:127], v[148:151], v[72:87]
    ds_read_b128 v[120:123], v58 offset:1856
    ds_read_b128 v[144:147], v59 offset:272
    s_waitcnt lgkmcnt(8)
    v_mfma_f32_32x32x16_bf16 v[72:87], v[104:107], v[128:131], v[72:87]
    ds_read_b128 v[124:127], v58 offset:1888
    ds_read_b128 v[148:151], v59 offset:240
    s_waitcnt lgkmcnt(8)
    v_mfma_f32_32x32x16_bf16 v[72:87], v[108:111], v[132:135], v[72:87]
    ds_read_b128 v[104:107], v58 offset:1920
    ds_read_b128 v[128:131], v59 offset:192
    s_waitcnt lgkmcnt(8)
    v_mfma_f32_32x32x16_bf16 v[72:87], v[112:115], v[136:139], v[72:87]
    ds_read_b128 v[108:111], v58 offset:1952
    ds_read_b128 v[132:135], v59 offset:160
    s_waitcnt lgkmcnt(8)
    v_mfma_f32_32x32x16_bf16 v[72:87], v[116:119], v[140:143], v[72:87]
    ds_read_b128 v[112:115], v58 offset:1984
    ds_read_b128 v[136:139], v59 offset:112
    s_waitcnt lgkmcnt(8)
    v_mfma_f32_32x32x16_bf16 v[72:87], v[120:123], v[144:147], v[72:87]
    ds_read_b128 v[116:119], v58 offset:2016
    ds_read_b128 v[140:143], v59 offset:80
    s_waitcnt lgkmcnt(8)
    v_mfma_f32_32x32x16_bf16 v[72:87], v[124:127], v[148:151], v[72:87]
    s_waitcnt lgkmcnt(6)
    v_mfma_f32_32x32x16_bf16 v[72:87], v[104:107], v[128:131], v[72:87]
    s_waitcnt lgkmcnt(4)
    v_mfma_f32_32x32x16_bf16 v[72:87], v[108:111], v[132:135], v[72:87]
    s_waitcnt lgkmcnt(2)
    v_mfma_f32_32x32x16_bf16 v[72:87], v[112:115], v[136:139], v[72:87]
    s_waitcnt lgkmcnt(0)
    v_mfma_f32_32x32x16_bf16 v[72:87], v[116:119], v[140:143], v[72:87]
    s_nop 11
    ds_write_b128 v70, v[72:75] offset:27648
    ds_write_b128 v70, v[76:79] offset:27680
    ds_write_b128 v70, v[80:83] offset:27712
    ds_write_b128 v70, v[84:87] offset:27744
c_pw_end_34:
    s_waitcnt lgkmcnt(0)
    s_barrier
    s_cmp_ge_u32 s34, 2
    s_cbranch_scc1 c_hf_39
    ds_read_b128 v[104:107], v71 offset:13824
    ds_read_b128 v[108:111], v71 offset:13840
    ds_read_b128 v[112:115], v71 offset:18432
    ds_read_b128 v[116:119], v71 offset:18448
    ds_read_b128 v[120:123], v71 offset:23040
    ds_read_b128 v[124:127], v71 offset:23056
    ds_read_b128 v[128:131], v71 offset:27648
    ds_read_b128 v[132:135], v71 offset:27664
    s_waitcnt lgkmcnt(0)
    v_pk_add_f32 v[104:105], v[104:105], v[112:113]
    v_pk_add_f32 v[106:107], v[106:107], v[114:115]
    v_pk_add_f32 v[108:109], v[108:109], v[116:117]
    v_pk_add_f32 v[110:111], v[110:111], v[118:119]
    v_pk_add_f32 v[104:105], v[104:105], v[120:121]
    v_pk_add_f32 v[106:107], v[106:107], v[122:123]
    v_pk_add_f32 v[108:109], v[108:109], v[124:125]
    v_pk_add_f32 v[110:111], v[110:111], v[126:127]
    v_pk_add_f32 v[104:105], v[104:105], v[128:129]
    v_pk_add_f32 v[106:107], v[106:107], v[130:131]
    v_pk_add_f32 v[108:109], v[108:109], v[132:133]
    v_pk_add_f32 v[110:111], v[110:111], v[134:135]
    v_cvt_pk_bf16_f32 v184, v104, v105
    v_cvt_pk_bf16_f32 v185, v106, v107
    v_cvt_pk_bf16_f32 v186, v108, v109
    v_cvt_pk_bf16_f32 v187, v110, v111
    s_lshl_b32 s40, s58, 12
    s_add_u32 s40, s40, 8912896
    v_and_b32 v3, 127, v0
    v_lshlrev_b32 v3, 4, v3
    buffer_store_dwordx4 v[184:187], v3, s[8:11], s40 offen sc1
    s_nop 1
c_hf_39:
c_halfE_27:
k2_kernel_end:
    s_endpgm

.globl k3_kernel
.p2align 8
.type k3_kernel,@function
k3_kernel:
    s_cmp_ge_u32 s2, 256
    s_cbranch_scc1 k3_kernel_end
    s_load_dwordx2 s[12:13], s[0:1], 104
    s_load_dwordx2 s[8:9], s[0:1], 0
    s_load_dwordx2 s[16:17], s[0:1], 88
    s_mov_b32 s10, 2621440
    s_mov_b32 s11, 0x20000
    s_mov_b32 s14, 15990784
    s_mov_b32 s15, 0x20000
    s_mov_b32 s18, 2621440
    s_mov_b32 s19, 0x20000
    v_lshrrev_b32 v4, 6, v0
    v_and_b32 v1, 63, v0
    v_readfirstlane_b32 s34, v4
    v_lshlrev_b32 v7, 4, v1
    s_and_b32 s40, s2, 7
    s_lshr_b32 s41, s2, 3
    s_lshr_b32 s32, s40, 1
    s_lshl_b32 s32, s32, 3
    s_and_b32 s42, s41, 7
    s_add_u32 s32, s32, s42
    s_and_b32 s33, s40, 1
    s_lshl_b32 s33, s33, 2
    s_lshr_b32 s42, s41, 3
    s_add_u32 s33, s33, s42
    s_add_u32 s40, s32, s33
    s_mul_i32 s41, s40, 43
    s_lshr_b32 s41, s41, 8
    s_mul_i32 s41, s41, 6
    s_sub_u32 s48, s40, s41
    s_mul_i32 s46, s33, 122880
    s_add_u32 s46, s46, 15007744
    s_mul_i32 s40, s34, 5120
    s_add_u32 s46, s46, s40
    s_mul_i32 s47, s32, 98304
    s_mul_i32 s41, s34, 24576
    s_add_u32 s47, s47, s41
    s_add_u32 s47, s47, 11534336
    s_add_u32 s40, s48, 0
    s_sub_u32 s41, s40, 6
    s_cmp_ge_u32 s40, 6
    s_cselect_b32 s50, s41, s40
    s_add_u32 s40, s48, 1
    s_sub_u32 s41, s40, 6
    s_cmp_ge_u32 s40, 6
    s_cselect_b32 s51, s41, s40
    s_add_u32 s40, s48, 2
    s_sub_u32 s41, s40, 6
    s_cmp_ge_u32 s40, 6
    s_cselect_b32 s52, s41, s40
    s_add_u32 s40, s48, 3
    s_sub_u32 s41, s40, 6
    s_cmp_ge_u32 s40, 6
    s_cselect_b32 s53, s41, s40
    s_add_u32 s40, s48, 4
    s_sub_u32 s41, s40, 6
    s_cmp_ge_u32 s40, 6
    s_cselect_b32 s54, s41, s40
    s_add_u32 s40, s48, 5
    s_sub_u32 s41, s40, 6
    s_cmp_ge_u32 s40, 6
    s_cselect_b32 s55, s41, s40
    s_waitcnt lgkmcnt(0)
    s_mul_i32 s40, s50, 20480
    s_add_u32 s40, s40, s46
    s_add_u32 s40, s40, 0
    s_mul_i32 s41, s34, 5120
    s_add_u32 m0, s41, 0
    s_nop 0
    buffer_load_dwordx4 v7, s[12:15], s40 offen lds
    s_mul_i32 s40, s50, 20480
    s_add_u32 s40, s40, s46
    s_add_u32 s40, s40, 1024
    s_mul_i32 s41, s34, 5120
    s_add_u32 m0, s41, 1024
    s_nop 0
    buffer_load_dwordx4 v7, s[12:15], s40 offen lds
    s_mul_i32 s40, s50, 20480
    s_add_u32 s40, s40, s46
    s_add_u32 s40, s40, 2048
    s_mul_i32 s41, s34, 5120
    s_add_u32 m0, s41, 2048
    s_nop 0
    buffer_load_dwordx4 v7, s[12:15], s40 offen lds
    s_mul_i32 s40, s50, 20480
    s_add_u32 s40, s40, s46
    s_add_u32 s40, s40, 3072
    s_mul_i32 s41, s34, 5120
    s_add_u32 m0, s41, 3072
    s_nop 0
    buffer_load_dwordx4 v7, s[12:15], s40 offen lds
    s_mul_i32 s40, s50, 20480
    s_add_u32 s40, s40, s46
    s_add_u32 s40, s40, 4096
    s_mul_i32 s41, s34, 5120
    s_add_u32 m0, s41, 4096
    s_nop 0
    buffer_load_dwordx4 v7, s[12:15], s40 offen lds
    s_lshl_b32 s42, s50, 12
    s_add_u32 s42, s42, s47
    buffer_load_dwordx4 v[8:11], v7, s[12:15], s42 offen offset:0
    s_lshl_b32 s42, s50, 12
    s_add_u32 s42, s42, s47
    buffer_load_dwordx4 v[12:15], v7, s[12:15], s42 offen offset:1024
    s_lshl_b32 s42, s50, 12
    s_add_u32 s42, s42, s47
    buffer_load_dwordx4 v[16:19], v7, s[12:15], s42 offen offset:2048
    s_lshl_b32 s42, s50, 12
    s_add_u32 s42, s42, s47
    buffer_load_dwordx4 v[20:23], v7, s[12:15], s42 offen offset:3072
    s_barrier
    s_mul_i32 s40, s51, 20480
    s_add_u32 s40, s40, s46
    s_add_u32 s40, s40, 0
    s_mul_i32 s41, s34, 5120
    s_add_u32 m0, s41, 20480
    s_nop 0
    buffer_load_dwordx4 v7, s[12:15], s40 offen lds
    s_mul_i32 s40, s51, 20480
    s_add_u32 s40, s40, s46
    s_add_u32 s40, s40, 1024
    s_mul_i32 s41, s34, 5120
    s_add_u32 m0, s41, 21504
    s_nop 0
    buffer_load_dwordx4 v7, s[12:15], s40 offen lds
    s_mul_i32 s40, s51, 20480
    s_add_u32 s40, s40, s46
    s_add_u32 s40, s40, 2048
    s_mul_i32 s41, s34, 5120
    s_add_u32 m0, s41, 22528
    s_nop 0
    buffer_load_dwordx4 v7, s[12:15], s40 offen lds
    s_mul_i32 s40, s51, 20480
    s_add_u32 s40, s40, s46
    s_add_u32 s40, s40, 3072
    s_mul_i32 s41, s34, 5120
    s_add_u32 m0, s41, 23552
    s_nop 0
    buffer_load_dwordx4 v7, s[12:15], s40 offen lds
    s_mul_i32 s40, s51, 20480
    s_add_u32 s40, s40, s46
    s_add_u32 s40, s40, 4096
    s_mul_i32 s41, s34, 5120
    s_add_u32 m0, s41, 24576
    s_nop 0
    buffer_load_dwordx4 v7, s[12:15], s40 offen lds
    s_lshl_b32 s42, s51, 12
    s_add_u32 s42, s42, s47
    buffer_load_dwordx4 v[24:27], v7, s[12:15], s42 offen offset:0
    s_lshl_b32 s42, s51, 12
    s_add_u32 s42, s42, s47
    buffer_load_dwordx4 v[28:31], v7, s[12:15], s42 offen offset:1024
    s_lshl_b32 s42, s51, 12
    s_add_u32 s42, s42, s47
    buffer_load_dwordx4 v[32:35], v7, s[12:15], s42 offen offset:2048
    s_lshl_b32 s42, s51, 12
    s_add_u32 s42, s42, s47
    buffer_load_dwordx4 v[36:39], v7, s[12:15], s42 offen offset:3072
    s_mul_i32 s44, s33, 160
    s_mul_i32 s45, s32, 81920
    s_add_u32 s45, s45, s44
    v_add_u32 v4, 0, v1
    v_mul_u32_u24 v5, 6554, v4
    v_lshrrev_b32 v5, 16, v5
    v_mul_u32_u24 v6, 10, v5
    v_sub_u32 v4, v4, v6
    v_lshlrev_b32 v4, 4, v4
    v_mul_u32_u24 v5, 1280, v5
    v_add_u32 v104, v4, v5
    v_add_u32 v4, 64, v1
    v_mul_u32_u24 v5, 6554, v4
    v_lshrrev_b32 v5, 16, v5
    v_mul_u32_u24 v6, 10, v5
    v_sub_u32 v4, v4, v6
    v_lshlrev_b32 v4, 4, v4
    v_mul_u32_u24 v5, 1280, v5
    v_add_u32 v105, v4, v5
    v_add_u32 v4, 128, v1
    v_mul_u32_u24 v5, 6554, v4
    v_lshrrev_b32 v5, 16, v5
    v_mul_u32_u24 v6, 10, v5
    v_sub_u32 v4, v4, v6
    v_lshlrev_b32 v4, 4, v4
    v_mul_u32_u24 v5, 1280, v5
    v_add_u32 v106, v4, v5
    v_add_u32 v4, 192, v1
    v_mul_u32_u24 v5, 6554, v4
    v_lshrrev_b32 v5, 16, v5
    v_mul_u32_u24 v6, 10, v5
    v_sub_u32 v4, v4, v6
    v_lshlrev_b32 v4, 4, v4
    v_mul_u32_u24 v5, 1280, v5
    v_add_u32 v107, v4, v5
    v_add_u32 v4, 256, v1
    v_mul_u32_u24 v5, 6554, v4
    v_lshrrev_b32 v5, 16, v5
    v_mul_u32_u24 v6, 10, v5
    v_sub_u32 v4, v4, v6
    v_lshlrev_b32 v4, 4, v4
    v_mul_u32_u24 v5, 1280, v5
    v_add_u32 v108, v4, v5
    v_lshrrev_b32 v2, 4, v1
    v_and_b32 v3, 15, v1
    v_mov_b32 v113, v7
    v_add_u32 v114, 61440, v7
    s_waitcnt vmcnt(13)
    s_barrier
    ds_read_b128 v[136:139], v113 offset:0
    ds_read_b128 v[140:143], v113 offset:1024
    ds_read_b128 v[144:147], v113 offset:2048
    ds_read_b128 v[148:151], v113 offset:3072
    ds_read_b128 v[152:155], v113 offset:4096
    ds_read_b128 v[156:159], v113 offset:5120
    ds_read_b128 v[160:163], v113 offset:6144
    ds_read_b128 v[164:167], v113 offset:7168
    ds_read_b128 v[168:171], v113 offset:8192
    ds_read_b128 v[172:175], v113 offset:9216
    s_waitcnt vmcnt(12)
    s_waitcnt lgkmcnt(9)
    v_mfma_f32_16x16x32_bf16 v[116:119], v[136:139], v[8:11], 0
    s_mul_i32 s40, s52, 20480
    s_add_u32 s40, s40, s46
    s_add_u32 s40, s40, 0
    s_mul_i32 s41, s34, 5120
    s_add_u32 m0, s41, 40960
    s_nop 0
    buffer_load_dwordx4 v7, s[12:15], s40 offen lds
    s_waitcnt lgkmcnt(8)
    v_mfma_f32_16x16x32_bf16 v[120:123], v[140:143], v[8:11], 0
    s_waitcnt lgkmcnt(7)
    v_mfma_f32_16x16x32_bf16 v[124:127], v[144:147], v[8:11], 0
    s_mul_i32 s40, s52, 20480
    s_add_u32 s40, s40, s46
    s_add_u32 s40, s40, 1024
    s_mul_i32 s41, s34, 5120
    s_add_u32 m0, s41, 41984
    s_nop 0
    buffer_load_dwordx4 v7, s[12:15], s40 offen lds
    s_waitcnt lgkmcnt(6)
    v_mfma_f32_16x16x32_bf16 v[128:131], v[148:151], v[8:11], 0
    s_waitcnt lgkmcnt(5)
    v_mfma_f32_16x16x32_bf16 v[132:135], v[152:155], v[8:11], 0
    s_mul_i32 s40, s52, 20480
    s_add_u32 s40, s40, s46
    s_add_u32 s40, s40, 2048
    s_mul_i32 s41, s34, 5120
    s_add_u32 m0, s41, 43008
    s_nop 0
    buffer_load_dwordx4 v7, s[12:15], s40 offen lds
    ds_read_b128 v[136:139], v113 offset:10240
    ds_read_b128 v[140:143], v113 offset:11264
    ds_read_b128 v[144:147], v113 offset:12288
    ds_read_b128 v[148:151], v113 offset:13312
    ds_read_b128 v[152:155], v113 offset:14336
    s_waitcnt vmcnt(14)
    s_waitcnt lgkmcnt(9)
    v_mfma_f32_16x16x32_bf16 v[116:119], v[156:159], v[12:15], v[116:119]
    s_mul_i32 s40, s52, 20480
    s_add_u32 s40, s40, s46
    s_add_u32 s40, s40, 3072
    s_mul_i32 s41, s34, 5120
    s_add_u32 m0, s41, 44032
    s_nop 0
    buffer_load_dwordx4 v7, s[12:15], s40 offen lds
    s_waitcnt lgkmcnt(8)
    v_mfma_f32_16x16x32_bf16 v[120:123], v[160:163], v[12:15], v[120:123]
    s_waitcnt lgkmcnt(7)
    v_mfma_f32_16x16x32_bf16 v[124:127], v[164:167], v[12:15], v[124:127]
    s_mul_i32 s40, s52, 20480
    s_add_u32 s40, s40, s46
    s_add_u32 s40, s40, 4096
    s_mul_i32 s41, s34, 5120
    s_add_u32 m0, s41, 45056
    s_nop 0
    buffer_load_dwordx4 v7, s[12:15], s40 offen lds
    s_waitcnt lgkmcnt(6)
    v_mfma_f32_16x16x32_bf16 v[128:131], v[168:171], v[12:15], v[128:131]
    s_waitcnt lgkmcnt(5)
    v_mfma_f32_16x16x32_bf16 v[132:135], v[172:175], v[12:15], v[132:135]
    s_lshl_b32 s42, s52, 12
    s_add_u32 s42, s42, s47
    buffer_load_dwordx4 v[40:43], v7, s[12:15], s42 offen offset:0
    ds_read_b128 v[156:159], v113 offset:15360
    ds_read_b128 v[160:163], v113 offset:16384
    ds_read_b128 v[164:167], v113 offset:17408
    ds_read_b128 v[168:171], v113 offset:18432
    ds_read_b128 v[172:175], v113 offset:19456
    s_waitcnt vmcnt(16)
    s_waitcnt lgkmcnt(9)
    v_mfma_f32_16x16x32_bf16 v[116:119], v[136:139], v[16:19], v[116:119]
    s_lshl_b32 s42, s52, 12
    s_add_u32 s42, s42, s47
    buffer_load_dwordx4 v[44:47], v7, s[12:15], s42 offen offset:1024
    s_waitcnt lgkmcnt(8)
    v_mfma_f32_16x16x32_bf16 v[120:123], v[140:143], v[16:19], v[120:123]
    s_waitcnt lgkmcnt(7)
    v_mfma_f32_16x16x32_bf16 v[124:127], v[144:147], v[16:19], v[124:127]
    s_lshl_b32 s42, s52, 12
    s_add_u32 s42, s42, s47
    buffer_load_dwordx4 v[48:51], v7, s[12:15], s42 offen offset:2048
    s_waitcnt lgkmcnt(6)
    v_mfma_f32_16x16x32_bf16 v[128:131], v[148:151], v[16:19], v[128:131]
    s_waitcnt lgkmcnt(5)
    v_mfma_f32_16x16x32_bf16 v[132:135], v[152:155], v[16:19], v[132:135]
    s_lshl_b32 s42, s52, 12
    s_add_u32 s42, s42, s47
    buffer_load_dwordx4 v[52:55], v7, s[12:15], s42 offen offset:3072
    s_waitcnt vmcnt(18)
    s_waitcnt lgkmcnt(4)
    v_mfma_f32_16x16x32_bf16 v[116:119], v[156:159], v[20:23], v[116:119]
    s_waitcnt lgkmcnt(3)
    v_mfma_f32_16x16x32_bf16 v[120:123], v[160:163], v[20:23], v[120:123]
    s_waitcnt lgkmcnt(2)
    v_mfma_f32_16x16x32_bf16 v[124:127], v[164:167], v[20:23], v[124:127]
    s_waitcnt lgkmcnt(1)
    v_mfma_f32_16x16x32_bf16 v[128:131], v[168:171], v[20:23], v[128:131]
    s_waitcnt lgkmcnt(0)
    v_mfma_f32_16x16x32_bf16 v[132:135], v[172:175], v[20:23], v[132:135]
    s_waitcnt vmcnt(13)
    s_barrier
    ds_read_b128 v[136:139], v113 offset:20480
    ds_read_b128 v[140:143], v113 offset:21504
    ds_read_b128 v[144:147], v113 offset:22528
    ds_read_b128 v[148:151], v113 offset:23552
    ds_read_b128 v[152:155], v113 offset:24576
    ds_read_b128 v[156:159], v113 offset:25600
    ds_read_b128 v[160:163], v113 offset:26624
    ds_read_b128 v[164:167], v113 offset:27648
    ds_read_b128 v[168:171], v113 offset:28672
    ds_read_b128 v[172:175], v113 offset:29696
    s_waitcnt vmcnt(12)
    s_waitcnt lgkmcnt(9)
    v_mfma_f32_16x16x32_bf16 v[116:119], v[136:139], v[24:27], v[116:119]
    s_mul_i32 s40, s53, 20480
    s_add_u32 s40, s40, s46
    s_add_u32 s40, s40, 0
    s_mul_i32 s41, s34, 5120
    s_add_u32 m0, s41, 61440
    s_nop 0
    buffer_load_dwordx4 v7, s[12:15], s40 offen lds
    s_waitcnt lgkmcnt(8)
    v_mfma_f32_16x16x32_bf16 v[120:123], v[140:143], v[24:27], v[120:123]
    s_waitcnt lgkmcnt(7)
    v_mfma_f32_16x16x32_bf16 v[124:127], v[144:147], v[24:27], v[124:127]
    s_mul_i32 s40, s53, 20480
    s_add_u32 s40, s40, s46
    s_add_u32 s40, s40, 1024
    s_mul_i32 s41, s34, 5120
    s_add_u32 m0, s41, 62464
    s_nop 0
    buffer_load_dwordx4 v7, s[12:15], s40 offen lds
    s_waitcnt lgkmcnt(6)
    v_mfma_f32_16x16x32_bf16 v[128:131], v[148:151], v[24:27], v[128:131]
    s_waitcnt lgkmcnt(5)
    v_mfma_f32_16x16x32_bf16 v[132:135], v[152:155], v[24:27], v[132:135]
    s_mul_i32 s40, s53, 20480
    s_add_u32 s40, s40, s46
    s_add_u32 s40, s40, 2048
    s_mul_i32 s41, s34, 5120
    s_add_u32 m0, s41, 63488
    s_nop 0
    buffer_load_dwordx4 v7, s[12:15], s40 offen lds
    ds_read_b128 v[136:139], v113 offset:30720
    ds_read_b128 v[140:143], v113 offset:31744
    ds_read_b128 v[144:147], v113 offset:32768
    ds_read_b128 v[148:151], v113 offset:33792
    ds_read_b128 v[152:155], v113 offset:34816
    s_waitcnt vmcnt(14)
    s_waitcnt lgkmcnt(9)
    v_mfma_f32_16x16x32_bf16 v[116:119], v[156:159], v[28:31], v[116:119]
    s_mul_i32 s40, s53, 20480
    s_add_u32 s40, s40, s46
    s_add_u32 s40, s40, 3072
    s_mul_i32 s41, s34, 5120
    s_add_u32 m0, s41, 64512
    s_nop 0
    buffer_load_dwordx4 v7, s[12:15], s40 offen lds
    s_waitcnt lgkmcnt(8)
    v_mfma_f32_16x16x32_bf16 v[120:123], v[160:163], v[28:31], v[120:123]
    s_waitcnt lgkmcnt(7)
    v_mfma_f32_16x16x32_bf16 v[124:127], v[164:167], v[28:31], v[124:127]
    s_mul_i32 s40, s53, 20480
    s_add_u32 s40, s40, s46
    s_add_u32 s40, s40, 4096
    s_mul_i32 s41, s34, 5120
    s_add_u32 m0, s41, 65536
    s_nop 0
    buffer_load_dwordx4 v7, s[12:15], s40 offen lds
    s_waitcnt lgkmcnt(6)
    v_mfma_f32_16x16x32_bf16 v[128:131], v[168:171], v[28:31], v[128:131]
    s_waitcnt lgkmcnt(5)
    v_mfma_f32_16x16x32_bf16 v[132:135], v[172:175], v[28:31], v[132:135]
    s_lshl_b32 s42, s53, 12
    s_add_u32 s42, s42, s47
    buffer_load_dwordx4 v[56:59], v7, s[12:15], s42 offen offset:0
    ds_read_b128 v[156:159], v113 offset:35840
    ds_read_b128 v[160:163], v113 offset:36864
    ds_read_b128 v[164:167], v113 offset:37888
    ds_read_b128 v[168:171], v113 offset:38912
    ds_read_b128 v[172:175], v113 offset:39936
    s_waitcnt vmcnt(16)
    s_waitcnt lgkmcnt(9)
    v_mfma_f32_16x16x32_bf16 v[116:119], v[136:139], v[32:35], v[116:119]
    s_lshl_b32 s42, s53, 12
    s_add_u32 s42, s42, s47
    buffer_load_dwordx4 v[60:63], v7, s[12:15], s42 offen offset:1024
    s_waitcnt lgkmcnt(8)
    v_mfma_f32_16x16x32_bf16 v[120:123], v[140:143], v[32:35], v[120:123]
    s_waitcnt lgkmcnt(7)
    v_mfma_f32_16x16x32_bf16 v[124:127], v[144:147], v[32:35], v[124:127]
    s_lshl_b32 s42, s53, 12
    s_add_u32 s42, s42, s47
    buffer_load_dwordx4 v[64:67], v7, s[12:15], s42 offen offset:2048
    s_waitcnt lgkmcnt(6)
    v_mfma_f32_16x16x32_bf16 v[128:131], v[148:151], v[32:35], v[128:131]
    s_waitcnt lgkmcnt(5)
    v_mfma_f32_16x16x32_bf16 v[132:135], v[152:155], v[32:35], v[132:135]
    s_lshl_b32 s42, s53, 12
    s_add_u32 s42, s42, s47
    buffer_load_dwordx4 v[68:71], v7, s[12:15], s42 offen offset:3072
    s_waitcnt vmcnt(18)
    s_waitcnt lgkmcnt(4)
    v_mfma_f32_16x16x32_bf16 v[116:119], v[156:159], v[36:39], v[116:119]
    s_waitcnt lgkmcnt(3)
    v_mfma_f32_16x16x32_bf16 v[120:123], v[160:163], v[36:39], v[120:123]
    s_waitcnt lgkmcnt(2)
    v_mfma_f32_16x16x32_bf16 v[124:127], v[164:167], v[36:39], v[124:127]
    s_waitcnt lgkmcnt(1)
    v_mfma_f32_16x16x32_bf16 v[128:131], v[168:171], v[36:39], v[128:131]
    s_waitcnt lgkmcnt(0)
    v_mfma_f32_16x16x32_bf16 v[132:135], v[172:175], v[36:39], v[132:135]
    s_waitcnt vmcnt(13)
    s_barrier
    ds_read_b128 v[136:139], v113 offset:40960
    ds_read_b128 v[140:143], v113 offset:41984
    ds_read_b128 v[144:147], v113 offset:43008
    ds_read_b128 v[148:151], v113 offset:44032
    ds_read_b128 v[152:155], v113 offset:45056
    ds_read_b128 v[156:159], v113 offset:46080
    ds_read_b128 v[160:163], v113 offset:47104
    ds_read_b128 v[164:167], v113 offset:48128
    ds_read_b128 v[168:171], v113 offset:49152
    ds_read_b128 v[172:175], v113 offset:50176
    s_waitcnt vmcnt(12)
    s_waitcnt lgkmcnt(9)
    v_mfma_f32_16x16x32_bf16 v[116:119], v[136:139], v[40:43], v[116:119]
    s_mul_i32 s40, s54, 20480
    s_add_u32 s40, s40, s46
    s_add_u32 s40, s40, 0
    s_mul_i32 s41, s34, 5120
    s_add_u32 m0, s41, 81920
    s_nop 0
    buffer_load_dwordx4 v7, s[12:15], s40 offen lds
    s_waitcnt lgkmcnt(8)
    v_mfma_f32_16x16x32_bf16 v[120:123], v[140:143], v[40:43], v[120:123]
    s_waitcnt lgkmcnt(7)
    v_mfma_f32_16x16x32_bf16 v[124:127], v[144:147], v[40:43], v[124:127]
    s_mul_i32 s40, s54, 20480
    s_add_u32 s40, s40, s46
    s_add_u32 s40, s40, 1024
    s_mul_i32 s41, s34, 5120
    s_add_u32 m0, s41, 82944
    s_nop 0
    buffer_load_dwordx4 v7, s[12:15], s40 offen lds
    s_waitcnt lgkmcnt(6)
    v_mfma_f32_16x16x32_bf16 v[128:131], v[148:151], v[40:43], v[128:131]
    s_waitcnt lgkmcnt(5)
    v_mfma_f32_16x16x32_bf16 v[132:135], v[152:155], v[40:43], v[132:135]
    s_mul_i32 s40, s54, 20480
    s_add_u32 s40, s40, s46
    s_add_u32 s40, s40, 2048
    s_mul_i32 s41, s34, 5120
    s_add_u32 m0, s41, 83968
    s_nop 0
    buffer_load_dwordx4 v7, s[12:15], s40 offen lds
    ds_read_b128 v[136:139], v113 offset:51200
    ds_read_b128 v[140:143], v113 offset:52224
    ds_read_b128 v[144:147], v113 offset:53248
    ds_read_b128 v[148:151], v113 offset:54272
    ds_read_b128 v[152:155], v113 offset:55296
    s_waitcnt vmcnt(14)
    s_waitcnt lgkmcnt(9)
    v_mfma_f32_16x16x32_bf16 v[116:119], v[156:159], v[44:47], v[116:119]
    s_mul_i32 s40, s54, 20480
    s_add_u32 s40, s40, s46
    s_add_u32 s40, s40, 3072
    s_mul_i32 s41, s34, 5120
    s_add_u32 m0, s41, 84992
    s_nop 0
    buffer_load_dwordx4 v7, s[12:15], s40 offen lds
    s_waitcnt lgkmcnt(8)
    v_mfma_f32_16x16x32_bf16 v[120:123], v[160:163], v[44:47], v[120:123]
    s_waitcnt lgkmcnt(7)
    v_mfma_f32_16x16x32_bf16 v[124:127], v[164:167], v[44:47], v[124:127]
    s_mul_i32 s40, s54, 20480
    s_add_u32 s40, s40, s46
    s_add_u32 s40, s40, 4096
    s_mul_i32 s41, s34, 5120
    s_add_u32 m0, s41, 86016
    s_nop 0
    buffer_load_dwordx4 v7, s[12:15], s40 offen lds
    s_waitcnt lgkmcnt(6)
    v_mfma_f32_16x16x32_bf16 v[128:131], v[168:171], v[44:47], v[128:131]
    s_waitcnt lgkmcnt(5)
    v_mfma_f32_16x16x32_bf16 v[132:135], v[172:175], v[44:47], v[132:135]
    s_lshl_b32 s42, s54, 12
    s_add_u32 s42, s42, s47
    buffer_load_dwordx4 v[72:75], v7, s[12:15], s42 offen offset:0
    ds_read_b128 v[156:159], v113 offset:56320
    ds_read_b128 v[160:163], v113 offset:57344
    ds_read_b128 v[164:167], v113 offset:58368
    ds_read_b128 v[168:171], v113 offset:59392
    ds_read_b128 v[172:175], v113 offset:60416
    s_waitcnt vmcnt(16)
    s_waitcnt lgkmcnt(9)
    v_mfma_f32_16x16x32_bf16 v[116:119], v[136:139], v[48:51], v[116:119]
    s_lshl_b32 s42, s54, 12
    s_add_u32 s42, s42, s47
    buffer_load_dwordx4 v[76:79], v7, s[12:15], s42 offen offset:1024
    s_waitcnt lgkmcnt(8)
    v_mfma_f32_16x16x32_bf16 v[120:123], v[140:143], v[48:51], v[120:123]
    s_waitcnt lgkmcnt(7)
    v_mfma_f32_16x16x32_bf16 v[124:127], v[144:147], v[48:51], v[124:127]
    s_lshl_b32 s42, s54, 12
    s_add_u32 s42, s42, s47
    buffer_load_dwordx4 v[80:83], v7, s[12:15], s42 offen offset:2048
    s_waitcnt lgkmcnt(6)
    v_mfma_f32_16x16x32_bf16 v[128:131], v[148:151], v[48:51], v[128:131]
    s_waitcnt lgkmcnt(5)
    v_mfma_f32_16x16x32_bf16 v[132:135], v[152:155], v[48:51], v[132:135]
    s_lshl_b32 s42, s54, 12
    s_add_u32 s42, s42, s47
    buffer_load_dwordx4 v[84:87], v7, s[12:15], s42 offen offset:3072
    s_waitcnt vmcnt(18)
    s_waitcnt lgkmcnt(4)
    v_mfma_f32_16x16x32_bf16 v[116:119], v[156:159], v[52:55], v[116:119]
    s_waitcnt lgkmcnt(3)
    v_mfma_f32_16x16x32_bf16 v[120:123], v[160:163], v[52:55], v[120:123]
    s_waitcnt lgkmcnt(2)
    v_mfma_f32_16x16x32_bf16 v[124:127], v[164:167], v[52:55], v[124:127]
    s_waitcnt lgkmcnt(1)
    v_mfma_f32_16x16x32_bf16 v[128:131], v[168:171], v[52:55], v[128:131]
    s_waitcnt lgkmcnt(0)
    v_mfma_f32_16x16x32_bf16 v[132:135], v[172:175], v[52:55], v[132:135]
    s_waitcnt vmcnt(13)
    s_barrier
    ds_read_b128 v[136:139], v114 offset:0
    ds_read_b128 v[140:143], v114 offset:1024
    ds_read_b128 v[144:147], v114 offset:2048
    ds_read_b128 v[148:151], v114 offset:3072
    ds_read_b128 v[152:155], v114 offset:4096
    ds_read_b128 v[156:159], v114 offset:5120
    ds_read_b128 v[160:163], v114 offset:6144
    ds_read_b128 v[164:167], v114 offset:7168
    ds_read_b128 v[168:171], v114 offset:8192
    ds_read_b128 v[172:175], v114 offset:9216
    s_waitcnt vmcnt(12)
    s_waitcnt lgkmcnt(9)
    v_mfma_f32_16x16x32_bf16 v[116:119], v[136:139], v[56:59], v[116:119]
    s_mul_i32 s40, s55, 20480
    s_add_u32 s40, s40, s46
    s_add_u32 s40, s40, 0
    s_mul_i32 s41, s34, 5120
    s_add_u32 m0, s41, 102400
    s_nop 0
    buffer_load_dwordx4 v7, s[12:15], s40 offen lds
    s_waitcnt lgkmcnt(8)
    v_mfma_f32_16x16x32_bf16 v[120:123], v[140:143], v[56:59], v[120:123]
    s_waitcnt lgkmcnt(7)
    v_mfma_f32_16x16x32_bf16 v[124:127], v[144:147], v[56:59], v[124:127]
    s_mul_i32 s40, s55, 20480
    s_add_u32 s40, s40, s46
    s_add_u32 s40, s40, 1024
    s_mul_i32 s41, s34, 5120
    s_add_u32 m0, s41, 103424
    s_nop 0
    buffer_load_dwordx4 v7, s[12:15], s40 offen lds
    s_waitcnt lgkmcnt(6)
    v_mfma_f32_16x16x32_bf16 v[128:131], v[148:151], v[56:59], v[128:131]
    s_waitcnt lgkmcnt(5)
    v_mfma_f32_16x16x32_bf16 v[132:135], v[152:155], v[56:59], v[132:135]
    s_mul_i32 s40, s55, 20480
    s_add_u32 s40, s40, s46
    s_add_u32 s40, s40, 2048
    s_mul_i32 s41, s34, 5120
    s_add_u32 m0, s41, 104448
    s_nop 0
    buffer_load_dwordx4 v7, s[12:15], s40 offen lds
    ds_read_b128 v[136:139], v114 offset:10240
    ds_read_b128 v[140:143], v114 offset:11264
    ds_read_b128 v[144:147], v114 offset:12288
    ds_read_b128 v[148:151], v114 offset:13312
    ds_read_b128 v[152:155], v114 offset:14336
    s_waitcnt vmcnt(14)
    s_waitcnt lgkmcnt(9)
    v_mfma_f32_16x16x32_bf16 v[116:119], v[156:159], v[60:63], v[116:119]
    s_mul_i32 s40, s55, 20480
    s_add_u32 s40, s40, s46
    s_add_u32 s40, s40, 3072
    s_mul_i32 s41, s34, 5120
    s_add_u32 m0, s41, 105472
    s_nop 0
    buffer_load_dwordx4 v7, s[12:15], s40 offen lds
    s_waitcnt lgkmcnt(8)
    v_mfma_f32_16x16x32_bf16 v[120:123], v[160:163], v[60:63], v[120:123]
    s_waitcnt lgkmcnt(7)
    v_mfma_f32_16x16x32_bf16 v[124:127], v[164:167], v[60:63], v[124:127]
    s_mul_i32 s40, s55, 20480
    s_add_u32 s40, s40, s46
    s_add_u32 s40, s40, 4096
    s_mul_i32 s41, s34, 5120
    s_add_u32 m0, s41, 106496
    s_nop 0
    buffer_load_dwordx4 v7, s[12:15], s40 offen lds
    s_waitcnt lgkmcnt(6)
    v_mfma_f32_16x16x32_bf16 v[128:131], v[168:171], v[60:63], v[128:131]
    s_waitcnt lgkmcnt(5)
    v_mfma_f32_16x16x32_bf16 v[132:135], v[172:175], v[60:63], v[132:135]
    s_lshl_b32 s42, s55, 12
    s_add_u32 s42, s42, s47
    buffer_load_dwordx4 v[88:91], v7, s[12:15], s42 offen offset:0
    ds_read_b128 v[156:159], v114 offset:15360
    ds_read_b128 v[160:163], v114 offset:16384
    ds_read_b128 v[164:167], v114 offset:17408
    ds_read_b128 v[168:171], v114 offset:18432
    ds_read_b128 v[172:175], v114 offset:19456
    s_waitcnt vmcnt(16)
    s_waitcnt lgkmcnt(9)
    v_mfma_f32_16x16x32_bf16 v[116:119], v[136:139], v[64:67], v[116:119]
    s_lshl_b32 s42, s55, 12
    s_add_u32 s42, s42, s47
    buffer_load_dwordx4 v[92:95], v7, s[12:15], s42 offen offset:1024
    s_waitcnt lgkmcnt(8)
    v_mfma_f32_16x16x32_bf16 v[120:123], v[140:143], v[64:67], v[120:123]
    s_waitcnt lgkmcnt(7)
    v_mfma_f32_16x16x32_bf16 v[124:127], v[144:147], v[64:67], v[124:127]
    s_lshl_b32 s42, s55, 12
    s_add_u32 s42, s42, s47
    buffer_load_dwordx4 v[96:99], v7, s[12:15], s42 offen offset:2048
    s_waitcnt lgkmcnt(6)
    v_mfma_f32_16x16x32_bf16 v[128:131], v[148:151], v[64:67], v[128:131]
    s_waitcnt lgkmcnt(5)
    v_mfma_f32_16x16x32_bf16 v[132:135], v[152:155], v[64:67], v[132:135]
    s_lshl_b32 s42, s55, 12
    s_add_u32 s42, s42, s47
    buffer_load_dwordx4 v[100:103], v7, s[12:15], s42 offen offset:3072
    s_waitcnt vmcnt(18)
    s_waitcnt lgkmcnt(4)
    v_mfma_f32_16x16x32_bf16 v[116:119], v[156:159], v[68:71], v[116:119]
    s_cmp_ge_u32 s34, 2
    s_cbranch_scc1 k3_y_1
    s_mul_i32 s40, s34, 40960
    s_add_u32 s40, s40, s45
    s_mul_i32 s41, s34, 5120
    s_add_u32 m0, s41, 122880
    s_nop 0
    buffer_load_dwordx4 v104, s[8:11], s40 offen lds
    s_add_u32 m0, s41, 123904
    s_nop 0
    buffer_load_dwordx4 v105, s[8:11], s40 offen lds
    s_add_u32 m0, s41, 124928
    s_nop 0
    buffer_load_dwordx4 v106, s[8:11], s40 offen lds
    s_add_u32 m0, s41, 125952
    s_nop 0
    buffer_load_dwordx4 v107, s[8:11], s40 offen lds
    s_add_u32 m0, s41, 126976
    s_nop 0
    buffer_load_dwordx4 v108, s[8:11], s40 offen lds
    s_branch k3_xy_2
k3_y_1:
    v_lshrrev_b32 v4, 3, v1
    v_lshlrev_b32 v4, 12, v4
    v_and_b32 v5, 7, v1
    v_lshl_add_u32 v112, v5, 4, v4
    s_sub_u32 s42, s34, 2
    s_mul_i32 s40, s42, 40
    s_mul_i32 s41, s33, 80
    s_add_u32 s40, s40, s41
    s_lshl_b32 s40, s40, 12
    s_lshl_b32 s41, s32, 7
    s_add_u32 s40, s40, s41
    s_add_u32 s40, s40, 8912896
    s_mul_i32 s41, s42, 5120
    s_add_u32 m0, s41, 133120
    s_nop 0
    buffer_load_dwordx4 v112, s[12:15], s40 offen lds
    s_add_u32 s40, s40, 32768
    s_add_u32 m0, s41, 134144
    s_nop 0
    buffer_load_dwordx4 v112, s[12:15], s40 offen lds
    s_add_u32 s40, s40, 32768
    s_add_u32 m0, s41, 135168
    s_nop 0
    buffer_load_dwordx4 v112, s[12:15], s40 offen lds
    s_add_u32 s40, s40, 32768
    s_add_u32 m0, s41, 136192
    s_nop 0
    buffer_load_dwordx4 v112, s[12:15], s40 offen lds
    s_add_u32 s40, s40, 32768
    s_add_u32 m0, s41, 137216
    s_nop 0
    buffer_load_dwordx4 v112, s[12:15], s40 offen lds
    s_add_u32 s40, s40, 32768
k3_xy_2:
    s_lshl_b32 s40, s32, 9
    s_lshl_b32 s41, s34, 7
    s_add_u32 s40, s40, s41
    s_add_u32 s40, s40, 14680064
    v_lshlrev_b32 v4, 3, v3
    buffer_load_dwordx2 v[110:111], v4, s[12:15], s40 offen
    s_waitcnt lgkmcnt(3)
    v_mfma_f32_16x16x32_bf16 v[120:123], v[160:163], v[68:71], v[120:123]
    s_waitcnt lgkmcnt(2)
    v_mfma_f32_16x16x32_bf16 v[124:127], v[164:167], v[68:71], v[124:127]
    s_waitcnt lgkmcnt(1)
    v_mfma_f32_16x16x32_bf16 v[128:131], v[168:171], v[68:71], v[128:131]
    s_waitcnt lgkmcnt(0)
    v_mfma_f32_16x16x32_bf16 v[132:135], v[172:175], v[68:71], v[132:135]
    s_waitcnt vmcnt(19)
    s_barrier
    ds_read_b128 v[136:139], v114 offset:20480
    ds_read_b128 v[140:143], v114 offset:21504
    ds_read_b128 v[144:147], v114 offset:22528
    ds_read_b128 v[148:151], v114 offset:23552
    ds_read_b128 v[152:155], v114 offset:24576
    ds_read_b128 v[156:159], v114 offset:25600
    ds_read_b128 v[160:163], v114 offset:26624
    ds_read_b128 v[164:167], v114 offset:27648
    ds_read_b128 v[168:171], v114 offset:28672
    ds_read_b128 v[172:175], v114 offset:29696
    s_waitcnt vmcnt(18)
    s_waitcnt lgkmcnt(9)
    v_mfma_f32_16x16x32_bf16 v[116:119], v[136:139], v[72:75], v[116:119]
    s_waitcnt lgkmcnt(8)
    v_mfma_f32_16x16x32_bf16 v[120:123], v[140:143], v[72:75], v[120:123]
    s_waitcnt lgkmcnt(7)
    v_mfma_f32_16x16x32_bf16 v[124:127], v[144:147], v[72:75], v[124:127]
    s_waitcnt lgkmcnt(6)
    v_mfma_f32_16x16x32_bf16 v[128:131], v[148:151], v[72:75], v[128:131]
    s_waitcnt lgkmcnt(5)
    v_mfma_f32_16x16x32_bf16 v[132:135], v[152:155], v[72:75], v[132:135]
    ds_read_b128 v[136:139], v114 offset:30720
    ds_read_b128 v[140:143], v114 offset:31744
    ds_read_b128 v[144:147], v114 offset:32768
    ds_read_b128 v[148:151], v114 offset:33792
    ds_read_b128 v[152:155], v114 offset:34816
    s_waitcnt vmcnt(17)
    s_waitcnt lgkmcnt(9)
    v_mfma_f32_16x16x32_bf16 v[116:119], v[156:159], v[76:79], v[116:119]
    s_waitcnt lgkmcnt(8)
    v_mfma_f32_16x16x32_bf16 v[120:123], v[160:163], v[76:79], v[120:123]
    s_waitcnt lgkmcnt(7)
    v_mfma_f32_16x16x32_bf16 v[124:127], v[164:167], v[76:79], v[124:127]
    s_waitcnt lgkmcnt(6)
    v_mfma_f32_16x16x32_bf16 v[128:131], v[168:171], v[76:79], v[128:131]
    s_waitcnt lgkmcnt(5)
    v_mfma_f32_16x16x32_bf16 v[132:135], v[172:175], v[76:79], v[132:135]
    ds_read_b128 v[156:159], v114 offset:35840
    ds_read_b128 v[160:163], v114 offset:36864
    ds_read_b128 v[164:167], v114 offset:37888
    ds_read_b128 v[168:171], v114 offset:38912
    ds_read_b128 v[172:175], v114 offset:39936
    s_waitcnt vmcnt(16)
    s_waitcnt lgkmcnt(9)
    v_mfma_f32_16x16x32_bf16 v[116:119], v[136:139], v[80:83], v[116:119]
    s_waitcnt lgkmcnt(8)
    v_mfma_f32_16x16x32_bf16 v[120:123], v[140:143], v[80:83], v[120:123]
    s_waitcnt lgkmcnt(7)
    v_mfma_f32_16x16x32_bf16 v[124:127], v[144:147], v[80:83], v[124:127]
    s_waitcnt lgkmcnt(6)
    v_mfma_f32_16x16x32_bf16 v[128:131], v[148:151], v[80:83], v[128:131]
    s_waitcnt lgkmcnt(5)
    v_mfma_f32_16x16x32_bf16 v[132:135], v[152:155], v[80:83], v[132:135]
    s_waitcnt vmcnt(15)
    s_waitcnt lgkmcnt(4)
    v_mfma_f32_16x16x32_bf16 v[116:119], v[156:159], v[84:87], v[116:119]
    s_waitcnt lgkmcnt(3)
    v_mfma_f32_16x16x32_bf16 v[120:123], v[160:163], v[84:87], v[120:123]
    s_waitcnt lgkmcnt(2)
    v_mfma_f32_16x16x32_bf16 v[124:127], v[164:167], v[84:87], v[124:127]
    s_waitcnt lgkmcnt(1)
    v_mfma_f32_16x16x32_bf16 v[128:131], v[168:171], v[84:87], v[128:131]
    s_waitcnt lgkmcnt(0)
    v_mfma_f32_16x16x32_bf16 v[132:135], v[172:175], v[84:87], v[132:135]
    s_waitcnt vmcnt(10)
    s_barrier
    ds_read_b128 v[136:139], v114 offset:40960
    ds_read_b128 v[140:143], v114 offset:41984
    ds_read_b128 v[144:147], v114 offset:43008
    ds_read_b128 v[148:151], v114 offset:44032
    ds_read_b128 v[152:155], v114 offset:45056
    ds_read_b128 v[156:159], v114 offset:46080
    ds_read_b128 v[160:163], v114 offset:47104
    ds_read_b128 v[164:167], v114 offset:48128
    ds_read_b128 v[168:171], v114 offset:49152
    ds_read_b128 v[172:175], v114 offset:50176
    s_waitcnt vmcnt(9)
    s_waitcnt lgkmcnt(9)
    v_mfma_f32_16x16x32_bf16 v[116:119], v[136:139], v[88:91], v[116:119]
    s_waitcnt lgkmcnt(8)
    v_mfma_f32_16x16x32_bf16 v[120:123], v[140:143], v[88:91], v[120:123]
    s_waitcnt lgkmcnt(7)
    v_mfma_f32_16x16x32_bf16 v[124:127], v[144:147], v[88:91], v[124:127]
    s_waitcnt lgkmcnt(6)
    v_mfma_f32_16x16x32_bf16 v[128:131], v[148:151], v[88:91], v[128:131]
    s_waitcnt lgkmcnt(5)
    v_mfma_f32_16x16x32_bf16 v[132:135], v[152:155], v[88:91], v[132:135]
    ds_read_b128 v[136:139], v114 offset:51200
    ds_read_b128 v[140:143], v114 offset:52224
    ds_read_b128 v[144:147], v114 offset:53248
    ds_read_b128 v[148:151], v114 offset:54272
    ds_read_b128 v[152:155], v114 offset:55296
    s_waitcnt vmcnt(8)
    s_waitcnt lgkmcnt(9)
    v_mfma_f32_16x16x32_bf16 v[116:119], v[156:159], v[92:95], v[116:119]
    s_waitcnt lgkmcnt(8)
    v_mfma_f32_16x16x32_bf16 v[120:123], v[160:163], v[92:95], v[120:123]
    s_waitcnt lgkmcnt(7)
    v_mfma_f32_16x16x32_bf16 v[124:127], v[164:167], v[92:95], v[124:127]
    s_waitcnt lgkmcnt(6)
    v_mfma_f32_16x16x32_bf16 v[128:131], v[168:171], v[92:95], v[128:131]
    s_waitcnt lgkmcnt(5)
    v_mfma_f32_16x16x32_bf16 v[132:135], v[172:175], v[92:95], v[132:135]
    ds_read_b128 v[156:159], v114 offset:56320
    ds_read_b128 v[160:163], v114 offset:57344
    ds_read_b128 v[164:167], v114 offset:58368
    ds_read_b128 v[168:171], v114 offset:59392
    ds_read_b128 v[172:175], v114 offset:60416
    s_waitcnt vmcnt(7)
    s_waitcnt lgkmcnt(9)
    v_mfma_f32_16x16x32_bf16 v[116:119], v[136:139], v[96:99], v[116:119]
    s_waitcnt lgkmcnt(8)
    v_mfma_f32_16x16x32_bf16 v[120:123], v[140:143], v[96:99], v[120:123]
    s_waitcnt lgkmcnt(7)
    v_mfma_f32_16x16x32_bf16 v[124:127], v[144:147], v[96:99], v[124:127]
    s_waitcnt lgkmcnt(6)
    v_mfma_f32_16x16x32_bf16 v[128:131], v[148:151], v[96:99], v[128:131]
    s_waitcnt lgkmcnt(5)
    v_mfma_f32_16x16x32_bf16 v[132:135], v[152:155], v[96:99], v[132:135]
    s_waitcnt vmcnt(6)
    s_waitcnt lgkmcnt(4)
    v_mfma_f32_16x16x32_bf16 v[116:119], v[156:159], v[100:103], v[116:119]
    s_waitcnt lgkmcnt(3)
    v_mfma_f32_16x16x32_bf16 v[120:123], v[160:163], v[100:103], v[120:123]
    s_waitcnt lgkmcnt(2)
    v_mfma_f32_16x16x32_bf16 v[124:127], v[164:167], v[100:103], v[124:127]
    s_waitcnt lgkmcnt(1)
    v_mfma_f32_16x16x32_bf16 v[128:131], v[168:171], v[100:103], v[128:131]
    s_waitcnt lgkmcnt(0)
    v_mfma_f32_16x16x32_bf16 v[132:135], v[172:175], v[100:103], v[132:135]
    s_lshl_b32 s40, s34, 4
    v_add_u32 v4, s40, v3
    v_mul_u32_u24 v4, 160, v4
    v_lshl_add_u32 v176, v2, 3, v4
    v_add_u32 v177, 122880, v176
    v_lshrrev_b32 v5, 2, v3
    v_lshl_add_u32 v4, v2, 2, v5
    v_lshlrev_b32 v4, 7, v4
    v_and_b32 v5, 3, v3
    v_lshl_add_u32 v4, v5, 3, v4
    s_lshl_b32 s40, s34, 5
    s_add_u32 s40, s40, 133120
    v_add_u32 v178, s40, v4
    s_mov_b32 s46, 0xbfb8aa3b
    s_mov_b32 s47, 0xbfb8aa3b
    v_pk_mul_f32 v[8:9], v[116:117], s[46:47]
    v_pk_mul_f32 v[10:11], v[118:119], s[46:47]
    v_pk_mul_f32 v[12:13], v[120:121], s[46:47]
    v_pk_mul_f32 v[14:15], v[122:123], s[46:47]
    v_pk_mul_f32 v[16:17], v[124:125], s[46:47]
    v_pk_mul_f32 v[18:19], v[126:127], s[46:47]
    v_pk_mul_f32 v[20:21], v[128:129], s[46:47]
    v_pk_mul_f32 v[22:23], v[130:131], s[46:47]
    v_pk_mul_f32 v[24:25], v[132:133], s[46:47]
    v_pk_mul_f32 v[26:27], v[134:135], s[46:47]
    s_waitcnt vmcnt(0)
    s_barrier
    ds_read_b64 v[136:137], v177 offset:0
    ds_read_b64 v[138:139], v177 offset:32
    ds_read_b64 v[140:141], v177 offset:64
    ds_read_b64 v[142:143], v177 offset:96
    ds_read_b64 v[144:145], v177 offset:128
    ds_read_b64_tr_b16 v[146:147], v178 offset:0
    ds_read_b64_tr_b16 v[148:149], v178 offset:2048
    ds_read_b64_tr_b16 v[150:151], v178 offset:4096
    ds_read_b64_tr_b16 v[152:153], v178 offset:6144
    ds_read_b64_tr_b16 v[154:155], v178 offset:8192
    v_exp_f32 v8, v8
    v_exp_f32 v9, v9
    v_exp_f32 v10, v10
    v_exp_f32 v11, v11
    v_exp_f32 v12, v12
    v_exp_f32 v13, v13
    v_exp_f32 v14, v14
    v_exp_f32 v15, v15
    v_exp_f32 v16, v16
    v_exp_f32 v17, v17
    v_exp_f32 v18, v18
    v_exp_f32 v19, v19
    v_exp_f32 v20, v20
    v_exp_f32 v21, v21
    v_exp_f32 v22, v22
    v_exp_f32 v23, v23
    v_exp_f32 v24, v24
    v_exp_f32 v25, v25
    v_exp_f32 v26, v26
    v_exp_f32 v27, v27
    v_pk_add_f32 v[8:9], v[8:9], 1.0 op_sel_hi:[1,0]
    v_pk_add_f32 v[10:11], v[10:11], 1.0 op_sel_hi:[1,0]
    v_pk_add_f32 v[12:13], v[12:13], 1.0 op_sel_hi:[1,0]
    v_pk_add_f32 v[14:15], v[14:15], 1.0 op_sel_hi:[1,0]
    v_pk_add_f32 v[16:17], v[16:17], 1.0 op_sel_hi:[1,0]
    v_pk_add_f32 v[18:19], v[18:19], 1.0 op_sel_hi:[1,0]
    v_pk_add_f32 v[20:21], v[20:21], 1.0 op_sel_hi:[1,0]
    v_pk_add_f32 v[22:23], v[22:23], 1.0 op_sel_hi:[1,0]
    v_pk_add_f32 v[24:25], v[24:25], 1.0 op_sel_hi:[1,0]
    v_pk_add_f32 v[26:27], v[26:27], 1.0 op_sel_hi:[1,0]
    v_rcp_f32 v8, v8
    v_rcp_f32 v9, v9
    v_rcp_f32 v10, v10
    v_rcp_f32 v11, v11
    v_rcp_f32 v12, v12
    v_rcp_f32 v13, v13
    v_rcp_f32 v14, v14
    v_rcp_f32 v15, v15
    v_rcp_f32 v16, v16
    v_rcp_f32 v17, v17
    v_rcp_f32 v18, v18
    v_rcp_f32 v19, v19
    v_rcp_f32 v20, v20
    v_rcp_f32 v21, v21
    v_rcp_f32 v22, v22
    v_rcp_f32 v23, v23
    v_rcp_f32 v24, v24
    v_rcp_f32 v25, v25
    v_rcp_f32 v26, v26
    v_rcp_f32 v27, v27
    v_pk_mul_f32 v[8:9], v[8:9], v[116:117]
    v_pk_mul_f32 v[10:11], v[10:11], v[118:119]
    v_pk_mul_f32 v[12:13], v[12:13], v[120:121]
    v_pk_mul_f32 v[14:15], v[14:15], v[122:123]
    v_pk_mul_f32 v[16:17], v[16:17], v[124:125]
    v_pk_mul_f32 v[18:19], v[18:19], v[126:127]
    v_pk_mul_f32 v[20:21], v[20:21], v[128:129]
    v_pk_mul_f32 v[22:23], v[22:23], v[130:131]
    v_pk_mul_f32 v[24:25], v[24:25], v[132:133]
    v_pk_mul_f32 v[26:27], v[26:27], v[134:135]
    s_waitcnt lgkmcnt(0)
    v_lshlrev_b32 v28, 16, v136
    v_and_b32 v29, 0xffff0000, v136
    v_lshlrev_b32 v48, 16, v146
    v_and_b32 v49, 0xffff0000, v146
    v_lshlrev_b32 v30, 16, v137
    v_and_b32 v31, 0xffff0000, v137
    v_lshlrev_b32 v50, 16, v147
    v_and_b32 v51, 0xffff0000, v147
    v_lshlrev_b32 v32, 16, v138
    v_and_b32 v33, 0xffff0000, v138
    v_lshlrev_b32 v52, 16, v148
    v_and_b32 v53, 0xffff0000, v148
    v_lshlrev_b32 v34, 16, v139
    v_and_b32 v35, 0xffff0000, v139
    v_lshlrev_b32 v54, 16, v149
    v_and_b32 v55, 0xffff0000, v149
    v_lshlrev_b32 v36, 16, v140
    v_and_b32 v37, 0xffff0000, v140
    v_lshlrev_b32 v56, 16, v150
    v_and_b32 v57, 0xffff0000, v150
    v_lshlrev_b32 v38, 16, v141
    v_and_b32 v39, 0xffff0000, v141
    v_lshlrev_b32 v58, 16, v151
    v_and_b32 v59, 0xffff0000, v151
    v_lshlrev_b32 v40, 16, v142
    v_and_b32 v41, 0xffff0000, v142
    v_lshlrev_b32 v60, 16, v152
    v_and_b32 v61, 0xffff0000, v152
    v_lshlrev_b32 v42, 16, v143
    v_and_b32 v43, 0xffff0000, v143
    v_lshlrev_b32 v62, 16, v153
    v_and_b32 v63, 0xffff0000, v153
    v_lshlrev_b32 v44, 16, v144
    v_and_b32 v45, 0xffff0000, v144
    v_lshlrev_b32 v64, 16, v154
    v_and_b32 v65, 0xffff0000, v154
    v_lshlrev_b32 v46, 16, v145
    v_and_b32 v47, 0xffff0000, v145
    v_lshlrev_b32 v66, 16, v155
    v_and_b32 v67, 0xffff0000, v155
    v_mov_b32 v180, v111
    v_pk_add_f32 v[68:69], v[28:29], v[110:111] op_sel_hi:[1,0] neg_lo:[0,1] neg_hi:[0,1]
    v_pk_add_f32 v[70:71], v[30:31], v[110:111] op_sel_hi:[1,0] neg_lo:[0,1] neg_hi:[0,1]
    v_pk_add_f32 v[72:73], v[32:33], v[110:111] op_sel_hi:[1,0] neg_lo:[0,1] neg_hi:[0,1]
    v_pk_add_f32 v[74:75], v[34:35], v[110:111] op_sel_hi:[1,0] neg_lo:[0,1] neg_hi:[0,1]
    v_pk_add_f32 v[76:77], v[36:37], v[110:111] op_sel_hi:[1,0] neg_lo:[0,1] neg_hi:[0,1]
    v_pk_add_f32 v[78:79], v[38:39], v[110:111] op_sel_hi:[1,0] neg_lo:[0,1] neg_hi:[0,1]
    v_pk_add_f32 v[80:81], v[40:41], v[110:111] op_sel_hi:[1,0] neg_lo:[0,1] neg_hi:[0,1]
    v_pk_add_f32 v[82:83], v[42:43], v[110:111] op_sel_hi:[1,0] neg_lo:[0,1] neg_hi:[0,1]
    v_pk_add_f32 v[84:85], v[44:45], v[110:111] op_sel_hi:[1,0] neg_lo:[0,1] neg_hi:[0,1]
    v_pk_add_f32 v[86:87], v[46:47], v[110:111] op_sel_hi:[1,0] neg_lo:[0,1] neg_hi:[0,1]
    v_pk_mul_f32 v[68:69], v[68:69], v[180:181] op_sel_hi:[1,0]
    v_pk_mul_f32 v[70:71], v[70:71], v[180:181] op_sel_hi:[1,0]
    v_pk_mul_f32 v[72:73], v[72:73], v[180:181] op_sel_hi:[1,0]
    v_pk_mul_f32 v[74:75], v[74:75], v[180:181] op_sel_hi:[1,0]
    v_pk_mul_f32 v[76:77], v[76:77], v[180:181] op_sel_hi:[1,0]
    v_pk_mul_f32 v[78:79], v[78:79], v[180:181] op_sel_hi:[1,0]
    v_pk_mul_f32 v[80:81], v[80:81], v[180:181] op_sel_hi:[1,0]
    v_pk_mul_f32 v[82:83], v[82:83], v[180:181] op_sel_hi:[1,0]
    v_pk_mul_f32 v[84:85], v[84:85], v[180:181] op_sel_hi:[1,0]
    v_pk_mul_f32 v[86:87], v[86:87], v[180:181] op_sel_hi:[1,0]
    v_pk_mul_f32 v[68:69], v[68:69], v[48:49]
    v_pk_mul_f32 v[70:71], v[70:71], v[50:51]
    v_pk_mul_f32 v[72:73], v[72:73], v[52:53]
    v_pk_mul_f32 v[74:75], v[74:75], v[54:55]
    v_pk_mul_f32 v[76:77], v[76:77], v[56:57]
    v_pk_mul_f32 v[78:79], v[78:79], v[58:59]
    v_pk_mul_f32 v[80:81], v[80:81], v[60:61]
    v_pk_mul_f32 v[82:83], v[82:83], v[62:63]
    v_pk_mul_f32 v[84:85], v[84:85], v[64:65]
    v_pk_mul_f32 v[86:87], v[86:87], v[66:67]
    v_pk_fma_f32 v[68:69], v[68:69], v[8:9], v[28:29]
    v_pk_fma_f32 v[70:71], v[70:71], v[10:11], v[30:31]
    v_pk_fma_f32 v[72:73], v[72:73], v[12:13], v[32:33]
    v_pk_fma_f32 v[74:75], v[74:75], v[14:15], v[34:35]
    v_pk_fma_f32 v[76:77], v[76:77], v[16:17], v[36:37]
    v_pk_fma_f32 v[78:79], v[78:79], v[18:19], v[38:39]
    v_pk_fma_f32 v[80:81], v[80:81], v[20:21], v[40:41]
    v_pk_fma_f32 v[82:83], v[82:83], v[22:23], v[42:43]
    v_pk_fma_f32 v[84:85], v[84:85], v[24:25], v[44:45]
    v_pk_fma_f32 v[86:87], v[86:87], v[26:27], v[46:47]
    v_cvt_pk_bf16_f32 v136, v68, v69
    v_cvt_pk_bf16_f32 v137, v70, v71
    v_cvt_pk_bf16_f32 v138, v72, v73
    v_cvt_pk_bf16_f32 v139, v74, v75
    v_cvt_pk_bf16_f32 v140, v76, v77
    v_cvt_pk_bf16_f32 v141, v78, v79
    v_cvt_pk_bf16_f32 v142, v80, v81
    v_cvt_pk_bf16_f32 v143, v82, v83
    v_cvt_pk_bf16_f32 v144, v84, v85
    v_cvt_pk_bf16_f32 v145, v86, v87
    v_add_u32 v182, 143360, v176
    ds_write_b64 v182, v[136:137] offset:0
    ds_write_b64 v182, v[138:139] offset:32
    ds_write_b64 v182, v[140:141] offset:64
    ds_write_b64 v182, v[142:143] offset:96
    ds_write_b64 v182, v[144:145] offset:128
    s_mul_i32 s40, s34, 2560
    s_add_u32 s40, s40, 143360
    v_add_u32 v4, s40, v7
    s_waitcnt lgkmcnt(0)
    ds_read_b128 v[8:11], v4 offset:0
    ds_read_b128 v[12:15], v4 offset:1024
    ds_read_b128 v[16:19], v4 offset:2048
    s_mul_i32 s40, s34, 20480
    s_add_u32 s40, s40, s45
    s_waitcnt lgkmcnt(0)
    buffer_store_dwordx4 v[8:11], v104, s[16:19], s40 offen
    buffer_store_dwordx4 v[12:15], v105, s[16:19], s40 offen
    s_mov_b32 exec_hi, 0
    buffer_store_dwordx4 v[16:19], v106, s[16:19], s40 offen
    s_mov_b64 exec, -1
k3_kernel_end:
    s_endpgm
.section .rodata,"a"
.p2align 6
.amdhsa_kernel k1_kernel
  .amdhsa_next_free_vgpr 248
  .amdhsa_next_free_sgpr 102
  .amdhsa_accum_offset 248
  .amdhsa_group_segment_fixed_size 0
  .amdhsa_kernarg_size 112
  .amdhsa_user_sgpr_count 2
  .amdhsa_user_sgpr_kernarg_segment_ptr 1
  .amdhsa_system_sgpr_workgroup_id_x 1
.end_amdhsa_kernel
.p2align 6
.amdhsa_kernel k2_kernel
  .amdhsa_next_free_vgpr 197
  .amdhsa_next_free_sgpr 102
  .amdhsa_accum_offset 200
  .amdhsa_group_segment_fixed_size 0
  .amdhsa_kernarg_size 112
  .amdhsa_user_sgpr_count 2
  .amdhsa_user_sgpr_kernarg_segment_ptr 1
  .amdhsa_system_sgpr_workgroup_id_x 1
.end_amdhsa_kernel
.p2align 6
.amdhsa_kernel k3_kernel
  .amdhsa_next_free_vgpr 183
  .amdhsa_next_free_sgpr 102
  .amdhsa_accum_offset 184
  .amdhsa_group_segment_fixed_size 0
  .amdhsa_kernarg_size 112
  .amdhsa_user_sgpr_count 2
  .amdhsa_user_sgpr_kernarg_segment_ptr 1
  .amdhsa_system_sgpr_workgroup_id_x 1
.end_amdhsa_kernel
```

```asm
; @launch kernel=k1_kernel grid=(256,1,1) block=(512,1,1) lds=163840
; @launch kernel=k2_kernel grid=(512,1,1) block=(256,1,1) lds=81920
; @launch kernel=k3_kernel grid=(256,1,1) block=(256,1,1) lds=153600
.amdgcn_target "amdgcn-amd-amdhsa--gfx950"
.text
.globl k1_kernel
.p2align 8
.type k1_kernel,@function
k1_kernel:
    s_cmp_ge_u32 s2, 256
    s_cbranch_scc1 k1_kernel_end
    s_load_dwordx2 s[4:5], s[0:1], 0
    s_load_dwordx2 s[8:9], s[0:1], 56
    s_load_dwordx2 s[12:13], s[0:1], 8
    s_load_dwordx2 s[16:17], s[0:1], 16
    s_load_dwordx2 s[20:21], s[0:1], 24
    s_load_dwordx2 s[24:25], s[0:1], 104
    s_load_dwordx2 s[28:29], s[0:1], 96
    s_load_dwordx2 s[32:33], s[0:1], 64
    s_load_dwordx2 s[36:37], s[0:1], 32
    s_load_dwordx2 s[84:85], s[0:1], 80
    v_lshrrev_b32 v2, 6, v0
    v_and_b32 v1, 63, v0
    v_readfirstlane_b32 s42, v2
    v_lshrrev_b32 v2, 4, v1
    v_and_b32 v3, 15, v1
    s_and_b32 s48, s2, 7
    s_lshr_b32 s49, s2, 3
    s_lshr_b32 s66, s48, 1
    s_and_b32 s67, s48, 1
    s_lshl_b32 s40, s66, 3
    s_and_b32 s48, s49, 7
    s_add_u32 s40, s40, s48
    s_lshl_b32 s41, s67, 2
    s_lshr_b32 s48, s49, 3
    s_add_u32 s41, s41, s48
    s_mul_i32 s52, s40, 81920
    s_mul_i32 s54, s41, 192
    s_add_u32 s53, s54, 1536
    s_lshl_b32 s60, s42, 11
    s_mul_i32 s61, s42, 3072
    s_mov_b32 s6, 2621440
    s_mov_b32 s7, 0x20000
    s_mov_b32 s10, 1966080
    s_mov_b32 s11, 0x20000
    s_lshl_b32 s48, s42, 3
    v_add_u32 v4, s48, v2
    v_and_b32 v5, 15, v4
    v_xor_b32 v5, v5, v3
    v_mul_u32_u24 v4, 1280, v4
    v_lshl_add_u32 v38, v5, 4, v4
    v_add_u32 v4, s48, v2
    v_add_u32 v4, 4, v4
    v_and_b32 v5, 15, v4
    v_xor_b32 v5, v5, v3
    v_mul_u32_u24 v4, 1280, v4
    v_lshl_add_u32 v39, v5, 4, v4
    s_mul_i32 s48, s42, 192
    v_add_u32 v4, s48, v1
    v_mul_u32_u24 v5, 43691, v4
    v_lshrrev_b32 v5, 19, v5
    v_mul_u32_u24 v6, 12, v5
    v_sub_u32 v4, v4, v6
    v_lshrrev_b32 v6, 2, v5
    v_and_b32 v6, 2, v6
    v_xor_b32 v4, v4, v6
    v_mul_u32_u24 v5, 3072, v5
    v_lshl_add_u32 v40, v4, 4, v5
    v_add_u32 v4, s48, v1
    v_add_u32 v4, 64, v4
    v_mul_u32_u24 v5, 43691, v4
    v_lshrrev_b32 v5, 19, v5
    v_mul_u32_u24 v6, 12, v5
    v_sub_u32 v4, v4, v6
    v_lshrrev_b32 v6, 2, v5
    v_and_b32 v6, 2, v6
    v_xor_b32 v4, v4, v6
    v_mul_u32_u24 v5, 3072, v5
    v_lshl_add_u32 v41, v4, 4, v5
    v_add_u32 v4, s48, v1
    v_add_u32 v4, 128, v4
    v_mul_u32_u24 v5, 43691, v4
    v_lshrrev_b32 v5, 19, v5
    v_mul_u32_u24 v6, 12, v5
    v_sub_u32 v4, v4, v6
    v_lshrrev_b32 v6, 2, v5
    v_and_b32 v6, 2, v6
    v_xor_b32 v4, v4, v6
    v_mul_u32_u24 v5, 3072, v5
    v_lshl_add_u32 v42, v4, 4, v5
    s_add_u32 s48, s40, s41
    s_mul_i32 s49, s48, 52
    s_lshr_b32 s49, s49, 8
    s_mul_i32 s49, s49, 5
    s_sub_u32 s51, s48, s49
    s_add_u32 s49, s51, 0
    s_sub_u32 s50, s49, 5
    s_cmp_ge_u32 s49, 5
    s_cselect_b32 s49, s50, s49
    s_lshl_b32 s90, s49, 8
    s_mul_i32 s95, s49, 393216
    s_add_u32 s49, s51, 1
    s_sub_u32 s50, s49, 5
    s_cmp_ge_u32 s49, 5
    s_cselect_b32 s49, s50, s49
    s_lshl_b32 s91, s49, 8
    s_mul_i32 s96, s49, 393216
    s_waitcnt lgkmcnt(0)
    s_add_u32 s65, s52, s90
    s_add_u32 m0, s60, 0
    s_nop 0
    buffer_load_dwordx4 v38, s[4:7], s65 offen lds
    s_add_u32 s65, s52, s90
    s_add_u32 m0, s60, 1024
    s_nop 0
    buffer_load_dwordx4 v39, s[4:7], s65 offen lds
    s_add_u32 s65, s53, s95
    s_add_u32 m0, s61, 81920
    s_nop 0
    buffer_load_dwordx4 v40, s[8:11], s65 offen lds
    s_add_u32 s65, s53, s95
    s_add_u32 m0, s61, 82944
    s_nop 0
    buffer_load_dwordx4 v41, s[8:11], s65 offen lds
    s_add_u32 s65, s53, s95
    s_add_u32 m0, s61, 83968
    s_nop 0
    buffer_load_dwordx4 v42, s[8:11], s65 offen lds
    s_mov_b32 s48, 14712832
    s_load_dwordx2 s[100:101], s[24:25], s48
    s_add_u32 s49, s51, 2
    s_sub_u32 s50, s49, 5
    s_cmp_ge_u32 s49, 5
    s_cselect_b32 s49, s50, s49
    s_lshl_b32 s92, s49, 8
    s_mul_i32 s97, s49, 393216
    s_add_u32 s49, s51, 3
    s_sub_u32 s50, s49, 5
    s_cmp_ge_u32 s49, 5
    s_cselect_b32 s49, s50, s49
    s_lshl_b32 s93, s49, 8
    s_mul_i32 s98, s49, 393216
    s_add_u32 s49, s51, 4
    s_sub_u32 s50, s49, 5
    s_cmp_ge_u32 s49, 5
    s_cselect_b32 s49, s50, s49
    s_lshl_b32 s94, s49, 8
    s_mul_i32 s99, s49, 393216
    s_mov_b32 s14, 2621440
    s_mov_b32 s15, 0x20000
    s_mov_b32 s18, 2621440
    s_mov_b32 s19, 0x20000
    s_mov_b32 s22, 5120
    s_mov_b32 s23, 0x20000
    s_mov_b32 s26, 15990784
    s_mov_b32 s27, 0x20000
    s_mov_b32 s30, 256
    s_mov_b32 s31, 0x20000
    s_mov_b32 s34, 8388608
    s_mov_b32 s35, 0x20000
    s_mov_b32 s38, 2621440
    s_mov_b32 s39, 0x20000
    s_mov_b32 s86, 983040
    s_mov_b32 s87, 0x20000
    v_lshlrev_b32 v36, 7, v1
    s_barrier
    s_add_u32 s65, s52, s91
    s_add_u32 m0, s60, 16384
    s_nop 0
    buffer_load_dwordx4 v38, s[4:7], s65 offen lds
    s_add_u32 s65, s52, s91
    s_add_u32 m0, s60, 17408
    s_nop 0
    buffer_load_dwordx4 v39, s[4:7], s65 offen lds
    s_add_u32 s65, s53, s96
    s_add_u32 m0, s61, 106496
    s_nop 0
    buffer_load_dwordx4 v40, s[8:11], s65 offen lds
    s_add_u32 s65, s53, s96
    s_add_u32 m0, s61, 107520
    s_nop 0
    buffer_load_dwordx4 v41, s[8:11], s65 offen lds
    s_add_u32 s65, s53, s96
    s_add_u32 m0, s61, 108544
    s_nop 0
    buffer_load_dwordx4 v42, s[8:11], s65 offen lds
    s_cmp_lg_u32 s42, 7
    s_cbranch_scc1 k1_shk_1
    v_lshlrev_b32 v4, 4, v1
    s_mul_i32 s48, s41, 640
    s_mov_b32 m0, 160768
    s_mov_b32 exec_lo, -1
    s_mov_b32 exec_hi, 0xff
    buffer_load_dwordx4 v4, s[20:23], s48 offen lds
    s_mov_b64 exec, -1
k1_shk_1:
    s_and_b32 s43, s42, 1
    s_lshr_b32 s44, s42, 1
    s_and_b32 s44, s44, 1
    s_lshr_b32 s45, s42, 2
    s_xor_b32 s46, s43, s45
    s_lshl_b32 s47, s44, 1
    s_add_u32 s47, s47, s46
    s_mov_b32 s55, 0x3727c5ac
    s_mov_b32 s56, 0x3f803f80
    s_mov_b32 s58, 0xbdd2d3e8
    s_mov_b32 s59, 0xbdd2d3e8
    s_lshl_b32 s48, s45, 1
    s_add_u32 s63, s48, s44
    s_xor_b32 s64, s63, 1
    v_xor_b32 v4, v2, v3
    v_lshlrev_b32 v6, 8, v3
    s_lshl_b32 s48, s44, 13
    s_lshl_b32 s49, s46, 12
    s_add_u32 s50, s48, s49
    s_xor_b32 s49, s49, 4096
    s_add_u32 s51, s48, s49
    s_lshl_b32 s48, s63, 2
    v_xor_b32 v5, s48, v4
    v_lshl_add_u32 v5, v5, 4, v6
    v_add_u32 v45, s50, v5
    v_add_u32 v46, s51, v5
    s_lshl_b32 s48, s64, 2
    v_xor_b32 v5, s48, v4
    v_lshl_add_u32 v5, v5, 4, v6
    v_add_u32 v47, s50, v5
    v_add_u32 v216, s51, v5
    v_lshrrev_b32 v5, 2, v3
    v_lshl_add_u32 v4, v2, 3, v5
    v_mul_u32_u24 v4, 192, v4
    v_and_b32 v5, 3, v3
    v_lshl_add_u32 v4, v5, 3, v4
    v_and_b32 v5, 1, v2
    s_mul_i32 s51, s43, 3
    s_mul_i32 s49, s63, 6144
    s_add_u32 s49, s49, 81920
    s_mul_i32 s50, s64, 6144
    s_add_u32 s50, s50, 81920
    s_add_u32 s48, s51, 0
    v_xor_b32 v6, s48, v5
    v_lshl_add_u32 v6, v6, 5, v4
    v_add_u32 v217, s49, v6
    v_add_u32 v220, s50, v6
    s_add_u32 s48, s51, 1
    v_xor_b32 v6, s48, v5
    v_lshl_add_u32 v6, v6, 5, v4
    v_add_u32 v218, s49, v6
    v_add_u32 v221, s50, v6
    s_add_u32 s48, s51, 2
    v_xor_b32 v6, s48, v5
    v_lshl_add_u32 v6, v6, 5, v4
    v_add_u32 v219, s49, v6
    v_add_u32 v222, s50, v6
    v_mov_b32 v244, s56
    v_mov_b32 v245, s56
    v_mov_b32 v246, s56
    v_mov_b32 v247, s56
    v_mul_u32_u24 v43, 205, v1
    v_lshrrev_b32 v43, 11, v43
    v_mul_u32_u24 v4, 10, v43
    v_sub_u32 v44, v1, v4
    s_lshl_b32 s48, s42, 3
    v_lshl_add_u32 v4, v43, 1, s48
    v_min_u32 v4, 62, v4
    v_mul_u32_u24 v4, 160, v4
    v_lshl_add_u32 v7, v44, 4, v4
    v_lshlrev_b32 v215, 10, v1
    s_lshl_b32 s89, s2, 3
    s_add_u32 s89, s89, s42
    s_waitcnt vmcnt(5)
    s_waitcnt lgkmcnt(0)
    s_add_u32 s100, s100, 1
    s_addc_u32 s101, s101, 0
    s_barrier
    ds_read_b64_tr_b16 v[128:129], v217 offset:0
    ds_read_b64_tr_b16 v[130:131], v217 offset:768
    ds_read_b64_tr_b16 v[132:133], v218 offset:0
    ds_read_b64_tr_b16 v[134:135], v218 offset:768
    ds_read_b64_tr_b16 v[136:137], v219 offset:0
    ds_read_b64_tr_b16 v[138:139], v219 offset:768
    ds_read_b64_tr_b16 v[140:141], v220 offset:0
    ds_read_b64_tr_b16 v[142:143], v220 offset:768
    ds_read_b64_tr_b16 v[144:145], v221 offset:0
    ds_read_b64_tr_b16 v[146:147], v221 offset:768
    ds_read_b64_tr_b16 v[148:149], v222 offset:0
    ds_read_b64_tr_b16 v[150:151], v222 offset:768
    ds_read_b128 v[48:51], v45 offset:0
    ds_read_b128 v[52:55], v46 offset:0
    ds_read_b128 v[56:59], v47 offset:0
    ds_read_b128 v[60:63], v216 offset:0
    s_add_u32 s65, s52, s92
    s_add_u32 m0, s60, 32768
    s_nop 0
    buffer_load_dwordx4 v38, s[4:7], s65 offen lds
    s_add_u32 s65, s52, s92
    s_add_u32 m0, s60, 33792
    s_nop 0
    buffer_load_dwordx4 v39, s[4:7], s65 offen lds
    s_add_u32 s65, s53, s97
    s_add_u32 m0, s61, 131072
    s_nop 0
    buffer_load_dwordx4 v40, s[8:11], s65 offen lds
    s_add_u32 s65, s53, s97
    s_add_u32 m0, s61, 132096
    s_nop 0
    buffer_load_dwordx4 v41, s[8:11], s65 offen lds
    s_add_u32 s65, s53, s97
    s_add_u32 m0, s61, 133120
    s_nop 0
    buffer_load_dwordx4 v42, s[8:11], s65 offen lds
    s_waitcnt vmcnt(5)
    s_waitcnt lgkmcnt(0)
    s_barrier
    v_mfma_f32_16x16x32_bf16 v[176:179], v[128:131], v[48:51], 0
    ds_read_b64_tr_b16 v[152:153], v217 offset:24576
    ds_read_b64_tr_b16 v[154:155], v217 offset:25344
    v_mfma_f32_16x16x32_bf16 v[180:183], v[128:131], v[52:55], 0
    s_add_u32 s65, s52, s93
    s_add_u32 m0, s60, 49152
    s_nop 0
    buffer_load_dwordx4 v38, s[4:7], s65 offen lds
    ds_read_b64_tr_b16 v[156:157], v218 offset:24576
    ds_read_b64_tr_b16 v[158:159], v218 offset:25344
    v_mfma_f32_16x16x32_bf16 v[224:227], v[128:131], v[244:247], 0
    ds_read_b64_tr_b16 v[160:161], v219 offset:24576
    ds_read_b64_tr_b16 v[162:163], v219 offset:25344
    v_mfma_f32_16x16x32_bf16 v[184:187], v[132:135], v[48:51], 0
    ds_read_b64_tr_b16 v[164:165], v220 offset:24576
    ds_read_b64_tr_b16 v[166:167], v220 offset:25344
    v_mfma_f32_16x16x32_bf16 v[188:191], v[132:135], v[52:55], 0
    s_add_u32 s65, s52, s93
    s_add_u32 m0, s60, 50176
    s_nop 0
    buffer_load_dwordx4 v39, s[4:7], s65 offen lds
    ds_read_b64_tr_b16 v[168:169], v221 offset:24576
    ds_read_b64_tr_b16 v[170:171], v221 offset:25344
    v_mfma_f32_16x16x32_bf16 v[228:231], v[132:135], v[244:247], 0
    ds_read_b64_tr_b16 v[172:173], v222 offset:24576
    ds_read_b64_tr_b16 v[174:175], v222 offset:25344
    v_mfma_f32_16x16x32_bf16 v[192:195], v[136:139], v[48:51], 0
    ds_read_b128 v[64:67], v45 offset:16384
    ds_read_b128 v[68:71], v46 offset:16384
    v_mfma_f32_16x16x32_bf16 v[196:199], v[136:139], v[52:55], 0
    s_add_u32 s65, s53, s98
    s_add_u32 m0, s61, 81920
    s_nop 0
    buffer_load_dwordx4 v40, s[8:11], s65 offen lds
    ds_read_b128 v[72:75], v47 offset:16384
    ds_read_b128 v[76:79], v216 offset:16384
    v_mfma_f32_16x16x32_bf16 v[232:235], v[136:139], v[244:247], 0
    v_mfma_f32_16x16x32_bf16 v[236:239], v[244:247], v[48:51], 0
    v_mfma_f32_16x16x32_bf16 v[240:243], v[48:51], v[48:51], 0
    s_add_u32 s65, s53, s98
    s_add_u32 m0, s61, 82944
    s_nop 0
    buffer_load_dwordx4 v41, s[8:11], s65 offen lds
    v_mfma_f32_16x16x32_bf16 v[176:179], v[140:143], v[56:59], v[176:179]
    v_mfma_f32_16x16x32_bf16 v[180:183], v[140:143], v[60:63], v[180:183]
    v_mfma_f32_16x16x32_bf16 v[184:187], v[144:147], v[56:59], v[184:187]
    s_add_u32 s65, s53, s98
    s_add_u32 m0, s61, 83968
    s_nop 0
    buffer_load_dwordx4 v42, s[8:11], s65 offen lds
    v_mfma_f32_16x16x32_bf16 v[188:191], v[144:147], v[60:63], v[188:191]
    v_mfma_f32_16x16x32_bf16 v[192:195], v[148:151], v[56:59], v[192:195]
    v_mfma_f32_16x16x32_bf16 v[196:199], v[148:151], v[60:63], v[196:199]
    v_mfma_f32_16x16x32_bf16 v[236:239], v[244:247], v[56:59], v[236:239]
    v_mfma_f32_16x16x32_bf16 v[240:243], v[56:59], v[56:59], v[240:243]
    s_waitcnt vmcnt(5)
    s_waitcnt lgkmcnt(0)
    s_barrier
    v_mfma_f32_16x16x32_bf16 v[176:179], v[152:155], v[64:67], v[176:179]
    ds_read_b64_tr_b16 v[128:129], v217 offset:49152
    ds_read_b64_tr_b16 v[130:131], v217 offset:49920
    v_mfma_f32_16x16x32_bf16 v[180:183], v[152:155], v[68:71], v[180:183]
    s_add_u32 s65, s52, s94
    s_add_u32 m0, s60, 65536
    s_nop 0
    buffer_load_dwordx4 v38, s[4:7], s65 offen lds
    ds_read_b64_tr_b16 v[132:133], v218 offset:49152
    ds_read_b64_tr_b16 v[134:135], v218 offset:49920
    v_mfma_f32_16x16x32_bf16 v[224:227], v[152:155], v[244:247], v[224:227]
    ds_read_b64_tr_b16 v[136:137], v219 offset:49152
    ds_read_b64_tr_b16 v[138:139], v219 offset:49920
    v_mfma_f32_16x16x32_bf16 v[184:187], v[156:159], v[64:67], v[184:187]
    ds_read_b64_tr_b16 v[140:141], v220 offset:49152
    ds_read_b64_tr_b16 v[142:143], v220 offset:49920
    v_mfma_f32_16x16x32_bf16 v[188:191], v[156:159], v[68:71], v[188:191]
    s_add_u32 s65, s52, s94
    s_add_u32 m0, s60, 66560
    s_nop 0
    buffer_load_dwordx4 v39, s[4:7], s65 offen lds
    ds_read_b64_tr_b16 v[144:145], v221 offset:49152
    ds_read_b64_tr_b16 v[146:147], v221 offset:49920
    v_mfma_f32_16x16x32_bf16 v[228:231], v[156:159], v[244:247], v[228:231]
    ds_read_b64_tr_b16 v[148:149], v222 offset:49152
    ds_read_b64_tr_b16 v[150:151], v222 offset:49920
    v_mfma_f32_16x16x32_bf16 v[192:195], v[160:163], v[64:67], v[192:195]
    ds_read_b128 v[80:83], v45 offset:32768
    ds_read_b128 v[84:87], v46 offset:32768
    v_mfma_f32_16x16x32_bf16 v[196:199], v[160:163], v[68:71], v[196:199]
    s_add_u32 s65, s53, s99
    s_add_u32 m0, s61, 106496
    s_nop 0
    buffer_load_dwordx4 v40, s[8:11], s65 offen lds
    ds_read_b128 v[88:91], v47 offset:32768
    ds_read_b128 v[92:95], v216 offset:32768
    v_mfma_f32_16x16x32_bf16 v[232:235], v[160:163], v[244:247], v[232:235]
    v_mfma_f32_16x16x32_bf16 v[236:239], v[244:247], v[64:67], v[236:239]
    v_mfma_f32_16x16x32_bf16 v[240:243], v[64:67], v[64:67], v[240:243]
    s_add_u32 s65, s53, s99
    s_add_u32 m0, s61, 107520
    s_nop 0
    buffer_load_dwordx4 v41, s[8:11], s65 offen lds
    v_mfma_f32_16x16x32_bf16 v[176:179], v[164:167], v[72:75], v[176:179]
    v_mfma_f32_16x16x32_bf16 v[180:183], v[164:167], v[76:79], v[180:183]
    v_mfma_f32_16x16x32_bf16 v[184:187], v[168:171], v[72:75], v[184:187]
    s_add_u32 s65, s53, s99
    s_add_u32 m0, s61, 108544
    s_nop 0
    buffer_load_dwordx4 v42, s[8:11], s65 offen lds
    v_mfma_f32_16x16x32_bf16 v[188:191], v[168:171], v[76:79], v[188:191]
    v_mfma_f32_16x16x32_bf16 v[192:195], v[172:175], v[72:75], v[192:195]
    v_mfma_f32_16x16x32_bf16 v[196:199], v[172:175], v[76:79], v[196:199]
    s_lshr_b32 s48, s2, 3
    s_lshl_b32 s48, s48, 3
    s_add_u32 s48, s48, s42
    s_lshl_b32 s48, s48, 13
    s_lshl_b32 s49, s66, 21
    s_add_u32 s48, s48, s49
    s_add_u32 s48, s48, 0
    s_mov_b64 exec, 0xff
    buffer_load_dword v37, v215, s[32:35], s48 offen
    s_mov_b64 exec, -1
    v_mfma_f32_16x16x32_bf16 v[236:239], v[244:247], v[72:75], v[236:239]
    v_mfma_f32_16x16x32_bf16 v[240:243], v[72:75], v[72:75], v[240:243]
    s_waitcnt vmcnt(6)
    s_waitcnt lgkmcnt(0)
    s_barrier
    v_mfma_f32_16x16x32_bf16 v[176:179], v[128:131], v[80:83], v[176:179]
    ds_read_b64_tr_b16 v[152:153], v217 offset:0
    ds_read_b64_tr_b16 v[154:155], v217 offset:768
    v_mfma_f32_16x16x32_bf16 v[180:183], v[128:131], v[84:87], v[180:183]
    s_add_u32 s65, s54, s95
    s_add_u32 m0, s61, 131072
    s_nop 0
    buffer_load_dwordx4 v40, s[8:11], s65 offen lds
    ds_read_b64_tr_b16 v[156:157], v218 offset:0
    ds_read_b64_tr_b16 v[158:159], v218 offset:768
    v_mfma_f32_16x16x32_bf16 v[224:227], v[128:131], v[244:247], v[224:227]
    ds_read_b64_tr_b16 v[160:161], v219 offset:0
    ds_read_b64_tr_b16 v[162:163], v219 offset:768
    v_mfma_f32_16x16x32_bf16 v[184:187], v[132:135], v[80:83], v[184:187]
    ds_read_b64_tr_b16 v[164:165], v220 offset:0
    ds_read_b64_tr_b16 v[166:167], v220 offset:768
    v_mfma_f32_16x16x32_bf16 v[188:191], v[132:135], v[84:87], v[188:191]
    s_add_u32 s65, s54, s95
    s_add_u32 m0, s61, 132096
    s_nop 0
    buffer_load_dwordx4 v41, s[8:11], s65 offen lds
    ds_read_b64_tr_b16 v[168:169], v221 offset:0
    ds_read_b64_tr_b16 v[170:171], v221 offset:768
    v_mfma_f32_16x16x32_bf16 v[228:231], v[132:135], v[244:247], v[228:231]
    ds_read_b64_tr_b16 v[172:173], v222 offset:0
    ds_read_b64_tr_b16 v[174:175], v222 offset:768
    v_mfma_f32_16x16x32_bf16 v[192:195], v[136:139], v[80:83], v[192:195]
    ds_read_b128 v[96:99], v45 offset:49152
    ds_read_b128 v[100:103], v46 offset:49152
    v_mfma_f32_16x16x32_bf16 v[196:199], v[136:139], v[84:87], v[196:199]
    s_add_u32 s65, s54, s95
    s_add_u32 m0, s61, 133120
    s_nop 0
    buffer_load_dwordx4 v42, s[8:11], s65 offen lds
    ds_read_b128 v[104:107], v47 offset:49152
    ds_read_b128 v[108:111], v216 offset:49152
    v_mfma_f32_16x16x32_bf16 v[232:235], v[136:139], v[244:247], v[232:235]
    v_mfma_f32_16x16x32_bf16 v[236:239], v[244:247], v[80:83], v[236:239]
    v_mfma_f32_16x16x32_bf16 v[240:243], v[80:83], v[80:83], v[240:243]
    s_lshr_b32 s48, s2, 3
    s_lshl_b32 s48, s48, 3
    s_add_u32 s48, s48, s42
    s_lshl_b32 s48, s48, 13
    s_lshl_b32 s49, s66, 21
    s_add_u32 s48, s48, s49
    s_add_u32 s48, s48, 128
    s_mov_b64 exec, 0xff
    buffer_load_dword v37, v215, s[32:35], s48 offen
    s_mov_b64 exec, -1
    v_mfma_f32_16x16x32_bf16 v[176:179], v[140:143], v[88:91], v[176:179]
    v_mfma_f32_16x16x32_bf16 v[180:183], v[140:143], v[92:95], v[180:183]
    v_mfma_f32_16x16x32_bf16 v[184:187], v[144:147], v[88:91], v[184:187]
    s_mul_i32 s48, s89, 1280
    s_add_u32 s48, s48, 0
    s_mov_b64 exec, 0x1f
    buffer_load_dword v37, v36, s[36:39], s48 offen
    s_mov_b64 exec, -1
    v_mfma_f32_16x16x32_bf16 v[188:191], v[144:147], v[92:95], v[188:191]
    v_mfma_f32_16x16x32_bf16 v[192:195], v[148:151], v[88:91], v[192:195]
    v_mfma_f32_16x16x32_bf16 v[196:199], v[148:151], v[92:95], v[196:199]
    v_mfma_f32_16x16x32_bf16 v[236:239], v[244:247], v[88:91], v[236:239]
    v_mfma_f32_16x16x32_bf16 v[240:243], v[88:91], v[88:91], v[240:243]
    s_waitcnt vmcnt(6)
    s_waitcnt lgkmcnt(0)
    s_barrier
    v_mfma_f32_16x16x32_bf16 v[176:179], v[152:155], v[96:99], v[176:179]
    ds_read_b64_tr_b16 v[128:129], v217 offset:24576
    ds_read_b64_tr_b16 v[130:131], v217 offset:25344
    v_mfma_f32_16x16x32_bf16 v[180:183], v[152:155], v[100:103], v[180:183]
    s_add_u32 s65, s54, s96
    s_add_u32 m0, s61, 81920
    s_nop 0
    buffer_load_dwordx4 v40, s[8:11], s65 offen lds
    ds_read_b64_tr_b16 v[132:133], v218 offset:24576
    ds_read_b64_tr_b16 v[134:135], v218 offset:25344
    v_mfma_f32_16x16x32_bf16 v[224:227], v[152:155], v[244:247], v[224:227]
    ds_read_b64_tr_b16 v[136:137], v219 offset:24576
    ds_read_b64_tr_b16 v[138:139], v219 offset:25344
    v_mfma_f32_16x16x32_bf16 v[184:187], v[156:159], v[96:99], v[184:187]
    ds_read_b64_tr_b16 v[140:141], v220 offset:24576
    ds_read_b64_tr_b16 v[142:143], v220 offset:25344
    v_mfma_f32_16x16x32_bf16 v[188:191], v[156:159], v[100:103], v[188:191]
    s_add_u32 s65, s54, s96
    s_add_u32 m0, s61, 82944
    s_nop 0
    buffer_load_dwordx4 v41, s[8:11], s65 offen lds
    ds_read_b64_tr_b16 v[144:145], v221 offset:24576
    ds_read_b64_tr_b16 v[146:147], v221 offset:25344
    v_mfma_f32_16x16x32_bf16 v[228:231], v[156:159], v[244:247], v[228:231]
    ds_read_b64_tr_b16 v[148:149], v222 offset:24576
    ds_read_b64_tr_b16 v[150:151], v222 offset:25344
    v_mfma_f32_16x16x32_bf16 v[192:195], v[160:163], v[96:99], v[192:195]
    v_add_u32 v45, 0x10000, v45
    v_add_u32 v46, 0x10000, v46
    v_add_u32 v47, 0x10000, v47
    v_add_u32 v216, 0x10000, v216
    ds_read_b128 v[112:115], v45 offset:0
    ds_read_b128 v[116:119], v46 offset:0
    v_mfma_f32_16x16x32_bf16 v[196:199], v[160:163], v[100:103], v[196:199]
    s_add_u32 s65, s54, s96
    s_add_u32 m0, s61, 83968
    s_nop 0
    buffer_load_dwordx4 v42, s[8:11], s65 offen lds
    ds_read_b128 v[120:123], v47 offset:0
    ds_read_b128 v[124:127], v216 offset:0
    v_mfma_f32_16x16x32_bf16 v[232:235], v[160:163], v[244:247], v[232:235]
    v_mfma_f32_16x16x32_bf16 v[236:239], v[244:247], v[96:99], v[236:239]
    v_mfma_f32_16x16x32_bf16 v[240:243], v[96:99], v[96:99], v[240:243]
    s_lshr_b32 s48, s2, 3
    s_lshl_b32 s48, s48, 3
    s_add_u32 s48, s48, s42
    s_lshl_b32 s48, s48, 13
    s_lshl_b32 s49, s66, 21
    s_add_u32 s48, s48, s49
    s_add_u32 s48, s48, 256
    s_mov_b64 exec, 0xff
    buffer_load_dword v37, v215, s[32:35], s48 offen
    s_mov_b64 exec, -1
    v_mfma_f32_16x16x32_bf16 v[176:179], v[164:167], v[104:107], v[176:179]
    v_mfma_f32_16x16x32_bf16 v[180:183], v[164:167], v[108:111], v[180:183]
    v_mfma_f32_16x16x32_bf16 v[184:187], v[168:171], v[104:107], v[184:187]
    v_mfma_f32_16x16x32_bf16 v[188:191], v[168:171], v[108:111], v[188:191]
    v_mfma_f32_16x16x32_bf16 v[192:195], v[172:175], v[104:107], v[192:195]
    v_mfma_f32_16x16x32_bf16 v[196:199], v[172:175], v[108:111], v[196:199]
    v_mfma_f32_16x16x32_bf16 v[236:239], v[244:247], v[104:107], v[236:239]
    v_mfma_f32_16x16x32_bf16 v[240:243], v[104:107], v[104:107], v[240:243]
    s_waitcnt vmcnt(6)
    s_waitcnt lgkmcnt(0)
    s_barrier
    v_mfma_f32_16x16x32_bf16 v[176:179], v[128:131], v[112:115], v[176:179]
    ds_read_b64_tr_b16 v[152:153], v217 offset:49152
    ds_read_b64_tr_b16 v[154:155], v217 offset:49920
    v_mfma_f32_16x16x32_bf16 v[180:183], v[128:131], v[116:119], v[180:183]
    s_add_u32 s65, s54, s97
    s_add_u32 m0, s61, 106496
    s_nop 0
    buffer_load_dwordx4 v40, s[8:11], s65 offen lds
    ds_read_b64_tr_b16 v[156:157], v218 offset:49152
    ds_read_b64_tr_b16 v[158:159], v218 offset:49920
    v_mfma_f32_16x16x32_bf16 v[224:227], v[128:131], v[244:247], v[224:227]
    ds_read_b64_tr_b16 v[160:161], v219 offset:49152
    ds_read_b64_tr_b16 v[162:163], v219 offset:49920
    v_mfma_f32_16x16x32_bf16 v[184:187], v[132:135], v[112:115], v[184:187]
    ds_read_b64_tr_b16 v[164:165], v220 offset:49152
    ds_read_b64_tr_b16 v[166:167], v220 offset:49920
    v_mfma_f32_16x16x32_bf16 v[188:191], v[132:135], v[116:119], v[188:191]
    s_add_u32 s65, s54, s97
    s_add_u32 m0, s61, 107520
    s_nop 0
    buffer_load_dwordx4 v41, s[8:11], s65 offen lds
    ds_read_b64_tr_b16 v[168:169], v221 offset:49152
    ds_read_b64_tr_b16 v[170:171], v221 offset:49920
    v_mfma_f32_16x16x32_bf16 v[228:231], v[132:135], v[244:247], v[228:231]
    ds_read_b64_tr_b16 v[172:173], v222 offset:49152
    ds_read_b64_tr_b16 v[174:175], v222 offset:49920
    v_mfma_f32_16x16x32_bf16 v[192:195], v[136:139], v[112:115], v[192:195]
    v_mfma_f32_16x16x32_bf16 v[196:199], v[136:139], v[116:119], v[196:199]
    s_add_u32 s65, s54, s97
    s_add_u32 m0, s61, 108544
    s_nop 0
    buffer_load_dwordx4 v42, s[8:11], s65 offen lds
    v_mfma_f32_16x16x32_bf16 v[232:235], v[136:139], v[244:247], v[232:235]
    v_mfma_f32_16x16x32_bf16 v[236:239], v[244:247], v[112:115], v[236:239]
    v_mfma_f32_16x16x32_bf16 v[240:243], v[112:115], v[112:115], v[240:243]
    s_lshr_b32 s48, s2, 3
    s_lshl_b32 s48, s48, 3
    s_add_u32 s48, s48, s42
    s_lshl_b32 s48, s48, 13
    s_lshl_b32 s49, s66, 21
    s_add_u32 s48, s48, s49
    s_add_u32 s48, s48, 384
    s_mov_b64 exec, 0xff
    buffer_load_dword v37, v215, s[32:35], s48 offen
    s_mov_b64 exec, -1
    v_mfma_f32_16x16x32_bf16 v[176:179], v[140:143], v[120:123], v[176:179]
    v_mfma_f32_16x16x32_bf16 v[180:183], v[140:143], v[124:127], v[180:183]
    v_mfma_f32_16x16x32_bf16 v[184:187], v[144:147], v[120:123], v[184:187]
    v_mfma_f32_16x16x32_bf16 v[188:191], v[144:147], v[124:127], v[188:191]
    v_mfma_f32_16x16x32_bf16 v[192:195], v[148:151], v[120:123], v[192:195]
    v_mfma_f32_16x16x32_bf16 v[196:199], v[148:151], v[124:127], v[196:199]
    v_mfma_f32_16x16x32_bf16 v[236:239], v[244:247], v[120:123], v[236:239]
    v_mfma_f32_16x16x32_bf16 v[240:243], v[120:123], v[120:123], v[240:243]
    s_mul_i32 s48, s42, 3072
    s_add_u32 s48, s48, 16384
    v_lshl_add_u32 v4, v1, 4, s48
    s_lshl_b32 s48, s43, 2
    s_lshl_b32 s49, s44, 1
    s_add_u32 s48, s48, s49
    s_add_u32 s48, s48, s45
    s_mul_i32 s48, s48, 192
    s_add_u32 s48, s48, 155648
    v_lshl_add_u32 v5, v2, 4, s48
    ds_write_b128 v4, v[180:183] offset:0
    ds_write_b128 v4, v[188:191] offset:1024
    ds_write_b128 v4, v[196:199] offset:2048
    s_mov_b32 exec_lo, 0x00010001
    s_mov_b32 exec_hi, 0x00010001
    ds_write_b128 v5, v[224:227] offset:0
    ds_write_b128 v5, v[228:231] offset:64
    ds_write_b128 v5, v[232:235] offset:128
    s_mov_b64 exec, -1
    v_and_b32 v8, 3, v3
    v_cmp_eq_u32 vcc, 1, v8
    s_nop 1
    v_cndmask_b32 v237, v240, v241, vcc
    v_cmp_eq_u32 vcc, 2, v8
    s_nop 1
    v_cndmask_b32 v237, v237, v242, vcc
    v_cmp_eq_u32 vcc, 3, v8
    s_nop 1
    v_cndmask_b32 v237, v237, v243, vcc
    s_lshl_b32 s48, s47, 1
    s_add_u32 s48, s48, s45
    s_lshl_b32 s48, s48, 7
    s_add_u32 s48, s48, 158720
    v_lshl_add_u32 v6, v3, 3, s48
    s_mov_b32 exec_lo, 0x00F0000F
    s_mov_b32 exec_hi, 0xF0000F00
    ds_write_b64 v6, v[236:237]
    s_mov_b64 exec, -1
    v_pk_add_f32 v[200:201], v[176:177], 0
    v_pk_add_f32 v[202:203], v[178:179], 0
    v_pk_add_f32 v[204:205], v[184:185], 0
    v_pk_add_f32 v[206:207], v[186:187], 0
    v_pk_add_f32 v[208:209], v[192:193], 0
    v_pk_add_f32 v[210:211], v[194:195], 0
    v_mov_b32 v238, 0xc0135761
    v_mov_b32 v239, 0xc0135761
    s_waitcnt vmcnt(5)
    s_waitcnt lgkmcnt(0)
    s_barrier
    s_xor_b32 s48, s42, 4
    s_mul_i32 s48, s48, 3072
    s_add_u32 s48, s48, 16384
    v_lshl_add_u32 v4, v1, 4, s48
    s_lshl_b32 s48, s47, 8
    s_add_u32 s48, s48, 158720
    v_lshl_add_u32 v5, v3, 3, s48
    ds_read_b64 v[20:21], v5
    ds_read_b64 v[22:23], v5 offset:128
    ds_read_b128 v[8:11], v4 offset:0
    ds_read_b128 v[12:15], v4 offset:1024
    ds_read_b128 v[16:19], v4 offset:2048
    s_mul_i32 s48, s43, 768
    s_add_u32 s48, s48, 155648
    v_lshl_add_u32 v6, v2, 4, s48
    ds_read_b128 v[24:27], v6 offset:0
    ds_read_b128 v[28:31], v6 offset:64
    ds_read_b128 v[32:35], v6 offset:128
    ds_read_b128 v[176:179], v6 offset:192
    ds_read_b128 v[180:183], v6 offset:256
    ds_read_b128 v[184:187], v6 offset:320
    ds_read_b128 v[188:191], v6 offset:384
    ds_read_b128 v[192:195], v6 offset:448
    ds_read_b128 v[196:199], v6 offset:512
    ds_read_b128 v[224:227], v6 offset:576
    ds_read_b128 v[228:231], v6 offset:640
    ds_read_b128 v[232:235], v6 offset:704
    s_waitcnt lgkmcnt(15)
    v_pk_add_f32 v[240:241], v[20:21], v[22:23]
    v_mul_f32 v240, 0x3acccccd, v240
    v_mul_f32 v241, 0x3acccccd, v241
    v_fma_f32 v241, -v240, v240, v241
    v_max_f32 v241, 0, v241
    v_cvt_pk_bf16_f32 v241, v241, v240
    v_and_b32 v240, 0xffff0000, v241
    v_lshlrev_b32 v241, 16, v241
    v_add_f32 v241, s55, v241
    v_cvt_pk_bf16_f32 v241, v241, v241
    v_and_b32 v241, 0xffff0000, v241
    v_sqrt_f32 v241, v241
    s_nop 0
    v_cvt_pk_bf16_f32 v241, v241, v241
    v_and_b32 v241, 0xffff0000, v241
    v_rcp_f32 v241, v241
    s_nop 0
    v_mov_b32 v242, v241
    s_waitcnt lgkmcnt(12)
    v_pk_add_f32 v[200:201], v[200:201], v[8:9]
    v_pk_add_f32 v[202:203], v[202:203], v[10:11]
    v_pk_add_f32 v[204:205], v[204:205], v[12:13]
    v_pk_add_f32 v[206:207], v[206:207], v[14:15]
    v_pk_add_f32 v[208:209], v[208:209], v[16:17]
    v_pk_add_f32 v[210:211], v[210:211], v[18:19]
    s_waitcnt lgkmcnt(6)
    v_pk_add_f32 v[24:25], v[24:25], v[176:177]
    v_pk_add_f32 v[26:27], v[26:27], v[178:179]
    v_pk_add_f32 v[28:29], v[28:29], v[180:181]
    v_pk_add_f32 v[30:31], v[30:31], v[182:183]
    v_pk_add_f32 v[32:33], v[32:33], v[184:185]
    v_pk_add_f32 v[34:35], v[34:35], v[186:187]
    s_waitcnt lgkmcnt(0)
    v_pk_add_f32 v[188:189], v[188:189], v[224:225]
    v_pk_add_f32 v[190:191], v[190:191], v[226:227]
    v_pk_add_f32 v[192:193], v[192:193], v[228:229]
    v_pk_add_f32 v[194:195], v[194:195], v[230:231]
    v_pk_add_f32 v[196:197], v[196:197], v[232:233]
    v_pk_add_f32 v[198:199], v[198:199], v[234:235]
    v_pk_add_f32 v[24:25], v[24:25], v[188:189]
    v_pk_add_f32 v[26:27], v[26:27], v[190:191]
    v_pk_add_f32 v[28:29], v[28:29], v[192:193]
    v_pk_add_f32 v[30:31], v[30:31], v[194:195]
    v_pk_add_f32 v[32:33], v[32:33], v[196:197]
    v_pk_add_f32 v[34:35], v[34:35], v[198:199]
    v_pk_fma_f32 v[200:201], v[24:25], v[240:241], v[200:201] op_sel_hi:[1,0,1] neg_lo:[0,1,0] neg_hi:[0,1,0]
    v_pk_fma_f32 v[202:203], v[26:27], v[240:241], v[202:203] op_sel_hi:[1,0,1] neg_lo:[0,1,0] neg_hi:[0,1,0]
    v_pk_fma_f32 v[204:205], v[28:29], v[240:241], v[204:205] op_sel_hi:[1,0,1] neg_lo:[0,1,0] neg_hi:[0,1,0]
    v_pk_fma_f32 v[206:207], v[30:31], v[240:241], v[206:207] op_sel_hi:[1,0,1] neg_lo:[0,1,0] neg_hi:[0,1,0]
    v_pk_fma_f32 v[208:209], v[32:33], v[240:241], v[208:209] op_sel_hi:[1,0,1] neg_lo:[0,1,0] neg_hi:[0,1,0]
    v_pk_fma_f32 v[210:211], v[34:35], v[240:241], v[210:211] op_sel_hi:[1,0,1] neg_lo:[0,1,0] neg_hi:[0,1,0]
    v_pk_mul_f32 v[200:201], v[200:201], v[242:243] op_sel_hi:[1,0]
    v_pk_mul_f32 v[202:203], v[202:203], v[242:243] op_sel_hi:[1,0]
    v_pk_mul_f32 v[204:205], v[204:205], v[242:243] op_sel_hi:[1,0]
    v_pk_mul_f32 v[206:207], v[206:207], v[242:243] op_sel_hi:[1,0]
    v_pk_mul_f32 v[208:209], v[208:209], v[242:243] op_sel_hi:[1,0]
    v_pk_mul_f32 v[210:211], v[210:211], v[242:243] op_sel_hi:[1,0]
    v_pk_mul_f32 v[8:9], v[200:201], v[200:201]
    v_pk_mul_f32 v[10:11], v[202:203], v[202:203]
    v_pk_mul_f32 v[12:13], v[204:205], v[204:205]
    v_pk_mul_f32 v[14:15], v[206:207], v[206:207]
    v_pk_mul_f32 v[16:17], v[208:209], v[208:209]
    v_pk_mul_f32 v[18:19], v[210:211], v[210:211]
    v_pk_fma_f32 v[8:9], v[8:9], s[58:59], v[238:239]
    v_pk_fma_f32 v[10:11], v[10:11], s[58:59], v[238:239]
    v_pk_fma_f32 v[12:13], v[12:13], s[58:59], v[238:239]
    v_pk_fma_f32 v[14:15], v[14:15], s[58:59], v[238:239]
    v_pk_fma_f32 v[16:17], v[16:17], s[58:59], v[238:239]
    v_pk_fma_f32 v[18:19], v[18:19], s[58:59], v[238:239]
    v_pk_mul_f32 v[8:9], v[8:9], v[200:201]
    v_pk_mul_f32 v[10:11], v[10:11], v[202:203]
    v_pk_mul_f32 v[12:13], v[12:13], v[204:205]
    v_pk_mul_f32 v[14:15], v[14:15], v[206:207]
    v_pk_mul_f32 v[16:17], v[16:17], v[208:209]
    v_pk_mul_f32 v[18:19], v[18:19], v[210:211]
    v_exp_f32 v8, v8
    v_exp_f32 v9, v9
    v_exp_f32 v10, v10
    v_exp_f32 v11, v11
    v_exp_f32 v12, v12
    v_exp_f32 v13, v13
    v_exp_f32 v14, v14
    v_exp_f32 v15, v15
    v_exp_f32 v16, v16
    v_exp_f32 v17, v17
    v_exp_f32 v18, v18
    v_exp_f32 v19, v19
    v_pk_add_f32 v[8:9], v[8:9], 1.0 op_sel_hi:[1,0]
    v_pk_add_f32 v[10:11], v[10:11], 1.0 op_sel_hi:[1,0]
    v_pk_add_f32 v[12:13], v[12:13], 1.0 op_sel_hi:[1,0]
    v_pk_add_f32 v[14:15], v[14:15], 1.0 op_sel_hi:[1,0]
    v_pk_add_f32 v[16:17], v[16:17], 1.0 op_sel_hi:[1,0]
    v_pk_add_f32 v[18:19], v[18:19], 1.0 op_sel_hi:[1,0]
    v_rcp_f32 v8, v8
    v_rcp_f32 v9, v9
    v_rcp_f32 v10, v10
    v_rcp_f32 v11, v11
    v_rcp_f32 v12, v12
    v_rcp_f32 v13, v13
    v_rcp_f32 v14, v14
    v_rcp_f32 v15, v15
    v_rcp_f32 v16, v16
    v_rcp_f32 v17, v17
    v_rcp_f32 v18, v18
    v_rcp_f32 v19, v19
    v_pk_mul_f32 v[200:201], v[200:201], v[8:9]
    v_pk_mul_f32 v[202:203], v[202:203], v[10:11]
    v_pk_mul_f32 v[204:205], v[204:205], v[12:13]
    v_pk_mul_f32 v[206:207], v[206:207], v[14:15]
    v_pk_mul_f32 v[208:209], v[208:209], v[16:17]
    v_pk_mul_f32 v[210:211], v[210:211], v[18:19]
    v_pk_add_f32 v[14:15], v[200:201], v[202:203]
    v_pk_mul_f32 v[16:17], v[200:201], v[200:201]
    v_pk_add_f32 v[18:19], v[204:205], v[206:207]
    v_pk_fma_f32 v[16:17], v[202:203], v[202:203], v[16:17]
    v_pk_add_f32 v[20:21], v[208:209], v[210:211]
    v_pk_fma_f32 v[16:17], v[204:205], v[204:205], v[16:17]
    v_pk_add_f32 v[14:15], v[14:15], v[18:19]
    v_pk_fma_f32 v[16:17], v[206:207], v[206:207], v[16:17]
    v_pk_add_f32 v[14:15], v[14:15], v[20:21]
    v_pk_fma_f32 v[16:17], v[208:209], v[208:209], v[16:17]
    v_pk_fma_f32 v[16:17], v[210:211], v[210:211], v[16:17]
    v_add_f32 v8, v14, v15
    v_add_f32 v9, v16, v17
    v_mov_b32 v10, 0
    v_mov_b32 v11, 0
    s_lshl_b32 s48, s47, 7
    s_lshl_b32 s49, s43, 9
    s_add_u32 s48, s48, s49
    s_add_u32 s48, s48, 159744
    v_lshl_add_u32 v4, v3, 3, s48
    v_add_f32 v8, v8, v10
    v_add_f32 v9, v9, v11
    v_mov_b32 v12, v8
    v_mov_b32 v13, v9
    s_nop 0
    v_permlane16_swap_b32 v8, v12
    v_permlane16_swap_b32 v9, v13
    v_add_f32 v8, v8, v12
    v_add_f32 v9, v9, v13
    v_mov_b32 v12, v8
    v_mov_b32 v13, v9
    s_nop 0
    v_permlane32_swap_b32 v8, v12
    v_permlane32_swap_b32 v9, v13
    v_add_f32 v8, v8, v12
    v_add_f32 v9, v9, v13
    s_mov_b64 exec, 0xffff
    ds_write_b64 v4, v[8:9]
    s_mov_b64 exec, -1
    s_or_b32 s48, s41, s43
    s_cmp_lg_u32 s48, 0
    s_cbranch_scc1 k1_xst_2
    s_lshl_b32 s48, s40, 9
    s_lshl_b32 s49, s47, 7
    s_add_u32 s48, s48, s49
    s_add_u32 s48, s48, 14680064
    v_lshlrev_b32 v4, 3, v3
    s_mov_b64 exec, 0xffff
    buffer_store_dwordx2 v[240:241], v4, s[24:27], s48 offen
    s_mov_b64 exec, -1
k1_xst_2:
    v_mfma_f32_16x16x32_bf16 v[176:179], v[152:155], v[48:51], 0
    ds_read_b64_tr_b16 v[128:129], v217 offset:0
    ds_read_b64_tr_b16 v[130:131], v217 offset:768
    v_mfma_f32_16x16x32_bf16 v[180:183], v[152:155], v[52:55], 0
    s_add_u32 s65, s54, s98
    s_add_u32 m0, s61, 131072
    s_nop 0
    buffer_load_dwordx4 v40, s[8:11], s65 offen lds
    ds_read_b64_tr_b16 v[132:133], v218 offset:0
    ds_read_b64_tr_b16 v[134:135], v218 offset:768
    v_mfma_f32_16x16x32_bf16 v[224:227], v[152:155], v[244:247], 0
    ds_read_b64_tr_b16 v[136:137], v219 offset:0
    ds_read_b64_tr_b16 v[138:139], v219 offset:768
    v_mfma_f32_16x16x32_bf16 v[184:187], v[156:159], v[48:51], 0
    ds_read_b64_tr_b16 v[140:141], v220 offset:0
    ds_read_b64_tr_b16 v[142:143], v220 offset:768
    v_mfma_f32_16x16x32_bf16 v[188:191], v[156:159], v[52:55], 0
    s_add_u32 s65, s54, s98
    s_add_u32 m0, s61, 132096
    s_nop 0
    buffer_load_dwordx4 v41, s[8:11], s65 offen lds
    ds_read_b64_tr_b16 v[144:145], v221 offset:0
    ds_read_b64_tr_b16 v[146:147], v221 offset:768
    v_mfma_f32_16x16x32_bf16 v[228:231], v[156:159], v[244:247], 0
    ds_read_b64_tr_b16 v[148:149], v222 offset:0
    ds_read_b64_tr_b16 v[150:151], v222 offset:768
    v_mfma_f32_16x16x32_bf16 v[192:195], v[160:163], v[48:51], 0
    v_mfma_f32_16x16x32_bf16 v[196:199], v[160:163], v[52:55], 0
    s_add_u32 s65, s54, s98
    s_add_u32 m0, s61, 133120
    s_nop 0
    buffer_load_dwordx4 v42, s[8:11], s65 offen lds
    v_mfma_f32_16x16x32_bf16 v[232:235], v[160:163], v[244:247], 0
    v_mfma_f32_16x16x32_bf16 v[176:179], v[164:167], v[56:59], v[176:179]
    v_mfma_f32_16x16x32_bf16 v[180:183], v[164:167], v[60:63], v[180:183]
    s_add_u32 s48, s42, 0
    s_cmp_ge_u32 s48, 21
    s_cbranch_scc1 k1_kvde_5
    s_sub_u32 s49, s48, 11
    s_cmp_ge_u32 s48, 11
    s_cselect_b32 s50, s49, s48
    s_lshl_b32 s50, s50, 6
    v_add_u32 v4, s50, v1
    v_mul_u32_u24 v5, 6554, v4
    v_lshrrev_b32 v5, 16, v5
    v_mul_u32_u24 v6, 10, v5
    v_sub_u32 v4, v4, v6
    v_mul_u32_u24 v5, 1280, v5
    v_lshl_add_u32 v4, v4, 4, v5
    s_mul_i32 s49, s41, 160
    s_add_u32 s49, s49, s52
    s_lshl_b32 s50, s50, 4
    s_cmp_ge_u32 s48, 11
    s_cbranch_scc1 k1_kvdv_4
    v_add_u32 v4, s49, v4
    v_subrev_u32 v4, 3840, v4
    s_add_u32 m0, s50, 65536
    s_nop 0
    buffer_load_dwordx4 v4, s[12:15], 0 offen lds
    s_branch k1_kvde_5
k1_kvdv_4:
    s_add_u32 m0, s50, 49152
    s_nop 0
    buffer_load_dwordx4 v4, s[16:19], s49 offen lds
k1_kvde_5:
    v_mfma_f32_16x16x32_bf16 v[184:187], v[168:171], v[56:59], v[184:187]
    v_mfma_f32_16x16x32_bf16 v[188:191], v[168:171], v[60:63], v[188:191]
    v_mfma_f32_16x16x32_bf16 v[192:195], v[172:175], v[56:59], v[192:195]
    s_add_u32 s48, s42, 8
    s_cmp_ge_u32 s48, 21
    s_cbranch_scc1 k1_kvde_8
    s_sub_u32 s49, s48, 11
    s_cmp_ge_u32 s48, 11
    s_cselect_b32 s50, s49, s48
    s_lshl_b32 s50, s50, 6
    v_add_u32 v4, s50, v1
    v_mul_u32_u24 v5, 6554, v4
    v_lshrrev_b32 v5, 16, v5
    v_mul_u32_u24 v6, 10, v5
    v_sub_u32 v4, v4, v6
    v_mul_u32_u24 v5, 1280, v5
    v_lshl_add_u32 v4, v4, 4, v5
    s_mul_i32 s49, s41, 160
    s_add_u32 s49, s49, s52
    s_lshl_b32 s50, s50, 4
    s_cmp_ge_u32 s48, 11
    s_cbranch_scc1 k1_kvdv_7
    v_add_u32 v4, s49, v4
    v_subrev_u32 v4, 3840, v4
    s_add_u32 m0, s50, 65536
    s_nop 0
    buffer_load_dwordx4 v4, s[12:15], 0 offen lds
    s_branch k1_kvde_8
k1_kvdv_7:
    s_add_u32 m0, s50, 49152
    s_nop 0
    buffer_load_dwordx4 v4, s[16:19], s49 offen lds
k1_kvde_8:
    v_mfma_f32_16x16x32_bf16 v[196:199], v[172:175], v[60:63], v[196:199]
    s_add_u32 s48, s42, 16
    s_cmp_ge_u32 s48, 21
    s_cbranch_scc1 k1_kvde_11
    s_sub_u32 s49, s48, 11
    s_cmp_ge_u32 s48, 11
    s_cselect_b32 s50, s49, s48
    s_lshl_b32 s50, s50, 6
    v_add_u32 v4, s50, v1
    v_mul_u32_u24 v5, 6554, v4
    v_lshrrev_b32 v5, 16, v5
    v_mul_u32_u24 v6, 10, v5
    v_sub_u32 v4, v4, v6
    v_mul_u32_u24 v5, 1280, v5
    v_lshl_add_u32 v4, v4, 4, v5
    s_mul_i32 s49, s41, 160
    s_add_u32 s49, s49, s52
    s_lshl_b32 s50, s50, 4
    s_cmp_ge_u32 s48, 11
    s_cbranch_scc1 k1_kvdv_10
    v_add_u32 v4, s49, v4
    v_subrev_u32 v4, 3840, v4
    s_add_u32 m0, s50, 65536
    s_nop 0
    buffer_load_dwordx4 v4, s[12:15], 0 offen lds
    s_branch k1_kvde_11
k1_kvdv_10:
    s_add_u32 m0, s50, 49152
    s_nop 0
    buffer_load_dwordx4 v4, s[16:19], s49 offen lds
k1_kvde_11:
    s_lshr_b32 s48, s2, 3
    s_lshl_b32 s48, s48, 3
    s_add_u32 s48, s48, s42
    s_lshl_b32 s48, s48, 13
    s_lshl_b32 s49, s66, 21
    s_add_u32 s48, s48, s49
    s_add_u32 s48, s48, 512
    s_mov_b64 exec, 0xff
    buffer_load_dword v37, v215, s[32:35], s48 offen
    s_mov_b64 exec, -1
    s_mul_i32 s48, s89, 1280
    s_add_u32 s48, s48, 640
    s_mov_b64 exec, 0x1f
    buffer_load_dword v37, v36, s[36:39], s48 offen
    s_mov_b64 exec, -1
    s_waitcnt vmcnt(6)
    s_waitcnt lgkmcnt(0)
    s_barrier
    s_cmp_lg_u32 s42, 0
    s_cbranch_scc1 k1_pub_12
    v_lshlrev_b32 v4, 3, v1
    v_add_u32 v5, 159744, v4
    ds_read_b64 v[8:9], v5
    ds_read_b64 v[12:13], v5 offset:512
    s_lshl_b32 s48, s40, 3
    s_add_u32 s48, s48, s41
    s_lshl_b32 s48, s48, 10
    s_add_u32 s48, s48, 14745600
    v_lshlrev_b32 v4, 4, v1
    v_mov_b32 v10, s100
    v_mov_b32 v11, s101
    s_waitcnt lgkmcnt(0)
    v_pk_add_f32 v[8:9], v[8:9], v[12:13]
    buffer_store_dwordx4 v[8:11], v4, s[24:27], s48 offen sc1
k1_pub_12:
    v_mfma_f32_16x16x32_bf16 v[176:179], v[128:131], v[64:67], v[176:179]
    ds_read_b64_tr_b16 v[152:153], v217 offset:24576
    ds_read_b64_tr_b16 v[154:155], v217 offset:25344
    v_mfma_f32_16x16x32_bf16 v[180:183], v[128:131], v[68:71], v[180:183]
    s_add_u32 s65, s54, s99
    s_add_u32 m0, s61, 81920
    s_nop 0
    buffer_load_dwordx4 v40, s[8:11], s65 offen lds
    ds_read_b64_tr_b16 v[156:157], v218 offset:24576
    ds_read_b64_tr_b16 v[158:159], v218 offset:25344
    v_mfma_f32_16x16x32_bf16 v[224:227], v[128:131], v[244:247], v[224:227]
    ds_read_b64_tr_b16 v[160:161], v219 offset:24576
    ds_read_b64_tr_b16 v[162:163], v219 offset:25344
    v_mfma_f32_16x16x32_bf16 v[184:187], v[132:135], v[64:67], v[184:187]
    ds_read_b64_tr_b16 v[164:165], v220 offset:24576
    ds_read_b64_tr_b16 v[166:167], v220 offset:25344
    v_mfma_f32_16x16x32_bf16 v[188:191], v[132:135], v[68:71], v[188:191]
    s_add_u32 s65, s54, s99
    s_add_u32 m0, s61, 82944
    s_nop 0
    buffer_load_dwordx4 v41, s[8:11], s65 offen lds
    ds_read_b64_tr_b16 v[168:169], v221 offset:24576
    ds_read_b64_tr_b16 v[170:171], v221 offset:25344
    v_mfma_f32_16x16x32_bf16 v[228:231], v[132:135], v[244:247], v[228:231]
    ds_read_b64_tr_b16 v[172:173], v222 offset:24576
    ds_read_b64_tr_b16 v[174:175], v222 offset:25344
    v_mfma_f32_16x16x32_bf16 v[192:195], v[136:139], v[64:67], v[192:195]
    v_mfma_f32_16x16x32_bf16 v[196:199], v[136:139], v[68:71], v[196:199]
    s_add_u32 s65, s54, s99
    s_add_u32 m0, s61, 83968
    s_nop 0
    buffer_load_dwordx4 v42, s[8:11], s65 offen lds
    v_mfma_f32_16x16x32_bf16 v[232:235], v[136:139], v[244:247], v[232:235]
    v_mfma_f32_16x16x32_bf16 v[176:179], v[140:143], v[72:75], v[176:179]
    v_mfma_f32_16x16x32_bf16 v[180:183], v[140:143], v[76:79], v[180:183]
    s_lshr_b32 s48, s2, 3
    s_lshl_b32 s48, s48, 3
    s_add_u32 s48, s48, s42
    s_lshl_b32 s48, s48, 13
    s_lshl_b32 s49, s66, 21
    s_add_u32 s48, s48, s49
    s_add_u32 s48, s48, 640
    s_mov_b64 exec, 0xff
    buffer_load_dword v37, v215, s[32:35], s48 offen
    s_mov_b64 exec, -1
    v_mfma_f32_16x16x32_bf16 v[184:187], v[144:147], v[72:75], v[184:187]
    v_mfma_f32_16x16x32_bf16 v[188:191], v[144:147], v[76:79], v[188:191]
    v_mfma_f32_16x16x32_bf16 v[192:195], v[148:151], v[72:75], v[192:195]
    v_mfma_f32_16x16x32_bf16 v[196:199], v[148:151], v[76:79], v[196:199]
    s_waitcnt vmcnt(6)
    s_waitcnt lgkmcnt(0)
    s_barrier
    v_mfma_f32_16x16x32_bf16 v[176:179], v[152:155], v[80:83], v[176:179]
    ds_read_b64_tr_b16 v[128:129], v217 offset:49152
    ds_read_b64_tr_b16 v[130:131], v217 offset:49920
    v_mfma_f32_16x16x32_bf16 v[180:183], v[152:155], v[84:87], v[180:183]
    s_lshr_b32 s48, s2, 3
    s_lshl_b32 s48, s48, 3
    s_add_u32 s48, s48, s42
    s_lshl_b32 s48, s48, 13
    s_lshl_b32 s49, s66, 21
    s_add_u32 s48, s48, s49
    s_add_u32 s48, s48, 768
    s_mov_b64 exec, 0xff
    buffer_load_dword v37, v215, s[32:35], s48 offen
    s_mov_b64 exec, -1
    ds_read_b64_tr_b16 v[132:133], v218 offset:49152
    ds_read_b64_tr_b16 v[134:135], v218 offset:49920
    v_mfma_f32_16x16x32_bf16 v[224:227], v[152:155], v[244:247], v[224:227]
    ds_read_b64_tr_b16 v[136:137], v219 offset:49152
    ds_read_b64_tr_b16 v[138:139], v219 offset:49920
    v_mfma_f32_16x16x32_bf16 v[184:187], v[156:159], v[80:83], v[184:187]
    ds_read_b64_tr_b16 v[140:141], v220 offset:49152
    ds_read_b64_tr_b16 v[142:143], v220 offset:49920
    v_mfma_f32_16x16x32_bf16 v[188:191], v[156:159], v[84:87], v[188:191]
    s_mul_i32 s48, s89, 512
    s_add_u32 s48, s48, 0
    s_mov_b64 exec, 0xf
    buffer_load_dword v37, v36, s[84:87], s48 offen
    s_mov_b64 exec, -1
    ds_read_b64_tr_b16 v[144:145], v221 offset:49152
    ds_read_b64_tr_b16 v[146:147], v221 offset:49920
    v_mfma_f32_16x16x32_bf16 v[228:231], v[156:159], v[244:247], v[228:231]
    ds_read_b64_tr_b16 v[148:149], v222 offset:49152
    ds_read_b64_tr_b16 v[150:151], v222 offset:49920
    v_mfma_f32_16x16x32_bf16 v[192:195], v[160:163], v[80:83], v[192:195]
    v_mfma_f32_16x16x32_bf16 v[196:199], v[160:163], v[84:87], v[196:199]
    v_mfma_f32_16x16x32_bf16 v[232:235], v[160:163], v[244:247], v[232:235]
    v_mfma_f32_16x16x32_bf16 v[176:179], v[164:167], v[88:91], v[176:179]
    v_mfma_f32_16x16x32_bf16 v[180:183], v[164:167], v[92:95], v[180:183]
    v_mfma_f32_16x16x32_bf16 v[184:187], v[168:171], v[88:91], v[184:187]
    v_mfma_f32_16x16x32_bf16 v[188:191], v[168:171], v[92:95], v[188:191]
    v_mfma_f32_16x16x32_bf16 v[192:195], v[172:175], v[88:91], v[192:195]
    v_mfma_f32_16x16x32_bf16 v[196:199], v[172:175], v[92:95], v[196:199]
    s_waitcnt vmcnt(3)
    s_waitcnt lgkmcnt(0)
    s_barrier
    v_mfma_f32_16x16x32_bf16 v[176:179], v[128:131], v[96:99], v[176:179]
    ds_read_b64_tr_b16 v[152:153], v217 offset:0
    ds_read_b64_tr_b16 v[154:155], v217 offset:768
    v_mfma_f32_16x16x32_bf16 v[180:183], v[128:131], v[100:103], v[180:183]
    s_lshr_b32 s48, s2, 3
    s_lshl_b32 s48, s48, 3
    s_add_u32 s48, s48, s42
    s_lshl_b32 s48, s48, 13
    s_lshl_b32 s49, s66, 21
    s_add_u32 s48, s48, s49
    s_add_u32 s48, s48, 896
    s_mov_b64 exec, 0xff
    buffer_load_dword v37, v215, s[32:35], s48 offen
    s_mov_b64 exec, -1
    ds_read_b64_tr_b16 v[156:157], v218 offset:0
    ds_read_b64_tr_b16 v[158:159], v218 offset:768
    v_mfma_f32_16x16x32_bf16 v[224:227], v[128:131], v[244:247], v[224:227]
    ds_read_b64_tr_b16 v[160:161], v219 offset:0
    ds_read_b64_tr_b16 v[162:163], v219 offset:768
    v_mfma_f32_16x16x32_bf16 v[184:187], v[132:135], v[96:99], v[184:187]
    ds_read_b64_tr_b16 v[164:165], v220 offset:0
    ds_read_b64_tr_b16 v[166:167], v220 offset:768
    v_mfma_f32_16x16x32_bf16 v[188:191], v[132:135], v[100:103], v[188:191]
    ds_read_b64_tr_b16 v[168:169], v221 offset:0
    ds_read_b64_tr_b16 v[170:171], v221 offset:768
    v_mfma_f32_16x16x32_bf16 v[228:231], v[132:135], v[244:247], v[228:231]
    ds_read_b64_tr_b16 v[172:173], v222 offset:0
    ds_read_b64_tr_b16 v[174:175], v222 offset:768
    v_mfma_f32_16x16x32_bf16 v[192:195], v[136:139], v[96:99], v[192:195]
    v_mfma_f32_16x16x32_bf16 v[196:199], v[136:139], v[100:103], v[196:199]
    v_mfma_f32_16x16x32_bf16 v[232:235], v[136:139], v[244:247], v[232:235]
    v_mfma_f32_16x16x32_bf16 v[176:179], v[140:143], v[104:107], v[176:179]
    v_mfma_f32_16x16x32_bf16 v[180:183], v[140:143], v[108:111], v[180:183]
    v_mfma_f32_16x16x32_bf16 v[184:187], v[144:147], v[104:107], v[184:187]
    v_mfma_f32_16x16x32_bf16 v[188:191], v[144:147], v[108:111], v[188:191]
    v_mfma_f32_16x16x32_bf16 v[192:195], v[148:151], v[104:107], v[192:195]
    v_mfma_f32_16x16x32_bf16 v[196:199], v[148:151], v[108:111], v[196:199]
    s_waitcnt lgkmcnt(0)
    s_barrier
    s_lshl_b32 s48, s40, 13
    s_lshl_b32 s49, s47, 8
    s_add_u32 s48, s48, s49
    s_add_u32 s62, s48, 14745600
    v_lshlrev_b32 v38, 4, v3
    v_lshl_add_u32 v38, v2, 11, v38
    buffer_load_dwordx4 v[28:31], v38, s[24:27], s62 offen sc1
    buffer_load_dwordx4 v[32:35], v38, s[24:27], s62 offen offset:1024 sc1
    v_mfma_f32_16x16x32_bf16 v[176:179], v[152:155], v[112:115], v[176:179]
    v_mfma_f32_16x16x32_bf16 v[180:183], v[152:155], v[116:119], v[180:183]
    v_mfma_f32_16x16x32_bf16 v[224:227], v[152:155], v[244:247], v[224:227]
    v_mfma_f32_16x16x32_bf16 v[184:187], v[156:159], v[112:115], v[184:187]
    v_mfma_f32_16x16x32_bf16 v[188:191], v[156:159], v[116:119], v[188:191]
    v_mfma_f32_16x16x32_bf16 v[228:231], v[156:159], v[244:247], v[228:231]
    v_mfma_f32_16x16x32_bf16 v[192:195], v[160:163], v[112:115], v[192:195]
    v_mfma_f32_16x16x32_bf16 v[196:199], v[160:163], v[116:119], v[196:199]
    v_mfma_f32_16x16x32_bf16 v[232:235], v[160:163], v[244:247], v[232:235]
    v_mfma_f32_16x16x32_bf16 v[176:179], v[164:167], v[120:123], v[176:179]
    v_mfma_f32_16x16x32_bf16 v[180:183], v[164:167], v[124:127], v[180:183]
    v_mfma_f32_16x16x32_bf16 v[184:187], v[168:171], v[120:123], v[184:187]
    v_mfma_f32_16x16x32_bf16 v[188:191], v[168:171], v[124:127], v[188:191]
    v_mfma_f32_16x16x32_bf16 v[192:195], v[172:175], v[120:123], v[192:195]
    v_mfma_f32_16x16x32_bf16 v[196:199], v[172:175], v[124:127], v[196:199]
    s_mul_i32 s48, s42, 3072
    s_add_u32 s48, s48, 16384
    v_lshl_add_u32 v4, v1, 4, s48
    s_lshl_b32 s48, s43, 2
    s_lshl_b32 s49, s44, 1
    s_add_u32 s48, s48, s49
    s_add_u32 s48, s48, s45
    s_mul_i32 s48, s48, 192
    s_add_u32 s48, s48, 157184
    v_lshl_add_u32 v5, v2, 4, s48
    ds_write_b128 v4, v[180:183] offset:0
    ds_write_b128 v4, v[188:191] offset:1024
    ds_write_b128 v4, v[196:199] offset:2048
    s_mov_b32 exec_lo, 0x00010001
    s_mov_b32 exec_hi, 0x00010001
    ds_write_b128 v5, v[224:227] offset:0
    ds_write_b128 v5, v[228:231] offset:64
    ds_write_b128 v5, v[232:235] offset:128
    s_mov_b64 exec, -1
    v_pk_add_f32 v[128:129], v[176:177], 0
    v_pk_add_f32 v[130:131], v[178:179], 0
    v_pk_add_f32 v[132:133], v[184:185], 0
    v_pk_add_f32 v[134:135], v[186:187], 0
    v_pk_add_f32 v[136:137], v[192:193], 0
    v_pk_add_f32 v[138:139], v[194:195], 0
    v_add_u32 v4, 65536, v7
    ds_read_b128 v[48:51], v4 offset:0
    ds_read_b128 v[52:55], v4 offset:160
    ds_read_b128 v[56:59], v4 offset:320
    ds_read_b128 v[60:63], v4 offset:480
    ds_read_b128 v[64:67], v4 offset:640
    v_add_u32 v4, 49152, v7
    ds_read_b128 v[68:71], v4
    ds_read_b128 v[72:75], v4 offset:160
    s_waitcnt lgkmcnt(0)
    v_mul_u32_u24 v7, 1152, v44
    v_lshlrev_b32 v106, 2, v43
    v_sub_u32 v7, v7, v106
    s_lshl_b32 s48, s42, 4
    s_add_u32 s48, s48, 106508
    v_add_u32 v7, s48, v7
    v_lshlrev_b32 v44, 6, v44
    v_add_u32 v44, 160768, v44
    ds_read_b128 v[108:111], v44 offset:0
    ds_read_b128 v[112:115], v44 offset:16
    v_lshlrev_b32 v80, 16, v48
    v_and_b32 v81, 0xffff0000, v48
    v_lshlrev_b32 v82, 16, v52
    v_and_b32 v83, 0xffff0000, v52
    v_lshlrev_b32 v84, 16, v56
    v_and_b32 v85, 0xffff0000, v56
    v_lshlrev_b32 v86, 16, v60
    v_and_b32 v87, 0xffff0000, v60
    v_lshlrev_b32 v88, 16, v64
    v_and_b32 v89, 0xffff0000, v64
    s_waitcnt lgkmcnt(0)
    v_lshlrev_b32 v90, 16, v108
    v_lshlrev_b32 v91, 16, v110
    v_and_b32 v92, 0xffff0000, v108
    v_and_b32 v93, 0xffff0000, v110
    v_lshlrev_b32 v94, 16, v109
    v_lshlrev_b32 v95, 16, v111
    v_and_b32 v96, 0xffff0000, v109
    v_and_b32 v97, 0xffff0000, v111
    v_pk_mul_f32 v[98:99], v[86:87], v[90:91]
    v_pk_mul_f32 v[100:101], v[88:89], v[90:91]
    v_pk_fma_f32 v[98:99], v[84:85], v[92:93], v[98:99]
    v_pk_fma_f32 v[100:101], v[86:87], v[92:93], v[100:101]
    v_pk_fma_f32 v[98:99], v[82:83], v[94:95], v[98:99]
    v_pk_fma_f32 v[100:101], v[84:85], v[94:95], v[100:101]
    v_pk_fma_f32 v[98:99], v[80:81], v[96:97], v[98:99]
    v_pk_fma_f32 v[100:101], v[82:83], v[96:97], v[100:101]
    v_lshlrev_b32 v102, 16, v68
    v_and_b32 v103, 0xffff0000, v68
    v_lshlrev_b32 v104, 16, v72
    v_and_b32 v105, 0xffff0000, v72
    v_pk_mul_f32 v[98:99], v[98:99], v[102:103]
    v_pk_mul_f32 v[100:101], v[100:101], v[104:105]
    v_cvt_pk_bf16_f32 v106, v100, v98
    v_cvt_pk_bf16_f32 v107, v101, v99
    s_mov_b32 exec_hi, 0xff
    ds_write_b32 v7, v106 offset:0
    ds_write_b32 v7, v107 offset:144
    s_mov_b32 exec_hi, -1
    v_lshlrev_b32 v80, 16, v49
    v_and_b32 v81, 0xffff0000, v49
    v_lshlrev_b32 v82, 16, v53
    v_and_b32 v83, 0xffff0000, v53
    v_lshlrev_b32 v84, 16, v57
    v_and_b32 v85, 0xffff0000, v57
    v_lshlrev_b32 v86, 16, v61
    v_and_b32 v87, 0xffff0000, v61
    v_lshlrev_b32 v88, 16, v65
    v_and_b32 v89, 0xffff0000, v65
    v_lshlrev_b32 v90, 16, v112
    v_lshlrev_b32 v91, 16, v114
    v_and_b32 v92, 0xffff0000, v112
    v_and_b32 v93, 0xffff0000, v114
    v_lshlrev_b32 v94, 16, v113
    v_lshlrev_b32 v95, 16, v115
    v_and_b32 v96, 0xffff0000, v113
    v_and_b32 v97, 0xffff0000, v115
    v_pk_mul_f32 v[98:99], v[86:87], v[90:91]
    v_pk_mul_f32 v[100:101], v[88:89], v[90:91]
    v_pk_fma_f32 v[98:99], v[84:85], v[92:93], v[98:99]
    v_pk_fma_f32 v[100:101], v[86:87], v[92:93], v[100:101]
    v_pk_fma_f32 v[98:99], v[82:83], v[94:95], v[98:99]
    v_pk_fma_f32 v[100:101], v[84:85], v[94:95], v[100:101]
    v_pk_fma_f32 v[98:99], v[80:81], v[96:97], v[98:99]
    v_pk_fma_f32 v[100:101], v[82:83], v[96:97], v[100:101]
    v_lshlrev_b32 v102, 16, v69
    v_and_b32 v103, 0xffff0000, v69
    v_lshlrev_b32 v104, 16, v73
    v_and_b32 v105, 0xffff0000, v73
    v_pk_mul_f32 v[98:99], v[98:99], v[102:103]
    v_pk_mul_f32 v[100:101], v[100:101], v[104:105]
    v_cvt_pk_bf16_f32 v106, v100, v98
    v_cvt_pk_bf16_f32 v107, v101, v99
    s_mov_b32 exec_hi, 0xff
    ds_write_b32 v7, v106 offset:288
    ds_write_b32 v7, v107 offset:432
    s_mov_b32 exec_hi, -1
    ds_read_b128 v[108:111], v44 offset:32
    ds_read_b128 v[112:115], v44 offset:48
    v_lshlrev_b32 v80, 16, v50
    v_and_b32 v81, 0xffff0000, v50
    v_lshlrev_b32 v82, 16, v54
    v_and_b32 v83, 0xffff0000, v54
    v_lshlrev_b32 v84, 16, v58
    v_and_b32 v85, 0xffff0000, v58
    v_lshlrev_b32 v86, 16, v62
    v_and_b32 v87, 0xffff0000, v62
    v_lshlrev_b32 v88, 16, v66
    v_and_b32 v89, 0xffff0000, v66
    s_waitcnt lgkmcnt(0)
    v_lshlrev_b32 v90, 16, v108
    v_lshlrev_b32 v91, 16, v110
    v_and_b32 v92, 0xffff0000, v108
    v_and_b32 v93, 0xffff0000, v110
    v_lshlrev_b32 v94, 16, v109
    v_lshlrev_b32 v95, 16, v111
    v_and_b32 v96, 0xffff0000, v109
    v_and_b32 v97, 0xffff0000, v111
    v_pk_mul_f32 v[98:99], v[86:87], v[90:91]
    v_pk_mul_f32 v[100:101], v[88:89], v[90:91]
    v_pk_fma_f32 v[98:99], v[84:85], v[92:93], v[98:99]
    v_pk_fma_f32 v[100:101], v[86:87], v[92:93], v[100:101]
    v_pk_fma_f32 v[98:99], v[82:83], v[94:95], v[98:99]
    v_pk_fma_f32 v[100:101], v[84:85], v[94:95], v[100:101]
    v_pk_fma_f32 v[98:99], v[80:81], v[96:97], v[98:99]
    v_pk_fma_f32 v[100:101], v[82:83], v[96:97], v[100:101]
    v_lshlrev_b32 v102, 16, v70
    v_and_b32 v103, 0xffff0000, v70
    v_lshlrev_b32 v104, 16, v74
    v_and_b32 v105, 0xffff0000, v74
    v_pk_mul_f32 v[98:99], v[98:99], v[102:103]
    v_pk_mul_f32 v[100:101], v[100:101], v[104:105]
    v_cvt_pk_bf16_f32 v106, v100, v98
    v_cvt_pk_bf16_f32 v107, v101, v99
    s_mov_b32 exec_hi, 0xff
    ds_write_b32 v7, v106 offset:576
    ds_write_b32 v7, v107 offset:720
    s_mov_b32 exec_hi, -1
    v_lshlrev_b32 v80, 16, v51
    v_and_b32 v81, 0xffff0000, v51
    v_lshlrev_b32 v82, 16, v55
    v_and_b32 v83, 0xffff0000, v55
    v_lshlrev_b32 v84, 16, v59
    v_and_b32 v85, 0xffff0000, v59
    v_lshlrev_b32 v86, 16, v63
    v_and_b32 v87, 0xffff0000, v63
    v_lshlrev_b32 v88, 16, v67
    v_and_b32 v89, 0xffff0000, v67
    v_lshlrev_b32 v90, 16, v112
    v_lshlrev_b32 v91, 16, v114
    v_and_b32 v92, 0xffff0000, v112
    v_and_b32 v93, 0xffff0000, v114
    v_lshlrev_b32 v94, 16, v113
    v_lshlrev_b32 v95, 16, v115
    v_and_b32 v96, 0xffff0000, v113
    v_and_b32 v97, 0xffff0000, v115
    v_pk_mul_f32 v[98:99], v[86:87], v[90:91]
    v_pk_mul_f32 v[100:101], v[88:89], v[90:91]
    v_pk_fma_f32 v[98:99], v[84:85], v[92:93], v[98:99]
    v_pk_fma_f32 v[100:101], v[86:87], v[92:93], v[100:101]
    v_pk_fma_f32 v[98:99], v[82:83], v[94:95], v[98:99]
    v_pk_fma_f32 v[100:101], v[84:85], v[94:95], v[100:101]
    v_pk_fma_f32 v[98:99], v[80:81], v[96:97], v[98:99]
    v_pk_fma_f32 v[100:101], v[82:83], v[96:97], v[100:101]
    v_lshlrev_b32 v102, 16, v71
    v_and_b32 v103, 0xffff0000, v71
    v_lshlrev_b32 v104, 16, v75
    v_and_b32 v105, 0xffff0000, v75
    v_pk_mul_f32 v[98:99], v[98:99], v[102:103]
    v_pk_mul_f32 v[100:101], v[100:101], v[104:105]
    v_cvt_pk_bf16_f32 v106, v100, v98
    v_cvt_pk_bf16_f32 v107, v101, v99
    s_mov_b32 exec_hi, 0xff
    ds_write_b32 v7, v106 offset:864
    ds_write_b32 v7, v107 offset:1008
    s_mov_b32 exec_hi, -1
    s_lshl_b32 s48, s47, 4
    v_add_u32 v43, s48, v3
    v_mul_u32_u24 v43, 200, v43
    v_lshl_add_u32 v43, v2, 3, v43
    s_mul_i32 s48, s43, 96
    s_add_u32 s48, s48, 0
    v_add_u32 v43, s48, v43
    s_waitcnt vmcnt(0)
    s_mov_b32 s65, 0
k1_poll_13:
    s_add_u32 s65, s65, 1
    s_cmp_gt_u32 s65, 100000
    s_cbranch_scc1 k1_polled_14
    v_cmp_ne_u32 vcc, s100, v30
    v_cmp_ne_u32 s[50:51], s101, v31
    s_nop 0
    s_or_b64 vcc, vcc, s[50:51]
    v_cmp_ne_u32 s[50:51], s100, v34
    s_nop 0
    s_or_b64 vcc, vcc, s[50:51]
    v_cmp_ne_u32 s[50:51], s101, v35
    s_nop 0
    s_or_b64 vcc, vcc, s[50:51]
    s_cmp_eq_u64 vcc, 0
    s_cbranch_scc1 k1_polled_14
    s_sleep 4
    buffer_load_dwordx4 v[28:31], v38, s[24:27], s62 offen sc1
    buffer_load_dwordx4 v[32:35], v38, s[24:27], s62 offen offset:1024 sc1
    s_waitcnt vmcnt(0)
    s_branch k1_poll_13
k1_polled_14:
    s_xor_b32 s48, s42, 1
    s_or_b32 s48, s48, s41
    s_cmp_lg_u32 s48, 0
    s_cbranch_scc1 k1_ep_15
    v_mov_b32 v4, 0
    v_mov_b32 v44, 1
    s_mov_b64 exec, 1
    buffer_atomic_add v44, v4, s[28:31], 0 offen sc0
    s_mov_b64 exec, -1
k1_ep_15:
    v_pk_add_f32 v[8:9], v[28:29], v[32:33]
    v_mov_b32 v10, v8
    v_mov_b32 v11, v9
    s_nop 0
    v_permlane16_swap_b32 v8, v10
    v_permlane16_swap_b32 v9, v11
    v_add_f32 v8, v8, v10
    v_add_f32 v9, v9, v11
    v_mov_b32 v10, v8
    v_mov_b32 v11, v9
    s_nop 0
    v_permlane32_swap_b32 v8, v10
    v_permlane32_swap_b32 v9, v11
    v_add_f32 v8, v8, v10
    v_add_f32 v9, v9, v11
    v_mul_f32 v8, 0x3aaaaaab, v8
    v_mul_f32 v9, 0x3aaaaaab, v9
    v_fma_f32 v9, -v8, v8, v9
    v_max_f32 v9, 0, v9
    v_cvt_pk_bf16_f32 v9, v9, v8
    v_and_b32 v8, 0xffff0000, v9
    v_lshlrev_b32 v9, 16, v9
    v_add_f32 v9, s55, v9
    v_cvt_pk_bf16_f32 v9, v9, v9
    v_and_b32 v9, 0xffff0000, v9
    v_sqrt_f32 v9, v9
    s_nop 0
    v_cvt_pk_bf16_f32 v9, v9, v9
    v_and_b32 v9, 0xffff0000, v9
    v_rcp_f32 v9, v9
    s_nop 0
    v_mov_b32 v10, v9
    v_pk_add_f32 v[200:201], v[200:201], v[8:9] op_sel_hi:[1,0] neg_lo:[0,1] neg_hi:[0,1]
    v_pk_add_f32 v[202:203], v[202:203], v[8:9] op_sel_hi:[1,0] neg_lo:[0,1] neg_hi:[0,1]
    v_pk_add_f32 v[204:205], v[204:205], v[8:9] op_sel_hi:[1,0] neg_lo:[0,1] neg_hi:[0,1]
    v_pk_add_f32 v[206:207], v[206:207], v[8:9] op_sel_hi:[1,0] neg_lo:[0,1] neg_hi:[0,1]
    v_pk_add_f32 v[208:209], v[208:209], v[8:9] op_sel_hi:[1,0] neg_lo:[0,1] neg_hi:[0,1]
    v_pk_add_f32 v[210:211], v[210:211], v[8:9] op_sel_hi:[1,0] neg_lo:[0,1] neg_hi:[0,1]
    v_pk_mul_f32 v[200:201], v[200:201], v[10:11] op_sel_hi:[1,0]
    v_pk_mul_f32 v[202:203], v[202:203], v[10:11] op_sel_hi:[1,0]
    v_pk_mul_f32 v[204:205], v[204:205], v[10:11] op_sel_hi:[1,0]
    v_pk_mul_f32 v[206:207], v[206:207], v[10:11] op_sel_hi:[1,0]
    v_pk_mul_f32 v[208:209], v[208:209], v[10:11] op_sel_hi:[1,0]
    v_pk_mul_f32 v[210:211], v[210:211], v[10:11] op_sel_hi:[1,0]
    v_cvt_pk_bf16_f32 v16, v200, v201
    v_cvt_pk_bf16_f32 v17, v202, v203
    ds_write_b64 v43, v[16:17] offset:0
    v_cvt_pk_bf16_f32 v18, v204, v205
    v_cvt_pk_bf16_f32 v19, v206, v207
    ds_write_b64 v43, v[18:19] offset:32
    v_cvt_pk_bf16_f32 v20, v208, v209
    v_cvt_pk_bf16_f32 v21, v210, v211
    ds_write_b64 v43, v[20:21] offset:64
    v_lshrrev_b32 v218, 1, v2
    v_lshrrev_b32 v5, 2, v3
    v_lshl_add_u32 v218, v218, 3, v5
    v_mul_u32_u24 v218, 200, v218
    v_and_b32 v5, 1, v2
    v_lshl_add_u32 v218, v5, 5, v218
    v_and_b32 v5, 3, v3
    v_lshl_add_u32 v218, v5, 3, v218
    v_lshlrev_b32 v219, 4, v1
    s_waitcnt lgkmcnt(0)
    s_barrier
    s_add_u32 s48, s42, 0
    s_mul_i32 s49, s48, 43
    s_lshr_b32 s49, s49, 7
    s_mul_i32 s50, s49, 3
    s_sub_u32 s50, s48, s50
    s_mul_i32 s49, s49, 3200
    s_lshl_b32 s50, s50, 6
    s_add_u32 s49, s49, s50
    s_add_u32 s49, s49, 0
    v_add_u32 v5, s49, v218
    ds_read_b64_tr_b16 v[8:9], v5
    ds_read_b64_tr_b16 v[10:11], v5 offset:800
    s_lshl_b32 s49, s41, 7
    s_lshl_b32 s50, s40, 2
    s_add_u32 s49, s49, s50
    s_mul_i32 s49, s49, 3
    s_add_u32 s49, s49, s48
    s_lshl_b32 s49, s49, 10
    s_add_u32 s49, s49, 0
    s_waitcnt lgkmcnt(0)
    buffer_store_dwordx4 v[8:11], v219, s[24:27], s49 offen
    s_cmp_ge_u32 s42, 4
    s_cbranch_scc1 k1_fr_16
    s_add_u32 s48, s42, 8
    s_mul_i32 s49, s48, 43
    s_lshr_b32 s49, s49, 7
    s_mul_i32 s50, s49, 3
    s_sub_u32 s50, s48, s50
    s_mul_i32 s49, s49, 3200
    s_lshl_b32 s50, s50, 6
    s_add_u32 s49, s49, s50
    s_add_u32 s49, s49, 0
    v_add_u32 v5, s49, v218
    ds_read_b64_tr_b16 v[12:13], v5
    ds_read_b64_tr_b16 v[14:15], v5 offset:800
    s_lshl_b32 s49, s41, 7
    s_lshl_b32 s50, s40, 2
    s_add_u32 s49, s49, s50
    s_mul_i32 s49, s49, 3
    s_add_u32 s49, s49, s48
    s_lshl_b32 s49, s49, 10
    s_add_u32 s49, s49, 0
    s_waitcnt lgkmcnt(0)
    buffer_store_dwordx4 v[12:15], v219, s[24:27], s49 offen
k1_fr_16:
    s_lshl_b32 s48, s42, 3
    v_lshrrev_b32 v4, 3, v1
    v_add_u32 v4, s48, v4
    v_and_b32 v5, 7, v1
    v_lshlrev_b32 v5, 4, v5
    v_mul_u32_u24 v6, 144, v4
    v_add_u32 v6, v6, v5
    v_add_u32 v6, 106496, v6
    ds_read_b128 v[120:123], v6
    v_lshlrev_b32 v4, 12, v4
    v_add_u32 v4, v4, v5
    s_mul_i32 s48, s41, 327680
    s_lshl_b32 s49, s40, 7
    s_add_u32 s48, s48, s49
    s_add_u32 s48, s48, 6291456
    s_waitcnt lgkmcnt(0)
    buffer_store_dwordx4 v[120:123], v4, s[24:27], s48 offen
    s_lshl_b32 s48, s42, 3
    s_add_u32 s48, s48, 64
    v_lshrrev_b32 v4, 3, v1
    v_add_u32 v4, s48, v4
    v_and_b32 v5, 7, v1
    v_lshlrev_b32 v5, 4, v5
    v_mul_u32_u24 v6, 144, v4
    v_add_u32 v6, v6, v5
    v_add_u32 v6, 106496, v6
    ds_read_b128 v[124:127], v6
    v_lshlrev_b32 v4, 12, v4
    v_add_u32 v4, v4, v5
    s_mul_i32 s48, s41, 327680
    s_lshl_b32 s49, s40, 7
    s_add_u32 s48, s48, s49
    s_add_u32 s48, s48, 6291456
    s_waitcnt lgkmcnt(0)
    s_cmp_ge_u32 s42, 2
    s_cbranch_scc1 k1_kvskip_17
    buffer_store_dwordx4 v[124:127], v4, s[24:27], s48 offen
k1_kvskip_17:
    s_xor_b32 s48, s42, 4
    s_mul_i32 s48, s48, 3072
    s_add_u32 s48, s48, 16384
    v_lshl_add_u32 v4, v1, 4, s48
    ds_read_b128 v[48:51], v4 offset:0
    ds_read_b128 v[52:55], v4 offset:1024
    ds_read_b128 v[56:59], v4 offset:2048
    s_mul_i32 s48, s43, 768
    s_add_u32 s48, s48, 157184
    v_lshl_add_u32 v6, v2, 4, s48
    ds_read_b128 v[64:67], v6 offset:0
    ds_read_b128 v[68:71], v6 offset:64
    ds_read_b128 v[72:75], v6 offset:128
    ds_read_b128 v[76:79], v6 offset:192
    ds_read_b128 v[80:83], v6 offset:256
    ds_read_b128 v[84:87], v6 offset:320
    ds_read_b128 v[88:91], v6 offset:384
    ds_read_b128 v[92:95], v6 offset:448
    ds_read_b128 v[96:99], v6 offset:512
    ds_read_b128 v[100:103], v6 offset:576
    ds_read_b128 v[104:107], v6 offset:640
    ds_read_b128 v[108:111], v6 offset:704
    s_waitcnt lgkmcnt(12)
    v_pk_add_f32 v[128:129], v[128:129], v[48:49]
    v_pk_add_f32 v[130:131], v[130:131], v[50:51]
    v_pk_add_f32 v[132:133], v[132:133], v[52:53]
    v_pk_add_f32 v[134:135], v[134:135], v[54:55]
    v_pk_add_f32 v[136:137], v[136:137], v[56:57]
    v_pk_add_f32 v[138:139], v[138:139], v[58:59]
    s_waitcnt lgkmcnt(6)
    v_pk_add_f32 v[64:65], v[64:65], v[76:77]
    v_pk_add_f32 v[66:67], v[66:67], v[78:79]
    v_pk_add_f32 v[68:69], v[68:69], v[80:81]
    v_pk_add_f32 v[70:71], v[70:71], v[82:83]
    v_pk_add_f32 v[72:73], v[72:73], v[84:85]
    v_pk_add_f32 v[74:75], v[74:75], v[86:87]
    s_waitcnt lgkmcnt(0)
    v_pk_add_f32 v[88:89], v[88:89], v[100:101]
    v_pk_add_f32 v[90:91], v[90:91], v[102:103]
    v_pk_add_f32 v[92:93], v[92:93], v[104:105]
    v_pk_add_f32 v[94:95], v[94:95], v[106:107]
    v_pk_add_f32 v[96:97], v[96:97], v[108:109]
    v_pk_add_f32 v[98:99], v[98:99], v[110:111]
    v_pk_add_f32 v[64:65], v[64:65], v[88:89]
    v_pk_add_f32 v[66:67], v[66:67], v[90:91]
    v_pk_add_f32 v[68:69], v[68:69], v[92:93]
    v_pk_add_f32 v[70:71], v[70:71], v[94:95]
    v_pk_add_f32 v[72:73], v[72:73], v[96:97]
    v_pk_add_f32 v[74:75], v[74:75], v[98:99]
    v_pk_fma_f32 v[128:129], v[64:65], v[240:241], v[128:129] op_sel_hi:[1,0,1] neg_lo:[0,1,0] neg_hi:[0,1,0]
    v_pk_fma_f32 v[130:131], v[66:67], v[240:241], v[130:131] op_sel_hi:[1,0,1] neg_lo:[0,1,0] neg_hi:[0,1,0]
    v_pk_fma_f32 v[132:133], v[68:69], v[240:241], v[132:133] op_sel_hi:[1,0,1] neg_lo:[0,1,0] neg_hi:[0,1,0]
    v_pk_fma_f32 v[134:135], v[70:71], v[240:241], v[134:135] op_sel_hi:[1,0,1] neg_lo:[0,1,0] neg_hi:[0,1,0]
    v_pk_fma_f32 v[136:137], v[72:73], v[240:241], v[136:137] op_sel_hi:[1,0,1] neg_lo:[0,1,0] neg_hi:[0,1,0]
    v_pk_fma_f32 v[138:139], v[74:75], v[240:241], v[138:139] op_sel_hi:[1,0,1] neg_lo:[0,1,0] neg_hi:[0,1,0]
    v_pk_mul_f32 v[128:129], v[128:129], v[242:243] op_sel_hi:[1,0]
    v_pk_mul_f32 v[130:131], v[130:131], v[242:243] op_sel_hi:[1,0]
    v_pk_mul_f32 v[132:133], v[132:133], v[242:243] op_sel_hi:[1,0]
    v_pk_mul_f32 v[134:135], v[134:135], v[242:243] op_sel_hi:[1,0]
    v_pk_mul_f32 v[136:137], v[136:137], v[242:243] op_sel_hi:[1,0]
    v_pk_mul_f32 v[138:139], v[138:139], v[242:243] op_sel_hi:[1,0]
    v_pk_mul_f32 v[48:49], v[128:129], v[128:129]
    v_pk_mul_f32 v[50:51], v[130:131], v[130:131]
    v_pk_mul_f32 v[52:53], v[132:133], v[132:133]
    v_pk_mul_f32 v[54:55], v[134:135], v[134:135]
    v_pk_mul_f32 v[56:57], v[136:137], v[136:137]
    v_pk_mul_f32 v[58:59], v[138:139], v[138:139]
    v_pk_fma_f32 v[48:49], v[48:49], s[58:59], v[238:239]
    v_pk_fma_f32 v[50:51], v[50:51], s[58:59], v[238:239]
    v_pk_fma_f32 v[52:53], v[52:53], s[58:59], v[238:239]
    v_pk_fma_f32 v[54:55], v[54:55], s[58:59], v[238:239]
    v_pk_fma_f32 v[56:57], v[56:57], s[58:59], v[238:239]
    v_pk_fma_f32 v[58:59], v[58:59], s[58:59], v[238:239]
    v_pk_mul_f32 v[48:49], v[48:49], v[128:129]
    v_pk_mul_f32 v[50:51], v[50:51], v[130:131]
    v_pk_mul_f32 v[52:53], v[52:53], v[132:133]
    v_pk_mul_f32 v[54:55], v[54:55], v[134:135]
    v_pk_mul_f32 v[56:57], v[56:57], v[136:137]
    v_pk_mul_f32 v[58:59], v[58:59], v[138:139]
    v_exp_f32 v48, v48
    v_exp_f32 v49, v49
    v_exp_f32 v50, v50
    v_exp_f32 v51, v51
    v_exp_f32 v52, v52
    v_exp_f32 v53, v53
    v_exp_f32 v54, v54
    v_exp_f32 v55, v55
    v_exp_f32 v56, v56
    v_exp_f32 v57, v57
    v_exp_f32 v58, v58
    v_exp_f32 v59, v59
    v_pk_add_f32 v[48:49], v[48:49], 1.0 op_sel_hi:[1,0]
    v_pk_add_f32 v[50:51], v[50:51], 1.0 op_sel_hi:[1,0]
    v_pk_add_f32 v[52:53], v[52:53], 1.0 op_sel_hi:[1,0]
    v_pk_add_f32 v[54:55], v[54:55], 1.0 op_sel_hi:[1,0]
    v_pk_add_f32 v[56:57], v[56:57], 1.0 op_sel_hi:[1,0]
    v_pk_add_f32 v[58:59], v[58:59], 1.0 op_sel_hi:[1,0]
    v_rcp_f32 v48, v48
    v_rcp_f32 v49, v49
    v_rcp_f32 v50, v50
    v_rcp_f32 v51, v51
    v_rcp_f32 v52, v52
    v_rcp_f32 v53, v53
    v_rcp_f32 v54, v54
    v_rcp_f32 v55, v55
    v_rcp_f32 v56, v56
    v_rcp_f32 v57, v57
    v_rcp_f32 v58, v58
    v_rcp_f32 v59, v59
    v_pk_mul_f32 v[128:129], v[128:129], v[48:49]
    v_pk_mul_f32 v[130:131], v[130:131], v[50:51]
    v_pk_mul_f32 v[132:133], v[132:133], v[52:53]
    v_pk_mul_f32 v[134:135], v[134:135], v[54:55]
    v_pk_mul_f32 v[136:137], v[136:137], v[56:57]
    v_pk_mul_f32 v[138:139], v[138:139], v[58:59]
    v_lshrrev_b32 v4, 1, v2
    v_mul_u32_u24 v4, 3072, v4
    v_and_b32 v5, 1, v2
    v_lshlrev_b32 v5, 5, v5
    v_add_u32 v5, v5, v3
    v_lshl_add_u32 v4, v5, 4, v4
    s_lshl_b32 s48, s40, 3
    s_add_u32 s48, s48, s41
    s_mul_i32 s62, s48, 12288
    s_lshr_b32 s48, s47, 1
    s_mul_i32 s48, s48, 6144
    s_add_u32 s62, s62, s48
    s_and_b32 s48, s47, 1
    s_lshl_b32 s48, s48, 8
    s_add_u32 s62, s62, s48
    s_add_u32 s62, s62, 3145728
    s_mul_i32 s51, s43, 3
    v_cvt_pk_bf16_f32 v48, v128, v129
    v_cvt_pk_bf16_f32 v49, v130, v131
    s_add_u32 s48, s51, 0
    s_lshr_b32 s49, s48, 1
    s_lshl_b32 s49, s49, 10
    s_and_b32 s48, s48, 1
    s_lshl_b32 s48, s48, 3
    s_add_u32 s48, s48, s49
    s_add_u32 s48, s48, s62
    buffer_store_dwordx2 v[48:49], v4, s[24:27], s48 offen
    v_cvt_pk_bf16_f32 v50, v132, v133
    v_cvt_pk_bf16_f32 v51, v134, v135
    s_add_u32 s48, s51, 1
    s_lshr_b32 s49, s48, 1
    s_lshl_b32 s49, s49, 10
    s_and_b32 s48, s48, 1
    s_lshl_b32 s48, s48, 3
    s_add_u32 s48, s48, s49
    s_add_u32 s48, s48, s62
    buffer_store_dwordx2 v[50:51], v4, s[24:27], s48 offen
    v_cvt_pk_bf16_f32 v52, v136, v137
    v_cvt_pk_bf16_f32 v53, v138, v139
    s_add_u32 s48, s51, 2
    s_lshr_b32 s49, s48, 1
    s_lshl_b32 s49, s49, 10
    s_and_b32 s48, s48, 1
    s_lshl_b32 s48, s48, 3
    s_add_u32 s48, s48, s49
    s_add_u32 s48, s48, s62
    buffer_store_dwordx2 v[52:53], v4, s[24:27], s48 offen
    s_xor_b32 s48, s42, 1
    s_or_b32 s48, s48, s41
    s_cmp_lg_u32 s48, 0
    s_cbranch_scc1 k1_ep2_18
    s_waitcnt vmcnt(0)
    v_readfirstlane_b32 s48, v44
    s_nop 0
    s_cmp_lg_u32 s48, 31
    s_cbranch_scc1 k1_ep2_18
    v_mov_b32 v8, s100
    v_mov_b32 v9, s101
    v_mov_b32 v4, 14712832
    s_mov_b64 exec, 1
    buffer_store_dwordx2 v[8:9], v4, s[24:27], 0 offen sc1
    s_mov_b64 exec, -1
k1_ep2_18:
k1_kernel_end:
    s_endpgm

.globl k2_kernel
.p2align 8
.type k2_kernel,@function
k2_kernel:
    s_cmp_ge_u32 s2, 512
    s_cbranch_scc1 k2_kernel_end
    s_cmp_lt_u32 s2, 256
    s_cbranch_scc1 k2_kernel_conv
    s_load_dwordx2 s[4:5], s[0:1], 64
    s_load_dwordx2 s[8:9], s[0:1], 104
    s_load_dwordx2 s[12:13], s[0:1], 72
    v_lshrrev_b32 v2, 6, v0
    v_and_b32 v1, 63, v0
    v_readfirstlane_b32 s34, v2
    s_mov_b32 s6, 8388608
    s_mov_b32 s7, 0x20000
    s_mov_b32 s10, 15990784
    s_mov_b32 s11, 0x20000
    s_mov_b32 s14, 4096
    s_mov_b32 s15, 0x20000
    s_and_b32 s40, s2, 7
    s_lshr_b32 s41, s2, 3
    s_and_b32 s41, s41, 31
    s_lshr_b32 s32, s40, 1
    s_lshl_b32 s32, s32, 3
    s_and_b32 s42, s41, 7
    s_add_u32 s32, s32, s42
    s_and_b32 s33, s40, 1
    s_lshl_b32 s33, s33, 2
    s_lshr_b32 s42, s41, 3
    s_add_u32 s33, s33, s42
    s_lshl_b32 s44, s33, 7
    s_lshl_b32 s40, s34, 5
    s_add_u32 s44, s44, s40
    s_mul_i32 s44, s44, 3072
    s_add_u32 s44, s44, 0
    s_lshl_b32 s45, s32, 18
    s_lshl_b32 s40, s34, 10
    s_add_u32 s45, s45, s40
    s_lshl_b32 s46, s34, 14
    v_lshlrev_b32 v5, 4, v1
    v_lshrrev_b32 v2, 3, v1
    v_lshlrev_b32 v2, 12, v2
    v_and_b32 v3, 7, v1
    v_lshrrev_b32 v4, 4, v1
    v_xor_b32 v3, v3, v4
    v_lshl_add_u32 v6, v3, 4, v2
    v_xor_b32 v7, 64, v6
    s_mov_b32 s50, 0
    s_waitcnt lgkmcnt(0)
    s_add_u32 s52, s50, 0
    s_and_b32 s52, s52, 7
    s_mul_i32 s52, s52, 12288
    s_add_u32 s52, s52, s44
    buffer_load_dwordx4 v[104:107], v5, s[8:11], s52 offen offset:0
    buffer_load_dwordx4 v[108:111], v5, s[8:11], s52 offen offset:1024
    buffer_load_dwordx4 v[112:115], v5, s[8:11], s52 offen offset:2048
    s_add_u32 s54, s50, 0
    s_and_b32 s54, s54, 7
    s_lshl_b32 s54, s54, 7
    s_add_u32 s54, s54, s45
    s_add_u32 s42, s54, 0
    s_add_u32 m0, s46, 0
    s_nop 0
    buffer_load_dwordx4 v6, s[4:7], s42 offen lds
    s_add_u32 s42, s54, 32768
    s_add_u32 m0, s46, 1024
    s_nop 0
    buffer_load_dwordx4 v7, s[4:7], s42 offen lds
    s_add_u32 s42, s54, 65536
    s_add_u32 m0, s46, 2048
    s_nop 0
    buffer_load_dwordx4 v6, s[4:7], s42 offen lds
    s_add_u32 s42, s54, 98304
    s_add_u32 m0, s46, 3072
    s_nop 0
    buffer_load_dwordx4 v7, s[4:7], s42 offen lds
    s_add_u32 s42, s54, 131072
    s_add_u32 m0, s46, 4096
    s_nop 0
    buffer_load_dwordx4 v6, s[4:7], s42 offen lds
    s_add_u32 s42, s54, 163840
    s_add_u32 m0, s46, 5120
    s_nop 0
    buffer_load_dwordx4 v7, s[4:7], s42 offen lds
    s_add_u32 s42, s54, 196608
    s_add_u32 m0, s46, 6144
    s_nop 0
    buffer_load_dwordx4 v6, s[4:7], s42 offen lds
    s_add_u32 s42, s54, 229376
    s_add_u32 m0, s46, 7168
    s_nop 0
    buffer_load_dwordx4 v7, s[4:7], s42 offen lds
    s_add_u32 s41, s52, 3072
    buffer_load_dwordx4 v[116:119], v5, s[8:11], s41 offen offset:0
    s_add_u32 s41, s52, 3072
    buffer_load_dwordx4 v[120:123], v5, s[8:11], s41 offen offset:1024
    s_add_u32 s41, s52, 3072
    buffer_load_dwordx4 v[124:127], v5, s[8:11], s41 offen offset:2048
    s_add_u32 s41, s52, 6144
    buffer_load_dwordx4 v[128:131], v5, s[8:11], s41 offen offset:0
    s_add_u32 s41, s52, 6144
    buffer_load_dwordx4 v[132:135], v5, s[8:11], s41 offen offset:1024
    s_add_u32 s41, s52, 6144
    buffer_load_dwordx4 v[136:139], v5, s[8:11], s41 offen offset:2048
    s_add_u32 s41, s52, 9216
    buffer_load_dwordx4 v[140:143], v5, s[8:11], s41 offen offset:0
    s_add_u32 s41, s52, 9216
    buffer_load_dwordx4 v[144:147], v5, s[8:11], s41 offen offset:1024
    s_add_u32 s41, s52, 9216
    buffer_load_dwordx4 v[148:151], v5, s[8:11], s41 offen offset:2048
    v_and_b32 v2, 31, v1
    v_lshrrev_b32 v3, 1, v2
    v_and_b32 v3, 7, v3
    v_lshrrev_b32 v4, 5, v1
    v_xor_b32 v3, v3, v4
    v_lshl_add_u32 v2, v2, 7, s46
    v_xor_b32 v4, 0, v3
    v_lshl_add_u32 v180, v4, 4, v2
    v_xor_b32 v4, 2, v3
    v_lshl_add_u32 v181, v4, 4, v2
    v_xor_b32 v4, 4, v3
    v_lshl_add_u32 v182, v4, 4, v2
    v_xor_b32 v4, 6, v3
    v_lshl_add_u32 v183, v4, 4, v2
    s_waitcnt vmcnt(9)
    s_setprio 2
    ds_read_b128 v[164:167], v180 offset:0
    ds_read_b128 v[168:171], v180 offset:4096
    s_waitcnt vmcnt(17)
    s_waitcnt lgkmcnt(0)
    v_mfma_f32_32x32x16_bf16 v[8:23], v[104:107], v[164:167], 0
    ds_read_b128 v[172:175], v181 offset:0
    ds_read_b128 v[176:179], v181 offset:4096
    v_mfma_f32_32x32x16_bf16 v[24:39], v[104:107], v[168:171], 0
    s_add_u32 s53, s50, 1
    s_and_b32 s53, s53, 7
    s_mul_i32 s53, s53, 12288
    s_add_u32 s53, s53, s44
    buffer_load_dwordx4 v[152:155], v5, s[8:11], s53 offen offset:0
    v_mfma_f32_32x32x16_bf16 v[40:55], v[108:111], v[164:167], 0
    buffer_load_dwordx4 v[156:159], v5, s[8:11], s53 offen offset:1024
    v_mfma_f32_32x32x16_bf16 v[56:71], v[108:111], v[168:171], 0
    buffer_load_dwordx4 v[160:163], v5, s[8:11], s53 offen offset:2048
    v_mfma_f32_32x32x16_bf16 v[72:87], v[112:115], v[164:167], 0
    s_add_u32 s55, s50, 1
    s_and_b32 s55, s55, 7
    s_lshl_b32 s55, s55, 7
    s_add_u32 s55, s55, s45
    s_add_u32 s42, s55, 0
    s_add_u32 m0, s46, 8192
    s_nop 0
    buffer_load_dwordx4 v6, s[4:7], s42 offen lds
    v_mfma_f32_32x32x16_bf16 v[88:103], v[112:115], v[168:171], 0
    s_add_u32 s42, s55, 32768
    s_add_u32 m0, s46, 9216
    s_nop 0
    buffer_load_dwordx4 v7, s[4:7], s42 offen lds
    s_add_u32 s42, s55, 65536
    s_add_u32 m0, s46, 10240
    s_nop 0
    buffer_load_dwordx4 v6, s[4:7], s42 offen lds
    s_add_u32 s42, s55, 98304
    s_add_u32 m0, s46, 11264
    s_nop 0
    buffer_load_dwordx4 v7, s[4:7], s42 offen lds
    s_waitcnt vmcnt(13)
    s_waitcnt lgkmcnt(0)
    v_mfma_f32_32x32x16_bf16 v[8:23], v[116:119], v[172:175], v[8:23]
    ds_read_b128 v[164:167], v182 offset:0
    ds_read_b128 v[168:171], v182 offset:4096
    v_mfma_f32_32x32x16_bf16 v[24:39], v[116:119], v[176:179], v[24:39]
    s_add_u32 s41, s53, 3072
    buffer_load_dwordx4 v[104:107], v5, s[8:11], s41 offen offset:0
    v_mfma_f32_32x32x16_bf16 v[40:55], v[120:123], v[172:175], v[40:55]
    s_add_u32 s41, s53, 3072
    buffer_load_dwordx4 v[108:111], v5, s[8:11], s41 offen offset:1024
    v_mfma_f32_32x32x16_bf16 v[56:71], v[120:123], v[176:179], v[56:71]
    s_add_u32 s41, s53, 3072
    buffer_load_dwordx4 v[112:115], v5, s[8:11], s41 offen offset:2048
    v_mfma_f32_32x32x16_bf16 v[72:87], v[124:127], v[172:175], v[72:87]
    s_add_u32 s42, s55, 131072
    s_add_u32 m0, s46, 12288
    s_nop 0
    buffer_load_dwordx4 v6, s[4:7], s42 offen lds
    v_mfma_f32_32x32x16_bf16 v[88:103], v[124:127], v[176:179], v[88:103]
    s_add_u32 s42, s55, 163840
    s_add_u32 m0, s46, 13312
    s_nop 0
    buffer_load_dwordx4 v7, s[4:7], s42 offen lds
    s_add_u32 s42, s55, 196608
    s_add_u32 m0, s46, 14336
    s_nop 0
    buffer_load_dwordx4 v6, s[4:7], s42 offen lds
    s_add_u32 s42, s55, 229376
    s_add_u32 m0, s46, 15360
    s_nop 0
    buffer_load_dwordx4 v7, s[4:7], s42 offen lds
    s_waitcnt vmcnt(17)
    s_waitcnt lgkmcnt(0)
    v_mfma_f32_32x32x16_bf16 v[8:23], v[128:131], v[164:167], v[8:23]
    ds_read_b128 v[172:175], v183 offset:0
    ds_read_b128 v[176:179], v183 offset:4096
    v_mfma_f32_32x32x16_bf16 v[24:39], v[128:131], v[168:171], v[24:39]
    s_add_u32 s41, s53, 6144
    buffer_load_dwordx4 v[116:119], v5, s[8:11], s41 offen offset:0
    v_mfma_f32_32x32x16_bf16 v[40:55], v[132:135], v[164:167], v[40:55]
    s_add_u32 s41, s53, 6144
    buffer_load_dwordx4 v[120:123], v5, s[8:11], s41 offen offset:1024
    v_mfma_f32_32x32x16_bf16 v[56:71], v[132:135], v[168:171], v[56:71]
    s_add_u32 s41, s53, 6144
    buffer_load_dwordx4 v[124:127], v5, s[8:11], s41 offen offset:2048
    v_mfma_f32_32x32x16_bf16 v[72:87], v[136:139], v[164:167], v[72:87]
    v_mfma_f32_32x32x16_bf16 v[88:103], v[136:139], v[168:171], v[88:103]
    s_waitcnt vmcnt(17)
    s_waitcnt lgkmcnt(0)
    v_mfma_f32_32x32x16_bf16 v[8:23], v[140:143], v[172:175], v[8:23]
    s_waitcnt vmcnt(3)
    ds_read_b128 v[164:167], v180 offset:8192
    ds_read_b128 v[168:171], v180 offset:12288
    v_mfma_f32_32x32x16_bf16 v[24:39], v[140:143], v[176:179], v[24:39]
    s_add_u32 s41, s53, 9216
    buffer_load_dwordx4 v[128:131], v5, s[8:11], s41 offen offset:0
    v_mfma_f32_32x32x16_bf16 v[40:55], v[144:147], v[172:175], v[40:55]
    s_add_u32 s41, s53, 9216
    buffer_load_dwordx4 v[132:135], v5, s[8:11], s41 offen offset:1024
    v_mfma_f32_32x32x16_bf16 v[56:71], v[144:147], v[176:179], v[56:71]
    s_add_u32 s41, s53, 9216
    buffer_load_dwordx4 v[136:139], v5, s[8:11], s41 offen offset:2048
    v_mfma_f32_32x32x16_bf16 v[72:87], v[148:151], v[172:175], v[72:87]
    s_add_u32 s54, s50, 2
    s_and_b32 s54, s54, 7
    s_lshl_b32 s54, s54, 7
    s_add_u32 s54, s54, s45
    s_add_u32 s42, s54, 0
    s_add_u32 m0, s46, 0
    s_nop 0
    buffer_load_dwordx4 v6, s[4:7], s42 offen lds
    v_mfma_f32_32x32x16_bf16 v[88:103], v[148:151], v[176:179], v[88:103]
    s_add_u32 s42, s54, 32768
    s_add_u32 m0, s46, 1024
    s_nop 0
    buffer_load_dwordx4 v7, s[4:7], s42 offen lds
    s_waitcnt vmcnt(19)
    s_waitcnt lgkmcnt(0)
    v_mfma_f32_32x32x16_bf16 v[8:23], v[152:155], v[164:167], v[8:23]
    ds_read_b128 v[172:175], v181 offset:8192
    ds_read_b128 v[176:179], v181 offset:12288
    v_mfma_f32_32x32x16_bf16 v[24:39], v[152:155], v[168:171], v[24:39]
    s_add_u32 s52, s50, 2
    s_and_b32 s52, s52, 7
    s_mul_i32 s52, s52, 12288
    s_add_u32 s52, s52, s44
    buffer_load_dwordx4 v[140:143], v5, s[8:11], s52 offen offset:0
    v_mfma_f32_32x32x16_bf16 v[40:55], v[156:159], v[164:167], v[40:55]
    buffer_load_dwordx4 v[144:147], v5, s[8:11], s52 offen offset:1024
    v_mfma_f32_32x32x16_bf16 v[56:71], v[156:159], v[168:171], v[56:71]
    buffer_load_dwordx4 v[148:151], v5, s[8:11], s52 offen offset:2048
    v_mfma_f32_32x32x16_bf16 v[72:87], v[160:163], v[164:167], v[72:87]
    s_add_u32 s42, s54, 65536
    s_add_u32 m0, s46, 2048
    s_nop 0
    buffer_load_dwordx4 v6, s[4:7], s42 offen lds
    v_mfma_f32_32x32x16_bf16 v[88:103], v[160:163], v[168:171], v[88:103]
    s_add_u32 s42, s54, 98304
    s_add_u32 m0, s46, 3072
    s_nop 0
    buffer_load_dwordx4 v7, s[4:7], s42 offen lds
    s_add_u32 s42, s54, 131072
    s_add_u32 m0, s46, 4096
    s_nop 0
    buffer_load_dwordx4 v6, s[4:7], s42 offen lds
    s_waitcnt vmcnt(18)
    s_waitcnt lgkmcnt(0)
    v_mfma_f32_32x32x16_bf16 v[8:23], v[104:107], v[172:175], v[8:23]
    ds_read_b128 v[164:167], v182 offset:8192
    ds_read_b128 v[168:171], v182 offset:12288
    v_mfma_f32_32x32x16_bf16 v[24:39], v[104:107], v[176:179], v[24:39]
    s_add_u32 s41, s52, 3072
    buffer_load_dwordx4 v[152:155], v5, s[8:11], s41 offen offset:0
    v_mfma_f32_32x32x16_bf16 v[40:55], v[108:111], v[172:175], v[40:55]
    s_add_u32 s41, s52, 3072
    buffer_load_dwordx4 v[156:159], v5, s[8:11], s41 offen offset:1024
    v_mfma_f32_32x32x16_bf16 v[56:71], v[108:111], v[176:179], v[56:71]
    s_add_u32 s41, s52, 3072
    buffer_load_dwordx4 v[160:163], v5, s[8:11], s41 offen offset:2048
    v_mfma_f32_32x32x16_bf16 v[72:87], v[112:115], v[172:175], v[72:87]
    s_add_u32 s42, s54, 163840
    s_add_u32 m0, s46, 5120
    s_nop 0
    buffer_load_dwordx4 v7, s[4:7], s42 offen lds
    v_mfma_f32_32x32x16_bf16 v[88:103], v[112:115], v[176:179], v[88:103]
    s_add_u32 s42, s54, 196608
    s_add_u32 m0, s46, 6144
    s_nop 0
    buffer_load_dwordx4 v6, s[4:7], s42 offen lds
    s_add_u32 s42, s54, 229376
    s_add_u32 m0, s46, 7168
    s_nop 0
    buffer_load_dwordx4 v7, s[4:7], s42 offen lds
    s_waitcnt vmcnt(17)
    s_waitcnt lgkmcnt(0)
    v_mfma_f32_32x32x16_bf16 v[8:23], v[116:119], v[164:167], v[8:23]
    ds_read_b128 v[172:175], v183 offset:8192
    ds_read_b128 v[176:179], v183 offset:12288
    v_mfma_f32_32x32x16_bf16 v[24:39], v[116:119], v[168:171], v[24:39]
    s_add_u32 s41, s52, 6144
    buffer_load_dwordx4 v[104:107], v5, s[8:11], s41 offen offset:0
    v_mfma_f32_32x32x16_bf16 v[40:55], v[120:123], v[164:167], v[40:55]
    s_add_u32 s41, s52, 6144
    buffer_load_dwordx4 v[108:111], v5, s[8:11], s41 offen offset:1024
    v_mfma_f32_32x32x16_bf16 v[56:71], v[120:123], v[168:171], v[56:71]
    s_add_u32 s41, s52, 6144
    buffer_load_dwordx4 v[112:115], v5, s[8:11], s41 offen offset:2048
    v_mfma_f32_32x32x16_bf16 v[72:87], v[124:127], v[164:167], v[72:87]
    v_mfma_f32_32x32x16_bf16 v[88:103], v[124:127], v[168:171], v[88:103]
    s_waitcnt vmcnt(17)
    s_waitcnt lgkmcnt(0)
    v_mfma_f32_32x32x16_bf16 v[8:23], v[128:131], v[172:175], v[8:23]
    s_waitcnt vmcnt(3)
    ds_read_b128 v[164:167], v180 offset:0
    ds_read_b128 v[168:171], v180 offset:4096
    v_mfma_f32_32x32x16_bf16 v[24:39], v[128:131], v[176:179], v[24:39]
    s_add_u32 s41, s52, 9216
    buffer_load_dwordx4 v[116:119], v5, s[8:11], s41 offen offset:0
    v_mfma_f32_32x32x16_bf16 v[40:55], v[132:135], v[172:175], v[40:55]
    s_add_u32 s41, s52, 9216
    buffer_load_dwordx4 v[120:123], v5, s[8:11], s41 offen offset:1024
    v_mfma_f32_32x32x16_bf16 v[56:71], v[132:135], v[176:179], v[56:71]
    s_add_u32 s41, s52, 9216
    buffer_load_dwordx4 v[124:127], v5, s[8:11], s41 offen offset:2048
    v_mfma_f32_32x32x16_bf16 v[72:87], v[136:139], v[172:175], v[72:87]
    s_add_u32 s55, s50, 3
    s_and_b32 s55, s55, 7
    s_lshl_b32 s55, s55, 7
    s_add_u32 s55, s55, s45
    s_add_u32 s42, s55, 0
    s_add_u32 m0, s46, 8192
    s_nop 0
    buffer_load_dwordx4 v6, s[4:7], s42 offen lds
    v_mfma_f32_32x32x16_bf16 v[88:103], v[136:139], v[176:179], v[88:103]
    s_add_u32 s42, s55, 32768
    s_add_u32 m0, s46, 9216
    s_nop 0
    buffer_load_dwordx4 v7, s[4:7], s42 offen lds
    s_waitcnt vmcnt(17)
    s_waitcnt lgkmcnt(0)
    v_mfma_f32_32x32x16_bf16 v[8:23], v[140:143], v[164:167], v[8:23]
    ds_read_b128 v[172:175], v181 offset:0
    ds_read_b128 v[176:179], v181 offset:4096
    v_mfma_f32_32x32x16_bf16 v[24:39], v[140:143], v[168:171], v[24:39]
    s_add_u32 s53, s50, 3
    s_and_b32 s53, s53, 7
    s_mul_i32 s53, s53, 12288
    s_add_u32 s53, s53, s44
    buffer_load_dwordx4 v[128:131], v5, s[8:11], s53 offen offset:0
    v_mfma_f32_32x32x16_bf16 v[40:55], v[144:147], v[164:167], v[40:55]
    buffer_load_dwordx4 v[132:135], v5, s[8:11], s53 offen offset:1024
    v_mfma_f32_32x32x16_bf16 v[56:71], v[144:147], v[168:171], v[56:71]
    buffer_load_dwordx4 v[136:139], v5, s[8:11], s53 offen offset:2048
    v_mfma_f32_32x32x16_bf16 v[72:87], v[148:151], v[164:167], v[72:87]
    s_add_u32 s42, s55, 65536
    s_add_u32 m0, s46, 10240
    s_nop 0
    buffer_load_dwordx4 v6, s[4:7], s42 offen lds
    v_mfma_f32_32x32x16_bf16 v[88:103], v[148:151], v[168:171], v[88:103]
    s_add_u32 s42, s55, 98304
    s_add_u32 m0, s46, 11264
    s_nop 0
    buffer_load_dwordx4 v7, s[4:7], s42 offen lds
    s_add_u32 s42, s55, 131072
    s_add_u32 m0, s46, 12288
    s_nop 0
    buffer_load_dwordx4 v6, s[4:7], s42 offen lds
    s_waitcnt vmcnt(17)
    s_waitcnt lgkmcnt(0)
    v_mfma_f32_32x32x16_bf16 v[8:23], v[152:155], v[172:175], v[8:23]
    ds_read_b128 v[164:167], v182 offset:0
    ds_read_b128 v[168:171], v182 offset:4096
    v_mfma_f32_32x32x16_bf16 v[24:39], v[152:155], v[176:179], v[24:39]
    s_add_u32 s41, s53, 3072
    buffer_load_dwordx4 v[140:143], v5, s[8:11], s41 offen offset:0
    v_mfma_f32_32x32x16_bf16 v[40:55], v[156:159], v[172:175], v[40:55]
    s_add_u32 s41, s53, 3072
    buffer_load_dwordx4 v[144:147], v5, s[8:11], s41 offen offset:1024
    v_mfma_f32_32x32x16_bf16 v[56:71], v[156:159], v[176:179], v[56:71]
    s_add_u32 s41, s53, 3072
    buffer_load_dwordx4 v[148:151], v5, s[8:11], s41 offen offset:2048
    v_mfma_f32_32x32x16_bf16 v[72:87], v[160:163], v[172:175], v[72:87]
    s_add_u32 s42, s55, 163840
    s_add_u32 m0, s46, 13312
    s_nop 0
    buffer_load_dwordx4 v7, s[4:7], s42 offen lds
    v_mfma_f32_32x32x16_bf16 v[88:103], v[160:163], v[176:179], v[88:103]
    s_add_u32 s42, s55, 196608
    s_add_u32 m0, s46, 14336
    s_nop 0
    buffer_load_dwordx4 v6, s[4:7], s42 offen lds
    s_add_u32 s42, s55, 229376
    s_add_u32 m0, s46, 15360
    s_nop 0
    buffer_load_dwordx4 v7, s[4:7], s42 offen lds
    s_waitcnt vmcnt(17)
    s_waitcnt lgkmcnt(0)
    v_mfma_f32_32x32x16_bf16 v[8:23], v[104:107], v[164:167], v[8:23]
    ds_read_b128 v[172:175], v183 offset:0
    ds_read_b128 v[176:179], v183 offset:4096
    v_mfma_f32_32x32x16_bf16 v[24:39], v[104:107], v[168:171], v[24:39]
    s_add_u32 s41, s53, 6144
    buffer_load_dwordx4 v[152:155], v5, s[8:11], s41 offen offset:0
    v_mfma_f32_32x32x16_bf16 v[40:55], v[108:111], v[164:167], v[40:55]
    s_add_u32 s41, s53, 6144
    buffer_load_dwordx4 v[156:159], v5, s[8:11], s41 offen offset:1024
    v_mfma_f32_32x32x16_bf16 v[56:71], v[108:111], v[168:171], v[56:71]
    s_add_u32 s41, s53, 6144
    buffer_load_dwordx4 v[160:163], v5, s[8:11], s41 offen offset:2048
    v_mfma_f32_32x32x16_bf16 v[72:87], v[112:115], v[164:167], v[72:87]
    v_mfma_f32_32x32x16_bf16 v[88:103], v[112:115], v[168:171], v[88:103]
    s_waitcnt vmcnt(17)
    s_waitcnt lgkmcnt(0)
    v_mfma_f32_32x32x16_bf16 v[8:23], v[116:119], v[172:175], v[8:23]
    s_waitcnt vmcnt(3)
    ds_read_b128 v[164:167], v180 offset:8192
    ds_read_b128 v[168:171], v180 offset:12288
    v_mfma_f32_32x32x16_bf16 v[24:39], v[116:119], v[176:179], v[24:39]
    s_add_u32 s41, s53, 9216
    buffer_load_dwordx4 v[104:107], v5, s[8:11], s41 offen offset:0
    v_mfma_f32_32x32x16_bf16 v[40:55], v[120:123], v[172:175], v[40:55]
    s_add_u32 s41, s53, 9216
    buffer_load_dwordx4 v[108:111], v5, s[8:11], s41 offen offset:1024
    v_mfma_f32_32x32x16_bf16 v[56:71], v[120:123], v[176:179], v[56:71]
    s_add_u32 s41, s53, 9216
    buffer_load_dwordx4 v[112:115], v5, s[8:11], s41 offen offset:2048
    v_mfma_f32_32x32x16_bf16 v[72:87], v[124:127], v[172:175], v[72:87]
    s_add_u32 s54, s50, 4
    s_and_b32 s54, s54, 7
    s_lshl_b32 s54, s54, 7
    s_add_u32 s54, s54, s45
    s_add_u32 s42, s54, 0
    s_add_u32 m0, s46, 0
    s_nop 0
    buffer_load_dwordx4 v6, s[4:7], s42 offen lds
    v_mfma_f32_32x32x16_bf16 v[88:103], v[124:127], v[176:179], v[88:103]
    s_add_u32 s42, s54, 32768
    s_add_u32 m0, s46, 1024
    s_nop 0
    buffer_load_dwordx4 v7, s[4:7], s42 offen lds
    s_waitcnt vmcnt(17)
    s_waitcnt lgkmcnt(0)
    v_mfma_f32_32x32x16_bf16 v[8:23], v[128:131], v[164:167], v[8:23]
    ds_read_b128 v[172:175], v181 offset:8192
    ds_read_b128 v[176:179], v181 offset:12288
    v_mfma_f32_32x32x16_bf16 v[24:39], v[128:131], v[168:171], v[24:39]
    s_add_u32 s52, s50, 4
    s_and_b32 s52, s52, 7
    s_mul_i32 s52, s52, 12288
    s_add_u32 s52, s52, s44
    buffer_load_dwordx4 v[116:119], v5, s[8:11], s52 offen offset:0
    v_mfma_f32_32x32x16_bf16 v[40:55], v[132:135], v[164:167], v[40:55]
    buffer_load_dwordx4 v[120:123], v5, s[8:11], s52 offen offset:1024
    v_mfma_f32_32x32x16_bf16 v[56:71], v[132:135], v[168:171], v[56:71]
    buffer_load_dwordx4 v[124:127], v5, s[8:11], s52 offen offset:2048
    v_mfma_f32_32x32x16_bf16 v[72:87], v[136:139], v[164:167], v[72:87]
    s_add_u32 s42, s54, 65536
    s_add_u32 m0, s46, 2048
    s_nop 0
    buffer_load_dwordx4 v6, s[4:7], s42 offen lds
    v_mfma_f32_32x32x16_bf16 v[88:103], v[136:139], v[168:171], v[88:103]
    s_add_u32 s42, s54, 98304
    s_add_u32 m0, s46, 3072
    s_nop 0
    buffer_load_dwordx4 v7, s[4:7], s42 offen lds
    s_add_u32 s42, s54, 131072
    s_add_u32 m0, s46, 4096
    s_nop 0
    buffer_load_dwordx4 v6, s[4:7], s42 offen lds
    s_waitcnt vmcnt(17)
    s_waitcnt lgkmcnt(0)
    v_mfma_f32_32x32x16_bf16 v[8:23], v[140:143], v[172:175], v[8:23]
    ds_read_b128 v[164:167], v182 offset:8192
    ds_read_b128 v[168:171], v182 offset:12288
    v_mfma_f32_32x32x16_bf16 v[24:39], v[140:143], v[176:179], v[24:39]
    s_add_u32 s41, s52, 3072
    buffer_load_dwordx4 v[128:131], v5, s[8:11], s41 offen offset:0
    v_mfma_f32_32x32x16_bf16 v[40:55], v[144:147], v[172:175], v[40:55]
    s_add_u32 s41, s52, 3072
    buffer_load_dwordx4 v[132:135], v5, s[8:11], s41 offen offset:1024
    v_mfma_f32_32x32x16_bf16 v[56:71], v[144:147], v[176:179], v[56:71]
    s_add_u32 s41, s52, 3072
    buffer_load_dwordx4 v[136:139], v5, s[8:11], s41 offen offset:2048
    v_mfma_f32_32x32x16_bf16 v[72:87], v[148:151], v[172:175], v[72:87]
    s_add_u32 s42, s54, 163840
    s_add_u32 m0, s46, 5120
    s_nop 0
    buffer_load_dwordx4 v7, s[4:7], s42 offen lds
    v_mfma_f32_32x32x16_bf16 v[88:103], v[148:151], v[176:179], v[88:103]
    s_add_u32 s42, s54, 196608
    s_add_u32 m0, s46, 6144
    s_nop 0
    buffer_load_dwordx4 v6, s[4:7], s42 offen lds
    s_add_u32 s42, s54, 229376
    s_add_u32 m0, s46, 7168
    s_nop 0
    buffer_load_dwordx4 v7, s[4:7], s42 offen lds
    s_waitcnt vmcnt(17)
    s_waitcnt lgkmcnt(0)
    v_mfma_f32_32x32x16_bf16 v[8:23], v[152:155], v[164:167], v[8:23]
    ds_read_b128 v[172:175], v183 offset:8192
    ds_read_b128 v[176:179], v183 offset:12288
    v_mfma_f32_32x32x16_bf16 v[24:39], v[152:155], v[168:171], v[24:39]
    s_add_u32 s41, s52, 6144
    buffer_load_dwordx4 v[140:143], v5, s[8:11], s41 offen offset:0
    v_mfma_f32_32x32x16_bf16 v[40:55], v[156:159], v[164:167], v[40:55]
    s_add_u32 s41, s52, 6144
    buffer_load_dwordx4 v[144:147], v5, s[8:11], s41 offen offset:1024
    v_mfma_f32_32x32x16_bf16 v[56:71], v[156:159], v[168:171], v[56:71]
    s_add_u32 s41, s52, 6144
    buffer_load_dwordx4 v[148:151], v5, s[8:11], s41 offen offset:2048
    v_mfma_f32_32x32x16_bf16 v[72:87], v[160:163], v[164:167], v[72:87]
    v_mfma_f32_32x32x16_bf16 v[88:103], v[160:163], v[168:171], v[88:103]
    s_waitcnt vmcnt(17)
    s_waitcnt lgkmcnt(0)
    v_mfma_f32_32x32x16_bf16 v[8:23], v[104:107], v[172:175], v[8:23]
    s_waitcnt vmcnt(3)
    ds_read_b128 v[164:167], v180 offset:0
    ds_read_b128 v[168:171], v180 offset:4096
    v_mfma_f32_32x32x16_bf16 v[24:39], v[104:107], v[176:179], v[24:39]
    s_add_u32 s41, s52, 9216
    buffer_load_dwordx4 v[152:155], v5, s[8:11], s41 offen offset:0
    v_mfma_f32_32x32x16_bf16 v[40:55], v[108:111], v[172:175], v[40:55]
    s_add_u32 s41, s52, 9216
    buffer_load_dwordx4 v[156:159], v5, s[8:11], s41 offen offset:1024
    v_mfma_f32_32x32x16_bf16 v[56:71], v[108:111], v[176:179], v[56:71]
    s_add_u32 s41, s52, 9216
    buffer_load_dwordx4 v[160:163], v5, s[8:11], s41 offen offset:2048
    v_mfma_f32_32x32x16_bf16 v[72:87], v[112:115], v[172:175], v[72:87]
    s_add_u32 s55, s50, 5
    s_and_b32 s55, s55, 7
    s_lshl_b32 s55, s55, 7
    s_add_u32 s55, s55, s45
    s_add_u32 s42, s55, 0
    s_add_u32 m0, s46, 8192
    s_nop 0
    buffer_load_dwordx4 v6, s[4:7], s42 offen lds
    v_mfma_f32_32x32x16_bf16 v[88:103], v[112:115], v[176:179], v[88:103]
    s_add_u32 s42, s55, 32768
    s_add_u32 m0, s46, 9216
    s_nop 0
    buffer_load_dwordx4 v7, s[4:7], s42 offen lds
    s_waitcnt vmcnt(17)
    s_waitcnt lgkmcnt(0)
    v_mfma_f32_32x32x16_bf16 v[8:23], v[116:119], v[164:167], v[8:23]
    ds_read_b128 v[172:175], v181 offset:0
    ds_read_b128 v[176:179], v181 offset:4096
    v_mfma_f32_32x32x16_bf16 v[24:39], v[116:119], v[168:171], v[24:39]
    s_add_u32 s53, s50, 5
    s_and_b32 s53, s53, 7
    s_mul_i32 s53, s53, 12288
    s_add_u32 s53, s53, s44
    buffer_load_dwordx4 v[104:107], v5, s[8:11], s53 offen offset:0
    v_mfma_f32_32x32x16_bf16 v[40:55], v[120:123], v[164:167], v[40:55]
    buffer_load_dwordx4 v[108:111], v5, s[8:11], s53 offen offset:1024
    v_mfma_f32_32x32x16_bf16 v[56:71], v[120:123], v[168:171], v[56:71]
    buffer_load_dwordx4 v[112:115], v5, s[8:11], s53 offen offset:2048
    v_mfma_f32_32x32x16_bf16 v[72:87], v[124:127], v[164:167], v[72:87]
    s_add_u32 s42, s55, 65536
    s_add_u32 m0, s46, 10240
    s_nop 0
    buffer_load_dwordx4 v6, s[4:7], s42 offen lds
    v_mfma_f32_32x32x16_bf16 v[88:103], v[124:127], v[168:171], v[88:103]
    s_add_u32 s42, s55, 98304
    s_add_u32 m0, s46, 11264
    s_nop 0
    buffer_load_dwordx4 v7, s[4:7], s42 offen lds
    s_add_u32 s42, s55, 131072
    s_add_u32 m0, s46, 12288
    s_nop 0
    buffer_load_dwordx4 v6, s[4:7], s42 offen lds
    s_waitcnt vmcnt(17)
    s_waitcnt lgkmcnt(0)
    v_mfma_f32_32x32x16_bf16 v[8:23], v[128:131], v[172:175], v[8:23]
    ds_read_b128 v[164:167], v182 offset:0
    ds_read_b128 v[168:171], v182 offset:4096
    v_mfma_f32_32x32x16_bf16 v[24:39], v[128:131], v[176:179], v[24:39]
    s_add_u32 s41, s53, 3072
    buffer_load_dwordx4 v[116:119], v5, s[8:11], s41 offen offset:0
    v_mfma_f32_32x32x16_bf16 v[40:55], v[132:135], v[172:175], v[40:55]
    s_add_u32 s41, s53, 3072
    buffer_load_dwordx4 v[120:123], v5, s[8:11], s41 offen offset:1024
    v_mfma_f32_32x32x16_bf16 v[56:71], v[132:135], v[176:179], v[56:71]
    s_add_u32 s41, s53, 3072
    buffer_load_dwordx4 v[124:127], v5, s[8:11], s41 offen offset:2048
    v_mfma_f32_32x32x16_bf16 v[72:87], v[136:139], v[172:175], v[72:87]
    s_add_u32 s42, s55, 163840
    s_add_u32 m0, s46, 13312
    s_nop 0
    buffer_load_dwordx4 v7, s[4:7], s42 offen lds
    v_mfma_f32_32x32x16_bf16 v[88:103], v[136:139], v[176:179], v[88:103]
    s_add_u32 s42, s55, 196608
    s_add_u32 m0, s46, 14336
    s_nop 0
    buffer_load_dwordx4 v6, s[4:7], s42 offen lds
    s_add_u32 s42, s55, 229376
    s_add_u32 m0, s46, 15360
    s_nop 0
    buffer_load_dwordx4 v7, s[4:7], s42 offen lds
    s_waitcnt vmcnt(17)
    s_waitcnt lgkmcnt(0)
    v_mfma_f32_32x32x16_bf16 v[8:23], v[140:143], v[164:167], v[8:23]
    ds_read_b128 v[172:175], v183 offset:0
    ds_read_b128 v[176:179], v183 offset:4096
    v_mfma_f32_32x32x16_bf16 v[24:39], v[140:143], v[168:171], v[24:39]
    s_add_u32 s41, s53, 6144
    buffer_load_dwordx4 v[128:131], v5, s[8:11], s41 offen offset:0
    v_mfma_f32_32x32x16_bf16 v[40:55], v[144:147], v[164:167], v[40:55]
    s_add_u32 s41, s53, 6144
    buffer_load_dwordx4 v[132:135], v5, s[8:11], s41 offen offset:1024
    v_mfma_f32_32x32x16_bf16 v[56:71], v[144:147], v[168:171], v[56:71]
    s_add_u32 s41, s53, 6144
    buffer_load_dwordx4 v[136:139], v5, s[8:11], s41 offen offset:2048
    v_mfma_f32_32x32x16_bf16 v[72:87], v[148:151], v[164:167], v[72:87]
    v_mfma_f32_32x32x16_bf16 v[88:103], v[148:151], v[168:171], v[88:103]
    s_waitcnt vmcnt(17)
    s_waitcnt lgkmcnt(0)
    v_mfma_f32_32x32x16_bf16 v[8:23], v[152:155], v[172:175], v[8:23]
    s_waitcnt vmcnt(3)
    ds_read_b128 v[164:167], v180 offset:8192
    ds_read_b128 v[168:171], v180 offset:12288
    v_mfma_f32_32x32x16_bf16 v[24:39], v[152:155], v[176:179], v[24:39]
    s_add_u32 s41, s53, 9216
    buffer_load_dwordx4 v[140:143], v5, s[8:11], s41 offen offset:0
    v_mfma_f32_32x32x16_bf16 v[40:55], v[156:159], v[172:175], v[40:55]
    s_add_u32 s41, s53, 9216
    buffer_load_dwordx4 v[144:147], v5, s[8:11], s41 offen offset:1024
    v_mfma_f32_32x32x16_bf16 v[56:71], v[156:159], v[176:179], v[56:71]
    s_add_u32 s41, s53, 9216
    buffer_load_dwordx4 v[148:151], v5, s[8:11], s41 offen offset:2048
    v_mfma_f32_32x32x16_bf16 v[72:87], v[160:163], v[172:175], v[72:87]
    s_add_u32 s54, s50, 6
    s_and_b32 s54, s54, 7
    s_lshl_b32 s54, s54, 7
    s_add_u32 s54, s54, s45
    s_add_u32 s42, s54, 0
    s_add_u32 m0, s46, 0
    s_nop 0
    buffer_load_dwordx4 v6, s[4:7], s42 offen lds
    v_mfma_f32_32x32x16_bf16 v[88:103], v[160:163], v[176:179], v[88:103]
    s_add_u32 s42, s54, 32768
    s_add_u32 m0, s46, 1024
    s_nop 0
    buffer_load_dwordx4 v7, s[4:7], s42 offen lds
    s_waitcnt vmcnt(17)
    s_waitcnt lgkmcnt(0)
    v_mfma_f32_32x32x16_bf16 v[8:23], v[104:107], v[164:167], v[8:23]
    ds_read_b128 v[172:175], v181 offset:8192
    ds_read_b128 v[176:179], v181 offset:12288
    v_mfma_f32_32x32x16_bf16 v[24:39], v[104:107], v[168:171], v[24:39]
    s_add_u32 s52, s50, 6
    s_and_b32 s52, s52, 7
    s_mul_i32 s52, s52, 12288
    s_add_u32 s52, s52, s44
    buffer_load_dwordx4 v[152:155], v5, s[8:11], s52 offen offset:0
    v_mfma_f32_32x32x16_bf16 v[40:55], v[108:111], v[164:167], v[40:55]
    buffer_load_dwordx4 v[156:159], v5, s[8:11], s52 offen offset:1024
    v_mfma_f32_32x32x16_bf16 v[56:71], v[108:111], v[168:171], v[56:71]
    buffer_load_dwordx4 v[160:163], v5, s[8:11], s52 offen offset:2048
    v_mfma_f32_32x32x16_bf16 v[72:87], v[112:115], v[164:167], v[72:87]
    s_add_u32 s42, s54, 65536
    s_add_u32 m0, s46, 2048
    s_nop 0
    buffer_load_dwordx4 v6, s[4:7], s42 offen lds
    v_mfma_f32_32x32x16_bf16 v[88:103], v[112:115], v[168:171], v[88:103]
    s_add_u32 s42, s54, 98304
    s_add_u32 m0, s46, 3072
    s_nop 0
    buffer_load_dwordx4 v7, s[4:7], s42 offen lds
    s_add_u32 s42, s54, 131072
    s_add_u32 m0, s46, 4096
    s_nop 0
    buffer_load_dwordx4 v6, s[4:7], s42 offen lds
    s_waitcnt vmcnt(17)
    s_waitcnt lgkmcnt(0)
    v_mfma_f32_32x32x16_bf16 v[8:23], v[116:119], v[172:175], v[8:23]
    ds_read_b128 v[164:167], v182 offset:8192
    ds_read_b128 v[168:171], v182 offset:12288
    v_mfma_f32_32x32x16_bf16 v[24:39], v[116:119], v[176:179], v[24:39]
    s_add_u32 s41, s52, 3072
    buffer_load_dwordx4 v[104:107], v5, s[8:11], s41 offen offset:0
    v_mfma_f32_32x32x16_bf16 v[40:55], v[120:123], v[172:175], v[40:55]
    s_add_u32 s41, s52, 3072
    buffer_load_dwordx4 v[108:111], v5, s[8:11], s41 offen offset:1024
    v_mfma_f32_32x32x16_bf16 v[56:71], v[120:123], v[176:179], v[56:71]
    s_add_u32 s41, s52, 3072
    buffer_load_dwordx4 v[112:115], v5, s[8:11], s41 offen offset:2048
    v_mfma_f32_32x32x16_bf16 v[72:87], v[124:127], v[172:175], v[72:87]
    s_add_u32 s42, s54, 163840
    s_add_u32 m0, s46, 5120
    s_nop 0
    buffer_load_dwordx4 v7, s[4:7], s42 offen lds
    v_mfma_f32_32x32x16_bf16 v[88:103], v[124:127], v[176:179], v[88:103]
    s_add_u32 s42, s54, 196608
    s_add_u32 m0, s46, 6144
    s_nop 0
    buffer_load_dwordx4 v6, s[4:7], s42 offen lds
    s_add_u32 s42, s54, 229376
    s_add_u32 m0, s46, 7168
    s_nop 0
    buffer_load_dwordx4 v7, s[4:7], s42 offen lds
    s_waitcnt vmcnt(17)
    s_waitcnt lgkmcnt(0)
    v_mfma_f32_32x32x16_bf16 v[8:23], v[128:131], v[164:167], v[8:23]
    ds_read_b128 v[172:175], v183 offset:8192
    ds_read_b128 v[176:179], v183 offset:12288
    v_mfma_f32_32x32x16_bf16 v[24:39], v[128:131], v[168:171], v[24:39]
    s_add_u32 s41, s52, 6144
    buffer_load_dwordx4 v[116:119], v5, s[8:11], s41 offen offset:0
    v_mfma_f32_32x32x16_bf16 v[40:55], v[132:135], v[164:167], v[40:55]
    s_add_u32 s41, s52, 6144
    buffer_load_dwordx4 v[120:123], v5, s[8:11], s41 offen offset:1024
    v_mfma_f32_32x32x16_bf16 v[56:71], v[132:135], v[168:171], v[56:71]
    s_add_u32 s41, s52, 6144
    buffer_load_dwordx4 v[124:127], v5, s[8:11], s41 offen offset:2048
    v_mfma_f32_32x32x16_bf16 v[72:87], v[136:139], v[164:167], v[72:87]
    v_mfma_f32_32x32x16_bf16 v[88:103], v[136:139], v[168:171], v[88:103]
    s_waitcnt vmcnt(17)
    s_waitcnt lgkmcnt(0)
    v_mfma_f32_32x32x16_bf16 v[8:23], v[140:143], v[172:175], v[8:23]
    s_waitcnt vmcnt(3)
    ds_read_b128 v[164:167], v180 offset:0
    ds_read_b128 v[168:171], v180 offset:4096
    v_mfma_f32_32x32x16_bf16 v[24:39], v[140:143], v[176:179], v[24:39]
    s_add_u32 s41, s52, 9216
    buffer_load_dwordx4 v[128:131], v5, s[8:11], s41 offen offset:0
    v_mfma_f32_32x32x16_bf16 v[40:55], v[144:147], v[172:175], v[40:55]
    s_add_u32 s41, s52, 9216
    buffer_load_dwordx4 v[132:135], v5, s[8:11], s41 offen offset:1024
    v_mfma_f32_32x32x16_bf16 v[56:71], v[144:147], v[176:179], v[56:71]
    s_add_u32 s41, s52, 9216
    buffer_load_dwordx4 v[136:139], v5, s[8:11], s41 offen offset:2048
    v_mfma_f32_32x32x16_bf16 v[72:87], v[148:151], v[172:175], v[72:87]
    s_add_u32 s55, s50, 7
    s_and_b32 s55, s55, 7
    s_lshl_b32 s55, s55, 7
    s_add_u32 s55, s55, s45
    s_add_u32 s42, s55, 0
    s_add_u32 m0, s46, 8192
    s_nop 0
    buffer_load_dwordx4 v6, s[4:7], s42 offen lds
    v_mfma_f32_32x32x16_bf16 v[88:103], v[148:151], v[176:179], v[88:103]
    s_add_u32 s42, s55, 32768
    s_add_u32 m0, s46, 9216
    s_nop 0
    buffer_load_dwordx4 v7, s[4:7], s42 offen lds
    s_waitcnt vmcnt(17)
    s_waitcnt lgkmcnt(0)
    v_mfma_f32_32x32x16_bf16 v[8:23], v[152:155], v[164:167], v[8:23]
    ds_read_b128 v[172:175], v181 offset:0
    ds_read_b128 v[176:179], v181 offset:4096
    v_mfma_f32_32x32x16_bf16 v[24:39], v[152:155], v[168:171], v[24:39]
    s_add_u32 s53, s50, 7
    s_and_b32 s53, s53, 7
    s_mul_i32 s53, s53, 12288
    s_add_u32 s53, s53, s44
    buffer_load_dwordx4 v[140:143], v5, s[8:11], s53 offen offset:0
    v_mfma_f32_32x32x16_bf16 v[40:55], v[156:159], v[164:167], v[40:55]
    buffer_load_dwordx4 v[144:147], v5, s[8:11], s53 offen offset:1024
    v_mfma_f32_32x32x16_bf16 v[56:71], v[156:159], v[168:171], v[56:71]
    buffer_load_dwordx4 v[148:151], v5, s[8:11], s53 offen offset:2048
    v_mfma_f32_32x32x16_bf16 v[72:87], v[160:163], v[164:167], v[72:87]
    s_add_u32 s42, s55, 65536
    s_add_u32 m0, s46, 10240
    s_nop 0
    buffer_load_dwordx4 v6, s[4:7], s42 offen lds
    v_mfma_f32_32x32x16_bf16 v[88:103], v[160:163], v[168:171], v[88:103]
    s_add_u32 s42, s55, 98304
    s_add_u32 m0, s46, 11264
    s_nop 0
    buffer_load_dwordx4 v7, s[4:7], s42 offen lds
    s_add_u32 s42, s55, 131072
    s_add_u32 m0, s46, 12288
    s_nop 0
    buffer_load_dwordx4 v6, s[4:7], s42 offen lds
    s_waitcnt vmcnt(17)
    s_waitcnt lgkmcnt(0)
    v_mfma_f32_32x32x16_bf16 v[8:23], v[104:107], v[172:175], v[8:23]
    ds_read_b128 v[164:167], v182 offset:0
    ds_read_b128 v[168:171], v182 offset:4096
    v_mfma_f32_32x32x16_bf16 v[24:39], v[104:107], v[176:179], v[24:39]
    s_add_u32 s41, s53, 3072
    buffer_load_dwordx4 v[152:155], v5, s[8:11], s41 offen offset:0
    v_mfma_f32_32x32x16_bf16 v[40:55], v[108:111], v[172:175], v[40:55]
    s_add_u32 s41, s53, 3072
    buffer_load_dwordx4 v[156:159], v5, s[8:11], s41 offen offset:1024
    v_mfma_f32_32x32x16_bf16 v[56:71], v[108:111], v[176:179], v[56:71]
    s_add_u32 s41, s53, 3072
    buffer_load_dwordx4 v[160:163], v5, s[8:11], s41 offen offset:2048
    v_mfma_f32_32x32x16_bf16 v[72:87], v[112:115], v[172:175], v[72:87]
    s_add_u32 s42, s55, 163840
    s_add_u32 m0, s46, 13312
    s_nop 0
    buffer_load_dwordx4 v7, s[4:7], s42 offen lds
    v_mfma_f32_32x32x16_bf16 v[88:103], v[112:115], v[176:179], v[88:103]
    s_add_u32 s42, s55, 196608
    s_add_u32 m0, s46, 14336
    s_nop 0
    buffer_load_dwordx4 v6, s[4:7], s42 offen lds
    s_add_u32 s42, s55, 229376
    s_add_u32 m0, s46, 15360
    s_nop 0
    buffer_load_dwordx4 v7, s[4:7], s42 offen lds
    s_waitcnt vmcnt(17)
    s_waitcnt lgkmcnt(0)
    v_mfma_f32_32x32x16_bf16 v[8:23], v[116:119], v[164:167], v[8:23]
    ds_read_b128 v[172:175], v183 offset:0
    ds_read_b128 v[176:179], v183 offset:4096
    v_mfma_f32_32x32x16_bf16 v[24:39], v[116:119], v[168:171], v[24:39]
    s_add_u32 s41, s53, 6144
    buffer_load_dwordx4 v[104:107], v5, s[8:11], s41 offen offset:0
    v_mfma_f32_32x32x16_bf16 v[40:55], v[120:123], v[164:167], v[40:55]
    s_add_u32 s41, s53, 6144
    buffer_load_dwordx4 v[108:111], v5, s[8:11], s41 offen offset:1024
    v_mfma_f32_32x32x16_bf16 v[56:71], v[120:123], v[168:171], v[56:71]
    s_add_u32 s41, s53, 6144
    buffer_load_dwordx4 v[112:115], v5, s[8:11], s41 offen offset:2048
    v_mfma_f32_32x32x16_bf16 v[72:87], v[124:127], v[164:167], v[72:87]
    v_mfma_f32_32x32x16_bf16 v[88:103], v[124:127], v[168:171], v[88:103]
    s_waitcnt vmcnt(17)
    s_waitcnt lgkmcnt(0)
    v_mfma_f32_32x32x16_bf16 v[8:23], v[128:131], v[172:175], v[8:23]
    s_waitcnt vmcnt(3)
    ds_read_b128 v[164:167], v180 offset:8192
    ds_read_b128 v[168:171], v180 offset:12288
    v_mfma_f32_32x32x16_bf16 v[24:39], v[128:131], v[176:179], v[24:39]
    s_add_u32 s41, s53, 9216
    buffer_load_dwordx4 v[116:119], v5, s[8:11], s41 offen offset:0
    v_mfma_f32_32x32x16_bf16 v[40:55], v[132:135], v[172:175], v[40:55]
    s_add_u32 s41, s53, 9216
    buffer_load_dwordx4 v[120:123], v5, s[8:11], s41 offen offset:1024
    v_mfma_f32_32x32x16_bf16 v[56:71], v[132:135], v[176:179], v[56:71]
    s_add_u32 s41, s53, 9216
    buffer_load_dwordx4 v[124:127], v5, s[8:11], s41 offen offset:2048
    v_mfma_f32_32x32x16_bf16 v[72:87], v[136:139], v[172:175], v[72:87]
    v_mfma_f32_32x32x16_bf16 v[88:103], v[136:139], v[176:179], v[88:103]
    s_waitcnt vmcnt(15)
    s_waitcnt lgkmcnt(0)
    v_mfma_f32_32x32x16_bf16 v[8:23], v[140:143], v[164:167], v[8:23]
    ds_read_b128 v[172:175], v181 offset:8192
    ds_read_b128 v[176:179], v181 offset:12288
    v_mfma_f32_32x32x16_bf16 v[24:39], v[140:143], v[168:171], v[24:39]
    v_mfma_f32_32x32x16_bf16 v[40:55], v[144:147], v[164:167], v[40:55]
    v_mfma_f32_32x32x16_bf16 v[56:71], v[144:147], v[168:171], v[56:71]
    v_mfma_f32_32x32x16_bf16 v[72:87], v[148:151], v[164:167], v[72:87]
    v_mfma_f32_32x32x16_bf16 v[88:103], v[148:151], v[168:171], v[88:103]
    s_waitcnt vmcnt(9)
    s_waitcnt lgkmcnt(0)
    v_mfma_f32_32x32x16_bf16 v[8:23], v[152:155], v[172:175], v[8:23]
    ds_read_b128 v[164:167], v182 offset:8192
    ds_read_b128 v[168:171], v182 offset:12288
    v_mfma_f32_32x32x16_bf16 v[24:39], v[152:155], v[176:179], v[24:39]
    v_mfma_f32_32x32x16_bf16 v[40:55], v[156:159], v[172:175], v[40:55]
    v_mfma_f32_32x32x16_bf16 v[56:71], v[156:159], v[176:179], v[56:71]
    v_mfma_f32_32x32x16_bf16 v[72:87], v[160:163], v[172:175], v[72:87]
    v_mfma_f32_32x32x16_bf16 v[88:103], v[160:163], v[176:179], v[88:103]
    s_waitcnt vmcnt(3)
    s_waitcnt lgkmcnt(0)
    v_mfma_f32_32x32x16_bf16 v[8:23], v[104:107], v[164:167], v[8:23]
    ds_read_b128 v[172:175], v183 offset:8192
    ds_read_b128 v[176:179], v183 offset:12288
    v_mfma_f32_32x32x16_bf16 v[24:39], v[104:107], v[168:171], v[24:39]
    s_lshl_b32 s40, s32, 3
    s_add_u32 s40, s40, s33
    s_lshl_b32 s40, s40, 2
    s_add_u32 s40, s40, s34
    s_mul_i32 s40, s40, 3072
    s_add_u32 s40, s40, 3145728
    buffer_load_dwordx4 v[184:187], v5, s[8:11], s40 offen offset:0
    v_mfma_f32_32x32x16_bf16 v[40:55], v[108:111], v[164:167], v[40:55]
    buffer_load_dwordx4 v[188:191], v5, s[8:11], s40 offen offset:1024
    v_mfma_f32_32x32x16_bf16 v[56:71], v[108:111], v[168:171], v[56:71]
    buffer_load_dwordx4 v[192:195], v5, s[8:11], s40 offen offset:2048
    v_mfma_f32_32x32x16_bf16 v[72:87], v[112:115], v[164:167], v[72:87]
    v_and_b32 v2, 31, v1
    v_lshlrev_b32 v2, 1, v2
    s_lshr_b32 s40, s34, 1
    s_lshl_b32 s40, s40, 6
    s_lshl_b32 s43, s32, 7
    s_add_u32 s40, s40, s43
    buffer_load_ushort v196, v2, s[12:15], s40 offen
    v_mfma_f32_32x32x16_bf16 v[88:103], v[112:115], v[168:171], v[88:103]
    s_waitcnt vmcnt(4)
    s_waitcnt lgkmcnt(0)
    v_mfma_f32_32x32x16_bf16 v[8:23], v[116:119], v[172:175], v[8:23]
    v_mfma_f32_32x32x16_bf16 v[24:39], v[116:119], v[176:179], v[24:39]
    v_mfma_f32_32x32x16_bf16 v[40:55], v[120:123], v[172:175], v[40:55]
    v_mfma_f32_32x32x16_bf16 v[56:71], v[120:123], v[176:179], v[56:71]
    v_mfma_f32_32x32x16_bf16 v[72:87], v[124:127], v[172:175], v[72:87]
    v_mfma_f32_32x32x16_bf16 v[88:103], v[124:127], v[176:179], v[88:103]
    s_setprio 0
    v_add_u32 v4, 0x10000, v5
    s_nop 15
    s_barrier
    s_cmp_lg_u32 s34, 0
    s_cbranch_scc1 g_epi_2
    ds_write_b128 v5, v[12:15] offset:30720
    ds_write_b128 v5, v[20:23] offset:31744
    ds_write_b128 v5, v[44:47] offset:32768
    ds_write_b128 v5, v[52:55] offset:33792
    ds_write_b128 v5, v[76:79] offset:34816
    ds_write_b128 v5, v[84:87] offset:35840
    ds_write_b128 v5, v[24:27] offset:43008
    ds_write_b128 v5, v[32:35] offset:44032
    ds_write_b128 v5, v[56:59] offset:45056
    ds_write_b128 v5, v[64:67] offset:46080
    ds_write_b128 v5, v[88:91] offset:47104
    ds_write_b128 v5, v[96:99] offset:48128
    ds_write_b128 v5, v[28:31] offset:55296
    ds_write_b128 v5, v[36:39] offset:56320
    ds_write_b128 v5, v[60:63] offset:57344
    ds_write_b128 v5, v[68:71] offset:58368
    ds_write_b128 v5, v[92:95] offset:59392
    ds_write_b128 v5, v[100:103] offset:60416
    v_pk_add_f32 v[104:105], v[8:9], 0
    v_pk_add_f32 v[106:107], v[10:11], 0
    v_pk_add_f32 v[108:109], v[16:17], 0
    v_pk_add_f32 v[110:111], v[18:19], 0
    v_pk_add_f32 v[112:113], v[40:41], 0
    v_pk_add_f32 v[114:115], v[42:43], 0
    v_pk_add_f32 v[116:117], v[48:49], 0
    v_pk_add_f32 v[118:119], v[50:51], 0
    v_pk_add_f32 v[120:121], v[72:73], 0
    v_pk_add_f32 v[122:123], v[74:75], 0
    v_pk_add_f32 v[124:125], v[80:81], 0
    v_pk_add_f32 v[126:127], v[82:83], 0
    s_branch g_epi_end_1
g_epi_2:
    s_cmp_lg_u32 s34, 1
    s_cbranch_scc1 g_epi_3
    ds_write_b128 v5, v[8:11] offset:0
    ds_write_b128 v5, v[16:19] offset:1024
    ds_write_b128 v5, v[40:43] offset:2048
    ds_write_b128 v5, v[48:51] offset:3072
    ds_write_b128 v5, v[72:75] offset:4096
    ds_write_b128 v5, v[80:83] offset:5120
    ds_write_b128 v5, v[24:27] offset:49152
    ds_write_b128 v5, v[32:35] offset:50176
    ds_write_b128 v5, v[56:59] offset:51200
    ds_write_b128 v5, v[64:67] offset:52224
    ds_write_b128 v5, v[88:91] offset:53248
    ds_write_b128 v5, v[96:99] offset:54272
    ds_write_b128 v5, v[28:31] offset:61440
    ds_write_b128 v5, v[36:39] offset:62464
    ds_write_b128 v5, v[60:63] offset:63488
    ds_write_b128 v5, v[68:71] offset:64512
    ds_write_b128 v4, v[92:95] offset:0
    ds_write_b128 v4, v[100:103] offset:1024
    v_pk_add_f32 v[104:105], v[12:13], 0
    v_pk_add_f32 v[106:107], v[14:15], 0
    v_pk_add_f32 v[108:109], v[20:21], 0
    v_pk_add_f32 v[110:111], v[22:23], 0
    v_pk_add_f32 v[112:113], v[44:45], 0
    v_pk_add_f32 v[114:115], v[46:47], 0
    v_pk_add_f32 v[116:117], v[52:53], 0
    v_pk_add_f32 v[118:119], v[54:55], 0
    v_pk_add_f32 v[120:121], v[76:77], 0
    v_pk_add_f32 v[122:123], v[78:79], 0
    v_pk_add_f32 v[124:125], v[84:85], 0
    v_pk_add_f32 v[126:127], v[86:87], 0
    s_branch g_epi_end_1
g_epi_3:
    s_cmp_lg_u32 s34, 2
    s_cbranch_scc1 g_epi_4
    ds_write_b128 v5, v[8:11] offset:6144
    ds_write_b128 v5, v[16:19] offset:7168
    ds_write_b128 v5, v[40:43] offset:8192
    ds_write_b128 v5, v[48:51] offset:9216
    ds_write_b128 v5, v[72:75] offset:10240
    ds_write_b128 v5, v[80:83] offset:11264
    ds_write_b128 v5, v[12:15] offset:18432
    ds_write_b128 v5, v[20:23] offset:19456
    ds_write_b128 v5, v[44:47] offset:20480
    ds_write_b128 v5, v[52:55] offset:21504
    ds_write_b128 v5, v[76:79] offset:22528
    ds_write_b128 v5, v[84:87] offset:23552
    ds_write_b128 v4, v[28:31] offset:2048
    ds_write_b128 v4, v[36:39] offset:3072
    ds_write_b128 v4, v[60:63] offset:4096
    ds_write_b128 v4, v[68:71] offset:5120
    ds_write_b128 v4, v[92:95] offset:6144
    ds_write_b128 v4, v[100:103] offset:7168
    v_pk_add_f32 v[104:105], v[24:25], 0
    v_pk_add_f32 v[106:107], v[26:27], 0
    v_pk_add_f32 v[108:109], v[32:33], 0
    v_pk_add_f32 v[110:111], v[34:35], 0
    v_pk_add_f32 v[112:113], v[56:57], 0
    v_pk_add_f32 v[114:115], v[58:59], 0
    v_pk_add_f32 v[116:117], v[64:65], 0
    v_pk_add_f32 v[118:119], v[66:67], 0
    v_pk_add_f32 v[120:121], v[88:89], 0
    v_pk_add_f32 v[122:123], v[90:91], 0
    v_pk_add_f32 v[124:125], v[96:97], 0
    v_pk_add_f32 v[126:127], v[98:99], 0
    s_branch g_epi_end_1
g_epi_4:
    ds_write_b128 v5, v[8:11] offset:12288
    ds_write_b128 v5, v[16:19] offset:13312
    ds_write_b128 v5, v[40:43] offset:14336
    ds_write_b128 v5, v[48:51] offset:15360
    ds_write_b128 v5, v[72:75] offset:16384
    ds_write_b128 v5, v[80:83] offset:17408
    ds_write_b128 v5, v[12:15] offset:24576
    ds_write_b128 v5, v[20:23] offset:25600
    ds_write_b128 v5, v[44:47] offset:26624
    ds_write_b128 v5, v[52:55] offset:27648
    ds_write_b128 v5, v[76:79] offset:28672
    ds_write_b128 v5, v[84:87] offset:29696
    ds_write_b128 v5, v[24:27] offset:36864
    ds_write_b128 v5, v[32:35] offset:37888
    ds_write_b128 v5, v[56:59] offset:38912
    ds_write_b128 v5, v[64:67] offset:39936
    ds_write_b128 v5, v[88:91] offset:40960
    ds_write_b128 v5, v[96:99] offset:41984
    v_pk_add_f32 v[104:105], v[28:29], 0
    v_pk_add_f32 v[106:107], v[30:31], 0
    v_pk_add_f32 v[108:109], v[36:37], 0
    v_pk_add_f32 v[110:111], v[38:39], 0
    v_pk_add_f32 v[112:113], v[60:61], 0
    v_pk_add_f32 v[114:115], v[62:63], 0
    v_pk_add_f32 v[116:117], v[68:69], 0
    v_pk_add_f32 v[118:119], v[70:71], 0
    v_pk_add_f32 v[120:121], v[92:93], 0
    v_pk_add_f32 v[122:123], v[94:95], 0
    v_pk_add_f32 v[124:125], v[100:101], 0
    v_pk_add_f32 v[126:127], v[102:103], 0
g_epi_end_1:
    s_waitcnt lgkmcnt(0)
    s_barrier
    s_mul_i32 s40, s34, 18432
    v_add_u32 v2, s40, v5
    ds_read_b128 v[8:11], v2 offset:0
    ds_read_b128 v[12:15], v2 offset:1024
    ds_read_b128 v[16:19], v2 offset:2048
    ds_read_b128 v[20:23], v2 offset:3072
    ds_read_b128 v[24:27], v2 offset:4096
    ds_read_b128 v[28:31], v2 offset:5120
    ds_read_b128 v[32:35], v2 offset:6144
    ds_read_b128 v[36:39], v2 offset:7168
    ds_read_b128 v[40:43], v2 offset:8192
    ds_read_b128 v[44:47], v2 offset:9216
    ds_read_b128 v[48:51], v2 offset:10240
    ds_read_b128 v[52:55], v2 offset:11264
    ds_read_b128 v[56:59], v2 offset:12288
    ds_read_b128 v[60:63], v2 offset:13312
    ds_read_b128 v[64:67], v2 offset:14336
    ds_read_b128 v[68:71], v2 offset:15360
    ds_read_b128 v[72:75], v2 offset:16384
    ds_read_b128 v[76:79], v2 offset:17408
    v_lshrrev_b32 v6, 4, v1
    v_and_b32 v6, 1, v6
    v_mul_u32_u24 v6, 24576, v6
    v_and_b32 v3, 15, v1
    v_lshrrev_b32 v4, 5, v1
    v_lshl_add_u32 v3, v4, 4, v3
    v_lshl_add_u32 v6, v3, 4, v6
    s_mul_i32 s40, s32, 98304
    s_lshr_b32 s41, s34, 1
    s_mul_i32 s41, s41, 49152
    s_add_u32 s40, s40, s41
    s_mul_i32 s41, s33, 3072
    s_add_u32 s40, s40, s41
    s_and_b32 s41, s34, 1
    s_lshl_b32 s41, s41, 9
    s_add_u32 s40, s40, s41
    s_add_u32 s40, s40, 11534336
    s_waitcnt vmcnt(0)
    v_lshlrev_b32 v180, 16, v196
    v_lshlrev_b32 v80, 16, v184
    v_and_b32 v81, 0xffff0000, v184
    v_lshlrev_b32 v82, 16, v185
    v_and_b32 v83, 0xffff0000, v185
    v_lshlrev_b32 v84, 16, v186
    v_and_b32 v85, 0xffff0000, v186
    v_lshlrev_b32 v86, 16, v187
    v_and_b32 v87, 0xffff0000, v187
    v_lshlrev_b32 v88, 16, v188
    v_and_b32 v89, 0xffff0000, v188
    v_lshlrev_b32 v90, 16, v189
    v_and_b32 v91, 0xffff0000, v189
    v_lshlrev_b32 v92, 16, v190
    v_and_b32 v93, 0xffff0000, v190
    v_lshlrev_b32 v94, 16, v191
    v_and_b32 v95, 0xffff0000, v191
    v_lshlrev_b32 v96, 16, v192
    v_and_b32 v97, 0xffff0000, v192
    v_lshlrev_b32 v98, 16, v193
    v_and_b32 v99, 0xffff0000, v193
    v_lshlrev_b32 v100, 16, v194
    v_and_b32 v101, 0xffff0000, v194
    v_lshlrev_b32 v102, 16, v195
    v_and_b32 v103, 0xffff0000, v195
    s_waitcnt lgkmcnt(12)
    v_pk_add_f32 v[104:105], v[104:105], v[8:9]
    v_pk_add_f32 v[106:107], v[106:107], v[10:11]
    v_pk_add_f32 v[108:109], v[108:109], v[12:13]
    v_pk_add_f32 v[110:111], v[110:111], v[14:15]
    v_pk_add_f32 v[112:113], v[112:113], v[16:17]
    v_pk_add_f32 v[114:115], v[114:115], v[18:19]
    v_pk_add_f32 v[116:117], v[116:117], v[20:21]
    v_pk_add_f32 v[118:119], v[118:119], v[22:23]
    v_pk_add_f32 v[120:121], v[120:121], v[24:25]
    v_pk_add_f32 v[122:123], v[122:123], v[26:27]
    v_pk_add_f32 v[124:125], v[124:125], v[28:29]
    v_pk_add_f32 v[126:127], v[126:127], v[30:31]
    s_waitcnt lgkmcnt(6)
    v_pk_add_f32 v[104:105], v[104:105], v[32:33]
    v_pk_add_f32 v[106:107], v[106:107], v[34:35]
    v_pk_add_f32 v[108:109], v[108:109], v[36:37]
    v_pk_add_f32 v[110:111], v[110:111], v[38:39]
    v_pk_add_f32 v[112:113], v[112:113], v[40:41]
    v_pk_add_f32 v[114:115], v[114:115], v[42:43]
    v_pk_add_f32 v[116:117], v[116:117], v[44:45]
    v_pk_add_f32 v[118:119], v[118:119], v[46:47]
    v_pk_add_f32 v[120:121], v[120:121], v[48:49]
    v_pk_add_f32 v[122:123], v[122:123], v[50:51]
    v_pk_add_f32 v[124:125], v[124:125], v[52:53]
    v_pk_add_f32 v[126:127], v[126:127], v[54:55]
    s_waitcnt lgkmcnt(0)
    v_pk_add_f32 v[104:105], v[104:105], v[56:57]
    v_pk_add_f32 v[106:107], v[106:107], v[58:59]
    v_pk_add_f32 v[108:109], v[108:109], v[60:61]
    v_pk_add_f32 v[110:111], v[110:111], v[62:63]
    v_pk_add_f32 v[112:113], v[112:113], v[64:65]
    v_pk_add_f32 v[114:115], v[114:115], v[66:67]
    v_pk_add_f32 v[116:117], v[116:117], v[68:69]
    v_pk_add_f32 v[118:119], v[118:119], v[70:71]
    v_pk_add_f32 v[120:121], v[120:121], v[72:73]
    v_pk_add_f32 v[122:123], v[122:123], v[74:75]
    v_pk_add_f32 v[124:125], v[124:125], v[76:77]
    v_pk_add_f32 v[126:127], v[126:127], v[78:79]
    v_pk_add_f32 v[104:105], v[104:105], v[180:181] op_sel_hi:[1,0]
    v_pk_add_f32 v[106:107], v[106:107], v[180:181] op_sel_hi:[1,0]
    v_pk_add_f32 v[108:109], v[108:109], v[180:181] op_sel_hi:[1,0]
    v_pk_add_f32 v[110:111], v[110:111], v[180:181] op_sel_hi:[1,0]
    v_pk_add_f32 v[112:113], v[112:113], v[180:181] op_sel_hi:[1,0]
    v_pk_add_f32 v[114:115], v[114:115], v[180:181] op_sel_hi:[1,0]
    v_pk_add_f32 v[116:117], v[116:117], v[180:181] op_sel_hi:[1,0]
    v_pk_add_f32 v[118:119], v[118:119], v[180:181] op_sel_hi:[1,0]
    v_pk_add_f32 v[120:121], v[120:121], v[180:181] op_sel_hi:[1,0]
    v_pk_add_f32 v[122:123], v[122:123], v[180:181] op_sel_hi:[1,0]
    v_pk_add_f32 v[124:125], v[124:125], v[180:181] op_sel_hi:[1,0]
    v_pk_add_f32 v[126:127], v[126:127], v[180:181] op_sel_hi:[1,0]
    v_pk_mul_f32 v[104:105], v[104:105], v[80:81]
    v_pk_mul_f32 v[106:107], v[106:107], v[82:83]
    v_pk_mul_f32 v[108:109], v[108:109], v[84:85]
    v_pk_mul_f32 v[110:111], v[110:111], v[86:87]
    v_pk_mul_f32 v[112:113], v[112:113], v[88:89]
    v_pk_mul_f32 v[114:115], v[114:115], v[90:91]
    v_pk_mul_f32 v[116:117], v[116:117], v[92:93]
    v_pk_mul_f32 v[118:119], v[118:119], v[94:95]
    v_pk_mul_f32 v[120:121], v[120:121], v[96:97]
    v_pk_mul_f32 v[122:123], v[122:123], v[98:99]
    v_pk_mul_f32 v[124:125], v[124:125], v[100:101]
    v_pk_mul_f32 v[126:127], v[126:127], v[102:103]
    v_cvt_pk_bf16_f32 v8, v104, v105
    v_cvt_pk_bf16_f32 v9, v106, v107
    v_cvt_pk_bf16_f32 v10, v108, v109
    v_cvt_pk_bf16_f32 v11, v110, v111
    buffer_store_dwordx4 v[8:11], v6, s[8:11], s40 offen offset:0 sc1
    v_cvt_pk_bf16_f32 v12, v112, v113
    v_cvt_pk_bf16_f32 v13, v114, v115
    v_cvt_pk_bf16_f32 v14, v116, v117
    v_cvt_pk_bf16_f32 v15, v118, v119
    buffer_store_dwordx4 v[12:15], v6, s[8:11], s40 offen offset:1024 sc1
    v_cvt_pk_bf16_f32 v16, v120, v121
    v_cvt_pk_bf16_f32 v17, v122, v123
    v_cvt_pk_bf16_f32 v18, v124, v125
    v_cvt_pk_bf16_f32 v19, v126, v127
    buffer_store_dwordx4 v[16:19], v6, s[8:11], s40 offen offset:2048 sc1
    s_endpgm
k2_kernel_conv:
    s_load_dwordx2 s[4:5], s[0:1], 32
    s_load_dwordx2 s[8:9], s[0:1], 104
    s_load_dwordx2 s[12:13], s[0:1], 40
    s_load_dwordx2 s[16:17], s[0:1], 64
    s_load_dwordx2 s[20:21], s[0:1], 80
    v_lshrrev_b32 v3, 6, v0
    v_and_b32 v1, 63, v0
    v_readfirstlane_b32 s34, v3
    s_mov_b32 s6, 2621440
    s_mov_b32 s7, 0x20000
    s_mov_b32 s10, 15990784
    s_mov_b32 s11, 0x20000
    s_mov_b32 s14, 1280
    s_mov_b32 s15, 0x20000
    s_mov_b32 s18, 8388608
    s_mov_b32 s19, 0x20000
    s_mov_b32 s22, 983040
    s_mov_b32 s23, 0x20000
    s_mov_b32 s32, s2
    v_lshlrev_b32 v2, 4, v0
    v_subrev_u32 v47, 16, v2
    s_mov_b32 s56, s2
    s_add_u32 s57, s2, 256
    s_lshr_b32 s58, s2, 1
    s_add_u32 s58, s58, 512
    s_waitcnt lgkmcnt(0)
    s_lshl_b32 s40, s56, 12
    buffer_load_dwordx4 v[12:15], v2, s[4:7], s40 offen
    buffer_load_dwordx4 v[8:11], v47, s[4:7], s40 offen
    s_add_u32 s40, s40, 6291456
    buffer_load_dwordx4 v[32:35], v2, s[8:11], s40 offen
    s_lshl_b32 s40, s56, 1
    v_mov_b32 v3, 0
    buffer_load_ushort v44, v3, s[12:15], s40 offen
    s_lshr_b32 s47, s2, 3
    s_lshl_b32 s47, s47, 2
    s_add_u32 s47, s47, s34
    s_mul_i32 s40, s47, 12
    v_add_u32 v3, s40, v1
    v_mul_u32_u24 v4, 43691, v3
    v_lshrrev_b32 v4, 22, v4
    v_mul_u32_u24 v5, 96, v4
    v_sub_u32 v3, v3, v5
    v_mul_u32_u24 v4, 98304, v4
    v_lshl_add_u32 v49, v3, 7, v4
    s_and_b32 s40, s2, 7
    s_lshr_b32 s52, s40, 1
    s_lshl_b32 s52, s52, 21
    s_and_b32 s53, s40, 1
    s_mul_i32 s53, s53, 1572864
    s_add_u32 s53, s53, 0
    s_lshl_b32 s40, s47, 4
    v_add_u32 v3, s40, v1
    v_lshrrev_b32 v4, 2, v3
    v_lshlrev_b32 v4, 12, v4
    v_and_b32 v3, 3, v3
    v_lshl_add_u32 v48, v3, 10, v4
    v_mov_b32 v52, 0
    v_mov_b32 v53, 0
    v_mov_b32 v54, 0
    v_mov_b32 v55, 0
    v_mul_u32_u24 v3, 4160, v0
    v_cmp_gt_u32 vcc, 64, v0
    s_nop 0
    s_and_saveexec_b64 s[50:51], vcc
    s_cbranch_execz c_z_6
    v_subrev_u32 v4, -32768, v2
    v_cmp_gt_u32 vcc, 8, v0
    s_nop 1
    v_cndmask_b32 v4, v4, v3, vcc
    v_add_u32 v5, -8, v0
    v_cmp_lt_u32 vcc, 23, v5
    s_nop 0
    s_and_b64 exec, exec, vcc
    ds_write_b128 v4, v[52:55]
c_z_6:
    s_mov_b64 exec, s[50:51]
    v_add_u32 v56, 16, v2
    v_add_u32 v57, 33792, v2
    v_and_b32 v3, 7, v1
    v_mul_u32_u24 v3, 4160, v3
    v_bfe_u32 v4, v1, 3, 1
    v_lshrrev_b32 v5, 4, v1
    v_sub_u32 v4, v4, v5
    v_add_u32 v4, 3, v4
    v_lshl_add_u32 v58, v4, 4, v3
    v_and_b32 v3, 15, v1
    v_lshl_add_u32 v3, v3, 1, v5
    v_lshlrev_b32 v59, 4, v3
    v_add_u32 v59, 33280, v59
    v_and_b32 v3, 15, v1
    v_lshlrev_b32 v4, 3, v5
    v_sub_u32 v4, v4, v3
    v_add_u32 v4, -9, v4
    v_mov_b32 v64, 0xffff
    v_mov_b32 v65, 0xffff0000
    v_cmp_eq_u32 vcc, 0, v4
    s_nop 1
    v_cndmask_b32 v60, 0, v64, vcc
    v_cmp_eq_u32 vcc, 1, v4
    s_nop 1
    v_cndmask_b32 v60, v60, v65, vcc
    v_cmp_eq_u32 vcc, 2, v4
    s_nop 1
    v_cndmask_b32 v61, 0, v64, vcc
    v_cmp_eq_u32 vcc, 3, v4
    s_nop 1
    v_cndmask_b32 v61, v61, v65, vcc
    v_cmp_eq_u32 vcc, 4, v4
    s_nop 1
    v_cndmask_b32 v62, 0, v64, vcc
    v_cmp_eq_u32 vcc, 5, v4
    s_nop 1
    v_cndmask_b32 v62, v62, v65, vcc
    v_cmp_eq_u32 vcc, 6, v4
    s_nop 1
    v_cndmask_b32 v63, 0, v64, vcc
    v_cmp_eq_u32 vcc, 7, v4
    s_nop 1
    v_cndmask_b32 v63, v63, v65, vcc
    v_and_b32 v3, 15, v1
    v_lshlrev_b32 v3, 6, v3
    v_lshl_add_u32 v3, v5, 4, v3
    s_lshl_b32 s40, s34, 13
    s_add_u32 s40, s40, 37888
    v_add_u32 v66, s40, v3
    v_lshlrev_b32 v67, 5, v0
    v_add_u32 v67, 37888, v67
    s_waitcnt vmcnt(0)
    v_cmp_ne_u32 vcc, 0, v0
    s_nop 1
    v_cndmask_b32 v8, 0, v8, vcc
    v_cndmask_b32 v9, 0, v9, vcc
    v_cndmask_b32 v10, 0, v10, vcc
    v_cndmask_b32 v11, 0, v11, vcc
    v_alignbit_b32 v176, v9, v8, 16
    v_alignbit_b32 v177, v10, v9, 16
    v_alignbit_b32 v178, v11, v10, 16
    v_alignbit_b32 v179, v12, v11, 16
    v_alignbit_b32 v180, v13, v12, 16
    v_alignbit_b32 v181, v14, v13, 16
    v_alignbit_b32 v182, v15, v14, 16
    ds_write_b128 v56, v[176:179] offset:0
    v_mov_b32 v184, v9
    v_mov_b32 v185, v10
    v_mov_b32 v186, v11
    v_mov_b32 v187, v12
    ds_write_b128 v56, v[184:187] offset:4160
    s_nop 1
    v_mov_b32 v184, v177
    v_mov_b32 v185, v178
    v_mov_b32 v186, v179
    v_mov_b32 v187, v180
    ds_write_b128 v56, v[184:187] offset:8320
    s_nop 1
    ds_write_b128 v56, v[10:13] offset:12480
    ds_write_b128 v56, v[178:181] offset:16640
    v_mov_b32 v184, v11
    v_mov_b32 v185, v12
    v_mov_b32 v186, v13
    v_mov_b32 v187, v14
    ds_write_b128 v56, v[184:187] offset:20800
    s_nop 1
    v_mov_b32 v184, v179
    v_mov_b32 v185, v180
    v_mov_b32 v186, v181
    v_mov_b32 v187, v182
    ds_write_b128 v56, v[184:187] offset:24960
    s_nop 1
    ds_write_b128 v56, v[12:15] offset:29120
    ds_write_b128 v57, v[32:35]
    v_lshlrev_b32 v3, 16, v44
    v_or_b32 v3, v3, v44
    v_and_b32 v188, v60, v3
    v_and_b32 v189, v61, v3
    v_and_b32 v190, v62, v3
    v_and_b32 v191, v63, v3
    s_cmp_ge_u32 s2, 192
    s_cbranch_scc1 c_wj_7
    s_mul_i32 s40, s2, 2731
    s_lshr_b32 s40, s40, 16
    s_mul_i32 s41, s40, 24
    s_sub_u32 s41, s2, s41
    s_mul_i32 s41, s41, 40960
    s_mul_i32 s40, s40, 160
    s_add_u32 s54, s40, s41
    v_mov_b32 v3, v0
    v_mul_u32_u24 v4, 6554, v3
    v_lshrrev_b32 v4, 16, v4
    v_mul_u32_u24 v5, 10, v4
    v_sub_u32 v3, v3, v5
    v_lshlrev_b32 v3, 4, v3
    v_mul_u32_u24 v4, 1280, v4
    v_add_u32 v3, v3, v4
    s_lshl_b32 s40, s34, 10
    s_add_u32 m0, s40, 70656
    s_nop 0
    buffer_load_dwordx4 v3, s[20:23], s54 offen lds
    s_cmp_lg_u32 s34, 0
    s_cbranch_scc1 c_wj2_8
    v_add_u32 v3, 256, v1
    v_mul_u32_u24 v4, 6554, v3
    v_lshrrev_b32 v4, 16, v4
    v_mul_u32_u24 v5, 10, v4
    v_sub_u32 v3, v3, v5
    v_lshlrev_b32 v3, 4, v3
    v_mul_u32_u24 v4, 1280, v4
    v_add_u32 v3, v3, v4
    s_mov_b32 m0, 74752
    s_nop 0
    buffer_load_dwordx4 v3, s[20:23], s54 offen lds
c_wj2_8:
c_wj_7:
    s_lshl_b32 s40, s57, 12
    buffer_load_dwordx4 v[20:23], v2, s[4:7], s40 offen
    buffer_load_dwordx4 v[16:19], v47, s[4:7], s40 offen
    s_add_u32 s40, s40, 6291456
    buffer_load_dwordx4 v[36:39], v2, s[8:11], s40 offen
    s_lshl_b32 s40, s57, 1
    v_mov_b32 v3, 0
    buffer_load_ushort v45, v3, s[12:15], s40 offen
    s_lshl_b32 s40, s58, 12
    buffer_load_dwordx4 v[28:31], v2, s[4:7], s40 offen
    buffer_load_dwordx4 v[24:27], v47, s[4:7], s40 offen
    s_add_u32 s40, s40, 6291456
    buffer_load_dwordx4 v[40:43], v2, s[8:11], s40 offen
    s_lshl_b32 s40, s58, 1
    v_mov_b32 v3, 0
    buffer_load_ushort v46, v3, s[12:15], s40 offen
    s_waitcnt lgkmcnt(0)
    s_barrier
    s_cmp_lg_u32 s34, 0
    s_cbranch_scc1 c_pw_10
    ds_read_b128 v[100:103], v58 offset:0
    ds_read_b128 v[112:115], v59 offset:480
    ds_read_b128 v[116:119], v59 offset:992
    ds_read_b128 v[120:123], v59 offset:1504
    ds_read_b128 v[124:127], v59 offset:2016
    ds_read_b128 v[128:131], v59 offset:2528
    ds_read_b128 v[132:135], v59 offset:3040
    ds_read_b128 v[136:139], v59 offset:3552
    ds_read_b128 v[140:143], v59 offset:4064
    ds_read_b128 v[104:107], v58 offset:512
    ds_read_b128 v[108:111], v58 offset:1024
    s_waitcnt lgkmcnt(2)
    v_mfma_f32_16x16x32_bf16 v[96:99], v[100:103], v[140:143], 0
    v_mfma_f32_16x16x32_bf16 v[92:95], v[100:103], v[136:139], 0
    v_mfma_f32_16x16x32_bf16 v[88:91], v[100:103], v[132:135], 0
    v_mfma_f32_16x16x32_bf16 v[84:87], v[100:103], v[128:131], 0
    v_mfma_f32_16x16x32_bf16 v[80:83], v[100:103], v[124:127], 0
    v_mfma_f32_16x16x32_bf16 v[76:79], v[100:103], v[120:123], 0
    v_mfma_f32_16x16x32_bf16 v[72:75], v[100:103], v[116:119], 0
    v_mfma_f32_16x16x32_bf16 v[68:71], v[100:103], v[112:115], 0
    v_mfma_f32_16x16x32_bf16 v[68:71], v[188:191], v[112:115], v[68:71]
    v_mfma_f32_16x16x32_bf16 v[72:75], v[188:191], v[116:119], v[72:75]
    v_mfma_f32_16x16x32_bf16 v[76:79], v[188:191], v[120:123], v[76:79]
    v_mfma_f32_16x16x32_bf16 v[80:83], v[188:191], v[124:127], v[80:83]
    v_mfma_f32_16x16x32_bf16 v[84:87], v[188:191], v[128:131], v[84:87]
    v_mfma_f32_16x16x32_bf16 v[88:91], v[188:191], v[132:135], v[88:91]
    v_mfma_f32_16x16x32_bf16 v[92:95], v[188:191], v[136:139], v[92:95]
    v_mfma_f32_16x16x32_bf16 v[96:99], v[188:191], v[140:143], v[96:99]
    ds_read_b128 v[100:103], v58 offset:1536
    s_waitcnt lgkmcnt(2)
    v_mfma_f32_16x16x32_bf16 v[96:99], v[104:107], v[136:139], v[96:99]
    v_mfma_f32_16x16x32_bf16 v[92:95], v[104:107], v[132:135], v[92:95]
    v_mfma_f32_16x16x32_bf16 v[88:91], v[104:107], v[128:131], v[88:91]
    v_mfma_f32_16x16x32_bf16 v[84:87], v[104:107], v[124:127], v[84:87]
    v_mfma_f32_16x16x32_bf16 v[80:83], v[104:107], v[120:123], v[80:83]
    v_mfma_f32_16x16x32_bf16 v[76:79], v[104:107], v[116:119], v[76:79]
    v_mfma_f32_16x16x32_bf16 v[72:75], v[104:107], v[112:115], v[72:75]
    ds_read_b128 v[104:107], v58 offset:2048
    ds_read_b128 v[144:147], v59 offset:416
    ds_read_b128 v[148:151], v59 offset:928
    ds_read_b128 v[152:155], v59 offset:1440
    ds_read_b128 v[156:159], v59 offset:1952
    ds_read_b128 v[160:163], v59 offset:2464
    ds_read_b128 v[164:167], v59 offset:2976
    ds_read_b128 v[168:171], v59 offset:3488
    ds_read_b128 v[172:175], v59 offset:4000
    s_waitcnt lgkmcnt(10)
    v_mfma_f32_16x16x32_bf16 v[96:99], v[108:111], v[132:135], v[96:99]
    v_mfma_f32_16x16x32_bf16 v[92:95], v[108:111], v[128:131], v[92:95]
    v_mfma_f32_16x16x32_bf16 v[88:91], v[108:111], v[124:127], v[88:91]
    v_mfma_f32_16x16x32_bf16 v[84:87], v[108:111], v[120:123], v[84:87]
    v_mfma_f32_16x16x32_bf16 v[80:83], v[108:111], v[116:119], v[80:83]
    v_mfma_f32_16x16x32_bf16 v[76:79], v[108:111], v[112:115], v[76:79]
    ds_read_b128 v[108:111], v58 offset:2560
    s_waitcnt lgkmcnt(10)
    v_mfma_f32_16x16x32_bf16 v[96:99], v[100:103], v[128:131], v[96:99]
    v_mfma_f32_16x16x32_bf16 v[92:95], v[100:103], v[124:127], v[92:95]
    v_mfma_f32_16x16x32_bf16 v[88:91], v[100:103], v[120:123], v[88:91]
    v_mfma_f32_16x16x32_bf16 v[84:87], v[100:103], v[116:119], v[84:87]
    v_mfma_f32_16x16x32_bf16 v[80:83], v[100:103], v[112:115], v[80:83]
    ds_read_b128 v[100:103], v58 offset:3072
    s_waitcnt lgkmcnt(10)
    v_mfma_f32_16x16x32_bf16 v[96:99], v[104:107], v[124:127], v[96:99]
    v_mfma_f32_16x16x32_bf16 v[92:95], v[104:107], v[120:123], v[92:95]
    v_mfma_f32_16x16x32_bf16 v[88:91], v[104:107], v[116:119], v[88:91]
    v_mfma_f32_16x16x32_bf16 v[84:87], v[104:107], v[112:115], v[84:87]
    ds_read_b128 v[104:107], v58 offset:3584
    s_waitcnt lgkmcnt(2)
    v_mfma_f32_16x16x32_bf16 v[96:99], v[108:111], v[120:123], v[96:99]
    v_mfma_f32_16x16x32_bf16 v[92:95], v[108:111], v[116:119], v[92:95]
    v_mfma_f32_16x16x32_bf16 v[88:91], v[108:111], v[112:115], v[88:91]
    ds_read_b128 v[108:111], v58 offset:64
    s_waitcnt lgkmcnt(2)
    v_mfma_f32_16x16x32_bf16 v[96:99], v[100:103], v[116:119], v[96:99]
    v_mfma_f32_16x16x32_bf16 v[92:95], v[100:103], v[112:115], v[92:95]
    ds_read_b128 v[100:103], v58 offset:576
    s_waitcnt lgkmcnt(2)
    v_mfma_f32_16x16x32_bf16 v[96:99], v[104:107], v[112:115], v[96:99]
    ds_read_b128 v[104:107], v58 offset:1088
    s_waitcnt lgkmcnt(2)
    v_mfma_f32_16x16x32_bf16 v[96:99], v[108:111], v[172:175], v[96:99]
    v_mfma_f32_16x16x32_bf16 v[92:95], v[108:111], v[168:171], v[92:95]
    v_mfma_f32_16x16x32_bf16 v[88:91], v[108:111], v[164:167], v[88:91]
    v_mfma_f32_16x16x32_bf16 v[84:87], v[108:111], v[160:163], v[84:87]
    v_mfma_f32_16x16x32_bf16 v[80:83], v[108:111], v[156:159], v[80:83]
    v_mfma_f32_16x16x32_bf16 v[76:79], v[108:111], v[152:155], v[76:79]
    v_mfma_f32_16x16x32_bf16 v[72:75], v[108:111], v[148:151], v[72:75]
    v_mfma_f32_16x16x32_bf16 v[68:71], v[108:111], v[144:147], v[68:71]
    ds_read_b128 v[108:111], v58 offset:1600
    s_waitcnt lgkmcnt(2)
    v_mfma_f32_16x16x32_bf16 v[96:99], v[100:103], v[168:171], v[96:99]
    v_mfma_f32_16x16x32_bf16 v[92:95], v[100:103], v[164:167], v[92:95]
    v_mfma_f32_16x16x32_bf16 v[88:91], v[100:103], v[160:163], v[88:91]
    v_mfma_f32_16x16x32_bf16 v[84:87], v[100:103], v[156:159], v[84:87]
    v_mfma_f32_16x16x32_bf16 v[80:83], v[100:103], v[152:155], v[80:83]
    v_mfma_f32_16x16x32_bf16 v[76:79], v[100:103], v[148:151], v[76:79]
    v_mfma_f32_16x16x32_bf16 v[72:75], v[100:103], v[144:147], v[72:75]
    ds_read_b128 v[100:103], v58 offset:2112
    s_waitcnt lgkmcnt(2)
    v_mfma_f32_16x16x32_bf16 v[96:99], v[104:107], v[164:167], v[96:99]
    v_mfma_f32_16x16x32_bf16 v[92:95], v[104:107], v[160:163], v[92:95]
    v_mfma_f32_16x16x32_bf16 v[88:91], v[104:107], v[156:159], v[88:91]
    v_mfma_f32_16x16x32_bf16 v[84:87], v[104:107], v[152:155], v[84:87]
    v_mfma_f32_16x16x32_bf16 v[80:83], v[104:107], v[148:151], v[80:83]
    v_mfma_f32_16x16x32_bf16 v[76:79], v[104:107], v[144:147], v[76:79]
    ds_read_b128 v[104:107], v58 offset:2624
    s_waitcnt lgkmcnt(2)
    v_mfma_f32_16x16x32_bf16 v[96:99], v[108:111], v[160:163], v[96:99]
    v_mfma_f32_16x16x32_bf16 v[92:95], v[108:111], v[156:159], v[92:95]
    v_mfma_f32_16x16x32_bf16 v[88:91], v[108:111], v[152:155], v[88:91]
    v_mfma_f32_16x16x32_bf16 v[84:87], v[108:111], v[148:151], v[84:87]
    v_mfma_f32_16x16x32_bf16 v[80:83], v[108:111], v[144:147], v[80:83]
    ds_read_b128 v[108:111], v58 offset:3136
    s_waitcnt lgkmcnt(2)
    v_mfma_f32_16x16x32_bf16 v[96:99], v[100:103], v[156:159], v[96:99]
    v_mfma_f32_16x16x32_bf16 v[92:95], v[100:103], v[152:155], v[92:95]
    v_mfma_f32_16x16x32_bf16 v[88:91], v[100:103], v[148:151], v[88:91]
    v_mfma_f32_16x16x32_bf16 v[84:87], v[100:103], v[144:147], v[84:87]
    ds_read_b128 v[100:103], v58 offset:3648
    s_waitcnt lgkmcnt(2)
    v_mfma_f32_16x16x32_bf16 v[96:99], v[104:107], v[152:155], v[96:99]
    v_mfma_f32_16x16x32_bf16 v[92:95], v[104:107], v[148:151], v[92:95]
    v_mfma_f32_16x16x32_bf16 v[88:91], v[104:107], v[144:147], v[88:91]
    s_waitcnt lgkmcnt(1)
    v_mfma_f32_16x16x32_bf16 v[96:99], v[108:111], v[148:151], v[96:99]
    v_mfma_f32_16x16x32_bf16 v[92:95], v[108:111], v[144:147], v[92:95]
    s_waitcnt lgkmcnt(0)
    v_mfma_f32_16x16x32_bf16 v[96:99], v[100:103], v[144:147], v[96:99]
    ds_write_b128 v66, v[68:71] offset:0
    ds_write_b128 v66, v[72:75] offset:1024
    ds_write_b128 v66, v[76:79] offset:2048
    ds_write_b128 v66, v[80:83] offset:3072
    ds_write_b128 v66, v[84:87] offset:4096
    ds_write_b128 v66, v[88:91] offset:5120
    ds_write_b128 v66, v[92:95] offset:6144
    s_nop 0
    ds_write_b128 v66, v[96:99] offset:7168
    s_branch c_pw_end_9
c_pw_10:
    s_cmp_lg_u32 s34, 1
    s_cbranch_scc1 c_pw_11
    ds_read_b128 v[100:103], v58 offset:128
    ds_read_b128 v[112:115], v59 offset:352
    ds_read_b128 v[116:119], v59 offset:864
    ds_read_b128 v[120:123], v59 offset:1376
    ds_read_b128 v[124:127], v59 offset:1888
    ds_read_b128 v[128:131], v59 offset:2400
    ds_read_b128 v[132:135], v59 offset:2912
    ds_read_b128 v[136:139], v59 offset:3424
    ds_read_b128 v[140:143], v59 offset:3936
    ds_read_b128 v[104:107], v58 offset:640
    ds_read_b128 v[108:111], v58 offset:1152
    s_waitcnt lgkmcnt(2)
    v_mfma_f32_16x16x32_bf16 v[96:99], v[100:103], v[140:143], 0
    v_mfma_f32_16x16x32_bf16 v[92:95], v[100:103], v[136:139], 0
    v_mfma_f32_16x16x32_bf16 v[88:91], v[100:103], v[132:135], 0
    v_mfma_f32_16x16x32_bf16 v[84:87], v[100:103], v[128:131], 0
    v_mfma_f32_16x16x32_bf16 v[80:83], v[100:103], v[124:127], 0
    v_mfma_f32_16x16x32_bf16 v[76:79], v[100:103], v[120:123], 0
    v_mfma_f32_16x16x32_bf16 v[72:75], v[100:103], v[116:119], 0
    v_mfma_f32_16x16x32_bf16 v[68:71], v[100:103], v[112:115], 0
    ds_read_b128 v[100:103], v58 offset:1664
    s_waitcnt lgkmcnt(2)
    v_mfma_f32_16x16x32_bf16 v[96:99], v[104:107], v[136:139], v[96:99]
    v_mfma_f32_16x16x32_bf16 v[92:95], v[104:107], v[132:135], v[92:95]
    v_mfma_f32_16x16x32_bf16 v[88:91], v[104:107], v[128:131], v[88:91]
    v_mfma_f32_16x16x32_bf16 v[84:87], v[104:107], v[124:127], v[84:87]
    v_mfma_f32_16x16x32_bf16 v[80:83], v[104:107], v[120:123], v[80:83]
    v_mfma_f32_16x16x32_bf16 v[76:79], v[104:107], v[116:119], v[76:79]
    v_mfma_f32_16x16x32_bf16 v[72:75], v[104:107], v[112:115], v[72:75]
    ds_read_b128 v[104:107], v58 offset:2176
    ds_read_b128 v[144:147], v59 offset:288
    ds_read_b128 v[148:151], v59 offset:800
    ds_read_b128 v[152:155], v59 offset:1312
    ds_read_b128 v[156:159], v59 offset:1824
    ds_read_b128 v[160:163], v59 offset:2336
    ds_read_b128 v[164:167], v59 offset:2848
    ds_read_b128 v[168:171], v59 offset:3360
    ds_read_b128 v[172:175], v59 offset:3872
    s_waitcnt lgkmcnt(10)
    v_mfma_f32_16x16x32_bf16 v[96:99], v[108:111], v[132:135], v[96:99]
    v_mfma_f32_16x16x32_bf16 v[92:95], v[108:111], v[128:131], v[92:95]
    v_mfma_f32_16x16x32_bf16 v[88:91], v[108:111], v[124:127], v[88:91]
    v_mfma_f32_16x16x32_bf16 v[84:87], v[108:111], v[120:123], v[84:87]
    v_mfma_f32_16x16x32_bf16 v[80:83], v[108:111], v[116:119], v[80:83]
    v_mfma_f32_16x16x32_bf16 v[76:79], v[108:111], v[112:115], v[76:79]
    ds_read_b128 v[108:111], v58 offset:2688
    s_waitcnt lgkmcnt(10)
    v_mfma_f32_16x16x32_bf16 v[96:99], v[100:103], v[128:131], v[96:99]
    v_mfma_f32_16x16x32_bf16 v[92:95], v[100:103], v[124:127], v[92:95]
    v_mfma_f32_16x16x32_bf16 v[88:91], v[100:103], v[120:123], v[88:91]
    v_mfma_f32_16x16x32_bf16 v[84:87], v[100:103], v[116:119], v[84:87]
    v_mfma_f32_16x16x32_bf16 v[80:83], v[100:103], v[112:115], v[80:83]
    ds_read_b128 v[100:103], v58 offset:3200
    s_waitcnt lgkmcnt(10)
    v_mfma_f32_16x16x32_bf16 v[96:99], v[104:107], v[124:127], v[96:99]
    v_mfma_f32_16x16x32_bf16 v[92:95], v[104:107], v[120:123], v[92:95]
    v_mfma_f32_16x16x32_bf16 v[88:91], v[104:107], v[116:119], v[88:91]
    v_mfma_f32_16x16x32_bf16 v[84:87], v[104:107], v[112:115], v[84:87]
    ds_read_b128 v[104:107], v58 offset:3712
    s_waitcnt lgkmcnt(2)
    v_mfma_f32_16x16x32_bf16 v[96:99], v[108:111], v[120:123], v[96:99]
    v_mfma_f32_16x16x32_bf16 v[92:95], v[108:111], v[116:119], v[92:95]
    v_mfma_f32_16x16x32_bf16 v[88:91], v[108:111], v[112:115], v[88:91]
    ds_read_b128 v[108:111], v58 offset:192
    s_waitcnt lgkmcnt(2)
    v_mfma_f32_16x16x32_bf16 v[96:99], v[100:103], v[116:119], v[96:99]
    v_mfma_f32_16x16x32_bf16 v[92:95], v[100:103], v[112:115], v[92:95]
    ds_read_b128 v[100:103], v58 offset:704
    s_waitcnt lgkmcnt(2)
    v_mfma_f32_16x16x32_bf16 v[96:99], v[104:107], v[112:115], v[96:99]
    ds_read_b128 v[104:107], v58 offset:1216
    s_waitcnt lgkmcnt(2)
    v_mfma_f32_16x16x32_bf16 v[96:99], v[108:111], v[172:175], v[96:99]
    v_mfma_f32_16x16x32_bf16 v[92:95], v[108:111], v[168:171], v[92:95]
    v_mfma_f32_16x16x32_bf16 v[88:91], v[108:111], v[164:167], v[88:91]
    v_mfma_f32_16x16x32_bf16 v[84:87], v[108:111], v[160:163], v[84:87]
    v_mfma_f32_16x16x32_bf16 v[80:83], v[108:111], v[156:159], v[80:83]
    v_mfma_f32_16x16x32_bf16 v[76:79], v[108:111], v[152:155], v[76:79]
    v_mfma_f32_16x16x32_bf16 v[72:75], v[108:111], v[148:151], v[72:75]
    v_mfma_f32_16x16x32_bf16 v[68:71], v[108:111], v[144:147], v[68:71]
    ds_read_b128 v[108:111], v58 offset:1728
    s_waitcnt lgkmcnt(2)
    v_mfma_f32_16x16x32_bf16 v[96:99], v[100:103], v[168:171], v[96:99]
    v_mfma_f32_16x16x32_bf16 v[92:95], v[100:103], v[164:167], v[92:95]
    v_mfma_f32_16x16x32_bf16 v[88:91], v[100:103], v[160:163], v[88:91]
    v_mfma_f32_16x16x32_bf16 v[84:87], v[100:103], v[156:159], v[84:87]
    v_mfma_f32_16x16x32_bf16 v[80:83], v[100:103], v[152:155], v[80:83]
    v_mfma_f32_16x16x32_bf16 v[76:79], v[100:103], v[148:151], v[76:79]
    v_mfma_f32_16x16x32_bf16 v[72:75], v[100:103], v[144:147], v[72:75]
    ds_read_b128 v[100:103], v58 offset:2240
    s_waitcnt lgkmcnt(2)
    v_mfma_f32_16x16x32_bf16 v[96:99], v[104:107], v[164:167], v[96:99]
    v_mfma_f32_16x16x32_bf16 v[92:95], v[104:107], v[160:163], v[92:95]
    v_mfma_f32_16x16x32_bf16 v[88:91], v[104:107], v[156:159], v[88:91]
    v_mfma_f32_16x16x32_bf16 v[84:87], v[104:107], v[152:155], v[84:87]
    v_mfma_f32_16x16x32_bf16 v[80:83], v[104:107], v[148:151], v[80:83]
    v_mfma_f32_16x16x32_bf16 v[76:79], v[104:107], v[144:147], v[76:79]
    ds_read_b128 v[104:107], v58 offset:2752
    s_waitcnt lgkmcnt(2)
    v_mfma_f32_16x16x32_bf16 v[96:99], v[108:111], v[160:163], v[96:99]
    v_mfma_f32_16x16x32_bf16 v[92:95], v[108:111], v[156:159], v[92:95]
    v_mfma_f32_16x16x32_bf16 v[88:91], v[108:111], v[152:155], v[88:91]
    v_mfma_f32_16x16x32_bf16 v[84:87], v[108:111], v[148:151], v[84:87]
    v_mfma_f32_16x16x32_bf16 v[80:83], v[108:111], v[144:147], v[80:83]
    ds_read_b128 v[108:111], v58 offset:3264
    s_waitcnt lgkmcnt(2)
    v_mfma_f32_16x16x32_bf16 v[96:99], v[100:103], v[156:159], v[96:99]
    v_mfma_f32_16x16x32_bf16 v[92:95], v[100:103], v[152:155], v[92:95]
    v_mfma_f32_16x16x32_bf16 v[88:91], v[100:103], v[148:151], v[88:91]
    v_mfma_f32_16x16x32_bf16 v[84:87], v[100:103], v[144:147], v[84:87]
    ds_read_b128 v[100:103], v58 offset:3776
    s_waitcnt lgkmcnt(2)
    v_mfma_f32_16x16x32_bf16 v[96:99], v[104:107], v[152:155], v[96:99]
    v_mfma_f32_16x16x32_bf16 v[92:95], v[104:107], v[148:151], v[92:95]
    v_mfma_f32_16x16x32_bf16 v[88:91], v[104:107], v[144:147], v[88:91]
    s_waitcnt lgkmcnt(1)
    v_mfma_f32_16x16x32_bf16 v[96:99], v[108:111], v[148:151], v[96:99]
    v_mfma_f32_16x16x32_bf16 v[92:95], v[108:111], v[144:147], v[92:95]
    s_waitcnt lgkmcnt(0)
    v_mfma_f32_16x16x32_bf16 v[96:99], v[100:103], v[144:147], v[96:99]
    ds_write_b128 v66, v[68:71] offset:0
    ds_write_b128 v66, v[72:75] offset:1024
    ds_write_b128 v66, v[76:79] offset:2048
    ds_write_b128 v66, v[80:83] offset:3072
    ds_write_b128 v66, v[84:87] offset:4096
    ds_write_b128 v66, v[88:91] offset:5120
    ds_write_b128 v66, v[92:95] offset:6144
    s_nop 0
    ds_write_b128 v66, v[96:99] offset:7168
    s_branch c_pw_end_9
c_pw_11:
    s_cmp_lg_u32 s34, 2
    s_cbranch_scc1 c_pw_12
    ds_read_b128 v[100:103], v58 offset:256
    ds_read_b128 v[112:115], v59 offset:224
    ds_read_b128 v[116:119], v59 offset:736
    ds_read_b128 v[120:123], v59 offset:1248
    ds_read_b128 v[124:127], v59 offset:1760
    ds_read_b128 v[128:131], v59 offset:2272
    ds_read_b128 v[132:135], v59 offset:2784
    ds_read_b128 v[136:139], v59 offset:3296
    ds_read_b128 v[140:143], v59 offset:3808
    ds_read_b128 v[104:107], v58 offset:768
    ds_read_b128 v[108:111], v58 offset:1280
    s_waitcnt lgkmcnt(2)
    v_mfma_f32_16x16x32_bf16 v[96:99], v[100:103], v[140:143], 0
    v_mfma_f32_16x16x32_bf16 v[92:95], v[100:103], v[136:139], 0
    v_mfma_f32_16x16x32_bf16 v[88:91], v[100:103], v[132:135], 0
    v_mfma_f32_16x16x32_bf16 v[84:87], v[100:103], v[128:131], 0
    v_mfma_f32_16x16x32_bf16 v[80:83], v[100:103], v[124:127], 0
    v_mfma_f32_16x16x32_bf16 v[76:79], v[100:103], v[120:123], 0
    v_mfma_f32_16x16x32_bf16 v[72:75], v[100:103], v[116:119], 0
    v_mfma_f32_16x16x32_bf16 v[68:71], v[100:103], v[112:115], 0
    ds_read_b128 v[100:103], v58 offset:1792
    s_waitcnt lgkmcnt(2)
    v_mfma_f32_16x16x32_bf16 v[96:99], v[104:107], v[136:139], v[96:99]
    v_mfma_f32_16x16x32_bf16 v[92:95], v[104:107], v[132:135], v[92:95]
    v_mfma_f32_16x16x32_bf16 v[88:91], v[104:107], v[128:131], v[88:91]
    v_mfma_f32_16x16x32_bf16 v[84:87], v[104:107], v[124:127], v[84:87]
    v_mfma_f32_16x16x32_bf16 v[80:83], v[104:107], v[120:123], v[80:83]
    v_mfma_f32_16x16x32_bf16 v[76:79], v[104:107], v[116:119], v[76:79]
    v_mfma_f32_16x16x32_bf16 v[72:75], v[104:107], v[112:115], v[72:75]
    ds_read_b128 v[104:107], v58 offset:2304
    ds_read_b128 v[144:147], v59 offset:160
    ds_read_b128 v[148:151], v59 offset:672
    ds_read_b128 v[152:155], v59 offset:1184
    ds_read_b128 v[156:159], v59 offset:1696
    ds_read_b128 v[160:163], v59 offset:2208
    ds_read_b128 v[164:167], v59 offset:2720
    ds_read_b128 v[168:171], v59 offset:3232
    ds_read_b128 v[172:175], v59 offset:3744
    s_waitcnt lgkmcnt(10)
    v_mfma_f32_16x16x32_bf16 v[96:99], v[108:111], v[132:135], v[96:99]
    v_mfma_f32_16x16x32_bf16 v[92:95], v[108:111], v[128:131], v[92:95]
    v_mfma_f32_16x16x32_bf16 v[88:91], v[108:111], v[124:127], v[88:91]
    v_mfma_f32_16x16x32_bf16 v[84:87], v[108:111], v[120:123], v[84:87]
    v_mfma_f32_16x16x32_bf16 v[80:83], v[108:111], v[116:119], v[80:83]
    v_mfma_f32_16x16x32_bf16 v[76:79], v[108:111], v[112:115], v[76:79]
    ds_read_b128 v[108:111], v58 offset:2816
    s_waitcnt lgkmcnt(10)
    v_mfma_f32_16x16x32_bf16 v[96:99], v[100:103], v[128:131], v[96:99]
    v_mfma_f32_16x16x32_bf16 v[92:95], v[100:103], v[124:127], v[92:95]
    v_mfma_f32_16x16x32_bf16 v[88:91], v[100:103], v[120:123], v[88:91]
    v_mfma_f32_16x16x32_bf16 v[84:87], v[100:103], v[116:119], v[84:87]
    v_mfma_f32_16x16x32_bf16 v[80:83], v[100:103], v[112:115], v[80:83]
    ds_read_b128 v[100:103], v58 offset:3328
    s_waitcnt lgkmcnt(10)
    v_mfma_f32_16x16x32_bf16 v[96:99], v[104:107], v[124:127], v[96:99]
    v_mfma_f32_16x16x32_bf16 v[92:95], v[104:107], v[120:123], v[92:95]
    v_mfma_f32_16x16x32_bf16 v[88:91], v[104:107], v[116:119], v[88:91]
    v_mfma_f32_16x16x32_bf16 v[84:87], v[104:107], v[112:115], v[84:87]
    ds_read_b128 v[104:107], v58 offset:3840
    s_waitcnt lgkmcnt(2)
    v_mfma_f32_16x16x32_bf16 v[96:99], v[108:111], v[120:123], v[96:99]
    v_mfma_f32_16x16x32_bf16 v[92:95], v[108:111], v[116:119], v[92:95]
    v_mfma_f32_16x16x32_bf16 v[88:91], v[108:111], v[112:115], v[88:91]
    ds_read_b128 v[108:111], v58 offset:320
    s_waitcnt lgkmcnt(2)
    v_mfma_f32_16x16x32_bf16 v[96:99], v[100:103], v[116:119], v[96:99]
    v_mfma_f32_16x16x32_bf16 v[92:95], v[100:103], v[112:115], v[92:95]
    ds_read_b128 v[100:103], v58 offset:832
    s_waitcnt lgkmcnt(2)
    v_mfma_f32_16x16x32_bf16 v[96:99], v[104:107], v[112:115], v[96:99]
    ds_read_b128 v[104:107], v58 offset:1344
    s_waitcnt lgkmcnt(2)
    v_mfma_f32_16x16x32_bf16 v[96:99], v[108:111], v[172:175], v[96:99]
    v_mfma_f32_16x16x32_bf16 v[92:95], v[108:111], v[168:171], v[92:95]
    v_mfma_f32_16x16x32_bf16 v[88:91], v[108:111], v[164:167], v[88:91]
    v_mfma_f32_16x16x32_bf16 v[84:87], v[108:111], v[160:163], v[84:87]
    v_mfma_f32_16x16x32_bf16 v[80:83], v[108:111], v[156:159], v[80:83]
    v_mfma_f32_16x16x32_bf16 v[76:79], v[108:111], v[152:155], v[76:79]
    v_mfma_f32_16x16x32_bf16 v[72:75], v[108:111], v[148:151], v[72:75]
    v_mfma_f32_16x16x32_bf16 v[68:71], v[108:111], v[144:147], v[68:71]
    ds_read_b128 v[108:111], v58 offset:1856
    s_waitcnt lgkmcnt(2)
    v_mfma_f32_16x16x32_bf16 v[96:99], v[100:103], v[168:171], v[96:99]
    v_mfma_f32_16x16x32_bf16 v[92:95], v[100:103], v[164:167], v[92:95]
    v_mfma_f32_16x16x32_bf16 v[88:91], v[100:103], v[160:163], v[88:91]
    v_mfma_f32_16x16x32_bf16 v[84:87], v[100:103], v[156:159], v[84:87]
    v_mfma_f32_16x16x32_bf16 v[80:83], v[100:103], v[152:155], v[80:83]
    v_mfma_f32_16x16x32_bf16 v[76:79], v[100:103], v[148:151], v[76:79]
    v_mfma_f32_16x16x32_bf16 v[72:75], v[100:103], v[144:147], v[72:75]
    ds_read_b128 v[100:103], v58 offset:2368
    s_waitcnt lgkmcnt(2)
    v_mfma_f32_16x16x32_bf16 v[96:99], v[104:107], v[164:167], v[96:99]
    v_mfma_f32_16x16x32_bf16 v[92:95], v[104:107], v[160:163], v[92:95]
    v_mfma_f32_16x16x32_bf16 v[88:91], v[104:107], v[156:159], v[88:91]
    v_mfma_f32_16x16x32_bf16 v[84:87], v[104:107], v[152:155], v[84:87]
    v_mfma_f32_16x16x32_bf16 v[80:83], v[104:107], v[148:151], v[80:83]
    v_mfma_f32_16x16x32_bf16 v[76:79], v[104:107], v[144:147], v[76:79]
    ds_read_b128 v[104:107], v58 offset:2880
    s_waitcnt lgkmcnt(2)
    v_mfma_f32_16x16x32_bf16 v[96:99], v[108:111], v[160:163], v[96:99]
    v_mfma_f32_16x16x32_bf16 v[92:95], v[108:111], v[156:159], v[92:95]
    v_mfma_f32_16x16x32_bf16 v[88:91], v[108:111], v[152:155], v[88:91]
    v_mfma_f32_16x16x32_bf16 v[84:87], v[108:111], v[148:151], v[84:87]
    v_mfma_f32_16x16x32_bf16 v[80:83], v[108:111], v[144:147], v[80:83]
    ds_read_b128 v[108:111], v58 offset:3392
    s_waitcnt lgkmcnt(2)
    v_mfma_f32_16x16x32_bf16 v[96:99], v[100:103], v[156:159], v[96:99]
    v_mfma_f32_16x16x32_bf16 v[92:95], v[100:103], v[152:155], v[92:95]
    v_mfma_f32_16x16x32_bf16 v[88:91], v[100:103], v[148:151], v[88:91]
    v_mfma_f32_16x16x32_bf16 v[84:87], v[100:103], v[144:147], v[84:87]
    ds_read_b128 v[100:103], v58 offset:3904
    s_waitcnt lgkmcnt(2)
    v_mfma_f32_16x16x32_bf16 v[96:99], v[104:107], v[152:155], v[96:99]
    v_mfma_f32_16x16x32_bf16 v[92:95], v[104:107], v[148:151], v[92:95]
    v_mfma_f32_16x16x32_bf16 v[88:91], v[104:107], v[144:147], v[88:91]
    s_waitcnt lgkmcnt(1)
    v_mfma_f32_16x16x32_bf16 v[96:99], v[108:111], v[148:151], v[96:99]
    v_mfma_f32_16x16x32_bf16 v[92:95], v[108:111], v[144:147], v[92:95]
    s_waitcnt lgkmcnt(0)
    v_mfma_f32_16x16x32_bf16 v[96:99], v[100:103], v[144:147], v[96:99]
    ds_write_b128 v66, v[68:71] offset:0
    ds_write_b128 v66, v[72:75] offset:1024
    ds_write_b128 v66, v[76:79] offset:2048
    ds_write_b128 v66, v[80:83] offset:3072
    ds_write_b128 v66, v[84:87] offset:4096
    ds_write_b128 v66, v[88:91] offset:5120
    ds_write_b128 v66, v[92:95] offset:6144
    s_nop 0
    ds_write_b128 v66, v[96:99] offset:7168
    s_branch c_pw_end_9
c_pw_12:
    ds_read_b128 v[100:103], v58 offset:384
    ds_read_b128 v[112:115], v59 offset:96
    ds_read_b128 v[116:119], v59 offset:608
    ds_read_b128 v[120:123], v59 offset:1120
    ds_read_b128 v[124:127], v59 offset:1632
    ds_read_b128 v[128:131], v59 offset:2144
    ds_read_b128 v[132:135], v59 offset:2656
    ds_read_b128 v[136:139], v59 offset:3168
    ds_read_b128 v[140:143], v59 offset:3680
    ds_read_b128 v[104:107], v58 offset:896
    ds_read_b128 v[108:111], v58 offset:1408
    s_waitcnt lgkmcnt(2)
    v_mfma_f32_16x16x32_bf16 v[96:99], v[100:103], v[140:143], 0
    v_mfma_f32_16x16x32_bf16 v[92:95], v[100:103], v[136:139], 0
    v_mfma_f32_16x16x32_bf16 v[88:91], v[100:103], v[132:135], 0
    v_mfma_f32_16x16x32_bf16 v[84:87], v[100:103], v[128:131], 0
    v_mfma_f32_16x16x32_bf16 v[80:83], v[100:103], v[124:127], 0
    v_mfma_f32_16x16x32_bf16 v[76:79], v[100:103], v[120:123], 0
    v_mfma_f32_16x16x32_bf16 v[72:75], v[100:103], v[116:119], 0
    v_mfma_f32_16x16x32_bf16 v[68:71], v[100:103], v[112:115], 0
    ds_read_b128 v[100:103], v58 offset:1920
    s_waitcnt lgkmcnt(2)
    v_mfma_f32_16x16x32_bf16 v[96:99], v[104:107], v[136:139], v[96:99]
    v_mfma_f32_16x16x32_bf16 v[92:95], v[104:107], v[132:135], v[92:95]
    v_mfma_f32_16x16x32_bf16 v[88:91], v[104:107], v[128:131], v[88:91]
    v_mfma_f32_16x16x32_bf16 v[84:87], v[104:107], v[124:127], v[84:87]
    v_mfma_f32_16x16x32_bf16 v[80:83], v[104:107], v[120:123], v[80:83]
    v_mfma_f32_16x16x32_bf16 v[76:79], v[104:107], v[116:119], v[76:79]
    v_mfma_f32_16x16x32_bf16 v[72:75], v[104:107], v[112:115], v[72:75]
    ds_read_b128 v[104:107], v58 offset:2432
    ds_read_b128 v[144:147], v59 offset:32
    ds_read_b128 v[148:151], v59 offset:544
    ds_read_b128 v[152:155], v59 offset:1056
    ds_read_b128 v[156:159], v59 offset:1568
    ds_read_b128 v[160:163], v59 offset:2080
    ds_read_b128 v[164:167], v59 offset:2592
    ds_read_b128 v[168:171], v59 offset:3104
    ds_read_b128 v[172:175], v59 offset:3616
    s_waitcnt lgkmcnt(10)
    v_mfma_f32_16x16x32_bf16 v[96:99], v[108:111], v[132:135], v[96:99]
    v_mfma_f32_16x16x32_bf16 v[92:95], v[108:111], v[128:131], v[92:95]
    v_mfma_f32_16x16x32_bf16 v[88:91], v[108:111], v[124:127], v[88:91]
    v_mfma_f32_16x16x32_bf16 v[84:87], v[108:111], v[120:123], v[84:87]
    v_mfma_f32_16x16x32_bf16 v[80:83], v[108:111], v[116:119], v[80:83]
    v_mfma_f32_16x16x32_bf16 v[76:79], v[108:111], v[112:115], v[76:79]
    ds_read_b128 v[108:111], v58 offset:2944
    s_waitcnt lgkmcnt(10)
    v_mfma_f32_16x16x32_bf16 v[96:99], v[100:103], v[128:131], v[96:99]
    v_mfma_f32_16x16x32_bf16 v[92:95], v[100:103], v[124:127], v[92:95]
    v_mfma_f32_16x16x32_bf16 v[88:91], v[100:103], v[120:123], v[88:91]
    v_mfma_f32_16x16x32_bf16 v[84:87], v[100:103], v[116:119], v[84:87]
    v_mfma_f32_16x16x32_bf16 v[80:83], v[100:103], v[112:115], v[80:83]
    ds_read_b128 v[100:103], v58 offset:3456
    s_waitcnt lgkmcnt(10)
    v_mfma_f32_16x16x32_bf16 v[96:99], v[104:107], v[124:127], v[96:99]
    v_mfma_f32_16x16x32_bf16 v[92:95], v[104:107], v[120:123], v[92:95]
    v_mfma_f32_16x16x32_bf16 v[88:91], v[104:107], v[116:119], v[88:91]
    v_mfma_f32_16x16x32_bf16 v[84:87], v[104:107], v[112:115], v[84:87]
    ds_read_b128 v[104:107], v58 offset:3968
    s_waitcnt lgkmcnt(2)
    v_mfma_f32_16x16x32_bf16 v[96:99], v[108:111], v[120:123], v[96:99]
    v_mfma_f32_16x16x32_bf16 v[92:95], v[108:111], v[116:119], v[92:95]
    v_mfma_f32_16x16x32_bf16 v[88:91], v[108:111], v[112:115], v[88:91]
    ds_read_b128 v[108:111], v58 offset:448
    s_waitcnt lgkmcnt(2)
    v_mfma_f32_16x16x32_bf16 v[96:99], v[100:103], v[116:119], v[96:99]
    v_mfma_f32_16x16x32_bf16 v[92:95], v[100:103], v[112:115], v[92:95]
    ds_read_b128 v[100:103], v58 offset:960
    s_waitcnt lgkmcnt(2)
    v_mfma_f32_16x16x32_bf16 v[96:99], v[104:107], v[112:115], v[96:99]
    ds_read_b128 v[104:107], v58 offset:1472
    s_waitcnt lgkmcnt(2)
    v_mfma_f32_16x16x32_bf16 v[96:99], v[108:111], v[172:175], v[96:99]
    v_mfma_f32_16x16x32_bf16 v[92:95], v[108:111], v[168:171], v[92:95]
    v_mfma_f32_16x16x32_bf16 v[88:91], v[108:111], v[164:167], v[88:91]
    v_mfma_f32_16x16x32_bf16 v[84:87], v[108:111], v[160:163], v[84:87]
    v_mfma_f32_16x16x32_bf16 v[80:83], v[108:111], v[156:159], v[80:83]
    v_mfma_f32_16x16x32_bf16 v[76:79], v[108:111], v[152:155], v[76:79]
    v_mfma_f32_16x16x32_bf16 v[72:75], v[108:111], v[148:151], v[72:75]
    v_mfma_f32_16x16x32_bf16 v[68:71], v[108:111], v[144:147], v[68:71]
    ds_read_b128 v[108:111], v58 offset:1984
    s_waitcnt lgkmcnt(2)
    v_mfma_f32_16x16x32_bf16 v[96:99], v[100:103], v[168:171], v[96:99]
    v_mfma_f32_16x16x32_bf16 v[92:95], v[100:103], v[164:167], v[92:95]
    v_mfma_f32_16x16x32_bf16 v[88:91], v[100:103], v[160:163], v[88:91]
    v_mfma_f32_16x16x32_bf16 v[84:87], v[100:103], v[156:159], v[84:87]
    v_mfma_f32_16x16x32_bf16 v[80:83], v[100:103], v[152:155], v[80:83]
    v_mfma_f32_16x16x32_bf16 v[76:79], v[100:103], v[148:151], v[76:79]
    v_mfma_f32_16x16x32_bf16 v[72:75], v[100:103], v[144:147], v[72:75]
    ds_read_b128 v[100:103], v58 offset:2496
    s_waitcnt lgkmcnt(2)
    v_mfma_f32_16x16x32_bf16 v[96:99], v[104:107], v[164:167], v[96:99]
    v_mfma_f32_16x16x32_bf16 v[92:95], v[104:107], v[160:163], v[92:95]
    v_mfma_f32_16x16x32_bf16 v[88:91], v[104:107], v[156:159], v[88:91]
    v_mfma_f32_16x16x32_bf16 v[84:87], v[104:107], v[152:155], v[84:87]
    v_mfma_f32_16x16x32_bf16 v[80:83], v[104:107], v[148:151], v[80:83]
    v_mfma_f32_16x16x32_bf16 v[76:79], v[104:107], v[144:147], v[76:79]
    ds_read_b128 v[104:107], v58 offset:3008
    s_waitcnt lgkmcnt(2)
    v_mfma_f32_16x16x32_bf16 v[96:99], v[108:111], v[160:163], v[96:99]
    v_mfma_f32_16x16x32_bf16 v[92:95], v[108:111], v[156:159], v[92:95]
    v_mfma_f32_16x16x32_bf16 v[88:91], v[108:111], v[152:155], v[88:91]
    v_mfma_f32_16x16x32_bf16 v[84:87], v[108:111], v[148:151], v[84:87]
    v_mfma_f32_16x16x32_bf16 v[80:83], v[108:111], v[144:147], v[80:83]
    ds_read_b128 v[108:111], v58 offset:3520
    s_waitcnt lgkmcnt(2)
    v_mfma_f32_16x16x32_bf16 v[96:99], v[100:103], v[156:159], v[96:99]
    v_mfma_f32_16x16x32_bf16 v[92:95], v[100:103], v[152:155], v[92:95]
    v_mfma_f32_16x16x32_bf16 v[88:91], v[100:103], v[148:151], v[88:91]
    v_mfma_f32_16x16x32_bf16 v[84:87], v[100:103], v[144:147], v[84:87]
    ds_read_b128 v[100:103], v58 offset:4032
    s_waitcnt lgkmcnt(2)
    v_mfma_f32_16x16x32_bf16 v[96:99], v[104:107], v[152:155], v[96:99]
    v_mfma_f32_16x16x32_bf16 v[92:95], v[104:107], v[148:151], v[92:95]
    v_mfma_f32_16x16x32_bf16 v[88:91], v[104:107], v[144:147], v[88:91]
    s_waitcnt lgkmcnt(1)
    v_mfma_f32_16x16x32_bf16 v[96:99], v[108:111], v[148:151], v[96:99]
    v_mfma_f32_16x16x32_bf16 v[92:95], v[108:111], v[144:147], v[92:95]
    s_waitcnt lgkmcnt(0)
    v_mfma_f32_16x16x32_bf16 v[96:99], v[100:103], v[144:147], v[96:99]
    ds_write_b128 v66, v[68:71] offset:0
    ds_write_b128 v66, v[72:75] offset:1024
    ds_write_b128 v66, v[76:79] offset:2048
    ds_write_b128 v66, v[80:83] offset:3072
    ds_write_b128 v66, v[84:87] offset:4096
    ds_write_b128 v66, v[88:91] offset:5120
    ds_write_b128 v66, v[92:95] offset:6144
    s_nop 0
    ds_write_b128 v66, v[96:99] offset:7168
c_pw_end_9:
    s_waitcnt lgkmcnt(0)
    s_barrier
    ds_read_b128 v[112:115], v67 offset:0
    ds_read_b128 v[116:119], v67 offset:16
    ds_read_b128 v[120:123], v67 offset:8192
    ds_read_b128 v[124:127], v67 offset:8208
    ds_read_b128 v[128:131], v67 offset:16384
    ds_read_b128 v[132:135], v67 offset:16400
    ds_read_b128 v[136:139], v67 offset:24576
    ds_read_b128 v[140:143], v67 offset:24592
    s_lshl_b32 s40, s56, 12
    s_add_u32 s40, s40, 8912896
    s_waitcnt lgkmcnt(0)
    v_pk_add_f32 v[112:113], v[112:113], v[120:121]
    v_pk_add_f32 v[128:129], v[128:129], v[136:137]
    v_pk_add_f32 v[114:115], v[114:115], v[122:123]
    v_pk_add_f32 v[130:131], v[130:131], v[138:139]
    v_pk_add_f32 v[116:117], v[116:117], v[124:125]
    v_pk_add_f32 v[132:133], v[132:133], v[140:141]
    v_pk_add_f32 v[118:119], v[118:119], v[126:127]
    v_pk_add_f32 v[134:135], v[134:135], v[142:143]
    v_pk_add_f32 v[112:113], v[112:113], v[128:129]
    v_pk_add_f32 v[114:115], v[114:115], v[130:131]
    v_pk_add_f32 v[116:117], v[116:117], v[132:133]
    v_pk_add_f32 v[118:119], v[118:119], v[134:135]
    v_cvt_pk_bf16_f32 v184, v112, v113
    v_cvt_pk_bf16_f32 v185, v114, v115
    v_cvt_pk_bf16_f32 v186, v116, v117
    v_cvt_pk_bf16_f32 v187, v118, v119
    buffer_store_dwordx4 v[184:187], v2, s[8:11], s40 offen sc1
    s_nop 1
    s_waitcnt vmcnt(4)
    v_cmp_ne_u32 vcc, 0, v0
    s_nop 1
    v_cndmask_b32 v16, 0, v16, vcc
    v_cndmask_b32 v17, 0, v17, vcc
    v_cndmask_b32 v18, 0, v18, vcc
    v_cndmask_b32 v19, 0, v19, vcc
    v_alignbit_b32 v176, v17, v16, 16
    v_alignbit_b32 v177, v18, v17, 16
    v_alignbit_b32 v178, v19, v18, 16
    v_alignbit_b32 v179, v20, v19, 16
    v_alignbit_b32 v180, v21, v20, 16
    v_alignbit_b32 v181, v22, v21, 16
    v_alignbit_b32 v182, v23, v22, 16
    ds_write_b128 v56, v[176:179] offset:0
    v_mov_b32 v184, v17
    v_mov_b32 v185, v18
    v_mov_b32 v186, v19
    v_mov_b32 v187, v20
    ds_write_b128 v56, v[184:187] offset:4160
    s_nop 1
    v_mov_b32 v184, v177
    v_mov_b32 v185, v178
    v_mov_b32 v186, v179
    v_mov_b32 v187, v180
    ds_write_b128 v56, v[184:187] offset:8320
    s_nop 1
    ds_write_b128 v56, v[18:21] offset:12480
    ds_write_b128 v56, v[178:181] offset:16640
    v_mov_b32 v184, v19
    v_mov_b32 v185, v20
    v_mov_b32 v186, v21
    v_mov_b32 v187, v22
    ds_write_b128 v56, v[184:187] offset:20800
    s_nop 1
    v_mov_b32 v184, v179
    v_mov_b32 v185, v180
    v_mov_b32 v186, v181
    v_mov_b32 v187, v182
    ds_write_b128 v56, v[184:187] offset:24960
    s_nop 1
    ds_write_b128 v56, v[20:23] offset:29120
    ds_write_b128 v57, v[36:39]
    v_lshlrev_b32 v3, 16, v45
    v_or_b32 v3, v3, v45
    v_and_b32 v188, v60, v3
    v_and_b32 v189, v61, v3
    v_and_b32 v190, v62, v3
    v_and_b32 v191, v63, v3
    s_waitcnt lgkmcnt(0)
    s_barrier
    s_cmp_ge_u32 s2, 192
    s_cbranch_scc1 c_wj3_14
    v_lshrrev_b32 v3, 4, v1
    v_and_b32 v5, 15, v1
    v_lshrrev_b32 v4, 2, v5
    v_lshl_add_u32 v3, v3, 2, v4
    v_mul_u32_u24 v3, 160, v3
    v_and_b32 v4, 3, v5
    v_lshl_add_u32 v3, v4, 3, v3
    v_lshlrev_b32 v5, 4, v1
    s_lshl_b32 s40, s34, 5
    s_add_u32 s41, s40, 70656
    v_add_u32 v4, s41, v3
    ds_read_b64_tr_b16 v[184:185], v4
    ds_read_b64_tr_b16 v[186:187], v4 offset:2560
    s_mul_i32 s41, s2, 5120
    s_lshl_b32 s40, s40, 5
    s_add_u32 s41, s41, s40
    s_add_u32 s41, s41, 15007744
    s_waitcnt lgkmcnt(0)
    buffer_store_dwordx4 v[184:187], v5, s[8:11], s41 offen sc1
    s_nop 1
    s_cmp_lg_u32 s34, 0
    s_cbranch_scc1 c_wj4_15
    s_mov_b32 s40, 128
    s_add_u32 s41, s40, 70656
    v_add_u32 v4, s41, v3
    ds_read_b64_tr_b16 v[184:185], v4
    ds_read_b64_tr_b16 v[186:187], v4 offset:2560
    s_mul_i32 s41, s2, 5120
    s_lshl_b32 s40, s40, 5
    s_add_u32 s41, s41, s40
    s_add_u32 s41, s41, 15007744
    s_waitcnt lgkmcnt(0)
    buffer_store_dwordx4 v[184:187], v5, s[8:11], s41 offen sc1
    s_nop 1
c_wj4_15:
c_wj3_14:
    s_cmp_lg_u32 s34, 0
    s_cbranch_scc1 c_pw_17
    ds_read_b128 v[100:103], v58 offset:0
    ds_read_b128 v[112:115], v59 offset:480
    ds_read_b128 v[116:119], v59 offset:992
    ds_read_b128 v[120:123], v59 offset:1504
    ds_read_b128 v[124:127], v59 offset:2016
    ds_read_b128 v[128:131], v59 offset:2528
    ds_read_b128 v[132:135], v59 offset:3040
    ds_read_b128 v[136:139], v59 offset:3552
    ds_read_b128 v[140:143], v59 offset:4064
    ds_read_b128 v[104:107], v58 offset:512
    ds_read_b128 v[108:111], v58 offset:1024
    s_waitcnt lgkmcnt(2)
    v_mfma_f32_16x16x32_bf16 v[96:99], v[100:103], v[140:143], 0
    v_mfma_f32_16x16x32_bf16 v[92:95], v[100:103], v[136:139], 0
    v_mfma_f32_16x16x32_bf16 v[88:91], v[100:103], v[132:135], 0
    v_mfma_f32_16x16x32_bf16 v[84:87], v[100:103], v[128:131], 0
    v_mfma_f32_16x16x32_bf16 v[80:83], v[100:103], v[124:127], 0
    v_mfma_f32_16x16x32_bf16 v[76:79], v[100:103], v[120:123], 0
    v_mfma_f32_16x16x32_bf16 v[72:75], v[100:103], v[116:119], 0
    v_mfma_f32_16x16x32_bf16 v[68:71], v[100:103], v[112:115], 0
    v_mfma_f32_16x16x32_bf16 v[68:71], v[188:191], v[112:115], v[68:71]
    v_mfma_f32_16x16x32_bf16 v[72:75], v[188:191], v[116:119], v[72:75]
    v_mfma_f32_16x16x32_bf16 v[76:79], v[188:191], v[120:123], v[76:79]
    v_mfma_f32_16x16x32_bf16 v[80:83], v[188:191], v[124:127], v[80:83]
    v_mfma_f32_16x16x32_bf16 v[84:87], v[188:191], v[128:131], v[84:87]
    v_mfma_f32_16x16x32_bf16 v[88:91], v[188:191], v[132:135], v[88:91]
    v_mfma_f32_16x16x32_bf16 v[92:95], v[188:191], v[136:139], v[92:95]
    v_mfma_f32_16x16x32_bf16 v[96:99], v[188:191], v[140:143], v[96:99]
    ds_read_b128 v[100:103], v58 offset:1536
    s_waitcnt lgkmcnt(2)
    v_mfma_f32_16x16x32_bf16 v[96:99], v[104:107], v[136:139], v[96:99]
    v_mfma_f32_16x16x32_bf16 v[92:95], v[104:107], v[132:135], v[92:95]
    v_mfma_f32_16x16x32_bf16 v[88:91], v[104:107], v[128:131], v[88:91]
    v_mfma_f32_16x16x32_bf16 v[84:87], v[104:107], v[124:127], v[84:87]
    v_mfma_f32_16x16x32_bf16 v[80:83], v[104:107], v[120:123], v[80:83]
    v_mfma_f32_16x16x32_bf16 v[76:79], v[104:107], v[116:119], v[76:79]
    v_mfma_f32_16x16x32_bf16 v[72:75], v[104:107], v[112:115], v[72:75]
    ds_read_b128 v[104:107], v58 offset:2048
    ds_read_b128 v[144:147], v59 offset:416
    ds_read_b128 v[148:151], v59 offset:928
    ds_read_b128 v[152:155], v59 offset:1440
    ds_read_b128 v[156:159], v59 offset:1952
    ds_read_b128 v[160:163], v59 offset:2464
    ds_read_b128 v[164:167], v59 offset:2976
    ds_read_b128 v[168:171], v59 offset:3488
    ds_read_b128 v[172:175], v59 offset:4000
    s_waitcnt lgkmcnt(10)
    v_mfma_f32_16x16x32_bf16 v[96:99], v[108:111], v[132:135], v[96:99]
    v_mfma_f32_16x16x32_bf16 v[92:95], v[108:111], v[128:131], v[92:95]
    v_mfma_f32_16x16x32_bf16 v[88:91], v[108:111], v[124:127], v[88:91]
    v_mfma_f32_16x16x32_bf16 v[84:87], v[108:111], v[120:123], v[84:87]
    v_mfma_f32_16x16x32_bf16 v[80:83], v[108:111], v[116:119], v[80:83]
    v_mfma_f32_16x16x32_bf16 v[76:79], v[108:111], v[112:115], v[76:79]
    ds_read_b128 v[108:111], v58 offset:2560
    s_waitcnt lgkmcnt(10)
    v_mfma_f32_16x16x32_bf16 v[96:99], v[100:103], v[128:131], v[96:99]
    v_mfma_f32_16x16x32_bf16 v[92:95], v[100:103], v[124:127], v[92:95]
    v_mfma_f32_16x16x32_bf16 v[88:91], v[100:103], v[120:123], v[88:91]
    v_mfma_f32_16x16x32_bf16 v[84:87], v[100:103], v[116:119], v[84:87]
    v_mfma_f32_16x16x32_bf16 v[80:83], v[100:103], v[112:115], v[80:83]
    ds_read_b128 v[100:103], v58 offset:3072
    s_waitcnt lgkmcnt(10)
    v_mfma_f32_16x16x32_bf16 v[96:99], v[104:107], v[124:127], v[96:99]
    v_mfma_f32_16x16x32_bf16 v[92:95], v[104:107], v[120:123], v[92:95]
    v_mfma_f32_16x16x32_bf16 v[88:91], v[104:107], v[116:119], v[88:91]
    v_mfma_f32_16x16x32_bf16 v[84:87], v[104:107], v[112:115], v[84:87]
    ds_read_b128 v[104:107], v58 offset:3584
    s_waitcnt lgkmcnt(2)
    v_mfma_f32_16x16x32_bf16 v[96:99], v[108:111], v[120:123], v[96:99]
    v_mfma_f32_16x16x32_bf16 v[92:95], v[108:111], v[116:119], v[92:95]
    v_mfma_f32_16x16x32_bf16 v[88:91], v[108:111], v[112:115], v[88:91]
    ds_read_b128 v[108:111], v58 offset:64
    s_waitcnt lgkmcnt(2)
    v_mfma_f32_16x16x32_bf16 v[96:99], v[100:103], v[116:119], v[96:99]
    v_mfma_f32_16x16x32_bf16 v[92:95], v[100:103], v[112:115], v[92:95]
    ds_read_b128 v[100:103], v58 offset:576
    s_waitcnt lgkmcnt(2)
    v_mfma_f32_16x16x32_bf16 v[96:99], v[104:107], v[112:115], v[96:99]
    ds_read_b128 v[104:107], v58 offset:1088
    s_waitcnt lgkmcnt(2)
    v_mfma_f32_16x16x32_bf16 v[96:99], v[108:111], v[172:175], v[96:99]
    v_mfma_f32_16x16x32_bf16 v[92:95], v[108:111], v[168:171], v[92:95]
    v_mfma_f32_16x16x32_bf16 v[88:91], v[108:111], v[164:167], v[88:91]
    v_mfma_f32_16x16x32_bf16 v[84:87], v[108:111], v[160:163], v[84:87]
    v_mfma_f32_16x16x32_bf16 v[80:83], v[108:111], v[156:159], v[80:83]
    v_mfma_f32_16x16x32_bf16 v[76:79], v[108:111], v[152:155], v[76:79]
    v_mfma_f32_16x16x32_bf16 v[72:75], v[108:111], v[148:151], v[72:75]
    v_mfma_f32_16x16x32_bf16 v[68:71], v[108:111], v[144:147], v[68:71]
    ds_read_b128 v[108:111], v58 offset:1600
    s_waitcnt lgkmcnt(2)
    v_mfma_f32_16x16x32_bf16 v[96:99], v[100:103], v[168:171], v[96:99]
    v_mfma_f32_16x16x32_bf16 v[92:95], v[100:103], v[164:167], v[92:95]
    v_mfma_f32_16x16x32_bf16 v[88:91], v[100:103], v[160:163], v[88:91]
    v_mfma_f32_16x16x32_bf16 v[84:87], v[100:103], v[156:159], v[84:87]
    v_mfma_f32_16x16x32_bf16 v[80:83], v[100:103], v[152:155], v[80:83]
    v_mfma_f32_16x16x32_bf16 v[76:79], v[100:103], v[148:151], v[76:79]
    v_mfma_f32_16x16x32_bf16 v[72:75], v[100:103], v[144:147], v[72:75]
    ds_read_b128 v[100:103], v58 offset:2112
    s_waitcnt lgkmcnt(2)
    v_mfma_f32_16x16x32_bf16 v[96:99], v[104:107], v[164:167], v[96:99]
    v_mfma_f32_16x16x32_bf16 v[92:95], v[104:107], v[160:163], v[92:95]
    v_mfma_f32_16x16x32_bf16 v[88:91], v[104:107], v[156:159], v[88:91]
    v_mfma_f32_16x16x32_bf16 v[84:87], v[104:107], v[152:155], v[84:87]
    v_mfma_f32_16x16x32_bf16 v[80:83], v[104:107], v[148:151], v[80:83]
    v_mfma_f32_16x16x32_bf16 v[76:79], v[104:107], v[144:147], v[76:79]
    ds_read_b128 v[104:107], v58 offset:2624
    s_waitcnt lgkmcnt(2)
    v_mfma_f32_16x16x32_bf16 v[96:99], v[108:111], v[160:163], v[96:99]
    v_mfma_f32_16x16x32_bf16 v[92:95], v[108:111], v[156:159], v[92:95]
    v_mfma_f32_16x16x32_bf16 v[88:91], v[108:111], v[152:155], v[88:91]
    v_mfma_f32_16x16x32_bf16 v[84:87], v[108:111], v[148:151], v[84:87]
    v_mfma_f32_16x16x32_bf16 v[80:83], v[108:111], v[144:147], v[80:83]
    ds_read_b128 v[108:111], v58 offset:3136
    s_waitcnt lgkmcnt(2)
    v_mfma_f32_16x16x32_bf16 v[96:99], v[100:103], v[156:159], v[96:99]
    v_mfma_f32_16x16x32_bf16 v[92:95], v[100:103], v[152:155], v[92:95]
    v_mfma_f32_16x16x32_bf16 v[88:91], v[100:103], v[148:151], v[88:91]
    v_mfma_f32_16x16x32_bf16 v[84:87], v[100:103], v[144:147], v[84:87]
    ds_read_b128 v[100:103], v58 offset:3648
    s_waitcnt lgkmcnt(2)
    v_mfma_f32_16x16x32_bf16 v[96:99], v[104:107], v[152:155], v[96:99]
    v_mfma_f32_16x16x32_bf16 v[92:95], v[104:107], v[148:151], v[92:95]
    v_mfma_f32_16x16x32_bf16 v[88:91], v[104:107], v[144:147], v[88:91]
    s_waitcnt lgkmcnt(1)
    v_mfma_f32_16x16x32_bf16 v[96:99], v[108:111], v[148:151], v[96:99]
    v_mfma_f32_16x16x32_bf16 v[92:95], v[108:111], v[144:147], v[92:95]
    s_waitcnt lgkmcnt(0)
    v_mfma_f32_16x16x32_bf16 v[96:99], v[100:103], v[144:147], v[96:99]
    ds_write_b128 v66, v[68:71] offset:0
    ds_write_b128 v66, v[72:75] offset:1024
    ds_write_b128 v66, v[76:79] offset:2048
    ds_write_b128 v66, v[80:83] offset:3072
    ds_write_b128 v66, v[84:87] offset:4096
    ds_write_b128 v66, v[88:91] offset:5120
    ds_write_b128 v66, v[92:95] offset:6144
    s_nop 0
    ds_write_b128 v66, v[96:99] offset:7168
    s_branch c_pw_end_16
c_pw_17:
    s_cmp_lg_u32 s34, 1
    s_cbranch_scc1 c_pw_18
    ds_read_b128 v[100:103], v58 offset:128
    ds_read_b128 v[112:115], v59 offset:352
    ds_read_b128 v[116:119], v59 offset:864
    ds_read_b128 v[120:123], v59 offset:1376
    ds_read_b128 v[124:127], v59 offset:1888
    ds_read_b128 v[128:131], v59 offset:2400
    ds_read_b128 v[132:135], v59 offset:2912
    ds_read_b128 v[136:139], v59 offset:3424
    ds_read_b128 v[140:143], v59 offset:3936
    ds_read_b128 v[104:107], v58 offset:640
    ds_read_b128 v[108:111], v58 offset:1152
    s_waitcnt lgkmcnt(2)
    v_mfma_f32_16x16x32_bf16 v[96:99], v[100:103], v[140:143], 0
    v_mfma_f32_16x16x32_bf16 v[92:95], v[100:103], v[136:139], 0
    v_mfma_f32_16x16x32_bf16 v[88:91], v[100:103], v[132:135], 0
    v_mfma_f32_16x16x32_bf16 v[84:87], v[100:103], v[128:131], 0
    v_mfma_f32_16x16x32_bf16 v[80:83], v[100:103], v[124:127], 0
    v_mfma_f32_16x16x32_bf16 v[76:79], v[100:103], v[120:123], 0
    v_mfma_f32_16x16x32_bf16 v[72:75], v[100:103], v[116:119], 0
    v_mfma_f32_16x16x32_bf16 v[68:71], v[100:103], v[112:115], 0
    ds_read_b128 v[100:103], v58 offset:1664
    s_waitcnt lgkmcnt(2)
    v_mfma_f32_16x16x32_bf16 v[96:99], v[104:107], v[136:139], v[96:99]
    v_mfma_f32_16x16x32_bf16 v[92:95], v[104:107], v[132:135], v[92:95]
    v_mfma_f32_16x16x32_bf16 v[88:91], v[104:107], v[128:131], v[88:91]
    v_mfma_f32_16x16x32_bf16 v[84:87], v[104:107], v[124:127], v[84:87]
    v_mfma_f32_16x16x32_bf16 v[80:83], v[104:107], v[120:123], v[80:83]
    v_mfma_f32_16x16x32_bf16 v[76:79], v[104:107], v[116:119], v[76:79]
    v_mfma_f32_16x16x32_bf16 v[72:75], v[104:107], v[112:115], v[72:75]
    ds_read_b128 v[104:107], v58 offset:2176
    ds_read_b128 v[144:147], v59 offset:288
    ds_read_b128 v[148:151], v59 offset:800
    ds_read_b128 v[152:155], v59 offset:1312
    ds_read_b128 v[156:159], v59 offset:1824
    ds_read_b128 v[160:163], v59 offset:2336
    ds_read_b128 v[164:167], v59 offset:2848
    ds_read_b128 v[168:171], v59 offset:3360
    ds_read_b128 v[172:175], v59 offset:3872
    s_waitcnt lgkmcnt(10)
    v_mfma_f32_16x16x32_bf16 v[96:99], v[108:111], v[132:135], v[96:99]
    v_mfma_f32_16x16x32_bf16 v[92:95], v[108:111], v[128:131], v[92:95]
    v_mfma_f32_16x16x32_bf16 v[88:91], v[108:111], v[124:127], v[88:91]
    v_mfma_f32_16x16x32_bf16 v[84:87], v[108:111], v[120:123], v[84:87]
    v_mfma_f32_16x16x32_bf16 v[80:83], v[108:111], v[116:119], v[80:83]
    v_mfma_f32_16x16x32_bf16 v[76:79], v[108:111], v[112:115], v[76:79]
    ds_read_b128 v[108:111], v58 offset:2688
    s_waitcnt lgkmcnt(10)
    v_mfma_f32_16x16x32_bf16 v[96:99], v[100:103], v[128:131], v[96:99]
    v_mfma_f32_16x16x32_bf16 v[92:95], v[100:103], v[124:127], v[92:95]
    v_mfma_f32_16x16x32_bf16 v[88:91], v[100:103], v[120:123], v[88:91]
    v_mfma_f32_16x16x32_bf16 v[84:87], v[100:103], v[116:119], v[84:87]
    v_mfma_f32_16x16x32_bf16 v[80:83], v[100:103], v[112:115], v[80:83]
    ds_read_b128 v[100:103], v58 offset:3200
    s_waitcnt lgkmcnt(10)
    v_mfma_f32_16x16x32_bf16 v[96:99], v[104:107], v[124:127], v[96:99]
    v_mfma_f32_16x16x32_bf16 v[92:95], v[104:107], v[120:123], v[92:95]
    v_mfma_f32_16x16x32_bf16 v[88:91], v[104:107], v[116:119], v[88:91]
    v_mfma_f32_16x16x32_bf16 v[84:87], v[104:107], v[112:115], v[84:87]
    ds_read_b128 v[104:107], v58 offset:3712
    s_waitcnt lgkmcnt(2)
    v_mfma_f32_16x16x32_bf16 v[96:99], v[108:111], v[120:123], v[96:99]
    v_mfma_f32_16x16x32_bf16 v[92:95], v[108:111], v[116:119], v[92:95]
    v_mfma_f32_16x16x32_bf16 v[88:91], v[108:111], v[112:115], v[88:91]
    ds_read_b128 v[108:111], v58 offset:192
    s_waitcnt lgkmcnt(2)
    v_mfma_f32_16x16x32_bf16 v[96:99], v[100:103], v[116:119], v[96:99]
    v_mfma_f32_16x16x32_bf16 v[92:95], v[100:103], v[112:115], v[92:95]
    ds_read_b128 v[100:103], v58 offset:704
    s_waitcnt lgkmcnt(2)
    v_mfma_f32_16x16x32_bf16 v[96:99], v[104:107], v[112:115], v[96:99]
    ds_read_b128 v[104:107], v58 offset:1216
    s_waitcnt lgkmcnt(2)
    v_mfma_f32_16x16x32_bf16 v[96:99], v[108:111], v[172:175], v[96:99]
    v_mfma_f32_16x16x32_bf16 v[92:95], v[108:111], v[168:171], v[92:95]
    v_mfma_f32_16x16x32_bf16 v[88:91], v[108:111], v[164:167], v[88:91]
    v_mfma_f32_16x16x32_bf16 v[84:87], v[108:111], v[160:163], v[84:87]
    v_mfma_f32_16x16x32_bf16 v[80:83], v[108:111], v[156:159], v[80:83]
    v_mfma_f32_16x16x32_bf16 v[76:79], v[108:111], v[152:155], v[76:79]
    v_mfma_f32_16x16x32_bf16 v[72:75], v[108:111], v[148:151], v[72:75]
    v_mfma_f32_16x16x32_bf16 v[68:71], v[108:111], v[144:147], v[68:71]
    ds_read_b128 v[108:111], v58 offset:1728
    s_waitcnt lgkmcnt(2)
    v_mfma_f32_16x16x32_bf16 v[96:99], v[100:103], v[168:171], v[96:99]
    v_mfma_f32_16x16x32_bf16 v[92:95], v[100:103], v[164:167], v[92:95]
    v_mfma_f32_16x16x32_bf16 v[88:91], v[100:103], v[160:163], v[88:91]
    v_mfma_f32_16x16x32_bf16 v[84:87], v[100:103], v[156:159], v[84:87]
    v_mfma_f32_16x16x32_bf16 v[80:83], v[100:103], v[152:155], v[80:83]
    v_mfma_f32_16x16x32_bf16 v[76:79], v[100:103], v[148:151], v[76:79]
    v_mfma_f32_16x16x32_bf16 v[72:75], v[100:103], v[144:147], v[72:75]
    ds_read_b128 v[100:103], v58 offset:2240
    s_waitcnt lgkmcnt(2)
    v_mfma_f32_16x16x32_bf16 v[96:99], v[104:107], v[164:167], v[96:99]
    v_mfma_f32_16x16x32_bf16 v[92:95], v[104:107], v[160:163], v[92:95]
    v_mfma_f32_16x16x32_bf16 v[88:91], v[104:107], v[156:159], v[88:91]
    v_mfma_f32_16x16x32_bf16 v[84:87], v[104:107], v[152:155], v[84:87]
    v_mfma_f32_16x16x32_bf16 v[80:83], v[104:107], v[148:151], v[80:83]
    v_mfma_f32_16x16x32_bf16 v[76:79], v[104:107], v[144:147], v[76:79]
    ds_read_b128 v[104:107], v58 offset:2752
    s_waitcnt lgkmcnt(2)
    v_mfma_f32_16x16x32_bf16 v[96:99], v[108:111], v[160:163], v[96:99]
    v_mfma_f32_16x16x32_bf16 v[92:95], v[108:111], v[156:159], v[92:95]
    v_mfma_f32_16x16x32_bf16 v[88:91], v[108:111], v[152:155], v[88:91]
    v_mfma_f32_16x16x32_bf16 v[84:87], v[108:111], v[148:151], v[84:87]
    v_mfma_f32_16x16x32_bf16 v[80:83], v[108:111], v[144:147], v[80:83]
    ds_read_b128 v[108:111], v58 offset:3264
    s_waitcnt lgkmcnt(2)
    v_mfma_f32_16x16x32_bf16 v[96:99], v[100:103], v[156:159], v[96:99]
    v_mfma_f32_16x16x32_bf16 v[92:95], v[100:103], v[152:155], v[92:95]
    v_mfma_f32_16x16x32_bf16 v[88:91], v[100:103], v[148:151], v[88:91]
    v_mfma_f32_16x16x32_bf16 v[84:87], v[100:103], v[144:147], v[84:87]
    ds_read_b128 v[100:103], v58 offset:3776
    s_waitcnt lgkmcnt(2)
    v_mfma_f32_16x16x32_bf16 v[96:99], v[104:107], v[152:155], v[96:99]
    v_mfma_f32_16x16x32_bf16 v[92:95], v[104:107], v[148:151], v[92:95]
    v_mfma_f32_16x16x32_bf16 v[88:91], v[104:107], v[144:147], v[88:91]
    s_waitcnt lgkmcnt(1)
    v_mfma_f32_16x16x32_bf16 v[96:99], v[108:111], v[148:151], v[96:99]
    v_mfma_f32_16x16x32_bf16 v[92:95], v[108:111], v[144:147], v[92:95]
    s_waitcnt lgkmcnt(0)
    v_mfma_f32_16x16x32_bf16 v[96:99], v[100:103], v[144:147], v[96:99]
    ds_write_b128 v66, v[68:71] offset:0
    ds_write_b128 v66, v[72:75] offset:1024
    ds_write_b128 v66, v[76:79] offset:2048
    ds_write_b128 v66, v[80:83] offset:3072
    ds_write_b128 v66, v[84:87] offset:4096
    ds_write_b128 v66, v[88:91] offset:5120
    ds_write_b128 v66, v[92:95] offset:6144
    s_nop 0
    ds_write_b128 v66, v[96:99] offset:7168
    s_branch c_pw_end_16
c_pw_18:
    s_cmp_lg_u32 s34, 2
    s_cbranch_scc1 c_pw_19
    ds_read_b128 v[100:103], v58 offset:256
    ds_read_b128 v[112:115], v59 offset:224
    ds_read_b128 v[116:119], v59 offset:736
    ds_read_b128 v[120:123], v59 offset:1248
    ds_read_b128 v[124:127], v59 offset:1760
    ds_read_b128 v[128:131], v59 offset:2272
    ds_read_b128 v[132:135], v59 offset:2784
    ds_read_b128 v[136:139], v59 offset:3296
    ds_read_b128 v[140:143], v59 offset:3808
    ds_read_b128 v[104:107], v58 offset:768
    ds_read_b128 v[108:111], v58 offset:1280
    s_waitcnt lgkmcnt(2)
    v_mfma_f32_16x16x32_bf16 v[96:99], v[100:103], v[140:143], 0
    v_mfma_f32_16x16x32_bf16 v[92:95], v[100:103], v[136:139], 0
    v_mfma_f32_16x16x32_bf16 v[88:91], v[100:103], v[132:135], 0
    v_mfma_f32_16x16x32_bf16 v[84:87], v[100:103], v[128:131], 0
    v_mfma_f32_16x16x32_bf16 v[80:83], v[100:103], v[124:127], 0
    v_mfma_f32_16x16x32_bf16 v[76:79], v[100:103], v[120:123], 0
    v_mfma_f32_16x16x32_bf16 v[72:75], v[100:103], v[116:119], 0
    v_mfma_f32_16x16x32_bf16 v[68:71], v[100:103], v[112:115], 0
    ds_read_b128 v[100:103], v58 offset:1792
    s_waitcnt lgkmcnt(2)
    v_mfma_f32_16x16x32_bf16 v[96:99], v[104:107], v[136:139], v[96:99]
    v_mfma_f32_16x16x32_bf16 v[92:95], v[104:107], v[132:135], v[92:95]
    v_mfma_f32_16x16x32_bf16 v[88:91], v[104:107], v[128:131], v[88:91]
    v_mfma_f32_16x16x32_bf16 v[84:87], v[104:107], v[124:127], v[84:87]
    v_mfma_f32_16x16x32_bf16 v[80:83], v[104:107], v[120:123], v[80:83]
    v_mfma_f32_16x16x32_bf16 v[76:79], v[104:107], v[116:119], v[76:79]
    v_mfma_f32_16x16x32_bf16 v[72:75], v[104:107], v[112:115], v[72:75]
    ds_read_b128 v[104:107], v58 offset:2304
    ds_read_b128 v[144:147], v59 offset:160
    ds_read_b128 v[148:151], v59 offset:672
    ds_read_b128 v[152:155], v59 offset:1184
    ds_read_b128 v[156:159], v59 offset:1696
    ds_read_b128 v[160:163], v59 offset:2208
    ds_read_b128 v[164:167], v59 offset:2720
    ds_read_b128 v[168:171], v59 offset:3232
    ds_read_b128 v[172:175], v59 offset:3744
    s_waitcnt lgkmcnt(10)
    v_mfma_f32_16x16x32_bf16 v[96:99], v[108:111], v[132:135], v[96:99]
    v_mfma_f32_16x16x32_bf16 v[92:95], v[108:111], v[128:131], v[92:95]
    v_mfma_f32_16x16x32_bf16 v[88:91], v[108:111], v[124:127], v[88:91]
    v_mfma_f32_16x16x32_bf16 v[84:87], v[108:111], v[120:123], v[84:87]
    v_mfma_f32_16x16x32_bf16 v[80:83], v[108:111], v[116:119], v[80:83]
    v_mfma_f32_16x16x32_bf16 v[76:79], v[108:111], v[112:115], v[76:79]
    ds_read_b128 v[108:111], v58 offset:2816
    s_waitcnt lgkmcnt(10)
    v_mfma_f32_16x16x32_bf16 v[96:99], v[100:103], v[128:131], v[96:99]
    v_mfma_f32_16x16x32_bf16 v[92:95], v[100:103], v[124:127], v[92:95]
    v_mfma_f32_16x16x32_bf16 v[88:91], v[100:103], v[120:123], v[88:91]
    v_mfma_f32_16x16x32_bf16 v[84:87], v[100:103], v[116:119], v[84:87]
    v_mfma_f32_16x16x32_bf16 v[80:83], v[100:103], v[112:115], v[80:83]
    ds_read_b128 v[100:103], v58 offset:3328
    s_waitcnt lgkmcnt(10)
    v_mfma_f32_16x16x32_bf16 v[96:99], v[104:107], v[124:127], v[96:99]
    v_mfma_f32_16x16x32_bf16 v[92:95], v[104:107], v[120:123], v[92:95]
    v_mfma_f32_16x16x32_bf16 v[88:91], v[104:107], v[116:119], v[88:91]
    v_mfma_f32_16x16x32_bf16 v[84:87], v[104:107], v[112:115], v[84:87]
    ds_read_b128 v[104:107], v58 offset:3840
    s_waitcnt lgkmcnt(2)
    v_mfma_f32_16x16x32_bf16 v[96:99], v[108:111], v[120:123], v[96:99]
    v_mfma_f32_16x16x32_bf16 v[92:95], v[108:111], v[116:119], v[92:95]
    v_mfma_f32_16x16x32_bf16 v[88:91], v[108:111], v[112:115], v[88:91]
    ds_read_b128 v[108:111], v58 offset:320
    s_waitcnt lgkmcnt(2)
    v_mfma_f32_16x16x32_bf16 v[96:99], v[100:103], v[116:119], v[96:99]
    v_mfma_f32_16x16x32_bf16 v[92:95], v[100:103], v[112:115], v[92:95]
    ds_read_b128 v[100:103], v58 offset:832
    s_waitcnt lgkmcnt(2)
    v_mfma_f32_16x16x32_bf16 v[96:99], v[104:107], v[112:115], v[96:99]
    ds_read_b128 v[104:107], v58 offset:1344
    s_waitcnt lgkmcnt(2)
    v_mfma_f32_16x16x32_bf16 v[96:99], v[108:111], v[172:175], v[96:99]
    v_mfma_f32_16x16x32_bf16 v[92:95], v[108:111], v[168:171], v[92:95]
    v_mfma_f32_16x16x32_bf16 v[88:91], v[108:111], v[164:167], v[88:91]
    v_mfma_f32_16x16x32_bf16 v[84:87], v[108:111], v[160:163], v[84:87]
    v_mfma_f32_16x16x32_bf16 v[80:83], v[108:111], v[156:159], v[80:83]
    v_mfma_f32_16x16x32_bf16 v[76:79], v[108:111], v[152:155], v[76:79]
    v_mfma_f32_16x16x32_bf16 v[72:75], v[108:111], v[148:151], v[72:75]
    v_mfma_f32_16x16x32_bf16 v[68:71], v[108:111], v[144:147], v[68:71]
    ds_read_b128 v[108:111], v58 offset:1856
    s_waitcnt lgkmcnt(2)
    v_mfma_f32_16x16x32_bf16 v[96:99], v[100:103], v[168:171], v[96:99]
    v_mfma_f32_16x16x32_bf16 v[92:95], v[100:103], v[164:167], v[92:95]
    v_mfma_f32_16x16x32_bf16 v[88:91], v[100:103], v[160:163], v[88:91]
    v_mfma_f32_16x16x32_bf16 v[84:87], v[100:103], v[156:159], v[84:87]
    v_mfma_f32_16x16x32_bf16 v[80:83], v[100:103], v[152:155], v[80:83]
    v_mfma_f32_16x16x32_bf16 v[76:79], v[100:103], v[148:151], v[76:79]
    v_mfma_f32_16x16x32_bf16 v[72:75], v[100:103], v[144:147], v[72:75]
    ds_read_b128 v[100:103], v58 offset:2368
    s_waitcnt lgkmcnt(2)
    v_mfma_f32_16x16x32_bf16 v[96:99], v[104:107], v[164:167], v[96:99]
    v_mfma_f32_16x16x32_bf16 v[92:95], v[104:107], v[160:163], v[92:95]
    v_mfma_f32_16x16x32_bf16 v[88:91], v[104:107], v[156:159], v[88:91]
    v_mfma_f32_16x16x32_bf16 v[84:87], v[104:107], v[152:155], v[84:87]
    v_mfma_f32_16x16x32_bf16 v[80:83], v[104:107], v[148:151], v[80:83]
    v_mfma_f32_16x16x32_bf16 v[76:79], v[104:107], v[144:147], v[76:79]
    ds_read_b128 v[104:107], v58 offset:2880
    s_waitcnt lgkmcnt(2)
    v_mfma_f32_16x16x32_bf16 v[96:99], v[108:111], v[160:163], v[96:99]
    v_mfma_f32_16x16x32_bf16 v[92:95], v[108:111], v[156:159], v[92:95]
    v_mfma_f32_16x16x32_bf16 v[88:91], v[108:111], v[152:155], v[88:91]
    v_mfma_f32_16x16x32_bf16 v[84:87], v[108:111], v[148:151], v[84:87]
    v_mfma_f32_16x16x32_bf16 v[80:83], v[108:111], v[144:147], v[80:83]
    ds_read_b128 v[108:111], v58 offset:3392
    s_waitcnt lgkmcnt(2)
    v_mfma_f32_16x16x32_bf16 v[96:99], v[100:103], v[156:159], v[96:99]
    v_mfma_f32_16x16x32_bf16 v[92:95], v[100:103], v[152:155], v[92:95]
    v_mfma_f32_16x16x32_bf16 v[88:91], v[100:103], v[148:151], v[88:91]
    v_mfma_f32_16x16x32_bf16 v[84:87], v[100:103], v[144:147], v[84:87]
    ds_read_b128 v[100:103], v58 offset:3904
    s_waitcnt lgkmcnt(2)
    v_mfma_f32_16x16x32_bf16 v[96:99], v[104:107], v[152:155], v[96:99]
    v_mfma_f32_16x16x32_bf16 v[92:95], v[104:107], v[148:151], v[92:95]
    v_mfma_f32_16x16x32_bf16 v[88:91], v[104:107], v[144:147], v[88:91]
    s_waitcnt lgkmcnt(1)
    v_mfma_f32_16x16x32_bf16 v[96:99], v[108:111], v[148:151], v[96:99]
    v_mfma_f32_16x16x32_bf16 v[92:95], v[108:111], v[144:147], v[92:95]
    s_waitcnt lgkmcnt(0)
    v_mfma_f32_16x16x32_bf16 v[96:99], v[100:103], v[144:147], v[96:99]
    ds_write_b128 v66, v[68:71] offset:0
    ds_write_b128 v66, v[72:75] offset:1024
    ds_write_b128 v66, v[76:79] offset:2048
    ds_write_b128 v66, v[80:83] offset:3072
    ds_write_b128 v66, v[84:87] offset:4096
    ds_write_b128 v66, v[88:91] offset:5120
    ds_write_b128 v66, v[92:95] offset:6144
    s_nop 0
    ds_write_b128 v66, v[96:99] offset:7168
    s_branch c_pw_end_16
c_pw_19:
    ds_read_b128 v[100:103], v58 offset:384
    ds_read_b128 v[112:115], v59 offset:96
    ds_read_b128 v[116:119], v59 offset:608
    ds_read_b128 v[120:123], v59 offset:1120
    ds_read_b128 v[124:127], v59 offset:1632
    ds_read_b128 v[128:131], v59 offset:2144
    ds_read_b128 v[132:135], v59 offset:2656
    ds_read_b128 v[136:139], v59 offset:3168
    ds_read_b128 v[140:143], v59 offset:3680
    ds_read_b128 v[104:107], v58 offset:896
    ds_read_b128 v[108:111], v58 offset:1408
    s_waitcnt lgkmcnt(2)
    v_mfma_f32_16x16x32_bf16 v[96:99], v[100:103], v[140:143], 0
    v_mfma_f32_16x16x32_bf16 v[92:95], v[100:103], v[136:139], 0
    v_mfma_f32_16x16x32_bf16 v[88:91], v[100:103], v[132:135], 0
    v_mfma_f32_16x16x32_bf16 v[84:87], v[100:103], v[128:131], 0
    v_mfma_f32_16x16x32_bf16 v[80:83], v[100:103], v[124:127], 0
    v_mfma_f32_16x16x32_bf16 v[76:79], v[100:103], v[120:123], 0
    v_mfma_f32_16x16x32_bf16 v[72:75], v[100:103], v[116:119], 0
    v_mfma_f32_16x16x32_bf16 v[68:71], v[100:103], v[112:115], 0
    ds_read_b128 v[100:103], v58 offset:1920
    s_waitcnt lgkmcnt(2)
    v_mfma_f32_16x16x32_bf16 v[96:99], v[104:107], v[136:139], v[96:99]
    v_mfma_f32_16x16x32_bf16 v[92:95], v[104:107], v[132:135], v[92:95]
    v_mfma_f32_16x16x32_bf16 v[88:91], v[104:107], v[128:131], v[88:91]
    v_mfma_f32_16x16x32_bf16 v[84:87], v[104:107], v[124:127], v[84:87]
    v_mfma_f32_16x16x32_bf16 v[80:83], v[104:107], v[120:123], v[80:83]
    v_mfma_f32_16x16x32_bf16 v[76:79], v[104:107], v[116:119], v[76:79]
    v_mfma_f32_16x16x32_bf16 v[72:75], v[104:107], v[112:115], v[72:75]
    ds_read_b128 v[104:107], v58 offset:2432
    ds_read_b128 v[144:147], v59 offset:32
    ds_read_b128 v[148:151], v59 offset:544
    ds_read_b128 v[152:155], v59 offset:1056
    ds_read_b128 v[156:159], v59 offset:1568
    ds_read_b128 v[160:163], v59 offset:2080
    ds_read_b128 v[164:167], v59 offset:2592
    ds_read_b128 v[168:171], v59 offset:3104
    ds_read_b128 v[172:175], v59 offset:3616
    s_waitcnt lgkmcnt(10)
    v_mfma_f32_16x16x32_bf16 v[96:99], v[108:111], v[132:135], v[96:99]
    v_mfma_f32_16x16x32_bf16 v[92:95], v[108:111], v[128:131], v[92:95]
    v_mfma_f32_16x16x32_bf16 v[88:91], v[108:111], v[124:127], v[88:91]
    v_mfma_f32_16x16x32_bf16 v[84:87], v[108:111], v[120:123], v[84:87]
    v_mfma_f32_16x16x32_bf16 v[80:83], v[108:111], v[116:119], v[80:83]
    v_mfma_f32_16x16x32_bf16 v[76:79], v[108:111], v[112:115], v[76:79]
    ds_read_b128 v[108:111], v58 offset:2944
    s_waitcnt lgkmcnt(10)
    v_mfma_f32_16x16x32_bf16 v[96:99], v[100:103], v[128:131], v[96:99]
    v_mfma_f32_16x16x32_bf16 v[92:95], v[100:103], v[124:127], v[92:95]
    v_mfma_f32_16x16x32_bf16 v[88:91], v[100:103], v[120:123], v[88:91]
    v_mfma_f32_16x16x32_bf16 v[84:87], v[100:103], v[116:119], v[84:87]
    v_mfma_f32_16x16x32_bf16 v[80:83], v[100:103], v[112:115], v[80:83]
    ds_read_b128 v[100:103], v58 offset:3456
    s_waitcnt lgkmcnt(10)
    v_mfma_f32_16x16x32_bf16 v[96:99], v[104:107], v[124:127], v[96:99]
    v_mfma_f32_16x16x32_bf16 v[92:95], v[104:107], v[120:123], v[92:95]
    v_mfma_f32_16x16x32_bf16 v[88:91], v[104:107], v[116:119], v[88:91]
    v_mfma_f32_16x16x32_bf16 v[84:87], v[104:107], v[112:115], v[84:87]
    ds_read_b128 v[104:107], v58 offset:3968
    s_waitcnt lgkmcnt(2)
    v_mfma_f32_16x16x32_bf16 v[96:99], v[108:111], v[120:123], v[96:99]
    v_mfma_f32_16x16x32_bf16 v[92:95], v[108:111], v[116:119], v[92:95]
    v_mfma_f32_16x16x32_bf16 v[88:91], v[108:111], v[112:115], v[88:91]
    ds_read_b128 v[108:111], v58 offset:448
    s_waitcnt lgkmcnt(2)
    v_mfma_f32_16x16x32_bf16 v[96:99], v[100:103], v[116:119], v[96:99]
    v_mfma_f32_16x16x32_bf16 v[92:95], v[100:103], v[112:115], v[92:95]
    ds_read_b128 v[100:103], v58 offset:960
    s_waitcnt lgkmcnt(2)
    v_mfma_f32_16x16x32_bf16 v[96:99], v[104:107], v[112:115], v[96:99]
    ds_read_b128 v[104:107], v58 offset:1472
    s_waitcnt lgkmcnt(2)
    v_mfma_f32_16x16x32_bf16 v[96:99], v[108:111], v[172:175], v[96:99]
    v_mfma_f32_16x16x32_bf16 v[92:95], v[108:111], v[168:171], v[92:95]
    v_mfma_f32_16x16x32_bf16 v[88:91], v[108:111], v[164:167], v[88:91]
    v_mfma_f32_16x16x32_bf16 v[84:87], v[108:111], v[160:163], v[84:87]
    v_mfma_f32_16x16x32_bf16 v[80:83], v[108:111], v[156:159], v[80:83]
    v_mfma_f32_16x16x32_bf16 v[76:79], v[108:111], v[152:155], v[76:79]
    v_mfma_f32_16x16x32_bf16 v[72:75], v[108:111], v[148:151], v[72:75]
    v_mfma_f32_16x16x32_bf16 v[68:71], v[108:111], v[144:147], v[68:71]
    ds_read_b128 v[108:111], v58 offset:1984
    s_waitcnt lgkmcnt(2)
    v_mfma_f32_16x16x32_bf16 v[96:99], v[100:103], v[168:171], v[96:99]
    v_mfma_f32_16x16x32_bf16 v[92:95], v[100:103], v[164:167], v[92:95]
    v_mfma_f32_16x16x32_bf16 v[88:91], v[100:103], v[160:163], v[88:91]
    v_mfma_f32_16x16x32_bf16 v[84:87], v[100:103], v[156:159], v[84:87]
    v_mfma_f32_16x16x32_bf16 v[80:83], v[100:103], v[152:155], v[80:83]
    v_mfma_f32_16x16x32_bf16 v[76:79], v[100:103], v[148:151], v[76:79]
    v_mfma_f32_16x16x32_bf16 v[72:75], v[100:103], v[144:147], v[72:75]
    ds_read_b128 v[100:103], v58 offset:2496
    s_waitcnt lgkmcnt(2)
    v_mfma_f32_16x16x32_bf16 v[96:99], v[104:107], v[164:167], v[96:99]
    v_mfma_f32_16x16x32_bf16 v[92:95], v[104:107], v[160:163], v[92:95]
    v_mfma_f32_16x16x32_bf16 v[88:91], v[104:107], v[156:159], v[88:91]
    v_mfma_f32_16x16x32_bf16 v[84:87], v[104:107], v[152:155], v[84:87]
    v_mfma_f32_16x16x32_bf16 v[80:83], v[104:107], v[148:151], v[80:83]
    v_mfma_f32_16x16x32_bf16 v[76:79], v[104:107], v[144:147], v[76:79]
    ds_read_b128 v[104:107], v58 offset:3008
    s_waitcnt lgkmcnt(2)
    v_mfma_f32_16x16x32_bf16 v[96:99], v[108:111], v[160:163], v[96:99]
    v_mfma_f32_16x16x32_bf16 v[92:95], v[108:111], v[156:159], v[92:95]
    v_mfma_f32_16x16x32_bf16 v[88:91], v[108:111], v[152:155], v[88:91]
    v_mfma_f32_16x16x32_bf16 v[84:87], v[108:111], v[148:151], v[84:87]
    v_mfma_f32_16x16x32_bf16 v[80:83], v[108:111], v[144:147], v[80:83]
    ds_read_b128 v[108:111], v58 offset:3520
    s_waitcnt lgkmcnt(2)
    v_mfma_f32_16x16x32_bf16 v[96:99], v[100:103], v[156:159], v[96:99]
    v_mfma_f32_16x16x32_bf16 v[92:95], v[100:103], v[152:155], v[92:95]
    v_mfma_f32_16x16x32_bf16 v[88:91], v[100:103], v[148:151], v[88:91]
    v_mfma_f32_16x16x32_bf16 v[84:87], v[100:103], v[144:147], v[84:87]
    ds_read_b128 v[100:103], v58 offset:4032
    s_waitcnt lgkmcnt(2)
    v_mfma_f32_16x16x32_bf16 v[96:99], v[104:107], v[152:155], v[96:99]
    v_mfma_f32_16x16x32_bf16 v[92:95], v[104:107], v[148:151], v[92:95]
    v_mfma_f32_16x16x32_bf16 v[88:91], v[104:107], v[144:147], v[88:91]
    s_waitcnt lgkmcnt(1)
    v_mfma_f32_16x16x32_bf16 v[96:99], v[108:111], v[148:151], v[96:99]
    v_mfma_f32_16x16x32_bf16 v[92:95], v[108:111], v[144:147], v[92:95]
    s_waitcnt lgkmcnt(0)
    v_mfma_f32_16x16x32_bf16 v[96:99], v[100:103], v[144:147], v[96:99]
    ds_write_b128 v66, v[68:71] offset:0
    ds_write_b128 v66, v[72:75] offset:1024
    ds_write_b128 v66, v[76:79] offset:2048
    ds_write_b128 v66, v[80:83] offset:3072
    ds_write_b128 v66, v[84:87] offset:4096
    ds_write_b128 v66, v[88:91] offset:5120
    ds_write_b128 v66, v[92:95] offset:6144
    s_nop 0
    ds_write_b128 v66, v[96:99] offset:7168
c_pw_end_16:
    s_waitcnt lgkmcnt(0)
    s_barrier
    ds_read_b128 v[112:115], v67 offset:0
    ds_read_b128 v[116:119], v67 offset:16
    ds_read_b128 v[120:123], v67 offset:8192
    ds_read_b128 v[124:127], v67 offset:8208
    ds_read_b128 v[128:131], v67 offset:16384
    ds_read_b128 v[132:135], v67 offset:16400
    ds_read_b128 v[136:139], v67 offset:24576
    ds_read_b128 v[140:143], v67 offset:24592
    s_lshl_b32 s40, s57, 12
    s_add_u32 s40, s40, 8912896
    s_waitcnt lgkmcnt(0)
    v_pk_add_f32 v[112:113], v[112:113], v[120:121]
    v_pk_add_f32 v[128:129], v[128:129], v[136:137]
    v_pk_add_f32 v[114:115], v[114:115], v[122:123]
    v_pk_add_f32 v[130:131], v[130:131], v[138:139]
    v_pk_add_f32 v[116:117], v[116:117], v[124:125]
    v_pk_add_f32 v[132:133], v[132:133], v[140:141]
    v_pk_add_f32 v[118:119], v[118:119], v[126:127]
    v_pk_add_f32 v[134:135], v[134:135], v[142:143]
    v_pk_add_f32 v[112:113], v[112:113], v[128:129]
    v_pk_add_f32 v[114:115], v[114:115], v[130:131]
    v_pk_add_f32 v[116:117], v[116:117], v[132:133]
    v_pk_add_f32 v[118:119], v[118:119], v[134:135]
    v_cvt_pk_bf16_f32 v184, v112, v113
    v_cvt_pk_bf16_f32 v185, v114, v115
    v_cvt_pk_bf16_f32 v186, v116, v117
    v_cvt_pk_bf16_f32 v187, v118, v119
    buffer_store_dwordx4 v[184:187], v2, s[8:11], s40 offen sc1
    s_nop 1
    s_waitcnt vmcnt(0)
    v_cmp_ne_u32 vcc, 0, v0
    s_nop 1
    v_cndmask_b32 v24, 0, v24, vcc
    v_cndmask_b32 v25, 0, v25, vcc
    v_cndmask_b32 v26, 0, v26, vcc
    v_cndmask_b32 v27, 0, v27, vcc
    v_alignbit_b32 v176, v25, v24, 16
    v_alignbit_b32 v177, v26, v25, 16
    v_alignbit_b32 v178, v27, v26, 16
    v_alignbit_b32 v179, v28, v27, 16
    v_alignbit_b32 v180, v29, v28, 16
    v_alignbit_b32 v181, v30, v29, 16
    v_alignbit_b32 v182, v31, v30, 16
    ds_write_b128 v56, v[176:179] offset:0
    v_mov_b32 v184, v25
    v_mov_b32 v185, v26
    v_mov_b32 v186, v27
    v_mov_b32 v187, v28
    ds_write_b128 v56, v[184:187] offset:4160
    s_nop 1
    v_mov_b32 v184, v177
    v_mov_b32 v185, v178
    v_mov_b32 v186, v179
    v_mov_b32 v187, v180
    ds_write_b128 v56, v[184:187] offset:8320
    s_nop 1
    ds_write_b128 v56, v[26:29] offset:12480
    ds_write_b128 v56, v[178:181] offset:16640
    v_mov_b32 v184, v27
    v_mov_b32 v185, v28
    v_mov_b32 v186, v29
    v_mov_b32 v187, v30
    ds_write_b128 v56, v[184:187] offset:20800
    s_nop 1
    v_mov_b32 v184, v179
    v_mov_b32 v185, v180
    v_mov_b32 v186, v181
    v_mov_b32 v187, v182
    ds_write_b128 v56, v[184:187] offset:24960
    s_nop 1
    ds_write_b128 v56, v[28:31] offset:29120
    ds_write_b128 v57, v[40:43]
    v_lshlrev_b32 v3, 16, v46
    v_or_b32 v3, v3, v46
    v_and_b32 v188, v60, v3
    v_and_b32 v189, v61, v3
    v_and_b32 v190, v62, v3
    v_and_b32 v191, v63, v3
    s_waitcnt lgkmcnt(0)
    s_barrier
    s_bitcmp1_b32 s2, 0
    s_cbranch_scc1 c_halfB_21
    s_cmp_lg_u32 s34, 0
    s_cbranch_scc1 c_pw_24
    ds_read_b128 v[100:103], v58 offset:0
    ds_read_b128 v[112:115], v59 offset:480
    ds_read_b128 v[116:119], v59 offset:992
    ds_read_b128 v[120:123], v59 offset:1504
    ds_read_b128 v[124:127], v59 offset:2016
    ds_read_b128 v[128:131], v59 offset:2528
    ds_read_b128 v[132:135], v59 offset:3040
    ds_read_b128 v[136:139], v59 offset:3552
    ds_read_b128 v[140:143], v59 offset:4064
    ds_read_b128 v[104:107], v58 offset:512
    ds_read_b128 v[108:111], v58 offset:1024
    s_waitcnt lgkmcnt(2)
    v_mfma_f32_16x16x32_bf16 v[96:99], v[100:103], v[140:143], 0
    v_mfma_f32_16x16x32_bf16 v[92:95], v[100:103], v[136:139], 0
    v_mfma_f32_16x16x32_bf16 v[76:79], v[100:103], v[120:123], 0
    v_mfma_f32_16x16x32_bf16 v[76:79], v[188:191], v[120:123], v[76:79]
    v_mfma_f32_16x16x32_bf16 v[92:95], v[188:191], v[136:139], v[92:95]
    v_mfma_f32_16x16x32_bf16 v[96:99], v[188:191], v[140:143], v[96:99]
    ds_read_b128 v[100:103], v58 offset:1536
    s_waitcnt lgkmcnt(2)
    v_mfma_f32_16x16x32_bf16 v[96:99], v[104:107], v[136:139], v[96:99]
    v_mfma_f32_16x16x32_bf16 v[92:95], v[104:107], v[132:135], v[92:95]
    v_mfma_f32_16x16x32_bf16 v[76:79], v[104:107], v[116:119], v[76:79]
    ds_read_b128 v[104:107], v58 offset:2048
    ds_read_b128 v[144:147], v59 offset:416
    ds_read_b128 v[148:151], v59 offset:928
    ds_read_b128 v[152:155], v59 offset:1440
    ds_read_b128 v[156:159], v59 offset:1952
    ds_read_b128 v[160:163], v59 offset:2464
    ds_read_b128 v[164:167], v59 offset:2976
    ds_read_b128 v[168:171], v59 offset:3488
    ds_read_b128 v[172:175], v59 offset:4000
    s_waitcnt lgkmcnt(10)
    v_mfma_f32_16x16x32_bf16 v[96:99], v[108:111], v[132:135], v[96:99]
    v_mfma_f32_16x16x32_bf16 v[92:95], v[108:111], v[128:131], v[92:95]
    v_mfma_f32_16x16x32_bf16 v[76:79], v[108:111], v[112:115], v[76:79]
    ds_read_b128 v[108:111], v58 offset:2560
    s_waitcnt lgkmcnt(10)
    v_mfma_f32_16x16x32_bf16 v[96:99], v[100:103], v[128:131], v[96:99]
    v_mfma_f32_16x16x32_bf16 v[92:95], v[100:103], v[124:127], v[92:95]
    ds_read_b128 v[100:103], v58 offset:3072
    s_waitcnt lgkmcnt(10)
    v_mfma_f32_16x16x32_bf16 v[96:99], v[104:107], v[124:127], v[96:99]
    v_mfma_f32_16x16x32_bf16 v[92:95], v[104:107], v[120:123], v[92:95]
    ds_read_b128 v[104:107], v58 offset:3584
    s_waitcnt lgkmcnt(2)
    v_mfma_f32_16x16x32_bf16 v[96:99], v[108:111], v[120:123], v[96:99]
    v_mfma_f32_16x16x32_bf16 v[92:95], v[108:111], v[116:119], v[92:95]
    ds_read_b128 v[108:111], v58 offset:64
    s_waitcnt lgkmcnt(2)
    v_mfma_f32_16x16x32_bf16 v[96:99], v[100:103], v[116:119], v[96:99]
    v_mfma_f32_16x16x32_bf16 v[92:95], v[100:103], v[112:115], v[92:95]
    ds_read_b128 v[100:103], v58 offset:576
    s_waitcnt lgkmcnt(2)
    v_mfma_f32_16x16x32_bf16 v[96:99], v[104:107], v[112:115], v[96:99]
    ds_read_b128 v[104:107], v58 offset:1088
    s_waitcnt lgkmcnt(2)
    v_mfma_f32_16x16x32_bf16 v[96:99], v[108:111], v[172:175], v[96:99]
    v_mfma_f32_16x16x32_bf16 v[92:95], v[108:111], v[168:171], v[92:95]
    v_mfma_f32_16x16x32_bf16 v[76:79], v[108:111], v[152:155], v[76:79]
    ds_read_b128 v[108:111], v58 offset:1600
    s_waitcnt lgkmcnt(2)
    v_mfma_f32_16x16x32_bf16 v[96:99], v[100:103], v[168:171], v[96:99]
    v_mfma_f32_16x16x32_bf16 v[92:95], v[100:103], v[164:167], v[92:95]
    v_mfma_f32_16x16x32_bf16 v[76:79], v[100:103], v[148:151], v[76:79]
    ds_read_b128 v[100:103], v58 offset:2112
    s_waitcnt lgkmcnt(2)
    v_mfma_f32_16x16x32_bf16 v[96:99], v[104:107], v[164:167], v[96:99]
    v_mfma_f32_16x16x32_bf16 v[92:95], v[104:107], v[160:163], v[92:95]
    v_mfma_f32_16x16x32_bf16 v[76:79], v[104:107], v[144:147], v[76:79]
    ds_read_b128 v[104:107], v58 offset:2624
    s_waitcnt lgkmcnt(2)
    v_mfma_f32_16x16x32_bf16 v[96:99], v[108:111], v[160:163], v[96:99]
    v_mfma_f32_16x16x32_bf16 v[92:95], v[108:111], v[156:159], v[92:95]
    ds_read_b128 v[108:111], v58 offset:3136
    s_waitcnt lgkmcnt(2)
    v_mfma_f32_16x16x32_bf16 v[96:99], v[100:103], v[156:159], v[96:99]
    v_mfma_f32_16x16x32_bf16 v[92:95], v[100:103], v[152:155], v[92:95]
    ds_read_b128 v[100:103], v58 offset:3648
    s_waitcnt lgkmcnt(2)
    v_mfma_f32_16x16x32_bf16 v[96:99], v[104:107], v[152:155], v[96:99]
    v_mfma_f32_16x16x32_bf16 v[92:95], v[104:107], v[148:151], v[92:95]
    s_waitcnt lgkmcnt(1)
    v_mfma_f32_16x16x32_bf16 v[96:99], v[108:111], v[148:151], v[96:99]
    v_mfma_f32_16x16x32_bf16 v[92:95], v[108:111], v[144:147], v[92:95]
    s_waitcnt lgkmcnt(0)
    v_mfma_f32_16x16x32_bf16 v[96:99], v[100:103], v[144:147], v[96:99]
    ds_write_b128 v66, v[76:79] offset:2048
    s_nop 4
    ds_write_b128 v66, v[92:95] offset:6144
    s_nop 0
    ds_write_b128 v66, v[96:99] offset:7168
    s_branch c_pw_end_23
c_pw_24:
    s_cmp_lg_u32 s34, 1
    s_cbranch_scc1 c_pw_25
    ds_read_b128 v[100:103], v58 offset:128
    ds_read_b128 v[112:115], v59 offset:352
    ds_read_b128 v[116:119], v59 offset:864
    ds_read_b128 v[120:123], v59 offset:1376
    ds_read_b128 v[124:127], v59 offset:1888
    ds_read_b128 v[128:131], v59 offset:2400
    ds_read_b128 v[132:135], v59 offset:2912
    ds_read_b128 v[136:139], v59 offset:3424
    ds_read_b128 v[140:143], v59 offset:3936
    ds_read_b128 v[104:107], v58 offset:640
    ds_read_b128 v[108:111], v58 offset:1152
    s_waitcnt lgkmcnt(2)
    v_mfma_f32_16x16x32_bf16 v[96:99], v[100:103], v[140:143], 0
    v_mfma_f32_16x16x32_bf16 v[92:95], v[100:103], v[136:139], 0
    v_mfma_f32_16x16x32_bf16 v[76:79], v[100:103], v[120:123], 0
    ds_read_b128 v[100:103], v58 offset:1664
    s_waitcnt lgkmcnt(2)
    v_mfma_f32_16x16x32_bf16 v[96:99], v[104:107], v[136:139], v[96:99]
    v_mfma_f32_16x16x32_bf16 v[92:95], v[104:107], v[132:135], v[92:95]
    v_mfma_f32_16x16x32_bf16 v[76:79], v[104:107], v[116:119], v[76:79]
    ds_read_b128 v[104:107], v58 offset:2176
    ds_read_b128 v[144:147], v59 offset:288
    ds_read_b128 v[148:151], v59 offset:800
    ds_read_b128 v[152:155], v59 offset:1312
    ds_read_b128 v[156:159], v59 offset:1824
    ds_read_b128 v[160:163], v59 offset:2336
    ds_read_b128 v[164:167], v59 offset:2848
    ds_read_b128 v[168:171], v59 offset:3360
    ds_read_b128 v[172:175], v59 offset:3872
    s_waitcnt lgkmcnt(10)
    v_mfma_f32_16x16x32_bf16 v[96:99], v[108:111], v[132:135], v[96:99]
    v_mfma_f32_16x16x32_bf16 v[92:95], v[108:111], v[128:131], v[92:95]
    v_mfma_f32_16x16x32_bf16 v[76:79], v[108:111], v[112:115], v[76:79]
    ds_read_b128 v[108:111], v58 offset:2688
    s_waitcnt lgkmcnt(10)
    v_mfma_f32_16x16x32_bf16 v[96:99], v[100:103], v[128:131], v[96:99]
    v_mfma_f32_16x16x32_bf16 v[92:95], v[100:103], v[124:127], v[92:95]
    ds_read_b128 v[100:103], v58 offset:3200
    s_waitcnt lgkmcnt(10)
    v_mfma_f32_16x16x32_bf16 v[96:99], v[104:107], v[124:127], v[96:99]
    v_mfma_f32_16x16x32_bf16 v[92:95], v[104:107], v[120:123], v[92:95]
    ds_read_b128 v[104:107], v58 offset:3712
    s_waitcnt lgkmcnt(2)
    v_mfma_f32_16x16x32_bf16 v[96:99], v[108:111], v[120:123], v[96:99]
    v_mfma_f32_16x16x32_bf16 v[92:95], v[108:111], v[116:119], v[92:95]
    ds_read_b128 v[108:111], v58 offset:192
    s_waitcnt lgkmcnt(2)
    v_mfma_f32_16x16x32_bf16 v[96:99], v[100:103], v[116:119], v[96:99]
    v_mfma_f32_16x16x32_bf16 v[92:95], v[100:103], v[112:115], v[92:95]
    ds_read_b128 v[100:103], v58 offset:704
    s_waitcnt lgkmcnt(2)
    v_mfma_f32_16x16x32_bf16 v[96:99], v[104:107], v[112:115], v[96:99]
    ds_read_b128 v[104:107], v58 offset:1216
    s_waitcnt lgkmcnt(2)
    v_mfma_f32_16x16x32_bf16 v[96:99], v[108:111], v[172:175], v[96:99]
    v_mfma_f32_16x16x32_bf16 v[92:95], v[108:111], v[168:171], v[92:95]
    v_mfma_f32_16x16x32_bf16 v[76:79], v[108:111], v[152:155], v[76:79]
    ds_read_b128 v[108:111], v58 offset:1728
    s_waitcnt lgkmcnt(2)
    v_mfma_f32_16x16x32_bf16 v[96:99], v[100:103], v[168:171], v[96:99]
    v_mfma_f32_16x16x32_bf16 v[92:95], v[100:103], v[164:167], v[92:95]
    v_mfma_f32_16x16x32_bf16 v[76:79], v[100:103], v[148:151], v[76:79]
    ds_read_b128 v[100:103], v58 offset:2240
    s_waitcnt lgkmcnt(2)
    v_mfma_f32_16x16x32_bf16 v[96:99], v[104:107], v[164:167], v[96:99]
    v_mfma_f32_16x16x32_bf16 v[92:95], v[104:107], v[160:163], v[92:95]
    v_mfma_f32_16x16x32_bf16 v[76:79], v[104:107], v[144:147], v[76:79]
    ds_read_b128 v[104:107], v58 offset:2752
    s_waitcnt lgkmcnt(2)
    v_mfma_f32_16x16x32_bf16 v[96:99], v[108:111], v[160:163], v[96:99]
    v_mfma_f32_16x16x32_bf16 v[92:95], v[108:111], v[156:159], v[92:95]
    ds_read_b128 v[108:111], v58 offset:3264
    s_waitcnt lgkmcnt(2)
    v_mfma_f32_16x16x32_bf16 v[96:99], v[100:103], v[156:159], v[96:99]
    v_mfma_f32_16x16x32_bf16 v[92:95], v[100:103], v[152:155], v[92:95]
    ds_read_b128 v[100:103], v58 offset:3776
    s_waitcnt lgkmcnt(2)
    v_mfma_f32_16x16x32_bf16 v[96:99], v[104:107], v[152:155], v[96:99]
    v_mfma_f32_16x16x32_bf16 v[92:95], v[104:107], v[148:151], v[92:95]
    s_waitcnt lgkmcnt(1)
    v_mfma_f32_16x16x32_bf16 v[96:99], v[108:111], v[148:151], v[96:99]
    v_mfma_f32_16x16x32_bf16 v[92:95], v[108:111], v[144:147], v[92:95]
    s_waitcnt lgkmcnt(0)
    v_mfma_f32_16x16x32_bf16 v[96:99], v[100:103], v[144:147], v[96:99]
    ds_write_b128 v66, v[76:79] offset:2048
    s_nop 4
    ds_write_b128 v66, v[92:95] offset:6144
    s_nop 0
    ds_write_b128 v66, v[96:99] offset:7168
    s_branch c_pw_end_23
c_pw_25:
    s_cmp_lg_u32 s34, 2
    s_cbranch_scc1 c_pw_26
    ds_read_b128 v[100:103], v58 offset:256
    ds_read_b128 v[112:115], v59 offset:224
    ds_read_b128 v[116:119], v59 offset:736
    ds_read_b128 v[120:123], v59 offset:1248
    ds_read_b128 v[124:127], v59 offset:1760
    ds_read_b128 v[128:131], v59 offset:2272
    ds_read_b128 v[132:135], v59 offset:2784
    ds_read_b128 v[136:139], v59 offset:3296
    ds_read_b128 v[140:143], v59 offset:3808
    ds_read_b128 v[104:107], v58 offset:768
    ds_read_b128 v[108:111], v58 offset:1280
    s_waitcnt lgkmcnt(2)
    v_mfma_f32_16x16x32_bf16 v[96:99], v[100:103], v[140:143], 0
    v_mfma_f32_16x16x32_bf16 v[92:95], v[100:103], v[136:139], 0
    v_mfma_f32_16x16x32_bf16 v[76:79], v[100:103], v[120:123], 0
    ds_read_b128 v[100:103], v58 offset:1792
    s_waitcnt lgkmcnt(2)
    v_mfma_f32_16x16x32_bf16 v[96:99], v[104:107], v[136:139], v[96:99]
    v_mfma_f32_16x16x32_bf16 v[92:95], v[104:107], v[132:135], v[92:95]
    v_mfma_f32_16x16x32_bf16 v[76:79], v[104:107], v[116:119], v[76:79]
    ds_read_b128 v[104:107], v58 offset:2304
    ds_read_b128 v[144:147], v59 offset:160
    ds_read_b128 v[148:151], v59 offset:672
    ds_read_b128 v[152:155], v59 offset:1184
    ds_read_b128 v[156:159], v59 offset:1696
    ds_read_b128 v[160:163], v59 offset:2208
    ds_read_b128 v[164:167], v59 offset:2720
    ds_read_b128 v[168:171], v59 offset:3232
    ds_read_b128 v[172:175], v59 offset:3744
    s_waitcnt lgkmcnt(10)
    v_mfma_f32_16x16x32_bf16 v[96:99], v[108:111], v[132:135], v[96:99]
    v_mfma_f32_16x16x32_bf16 v[92:95], v[108:111], v[128:131], v[92:95]
    v_mfma_f32_16x16x32_bf16 v[76:79], v[108:111], v[112:115], v[76:79]
    ds_read_b128 v[108:111], v58 offset:2816
    s_waitcnt lgkmcnt(10)
    v_mfma_f32_16x16x32_bf16 v[96:99], v[100:103], v[128:131], v[96:99]
    v_mfma_f32_16x16x32_bf16 v[92:95], v[100:103], v[124:127], v[92:95]
    ds_read_b128 v[100:103], v58 offset:3328
    s_waitcnt lgkmcnt(10)
    v_mfma_f32_16x16x32_bf16 v[96:99], v[104:107], v[124:127], v[96:99]
    v_mfma_f32_16x16x32_bf16 v[92:95], v[104:107], v[120:123], v[92:95]
    ds_read_b128 v[104:107], v58 offset:3840
    s_waitcnt lgkmcnt(2)
    v_mfma_f32_16x16x32_bf16 v[96:99], v[108:111], v[120:123], v[96:99]
    v_mfma_f32_16x16x32_bf16 v[92:95], v[108:111], v[116:119], v[92:95]
    ds_read_b128 v[108:111], v58 offset:320
    s_waitcnt lgkmcnt(2)
    v_mfma_f32_16x16x32_bf16 v[96:99], v[100:103], v[116:119], v[96:99]
    v_mfma_f32_16x16x32_bf16 v[92:95], v[100:103], v[112:115], v[92:95]
    ds_read_b128 v[100:103], v58 offset:832
    s_waitcnt lgkmcnt(2)
    v_mfma_f32_16x16x32_bf16 v[96:99], v[104:107], v[112:115], v[96:99]
    ds_read_b128 v[104:107], v58 offset:1344
    s_waitcnt lgkmcnt(2)
    v_mfma_f32_16x16x32_bf16 v[96:99], v[108:111], v[172:175], v[96:99]
    v_mfma_f32_16x16x32_bf16 v[92:95], v[108:111], v[168:171], v[92:95]
    v_mfma_f32_16x16x32_bf16 v[76:79], v[108:111], v[152:155], v[76:79]
    ds_read_b128 v[108:111], v58 offset:1856
    s_waitcnt lgkmcnt(2)
    v_mfma_f32_16x16x32_bf16 v[96:99], v[100:103], v[168:171], v[96:99]
    v_mfma_f32_16x16x32_bf16 v[92:95], v[100:103], v[164:167], v[92:95]
    v_mfma_f32_16x16x32_bf16 v[76:79], v[100:103], v[148:151], v[76:79]
    ds_read_b128 v[100:103], v58 offset:2368
    s_waitcnt lgkmcnt(2)
    v_mfma_f32_16x16x32_bf16 v[96:99], v[104:107], v[164:167], v[96:99]
    v_mfma_f32_16x16x32_bf16 v[92:95], v[104:107], v[160:163], v[92:95]
    v_mfma_f32_16x16x32_bf16 v[76:79], v[104:107], v[144:147], v[76:79]
    ds_read_b128 v[104:107], v58 offset:2880
    s_waitcnt lgkmcnt(2)
    v_mfma_f32_16x16x32_bf16 v[96:99], v[108:111], v[160:163], v[96:99]
    v_mfma_f32_16x16x32_bf16 v[92:95], v[108:111], v[156:159], v[92:95]
    ds_read_b128 v[108:111], v58 offset:3392
    s_waitcnt lgkmcnt(2)
    v_mfma_f32_16x16x32_bf16 v[96:99], v[100:103], v[156:159], v[96:99]
    v_mfma_f32_16x16x32_bf16 v[92:95], v[100:103], v[152:155], v[92:95]
    ds_read_b128 v[100:103], v58 offset:3904
    s_waitcnt lgkmcnt(2)
    v_mfma_f32_16x16x32_bf16 v[96:99], v[104:107], v[152:155], v[96:99]
    v_mfma_f32_16x16x32_bf16 v[92:95], v[104:107], v[148:151], v[92:95]
    s_waitcnt lgkmcnt(1)
    v_mfma_f32_16x16x32_bf16 v[96:99], v[108:111], v[148:151], v[96:99]
    v_mfma_f32_16x16x32_bf16 v[92:95], v[108:111], v[144:147], v[92:95]
    s_waitcnt lgkmcnt(0)
    v_mfma_f32_16x16x32_bf16 v[96:99], v[100:103], v[144:147], v[96:99]
    ds_write_b128 v66, v[76:79] offset:2048
    s_nop 4
    ds_write_b128 v66, v[92:95] offset:6144
    s_nop 0
    ds_write_b128 v66, v[96:99] offset:7168
    s_branch c_pw_end_23
c_pw_26:
    ds_read_b128 v[100:103], v58 offset:384
    ds_read_b128 v[112:115], v59 offset:96
    ds_read_b128 v[116:119], v59 offset:608
    ds_read_b128 v[120:123], v59 offset:1120
    ds_read_b128 v[124:127], v59 offset:1632
    ds_read_b128 v[128:131], v59 offset:2144
    ds_read_b128 v[132:135], v59 offset:2656
    ds_read_b128 v[136:139], v59 offset:3168
    ds_read_b128 v[140:143], v59 offset:3680
    ds_read_b128 v[104:107], v58 offset:896
    ds_read_b128 v[108:111], v58 offset:1408
    s_waitcnt lgkmcnt(2)
    v_mfma_f32_16x16x32_bf16 v[96:99], v[100:103], v[140:143], 0
    v_mfma_f32_16x16x32_bf16 v[92:95], v[100:103], v[136:139], 0
    v_mfma_f32_16x16x32_bf16 v[76:79], v[100:103], v[120:123], 0
    ds_read_b128 v[100:103], v58 offset:1920
    s_waitcnt lgkmcnt(2)
    v_mfma_f32_16x16x32_bf16 v[96:99], v[104:107], v[136:139], v[96:99]
    v_mfma_f32_16x16x32_bf16 v[92:95], v[104:107], v[132:135], v[92:95]
    v_mfma_f32_16x16x32_bf16 v[76:79], v[104:107], v[116:119], v[76:79]
    ds_read_b128 v[104:107], v58 offset:2432
    ds_read_b128 v[144:147], v59 offset:32
    ds_read_b128 v[148:151], v59 offset:544
    ds_read_b128 v[152:155], v59 offset:1056
    ds_read_b128 v[156:159], v59 offset:1568
    ds_read_b128 v[160:163], v59 offset:2080
    ds_read_b128 v[164:167], v59 offset:2592
    ds_read_b128 v[168:171], v59 offset:3104
    ds_read_b128 v[172:175], v59 offset:3616
    s_waitcnt lgkmcnt(10)
    v_mfma_f32_16x16x32_bf16 v[96:99], v[108:111], v[132:135], v[96:99]
    v_mfma_f32_16x16x32_bf16 v[92:95], v[108:111], v[128:131], v[92:95]
    v_mfma_f32_16x16x32_bf16 v[76:79], v[108:111], v[112:115], v[76:79]
    ds_read_b128 v[108:111], v58 offset:2944
    s_waitcnt lgkmcnt(10)
    v_mfma_f32_16x16x32_bf16 v[96:99], v[100:103], v[128:131], v[96:99]
    v_mfma_f32_16x16x32_bf16 v[92:95], v[100:103], v[124:127], v[92:95]
    ds_read_b128 v[100:103], v58 offset:3456
    s_waitcnt lgkmcnt(10)
    v_mfma_f32_16x16x32_bf16 v[96:99], v[104:107], v[124:127], v[96:99]
    v_mfma_f32_16x16x32_bf16 v[92:95], v[104:107], v[120:123], v[92:95]
    ds_read_b128 v[104:107], v58 offset:3968
    s_waitcnt lgkmcnt(2)
    v_mfma_f32_16x16x32_bf16 v[96:99], v[108:111], v[120:123], v[96:99]
    v_mfma_f32_16x16x32_bf16 v[92:95], v[108:111], v[116:119], v[92:95]
    ds_read_b128 v[108:111], v58 offset:448
    s_waitcnt lgkmcnt(2)
    v_mfma_f32_16x16x32_bf16 v[96:99], v[100:103], v[116:119], v[96:99]
    v_mfma_f32_16x16x32_bf16 v[92:95], v[100:103], v[112:115], v[92:95]
    ds_read_b128 v[100:103], v58 offset:960
    s_waitcnt lgkmcnt(2)
    v_mfma_f32_16x16x32_bf16 v[96:99], v[104:107], v[112:115], v[96:99]
    ds_read_b128 v[104:107], v58 offset:1472
    s_waitcnt lgkmcnt(2)
    v_mfma_f32_16x16x32_bf16 v[96:99], v[108:111], v[172:175], v[96:99]
    v_mfma_f32_16x16x32_bf16 v[92:95], v[108:111], v[168:171], v[92:95]
    v_mfma_f32_16x16x32_bf16 v[76:79], v[108:111], v[152:155], v[76:79]
    ds_read_b128 v[108:111], v58 offset:1984
    s_waitcnt lgkmcnt(2)
    v_mfma_f32_16x16x32_bf16 v[96:99], v[100:103], v[168:171], v[96:99]
    v_mfma_f32_16x16x32_bf16 v[92:95], v[100:103], v[164:167], v[92:95]
    v_mfma_f32_16x16x32_bf16 v[76:79], v[100:103], v[148:151], v[76:79]
    ds_read_b128 v[100:103], v58 offset:2496
    s_waitcnt lgkmcnt(2)
    v_mfma_f32_16x16x32_bf16 v[96:99], v[104:107], v[164:167], v[96:99]
    v_mfma_f32_16x16x32_bf16 v[92:95], v[104:107], v[160:163], v[92:95]
    v_mfma_f32_16x16x32_bf16 v[76:79], v[104:107], v[144:147], v[76:79]
    ds_read_b128 v[104:107], v58 offset:3008
    s_waitcnt lgkmcnt(2)
    v_mfma_f32_16x16x32_bf16 v[96:99], v[108:111], v[160:163], v[96:99]
    v_mfma_f32_16x16x32_bf16 v[92:95], v[108:111], v[156:159], v[92:95]
    ds_read_b128 v[108:111], v58 offset:3520
    s_waitcnt lgkmcnt(2)
    v_mfma_f32_16x16x32_bf16 v[96:99], v[100:103], v[156:159], v[96:99]
    v_mfma_f32_16x16x32_bf16 v[92:95], v[100:103], v[152:155], v[92:95]
    ds_read_b128 v[100:103], v58 offset:4032
    s_waitcnt lgkmcnt(2)
    v_mfma_f32_16x16x32_bf16 v[96:99], v[104:107], v[152:155], v[96:99]
    v_mfma_f32_16x16x32_bf16 v[92:95], v[104:107], v[148:151], v[92:95]
    s_waitcnt lgkmcnt(1)
    v_mfma_f32_16x16x32_bf16 v[96:99], v[108:111], v[148:151], v[96:99]
    v_mfma_f32_16x16x32_bf16 v[92:95], v[108:111], v[144:147], v[92:95]
    s_waitcnt lgkmcnt(0)
    v_mfma_f32_16x16x32_bf16 v[96:99], v[100:103], v[144:147], v[96:99]
    ds_write_b128 v66, v[76:79] offset:2048
    s_nop 4
    ds_write_b128 v66, v[92:95] offset:6144
    s_nop 0
    ds_write_b128 v66, v[96:99] offset:7168
c_pw_end_23:
    s_waitcnt lgkmcnt(0)
    s_barrier
    s_mov_b64 exec, 0
    s_cmp_eq_u32 s34, 0
    s_cselect_b32 exec_lo, 0, exec_lo
    s_cselect_b32 exec_hi, 0, exec_hi
    s_cmp_eq_u32 s34, 1
    s_cselect_b32 exec_lo, -1, exec_lo
    s_cselect_b32 exec_hi, 0, exec_hi
    s_cmp_eq_u32 s34, 2
    s_cselect_b32 exec_lo, 0, exec_lo
    s_cselect_b32 exec_hi, 0, exec_hi
    s_cmp_eq_u32 s34, 3
    s_cselect_b32 exec_lo, -1, exec_lo
    s_cselect_b32 exec_hi, -1, exec_hi
    s_cbranch_execz c_fskip_29
    ds_read_b128 v[112:115], v67 offset:0
    ds_read_b128 v[116:119], v67 offset:16
    ds_read_b128 v[120:123], v67 offset:8192
    ds_read_b128 v[124:127], v67 offset:8208
    ds_read_b128 v[128:131], v67 offset:16384
    ds_read_b128 v[132:135], v67 offset:16400
    ds_read_b128 v[136:139], v67 offset:24576
    ds_read_b128 v[140:143], v67 offset:24592
    s_lshl_b32 s40, s58, 12
    s_add_u32 s40, s40, 8912896
    s_waitcnt lgkmcnt(0)
    v_pk_add_f32 v[112:113], v[112:113], v[120:121]
    v_pk_add_f32 v[128:129], v[128:129], v[136:137]
    v_pk_add_f32 v[114:115], v[114:115], v[122:123]
    v_pk_add_f32 v[130:131], v[130:131], v[138:139]
    v_pk_add_f32 v[116:117], v[116:117], v[124:125]
    v_pk_add_f32 v[132:133], v[132:133], v[140:141]
    v_pk_add_f32 v[118:119], v[118:119], v[126:127]
    v_pk_add_f32 v[134:135], v[134:135], v[142:143]
    v_pk_add_f32 v[112:113], v[112:113], v[128:129]
    v_pk_add_f32 v[114:115], v[114:115], v[130:131]
    v_pk_add_f32 v[116:117], v[116:117], v[132:133]
    v_pk_add_f32 v[118:119], v[118:119], v[134:135]
    v_cvt_pk_bf16_f32 v184, v112, v113
    v_cvt_pk_bf16_f32 v185, v114, v115
    v_cvt_pk_bf16_f32 v186, v116, v117
    v_cvt_pk_bf16_f32 v187, v118, v119
    buffer_store_dwordx4 v[184:187], v2, s[8:11], s40 offen sc1
c_fskip_29:
    s_mov_b64 exec, -1
    s_nop 1
    s_branch c_halfE_22
c_halfB_21:
    s_cmp_lg_u32 s34, 0
    s_cbranch_scc1 c_pw_31
    ds_read_b128 v[100:103], v58 offset:0
    ds_read_b128 v[112:115], v59 offset:480
    ds_read_b128 v[116:119], v59 offset:992
    ds_read_b128 v[120:123], v59 offset:1504
    ds_read_b128 v[124:127], v59 offset:2016
    ds_read_b128 v[128:131], v59 offset:2528
    ds_read_b128 v[132:135], v59 offset:3040
    ds_read_b128 v[104:107], v58 offset:512
    ds_read_b128 v[108:111], v58 offset:1024
    s_waitcnt lgkmcnt(2)
    v_mfma_f32_16x16x32_bf16 v[88:91], v[100:103], v[132:135], 0
    v_mfma_f32_16x16x32_bf16 v[84:87], v[100:103], v[128:131], 0
    v_mfma_f32_16x16x32_bf16 v[80:83], v[100:103], v[124:127], 0
    v_mfma_f32_16x16x32_bf16 v[72:75], v[100:103], v[116:119], 0
    v_mfma_f32_16x16x32_bf16 v[68:71], v[100:103], v[112:115], 0
    v_mfma_f32_16x16x32_bf16 v[68:71], v[188:191], v[112:115], v[68:71]
    v_mfma_f32_16x16x32_bf16 v[72:75], v[188:191], v[116:119], v[72:75]
    v_mfma_f32_16x16x32_bf16 v[80:83], v[188:191], v[124:127], v[80:83]
    v_mfma_f32_16x16x32_bf16 v[84:87], v[188:191], v[128:131], v[84:87]
    v_mfma_f32_16x16x32_bf16 v[88:91], v[188:191], v[132:135], v[88:91]
    ds_read_b128 v[100:103], v58 offset:1536
    s_waitcnt lgkmcnt(2)
    v_mfma_f32_16x16x32_bf16 v[88:91], v[104:107], v[128:131], v[88:91]
    v_mfma_f32_16x16x32_bf16 v[84:87], v[104:107], v[124:127], v[84:87]
    v_mfma_f32_16x16x32_bf16 v[80:83], v[104:107], v[120:123], v[80:83]
    v_mfma_f32_16x16x32_bf16 v[72:75], v[104:107], v[112:115], v[72:75]
    ds_read_b128 v[104:107], v58 offset:2048
    ds_read_b128 v[144:147], v59 offset:416
    ds_read_b128 v[148:151], v59 offset:928
    ds_read_b128 v[152:155], v59 offset:1440
    ds_read_b128 v[156:159], v59 offset:1952
    ds_read_b128 v[160:163], v59 offset:2464
    ds_read_b128 v[164:167], v59 offset:2976
    s_waitcnt lgkmcnt(8)
    v_mfma_f32_16x16x32_bf16 v[88:91], v[108:111], v[124:127], v[88:91]
    v_mfma_f32_16x16x32_bf16 v[84:87], v[108:111], v[120:123], v[84:87]
    v_mfma_f32_16x16x32_bf16 v[80:83], v[108:111], v[116:119], v[80:83]
    ds_read_b128 v[108:111], v58 offset:2560
    s_waitcnt lgkmcnt(8)
    v_mfma_f32_16x16x32_bf16 v[88:91], v[100:103], v[120:123], v[88:91]
    v_mfma_f32_16x16x32_bf16 v[84:87], v[100:103], v[116:119], v[84:87]
    v_mfma_f32_16x16x32_bf16 v[80:83], v[100:103], v[112:115], v[80:83]
    ds_read_b128 v[100:103], v58 offset:64
    s_waitcnt lgkmcnt(8)
    v_mfma_f32_16x16x32_bf16 v[88:91], v[104:107], v[116:119], v[88:91]
    v_mfma_f32_16x16x32_bf16 v[84:87], v[104:107], v[112:115], v[84:87]
    ds_read_b128 v[104:107], v58 offset:576
    s_waitcnt lgkmcnt(2)
    v_mfma_f32_16x16x32_bf16 v[88:91], v[108:111], v[112:115], v[88:91]
    ds_read_b128 v[108:111], v58 offset:1088
    s_waitcnt lgkmcnt(2)
    v_mfma_f32_16x16x32_bf16 v[88:91], v[100:103], v[164:167], v[88:91]
    v_mfma_f32_16x16x32_bf16 v[84:87], v[100:103], v[160:163], v[84:87]
    v_mfma_f32_16x16x32_bf16 v[80:83], v[100:103], v[156:159], v[80:83]
    v_mfma_f32_16x16x32_bf16 v[72:75], v[100:103], v[148:151], v[72:75]
    v_mfma_f32_16x16x32_bf16 v[68:71], v[100:103], v[144:147], v[68:71]
    ds_read_b128 v[100:103], v58 offset:1600
    s_waitcnt lgkmcnt(2)
    v_mfma_f32_16x16x32_bf16 v[88:91], v[104:107], v[160:163], v[88:91]
    v_mfma_f32_16x16x32_bf16 v[84:87], v[104:107], v[156:159], v[84:87]
    v_mfma_f32_16x16x32_bf16 v[80:83], v[104:107], v[152:155], v[80:83]
    v_mfma_f32_16x16x32_bf16 v[72:75], v[104:107], v[144:147], v[72:75]
    ds_read_b128 v[104:107], v58 offset:2112
    s_waitcnt lgkmcnt(2)
    v_mfma_f32_16x16x32_bf16 v[88:91], v[108:111], v[156:159], v[88:91]
    v_mfma_f32_16x16x32_bf16 v[84:87], v[108:111], v[152:155], v[84:87]
    v_mfma_f32_16x16x32_bf16 v[80:83], v[108:111], v[148:151], v[80:83]
    ds_read_b128 v[108:111], v58 offset:2624
    s_waitcnt lgkmcnt(2)
    v_mfma_f32_16x16x32_bf16 v[88:91], v[100:103], v[152:155], v[88:91]
    v_mfma_f32_16x16x32_bf16 v[84:87], v[100:103], v[148:151], v[84:87]
    v_mfma_f32_16x16x32_bf16 v[80:83], v[100:103], v[144:147], v[80:83]
    s_waitcnt lgkmcnt(1)
    v_mfma_f32_16x16x32_bf16 v[88:91], v[104:107], v[148:151], v[88:91]
    v_mfma_f32_16x16x32_bf16 v[84:87], v[104:107], v[144:147], v[84:87]
    s_waitcnt lgkmcnt(0)
    v_mfma_f32_16x16x32_bf16 v[88:91], v[108:111], v[144:147], v[88:91]
    ds_write_b128 v66, v[68:71] offset:0
    ds_write_b128 v66, v[72:75] offset:1024
    s_nop 0
    ds_write_b128 v66, v[80:83] offset:3072
    s_nop 1
    ds_write_b128 v66, v[84:87] offset:4096
    s_nop 0
    ds_write_b128 v66, v[88:91] offset:5120
    s_branch c_pw_end_30
c_pw_31:
    s_cmp_lg_u32 s34, 1
    s_cbranch_scc1 c_pw_32
    ds_read_b128 v[100:103], v58 offset:128
    ds_read_b128 v[112:115], v59 offset:352
    ds_read_b128 v[116:119], v59 offset:864
    ds_read_b128 v[120:123], v59 offset:1376
    ds_read_b128 v[124:127], v59 offset:1888
    ds_read_b128 v[128:131], v59 offset:2400
    ds_read_b128 v[132:135], v59 offset:2912
    ds_read_b128 v[104:107], v58 offset:640
    ds_read_b128 v[108:111], v58 offset:1152
    s_waitcnt lgkmcnt(2)
    v_mfma_f32_16x16x32_bf16 v[88:91], v[100:103], v[132:135], 0
    v_mfma_f32_16x16x32_bf16 v[84:87], v[100:103], v[128:131], 0
    v_mfma_f32_16x16x32_bf16 v[80:83], v[100:103], v[124:127], 0
    v_mfma_f32_16x16x32_bf16 v[72:75], v[100:103], v[116:119], 0
    v_mfma_f32_16x16x32_bf16 v[68:71], v[100:103], v[112:115], 0
    ds_read_b128 v[100:103], v58 offset:1664
    s_waitcnt lgkmcnt(2)
    v_mfma_f32_16x16x32_bf16 v[88:91], v[104:107], v[128:131], v[88:91]
    v_mfma_f32_16x16x32_bf16 v[84:87], v[104:107], v[124:127], v[84:87]
    v_mfma_f32_16x16x32_bf16 v[80:83], v[104:107], v[120:123], v[80:83]
    v_mfma_f32_16x16x32_bf16 v[72:75], v[104:107], v[112:115], v[72:75]
    ds_read_b128 v[104:107], v58 offset:2176
    ds_read_b128 v[144:147], v59 offset:288
    ds_read_b128 v[148:151], v59 offset:800
    ds_read_b128 v[152:155], v59 offset:1312
    ds_read_b128 v[156:159], v59 offset:1824
    ds_read_b128 v[160:163], v59 offset:2336
    ds_read_b128 v[164:167], v59 offset:2848
    s_waitcnt lgkmcnt(8)
    v_mfma_f32_16x16x32_bf16 v[88:91], v[108:111], v[124:127], v[88:91]
    v_mfma_f32_16x16x32_bf16 v[84:87], v[108:111], v[120:123], v[84:87]
    v_mfma_f32_16x16x32_bf16 v[80:83], v[108:111], v[116:119], v[80:83]
    ds_read_b128 v[108:111], v58 offset:2688
    s_waitcnt lgkmcnt(8)
    v_mfma_f32_16x16x32_bf16 v[88:91], v[100:103], v[120:123], v[88:91]
    v_mfma_f32_16x16x32_bf16 v[84:87], v[100:103], v[116:119], v[84:87]
    v_mfma_f32_16x16x32_bf16 v[80:83], v[100:103], v[112:115], v[80:83]
    ds_read_b128 v[100:103], v58 offset:192
    s_waitcnt lgkmcnt(8)
    v_mfma_f32_16x16x32_bf16 v[88:91], v[104:107], v[116:119], v[88:91]
    v_mfma_f32_16x16x32_bf16 v[84:87], v[104:107], v[112:115], v[84:87]
    ds_read_b128 v[104:107], v58 offset:704
    s_waitcnt lgkmcnt(2)
    v_mfma_f32_16x16x32_bf16 v[88:91], v[108:111], v[112:115], v[88:91]
    ds_read_b128 v[108:111], v58 offset:1216
    s_waitcnt lgkmcnt(2)
    v_mfma_f32_16x16x32_bf16 v[88:91], v[100:103], v[164:167], v[88:91]
    v_mfma_f32_16x16x32_bf16 v[84:87], v[100:103], v[160:163], v[84:87]
    v_mfma_f32_16x16x32_bf16 v[80:83], v[100:103], v[156:159], v[80:83]
    v_mfma_f32_16x16x32_bf16 v[72:75], v[100:103], v[148:151], v[72:75]
    v_mfma_f32_16x16x32_bf16 v[68:71], v[100:103], v[144:147], v[68:71]
    ds_read_b128 v[100:103], v58 offset:1728
    s_waitcnt lgkmcnt(2)
    v_mfma_f32_16x16x32_bf16 v[88:91], v[104:107], v[160:163], v[88:91]
    v_mfma_f32_16x16x32_bf16 v[84:87], v[104:107], v[156:159], v[84:87]
    v_mfma_f32_16x16x32_bf16 v[80:83], v[104:107], v[152:155], v[80:83]
    v_mfma_f32_16x16x32_bf16 v[72:75], v[104:107], v[144:147], v[72:75]
    ds_read_b128 v[104:107], v58 offset:2240
    s_waitcnt lgkmcnt(2)
    v_mfma_f32_16x16x32_bf16 v[88:91], v[108:111], v[156:159], v[88:91]
    v_mfma_f32_16x16x32_bf16 v[84:87], v[108:111], v[152:155], v[84:87]
    v_mfma_f32_16x16x32_bf16 v[80:83], v[108:111], v[148:151], v[80:83]
    ds_read_b128 v[108:111], v58 offset:2752
    s_waitcnt lgkmcnt(2)
    v_mfma_f32_16x16x32_bf16 v[88:91], v[100:103], v[152:155], v[88:91]
    v_mfma_f32_16x16x32_bf16 v[84:87], v[100:103], v[148:151], v[84:87]
    v_mfma_f32_16x16x32_bf16 v[80:83], v[100:103], v[144:147], v[80:83]
    s_waitcnt lgkmcnt(1)
    v_mfma_f32_16x16x32_bf16 v[88:91], v[104:107], v[148:151], v[88:91]
    v_mfma_f32_16x16x32_bf16 v[84:87], v[104:107], v[144:147], v[84:87]
    s_waitcnt lgkmcnt(0)
    v_mfma_f32_16x16x32_bf16 v[88:91], v[108:111], v[144:147], v[88:91]
    ds_write_b128 v66, v[68:71] offset:0
    ds_write_b128 v66, v[72:75] offset:1024
    s_nop 0
    ds_write_b128 v66, v[80:83] offset:3072
    s_nop 1
    ds_write_b128 v66, v[84:87] offset:4096
    s_nop 0
    ds_write_b128 v66, v[88:91] offset:5120
    s_branch c_pw_end_30
c_pw_32:
    s_cmp_lg_u32 s34, 2
    s_cbranch_scc1 c_pw_33
    ds_read_b128 v[100:103], v58 offset:256
    ds_read_b128 v[112:115], v59 offset:224
    ds_read_b128 v[116:119], v59 offset:736
    ds_read_b128 v[120:123], v59 offset:1248
    ds_read_b128 v[124:127], v59 offset:1760
    ds_read_b128 v[128:131], v59 offset:2272
    ds_read_b128 v[132:135], v59 offset:2784
    ds_read_b128 v[104:107], v58 offset:768
    ds_read_b128 v[108:111], v58 offset:1280
    s_waitcnt lgkmcnt(2)
    v_mfma_f32_16x16x32_bf16 v[88:91], v[100:103], v[132:135], 0
    v_mfma_f32_16x16x32_bf16 v[84:87], v[100:103], v[128:131], 0
    v_mfma_f32_16x16x32_bf16 v[80:83], v[100:103], v[124:127], 0
    v_mfma_f32_16x16x32_bf16 v[72:75], v[100:103], v[116:119], 0
    v_mfma_f32_16x16x32_bf16 v[68:71], v[100:103], v[112:115], 0
    ds_read_b128 v[100:103], v58 offset:1792
    s_waitcnt lgkmcnt(2)
    v_mfma_f32_16x16x32_bf16 v[88:91], v[104:107], v[128:131], v[88:91]
    v_mfma_f32_16x16x32_bf16 v[84:87], v[104:107], v[124:127], v[84:87]
    v_mfma_f32_16x16x32_bf16 v[80:83], v[104:107], v[120:123], v[80:83]
    v_mfma_f32_16x16x32_bf16 v[72:75], v[104:107], v[112:115], v[72:75]
    ds_read_b128 v[104:107], v58 offset:2304
    ds_read_b128 v[144:147], v59 offset:160
    ds_read_b128 v[148:151], v59 offset:672
    ds_read_b128 v[152:155], v59 offset:1184
    ds_read_b128 v[156:159], v59 offset:1696
    ds_read_b128 v[160:163], v59 offset:2208
    ds_read_b128 v[164:167], v59 offset:2720
    s_waitcnt lgkmcnt(8)
    v_mfma_f32_16x16x32_bf16 v[88:91], v[108:111], v[124:127], v[88:91]
    v_mfma_f32_16x16x32_bf16 v[84:87], v[108:111], v[120:123], v[84:87]
    v_mfma_f32_16x16x32_bf16 v[80:83], v[108:111], v[116:119], v[80:83]
    ds_read_b128 v[108:111], v58 offset:2816
    s_waitcnt lgkmcnt(8)
    v_mfma_f32_16x16x32_bf16 v[88:91], v[100:103], v[120:123], v[88:91]
    v_mfma_f32_16x16x32_bf16 v[84:87], v[100:103], v[116:119], v[84:87]
    v_mfma_f32_16x16x32_bf16 v[80:83], v[100:103], v[112:115], v[80:83]
    ds_read_b128 v[100:103], v58 offset:320
    s_waitcnt lgkmcnt(8)
    v_mfma_f32_16x16x32_bf16 v[88:91], v[104:107], v[116:119], v[88:91]
    v_mfma_f32_16x16x32_bf16 v[84:87], v[104:107], v[112:115], v[84:87]
    ds_read_b128 v[104:107], v58 offset:832
    s_waitcnt lgkmcnt(2)
    v_mfma_f32_16x16x32_bf16 v[88:91], v[108:111], v[112:115], v[88:91]
    ds_read_b128 v[108:111], v58 offset:1344
    s_waitcnt lgkmcnt(2)
    v_mfma_f32_16x16x32_bf16 v[88:91], v[100:103], v[164:167], v[88:91]
    v_mfma_f32_16x16x32_bf16 v[84:87], v[100:103], v[160:163], v[84:87]
    v_mfma_f32_16x16x32_bf16 v[80:83], v[100:103], v[156:159], v[80:83]
    v_mfma_f32_16x16x32_bf16 v[72:75], v[100:103], v[148:151], v[72:75]
    v_mfma_f32_16x16x32_bf16 v[68:71], v[100:103], v[144:147], v[68:71]
    ds_read_b128 v[100:103], v58 offset:1856
    s_waitcnt lgkmcnt(2)
    v_mfma_f32_16x16x32_bf16 v[88:91], v[104:107], v[160:163], v[88:91]
    v_mfma_f32_16x16x32_bf16 v[84:87], v[104:107], v[156:159], v[84:87]
    v_mfma_f32_16x16x32_bf16 v[80:83], v[104:107], v[152:155], v[80:83]
    v_mfma_f32_16x16x32_bf16 v[72:75], v[104:107], v[144:147], v[72:75]
    ds_read_b128 v[104:107], v58 offset:2368
    s_waitcnt lgkmcnt(2)
    v_mfma_f32_16x16x32_bf16 v[88:91], v[108:111], v[156:159], v[88:91]
    v_mfma_f32_16x16x32_bf16 v[84:87], v[108:111], v[152:155], v[84:87]
    v_mfma_f32_16x16x32_bf16 v[80:83], v[108:111], v[148:151], v[80:83]
    ds_read_b128 v[108:111], v58 offset:2880
    s_waitcnt lgkmcnt(2)
    v_mfma_f32_16x16x32_bf16 v[88:91], v[100:103], v[152:155], v[88:91]
    v_mfma_f32_16x16x32_bf16 v[84:87], v[100:103], v[148:151], v[84:87]
    v_mfma_f32_16x16x32_bf16 v[80:83], v[100:103], v[144:147], v[80:83]
    s_waitcnt lgkmcnt(1)
    v_mfma_f32_16x16x32_bf16 v[88:91], v[104:107], v[148:151], v[88:91]
    v_mfma_f32_16x16x32_bf16 v[84:87], v[104:107], v[144:147], v[84:87]
    s_waitcnt lgkmcnt(0)
    v_mfma_f32_16x16x32_bf16 v[88:91], v[108:111], v[144:147], v[88:91]
    ds_write_b128 v66, v[68:71] offset:0
    ds_write_b128 v66, v[72:75] offset:1024
    s_nop 0
    ds_write_b128 v66, v[80:83] offset:3072
    s_nop 1
    ds_write_b128 v66, v[84:87] offset:4096
    s_nop 0
    ds_write_b128 v66, v[88:91] offset:5120
    s_branch c_pw_end_30
c_pw_33:
    ds_read_b128 v[100:103], v58 offset:384
    ds_read_b128 v[112:115], v59 offset:96
    ds_read_b128 v[116:119], v59 offset:608
    ds_read_b128 v[120:123], v59 offset:1120
    ds_read_b128 v[124:127], v59 offset:1632
    ds_read_b128 v[128:131], v59 offset:2144
    ds_read_b128 v[132:135], v59 offset:2656
    ds_read_b128 v[104:107], v58 offset:896
    ds_read_b128 v[108:111], v58 offset:1408
    s_waitcnt lgkmcnt(2)
    v_mfma_f32_16x16x32_bf16 v[88:91], v[100:103], v[132:135], 0
    v_mfma_f32_16x16x32_bf16 v[84:87], v[100:103], v[128:131], 0
    v_mfma_f32_16x16x32_bf16 v[80:83], v[100:103], v[124:127], 0
    v_mfma_f32_16x16x32_bf16 v[72:75], v[100:103], v[116:119], 0
    v_mfma_f32_16x16x32_bf16 v[68:71], v[100:103], v[112:115], 0
    ds_read_b128 v[100:103], v58 offset:1920
    s_waitcnt lgkmcnt(2)
    v_mfma_f32_16x16x32_bf16 v[88:91], v[104:107], v[128:131], v[88:91]
    v_mfma_f32_16x16x32_bf16 v[84:87], v[104:107], v[124:127], v[84:87]
    v_mfma_f32_16x16x32_bf16 v[80:83], v[104:107], v[120:123], v[80:83]
    v_mfma_f32_16x16x32_bf16 v[72:75], v[104:107], v[112:115], v[72:75]
    ds_read_b128 v[104:107], v58 offset:2432
    ds_read_b128 v[144:147], v59 offset:32
    ds_read_b128 v[148:151], v59 offset:544
    ds_read_b128 v[152:155], v59 offset:1056
    ds_read_b128 v[156:159], v59 offset:1568
    ds_read_b128 v[160:163], v59 offset:2080
    ds_read_b128 v[164:167], v59 offset:2592
    s_waitcnt lgkmcnt(8)
    v_mfma_f32_16x16x32_bf16 v[88:91], v[108:111], v[124:127], v[88:91]
    v_mfma_f32_16x16x32_bf16 v[84:87], v[108:111], v[120:123], v[84:87]
    v_mfma_f32_16x16x32_bf16 v[80:83], v[108:111], v[116:119], v[80:83]
    ds_read_b128 v[108:111], v58 offset:2944
    s_waitcnt lgkmcnt(8)
    v_mfma_f32_16x16x32_bf16 v[88:91], v[100:103], v[120:123], v[88:91]
    v_mfma_f32_16x16x32_bf16 v[84:87], v[100:103], v[116:119], v[84:87]
    v_mfma_f32_16x16x32_bf16 v[80:83], v[100:103], v[112:115], v[80:83]
    ds_read_b128 v[100:103], v58 offset:448
    s_waitcnt lgkmcnt(8)
    v_mfma_f32_16x16x32_bf16 v[88:91], v[104:107], v[116:119], v[88:91]
    v_mfma_f32_16x16x32_bf16 v[84:87], v[104:107], v[112:115], v[84:87]
    ds_read_b128 v[104:107], v58 offset:960
    s_waitcnt lgkmcnt(2)
    v_mfma_f32_16x16x32_bf16 v[88:91], v[108:111], v[112:115], v[88:91]
    ds_read_b128 v[108:111], v58 offset:1472
    s_waitcnt lgkmcnt(2)
    v_mfma_f32_16x16x32_bf16 v[88:91], v[100:103], v[164:167], v[88:91]
    v_mfma_f32_16x16x32_bf16 v[84:87], v[100:103], v[160:163], v[84:87]
    v_mfma_f32_16x16x32_bf16 v[80:83], v[100:103], v[156:159], v[80:83]
    v_mfma_f32_16x16x32_bf16 v[72:75], v[100:103], v[148:151], v[72:75]
    v_mfma_f32_16x16x32_bf16 v[68:71], v[100:103], v[144:147], v[68:71]
    ds_read_b128 v[100:103], v58 offset:1984
    s_waitcnt lgkmcnt(2)
    v_mfma_f32_16x16x32_bf16 v[88:91], v[104:107], v[160:163], v[88:91]
    v_mfma_f32_16x16x32_bf16 v[84:87], v[104:107], v[156:159], v[84:87]
    v_mfma_f32_16x16x32_bf16 v[80:83], v[104:107], v[152:155], v[80:83]
    v_mfma_f32_16x16x32_bf16 v[72:75], v[104:107], v[144:147], v[72:75]
    ds_read_b128 v[104:107], v58 offset:2496
    s_waitcnt lgkmcnt(2)
    v_mfma_f32_16x16x32_bf16 v[88:91], v[108:111], v[156:159], v[88:91]
    v_mfma_f32_16x16x32_bf16 v[84:87], v[108:111], v[152:155], v[84:87]
    v_mfma_f32_16x16x32_bf16 v[80:83], v[108:111], v[148:151], v[80:83]
    ds_read_b128 v[108:111], v58 offset:3008
    s_waitcnt lgkmcnt(2)
    v_mfma_f32_16x16x32_bf16 v[88:91], v[100:103], v[152:155], v[88:91]
    v_mfma_f32_16x16x32_bf16 v[84:87], v[100:103], v[148:151], v[84:87]
    v_mfma_f32_16x16x32_bf16 v[80:83], v[100:103], v[144:147], v[80:83]
    s_waitcnt lgkmcnt(1)
    v_mfma_f32_16x16x32_bf16 v[88:91], v[104:107], v[148:151], v[88:91]
    v_mfma_f32_16x16x32_bf16 v[84:87], v[104:107], v[144:147], v[84:87]
    s_waitcnt lgkmcnt(0)
    v_mfma_f32_16x16x32_bf16 v[88:91], v[108:111], v[144:147], v[88:91]
    ds_write_b128 v66, v[68:71] offset:0
    ds_write_b128 v66, v[72:75] offset:1024
    s_nop 0
    ds_write_b128 v66, v[80:83] offset:3072
    s_nop 1
    ds_write_b128 v66, v[84:87] offset:4096
    s_nop 0
    ds_write_b128 v66, v[88:91] offset:5120
c_pw_end_30:
    s_waitcnt lgkmcnt(0)
    s_barrier
    s_mov_b64 exec, 0
    s_cmp_eq_u32 s34, 0
    s_cselect_b32 exec_lo, -1, exec_lo
    s_cselect_b32 exec_hi, -1, exec_hi
    s_cmp_eq_u32 s34, 1
    s_cselect_b32 exec_lo, 0, exec_lo
    s_cselect_b32 exec_hi, -1, exec_hi
    s_cmp_eq_u32 s34, 2
    s_cselect_b32 exec_lo, -1, exec_lo
    s_cselect_b32 exec_hi, -1, exec_hi
    s_cmp_eq_u32 s34, 3
    s_cselect_b32 exec_lo, 0, exec_lo
    s_cselect_b32 exec_hi, 0, exec_hi
    s_cbranch_execz c_fskip_36
    ds_read_b128 v[112:115], v67 offset:0
    ds_read_b128 v[116:119], v67 offset:16
    ds_read_b128 v[120:123], v67 offset:8192
    ds_read_b128 v[124:127], v67 offset:8208
    ds_read_b128 v[128:131], v67 offset:16384
    ds_read_b128 v[132:135], v67 offset:16400
    ds_read_b128 v[136:139], v67 offset:24576
    ds_read_b128 v[140:143], v67 offset:24592
    s_lshl_b32 s40, s58, 12
    s_add_u32 s40, s40, 8912896
    s_waitcnt lgkmcnt(0)
    v_pk_add_f32 v[112:113], v[112:113], v[120:121]
    v_pk_add_f32 v[128:129], v[128:129], v[136:137]
    v_pk_add_f32 v[114:115], v[114:115], v[122:123]
    v_pk_add_f32 v[130:131], v[130:131], v[138:139]
    v_pk_add_f32 v[116:117], v[116:117], v[124:125]
    v_pk_add_f32 v[132:133], v[132:133], v[140:141]
    v_pk_add_f32 v[118:119], v[118:119], v[126:127]
    v_pk_add_f32 v[134:135], v[134:135], v[142:143]
    v_pk_add_f32 v[112:113], v[112:113], v[128:129]
    v_pk_add_f32 v[114:115], v[114:115], v[130:131]
    v_pk_add_f32 v[116:117], v[116:117], v[132:133]
    v_pk_add_f32 v[118:119], v[118:119], v[134:135]
    v_cvt_pk_bf16_f32 v184, v112, v113
    v_cvt_pk_bf16_f32 v185, v114, v115
    v_cvt_pk_bf16_f32 v186, v116, v117
    v_cvt_pk_bf16_f32 v187, v118, v119
    buffer_store_dwordx4 v[184:187], v2, s[8:11], s40 offen sc1
c_fskip_36:
    s_mov_b64 exec, -1
    s_nop 1
c_halfE_22:
k2_kernel_end:
    s_endpgm

.globl k3_kernel
.p2align 8
.type k3_kernel,@function
k3_kernel:
    s_cmp_ge_u32 s2, 256
    s_cbranch_scc1 k3_kernel_end
    s_load_dwordx2 s[12:13], s[0:1], 104
    s_load_dwordx2 s[8:9], s[0:1], 0
    s_load_dwordx2 s[16:17], s[0:1], 88
    s_mov_b32 s10, 2621440
    s_mov_b32 s11, 0x20000
    s_mov_b32 s14, 15990784
    s_mov_b32 s15, 0x20000
    s_mov_b32 s18, 2621440
    s_mov_b32 s19, 0x20000
    v_lshrrev_b32 v4, 6, v0
    v_and_b32 v1, 63, v0
    v_readfirstlane_b32 s34, v4
    v_lshlrev_b32 v7, 4, v1
    s_and_b32 s40, s2, 7
    s_lshr_b32 s41, s2, 3
    s_lshr_b32 s32, s40, 1
    s_lshl_b32 s32, s32, 3
    s_and_b32 s42, s41, 7
    s_add_u32 s32, s32, s42
    s_and_b32 s33, s40, 1
    s_lshl_b32 s33, s33, 2
    s_lshr_b32 s42, s41, 3
    s_add_u32 s33, s33, s42
    s_add_u32 s40, s32, s33
    s_mul_i32 s41, s40, 43
    s_lshr_b32 s41, s41, 8
    s_mul_i32 s41, s41, 6
    s_sub_u32 s48, s40, s41
    s_mul_i32 s46, s33, 122880
    s_add_u32 s46, s46, 15007744
    s_mul_i32 s40, s34, 5120
    s_add_u32 s46, s46, s40
    s_mul_i32 s47, s32, 98304
    s_mul_i32 s41, s34, 24576
    s_add_u32 s47, s47, s41
    s_add_u32 s47, s47, 11534336
    s_add_u32 s40, s48, 0
    s_sub_u32 s41, s40, 6
    s_cmp_ge_u32 s40, 6
    s_cselect_b32 s50, s41, s40
    s_add_u32 s40, s48, 1
    s_sub_u32 s41, s40, 6
    s_cmp_ge_u32 s40, 6
    s_cselect_b32 s51, s41, s40
    s_add_u32 s40, s48, 2
    s_sub_u32 s41, s40, 6
    s_cmp_ge_u32 s40, 6
    s_cselect_b32 s52, s41, s40
    s_add_u32 s40, s48, 3
    s_sub_u32 s41, s40, 6
    s_cmp_ge_u32 s40, 6
    s_cselect_b32 s53, s41, s40
    s_add_u32 s40, s48, 4
    s_sub_u32 s41, s40, 6
    s_cmp_ge_u32 s40, 6
    s_cselect_b32 s54, s41, s40
    s_add_u32 s40, s48, 5
    s_sub_u32 s41, s40, 6
    s_cmp_ge_u32 s40, 6
    s_cselect_b32 s55, s41, s40
    s_waitcnt lgkmcnt(0)
    s_mul_i32 s40, s50, 20480
    s_add_u32 s40, s40, s46
    s_add_u32 s40, s40, 0
    s_mul_i32 s41, s34, 5120
    s_add_u32 m0, s41, 0
    s_nop 0
    buffer_load_dwordx4 v7, s[12:15], s40 offen lds
    s_mul_i32 s40, s50, 20480
    s_add_u32 s40, s40, s46
    s_add_u32 s40, s40, 1024
    s_mul_i32 s41, s34, 5120
    s_add_u32 m0, s41, 1024
    s_nop 0
    buffer_load_dwordx4 v7, s[12:15], s40 offen lds
    s_mul_i32 s40, s50, 20480
    s_add_u32 s40, s40, s46
    s_add_u32 s40, s40, 2048
    s_mul_i32 s41, s34, 5120
    s_add_u32 m0, s41, 2048
    s_nop 0
    buffer_load_dwordx4 v7, s[12:15], s40 offen lds
    s_mul_i32 s40, s50, 20480
    s_add_u32 s40, s40, s46
    s_add_u32 s40, s40, 3072
    s_mul_i32 s41, s34, 5120
    s_add_u32 m0, s41, 3072
    s_nop 0
    buffer_load_dwordx4 v7, s[12:15], s40 offen lds
    s_mul_i32 s40, s50, 20480
    s_add_u32 s40, s40, s46
    s_add_u32 s40, s40, 4096
    s_mul_i32 s41, s34, 5120
    s_add_u32 m0, s41, 4096
    s_nop 0
    buffer_load_dwordx4 v7, s[12:15], s40 offen lds
    s_lshl_b32 s42, s50, 12
    s_add_u32 s42, s42, s47
    buffer_load_dwordx4 v[8:11], v7, s[12:15], s42 offen offset:0
    s_lshl_b32 s42, s50, 12
    s_add_u32 s42, s42, s47
    buffer_load_dwordx4 v[12:15], v7, s[12:15], s42 offen offset:1024
    s_lshl_b32 s42, s50, 12
    s_add_u32 s42, s42, s47
    buffer_load_dwordx4 v[16:19], v7, s[12:15], s42 offen offset:2048
    s_lshl_b32 s42, s50, 12
    s_add_u32 s42, s42, s47
    buffer_load_dwordx4 v[20:23], v7, s[12:15], s42 offen offset:3072
    s_barrier
    s_mul_i32 s40, s51, 20480
    s_add_u32 s40, s40, s46
    s_add_u32 s40, s40, 0
    s_mul_i32 s41, s34, 5120
    s_add_u32 m0, s41, 20480
    s_nop 0
    buffer_load_dwordx4 v7, s[12:15], s40 offen lds
    s_mul_i32 s40, s51, 20480
    s_add_u32 s40, s40, s46
    s_add_u32 s40, s40, 1024
    s_mul_i32 s41, s34, 5120
    s_add_u32 m0, s41, 21504
    s_nop 0
    buffer_load_dwordx4 v7, s[12:15], s40 offen lds
    s_mul_i32 s40, s51, 20480
    s_add_u32 s40, s40, s46
    s_add_u32 s40, s40, 2048
    s_mul_i32 s41, s34, 5120
    s_add_u32 m0, s41, 22528
    s_nop 0
    buffer_load_dwordx4 v7, s[12:15], s40 offen lds
    s_mul_i32 s40, s51, 20480
    s_add_u32 s40, s40, s46
    s_add_u32 s40, s40, 3072
    s_mul_i32 s41, s34, 5120
    s_add_u32 m0, s41, 23552
    s_nop 0
    buffer_load_dwordx4 v7, s[12:15], s40 offen lds
    s_mul_i32 s40, s51, 20480
    s_add_u32 s40, s40, s46
    s_add_u32 s40, s40, 4096
    s_mul_i32 s41, s34, 5120
    s_add_u32 m0, s41, 24576
    s_nop 0
    buffer_load_dwordx4 v7, s[12:15], s40 offen lds
    s_lshl_b32 s42, s51, 12
    s_add_u32 s42, s42, s47
    buffer_load_dwordx4 v[24:27], v7, s[12:15], s42 offen offset:0
    s_lshl_b32 s42, s51, 12
    s_add_u32 s42, s42, s47
    buffer_load_dwordx4 v[28:31], v7, s[12:15], s42 offen offset:1024
    s_lshl_b32 s42, s51, 12
    s_add_u32 s42, s42, s47
    buffer_load_dwordx4 v[32:35], v7, s[12:15], s42 offen offset:2048
    s_lshl_b32 s42, s51, 12
    s_add_u32 s42, s42, s47
    buffer_load_dwordx4 v[36:39], v7, s[12:15], s42 offen offset:3072
    s_mul_i32 s44, s33, 160
    s_mul_i32 s45, s32, 81920
    s_add_u32 s45, s45, s44
    v_add_u32 v4, 0, v1
    v_mul_u32_u24 v5, 6554, v4
    v_lshrrev_b32 v5, 16, v5
    v_mul_u32_u24 v6, 10, v5
    v_sub_u32 v4, v4, v6
    v_lshlrev_b32 v4, 4, v4
    v_mul_u32_u24 v5, 1280, v5
    v_add_u32 v104, v4, v5
    v_add_u32 v4, 64, v1
    v_mul_u32_u24 v5, 6554, v4
    v_lshrrev_b32 v5, 16, v5
    v_mul_u32_u24 v6, 10, v5
    v_sub_u32 v4, v4, v6
    v_lshlrev_b32 v4, 4, v4
    v_mul_u32_u24 v5, 1280, v5
    v_add_u32 v105, v4, v5
    v_add_u32 v4, 128, v1
    v_mul_u32_u24 v5, 6554, v4
    v_lshrrev_b32 v5, 16, v5
    v_mul_u32_u24 v6, 10, v5
    v_sub_u32 v4, v4, v6
    v_lshlrev_b32 v4, 4, v4
    v_mul_u32_u24 v5, 1280, v5
    v_add_u32 v106, v4, v5
    v_add_u32 v4, 192, v1
    v_mul_u32_u24 v5, 6554, v4
    v_lshrrev_b32 v5, 16, v5
    v_mul_u32_u24 v6, 10, v5
    v_sub_u32 v4, v4, v6
    v_lshlrev_b32 v4, 4, v4
    v_mul_u32_u24 v5, 1280, v5
    v_add_u32 v107, v4, v5
    v_add_u32 v4, 256, v1
    v_mul_u32_u24 v5, 6554, v4
    v_lshrrev_b32 v5, 16, v5
    v_mul_u32_u24 v6, 10, v5
    v_sub_u32 v4, v4, v6
    v_lshlrev_b32 v4, 4, v4
    v_mul_u32_u24 v5, 1280, v5
    v_add_u32 v108, v4, v5
    v_lshrrev_b32 v2, 4, v1
    v_and_b32 v3, 15, v1
    v_mov_b32 v113, v7
    v_add_u32 v114, 61440, v7
    s_waitcnt vmcnt(13)
    s_barrier
    ds_read_b128 v[136:139], v113 offset:0
    ds_read_b128 v[140:143], v113 offset:1024
    ds_read_b128 v[144:147], v113 offset:2048
    ds_read_b128 v[148:151], v113 offset:3072
    ds_read_b128 v[152:155], v113 offset:4096
    ds_read_b128 v[156:159], v113 offset:5120
    ds_read_b128 v[160:163], v113 offset:6144
    ds_read_b128 v[164:167], v113 offset:7168
    ds_read_b128 v[168:171], v113 offset:8192
    ds_read_b128 v[172:175], v113 offset:9216
    s_waitcnt vmcnt(12)
    s_waitcnt lgkmcnt(9)
    v_mfma_f32_16x16x32_bf16 v[116:119], v[136:139], v[8:11], 0
    s_mul_i32 s40, s52, 20480
    s_add_u32 s40, s40, s46
    s_add_u32 s40, s40, 0
    s_mul_i32 s41, s34, 5120
    s_add_u32 m0, s41, 40960
    s_nop 0
    buffer_load_dwordx4 v7, s[12:15], s40 offen lds
    s_waitcnt lgkmcnt(8)
    v_mfma_f32_16x16x32_bf16 v[120:123], v[140:143], v[8:11], 0
    s_waitcnt lgkmcnt(7)
    v_mfma_f32_16x16x32_bf16 v[124:127], v[144:147], v[8:11], 0
    s_mul_i32 s40, s52, 20480
    s_add_u32 s40, s40, s46
    s_add_u32 s40, s40, 1024
    s_mul_i32 s41, s34, 5120
    s_add_u32 m0, s41, 41984
    s_nop 0
    buffer_load_dwordx4 v7, s[12:15], s40 offen lds
    s_waitcnt lgkmcnt(6)
    v_mfma_f32_16x16x32_bf16 v[128:131], v[148:151], v[8:11], 0
    s_waitcnt lgkmcnt(5)
    v_mfma_f32_16x16x32_bf16 v[132:135], v[152:155], v[8:11], 0
    s_mul_i32 s40, s52, 20480
    s_add_u32 s40, s40, s46
    s_add_u32 s40, s40, 2048
    s_mul_i32 s41, s34, 5120
    s_add_u32 m0, s41, 43008
    s_nop 0
    buffer_load_dwordx4 v7, s[12:15], s40 offen lds
    ds_read_b128 v[136:139], v113 offset:10240
    ds_read_b128 v[140:143], v113 offset:11264
    ds_read_b128 v[144:147], v113 offset:12288
    ds_read_b128 v[148:151], v113 offset:13312
    ds_read_b128 v[152:155], v113 offset:14336
    s_waitcnt vmcnt(14)
    s_waitcnt lgkmcnt(9)
    v_mfma_f32_16x16x32_bf16 v[116:119], v[156:159], v[12:15], v[116:119]
    s_mul_i32 s40, s52, 20480
    s_add_u32 s40, s40, s46
    s_add_u32 s40, s40, 3072
    s_mul_i32 s41, s34, 5120
    s_add_u32 m0, s41, 44032
    s_nop 0
    buffer_load_dwordx4 v7, s[12:15], s40 offen lds
    s_waitcnt lgkmcnt(8)
    v_mfma_f32_16x16x32_bf16 v[120:123], v[160:163], v[12:15], v[120:123]
    s_waitcnt lgkmcnt(7)
    v_mfma_f32_16x16x32_bf16 v[124:127], v[164:167], v[12:15], v[124:127]
    s_mul_i32 s40, s52, 20480
    s_add_u32 s40, s40, s46
    s_add_u32 s40, s40, 4096
    s_mul_i32 s41, s34, 5120
    s_add_u32 m0, s41, 45056
    s_nop 0
    buffer_load_dwordx4 v7, s[12:15], s40 offen lds
    s_waitcnt lgkmcnt(6)
    v_mfma_f32_16x16x32_bf16 v[128:131], v[168:171], v[12:15], v[128:131]
    s_waitcnt lgkmcnt(5)
    v_mfma_f32_16x16x32_bf16 v[132:135], v[172:175], v[12:15], v[132:135]
    s_lshl_b32 s42, s52, 12
    s_add_u32 s42, s42, s47
    buffer_load_dwordx4 v[40:43], v7, s[12:15], s42 offen offset:0
    ds_read_b128 v[156:159], v113 offset:15360
    ds_read_b128 v[160:163], v113 offset:16384
    ds_read_b128 v[164:167], v113 offset:17408
    ds_read_b128 v[168:171], v113 offset:18432
    ds_read_b128 v[172:175], v113 offset:19456
    s_waitcnt vmcnt(16)
    s_waitcnt lgkmcnt(9)
    v_mfma_f32_16x16x32_bf16 v[116:119], v[136:139], v[16:19], v[116:119]
    s_lshl_b32 s42, s52, 12
    s_add_u32 s42, s42, s47
    buffer_load_dwordx4 v[44:47], v7, s[12:15], s42 offen offset:1024
    s_waitcnt lgkmcnt(8)
    v_mfma_f32_16x16x32_bf16 v[120:123], v[140:143], v[16:19], v[120:123]
    s_waitcnt lgkmcnt(7)
    v_mfma_f32_16x16x32_bf16 v[124:127], v[144:147], v[16:19], v[124:127]
    s_lshl_b32 s42, s52, 12
    s_add_u32 s42, s42, s47
    buffer_load_dwordx4 v[48:51], v7, s[12:15], s42 offen offset:2048
    s_waitcnt lgkmcnt(6)
    v_mfma_f32_16x16x32_bf16 v[128:131], v[148:151], v[16:19], v[128:131]
    s_waitcnt lgkmcnt(5)
    v_mfma_f32_16x16x32_bf16 v[132:135], v[152:155], v[16:19], v[132:135]
    s_lshl_b32 s42, s52, 12
    s_add_u32 s42, s42, s47
    buffer_load_dwordx4 v[52:55], v7, s[12:15], s42 offen offset:3072
    s_waitcnt vmcnt(18)
    s_waitcnt lgkmcnt(4)
    v_mfma_f32_16x16x32_bf16 v[116:119], v[156:159], v[20:23], v[116:119]
    s_waitcnt lgkmcnt(3)
    v_mfma_f32_16x16x32_bf16 v[120:123], v[160:163], v[20:23], v[120:123]
    s_waitcnt lgkmcnt(2)
    v_mfma_f32_16x16x32_bf16 v[124:127], v[164:167], v[20:23], v[124:127]
    s_waitcnt lgkmcnt(1)
    v_mfma_f32_16x16x32_bf16 v[128:131], v[168:171], v[20:23], v[128:131]
    s_waitcnt lgkmcnt(0)
    v_mfma_f32_16x16x32_bf16 v[132:135], v[172:175], v[20:23], v[132:135]
    s_waitcnt vmcnt(13)
    s_barrier
    ds_read_b128 v[136:139], v113 offset:20480
    ds_read_b128 v[140:143], v113 offset:21504
    ds_read_b128 v[144:147], v113 offset:22528
    ds_read_b128 v[148:151], v113 offset:23552
    ds_read_b128 v[152:155], v113 offset:24576
    ds_read_b128 v[156:159], v113 offset:25600
    ds_read_b128 v[160:163], v113 offset:26624
    ds_read_b128 v[164:167], v113 offset:27648
    ds_read_b128 v[168:171], v113 offset:28672
    ds_read_b128 v[172:175], v113 offset:29696
    s_waitcnt vmcnt(12)
    s_waitcnt lgkmcnt(9)
    v_mfma_f32_16x16x32_bf16 v[116:119], v[136:139], v[24:27], v[116:119]
    s_mul_i32 s40, s53, 20480
    s_add_u32 s40, s40, s46
    s_add_u32 s40, s40, 0
    s_mul_i32 s41, s34, 5120
    s_add_u32 m0, s41, 61440
    s_nop 0
    buffer_load_dwordx4 v7, s[12:15], s40 offen lds
    s_waitcnt lgkmcnt(8)
    v_mfma_f32_16x16x32_bf16 v[120:123], v[140:143], v[24:27], v[120:123]
    s_waitcnt lgkmcnt(7)
    v_mfma_f32_16x16x32_bf16 v[124:127], v[144:147], v[24:27], v[124:127]
    s_mul_i32 s40, s53, 20480
    s_add_u32 s40, s40, s46
    s_add_u32 s40, s40, 1024
    s_mul_i32 s41, s34, 5120
    s_add_u32 m0, s41, 62464
    s_nop 0
    buffer_load_dwordx4 v7, s[12:15], s40 offen lds
    s_waitcnt lgkmcnt(6)
    v_mfma_f32_16x16x32_bf16 v[128:131], v[148:151], v[24:27], v[128:131]
    s_waitcnt lgkmcnt(5)
    v_mfma_f32_16x16x32_bf16 v[132:135], v[152:155], v[24:27], v[132:135]
    s_mul_i32 s40, s53, 20480
    s_add_u32 s40, s40, s46
    s_add_u32 s40, s40, 2048
    s_mul_i32 s41, s34, 5120
    s_add_u32 m0, s41, 63488
    s_nop 0
    buffer_load_dwordx4 v7, s[12:15], s40 offen lds
    ds_read_b128 v[136:139], v113 offset:30720
    ds_read_b128 v[140:143], v113 offset:31744
    ds_read_b128 v[144:147], v113 offset:32768
    ds_read_b128 v[148:151], v113 offset:33792
    ds_read_b128 v[152:155], v113 offset:34816
    s_waitcnt vmcnt(14)
    s_waitcnt lgkmcnt(9)
    v_mfma_f32_16x16x32_bf16 v[116:119], v[156:159], v[28:31], v[116:119]
    s_mul_i32 s40, s53, 20480
    s_add_u32 s40, s40, s46
    s_add_u32 s40, s40, 3072
    s_mul_i32 s41, s34, 5120
    s_add_u32 m0, s41, 64512
    s_nop 0
    buffer_load_dwordx4 v7, s[12:15], s40 offen lds
    s_waitcnt lgkmcnt(8)
    v_mfma_f32_16x16x32_bf16 v[120:123], v[160:163], v[28:31], v[120:123]
    s_waitcnt lgkmcnt(7)
    v_mfma_f32_16x16x32_bf16 v[124:127], v[164:167], v[28:31], v[124:127]
    s_mul_i32 s40, s53, 20480
    s_add_u32 s40, s40, s46
    s_add_u32 s40, s40, 4096
    s_mul_i32 s41, s34, 5120
    s_add_u32 m0, s41, 65536
    s_nop 0
    buffer_load_dwordx4 v7, s[12:15], s40 offen lds
    s_waitcnt lgkmcnt(6)
    v_mfma_f32_16x16x32_bf16 v[128:131], v[168:171], v[28:31], v[128:131]
    s_waitcnt lgkmcnt(5)
    v_mfma_f32_16x16x32_bf16 v[132:135], v[172:175], v[28:31], v[132:135]
    s_lshl_b32 s42, s53, 12
    s_add_u32 s42, s42, s47
    buffer_load_dwordx4 v[56:59], v7, s[12:15], s42 offen offset:0
    ds_read_b128 v[156:159], v113 offset:35840
    ds_read_b128 v[160:163], v113 offset:36864
    ds_read_b128 v[164:167], v113 offset:37888
    ds_read_b128 v[168:171], v113 offset:38912
    ds_read_b128 v[172:175], v113 offset:39936
    s_waitcnt vmcnt(16)
    s_waitcnt lgkmcnt(9)
    v_mfma_f32_16x16x32_bf16 v[116:119], v[136:139], v[32:35], v[116:119]
    s_lshl_b32 s42, s53, 12
    s_add_u32 s42, s42, s47
    buffer_load_dwordx4 v[60:63], v7, s[12:15], s42 offen offset:1024
    s_waitcnt lgkmcnt(8)
    v_mfma_f32_16x16x32_bf16 v[120:123], v[140:143], v[32:35], v[120:123]
    s_waitcnt lgkmcnt(7)
    v_mfma_f32_16x16x32_bf16 v[124:127], v[144:147], v[32:35], v[124:127]
    s_lshl_b32 s42, s53, 12
    s_add_u32 s42, s42, s47
    buffer_load_dwordx4 v[64:67], v7, s[12:15], s42 offen offset:2048
    s_waitcnt lgkmcnt(6)
    v_mfma_f32_16x16x32_bf16 v[128:131], v[148:151], v[32:35], v[128:131]
    s_waitcnt lgkmcnt(5)
    v_mfma_f32_16x16x32_bf16 v[132:135], v[152:155], v[32:35], v[132:135]
    s_lshl_b32 s42, s53, 12
    s_add_u32 s42, s42, s47
    buffer_load_dwordx4 v[68:71], v7, s[12:15], s42 offen offset:3072
    s_waitcnt vmcnt(18)
    s_waitcnt lgkmcnt(4)
    v_mfma_f32_16x16x32_bf16 v[116:119], v[156:159], v[36:39], v[116:119]
    s_waitcnt lgkmcnt(3)
    v_mfma_f32_16x16x32_bf16 v[120:123], v[160:163], v[36:39], v[120:123]
    s_waitcnt lgkmcnt(2)
    v_mfma_f32_16x16x32_bf16 v[124:127], v[164:167], v[36:39], v[124:127]
    s_waitcnt lgkmcnt(1)
    v_mfma_f32_16x16x32_bf16 v[128:131], v[168:171], v[36:39], v[128:131]
    s_waitcnt lgkmcnt(0)
    v_mfma_f32_16x16x32_bf16 v[132:135], v[172:175], v[36:39], v[132:135]
    s_waitcnt vmcnt(13)
    s_barrier
    ds_read_b128 v[136:139], v113 offset:40960
    ds_read_b128 v[140:143], v113 offset:41984
    ds_read_b128 v[144:147], v113 offset:43008
    ds_read_b128 v[148:151], v113 offset:44032
    ds_read_b128 v[152:155], v113 offset:45056
    ds_read_b128 v[156:159], v113 offset:46080
    ds_read_b128 v[160:163], v113 offset:47104
    ds_read_b128 v[164:167], v113 offset:48128
    ds_read_b128 v[168:171], v113 offset:49152
    ds_read_b128 v[172:175], v113 offset:50176
    s_waitcnt vmcnt(12)
    s_waitcnt lgkmcnt(9)
    v_mfma_f32_16x16x32_bf16 v[116:119], v[136:139], v[40:43], v[116:119]
    s_mul_i32 s40, s54, 20480
    s_add_u32 s40, s40, s46
    s_add_u32 s40, s40, 0
    s_mul_i32 s41, s34, 5120
    s_add_u32 m0, s41, 81920
    s_nop 0
    buffer_load_dwordx4 v7, s[12:15], s40 offen lds
    s_waitcnt lgkmcnt(8)
    v_mfma_f32_16x16x32_bf16 v[120:123], v[140:143], v[40:43], v[120:123]
    s_waitcnt lgkmcnt(7)
    v_mfma_f32_16x16x32_bf16 v[124:127], v[144:147], v[40:43], v[124:127]
    s_mul_i32 s40, s54, 20480
    s_add_u32 s40, s40, s46
    s_add_u32 s40, s40, 1024
    s_mul_i32 s41, s34, 5120
    s_add_u32 m0, s41, 82944
    s_nop 0
    buffer_load_dwordx4 v7, s[12:15], s40 offen lds
    s_waitcnt lgkmcnt(6)
    v_mfma_f32_16x16x32_bf16 v[128:131], v[148:151], v[40:43], v[128:131]
    s_waitcnt lgkmcnt(5)
    v_mfma_f32_16x16x32_bf16 v[132:135], v[152:155], v[40:43], v[132:135]
    s_mul_i32 s40, s54, 20480
    s_add_u32 s40, s40, s46
    s_add_u32 s40, s40, 2048
    s_mul_i32 s41, s34, 5120
    s_add_u32 m0, s41, 83968
    s_nop 0
    buffer_load_dwordx4 v7, s[12:15], s40 offen lds
    ds_read_b128 v[136:139], v113 offset:51200
    ds_read_b128 v[140:143], v113 offset:52224
    ds_read_b128 v[144:147], v113 offset:53248
    ds_read_b128 v[148:151], v113 offset:54272
    ds_read_b128 v[152:155], v113 offset:55296
    s_waitcnt vmcnt(14)
    s_waitcnt lgkmcnt(9)
    v_mfma_f32_16x16x32_bf16 v[116:119], v[156:159], v[44:47], v[116:119]
    s_mul_i32 s40, s54, 20480
    s_add_u32 s40, s40, s46
    s_add_u32 s40, s40, 3072
    s_mul_i32 s41, s34, 5120
    s_add_u32 m0, s41, 84992
    s_nop 0
    buffer_load_dwordx4 v7, s[12:15], s40 offen lds
    s_waitcnt lgkmcnt(8)
    v_mfma_f32_16x16x32_bf16 v[120:123], v[160:163], v[44:47], v[120:123]
    s_waitcnt lgkmcnt(7)
    v_mfma_f32_16x16x32_bf16 v[124:127], v[164:167], v[44:47], v[124:127]
    s_mul_i32 s40, s54, 20480
    s_add_u32 s40, s40, s46
    s_add_u32 s40, s40, 4096
    s_mul_i32 s41, s34, 5120
    s_add_u32 m0, s41, 86016
    s_nop 0
    buffer_load_dwordx4 v7, s[12:15], s40 offen lds
    s_waitcnt lgkmcnt(6)
    v_mfma_f32_16x16x32_bf16 v[128:131], v[168:171], v[44:47], v[128:131]
    s_waitcnt lgkmcnt(5)
    v_mfma_f32_16x16x32_bf16 v[132:135], v[172:175], v[44:47], v[132:135]
    s_lshl_b32 s42, s54, 12
    s_add_u32 s42, s42, s47
    buffer_load_dwordx4 v[72:75], v7, s[12:15], s42 offen offset:0
    ds_read_b128 v[156:159], v113 offset:56320
    ds_read_b128 v[160:163], v113 offset:57344
    ds_read_b128 v[164:167], v113 offset:58368
    ds_read_b128 v[168:171], v113 offset:59392
    ds_read_b128 v[172:175], v113 offset:60416
    s_waitcnt vmcnt(16)
    s_waitcnt lgkmcnt(9)
    v_mfma_f32_16x16x32_bf16 v[116:119], v[136:139], v[48:51], v[116:119]
    s_lshl_b32 s42, s54, 12
    s_add_u32 s42, s42, s47
    buffer_load_dwordx4 v[76:79], v7, s[12:15], s42 offen offset:1024
    s_waitcnt lgkmcnt(8)
    v_mfma_f32_16x16x32_bf16 v[120:123], v[140:143], v[48:51], v[120:123]
    s_waitcnt lgkmcnt(7)
    v_mfma_f32_16x16x32_bf16 v[124:127], v[144:147], v[48:51], v[124:127]
    s_lshl_b32 s42, s54, 12
    s_add_u32 s42, s42, s47
    buffer_load_dwordx4 v[80:83], v7, s[12:15], s42 offen offset:2048
    s_waitcnt lgkmcnt(6)
    v_mfma_f32_16x16x32_bf16 v[128:131], v[148:151], v[48:51], v[128:131]
    s_waitcnt lgkmcnt(5)
    v_mfma_f32_16x16x32_bf16 v[132:135], v[152:155], v[48:51], v[132:135]
    s_lshl_b32 s42, s54, 12
    s_add_u32 s42, s42, s47
    buffer_load_dwordx4 v[84:87], v7, s[12:15], s42 offen offset:3072
    s_waitcnt vmcnt(18)
    s_waitcnt lgkmcnt(4)
    v_mfma_f32_16x16x32_bf16 v[116:119], v[156:159], v[52:55], v[116:119]
    s_waitcnt lgkmcnt(3)
    v_mfma_f32_16x16x32_bf16 v[120:123], v[160:163], v[52:55], v[120:123]
    s_waitcnt lgkmcnt(2)
    v_mfma_f32_16x16x32_bf16 v[124:127], v[164:167], v[52:55], v[124:127]
    s_waitcnt lgkmcnt(1)
    v_mfma_f32_16x16x32_bf16 v[128:131], v[168:171], v[52:55], v[128:131]
    s_waitcnt lgkmcnt(0)
    v_mfma_f32_16x16x32_bf16 v[132:135], v[172:175], v[52:55], v[132:135]
    s_waitcnt vmcnt(13)
    s_barrier
    ds_read_b128 v[136:139], v114 offset:0
    ds_read_b128 v[140:143], v114 offset:1024
    ds_read_b128 v[144:147], v114 offset:2048
    ds_read_b128 v[148:151], v114 offset:3072
    ds_read_b128 v[152:155], v114 offset:4096
    ds_read_b128 v[156:159], v114 offset:5120
    ds_read_b128 v[160:163], v114 offset:6144
    ds_read_b128 v[164:167], v114 offset:7168
    ds_read_b128 v[168:171], v114 offset:8192
    ds_read_b128 v[172:175], v114 offset:9216
    s_waitcnt vmcnt(12)
    s_waitcnt lgkmcnt(9)
    v_mfma_f32_16x16x32_bf16 v[116:119], v[136:139], v[56:59], v[116:119]
    s_mul_i32 s40, s55, 20480
    s_add_u32 s40, s40, s46
    s_add_u32 s40, s40, 0
    s_mul_i32 s41, s34, 5120
    s_add_u32 m0, s41, 102400
    s_nop 0
    buffer_load_dwordx4 v7, s[12:15], s40 offen lds
    s_waitcnt lgkmcnt(8)
    v_mfma_f32_16x16x32_bf16 v[120:123], v[140:143], v[56:59], v[120:123]
    s_waitcnt lgkmcnt(7)
    v_mfma_f32_16x16x32_bf16 v[124:127], v[144:147], v[56:59], v[124:127]
    s_mul_i32 s40, s55, 20480
    s_add_u32 s40, s40, s46
    s_add_u32 s40, s40, 1024
    s_mul_i32 s41, s34, 5120
    s_add_u32 m0, s41, 103424
    s_nop 0
    buffer_load_dwordx4 v7, s[12:15], s40 offen lds
    s_waitcnt lgkmcnt(6)
    v_mfma_f32_16x16x32_bf16 v[128:131], v[148:151], v[56:59], v[128:131]
    s_waitcnt lgkmcnt(5)
    v_mfma_f32_16x16x32_bf16 v[132:135], v[152:155], v[56:59], v[132:135]
    s_mul_i32 s40, s55, 20480
    s_add_u32 s40, s40, s46
    s_add_u32 s40, s40, 2048
    s_mul_i32 s41, s34, 5120
    s_add_u32 m0, s41, 104448
    s_nop 0
    buffer_load_dwordx4 v7, s[12:15], s40 offen lds
    ds_read_b128 v[136:139], v114 offset:10240
    ds_read_b128 v[140:143], v114 offset:11264
    ds_read_b128 v[144:147], v114 offset:12288
    ds_read_b128 v[148:151], v114 offset:13312
    ds_read_b128 v[152:155], v114 offset:14336
    s_waitcnt vmcnt(14)
    s_waitcnt lgkmcnt(9)
    v_mfma_f32_16x16x32_bf16 v[116:119], v[156:159], v[60:63], v[116:119]
    s_mul_i32 s40, s55, 20480
    s_add_u32 s40, s40, s46
    s_add_u32 s40, s40, 3072
    s_mul_i32 s41, s34, 5120
    s_add_u32 m0, s41, 105472
    s_nop 0
    buffer_load_dwordx4 v7, s[12:15], s40 offen lds
    s_waitcnt lgkmcnt(8)
    v_mfma_f32_16x16x32_bf16 v[120:123], v[160:163], v[60:63], v[120:123]
    s_waitcnt lgkmcnt(7)
    v_mfma_f32_16x16x32_bf16 v[124:127], v[164:167], v[60:63], v[124:127]
    s_mul_i32 s40, s55, 20480
    s_add_u32 s40, s40, s46
    s_add_u32 s40, s40, 4096
    s_mul_i32 s41, s34, 5120
    s_add_u32 m0, s41, 106496
    s_nop 0
    buffer_load_dwordx4 v7, s[12:15], s40 offen lds
    s_waitcnt lgkmcnt(6)
    v_mfma_f32_16x16x32_bf16 v[128:131], v[168:171], v[60:63], v[128:131]
    s_waitcnt lgkmcnt(5)
    v_mfma_f32_16x16x32_bf16 v[132:135], v[172:175], v[60:63], v[132:135]
    s_lshl_b32 s42, s55, 12
    s_add_u32 s42, s42, s47
    buffer_load_dwordx4 v[88:91], v7, s[12:15], s42 offen offset:0
    ds_read_b128 v[156:159], v114 offset:15360
    ds_read_b128 v[160:163], v114 offset:16384
    ds_read_b128 v[164:167], v114 offset:17408
    ds_read_b128 v[168:171], v114 offset:18432
    ds_read_b128 v[172:175], v114 offset:19456
    s_waitcnt vmcnt(16)
    s_waitcnt lgkmcnt(9)
    v_mfma_f32_16x16x32_bf16 v[116:119], v[136:139], v[64:67], v[116:119]
    s_lshl_b32 s42, s55, 12
    s_add_u32 s42, s42, s47
    buffer_load_dwordx4 v[92:95], v7, s[12:15], s42 offen offset:1024
    s_waitcnt lgkmcnt(8)
    v_mfma_f32_16x16x32_bf16 v[120:123], v[140:143], v[64:67], v[120:123]
    s_waitcnt lgkmcnt(7)
    v_mfma_f32_16x16x32_bf16 v[124:127], v[144:147], v[64:67], v[124:127]
    s_lshl_b32 s42, s55, 12
    s_add_u32 s42, s42, s47
    buffer_load_dwordx4 v[96:99], v7, s[12:15], s42 offen offset:2048
    s_waitcnt lgkmcnt(6)
    v_mfma_f32_16x16x32_bf16 v[128:131], v[148:151], v[64:67], v[128:131]
    s_waitcnt lgkmcnt(5)
    v_mfma_f32_16x16x32_bf16 v[132:135], v[152:155], v[64:67], v[132:135]
    s_lshl_b32 s42, s55, 12
    s_add_u32 s42, s42, s47
    buffer_load_dwordx4 v[100:103], v7, s[12:15], s42 offen offset:3072
    s_waitcnt vmcnt(18)
    s_waitcnt lgkmcnt(4)
    v_mfma_f32_16x16x32_bf16 v[116:119], v[156:159], v[68:71], v[116:119]
    s_cmp_ge_u32 s34, 2
    s_cbranch_scc1 k3_y_1
    s_mul_i32 s40, s34, 40960
    s_add_u32 s40, s40, s45
    s_mul_i32 s41, s34, 5120
    s_add_u32 m0, s41, 122880
    s_nop 0
    buffer_load_dwordx4 v104, s[8:11], s40 offen lds
    s_add_u32 m0, s41, 123904
    s_nop 0
    buffer_load_dwordx4 v105, s[8:11], s40 offen lds
    s_add_u32 m0, s41, 124928
    s_nop 0
    buffer_load_dwordx4 v106, s[8:11], s40 offen lds
    s_add_u32 m0, s41, 125952
    s_nop 0
    buffer_load_dwordx4 v107, s[8:11], s40 offen lds
    s_add_u32 m0, s41, 126976
    s_nop 0
    buffer_load_dwordx4 v108, s[8:11], s40 offen lds
    s_branch k3_xy_2
k3_y_1:
    v_lshrrev_b32 v4, 3, v1
    v_lshlrev_b32 v4, 12, v4
    v_and_b32 v5, 7, v1
    v_lshl_add_u32 v112, v5, 4, v4
    s_sub_u32 s42, s34, 2
    s_mul_i32 s40, s42, 40
    s_mul_i32 s41, s33, 80
    s_add_u32 s40, s40, s41
    s_lshl_b32 s40, s40, 12
    s_lshl_b32 s41, s32, 7
    s_add_u32 s40, s40, s41
    s_add_u32 s40, s40, 8912896
    s_mul_i32 s41, s42, 5120
    s_add_u32 m0, s41, 133120
    s_nop 0
    buffer_load_dwordx4 v112, s[12:15], s40 offen lds
    s_add_u32 s40, s40, 32768
    s_add_u32 m0, s41, 134144
    s_nop 0
    buffer_load_dwordx4 v112, s[12:15], s40 offen lds
    s_add_u32 s40, s40, 32768
    s_add_u32 m0, s41, 135168
    s_nop 0
    buffer_load_dwordx4 v112, s[12:15], s40 offen lds
    s_add_u32 s40, s40, 32768
    s_add_u32 m0, s41, 136192
    s_nop 0
    buffer_load_dwordx4 v112, s[12:15], s40 offen lds
    s_add_u32 s40, s40, 32768
    s_add_u32 m0, s41, 137216
    s_nop 0
    buffer_load_dwordx4 v112, s[12:15], s40 offen lds
    s_add_u32 s40, s40, 32768
k3_xy_2:
    s_lshl_b32 s40, s32, 9
    s_lshl_b32 s41, s34, 7
    s_add_u32 s40, s40, s41
    s_add_u32 s40, s40, 14680064
    v_lshlrev_b32 v4, 3, v3
    buffer_load_dwordx2 v[110:111], v4, s[12:15], s40 offen
    s_waitcnt lgkmcnt(3)
    v_mfma_f32_16x16x32_bf16 v[120:123], v[160:163], v[68:71], v[120:123]
    s_waitcnt lgkmcnt(2)
    v_mfma_f32_16x16x32_bf16 v[124:127], v[164:167], v[68:71], v[124:127]
    s_waitcnt lgkmcnt(1)
    v_mfma_f32_16x16x32_bf16 v[128:131], v[168:171], v[68:71], v[128:131]
    s_waitcnt lgkmcnt(0)
    v_mfma_f32_16x16x32_bf16 v[132:135], v[172:175], v[68:71], v[132:135]
    s_waitcnt vmcnt(19)
    s_barrier
    ds_read_b128 v[136:139], v114 offset:20480
    ds_read_b128 v[140:143], v114 offset:21504
    ds_read_b128 v[144:147], v114 offset:22528
    ds_read_b128 v[148:151], v114 offset:23552
    ds_read_b128 v[152:155], v114 offset:24576
    ds_read_b128 v[156:159], v114 offset:25600
    ds_read_b128 v[160:163], v114 offset:26624
    ds_read_b128 v[164:167], v114 offset:27648
    ds_read_b128 v[168:171], v114 offset:28672
    ds_read_b128 v[172:175], v114 offset:29696
    s_waitcnt vmcnt(18)
    s_waitcnt lgkmcnt(9)
    v_mfma_f32_16x16x32_bf16 v[116:119], v[136:139], v[72:75], v[116:119]
    s_waitcnt lgkmcnt(8)
    v_mfma_f32_16x16x32_bf16 v[120:123], v[140:143], v[72:75], v[120:123]
    s_waitcnt lgkmcnt(7)
    v_mfma_f32_16x16x32_bf16 v[124:127], v[144:147], v[72:75], v[124:127]
    s_waitcnt lgkmcnt(6)
    v_mfma_f32_16x16x32_bf16 v[128:131], v[148:151], v[72:75], v[128:131]
    s_waitcnt lgkmcnt(5)
    v_mfma_f32_16x16x32_bf16 v[132:135], v[152:155], v[72:75], v[132:135]
    ds_read_b128 v[136:139], v114 offset:30720
    ds_read_b128 v[140:143], v114 offset:31744
    ds_read_b128 v[144:147], v114 offset:32768
    ds_read_b128 v[148:151], v114 offset:33792
    ds_read_b128 v[152:155], v114 offset:34816
    s_waitcnt vmcnt(17)
    s_waitcnt lgkmcnt(9)
    v_mfma_f32_16x16x32_bf16 v[116:119], v[156:159], v[76:79], v[116:119]
    s_waitcnt lgkmcnt(8)
    v_mfma_f32_16x16x32_bf16 v[120:123], v[160:163], v[76:79], v[120:123]
    s_waitcnt lgkmcnt(7)
    v_mfma_f32_16x16x32_bf16 v[124:127], v[164:167], v[76:79], v[124:127]
    s_waitcnt lgkmcnt(6)
    v_mfma_f32_16x16x32_bf16 v[128:131], v[168:171], v[76:79], v[128:131]
    s_waitcnt lgkmcnt(5)
    v_mfma_f32_16x16x32_bf16 v[132:135], v[172:175], v[76:79], v[132:135]
    ds_read_b128 v[156:159], v114 offset:35840
    ds_read_b128 v[160:163], v114 offset:36864
    ds_read_b128 v[164:167], v114 offset:37888
    ds_read_b128 v[168:171], v114 offset:38912
    ds_read_b128 v[172:175], v114 offset:39936
    s_waitcnt vmcnt(16)
    s_waitcnt lgkmcnt(9)
    v_mfma_f32_16x16x32_bf16 v[116:119], v[136:139], v[80:83], v[116:119]
    s_waitcnt lgkmcnt(8)
    v_mfma_f32_16x16x32_bf16 v[120:123], v[140:143], v[80:83], v[120:123]
    s_waitcnt lgkmcnt(7)
    v_mfma_f32_16x16x32_bf16 v[124:127], v[144:147], v[80:83], v[124:127]
    s_waitcnt lgkmcnt(6)
    v_mfma_f32_16x16x32_bf16 v[128:131], v[148:151], v[80:83], v[128:131]
    s_waitcnt lgkmcnt(5)
    v_mfma_f32_16x16x32_bf16 v[132:135], v[152:155], v[80:83], v[132:135]
    s_waitcnt vmcnt(15)
    s_waitcnt lgkmcnt(4)
    v_mfma_f32_16x16x32_bf16 v[116:119], v[156:159], v[84:87], v[116:119]
    s_waitcnt lgkmcnt(3)
    v_mfma_f32_16x16x32_bf16 v[120:123], v[160:163], v[84:87], v[120:123]
    s_waitcnt lgkmcnt(2)
    v_mfma_f32_16x16x32_bf16 v[124:127], v[164:167], v[84:87], v[124:127]
    s_waitcnt lgkmcnt(1)
    v_mfma_f32_16x16x32_bf16 v[128:131], v[168:171], v[84:87], v[128:131]
    s_waitcnt lgkmcnt(0)
    v_mfma_f32_16x16x32_bf16 v[132:135], v[172:175], v[84:87], v[132:135]
    s_waitcnt vmcnt(10)
    s_barrier
    ds_read_b128 v[136:139], v114 offset:40960
    ds_read_b128 v[140:143], v114 offset:41984
    ds_read_b128 v[144:147], v114 offset:43008
    ds_read_b128 v[148:151], v114 offset:44032
    ds_read_b128 v[152:155], v114 offset:45056
    ds_read_b128 v[156:159], v114 offset:46080
    ds_read_b128 v[160:163], v114 offset:47104
    ds_read_b128 v[164:167], v114 offset:48128
    ds_read_b128 v[168:171], v114 offset:49152
    ds_read_b128 v[172:175], v114 offset:50176
    s_waitcnt vmcnt(9)
    s_waitcnt lgkmcnt(9)
    v_mfma_f32_16x16x32_bf16 v[116:119], v[136:139], v[88:91], v[116:119]
    s_waitcnt lgkmcnt(8)
    v_mfma_f32_16x16x32_bf16 v[120:123], v[140:143], v[88:91], v[120:123]
    s_waitcnt lgkmcnt(7)
    v_mfma_f32_16x16x32_bf16 v[124:127], v[144:147], v[88:91], v[124:127]
    s_waitcnt lgkmcnt(6)
    v_mfma_f32_16x16x32_bf16 v[128:131], v[148:151], v[88:91], v[128:131]
    s_waitcnt lgkmcnt(5)
    v_mfma_f32_16x16x32_bf16 v[132:135], v[152:155], v[88:91], v[132:135]
    ds_read_b128 v[136:139], v114 offset:51200
    ds_read_b128 v[140:143], v114 offset:52224
    ds_read_b128 v[144:147], v114 offset:53248
    ds_read_b128 v[148:151], v114 offset:54272
    ds_read_b128 v[152:155], v114 offset:55296
    s_waitcnt vmcnt(8)
    s_waitcnt lgkmcnt(9)
    v_mfma_f32_16x16x32_bf16 v[116:119], v[156:159], v[92:95], v[116:119]
    s_waitcnt lgkmcnt(8)
    v_mfma_f32_16x16x32_bf16 v[120:123], v[160:163], v[92:95], v[120:123]
    s_waitcnt lgkmcnt(7)
    v_mfma_f32_16x16x32_bf16 v[124:127], v[164:167], v[92:95], v[124:127]
    s_waitcnt lgkmcnt(6)
    v_mfma_f32_16x16x32_bf16 v[128:131], v[168:171], v[92:95], v[128:131]
    s_waitcnt lgkmcnt(5)
    v_mfma_f32_16x16x32_bf16 v[132:135], v[172:175], v[92:95], v[132:135]
    ds_read_b128 v[156:159], v114 offset:56320
    ds_read_b128 v[160:163], v114 offset:57344
    ds_read_b128 v[164:167], v114 offset:58368
    ds_read_b128 v[168:171], v114 offset:59392
    ds_read_b128 v[172:175], v114 offset:60416
    s_waitcnt vmcnt(7)
    s_waitcnt lgkmcnt(9)
    v_mfma_f32_16x16x32_bf16 v[116:119], v[136:139], v[96:99], v[116:119]
    s_waitcnt lgkmcnt(8)
    v_mfma_f32_16x16x32_bf16 v[120:123], v[140:143], v[96:99], v[120:123]
    s_waitcnt lgkmcnt(7)
    v_mfma_f32_16x16x32_bf16 v[124:127], v[144:147], v[96:99], v[124:127]
    s_waitcnt lgkmcnt(6)
    v_mfma_f32_16x16x32_bf16 v[128:131], v[148:151], v[96:99], v[128:131]
    s_waitcnt lgkmcnt(5)
    v_mfma_f32_16x16x32_bf16 v[132:135], v[152:155], v[96:99], v[132:135]
    s_waitcnt vmcnt(6)
    s_waitcnt lgkmcnt(4)
    v_mfma_f32_16x16x32_bf16 v[116:119], v[156:159], v[100:103], v[116:119]
    s_waitcnt lgkmcnt(3)
    v_mfma_f32_16x16x32_bf16 v[120:123], v[160:163], v[100:103], v[120:123]
    s_waitcnt lgkmcnt(2)
    v_mfma_f32_16x16x32_bf16 v[124:127], v[164:167], v[100:103], v[124:127]
    s_waitcnt lgkmcnt(1)
    v_mfma_f32_16x16x32_bf16 v[128:131], v[168:171], v[100:103], v[128:131]
    s_waitcnt lgkmcnt(0)
    v_mfma_f32_16x16x32_bf16 v[132:135], v[172:175], v[100:103], v[132:135]
    s_lshl_b32 s40, s34, 4
    v_add_u32 v4, s40, v3
    v_mul_u32_u24 v4, 160, v4
    v_lshl_add_u32 v176, v2, 3, v4
    v_add_u32 v177, 122880, v176
    v_lshrrev_b32 v5, 2, v3
    v_lshl_add_u32 v4, v2, 2, v5
    v_lshlrev_b32 v4, 7, v4
    v_and_b32 v5, 3, v3
    v_lshl_add_u32 v4, v5, 3, v4
    s_lshl_b32 s40, s34, 5
    s_add_u32 s40, s40, 133120
    v_add_u32 v178, s40, v4
    s_mov_b32 s46, 0xbfb8aa3b
    s_mov_b32 s47, 0xbfb8aa3b
    v_pk_mul_f32 v[8:9], v[116:117], s[46:47]
    v_pk_mul_f32 v[10:11], v[118:119], s[46:47]
    v_pk_mul_f32 v[12:13], v[120:121], s[46:47]
    v_pk_mul_f32 v[14:15], v[122:123], s[46:47]
    v_pk_mul_f32 v[16:17], v[124:125], s[46:47]
    v_pk_mul_f32 v[18:19], v[126:127], s[46:47]
    v_pk_mul_f32 v[20:21], v[128:129], s[46:47]
    v_pk_mul_f32 v[22:23], v[130:131], s[46:47]
    v_pk_mul_f32 v[24:25], v[132:133], s[46:47]
    v_pk_mul_f32 v[26:27], v[134:135], s[46:47]
    s_waitcnt vmcnt(0)
    s_barrier
    ds_read_b64 v[136:137], v177 offset:0
    ds_read_b64 v[138:139], v177 offset:32
    ds_read_b64 v[140:141], v177 offset:64
    ds_read_b64 v[142:143], v177 offset:96
    ds_read_b64 v[144:145], v177 offset:128
    ds_read_b64_tr_b16 v[146:147], v178 offset:0
    ds_read_b64_tr_b16 v[148:149], v178 offset:2048
    ds_read_b64_tr_b16 v[150:151], v178 offset:4096
    ds_read_b64_tr_b16 v[152:153], v178 offset:6144
    ds_read_b64_tr_b16 v[154:155], v178 offset:8192
    v_exp_f32 v8, v8
    v_exp_f32 v9, v9
    v_exp_f32 v10, v10
    v_exp_f32 v11, v11
    v_exp_f32 v12, v12
    v_exp_f32 v13, v13
    v_exp_f32 v14, v14
    v_exp_f32 v15, v15
    v_exp_f32 v16, v16
    v_exp_f32 v17, v17
    v_exp_f32 v18, v18
    v_exp_f32 v19, v19
    v_exp_f32 v20, v20
    v_exp_f32 v21, v21
    v_exp_f32 v22, v22
    v_exp_f32 v23, v23
    v_exp_f32 v24, v24
    v_exp_f32 v25, v25
    v_exp_f32 v26, v26
    v_exp_f32 v27, v27
    v_pk_add_f32 v[8:9], v[8:9], 1.0 op_sel_hi:[1,0]
    v_pk_add_f32 v[10:11], v[10:11], 1.0 op_sel_hi:[1,0]
    v_pk_add_f32 v[12:13], v[12:13], 1.0 op_sel_hi:[1,0]
    v_pk_add_f32 v[14:15], v[14:15], 1.0 op_sel_hi:[1,0]
    v_pk_add_f32 v[16:17], v[16:17], 1.0 op_sel_hi:[1,0]
    v_pk_add_f32 v[18:19], v[18:19], 1.0 op_sel_hi:[1,0]
    v_pk_add_f32 v[20:21], v[20:21], 1.0 op_sel_hi:[1,0]
    v_pk_add_f32 v[22:23], v[22:23], 1.0 op_sel_hi:[1,0]
    v_pk_add_f32 v[24:25], v[24:25], 1.0 op_sel_hi:[1,0]
    v_pk_add_f32 v[26:27], v[26:27], 1.0 op_sel_hi:[1,0]
    v_rcp_f32 v8, v8
    v_rcp_f32 v9, v9
    v_rcp_f32 v10, v10
    v_rcp_f32 v11, v11
    v_rcp_f32 v12, v12
    v_rcp_f32 v13, v13
    v_rcp_f32 v14, v14
    v_rcp_f32 v15, v15
    v_rcp_f32 v16, v16
    v_rcp_f32 v17, v17
    v_rcp_f32 v18, v18
    v_rcp_f32 v19, v19
    v_rcp_f32 v20, v20
    v_rcp_f32 v21, v21
    v_rcp_f32 v22, v22
    v_rcp_f32 v23, v23
    v_rcp_f32 v24, v24
    v_rcp_f32 v25, v25
    v_rcp_f32 v26, v26
    v_rcp_f32 v27, v27
    v_pk_mul_f32 v[8:9], v[8:9], v[116:117]
    v_pk_mul_f32 v[10:11], v[10:11], v[118:119]
    v_pk_mul_f32 v[12:13], v[12:13], v[120:121]
    v_pk_mul_f32 v[14:15], v[14:15], v[122:123]
    v_pk_mul_f32 v[16:17], v[16:17], v[124:125]
    v_pk_mul_f32 v[18:19], v[18:19], v[126:127]
    v_pk_mul_f32 v[20:21], v[20:21], v[128:129]
    v_pk_mul_f32 v[22:23], v[22:23], v[130:131]
    v_pk_mul_f32 v[24:25], v[24:25], v[132:133]
    v_pk_mul_f32 v[26:27], v[26:27], v[134:135]
    s_waitcnt lgkmcnt(0)
    v_lshlrev_b32 v28, 16, v136
    v_and_b32 v29, 0xffff0000, v136
    v_lshlrev_b32 v48, 16, v146
    v_and_b32 v49, 0xffff0000, v146
    v_lshlrev_b32 v30, 16, v137
    v_and_b32 v31, 0xffff0000, v137
    v_lshlrev_b32 v50, 16, v147
    v_and_b32 v51, 0xffff0000, v147
    v_lshlrev_b32 v32, 16, v138
    v_and_b32 v33, 0xffff0000, v138
    v_lshlrev_b32 v52, 16, v148
    v_and_b32 v53, 0xffff0000, v148
    v_lshlrev_b32 v34, 16, v139
    v_and_b32 v35, 0xffff0000, v139
    v_lshlrev_b32 v54, 16, v149
    v_and_b32 v55, 0xffff0000, v149
    v_lshlrev_b32 v36, 16, v140
    v_and_b32 v37, 0xffff0000, v140
    v_lshlrev_b32 v56, 16, v150
    v_and_b32 v57, 0xffff0000, v150
    v_lshlrev_b32 v38, 16, v141
    v_and_b32 v39, 0xffff0000, v141
    v_lshlrev_b32 v58, 16, v151
    v_and_b32 v59, 0xffff0000, v151
    v_lshlrev_b32 v40, 16, v142
    v_and_b32 v41, 0xffff0000, v142
    v_lshlrev_b32 v60, 16, v152
    v_and_b32 v61, 0xffff0000, v152
    v_lshlrev_b32 v42, 16, v143
    v_and_b32 v43, 0xffff0000, v143
    v_lshlrev_b32 v62, 16, v153
    v_and_b32 v63, 0xffff0000, v153
    v_lshlrev_b32 v44, 16, v144
    v_and_b32 v45, 0xffff0000, v144
    v_lshlrev_b32 v64, 16, v154
    v_and_b32 v65, 0xffff0000, v154
    v_lshlrev_b32 v46, 16, v145
    v_and_b32 v47, 0xffff0000, v145
    v_lshlrev_b32 v66, 16, v155
    v_and_b32 v67, 0xffff0000, v155
    v_mov_b32 v180, v111
    v_pk_add_f32 v[68:69], v[28:29], v[110:111] op_sel_hi:[1,0] neg_lo:[0,1] neg_hi:[0,1]
    v_pk_add_f32 v[70:71], v[30:31], v[110:111] op_sel_hi:[1,0] neg_lo:[0,1] neg_hi:[0,1]
    v_pk_add_f32 v[72:73], v[32:33], v[110:111] op_sel_hi:[1,0] neg_lo:[0,1] neg_hi:[0,1]
    v_pk_add_f32 v[74:75], v[34:35], v[110:111] op_sel_hi:[1,0] neg_lo:[0,1] neg_hi:[0,1]
    v_pk_add_f32 v[76:77], v[36:37], v[110:111] op_sel_hi:[1,0] neg_lo:[0,1] neg_hi:[0,1]
    v_pk_add_f32 v[78:79], v[38:39], v[110:111] op_sel_hi:[1,0] neg_lo:[0,1] neg_hi:[0,1]
    v_pk_add_f32 v[80:81], v[40:41], v[110:111] op_sel_hi:[1,0] neg_lo:[0,1] neg_hi:[0,1]
    v_pk_add_f32 v[82:83], v[42:43], v[110:111] op_sel_hi:[1,0] neg_lo:[0,1] neg_hi:[0,1]
    v_pk_add_f32 v[84:85], v[44:45], v[110:111] op_sel_hi:[1,0] neg_lo:[0,1] neg_hi:[0,1]
    v_pk_add_f32 v[86:87], v[46:47], v[110:111] op_sel_hi:[1,0] neg_lo:[0,1] neg_hi:[0,1]
    v_pk_mul_f32 v[68:69], v[68:69], v[180:181] op_sel_hi:[1,0]
    v_pk_mul_f32 v[70:71], v[70:71], v[180:181] op_sel_hi:[1,0]
    v_pk_mul_f32 v[72:73], v[72:73], v[180:181] op_sel_hi:[1,0]
    v_pk_mul_f32 v[74:75], v[74:75], v[180:181] op_sel_hi:[1,0]
    v_pk_mul_f32 v[76:77], v[76:77], v[180:181] op_sel_hi:[1,0]
    v_pk_mul_f32 v[78:79], v[78:79], v[180:181] op_sel_hi:[1,0]
    v_pk_mul_f32 v[80:81], v[80:81], v[180:181] op_sel_hi:[1,0]
    v_pk_mul_f32 v[82:83], v[82:83], v[180:181] op_sel_hi:[1,0]
    v_pk_mul_f32 v[84:85], v[84:85], v[180:181] op_sel_hi:[1,0]
    v_pk_mul_f32 v[86:87], v[86:87], v[180:181] op_sel_hi:[1,0]
    v_pk_mul_f32 v[68:69], v[68:69], v[48:49]
    v_pk_mul_f32 v[70:71], v[70:71], v[50:51]
    v_pk_mul_f32 v[72:73], v[72:73], v[52:53]
    v_pk_mul_f32 v[74:75], v[74:75], v[54:55]
    v_pk_mul_f32 v[76:77], v[76:77], v[56:57]
    v_pk_mul_f32 v[78:79], v[78:79], v[58:59]
    v_pk_mul_f32 v[80:81], v[80:81], v[60:61]
    v_pk_mul_f32 v[82:83], v[82:83], v[62:63]
    v_pk_mul_f32 v[84:85], v[84:85], v[64:65]
    v_pk_mul_f32 v[86:87], v[86:87], v[66:67]
    v_pk_fma_f32 v[68:69], v[68:69], v[8:9], v[28:29]
    v_pk_fma_f32 v[70:71], v[70:71], v[10:11], v[30:31]
    v_pk_fma_f32 v[72:73], v[72:73], v[12:13], v[32:33]
    v_pk_fma_f32 v[74:75], v[74:75], v[14:15], v[34:35]
    v_pk_fma_f32 v[76:77], v[76:77], v[16:17], v[36:37]
    v_pk_fma_f32 v[78:79], v[78:79], v[18:19], v[38:39]
    v_pk_fma_f32 v[80:81], v[80:81], v[20:21], v[40:41]
    v_pk_fma_f32 v[82:83], v[82:83], v[22:23], v[42:43]
    v_pk_fma_f32 v[84:85], v[84:85], v[24:25], v[44:45]
    v_pk_fma_f32 v[86:87], v[86:87], v[26:27], v[46:47]
    v_cvt_pk_bf16_f32 v136, v68, v69
    v_cvt_pk_bf16_f32 v137, v70, v71
    v_cvt_pk_bf16_f32 v138, v72, v73
    v_cvt_pk_bf16_f32 v139, v74, v75
    v_cvt_pk_bf16_f32 v140, v76, v77
    v_cvt_pk_bf16_f32 v141, v78, v79
    v_cvt_pk_bf16_f32 v142, v80, v81
    v_cvt_pk_bf16_f32 v143, v82, v83
    v_cvt_pk_bf16_f32 v144, v84, v85
    v_cvt_pk_bf16_f32 v145, v86, v87
    v_add_u32 v182, 143360, v176
    ds_write_b64 v182, v[136:137] offset:0
    ds_write_b64 v182, v[138:139] offset:32
    ds_write_b64 v182, v[140:141] offset:64
    ds_write_b64 v182, v[142:143] offset:96
    ds_write_b64 v182, v[144:145] offset:128
    s_mul_i32 s40, s34, 2560
    s_add_u32 s40, s40, 143360
    v_add_u32 v4, s40, v7
    s_waitcnt lgkmcnt(0)
    ds_read_b128 v[8:11], v4 offset:0
    ds_read_b128 v[12:15], v4 offset:1024
    ds_read_b128 v[16:19], v4 offset:2048
    s_mul_i32 s40, s34, 20480
    s_add_u32 s40, s40, s45
    s_waitcnt lgkmcnt(0)
    buffer_store_dwordx4 v[8:11], v104, s[16:19], s40 offen
    buffer_store_dwordx4 v[12:15], v105, s[16:19], s40 offen
    s_mov_b32 exec_hi, 0
    buffer_store_dwordx4 v[16:19], v106, s[16:19], s40 offen
    s_mov_b64 exec, -1
k3_kernel_end:
    s_endpgm
.section .rodata,"a"
.p2align 6
.amdhsa_kernel k1_kernel
  .amdhsa_next_free_vgpr 248
  .amdhsa_next_free_sgpr 102
  .amdhsa_accum_offset 248
  .amdhsa_group_segment_fixed_size 0
  .amdhsa_kernarg_size 112
  .amdhsa_user_sgpr_count 2
  .amdhsa_user_sgpr_kernarg_segment_ptr 1
  .amdhsa_system_sgpr_workgroup_id_x 1
.end_amdhsa_kernel
.p2align 6
.amdhsa_kernel k2_kernel
  .amdhsa_next_free_vgpr 197
  .amdhsa_next_free_sgpr 102
  .amdhsa_accum_offset 200
  .amdhsa_group_segment_fixed_size 0
  .amdhsa_kernarg_size 112
  .amdhsa_user_sgpr_count 2
  .amdhsa_user_sgpr_kernarg_segment_ptr 1
  .amdhsa_system_sgpr_workgroup_id_x 1
.end_amdhsa_kernel
.p2align 6
.amdhsa_kernel k3_kernel
  .amdhsa_next_free_vgpr 183
  .amdhsa_next_free_sgpr 102
  .amdhsa_accum_offset 184
  .amdhsa_group_segment_fixed_size 0
  .amdhsa_kernarg_size 112
  .amdhsa_user_sgpr_count 2
  .amdhsa_user_sgpr_kernarg_segment_ptr 1
  .amdhsa_system_sgpr_workgroup_id_x 1
.end_amdhsa_kernel
```

```asm
; @launch kernel=k1_kernel grid=(256,1,1) block=(512,1,1) lds=163840
; @launch kernel=k2_kernel grid=(512,1,1) block=(256,1,1) lds=81920
; @launch kernel=k3_kernel grid=(256,1,1) block=(256,1,1) lds=153600
.amdgcn_target "amdgcn-amd-amdhsa--gfx950"
.text
.globl k1_kernel
.p2align 8
.type k1_kernel,@function
k1_kernel:
    s_cmp_ge_u32 s2, 256
    s_cbranch_scc1 k1_kernel_end
    s_load_dwordx2 s[4:5], s[0:1], 0
    s_load_dwordx2 s[8:9], s[0:1], 56
    s_load_dwordx2 s[12:13], s[0:1], 8
    s_load_dwordx2 s[16:17], s[0:1], 16
    s_load_dwordx2 s[20:21], s[0:1], 24
    s_load_dwordx2 s[24:25], s[0:1], 104
    s_load_dwordx2 s[28:29], s[0:1], 96
    s_load_dwordx2 s[32:33], s[0:1], 64
    s_load_dwordx2 s[36:37], s[0:1], 32
    s_load_dwordx2 s[84:85], s[0:1], 80
    v_lshrrev_b32 v2, 6, v0
    v_and_b32 v1, 63, v0
    v_readfirstlane_b32 s42, v2
    v_lshrrev_b32 v2, 4, v1
    v_and_b32 v3, 15, v1
    s_and_b32 s48, s2, 7
    s_lshr_b32 s49, s2, 3
    s_lshr_b32 s66, s48, 1
    s_and_b32 s67, s48, 1
    s_lshl_b32 s40, s66, 3
    s_and_b32 s48, s49, 7
    s_add_u32 s40, s40, s48
    s_lshl_b32 s41, s67, 2
    s_lshr_b32 s48, s49, 3
    s_add_u32 s41, s41, s48
    s_mul_i32 s52, s40, 81920
    s_mul_i32 s54, s41, 192
    s_add_u32 s53, s54, 1536
    s_lshl_b32 s60, s42, 11
    s_mul_i32 s61, s42, 3072
    s_mov_b32 s6, 2621440
    s_mov_b32 s7, 0x20000
    s_mov_b32 s10, 1966080
    s_mov_b32 s11, 0x20000
    s_lshl_b32 s48, s42, 3
    v_add_u32 v4, s48, v2
    v_and_b32 v5, 15, v4
    v_xor_b32 v5, v5, v3
    v_mul_u32_u24 v4, 1280, v4
    v_lshl_add_u32 v38, v5, 4, v4
    v_add_u32 v4, s48, v2
    v_add_u32 v4, 4, v4
    v_and_b32 v5, 15, v4
    v_xor_b32 v5, v5, v3
    v_mul_u32_u24 v4, 1280, v4
    v_lshl_add_u32 v39, v5, 4, v4
    s_mul_i32 s48, s42, 192
    v_add_u32 v4, s48, v1
    v_mul_u32_u24 v5, 43691, v4
    v_lshrrev_b32 v5, 19, v5
    v_mul_u32_u24 v6, 12, v5
    v_sub_u32 v4, v4, v6
    v_lshrrev_b32 v6, 2, v5
    v_and_b32 v6, 2, v6
    v_xor_b32 v4, v4, v6
    v_mul_u32_u24 v5, 3072, v5
    v_lshl_add_u32 v40, v4, 4, v5
    v_add_u32 v4, s48, v1
    v_add_u32 v4, 64, v4
    v_mul_u32_u24 v5, 43691, v4
    v_lshrrev_b32 v5, 19, v5
    v_mul_u32_u24 v6, 12, v5
    v_sub_u32 v4, v4, v6
    v_lshrrev_b32 v6, 2, v5
    v_and_b32 v6, 2, v6
    v_xor_b32 v4, v4, v6
    v_mul_u32_u24 v5, 3072, v5
    v_lshl_add_u32 v41, v4, 4, v5
    v_add_u32 v4, s48, v1
    v_add_u32 v4, 128, v4
    v_mul_u32_u24 v5, 43691, v4
    v_lshrrev_b32 v5, 19, v5
    v_mul_u32_u24 v6, 12, v5
    v_sub_u32 v4, v4, v6
    v_lshrrev_b32 v6, 2, v5
    v_and_b32 v6, 2, v6
    v_xor_b32 v4, v4, v6
    v_mul_u32_u24 v5, 3072, v5
    v_lshl_add_u32 v42, v4, 4, v5
    s_add_u32 s48, s40, s41
    s_mul_i32 s49, s48, 52
    s_lshr_b32 s49, s49, 8
    s_mul_i32 s49, s49, 5
    s_sub_u32 s51, s48, s49
    s_add_u32 s49, s51, 0
    s_sub_u32 s50, s49, 5
    s_cmp_ge_u32 s49, 5
    s_cselect_b32 s49, s50, s49
    s_lshl_b32 s90, s49, 8
    s_mul_i32 s95, s49, 393216
    s_add_u32 s49, s51, 1
    s_sub_u32 s50, s49, 5
    s_cmp_ge_u32 s49, 5
    s_cselect_b32 s49, s50, s49
    s_lshl_b32 s91, s49, 8
    s_mul_i32 s96, s49, 393216
    s_waitcnt lgkmcnt(0)
    s_add_u32 s65, s52, s90
    s_add_u32 m0, s60, 0
    s_nop 0
    buffer_load_dwordx4 v38, s[4:7], s65 offen lds
    s_add_u32 s65, s52, s90
    s_add_u32 m0, s60, 1024
    s_nop 0
    buffer_load_dwordx4 v39, s[4:7], s65 offen lds
    s_add_u32 s65, s53, s95
    s_add_u32 m0, s61, 81920
    s_nop 0
    buffer_load_dwordx4 v40, s[8:11], s65 offen lds
    s_add_u32 s65, s53, s95
    s_add_u32 m0, s61, 82944
    s_nop 0
    buffer_load_dwordx4 v41, s[8:11], s65 offen lds
    s_add_u32 s65, s53, s95
    s_add_u32 m0, s61, 83968
    s_nop 0
    buffer_load_dwordx4 v42, s[8:11], s65 offen lds
    s_mov_b32 s48, 14712832
    s_load_dwordx2 s[100:101], s[24:25], s48
    s_add_u32 s49, s51, 2
    s_sub_u32 s50, s49, 5
    s_cmp_ge_u32 s49, 5
    s_cselect_b32 s49, s50, s49
    s_lshl_b32 s92, s49, 8
    s_mul_i32 s97, s49, 393216
    s_add_u32 s49, s51, 3
    s_sub_u32 s50, s49, 5
    s_cmp_ge_u32 s49, 5
    s_cselect_b32 s49, s50, s49
    s_lshl_b32 s93, s49, 8
    s_mul_i32 s98, s49, 393216
    s_add_u32 s49, s51, 4
    s_sub_u32 s50, s49, 5
    s_cmp_ge_u32 s49, 5
    s_cselect_b32 s49, s50, s49
    s_lshl_b32 s94, s49, 8
    s_mul_i32 s99, s49, 393216
    s_mov_b32 s14, 2621440
    s_mov_b32 s15, 0x20000
    s_mov_b32 s18, 2621440
    s_mov_b32 s19, 0x20000
    s_mov_b32 s22, 5120
    s_mov_b32 s23, 0x20000
    s_mov_b32 s26, 15990784
    s_mov_b32 s27, 0x20000
    s_mov_b32 s30, 256
    s_mov_b32 s31, 0x20000
    s_mov_b32 s34, 8388608
    s_mov_b32 s35, 0x20000
    s_mov_b32 s38, 2621440
    s_mov_b32 s39, 0x20000
    s_mov_b32 s86, 983040
    s_mov_b32 s87, 0x20000
    v_lshlrev_b32 v36, 7, v1
    s_barrier
    s_add_u32 s65, s52, s91
    s_add_u32 m0, s60, 16384
    s_nop 0
    buffer_load_dwordx4 v38, s[4:7], s65 offen lds
    s_add_u32 s65, s52, s91
    s_add_u32 m0, s60, 17408
    s_nop 0
    buffer_load_dwordx4 v39, s[4:7], s65 offen lds
    s_add_u32 s65, s53, s96
    s_add_u32 m0, s61, 106496
    s_nop 0
    buffer_load_dwordx4 v40, s[8:11], s65 offen lds
    s_add_u32 s65, s53, s96
    s_add_u32 m0, s61, 107520
    s_nop 0
    buffer_load_dwordx4 v41, s[8:11], s65 offen lds
    s_add_u32 s65, s53, s96
    s_add_u32 m0, s61, 108544
    s_nop 0
    buffer_load_dwordx4 v42, s[8:11], s65 offen lds
    s_cmp_lg_u32 s42, 7
    s_cbranch_scc1 k1_shk_1
    v_lshlrev_b32 v4, 4, v1
    s_mul_i32 s48, s41, 640
    s_mov_b32 m0, 160768
    s_mov_b32 exec_lo, -1
    s_mov_b32 exec_hi, 0xff
    buffer_load_dwordx4 v4, s[20:23], s48 offen lds
    s_mov_b64 exec, -1
k1_shk_1:
    s_and_b32 s43, s42, 1
    s_lshr_b32 s44, s42, 1
    s_and_b32 s44, s44, 1
    s_lshr_b32 s45, s42, 2
    s_xor_b32 s46, s43, s45
    s_lshl_b32 s47, s44, 1
    s_add_u32 s47, s47, s46
    s_mov_b32 s55, 0x3727c5ac
    s_mov_b32 s56, 0x3f803f80
    s_mov_b32 s58, 0xbdd2d3e8
    s_mov_b32 s59, 0xbdd2d3e8
    s_lshl_b32 s48, s45, 1
    s_add_u32 s63, s48, s44
    s_xor_b32 s64, s63, 1
    v_xor_b32 v4, v2, v3
    v_lshlrev_b32 v6, 8, v3
    s_lshl_b32 s48, s44, 13
    s_lshl_b32 s49, s46, 12
    s_add_u32 s50, s48, s49
    s_xor_b32 s49, s49, 4096
    s_add_u32 s51, s48, s49
    s_lshl_b32 s48, s63, 2
    v_xor_b32 v5, s48, v4
    v_lshl_add_u32 v5, v5, 4, v6
    v_add_u32 v45, s50, v5
    v_add_u32 v46, s51, v5
    s_lshl_b32 s48, s64, 2
    v_xor_b32 v5, s48, v4
    v_lshl_add_u32 v5, v5, 4, v6
    v_add_u32 v47, s50, v5
    v_add_u32 v216, s51, v5
    v_lshrrev_b32 v5, 2, v3
    v_lshl_add_u32 v4, v2, 3, v5
    v_mul_u32_u24 v4, 192, v4
    v_and_b32 v5, 3, v3
    v_lshl_add_u32 v4, v5, 3, v4
    v_and_b32 v5, 1, v2
    s_mul_i32 s51, s43, 3
    s_mul_i32 s49, s63, 6144
    s_add_u32 s49, s49, 81920
    s_mul_i32 s50, s64, 6144
    s_add_u32 s50, s50, 81920
    s_add_u32 s48, s51, 0
    v_xor_b32 v6, s48, v5
    v_lshl_add_u32 v6, v6, 5, v4
    v_add_u32 v217, s49, v6
    v_add_u32 v220, s50, v6
    s_add_u32 s48, s51, 1
    v_xor_b32 v6, s48, v5
    v_lshl_add_u32 v6, v6, 5, v4
    v_add_u32 v218, s49, v6
    v_add_u32 v221, s50, v6
    s_add_u32 s48, s51, 2
    v_xor_b32 v6, s48, v5
    v_lshl_add_u32 v6, v6, 5, v4
    v_add_u32 v219, s49, v6
    v_add_u32 v222, s50, v6
    v_mov_b32 v244, s56
    v_mov_b32 v245, s56
    v_mov_b32 v246, s56
    v_mov_b32 v247, s56
    v_mul_u32_u24 v43, 205, v1
    v_lshrrev_b32 v43, 11, v43
    v_mul_u32_u24 v4, 10, v43
    v_sub_u32 v44, v1, v4
    s_lshl_b32 s48, s42, 3
    v_lshl_add_u32 v4, v43, 1, s48
    v_min_u32 v4, 62, v4
    v_mul_u32_u24 v4, 160, v4
    v_lshl_add_u32 v7, v44, 4, v4
    v_lshlrev_b32 v215, 10, v1
    s_lshl_b32 s89, s2, 3
    s_add_u32 s89, s89, s42
    s_mul_i32 s70, s42, 3072
    s_add_u32 s70, s70, 16384
    s_xor_b32 s48, s42, 4
    s_mul_i32 s71, s48, 3072
    s_add_u32 s71, s71, 16384
    s_lshl_b32 s48, s43, 2
    s_lshl_b32 s49, s44, 1
    s_add_u32 s48, s48, s49
    s_add_u32 s48, s48, s45
    s_mul_i32 s72, s48, 192
    s_add_u32 s72, s72, 155648
    s_mul_i32 s73, s43, 768
    s_add_u32 s73, s73, 155648
    s_lshl_b32 s48, s47, 1
    s_add_u32 s48, s48, s45
    s_lshl_b32 s48, s48, 7
    s_add_u32 s74, s48, 158720
    s_lshl_b32 s48, s47, 8
    s_add_u32 s75, s48, 158720
    s_lshl_b32 s48, s47, 7
    s_lshl_b32 s49, s43, 9
    s_add_u32 s48, s48, s49
    s_add_u32 s76, s48, 159744
    s_lshl_b32 s48, s40, 3
    s_add_u32 s48, s48, s41
    s_lshl_b32 s49, s48, 10
    s_add_u32 s77, s49, 14745600
    s_mul_i32 s48, s48, 12288
    s_lshr_b32 s49, s47, 1
    s_mul_i32 s49, s49, 6144
    s_add_u32 s48, s48, s49
    s_and_b32 s49, s47, 1
    s_lshl_b32 s49, s49, 8
    s_add_u32 s48, s48, s49
    s_add_u32 s48, s48, 3145728
    s_mul_i32 s49, s43, 3
    s_add_u32 s49, s49, 0
    s_lshr_b32 s50, s49, 1
    s_lshl_b32 s50, s50, 10
    s_and_b32 s49, s49, 1
    s_lshl_b32 s49, s49, 3
    s_add_u32 s80, s48, s49
    s_add_u32 s80, s80, s50
    s_mul_i32 s49, s43, 3
    s_add_u32 s49, s49, 1
    s_lshr_b32 s50, s49, 1
    s_lshl_b32 s50, s50, 10
    s_and_b32 s49, s49, 1
    s_lshl_b32 s49, s49, 3
    s_add_u32 s81, s48, s49
    s_add_u32 s81, s81, s50
    s_mul_i32 s49, s43, 3
    s_add_u32 s49, s49, 2
    s_lshr_b32 s50, s49, 1
    s_lshl_b32 s50, s50, 10
    s_and_b32 s49, s49, 1
    s_lshl_b32 s49, s49, 3
    s_add_u32 s82, s48, s49
    s_add_u32 s82, s82, s50
    s_lshl_b32 s48, s40, 13
    s_lshl_b32 s49, s47, 8
    s_add_u32 s48, s48, s49
    s_add_u32 s78, s48, 14745600
    s_lshl_b32 s48, s40, 9
    s_lshl_b32 s49, s47, 7
    s_add_u32 s48, s48, s49
    s_add_u32 s79, s48, 14680064
    s_mul_i32 s48, s41, 327680
    s_lshl_b32 s49, s40, 7
    s_add_u32 s48, s48, s49
    s_add_u32 s83, s48, 6291456
    s_lshr_b32 s48, s2, 3
    s_lshl_b32 s48, s48, 3
    s_add_u32 s48, s48, s42
    s_lshl_b32 s48, s48, 13
    s_lshl_b32 s49, s66, 21
    s_add_u32 s66, s48, s49
    s_add_u32 s51, s42, 0
    s_mul_i32 s48, s51, 43
    s_lshr_b32 s48, s48, 7
    s_mul_i32 s49, s48, 3
    s_sub_u32 s49, s51, s49
    s_mul_i32 s48, s48, 3200
    s_lshl_b32 s49, s49, 6
    s_add_u32 s48, s48, s49
    s_add_u32 s88, s48, 0
    s_lshl_b32 s48, s41, 7
    s_lshl_b32 s49, s40, 2
    s_add_u32 s48, s48, s49
    s_mul_i32 s48, s48, 3
    s_add_u32 s48, s48, s51
    s_lshl_b32 s48, s48, 10
    s_add_u32 s64, s48, 0
    s_add_u32 s51, s42, 8
    s_mul_i32 s48, s51, 43
    s_lshr_b32 s48, s48, 7
    s_mul_i32 s49, s48, 3
    s_sub_u32 s49, s51, s49
    s_mul_i32 s48, s48, 3200
    s_lshl_b32 s49, s49, 6
    s_add_u32 s48, s48, s49
    s_add_u32 s63, s48, 0
    s_lshl_b32 s48, s41, 7
    s_lshl_b32 s49, s40, 2
    s_add_u32 s48, s48, s49
    s_mul_i32 s48, s48, 3
    s_add_u32 s48, s48, s51
    s_lshl_b32 s48, s48, 10
    s_add_u32 s67, s48, 0
    s_waitcnt vmcnt(5)
    s_waitcnt lgkmcnt(0)
    s_add_u32 s100, s100, 1
    s_addc_u32 s101, s101, 0
    s_barrier
    ds_read_b64_tr_b16 v[128:129], v217 offset:0
    ds_read_b64_tr_b16 v[130:131], v217 offset:768
    ds_read_b64_tr_b16 v[132:133], v218 offset:0
    ds_read_b64_tr_b16 v[134:135], v218 offset:768
    ds_read_b64_tr_b16 v[136:137], v219 offset:0
    ds_read_b64_tr_b16 v[138:139], v219 offset:768
    ds_read_b64_tr_b16 v[140:141], v220 offset:0
    ds_read_b64_tr_b16 v[142:143], v220 offset:768
    ds_read_b64_tr_b16 v[144:145], v221 offset:0
    ds_read_b64_tr_b16 v[146:147], v221 offset:768
    ds_read_b64_tr_b16 v[148:149], v222 offset:0
    ds_read_b64_tr_b16 v[150:151], v222 offset:768
    ds_read_b128 v[48:51], v45 offset:0
    ds_read_b128 v[52:55], v46 offset:0
    ds_read_b128 v[56:59], v47 offset:0
    ds_read_b128 v[60:63], v216 offset:0
    s_add_u32 s65, s52, s92
    s_add_u32 m0, s60, 32768
    s_nop 0
    buffer_load_dwordx4 v38, s[4:7], s65 offen lds
    s_add_u32 s65, s52, s92
    s_add_u32 m0, s60, 33792
    s_nop 0
    buffer_load_dwordx4 v39, s[4:7], s65 offen lds
    s_add_u32 s65, s53, s97
    s_add_u32 m0, s61, 131072
    s_nop 0
    buffer_load_dwordx4 v40, s[8:11], s65 offen lds
    s_add_u32 s65, s53, s97
    s_add_u32 m0, s61, 132096
    s_nop 0
    buffer_load_dwordx4 v41, s[8:11], s65 offen lds
    s_add_u32 s65, s53, s97
    s_add_u32 m0, s61, 133120
    s_nop 0
    buffer_load_dwordx4 v42, s[8:11], s65 offen lds
    s_waitcnt vmcnt(5)
    s_waitcnt lgkmcnt(0)
    s_barrier
    v_mfma_f32_16x16x32_bf16 v[176:179], v[128:131], v[48:51], 0
    ds_read_b64_tr_b16 v[152:153], v217 offset:24576
    ds_read_b64_tr_b16 v[154:155], v217 offset:25344
    v_mfma_f32_16x16x32_bf16 v[180:183], v[128:131], v[52:55], 0
    s_add_u32 s65, s52, s93
    s_add_u32 m0, s60, 49152
    s_nop 0
    buffer_load_dwordx4 v38, s[4:7], s65 offen lds
    ds_read_b64_tr_b16 v[156:157], v218 offset:24576
    ds_read_b64_tr_b16 v[158:159], v218 offset:25344
    v_mfma_f32_16x16x32_bf16 v[224:227], v[128:131], v[244:247], 0
    ds_read_b64_tr_b16 v[160:161], v219 offset:24576
    ds_read_b64_tr_b16 v[162:163], v219 offset:25344
    v_mfma_f32_16x16x32_bf16 v[184:187], v[132:135], v[48:51], 0
    ds_read_b64_tr_b16 v[164:165], v220 offset:24576
    ds_read_b64_tr_b16 v[166:167], v220 offset:25344
    v_mfma_f32_16x16x32_bf16 v[188:191], v[132:135], v[52:55], 0
    s_add_u32 s65, s52, s93
    s_add_u32 m0, s60, 50176
    s_nop 0
    buffer_load_dwordx4 v39, s[4:7], s65 offen lds
    ds_read_b64_tr_b16 v[168:169], v221 offset:24576
    ds_read_b64_tr_b16 v[170:171], v221 offset:25344
    v_mfma_f32_16x16x32_bf16 v[228:231], v[132:135], v[244:247], 0
    ds_read_b64_tr_b16 v[172:173], v222 offset:24576
    ds_read_b64_tr_b16 v[174:175], v222 offset:25344
    v_mfma_f32_16x16x32_bf16 v[192:195], v[136:139], v[48:51], 0
    ds_read_b128 v[64:67], v45 offset:16384
    ds_read_b128 v[68:71], v46 offset:16384
    v_mfma_f32_16x16x32_bf16 v[196:199], v[136:139], v[52:55], 0
    s_add_u32 s65, s53, s98
    s_add_u32 m0, s61, 81920
    s_nop 0
    buffer_load_dwordx4 v40, s[8:11], s65 offen lds
    ds_read_b128 v[72:75], v47 offset:16384
    ds_read_b128 v[76:79], v216 offset:16384
    v_mfma_f32_16x16x32_bf16 v[232:235], v[136:139], v[244:247], 0
    v_mfma_f32_16x16x32_bf16 v[236:239], v[244:247], v[48:51], 0
    v_mfma_f32_16x16x32_bf16 v[240:243], v[48:51], v[48:51], 0
    s_add_u32 s65, s53, s98
    s_add_u32 m0, s61, 82944
    s_nop 0
    buffer_load_dwordx4 v41, s[8:11], s65 offen lds
    v_mfma_f32_16x16x32_bf16 v[176:179], v[140:143], v[56:59], v[176:179]
    v_mfma_f32_16x16x32_bf16 v[180:183], v[140:143], v[60:63], v[180:183]
    v_mfma_f32_16x16x32_bf16 v[184:187], v[144:147], v[56:59], v[184:187]
    s_add_u32 s65, s53, s98
    s_add_u32 m0, s61, 83968
    s_nop 0
    buffer_load_dwordx4 v42, s[8:11], s65 offen lds
    v_mfma_f32_16x16x32_bf16 v[188:191], v[144:147], v[60:63], v[188:191]
    v_mfma_f32_16x16x32_bf16 v[192:195], v[148:151], v[56:59], v[192:195]
    v_mfma_f32_16x16x32_bf16 v[196:199], v[148:151], v[60:63], v[196:199]
    v_mfma_f32_16x16x32_bf16 v[236:239], v[244:247], v[56:59], v[236:239]
    v_mfma_f32_16x16x32_bf16 v[240:243], v[56:59], v[56:59], v[240:243]
    s_waitcnt vmcnt(5)
    s_waitcnt lgkmcnt(0)
    s_barrier
    v_mfma_f32_16x16x32_bf16 v[176:179], v[152:155], v[64:67], v[176:179]
    ds_read_b64_tr_b16 v[128:129], v217 offset:49152
    ds_read_b64_tr_b16 v[130:131], v217 offset:49920
    v_mfma_f32_16x16x32_bf16 v[180:183], v[152:155], v[68:71], v[180:183]
    s_add_u32 s65, s52, s94
    s_add_u32 m0, s60, 65536
    s_nop 0
    buffer_load_dwordx4 v38, s[4:7], s65 offen lds
    ds_read_b64_tr_b16 v[132:133], v218 offset:49152
    ds_read_b64_tr_b16 v[134:135], v218 offset:49920
    v_mfma_f32_16x16x32_bf16 v[224:227], v[152:155], v[244:247], v[224:227]
    ds_read_b64_tr_b16 v[136:137], v219 offset:49152
    ds_read_b64_tr_b16 v[138:139], v219 offset:49920
    v_mfma_f32_16x16x32_bf16 v[184:187], v[156:159], v[64:67], v[184:187]
    ds_read_b64_tr_b16 v[140:141], v220 offset:49152
    ds_read_b64_tr_b16 v[142:143], v220 offset:49920
    v_mfma_f32_16x16x32_bf16 v[188:191], v[156:159], v[68:71], v[188:191]
    s_add_u32 s65, s52, s94
    s_add_u32 m0, s60, 66560
    s_nop 0
    buffer_load_dwordx4 v39, s[4:7], s65 offen lds
    ds_read_b64_tr_b16 v[144:145], v221 offset:49152
    ds_read_b64_tr_b16 v[146:147], v221 offset:49920
    v_mfma_f32_16x16x32_bf16 v[228:231], v[156:159], v[244:247], v[228:231]
    ds_read_b64_tr_b16 v[148:149], v222 offset:49152
    ds_read_b64_tr_b16 v[150:151], v222 offset:49920
    v_mfma_f32_16x16x32_bf16 v[192:195], v[160:163], v[64:67], v[192:195]
    ds_read_b128 v[80:83], v45 offset:32768
    ds_read_b128 v[84:87], v46 offset:32768
    v_mfma_f32_16x16x32_bf16 v[196:199], v[160:163], v[68:71], v[196:199]
    s_add_u32 s65, s53, s99
    s_add_u32 m0, s61, 106496
    s_nop 0
    buffer_load_dwordx4 v40, s[8:11], s65 offen lds
    ds_read_b128 v[88:91], v47 offset:32768
    ds_read_b128 v[92:95], v216 offset:32768
    v_mfma_f32_16x16x32_bf16 v[232:235], v[160:163], v[244:247], v[232:235]
    v_mfma_f32_16x16x32_bf16 v[236:239], v[244:247], v[64:67], v[236:239]
    v_mfma_f32_16x16x32_bf16 v[240:243], v[64:67], v[64:67], v[240:243]
    s_add_u32 s65, s53, s99
    s_add_u32 m0, s61, 107520
    s_nop 0
    buffer_load_dwordx4 v41, s[8:11], s65 offen lds
    v_mfma_f32_16x16x32_bf16 v[176:179], v[164:167], v[72:75], v[176:179]
    v_mfma_f32_16x16x32_bf16 v[180:183], v[164:167], v[76:79], v[180:183]
    v_mfma_f32_16x16x32_bf16 v[184:187], v[168:171], v[72:75], v[184:187]
    s_add_u32 s65, s53, s99
    s_add_u32 m0, s61, 108544
    s_nop 0
    buffer_load_dwordx4 v42, s[8:11], s65 offen lds
    v_mfma_f32_16x16x32_bf16 v[188:191], v[168:171], v[76:79], v[188:191]
    v_mfma_f32_16x16x32_bf16 v[192:195], v[172:175], v[72:75], v[192:195]
    v_mfma_f32_16x16x32_bf16 v[196:199], v[172:175], v[76:79], v[196:199]
    s_add_u32 s48, s66, 0
    s_mov_b64 exec, 0xff
    buffer_load_dword v37, v215, s[32:35], s48 offen
    s_mov_b64 exec, -1
    v_mfma_f32_16x16x32_bf16 v[236:239], v[244:247], v[72:75], v[236:239]
    v_mfma_f32_16x16x32_bf16 v[240:243], v[72:75], v[72:75], v[240:243]
    s_waitcnt vmcnt(6)
    s_waitcnt lgkmcnt(0)
    s_barrier
    v_mfma_f32_16x16x32_bf16 v[176:179], v[128:131], v[80:83], v[176:179]
    ds_read_b64_tr_b16 v[152:153], v217 offset:0
    ds_read_b64_tr_b16 v[154:155], v217 offset:768
    v_mfma_f32_16x16x32_bf16 v[180:183], v[128:131], v[84:87], v[180:183]
    s_add_u32 s65, s54, s95
    s_add_u32 m0, s61, 131072
    s_nop 0
    buffer_load_dwordx4 v40, s[8:11], s65 offen lds
    ds_read_b64_tr_b16 v[156:157], v218 offset:0
    ds_read_b64_tr_b16 v[158:159], v218 offset:768
    v_mfma_f32_16x16x32_bf16 v[224:227], v[128:131], v[244:247], v[224:227]
    ds_read_b64_tr_b16 v[160:161], v219 offset:0
    ds_read_b64_tr_b16 v[162:163], v219 offset:768
    v_mfma_f32_16x16x32_bf16 v[184:187], v[132:135], v[80:83], v[184:187]
    ds_read_b64_tr_b16 v[164:165], v220 offset:0
    ds_read_b64_tr_b16 v[166:167], v220 offset:768
    v_mfma_f32_16x16x32_bf16 v[188:191], v[132:135], v[84:87], v[188:191]
    s_add_u32 s65, s54, s95
    s_add_u32 m0, s61, 132096
    s_nop 0
    buffer_load_dwordx4 v41, s[8:11], s65 offen lds
    ds_read_b64_tr_b16 v[168:169], v221 offset:0
    ds_read_b64_tr_b16 v[170:171], v221 offset:768
    v_mfma_f32_16x16x32_bf16 v[228:231], v[132:135], v[244:247], v[228:231]
    ds_read_b64_tr_b16 v[172:173], v222 offset:0
    ds_read_b64_tr_b16 v[174:175], v222 offset:768
    v_mfma_f32_16x16x32_bf16 v[192:195], v[136:139], v[80:83], v[192:195]
    ds_read_b128 v[96:99], v45 offset:49152
    ds_read_b128 v[100:103], v46 offset:49152
    v_mfma_f32_16x16x32_bf16 v[196:199], v[136:139], v[84:87], v[196:199]
    s_add_u32 s65, s54, s95
    s_add_u32 m0, s61, 133120
    s_nop 0
    buffer_load_dwordx4 v42, s[8:11], s65 offen lds
    ds_read_b128 v[104:107], v47 offset:49152
    ds_read_b128 v[108:111], v216 offset:49152
    v_mfma_f32_16x16x32_bf16 v[232:235], v[136:139], v[244:247], v[232:235]
    v_mfma_f32_16x16x32_bf16 v[236:239], v[244:247], v[80:83], v[236:239]
    v_mfma_f32_16x16x32_bf16 v[240:243], v[80:83], v[80:83], v[240:243]
    s_add_u32 s48, s66, 128
    s_mov_b64 exec, 0xff
    buffer_load_dword v37, v215, s[32:35], s48 offen
    s_mov_b64 exec, -1
    v_mfma_f32_16x16x32_bf16 v[176:179], v[140:143], v[88:91], v[176:179]
    v_mfma_f32_16x16x32_bf16 v[180:183], v[140:143], v[92:95], v[180:183]
    v_mfma_f32_16x16x32_bf16 v[184:187], v[144:147], v[88:91], v[184:187]
    s_mul_i32 s48, s89, 1280
    s_add_u32 s48, s48, 0
    s_mov_b64 exec, 0x1f
    buffer_load_dword v37, v36, s[36:39], s48 offen
    s_mov_b64 exec, -1
    v_mfma_f32_16x16x32_bf16 v[188:191], v[144:147], v[92:95], v[188:191]
    v_mfma_f32_16x16x32_bf16 v[192:195], v[148:151], v[88:91], v[192:195]
    v_mfma_f32_16x16x32_bf16 v[196:199], v[148:151], v[92:95], v[196:199]
    v_mfma_f32_16x16x32_bf16 v[236:239], v[244:247], v[88:91], v[236:239]
    v_mfma_f32_16x16x32_bf16 v[240:243], v[88:91], v[88:91], v[240:243]
    s_waitcnt vmcnt(6)
    s_waitcnt lgkmcnt(0)
    s_barrier
    v_mfma_f32_16x16x32_bf16 v[176:179], v[152:155], v[96:99], v[176:179]
    ds_read_b64_tr_b16 v[128:129], v217 offset:24576
    ds_read_b64_tr_b16 v[130:131], v217 offset:25344
    v_mfma_f32_16x16x32_bf16 v[180:183], v[152:155], v[100:103], v[180:183]
    s_add_u32 s65, s54, s96
    s_add_u32 m0, s61, 81920
    s_nop 0
    buffer_load_dwordx4 v40, s[8:11], s65 offen lds
    ds_read_b64_tr_b16 v[132:133], v218 offset:24576
    ds_read_b64_tr_b16 v[134:135], v218 offset:25344
    v_mfma_f32_16x16x32_bf16 v[224:227], v[152:155], v[244:247], v[224:227]
    ds_read_b64_tr_b16 v[136:137], v219 offset:24576
    ds_read_b64_tr_b16 v[138:139], v219 offset:25344
    v_mfma_f32_16x16x32_bf16 v[184:187], v[156:159], v[96:99], v[184:187]
    ds_read_b64_tr_b16 v[140:141], v220 offset:24576
    ds_read_b64_tr_b16 v[142:143], v220 offset:25344
    v_mfma_f32_16x16x32_bf16 v[188:191], v[156:159], v[100:103], v[188:191]
    s_add_u32 s65, s54, s96
    s_add_u32 m0, s61, 82944
    s_nop 0
    buffer_load_dwordx4 v41, s[8:11], s65 offen lds
    ds_read_b64_tr_b16 v[144:145], v221 offset:24576
    ds_read_b64_tr_b16 v[146:147], v221 offset:25344
    v_mfma_f32_16x16x32_bf16 v[228:231], v[156:159], v[244:247], v[228:231]
    ds_read_b64_tr_b16 v[148:149], v222 offset:24576
    ds_read_b64_tr_b16 v[150:151], v222 offset:25344
    v_mfma_f32_16x16x32_bf16 v[192:195], v[160:163], v[96:99], v[192:195]
    v_add_u32 v45, 0x10000, v45
    v_add_u32 v46, 0x10000, v46
    v_add_u32 v47, 0x10000, v47
    v_add_u32 v216, 0x10000, v216
    ds_read_b128 v[112:115], v45 offset:0
    ds_read_b128 v[116:119], v46 offset:0
    v_mfma_f32_16x16x32_bf16 v[196:199], v[160:163], v[100:103], v[196:199]
    s_add_u32 s65, s54, s96
    s_add_u32 m0, s61, 83968
    s_nop 0
    buffer_load_dwordx4 v42, s[8:11], s65 offen lds
    ds_read_b128 v[120:123], v47 offset:0
    ds_read_b128 v[124:127], v216 offset:0
    v_mfma_f32_16x16x32_bf16 v[232:235], v[160:163], v[244:247], v[232:235]
    v_mfma_f32_16x16x32_bf16 v[236:239], v[244:247], v[96:99], v[236:239]
    v_mfma_f32_16x16x32_bf16 v[240:243], v[96:99], v[96:99], v[240:243]
    s_add_u32 s48, s66, 256
    s_mov_b64 exec, 0xff
    buffer_load_dword v37, v215, s[32:35], s48 offen
    s_mov_b64 exec, -1
    v_mfma_f32_16x16x32_bf16 v[176:179], v[164:167], v[104:107], v[176:179]
    v_mfma_f32_16x16x32_bf16 v[180:183], v[164:167], v[108:111], v[180:183]
    v_mfma_f32_16x16x32_bf16 v[184:187], v[168:171], v[104:107], v[184:187]
    v_mfma_f32_16x16x32_bf16 v[188:191], v[168:171], v[108:111], v[188:191]
    v_mfma_f32_16x16x32_bf16 v[192:195], v[172:175], v[104:107], v[192:195]
    v_mfma_f32_16x16x32_bf16 v[196:199], v[172:175], v[108:111], v[196:199]
    v_mfma_f32_16x16x32_bf16 v[236:239], v[244:247], v[104:107], v[236:239]
    v_mfma_f32_16x16x32_bf16 v[240:243], v[104:107], v[104:107], v[240:243]
    s_waitcnt vmcnt(6)
    s_waitcnt lgkmcnt(0)
    s_barrier
    v_mfma_f32_16x16x32_bf16 v[176:179], v[128:131], v[112:115], v[176:179]
    ds_read_b64_tr_b16 v[152:153], v217 offset:49152
    ds_read_b64_tr_b16 v[154:155], v217 offset:49920
    v_mfma_f32_16x16x32_bf16 v[180:183], v[128:131], v[116:119], v[180:183]
    s_add_u32 s65, s54, s97
    s_add_u32 m0, s61, 106496
    s_nop 0
    buffer_load_dwordx4 v40, s[8:11], s65 offen lds
    ds_read_b64_tr_b16 v[156:157], v218 offset:49152
    ds_read_b64_tr_b16 v[158:159], v218 offset:49920
    v_mfma_f32_16x16x32_bf16 v[224:227], v[128:131], v[244:247], v[224:227]
    ds_read_b64_tr_b16 v[160:161], v219 offset:49152
    ds_read_b64_tr_b16 v[162:163], v219 offset:49920
    v_mfma_f32_16x16x32_bf16 v[184:187], v[132:135], v[112:115], v[184:187]
    ds_read_b64_tr_b16 v[164:165], v220 offset:49152
    ds_read_b64_tr_b16 v[166:167], v220 offset:49920
    v_mfma_f32_16x16x32_bf16 v[188:191], v[132:135], v[116:119], v[188:191]
    s_add_u32 s65, s54, s97
    s_add_u32 m0, s61, 107520
    s_nop 0
    buffer_load_dwordx4 v41, s[8:11], s65 offen lds
    ds_read_b64_tr_b16 v[168:169], v221 offset:49152
    ds_read_b64_tr_b16 v[170:171], v221 offset:49920
    v_mfma_f32_16x16x32_bf16 v[228:231], v[132:135], v[244:247], v[228:231]
    ds_read_b64_tr_b16 v[172:173], v222 offset:49152
    ds_read_b64_tr_b16 v[174:175], v222 offset:49920
    v_mfma_f32_16x16x32_bf16 v[192:195], v[136:139], v[112:115], v[192:195]
    v_mfma_f32_16x16x32_bf16 v[196:199], v[136:139], v[116:119], v[196:199]
    s_add_u32 s65, s54, s97
    s_add_u32 m0, s61, 108544
    s_nop 0
    buffer_load_dwordx4 v42, s[8:11], s65 offen lds
    v_mfma_f32_16x16x32_bf16 v[232:235], v[136:139], v[244:247], v[232:235]
    v_mfma_f32_16x16x32_bf16 v[236:239], v[244:247], v[112:115], v[236:239]
    v_mfma_f32_16x16x32_bf16 v[240:243], v[112:115], v[112:115], v[240:243]
    s_add_u32 s48, s66, 384
    s_mov_b64 exec, 0xff
    buffer_load_dword v37, v215, s[32:35], s48 offen
    s_mov_b64 exec, -1
    v_mfma_f32_16x16x32_bf16 v[176:179], v[140:143], v[120:123], v[176:179]
    v_mfma_f32_16x16x32_bf16 v[180:183], v[140:143], v[124:127], v[180:183]
    v_mfma_f32_16x16x32_bf16 v[184:187], v[144:147], v[120:123], v[184:187]
    v_mfma_f32_16x16x32_bf16 v[188:191], v[144:147], v[124:127], v[188:191]
    v_mfma_f32_16x16x32_bf16 v[192:195], v[148:151], v[120:123], v[192:195]
    v_mfma_f32_16x16x32_bf16 v[196:199], v[148:151], v[124:127], v[196:199]
    v_mfma_f32_16x16x32_bf16 v[236:239], v[244:247], v[120:123], v[236:239]
    v_mfma_f32_16x16x32_bf16 v[240:243], v[120:123], v[120:123], v[240:243]
    v_lshl_add_u32 v4, v1, 4, s70
    v_lshl_add_u32 v5, v2, 4, s72
    ds_write_b128 v4, v[180:183] offset:0
    s_nop 0
    ds_write_b128 v4, v[188:191] offset:1024
    s_nop 0
    ds_write_b128 v4, v[196:199] offset:2048
    s_mov_b32 exec_lo, 0x00010001
    s_mov_b32 exec_hi, 0x00010001
    ds_write_b128 v5, v[224:227] offset:0
    ds_write_b128 v5, v[228:231] offset:64
    ds_write_b128 v5, v[232:235] offset:128
    s_mov_b64 exec, -1
    v_and_b32 v8, 3, v3
    v_cmp_eq_u32 vcc, 1, v8
    s_nop 1
    v_cndmask_b32 v237, v240, v241, vcc
    v_cmp_eq_u32 vcc, 2, v8
    s_nop 1
    v_cndmask_b32 v237, v237, v242, vcc
    v_cmp_eq_u32 vcc, 3, v8
    s_nop 1
    v_cndmask_b32 v237, v237, v243, vcc
    v_lshl_add_u32 v6, v3, 3, s74
    s_mov_b32 exec_lo, 0x00F0000F
    s_mov_b32 exec_hi, 0xF0000F00
    ds_write_b64 v6, v[236:237]
    s_mov_b64 exec, -1
    v_pk_add_f32 v[200:201], v[176:177], 0
    v_pk_add_f32 v[202:203], v[178:179], 0
    v_pk_add_f32 v[204:205], v[184:185], 0
    v_pk_add_f32 v[206:207], v[186:187], 0
    v_pk_add_f32 v[208:209], v[192:193], 0
    v_pk_add_f32 v[210:211], v[194:195], 0
    v_mov_b32 v238, 0xc0135761
    v_mov_b32 v239, 0xc0135761
    s_waitcnt vmcnt(5)
    s_waitcnt lgkmcnt(0)
    s_barrier
    v_lshl_add_u32 v4, v1, 4, s71
    v_lshl_add_u32 v5, v3, 3, s75
    ds_read_b64 v[20:21], v5
    ds_read_b64 v[22:23], v5 offset:128
    ds_read_b128 v[8:11], v4 offset:0
    ds_read_b128 v[12:15], v4 offset:1024
    ds_read_b128 v[16:19], v4 offset:2048
    v_lshl_add_u32 v6, v2, 4, s73
    ds_read_b128 v[24:27], v6 offset:0
    ds_read_b128 v[28:31], v6 offset:64
    ds_read_b128 v[32:35], v6 offset:128
    ds_read_b128 v[176:179], v6 offset:192
    ds_read_b128 v[180:183], v6 offset:256
    ds_read_b128 v[184:187], v6 offset:320
    ds_read_b128 v[188:191], v6 offset:384
    ds_read_b128 v[192:195], v6 offset:448
    ds_read_b128 v[196:199], v6 offset:512
    ds_read_b128 v[224:227], v6 offset:576
    ds_read_b128 v[228:231], v6 offset:640
    ds_read_b128 v[232:235], v6 offset:704
    s_waitcnt lgkmcnt(15)
    v_pk_add_f32 v[240:241], v[20:21], v[22:23]
    v_mul_f32 v240, 0x3acccccd, v240
    v_mul_f32 v241, 0x3acccccd, v241
    v_fma_f32 v241, -v240, v240, v241
    v_max_f32 v241, 0, v241
    v_cvt_pk_bf16_f32 v241, v241, v240
    v_and_b32 v240, 0xffff0000, v241
    v_lshlrev_b32 v241, 16, v241
    v_add_f32 v241, s55, v241
    v_cvt_pk_bf16_f32 v241, v241, v241
    v_and_b32 v241, 0xffff0000, v241
    v_sqrt_f32 v241, v241
    s_nop 0
    v_cvt_pk_bf16_f32 v241, v241, v241
    v_and_b32 v241, 0xffff0000, v241
    v_rcp_f32 v241, v241
    s_nop 0
    v_mov_b32 v242, v241
    s_waitcnt lgkmcnt(12)
    v_pk_add_f32 v[200:201], v[200:201], v[8:9]
    v_pk_add_f32 v[202:203], v[202:203], v[10:11]
    v_pk_add_f32 v[204:205], v[204:205], v[12:13]
    v_pk_add_f32 v[206:207], v[206:207], v[14:15]
    v_pk_add_f32 v[208:209], v[208:209], v[16:17]
    v_pk_add_f32 v[210:211], v[210:211], v[18:19]
    s_waitcnt lgkmcnt(6)
    v_pk_add_f32 v[24:25], v[24:25], v[176:177]
    v_pk_add_f32 v[26:27], v[26:27], v[178:179]
    v_pk_add_f32 v[28:29], v[28:29], v[180:181]
    v_pk_add_f32 v[30:31], v[30:31], v[182:183]
    v_pk_add_f32 v[32:33], v[32:33], v[184:185]
    v_pk_add_f32 v[34:35], v[34:35], v[186:187]
    s_waitcnt lgkmcnt(0)
    v_pk_add_f32 v[188:189], v[188:189], v[224:225]
    v_pk_add_f32 v[190:191], v[190:191], v[226:227]
    v_pk_add_f32 v[192:193], v[192:193], v[228:229]
    v_pk_add_f32 v[194:195], v[194:195], v[230:231]
    v_pk_add_f32 v[196:197], v[196:197], v[232:233]
    v_pk_add_f32 v[198:199], v[198:199], v[234:235]
    v_pk_add_f32 v[24:25], v[24:25], v[188:189]
    v_pk_add_f32 v[26:27], v[26:27], v[190:191]
    v_pk_add_f32 v[28:29], v[28:29], v[192:193]
    v_pk_add_f32 v[30:31], v[30:31], v[194:195]
    v_pk_add_f32 v[32:33], v[32:33], v[196:197]
    v_pk_add_f32 v[34:35], v[34:35], v[198:199]
    v_pk_fma_f32 v[200:201], v[24:25], v[240:241], v[200:201] op_sel_hi:[1,0,1] neg_lo:[0,1,0] neg_hi:[0,1,0]
    v_pk_fma_f32 v[202:203], v[26:27], v[240:241], v[202:203] op_sel_hi:[1,0,1] neg_lo:[0,1,0] neg_hi:[0,1,0]
    v_pk_fma_f32 v[204:205], v[28:29], v[240:241], v[204:205] op_sel_hi:[1,0,1] neg_lo:[0,1,0] neg_hi:[0,1,0]
    v_pk_fma_f32 v[206:207], v[30:31], v[240:241], v[206:207] op_sel_hi:[1,0,1] neg_lo:[0,1,0] neg_hi:[0,1,0]
    v_pk_fma_f32 v[208:209], v[32:33], v[240:241], v[208:209] op_sel_hi:[1,0,1] neg_lo:[0,1,0] neg_hi:[0,1,0]
    v_pk_fma_f32 v[210:211], v[34:35], v[240:241], v[210:211] op_sel_hi:[1,0,1] neg_lo:[0,1,0] neg_hi:[0,1,0]
    v_pk_mul_f32 v[200:201], v[200:201], v[242:243] op_sel_hi:[1,0]
    v_pk_mul_f32 v[202:203], v[202:203], v[242:243] op_sel_hi:[1,0]
    v_pk_mul_f32 v[204:205], v[204:205], v[242:243] op_sel_hi:[1,0]
    v_pk_mul_f32 v[206:207], v[206:207], v[242:243] op_sel_hi:[1,0]
    v_pk_mul_f32 v[208:209], v[208:209], v[242:243] op_sel_hi:[1,0]
    v_pk_mul_f32 v[210:211], v[210:211], v[242:243] op_sel_hi:[1,0]
    v_pk_mul_f32 v[8:9], v[200:201], v[200:201]
    v_pk_mul_f32 v[10:11], v[202:203], v[202:203]
    v_pk_mul_f32 v[12:13], v[204:205], v[204:205]
    v_pk_mul_f32 v[14:15], v[206:207], v[206:207]
    v_pk_mul_f32 v[16:17], v[208:209], v[208:209]
    v_pk_mul_f32 v[18:19], v[210:211], v[210:211]
    v_pk_fma_f32 v[8:9], v[8:9], s[58:59], v[238:239]
    v_pk_fma_f32 v[10:11], v[10:11], s[58:59], v[238:239]
    v_pk_fma_f32 v[12:13], v[12:13], s[58:59], v[238:239]
    v_pk_fma_f32 v[14:15], v[14:15], s[58:59], v[238:239]
    v_pk_fma_f32 v[16:17], v[16:17], s[58:59], v[238:239]
    v_pk_fma_f32 v[18:19], v[18:19], s[58:59], v[238:239]
    v_pk_mul_f32 v[8:9], v[8:9], v[200:201]
    v_pk_mul_f32 v[10:11], v[10:11], v[202:203]
    v_pk_mul_f32 v[12:13], v[12:13], v[204:205]
    v_pk_mul_f32 v[14:15], v[14:15], v[206:207]
    v_pk_mul_f32 v[16:17], v[16:17], v[208:209]
    v_pk_mul_f32 v[18:19], v[18:19], v[210:211]
    v_exp_f32 v8, v8
    v_exp_f32 v9, v9
    v_exp_f32 v10, v10
    v_exp_f32 v11, v11
    v_exp_f32 v12, v12
    v_exp_f32 v13, v13
    v_exp_f32 v14, v14
    v_exp_f32 v15, v15
    v_exp_f32 v16, v16
    v_exp_f32 v17, v17
    v_exp_f32 v18, v18
    v_exp_f32 v19, v19
    v_pk_add_f32 v[8:9], v[8:9], 1.0 op_sel_hi:[1,0]
    v_pk_add_f32 v[10:11], v[10:11], 1.0 op_sel_hi:[1,0]
    v_pk_add_f32 v[12:13], v[12:13], 1.0 op_sel_hi:[1,0]
    v_pk_add_f32 v[14:15], v[14:15], 1.0 op_sel_hi:[1,0]
    v_pk_add_f32 v[16:17], v[16:17], 1.0 op_sel_hi:[1,0]
    v_pk_add_f32 v[18:19], v[18:19], 1.0 op_sel_hi:[1,0]
    v_rcp_f32 v8, v8
    v_rcp_f32 v9, v9
    v_rcp_f32 v10, v10
    v_rcp_f32 v11, v11
    v_rcp_f32 v12, v12
    v_rcp_f32 v13, v13
    v_rcp_f32 v14, v14
    v_rcp_f32 v15, v15
    v_rcp_f32 v16, v16
    v_rcp_f32 v17, v17
    v_rcp_f32 v18, v18
    v_rcp_f32 v19, v19
    v_pk_mul_f32 v[200:201], v[200:201], v[8:9]
    v_pk_mul_f32 v[202:203], v[202:203], v[10:11]
    v_pk_mul_f32 v[204:205], v[204:205], v[12:13]
    v_pk_mul_f32 v[206:207], v[206:207], v[14:15]
    v_pk_mul_f32 v[208:209], v[208:209], v[16:17]
    v_pk_mul_f32 v[210:211], v[210:211], v[18:19]
    v_pk_add_f32 v[14:15], v[200:201], v[202:203]
    v_pk_mul_f32 v[16:17], v[200:201], v[200:201]
    v_pk_add_f32 v[18:19], v[204:205], v[206:207]
    v_pk_fma_f32 v[16:17], v[202:203], v[202:203], v[16:17]
    v_pk_add_f32 v[20:21], v[208:209], v[210:211]
    v_pk_fma_f32 v[16:17], v[204:205], v[204:205], v[16:17]
    v_pk_add_f32 v[14:15], v[14:15], v[18:19]
    v_pk_fma_f32 v[16:17], v[206:207], v[206:207], v[16:17]
    v_pk_add_f32 v[14:15], v[14:15], v[20:21]
    v_pk_fma_f32 v[16:17], v[208:209], v[208:209], v[16:17]
    v_pk_fma_f32 v[16:17], v[210:211], v[210:211], v[16:17]
    v_add_f32 v8, v14, v15
    v_add_f32 v9, v16, v17
    v_lshl_add_u32 v4, v3, 3, s76
    v_mov_b32 v12, v8
    v_mov_b32 v13, v9
    s_nop 0
    v_permlane16_swap_b32 v8, v12
    v_permlane16_swap_b32 v9, v13
    v_add_f32 v8, v8, v12
    v_add_f32 v9, v9, v13
    v_mov_b32 v12, v8
    v_mov_b32 v13, v9
    s_nop 0
    v_permlane32_swap_b32 v8, v12
    v_permlane32_swap_b32 v9, v13
    v_add_f32 v8, v8, v12
    v_add_f32 v9, v9, v13
    s_mov_b64 exec, 0xffff
    ds_write_b64 v4, v[8:9]
    s_mov_b64 exec, -1
    s_or_b32 s48, s41, s43
    s_cmp_eq_u32 s48, 0
    v_lshlrev_b32 v4, 3, v3
    s_cselect_b64 exec, 0xffff, 0
    buffer_store_dwordx2 v[240:241], v4, s[24:27], s79 offen
    s_mov_b64 exec, -1
    v_mfma_f32_16x16x32_bf16 v[176:179], v[152:155], v[48:51], 0
    ds_read_b64_tr_b16 v[128:129], v217 offset:0
    ds_read_b64_tr_b16 v[130:131], v217 offset:768
    v_mfma_f32_16x16x32_bf16 v[180:183], v[152:155], v[52:55], 0
    s_add_u32 s65, s54, s98
    s_add_u32 m0, s61, 131072
    s_nop 0
    buffer_load_dwordx4 v40, s[8:11], s65 offen lds
    ds_read_b64_tr_b16 v[132:133], v218 offset:0
    ds_read_b64_tr_b16 v[134:135], v218 offset:768
    v_mfma_f32_16x16x32_bf16 v[224:227], v[152:155], v[244:247], 0
    ds_read_b64_tr_b16 v[136:137], v219 offset:0
    ds_read_b64_tr_b16 v[138:139], v219 offset:768
    v_mfma_f32_16x16x32_bf16 v[184:187], v[156:159], v[48:51], 0
    ds_read_b64_tr_b16 v[140:141], v220 offset:0
    ds_read_b64_tr_b16 v[142:143], v220 offset:768
    v_mfma_f32_16x16x32_bf16 v[188:191], v[156:159], v[52:55], 0
    s_add_u32 s65, s54, s98
    s_add_u32 m0, s61, 132096
    s_nop 0
    buffer_load_dwordx4 v41, s[8:11], s65 offen lds
    ds_read_b64_tr_b16 v[144:145], v221 offset:0
    ds_read_b64_tr_b16 v[146:147], v221 offset:768
    v_mfma_f32_16x16x32_bf16 v[228:231], v[156:159], v[244:247], 0
    ds_read_b64_tr_b16 v[148:149], v222 offset:0
    ds_read_b64_tr_b16 v[150:151], v222 offset:768
    v_mfma_f32_16x16x32_bf16 v[192:195], v[160:163], v[48:51], 0
    v_mfma_f32_16x16x32_bf16 v[196:199], v[160:163], v[52:55], 0
    s_add_u32 s65, s54, s98
    s_add_u32 m0, s61, 133120
    s_nop 0
    buffer_load_dwordx4 v42, s[8:11], s65 offen lds
    v_mfma_f32_16x16x32_bf16 v[232:235], v[160:163], v[244:247], 0
    v_mfma_f32_16x16x32_bf16 v[176:179], v[164:167], v[56:59], v[176:179]
    v_mfma_f32_16x16x32_bf16 v[180:183], v[164:167], v[60:63], v[180:183]
    v_mul_u32_u24 v4, 1280, v43
    v_lshl_add_u32 v4, v44, 4, v4
    s_mul_i32 s51, s41, 160
    s_add_u32 s51, s51, s52
    s_mul_i32 s48, s42, 7680
    s_add_u32 s48, s48, s51
    s_sub_i32 s48, s48, 3840
    s_cmp_lt_i32 s48, 0
    s_cselect_b32 s49, 3840, 0
    s_add_u32 s48, s48, s49
    v_subrev_u32 v5, s49, v4
    s_mul_i32 s50, s42, 960
    s_add_u32 m0, s50, 65536
    s_mov_b32 exec_lo, -1
    s_mov_b32 exec_hi, 0xfffffff
    buffer_load_dwordx4 v5, s[12:15], s48 offen lds
    s_mov_b64 exec, -1
    v_mfma_f32_16x16x32_bf16 v[184:187], v[168:171], v[56:59], v[184:187]
    v_mfma_f32_16x16x32_bf16 v[188:191], v[168:171], v[60:63], v[188:191]
    v_mfma_f32_16x16x32_bf16 v[192:195], v[172:175], v[56:59], v[192:195]
    s_cmp_ge_u32 s42, 4
    s_mov_b32 exec_lo, -1
    s_mov_b32 exec_hi, 0xfffffff
    s_cbranch_scc1 k1_kvv_2
    s_mul_i32 s48, s42, 7680
    s_add_u32 s48, s48, s51
    s_add_u32 s48, s48, 57600
    s_mul_i32 s50, s42, 960
    s_add_u32 m0, s50, 73216
    s_nop 0
    buffer_load_dwordx4 v4, s[12:15], s48 offen lds
    s_branch k1_kve_3
k1_kvv_2:
    s_sub_u32 s49, s42, 4
    s_mul_i32 s48, s49, 7680
    s_add_u32 s48, s48, s51
    s_mul_i32 s50, s49, 960
    s_add_u32 m0, s50, 49152
    s_nop 0
    buffer_load_dwordx4 v4, s[16:19], s48 offen lds
k1_kve_3:
    s_mov_b64 exec, -1
    v_mfma_f32_16x16x32_bf16 v[196:199], v[172:175], v[60:63], v[196:199]
    s_add_u32 s49, s42, 4
    s_mul_i32 s48, s49, 7680
    s_add_u32 s48, s48, s51
    s_mul_i32 s50, s49, 960
    s_add_u32 m0, s50, 49152
    s_mov_b32 exec_lo, -1
    s_mov_b32 exec_hi, 0xfffffff
    buffer_load_dwordx4 v4, s[16:19], s48 offen lds
    s_mov_b64 exec, -1
    s_add_u32 s48, s66, 512
    s_mov_b64 exec, 0xff
    buffer_load_dword v37, v215, s[32:35], s48 offen
    s_mov_b64 exec, -1
    s_mul_i32 s48, s89, 1280
    s_add_u32 s48, s48, 640
    s_mov_b64 exec, 0x1f
    buffer_load_dword v37, v36, s[36:39], s48 offen
    s_mov_b64 exec, -1
    s_waitcnt vmcnt(10)
    s_waitcnt lgkmcnt(0)
    s_barrier
    s_cmp_lg_u32 s42, 0
    s_cbranch_scc1 k1_pub_4
    v_lshlrev_b32 v4, 3, v1
    v_add_u32 v5, 159744, v4
    ds_read_b64 v[8:9], v5
    ds_read_b64 v[12:13], v5 offset:512
    v_lshlrev_b32 v4, 4, v1
    v_mov_b32 v10, s100
    v_mov_b32 v11, s101
    s_waitcnt lgkmcnt(0)
    v_pk_add_f32 v[8:9], v[8:9], v[12:13]
k1_pub_4:
    s_cmp_eq_u32 s42, 0
    s_cselect_b64 exec, -1, 0
    buffer_store_dwordx4 v[8:11], v4, s[24:27], s77 offen sc1
    s_mov_b64 exec, -1
    v_mfma_f32_16x16x32_bf16 v[176:179], v[128:131], v[64:67], v[176:179]
    ds_read_b64_tr_b16 v[152:153], v217 offset:24576
    ds_read_b64_tr_b16 v[154:155], v217 offset:25344
    v_mfma_f32_16x16x32_bf16 v[180:183], v[128:131], v[68:71], v[180:183]
    s_add_u32 s65, s54, s99
    s_add_u32 m0, s61, 81920
    s_nop 0
    buffer_load_dwordx4 v40, s[8:11], s65 offen lds
    ds_read_b64_tr_b16 v[156:157], v218 offset:24576
    ds_read_b64_tr_b16 v[158:159], v218 offset:25344
    v_mfma_f32_16x16x32_bf16 v[224:227], v[128:131], v[244:247], v[224:227]
    ds_read_b64_tr_b16 v[160:161], v219 offset:24576
    ds_read_b64_tr_b16 v[162:163], v219 offset:25344
    v_mfma_f32_16x16x32_bf16 v[184:187], v[132:135], v[64:67], v[184:187]
    ds_read_b64_tr_b16 v[164:165], v220 offset:24576
    ds_read_b64_tr_b16 v[166:167], v220 offset:25344
    v_mfma_f32_16x16x32_bf16 v[188:191], v[132:135], v[68:71], v[188:191]
    s_add_u32 s65, s54, s99
    s_add_u32 m0, s61, 82944
    s_nop 0
    buffer_load_dwordx4 v41, s[8:11], s65 offen lds
    ds_read_b64_tr_b16 v[168:169], v221 offset:24576
    ds_read_b64_tr_b16 v[170:171], v221 offset:25344
    v_mfma_f32_16x16x32_bf16 v[228:231], v[132:135], v[244:247], v[228:231]
    ds_read_b64_tr_b16 v[172:173], v222 offset:24576
    ds_read_b64_tr_b16 v[174:175], v222 offset:25344
    v_mfma_f32_16x16x32_bf16 v[192:195], v[136:139], v[64:67], v[192:195]
    v_mfma_f32_16x16x32_bf16 v[196:199], v[136:139], v[68:71], v[196:199]
    s_add_u32 s65, s54, s99
    s_add_u32 m0, s61, 83968
    s_nop 0
    buffer_load_dwordx4 v42, s[8:11], s65 offen lds
    v_mfma_f32_16x16x32_bf16 v[232:235], v[136:139], v[244:247], v[232:235]
    v_mfma_f32_16x16x32_bf16 v[176:179], v[140:143], v[72:75], v[176:179]
    v_mfma_f32_16x16x32_bf16 v[180:183], v[140:143], v[76:79], v[180:183]
    s_add_u32 s48, s66, 640
    s_mov_b64 exec, 0xff
    buffer_load_dword v37, v215, s[32:35], s48 offen
    s_mov_b64 exec, -1
    v_mfma_f32_16x16x32_bf16 v[184:187], v[144:147], v[72:75], v[184:187]
    v_mfma_f32_16x16x32_bf16 v[188:191], v[144:147], v[76:79], v[188:191]
    v_mfma_f32_16x16x32_bf16 v[192:195], v[148:151], v[72:75], v[192:195]
    v_mfma_f32_16x16x32_bf16 v[196:199], v[148:151], v[76:79], v[196:199]
    s_waitcnt vmcnt(10)
    s_waitcnt lgkmcnt(0)
    s_barrier
    v_mfma_f32_16x16x32_bf16 v[176:179], v[152:155], v[80:83], v[176:179]
    ds_read_b64_tr_b16 v[128:129], v217 offset:49152
    ds_read_b64_tr_b16 v[130:131], v217 offset:49920
    v_mfma_f32_16x16x32_bf16 v[180:183], v[152:155], v[84:87], v[180:183]
    s_add_u32 s48, s66, 768
    s_mov_b64 exec, 0xff
    buffer_load_dword v37, v215, s[32:35], s48 offen
    s_mov_b64 exec, -1
    ds_read_b64_tr_b16 v[132:133], v218 offset:49152
    ds_read_b64_tr_b16 v[134:135], v218 offset:49920
    v_mfma_f32_16x16x32_bf16 v[224:227], v[152:155], v[244:247], v[224:227]
    ds_read_b64_tr_b16 v[136:137], v219 offset:49152
    ds_read_b64_tr_b16 v[138:139], v219 offset:49920
    v_mfma_f32_16x16x32_bf16 v[184:187], v[156:159], v[80:83], v[184:187]
    ds_read_b64_tr_b16 v[140:141], v220 offset:49152
    ds_read_b64_tr_b16 v[142:143], v220 offset:49920
    v_mfma_f32_16x16x32_bf16 v[188:191], v[156:159], v[84:87], v[188:191]
    s_mul_i32 s48, s89, 512
    s_add_u32 s48, s48, 0
    s_mov_b64 exec, 0xf
    buffer_load_dword v37, v36, s[84:87], s48 offen
    s_mov_b64 exec, -1
    ds_read_b64_tr_b16 v[144:145], v221 offset:49152
    ds_read_b64_tr_b16 v[146:147], v221 offset:49920
    v_mfma_f32_16x16x32_bf16 v[228:231], v[156:159], v[244:247], v[228:231]
    ds_read_b64_tr_b16 v[148:149], v222 offset:49152
    ds_read_b64_tr_b16 v[150:151], v222 offset:49920
    v_mfma_f32_16x16x32_bf16 v[192:195], v[160:163], v[80:83], v[192:195]
    v_mfma_f32_16x16x32_bf16 v[196:199], v[160:163], v[84:87], v[196:199]
    v_mfma_f32_16x16x32_bf16 v[232:235], v[160:163], v[244:247], v[232:235]
    v_mfma_f32_16x16x32_bf16 v[176:179], v[164:167], v[88:91], v[176:179]
    v_mfma_f32_16x16x32_bf16 v[180:183], v[164:167], v[92:95], v[180:183]
    v_mfma_f32_16x16x32_bf16 v[184:187], v[168:171], v[88:91], v[184:187]
    v_mfma_f32_16x16x32_bf16 v[188:191], v[168:171], v[92:95], v[188:191]
    v_mfma_f32_16x16x32_bf16 v[192:195], v[172:175], v[88:91], v[192:195]
    v_mfma_f32_16x16x32_bf16 v[196:199], v[172:175], v[92:95], v[196:199]
    s_waitcnt vmcnt(3)
    s_waitcnt lgkmcnt(0)
    s_barrier
    v_mfma_f32_16x16x32_bf16 v[176:179], v[128:131], v[96:99], v[176:179]
    ds_read_b64_tr_b16 v[152:153], v217 offset:0
    ds_read_b64_tr_b16 v[154:155], v217 offset:768
    v_mfma_f32_16x16x32_bf16 v[180:183], v[128:131], v[100:103], v[180:183]
    s_add_u32 s48, s66, 896
    s_mov_b64 exec, 0xff
    buffer_load_dword v37, v215, s[32:35], s48 offen
    s_mov_b64 exec, -1
    ds_read_b64_tr_b16 v[156:157], v218 offset:0
    ds_read_b64_tr_b16 v[158:159], v218 offset:768
    v_mfma_f32_16x16x32_bf16 v[224:227], v[128:131], v[244:247], v[224:227]
    ds_read_b64_tr_b16 v[160:161], v219 offset:0
    ds_read_b64_tr_b16 v[162:163], v219 offset:768
    v_mfma_f32_16x16x32_bf16 v[184:187], v[132:135], v[96:99], v[184:187]
    ds_read_b64_tr_b16 v[164:165], v220 offset:0
    ds_read_b64_tr_b16 v[166:167], v220 offset:768
    v_mfma_f32_16x16x32_bf16 v[188:191], v[132:135], v[100:103], v[188:191]
    ds_read_b64_tr_b16 v[168:169], v221 offset:0
    ds_read_b64_tr_b16 v[170:171], v221 offset:768
    v_mfma_f32_16x16x32_bf16 v[228:231], v[132:135], v[244:247], v[228:231]
    ds_read_b64_tr_b16 v[172:173], v222 offset:0
    ds_read_b64_tr_b16 v[174:175], v222 offset:768
    v_mfma_f32_16x16x32_bf16 v[192:195], v[136:139], v[96:99], v[192:195]
    v_mfma_f32_16x16x32_bf16 v[196:199], v[136:139], v[100:103], v[196:199]
    v_mfma_f32_16x16x32_bf16 v[232:235], v[136:139], v[244:247], v[232:235]
    v_mfma_f32_16x16x32_bf16 v[176:179], v[140:143], v[104:107], v[176:179]
    v_mfma_f32_16x16x32_bf16 v[180:183], v[140:143], v[108:111], v[180:183]
    v_mfma_f32_16x16x32_bf16 v[184:187], v[144:147], v[104:107], v[184:187]
    v_mfma_f32_16x16x32_bf16 v[188:191], v[144:147], v[108:111], v[188:191]
    v_mfma_f32_16x16x32_bf16 v[192:195], v[148:151], v[104:107], v[192:195]
    v_mfma_f32_16x16x32_bf16 v[196:199], v[148:151], v[108:111], v[196:199]
    s_waitcnt lgkmcnt(0)
    s_barrier
    v_lshlrev_b32 v38, 4, v3
    v_lshl_add_u32 v38, v2, 11, v38
    buffer_load_dwordx4 v[28:31], v38, s[24:27], s78 offen sc1
    buffer_load_dwordx4 v[32:35], v38, s[24:27], s78 offen offset:1024 sc1
    v_mfma_f32_16x16x32_bf16 v[176:179], v[152:155], v[112:115], v[176:179]
    v_mfma_f32_16x16x32_bf16 v[180:183], v[152:155], v[116:119], v[180:183]
    v_mfma_f32_16x16x32_bf16 v[224:227], v[152:155], v[244:247], v[224:227]
    v_mfma_f32_16x16x32_bf16 v[184:187], v[156:159], v[112:115], v[184:187]
    v_mfma_f32_16x16x32_bf16 v[188:191], v[156:159], v[116:119], v[188:191]
    v_mfma_f32_16x16x32_bf16 v[228:231], v[156:159], v[244:247], v[228:231]
    v_mfma_f32_16x16x32_bf16 v[192:195], v[160:163], v[112:115], v[192:195]
    v_mfma_f32_16x16x32_bf16 v[196:199], v[160:163], v[116:119], v[196:199]
    v_mfma_f32_16x16x32_bf16 v[232:235], v[160:163], v[244:247], v[232:235]
    v_mfma_f32_16x16x32_bf16 v[176:179], v[164:167], v[120:123], v[176:179]
    v_mfma_f32_16x16x32_bf16 v[180:183], v[164:167], v[124:127], v[180:183]
    v_mfma_f32_16x16x32_bf16 v[184:187], v[168:171], v[120:123], v[184:187]
    v_mfma_f32_16x16x32_bf16 v[188:191], v[168:171], v[124:127], v[188:191]
    v_mfma_f32_16x16x32_bf16 v[192:195], v[172:175], v[120:123], v[192:195]
    v_mfma_f32_16x16x32_bf16 v[196:199], v[172:175], v[124:127], v[196:199]
    v_lshl_add_u32 v4, v1, 4, s70
    v_lshl_add_u32 v5, v2, 4, s72
    s_nop 1
    ds_write_b128 v4, v[180:183] offset:0
    s_nop 0
    ds_write_b128 v4, v[188:191] offset:1024
    s_nop 0
    ds_write_b128 v4, v[196:199] offset:2048
    s_mov_b32 exec_lo, 0x00010001
    s_mov_b32 exec_hi, 0x00010001
    ds_write_b128 v5, v[224:227] offset:1536
    ds_write_b128 v5, v[228:231] offset:1600
    ds_write_b128 v5, v[232:235] offset:1664
    s_mov_b64 exec, -1
    v_pk_add_f32 v[128:129], v[176:177], 0
    v_pk_add_f32 v[130:131], v[178:179], 0
    v_pk_add_f32 v[132:133], v[184:185], 0
    v_pk_add_f32 v[134:135], v[186:187], 0
    v_pk_add_f32 v[136:137], v[192:193], 0
    v_pk_add_f32 v[138:139], v[194:195], 0
    v_add_u32 v4, 65536, v7
    ds_read_b128 v[48:51], v4 offset:0
    ds_read_b128 v[52:55], v4 offset:160
    ds_read_b128 v[56:59], v4 offset:320
    ds_read_b128 v[60:63], v4 offset:480
    ds_read_b128 v[64:67], v4 offset:640
    v_add_u32 v4, 49152, v7
    ds_read_b128 v[68:71], v4
    ds_read_b128 v[72:75], v4 offset:160
    s_waitcnt lgkmcnt(0)
    v_mul_u32_u24 v7, 1152, v44
    v_lshlrev_b32 v106, 2, v43
    v_sub_u32 v7, v7, v106
    s_lshl_b32 s48, s42, 4
    s_add_u32 s48, s48, 106508
    v_add_u32 v7, s48, v7
    v_lshlrev_b32 v44, 6, v44
    v_add_u32 v44, 160768, v44
    ds_read_b128 v[108:111], v44 offset:0
    ds_read_b128 v[112:115], v44 offset:16
    v_lshlrev_b32 v80, 16, v48
    v_and_b32 v81, 0xffff0000, v48
    v_lshlrev_b32 v82, 16, v52
    v_and_b32 v83, 0xffff0000, v52
    v_lshlrev_b32 v84, 16, v56
    v_and_b32 v85, 0xffff0000, v56
    v_lshlrev_b32 v86, 16, v60
    v_and_b32 v87, 0xffff0000, v60
    v_lshlrev_b32 v88, 16, v64
    v_and_b32 v89, 0xffff0000, v64
    s_waitcnt lgkmcnt(0)
    v_lshlrev_b32 v90, 16, v108
    v_lshlrev_b32 v91, 16, v110
    v_and_b32 v92, 0xffff0000, v108
    v_and_b32 v93, 0xffff0000, v110
    v_lshlrev_b32 v94, 16, v109
    v_lshlrev_b32 v95, 16, v111
    v_and_b32 v96, 0xffff0000, v109
    v_and_b32 v97, 0xffff0000, v111
    v_pk_mul_f32 v[98:99], v[86:87], v[90:91]
    v_pk_mul_f32 v[100:101], v[88:89], v[90:91]
    v_pk_fma_f32 v[98:99], v[84:85], v[92:93], v[98:99]
    v_pk_fma_f32 v[100:101], v[86:87], v[92:93], v[100:101]
    v_pk_fma_f32 v[98:99], v[82:83], v[94:95], v[98:99]
    v_pk_fma_f32 v[100:101], v[84:85], v[94:95], v[100:101]
    v_pk_fma_f32 v[98:99], v[80:81], v[96:97], v[98:99]
    v_pk_fma_f32 v[100:101], v[82:83], v[96:97], v[100:101]
    v_lshlrev_b32 v102, 16, v68
    v_and_b32 v103, 0xffff0000, v68
    v_lshlrev_b32 v104, 16, v72
    v_and_b32 v105, 0xffff0000, v72
    v_pk_mul_f32 v[98:99], v[98:99], v[102:103]
    v_pk_mul_f32 v[100:101], v[100:101], v[104:105]
    v_cvt_pk_bf16_f32 v106, v100, v98
    v_cvt_pk_bf16_f32 v107, v101, v99
    s_mov_b32 exec_hi, 0xff
    ds_write_b32 v7, v106 offset:0
    ds_write_b32 v7, v107 offset:144
    s_mov_b32 exec_hi, -1
    v_lshlrev_b32 v80, 16, v49
    v_and_b32 v81, 0xffff0000, v49
    v_lshlrev_b32 v82, 16, v53
    v_and_b32 v83, 0xffff0000, v53
    v_lshlrev_b32 v84, 16, v57
    v_and_b32 v85, 0xffff0000, v57
    v_lshlrev_b32 v86, 16, v61
    v_and_b32 v87, 0xffff0000, v61
    v_lshlrev_b32 v88, 16, v65
    v_and_b32 v89, 0xffff0000, v65
    v_lshlrev_b32 v90, 16, v112
    v_lshlrev_b32 v91, 16, v114
    v_and_b32 v92, 0xffff0000, v112
    v_and_b32 v93, 0xffff0000, v114
    v_lshlrev_b32 v94, 16, v113
    v_lshlrev_b32 v95, 16, v115
    v_and_b32 v96, 0xffff0000, v113
    v_and_b32 v97, 0xffff0000, v115
    v_pk_mul_f32 v[98:99], v[86:87], v[90:91]
    v_pk_mul_f32 v[100:101], v[88:89], v[90:91]
    v_pk_fma_f32 v[98:99], v[84:85], v[92:93], v[98:99]
    v_pk_fma_f32 v[100:101], v[86:87], v[92:93], v[100:101]
    v_pk_fma_f32 v[98:99], v[82:83], v[94:95], v[98:99]
    v_pk_fma_f32 v[100:101], v[84:85], v[94:95], v[100:101]
    v_pk_fma_f32 v[98:99], v[80:81], v[96:97], v[98:99]
    v_pk_fma_f32 v[100:101], v[82:83], v[96:97], v[100:101]
    v_lshlrev_b32 v102, 16, v69
    v_and_b32 v103, 0xffff0000, v69
    v_lshlrev_b32 v104, 16, v73
    v_and_b32 v105, 0xffff0000, v73
    v_pk_mul_f32 v[98:99], v[98:99], v[102:103]
    v_pk_mul_f32 v[100:101], v[100:101], v[104:105]
    v_cvt_pk_bf16_f32 v106, v100, v98
    v_cvt_pk_bf16_f32 v107, v101, v99
    s_mov_b32 exec_hi, 0xff
    ds_write_b32 v7, v106 offset:288
    ds_write_b32 v7, v107 offset:432
    s_mov_b32 exec_hi, -1
    ds_read_b128 v[108:111], v44 offset:32
    ds_read_b128 v[112:115], v44 offset:48
    v_lshlrev_b32 v80, 16, v50
    v_and_b32 v81, 0xffff0000, v50
    v_lshlrev_b32 v82, 16, v54
    v_and_b32 v83, 0xffff0000, v54
    v_lshlrev_b32 v84, 16, v58
    v_and_b32 v85, 0xffff0000, v58
    v_lshlrev_b32 v86, 16, v62
    v_and_b32 v87, 0xffff0000, v62
    v_lshlrev_b32 v88, 16, v66
    v_and_b32 v89, 0xffff0000, v66
    s_waitcnt lgkmcnt(0)
    v_lshlrev_b32 v90, 16, v108
    v_lshlrev_b32 v91, 16, v110
    v_and_b32 v92, 0xffff0000, v108
    v_and_b32 v93, 0xffff0000, v110
    v_lshlrev_b32 v94, 16, v109
    v_lshlrev_b32 v95, 16, v111
    v_and_b32 v96, 0xffff0000, v109
    v_and_b32 v97, 0xffff0000, v111
    v_pk_mul_f32 v[98:99], v[86:87], v[90:91]
    v_pk_mul_f32 v[100:101], v[88:89], v[90:91]
    v_pk_fma_f32 v[98:99], v[84:85], v[92:93], v[98:99]
    v_pk_fma_f32 v[100:101], v[86:87], v[92:93], v[100:101]
    v_pk_fma_f32 v[98:99], v[82:83], v[94:95], v[98:99]
    v_pk_fma_f32 v[100:101], v[84:85], v[94:95], v[100:101]
    v_pk_fma_f32 v[98:99], v[80:81], v[96:97], v[98:99]
    v_pk_fma_f32 v[100:101], v[82:83], v[96:97], v[100:101]
    v_lshlrev_b32 v102, 16, v70
    v_and_b32 v103, 0xffff0000, v70
    v_lshlrev_b32 v104, 16, v74
    v_and_b32 v105, 0xffff0000, v74
    v_pk_mul_f32 v[98:99], v[98:99], v[102:103]
    v_pk_mul_f32 v[100:101], v[100:101], v[104:105]
    v_cvt_pk_bf16_f32 v106, v100, v98
    v_cvt_pk_bf16_f32 v107, v101, v99
    s_mov_b32 exec_hi, 0xff
    ds_write_b32 v7, v106 offset:576
    ds_write_b32 v7, v107 offset:720
    s_mov_b32 exec_hi, -1
    v_lshlrev_b32 v80, 16, v51
    v_and_b32 v81, 0xffff0000, v51
    v_lshlrev_b32 v82, 16, v55
    v_and_b32 v83, 0xffff0000, v55
    v_lshlrev_b32 v84, 16, v59
    v_and_b32 v85, 0xffff0000, v59
    v_lshlrev_b32 v86, 16, v63
    v_and_b32 v87, 0xffff0000, v63
    v_lshlrev_b32 v88, 16, v67
    v_and_b32 v89, 0xffff0000, v67
    v_lshlrev_b32 v90, 16, v112
    v_lshlrev_b32 v91, 16, v114
    v_and_b32 v92, 0xffff0000, v112
    v_and_b32 v93, 0xffff0000, v114
    v_lshlrev_b32 v94, 16, v113
    v_lshlrev_b32 v95, 16, v115
    v_and_b32 v96, 0xffff0000, v113
    v_and_b32 v97, 0xffff0000, v115
    v_pk_mul_f32 v[98:99], v[86:87], v[90:91]
    v_pk_mul_f32 v[100:101], v[88:89], v[90:91]
    v_pk_fma_f32 v[98:99], v[84:85], v[92:93], v[98:99]
    v_pk_fma_f32 v[100:101], v[86:87], v[92:93], v[100:101]
    v_pk_fma_f32 v[98:99], v[82:83], v[94:95], v[98:99]
    v_pk_fma_f32 v[100:101], v[84:85], v[94:95], v[100:101]
    v_pk_fma_f32 v[98:99], v[80:81], v[96:97], v[98:99]
    v_pk_fma_f32 v[100:101], v[82:83], v[96:97], v[100:101]
    v_lshlrev_b32 v102, 16, v71
    v_and_b32 v103, 0xffff0000, v71
    v_lshlrev_b32 v104, 16, v75
    v_and_b32 v105, 0xffff0000, v75
    v_pk_mul_f32 v[98:99], v[98:99], v[102:103]
    v_pk_mul_f32 v[100:101], v[100:101], v[104:105]
    v_cvt_pk_bf16_f32 v106, v100, v98
    v_cvt_pk_bf16_f32 v107, v101, v99
    s_mov_b32 exec_hi, 0xff
    ds_write_b32 v7, v106 offset:864
    ds_write_b32 v7, v107 offset:1008
    s_mov_b32 exec_hi, -1
    s_lshl_b32 s48, s47, 4
    v_add_u32 v43, s48, v3
    v_mul_u32_u24 v43, 200, v43
    v_lshl_add_u32 v43, v2, 3, v43
    s_mul_i32 s48, s43, 96
    s_add_u32 s48, s48, 0
    v_add_u32 v43, s48, v43
    s_waitcnt vmcnt(0)
    s_mov_b32 s65, 0
k1_poll_5:
    s_add_u32 s65, s65, 1
    s_cmp_gt_u32 s65, 100000
    s_cbranch_scc1 k1_polled_6
    v_cmp_ne_u32 vcc, s100, v30
    v_cmp_ne_u32 s[50:51], s101, v31
    s_nop 0
    s_or_b64 vcc, vcc, s[50:51]
    v_cmp_ne_u32 s[50:51], s100, v34
    s_nop 0
    s_or_b64 vcc, vcc, s[50:51]
    v_cmp_ne_u32 s[50:51], s101, v35
    s_nop 0
    s_or_b64 vcc, vcc, s[50:51]
    s_cmp_eq_u64 vcc, 0
    s_cbranch_scc1 k1_polled_6
    s_sleep 4
    buffer_load_dwordx4 v[28:31], v38, s[24:27], s78 offen sc1
    buffer_load_dwordx4 v[32:35], v38, s[24:27], s78 offen offset:1024 sc1
    s_waitcnt vmcnt(0)
    s_branch k1_poll_5
k1_polled_6:
    s_xor_b32 s48, s42, 1
    s_or_b32 s48, s48, s41
    s_cmp_lg_u32 s48, 0
    s_cbranch_scc1 k1_ep_7
    v_mov_b32 v4, 0
    v_mov_b32 v44, 1
    s_mov_b64 exec, 1
    buffer_atomic_add v44, v4, s[28:31], 0 offen sc0
    s_mov_b64 exec, -1
k1_ep_7:
    v_pk_add_f32 v[8:9], v[28:29], v[32:33]
    v_mov_b32 v10, v8
    v_mov_b32 v11, v9
    s_nop 0
    v_permlane16_swap_b32 v8, v10
    v_permlane16_swap_b32 v9, v11
    v_add_f32 v8, v8, v10
    v_add_f32 v9, v9, v11
    v_mov_b32 v10, v8
    v_mov_b32 v11, v9
    s_nop 0
    v_permlane32_swap_b32 v8, v10
    v_permlane32_swap_b32 v9, v11
    v_add_f32 v8, v8, v10
    v_add_f32 v9, v9, v11
    v_mul_f32 v8, 0x3aaaaaab, v8
    v_mul_f32 v9, 0x3aaaaaab, v9
    v_fma_f32 v9, -v8, v8, v9
    v_max_f32 v9, 0, v9
    v_cvt_pk_bf16_f32 v9, v9, v8
    v_and_b32 v8, 0xffff0000, v9
    v_lshlrev_b32 v9, 16, v9
    v_add_f32 v9, s55, v9
    v_cvt_pk_bf16_f32 v9, v9, v9
    v_and_b32 v9, 0xffff0000, v9
    v_sqrt_f32 v9, v9
    s_nop 0
    v_cvt_pk_bf16_f32 v9, v9, v9
    v_and_b32 v9, 0xffff0000, v9
    v_rcp_f32 v9, v9
    s_nop 0
    v_mov_b32 v10, v9
    v_pk_add_f32 v[200:201], v[200:201], v[8:9] op_sel_hi:[1,0] neg_lo:[0,1] neg_hi:[0,1]
    v_pk_add_f32 v[202:203], v[202:203], v[8:9] op_sel_hi:[1,0] neg_lo:[0,1] neg_hi:[0,1]
    v_pk_add_f32 v[204:205], v[204:205], v[8:9] op_sel_hi:[1,0] neg_lo:[0,1] neg_hi:[0,1]
    v_pk_add_f32 v[206:207], v[206:207], v[8:9] op_sel_hi:[1,0] neg_lo:[0,1] neg_hi:[0,1]
    v_pk_add_f32 v[208:209], v[208:209], v[8:9] op_sel_hi:[1,0] neg_lo:[0,1] neg_hi:[0,1]
    v_pk_add_f32 v[210:211], v[210:211], v[8:9] op_sel_hi:[1,0] neg_lo:[0,1] neg_hi:[0,1]
    v_pk_mul_f32 v[200:201], v[200:201], v[10:11] op_sel_hi:[1,0]
    v_pk_mul_f32 v[202:203], v[202:203], v[10:11] op_sel_hi:[1,0]
    v_pk_mul_f32 v[204:205], v[204:205], v[10:11] op_sel_hi:[1,0]
    v_pk_mul_f32 v[206:207], v[206:207], v[10:11] op_sel_hi:[1,0]
    v_pk_mul_f32 v[208:209], v[208:209], v[10:11] op_sel_hi:[1,0]
    v_pk_mul_f32 v[210:211], v[210:211], v[10:11] op_sel_hi:[1,0]
    v_cvt_pk_bf16_f32 v16, v200, v201
    v_cvt_pk_bf16_f32 v17, v202, v203
    ds_write_b64 v43, v[16:17] offset:0
    v_cvt_pk_bf16_f32 v18, v204, v205
    v_cvt_pk_bf16_f32 v19, v206, v207
    ds_write_b64 v43, v[18:19] offset:32
    v_cvt_pk_bf16_f32 v20, v208, v209
    v_cvt_pk_bf16_f32 v21, v210, v211
    ds_write_b64 v43, v[20:21] offset:64
    v_lshrrev_b32 v218, 1, v2
    v_lshrrev_b32 v5, 2, v3
    v_lshl_add_u32 v218, v218, 3, v5
    v_mul_u32_u24 v218, 200, v218
    v_and_b32 v5, 1, v2
    v_lshl_add_u32 v218, v5, 5, v218
    v_and_b32 v5, 3, v3
    v_lshl_add_u32 v218, v5, 3, v218
    v_lshlrev_b32 v219, 4, v1
    s_waitcnt lgkmcnt(0)
    s_barrier
    v_add_u32 v5, s88, v218
    ds_read_b64_tr_b16 v[8:9], v5
    ds_read_b64_tr_b16 v[10:11], v5 offset:800
    s_waitcnt lgkmcnt(0)
    buffer_store_dwordx4 v[8:11], v219, s[24:27], s64 offen
    s_cmp_ge_u32 s42, 4
    s_cbranch_scc1 k1_fr_8
    v_add_u32 v5, s63, v218
    ds_read_b64_tr_b16 v[12:13], v5
    ds_read_b64_tr_b16 v[14:15], v5 offset:800
    s_waitcnt lgkmcnt(0)
    buffer_store_dwordx4 v[12:15], v219, s[24:27], s67 offen
k1_fr_8:
    s_lshl_b32 s48, s42, 3
    v_lshrrev_b32 v4, 3, v1
    v_add_u32 v4, s48, v4
    v_and_b32 v5, 7, v1
    v_lshlrev_b32 v5, 4, v5
    v_mul_u32_u24 v6, 144, v4
    v_add_u32 v6, v6, v5
    v_add_u32 v6, 106496, v6
    ds_read_b128 v[120:123], v6
    v_lshlrev_b32 v4, 12, v4
    v_add_u32 v4, v4, v5
    s_waitcnt lgkmcnt(0)
    buffer_store_dwordx4 v[120:123], v4, s[24:27], s83 offen
    s_lshl_b32 s48, s42, 3
    s_add_u32 s48, s48, 64
    v_lshrrev_b32 v4, 3, v1
    v_add_u32 v4, s48, v4
    v_and_b32 v5, 7, v1
    v_lshlrev_b32 v5, 4, v5
    v_mul_u32_u24 v6, 144, v4
    v_add_u32 v6, v6, v5
    v_add_u32 v6, 106496, v6
    ds_read_b128 v[124:127], v6
    v_lshlrev_b32 v4, 12, v4
    v_add_u32 v4, v4, v5
    s_waitcnt lgkmcnt(0)
    s_cmp_ge_u32 s42, 2
    s_cbranch_scc1 k1_kvskip_9
    buffer_store_dwordx4 v[124:127], v4, s[24:27], s83 offen
k1_kvskip_9:
    v_lshl_add_u32 v4, v1, 4, s71
    ds_read_b128 v[48:51], v4 offset:0
    ds_read_b128 v[52:55], v4 offset:1024
    ds_read_b128 v[56:59], v4 offset:2048
    v_lshl_add_u32 v6, v2, 4, s73
    ds_read_b128 v[64:67], v6 offset:1536
    ds_read_b128 v[68:71], v6 offset:1600
    ds_read_b128 v[72:75], v6 offset:1664
    ds_read_b128 v[76:79], v6 offset:1728
    ds_read_b128 v[80:83], v6 offset:1792
    ds_read_b128 v[84:87], v6 offset:1856
    ds_read_b128 v[88:91], v6 offset:1920
    ds_read_b128 v[92:95], v6 offset:1984
    ds_read_b128 v[96:99], v6 offset:2048
    ds_read_b128 v[100:103], v6 offset:2112
    ds_read_b128 v[104:107], v6 offset:2176
    ds_read_b128 v[108:111], v6 offset:2240
    s_waitcnt lgkmcnt(12)
    v_pk_add_f32 v[128:129], v[128:129], v[48:49]
    v_pk_add_f32 v[130:131], v[130:131], v[50:51]
    v_pk_add_f32 v[132:133], v[132:133], v[52:53]
    v_pk_add_f32 v[134:135], v[134:135], v[54:55]
    v_pk_add_f32 v[136:137], v[136:137], v[56:57]
    v_pk_add_f32 v[138:139], v[138:139], v[58:59]
    s_waitcnt lgkmcnt(6)
    v_pk_add_f32 v[64:65], v[64:65], v[76:77]
    v_pk_add_f32 v[66:67], v[66:67], v[78:79]
    v_pk_add_f32 v[68:69], v[68:69], v[80:81]
    v_pk_add_f32 v[70:71], v[70:71], v[82:83]
    v_pk_add_f32 v[72:73], v[72:73], v[84:85]
    v_pk_add_f32 v[74:75], v[74:75], v[86:87]
    s_waitcnt lgkmcnt(0)
    v_pk_add_f32 v[88:89], v[88:89], v[100:101]
    v_pk_add_f32 v[90:91], v[90:91], v[102:103]
    v_pk_add_f32 v[92:93], v[92:93], v[104:105]
    v_pk_add_f32 v[94:95], v[94:95], v[106:107]
    v_pk_add_f32 v[96:97], v[96:97], v[108:109]
    v_pk_add_f32 v[98:99], v[98:99], v[110:111]
    v_pk_add_f32 v[64:65], v[64:65], v[88:89]
    v_pk_add_f32 v[66:67], v[66:67], v[90:91]
    v_pk_add_f32 v[68:69], v[68:69], v[92:93]
    v_pk_add_f32 v[70:71], v[70:71], v[94:95]
    v_pk_add_f32 v[72:73], v[72:73], v[96:97]
    v_pk_add_f32 v[74:75], v[74:75], v[98:99]
    v_pk_fma_f32 v[128:129], v[64:65], v[240:241], v[128:129] op_sel_hi:[1,0,1] neg_lo:[0,1,0] neg_hi:[0,1,0]
    v_pk_fma_f32 v[130:131], v[66:67], v[240:241], v[130:131] op_sel_hi:[1,0,1] neg_lo:[0,1,0] neg_hi:[0,1,0]
    v_pk_fma_f32 v[132:133], v[68:69], v[240:241], v[132:133] op_sel_hi:[1,0,1] neg_lo:[0,1,0] neg_hi:[0,1,0]
    v_pk_fma_f32 v[134:135], v[70:71], v[240:241], v[134:135] op_sel_hi:[1,0,1] neg_lo:[0,1,0] neg_hi:[0,1,0]
    v_pk_fma_f32 v[136:137], v[72:73], v[240:241], v[136:137] op_sel_hi:[1,0,1] neg_lo:[0,1,0] neg_hi:[0,1,0]
    v_pk_fma_f32 v[138:139], v[74:75], v[240:241], v[138:139] op_sel_hi:[1,0,1] neg_lo:[0,1,0] neg_hi:[0,1,0]
    v_pk_mul_f32 v[128:129], v[128:129], v[242:243] op_sel_hi:[1,0]
    v_pk_mul_f32 v[130:131], v[130:131], v[242:243] op_sel_hi:[1,0]
    v_pk_mul_f32 v[132:133], v[132:133], v[242:243] op_sel_hi:[1,0]
    v_pk_mul_f32 v[134:135], v[134:135], v[242:243] op_sel_hi:[1,0]
    v_pk_mul_f32 v[136:137], v[136:137], v[242:243] op_sel_hi:[1,0]
    v_pk_mul_f32 v[138:139], v[138:139], v[242:243] op_sel_hi:[1,0]
    v_pk_mul_f32 v[48:49], v[128:129], v[128:129]
    v_pk_mul_f32 v[50:51], v[130:131], v[130:131]
    v_pk_mul_f32 v[52:53], v[132:133], v[132:133]
    v_pk_mul_f32 v[54:55], v[134:135], v[134:135]
    v_pk_mul_f32 v[56:57], v[136:137], v[136:137]
    v_pk_mul_f32 v[58:59], v[138:139], v[138:139]
    v_pk_fma_f32 v[48:49], v[48:49], s[58:59], v[238:239]
    v_pk_fma_f32 v[50:51], v[50:51], s[58:59], v[238:239]
    v_pk_fma_f32 v[52:53], v[52:53], s[58:59], v[238:239]
    v_pk_fma_f32 v[54:55], v[54:55], s[58:59], v[238:239]
    v_pk_fma_f32 v[56:57], v[56:57], s[58:59], v[238:239]
    v_pk_fma_f32 v[58:59], v[58:59], s[58:59], v[238:239]
    v_pk_mul_f32 v[48:49], v[48:49], v[128:129]
    v_pk_mul_f32 v[50:51], v[50:51], v[130:131]
    v_pk_mul_f32 v[52:53], v[52:53], v[132:133]
    v_pk_mul_f32 v[54:55], v[54:55], v[134:135]
    v_pk_mul_f32 v[56:57], v[56:57], v[136:137]
    v_pk_mul_f32 v[58:59], v[58:59], v[138:139]
    v_exp_f32 v48, v48
    v_exp_f32 v49, v49
    v_exp_f32 v50, v50
    v_exp_f32 v51, v51
    v_exp_f32 v52, v52
    v_exp_f32 v53, v53
    v_exp_f32 v54, v54
    v_exp_f32 v55, v55
    v_exp_f32 v56, v56
    v_exp_f32 v57, v57
    v_exp_f32 v58, v58
    v_exp_f32 v59, v59
    v_pk_add_f32 v[48:49], v[48:49], 1.0 op_sel_hi:[1,0]
    v_pk_add_f32 v[50:51], v[50:51], 1.0 op_sel_hi:[1,0]
    v_pk_add_f32 v[52:53], v[52:53], 1.0 op_sel_hi:[1,0]
    v_pk_add_f32 v[54:55], v[54:55], 1.0 op_sel_hi:[1,0]
    v_pk_add_f32 v[56:57], v[56:57], 1.0 op_sel_hi:[1,0]
    v_pk_add_f32 v[58:59], v[58:59], 1.0 op_sel_hi:[1,0]
    v_rcp_f32 v48, v48
    v_rcp_f32 v49, v49
    v_rcp_f32 v50, v50
    v_rcp_f32 v51, v51
    v_rcp_f32 v52, v52
    v_rcp_f32 v53, v53
    v_rcp_f32 v54, v54
    v_rcp_f32 v55, v55
    v_rcp_f32 v56, v56
    v_rcp_f32 v57, v57
    v_rcp_f32 v58, v58
    v_rcp_f32 v59, v59
    v_pk_mul_f32 v[128:129], v[128:129], v[48:49]
    v_pk_mul_f32 v[130:131], v[130:131], v[50:51]
    v_pk_mul_f32 v[132:133], v[132:133], v[52:53]
    v_pk_mul_f32 v[134:135], v[134:135], v[54:55]
    v_pk_mul_f32 v[136:137], v[136:137], v[56:57]
    v_pk_mul_f32 v[138:139], v[138:139], v[58:59]
    v_lshrrev_b32 v4, 1, v2
    v_mul_u32_u24 v4, 3072, v4
    v_and_b32 v5, 1, v2
    v_lshlrev_b32 v5, 5, v5
    v_add_u32 v5, v5, v3
    v_lshl_add_u32 v4, v5, 4, v4
    v_cvt_pk_bf16_f32 v48, v128, v129
    v_cvt_pk_bf16_f32 v49, v130, v131
    buffer_store_dwordx2 v[48:49], v4, s[24:27], s80 offen
    v_cvt_pk_bf16_f32 v50, v132, v133
    v_cvt_pk_bf16_f32 v51, v134, v135
    buffer_store_dwordx2 v[50:51], v4, s[24:27], s81 offen
    v_cvt_pk_bf16_f32 v52, v136, v137
    v_cvt_pk_bf16_f32 v53, v138, v139
    buffer_store_dwordx2 v[52:53], v4, s[24:27], s82 offen
    s_xor_b32 s48, s42, 1
    s_or_b32 s48, s48, s41
    s_cmp_lg_u32 s48, 0
    s_cbranch_scc1 k1_ep2_10
    s_waitcnt vmcnt(0)
    v_readfirstlane_b32 s48, v44
    s_nop 0
    s_cmp_lg_u32 s48, 31
    s_cbranch_scc1 k1_ep2_10
    v_mov_b32 v8, s100
    v_mov_b32 v9, s101
    v_mov_b32 v4, 14712832
    s_mov_b64 exec, 1
    buffer_store_dwordx2 v[8:9], v4, s[24:27], 0 offen sc1
    s_mov_b64 exec, -1
k1_ep2_10:
k1_kernel_end:
    s_endpgm

.globl k2_kernel
.p2align 8
.type k2_kernel,@function
k2_kernel:
    s_cmp_ge_u32 s2, 512
    s_cbranch_scc1 k2_kernel_end
    s_cmp_lt_u32 s2, 256
    s_cbranch_scc1 k2_kernel_conv
    s_load_dwordx2 s[4:5], s[0:1], 64
    s_load_dwordx2 s[8:9], s[0:1], 104
    s_load_dwordx2 s[12:13], s[0:1], 72
    v_lshrrev_b32 v2, 6, v0
    v_and_b32 v1, 63, v0
    v_readfirstlane_b32 s34, v2
    s_mov_b32 s6, 8388608
    s_mov_b32 s7, 0x20000
    s_mov_b32 s10, 15990784
    s_mov_b32 s11, 0x20000
    s_mov_b32 s14, 4096
    s_mov_b32 s15, 0x20000
    s_and_b32 s40, s2, 7
    s_lshr_b32 s41, s2, 3
    s_and_b32 s41, s41, 31
    s_lshr_b32 s32, s40, 1
    s_lshl_b32 s32, s32, 3
    s_and_b32 s42, s41, 7
    s_add_u32 s32, s32, s42
    s_and_b32 s33, s40, 1
    s_lshl_b32 s33, s33, 2
    s_lshr_b32 s42, s41, 3
    s_add_u32 s33, s33, s42
    s_lshl_b32 s44, s33, 7
    s_lshl_b32 s40, s34, 5
    s_add_u32 s44, s44, s40
    s_mul_i32 s44, s44, 3072
    s_add_u32 s44, s44, 0
    s_lshl_b32 s45, s32, 18
    s_lshl_b32 s40, s34, 10
    s_add_u32 s45, s45, s40
    s_lshl_b32 s46, s34, 14
    v_lshlrev_b32 v5, 4, v1
    v_lshrrev_b32 v2, 3, v1
    v_lshlrev_b32 v2, 12, v2
    v_and_b32 v3, 7, v1
    v_lshrrev_b32 v4, 4, v1
    v_xor_b32 v3, v3, v4
    v_lshl_add_u32 v6, v3, 4, v2
    v_xor_b32 v7, 64, v6
    s_mov_b32 s50, 0
    s_waitcnt lgkmcnt(0)
    s_add_u32 s52, s50, 0
    s_and_b32 s52, s52, 7
    s_mul_i32 s52, s52, 12288
    s_add_u32 s52, s52, s44
    buffer_load_dwordx4 v[104:107], v5, s[8:11], s52 offen offset:0
    buffer_load_dwordx4 v[108:111], v5, s[8:11], s52 offen offset:1024
    buffer_load_dwordx4 v[112:115], v5, s[8:11], s52 offen offset:2048
    s_add_u32 s54, s50, 0
    s_and_b32 s54, s54, 7
    s_lshl_b32 s54, s54, 7
    s_add_u32 s54, s54, s45
    s_add_u32 s42, s54, 0
    s_add_u32 m0, s46, 0
    s_nop 0
    buffer_load_dwordx4 v6, s[4:7], s42 offen lds
    s_add_u32 s42, s54, 32768
    s_add_u32 m0, s46, 1024
    s_nop 0
    buffer_load_dwordx4 v7, s[4:7], s42 offen lds
    s_add_u32 s42, s54, 65536
    s_add_u32 m0, s46, 2048
    s_nop 0
    buffer_load_dwordx4 v6, s[4:7], s42 offen lds
    s_add_u32 s42, s54, 98304
    s_add_u32 m0, s46, 3072
    s_nop 0
    buffer_load_dwordx4 v7, s[4:7], s42 offen lds
    s_add_u32 s42, s54, 131072
    s_add_u32 m0, s46, 4096
    s_nop 0
    buffer_load_dwordx4 v6, s[4:7], s42 offen lds
    s_add_u32 s42, s54, 163840
    s_add_u32 m0, s46, 5120
    s_nop 0
    buffer_load_dwordx4 v7, s[4:7], s42 offen lds
    s_add_u32 s42, s54, 196608
    s_add_u32 m0, s46, 6144
    s_nop 0
    buffer_load_dwordx4 v6, s[4:7], s42 offen lds
    s_add_u32 s42, s54, 229376
    s_add_u32 m0, s46, 7168
    s_nop 0
    buffer_load_dwordx4 v7, s[4:7], s42 offen lds
    s_add_u32 s41, s52, 3072
    buffer_load_dwordx4 v[116:119], v5, s[8:11], s41 offen offset:0
    s_add_u32 s41, s52, 3072
    buffer_load_dwordx4 v[120:123], v5, s[8:11], s41 offen offset:1024
    s_add_u32 s41, s52, 3072
    buffer_load_dwordx4 v[124:127], v5, s[8:11], s41 offen offset:2048
    s_add_u32 s41, s52, 6144
    buffer_load_dwordx4 v[128:131], v5, s[8:11], s41 offen offset:0
    s_add_u32 s41, s52, 6144
    buffer_load_dwordx4 v[132:135], v5, s[8:11], s41 offen offset:1024
    s_add_u32 s41, s52, 6144
    buffer_load_dwordx4 v[136:139], v5, s[8:11], s41 offen offset:2048
    s_add_u32 s41, s52, 9216
    buffer_load_dwordx4 v[140:143], v5, s[8:11], s41 offen offset:0
    s_add_u32 s41, s52, 9216
    buffer_load_dwordx4 v[144:147], v5, s[8:11], s41 offen offset:1024
    s_add_u32 s41, s52, 9216
    buffer_load_dwordx4 v[148:151], v5, s[8:11], s41 offen offset:2048
    v_and_b32 v2, 31, v1
    v_lshrrev_b32 v3, 1, v2
    v_and_b32 v3, 7, v3
    v_lshrrev_b32 v4, 5, v1
    v_xor_b32 v3, v3, v4
    v_lshl_add_u32 v2, v2, 7, s46
    v_xor_b32 v4, 0, v3
    v_lshl_add_u32 v180, v4, 4, v2
    v_xor_b32 v4, 2, v3
    v_lshl_add_u32 v181, v4, 4, v2
    v_xor_b32 v4, 4, v3
    v_lshl_add_u32 v182, v4, 4, v2
    v_xor_b32 v4, 6, v3
    v_lshl_add_u32 v183, v4, 4, v2
    s_waitcnt vmcnt(9)
    s_setprio 2
    ds_read_b128 v[164:167], v180 offset:0
    ds_read_b128 v[168:171], v180 offset:4096
    s_waitcnt vmcnt(17)
    s_waitcnt lgkmcnt(0)
    v_mfma_f32_32x32x16_bf16 v[8:23], v[104:107], v[164:167], 0
    ds_read_b128 v[172:175], v181 offset:0
    ds_read_b128 v[176:179], v181 offset:4096
    v_mfma_f32_32x32x16_bf16 v[24:39], v[104:107], v[168:171], 0
    s_add_u32 s53, s50, 1
    s_and_b32 s53, s53, 7
    s_mul_i32 s53, s53, 12288
    s_add_u32 s53, s53, s44
    buffer_load_dwordx4 v[152:155], v5, s[8:11], s53 offen offset:0
    v_mfma_f32_32x32x16_bf16 v[40:55], v[108:111], v[164:167], 0
    buffer_load_dwordx4 v[156:159], v5, s[8:11], s53 offen offset:1024
    v_mfma_f32_32x32x16_bf16 v[56:71], v[108:111], v[168:171], 0
    buffer_load_dwordx4 v[160:163], v5, s[8:11], s53 offen offset:2048
    v_mfma_f32_32x32x16_bf16 v[72:87], v[112:115], v[164:167], 0
    s_add_u32 s55, s50, 1
    s_and_b32 s55, s55, 7
    s_lshl_b32 s55, s55, 7
    s_add_u32 s55, s55, s45
    s_add_u32 s42, s55, 0
    s_add_u32 m0, s46, 8192
    s_nop 0
    buffer_load_dwordx4 v6, s[4:7], s42 offen lds
    v_mfma_f32_32x32x16_bf16 v[88:103], v[112:115], v[168:171], 0
    s_add_u32 s42, s55, 32768
    s_add_u32 m0, s46, 9216
    s_nop 0
    buffer_load_dwordx4 v7, s[4:7], s42 offen lds
    s_add_u32 s42, s55, 65536
    s_add_u32 m0, s46, 10240
    s_nop 0
    buffer_load_dwordx4 v6, s[4:7], s42 offen lds
    s_add_u32 s42, s55, 98304
    s_add_u32 m0, s46, 11264
    s_nop 0
    buffer_load_dwordx4 v7, s[4:7], s42 offen lds
    s_waitcnt vmcnt(13)
    s_waitcnt lgkmcnt(0)
    v_mfma_f32_32x32x16_bf16 v[8:23], v[116:119], v[172:175], v[8:23]
    ds_read_b128 v[164:167], v182 offset:0
    ds_read_b128 v[168:171], v182 offset:4096
    v_mfma_f32_32x32x16_bf16 v[24:39], v[116:119], v[176:179], v[24:39]
    s_add_u32 s41, s53, 3072
    buffer_load_dwordx4 v[104:107], v5, s[8:11], s41 offen offset:0
    v_mfma_f32_32x32x16_bf16 v[40:55], v[120:123], v[172:175], v[40:55]
    s_add_u32 s41, s53, 3072
    buffer_load_dwordx4 v[108:111], v5, s[8:11], s41 offen offset:1024
    v_mfma_f32_32x32x16_bf16 v[56:71], v[120:123], v[176:179], v[56:71]
    s_add_u32 s41, s53, 3072
    buffer_load_dwordx4 v[112:115], v5, s[8:11], s41 offen offset:2048
    v_mfma_f32_32x32x16_bf16 v[72:87], v[124:127], v[172:175], v[72:87]
    s_add_u32 s42, s55, 131072
    s_add_u32 m0, s46, 12288
    s_nop 0
    buffer_load_dwordx4 v6, s[4:7], s42 offen lds
    v_mfma_f32_32x32x16_bf16 v[88:103], v[124:127], v[176:179], v[88:103]
    s_add_u32 s42, s55, 163840
    s_add_u32 m0, s46, 13312
    s_nop 0
    buffer_load_dwordx4 v7, s[4:7], s42 offen lds
    s_add_u32 s42, s55, 196608
    s_add_u32 m0, s46, 14336
    s_nop 0
    buffer_load_dwordx4 v6, s[4:7], s42 offen lds
    s_add_u32 s42, s55, 229376
    s_add_u32 m0, s46, 15360
    s_nop 0
    buffer_load_dwordx4 v7, s[4:7], s42 offen lds
    s_waitcnt vmcnt(17)
    s_waitcnt lgkmcnt(0)
    v_mfma_f32_32x32x16_bf16 v[8:23], v[128:131], v[164:167], v[8:23]
    ds_read_b128 v[172:175], v183 offset:0
    ds_read_b128 v[176:179], v183 offset:4096
    v_mfma_f32_32x32x16_bf16 v[24:39], v[128:131], v[168:171], v[24:39]
    s_add_u32 s41, s53, 6144
    buffer_load_dwordx4 v[116:119], v5, s[8:11], s41 offen offset:0
    v_mfma_f32_32x32x16_bf16 v[40:55], v[132:135], v[164:167], v[40:55]
    s_add_u32 s41, s53, 6144
    buffer_load_dwordx4 v[120:123], v5, s[8:11], s41 offen offset:1024
    v_mfma_f32_32x32x16_bf16 v[56:71], v[132:135], v[168:171], v[56:71]
    s_add_u32 s41, s53, 6144
    buffer_load_dwordx4 v[124:127], v5, s[8:11], s41 offen offset:2048
    v_mfma_f32_32x32x16_bf16 v[72:87], v[136:139], v[164:167], v[72:87]
    v_mfma_f32_32x32x16_bf16 v[88:103], v[136:139], v[168:171], v[88:103]
    s_waitcnt vmcnt(17)
    s_waitcnt lgkmcnt(0)
    v_mfma_f32_32x32x16_bf16 v[8:23], v[140:143], v[172:175], v[8:23]
    s_waitcnt vmcnt(3)
    ds_read_b128 v[164:167], v180 offset:8192
    ds_read_b128 v[168:171], v180 offset:12288
    v_mfma_f32_32x32x16_bf16 v[24:39], v[140:143], v[176:179], v[24:39]
    s_add_u32 s41, s53, 9216
    buffer_load_dwordx4 v[128:131], v5, s[8:11], s41 offen offset:0
    v_mfma_f32_32x32x16_bf16 v[40:55], v[144:147], v[172:175], v[40:55]
    s_add_u32 s41, s53, 9216
    buffer_load_dwordx4 v[132:135], v5, s[8:11], s41 offen offset:1024
    v_mfma_f32_32x32x16_bf16 v[56:71], v[144:147], v[176:179], v[56:71]
    s_add_u32 s41, s53, 9216
    buffer_load_dwordx4 v[136:139], v5, s[8:11], s41 offen offset:2048
    v_mfma_f32_32x32x16_bf16 v[72:87], v[148:151], v[172:175], v[72:87]
    s_add_u32 s54, s50, 2
    s_and_b32 s54, s54, 7
    s_lshl_b32 s54, s54, 7
    s_add_u32 s54, s54, s45
    s_add_u32 s42, s54, 0
    s_add_u32 m0, s46, 0
    s_nop 0
    buffer_load_dwordx4 v6, s[4:7], s42 offen lds
    v_mfma_f32_32x32x16_bf16 v[88:103], v[148:151], v[176:179], v[88:103]
    s_add_u32 s42, s54, 32768
    s_add_u32 m0, s46, 1024
    s_nop 0
    buffer_load_dwordx4 v7, s[4:7], s42 offen lds
    s_waitcnt vmcnt(19)
    s_waitcnt lgkmcnt(0)
    v_mfma_f32_32x32x16_bf16 v[8:23], v[152:155], v[164:167], v[8:23]
    ds_read_b128 v[172:175], v181 offset:8192
    ds_read_b128 v[176:179], v181 offset:12288
    v_mfma_f32_32x32x16_bf16 v[24:39], v[152:155], v[168:171], v[24:39]
    s_add_u32 s52, s50, 2
    s_and_b32 s52, s52, 7
    s_mul_i32 s52, s52, 12288
    s_add_u32 s52, s52, s44
    buffer_load_dwordx4 v[140:143], v5, s[8:11], s52 offen offset:0
    v_mfma_f32_32x32x16_bf16 v[40:55], v[156:159], v[164:167], v[40:55]
    buffer_load_dwordx4 v[144:147], v5, s[8:11], s52 offen offset:1024
    v_mfma_f32_32x32x16_bf16 v[56:71], v[156:159], v[168:171], v[56:71]
    buffer_load_dwordx4 v[148:151], v5, s[8:11], s52 offen offset:2048
    v_mfma_f32_32x32x16_bf16 v[72:87], v[160:163], v[164:167], v[72:87]
    s_add_u32 s42, s54, 65536
    s_add_u32 m0, s46, 2048
    s_nop 0
    buffer_load_dwordx4 v6, s[4:7], s42 offen lds
    v_mfma_f32_32x32x16_bf16 v[88:103], v[160:163], v[168:171], v[88:103]
    s_add_u32 s42, s54, 98304
    s_add_u32 m0, s46, 3072
    s_nop 0
    buffer_load_dwordx4 v7, s[4:7], s42 offen lds
    s_add_u32 s42, s54, 131072
    s_add_u32 m0, s46, 4096
    s_nop 0
    buffer_load_dwordx4 v6, s[4:7], s42 offen lds
    s_waitcnt vmcnt(18)
    s_waitcnt lgkmcnt(0)
    v_mfma_f32_32x32x16_bf16 v[8:23], v[104:107], v[172:175], v[8:23]
    ds_read_b128 v[164:167], v182 offset:8192
    ds_read_b128 v[168:171], v182 offset:12288
    v_mfma_f32_32x32x16_bf16 v[24:39], v[104:107], v[176:179], v[24:39]
    s_add_u32 s41, s52, 3072
    buffer_load_dwordx4 v[152:155], v5, s[8:11], s41 offen offset:0
    v_mfma_f32_32x32x16_bf16 v[40:55], v[108:111], v[172:175], v[40:55]
    s_add_u32 s41, s52, 3072
    buffer_load_dwordx4 v[156:159], v5, s[8:11], s41 offen offset:1024
    v_mfma_f32_32x32x16_bf16 v[56:71], v[108:111], v[176:179], v[56:71]
    s_add_u32 s41, s52, 3072
    buffer_load_dwordx4 v[160:163], v5, s[8:11], s41 offen offset:2048
    v_mfma_f32_32x32x16_bf16 v[72:87], v[112:115], v[172:175], v[72:87]
    s_add_u32 s42, s54, 163840
    s_add_u32 m0, s46, 5120
    s_nop 0
    buffer_load_dwordx4 v7, s[4:7], s42 offen lds
    v_mfma_f32_32x32x16_bf16 v[88:103], v[112:115], v[176:179], v[88:103]
    s_add_u32 s42, s54, 196608
    s_add_u32 m0, s46, 6144
    s_nop 0
    buffer_load_dwordx4 v6, s[4:7], s42 offen lds
    s_add_u32 s42, s54, 229376
    s_add_u32 m0, s46, 7168
    s_nop 0
    buffer_load_dwordx4 v7, s[4:7], s42 offen lds
    s_waitcnt vmcnt(17)
    s_waitcnt lgkmcnt(0)
    v_mfma_f32_32x32x16_bf16 v[8:23], v[116:119], v[164:167], v[8:23]
    ds_read_b128 v[172:175], v183 offset:8192
    ds_read_b128 v[176:179], v183 offset:12288
    v_mfma_f32_32x32x16_bf16 v[24:39], v[116:119], v[168:171], v[24:39]
    s_add_u32 s41, s52, 6144
    buffer_load_dwordx4 v[104:107], v5, s[8:11], s41 offen offset:0
    v_mfma_f32_32x32x16_bf16 v[40:55], v[120:123], v[164:167], v[40:55]
    s_add_u32 s41, s52, 6144
    buffer_load_dwordx4 v[108:111], v5, s[8:11], s41 offen offset:1024
    v_mfma_f32_32x32x16_bf16 v[56:71], v[120:123], v[168:171], v[56:71]
    s_add_u32 s41, s52, 6144
    buffer_load_dwordx4 v[112:115], v5, s[8:11], s41 offen offset:2048
    v_mfma_f32_32x32x16_bf16 v[72:87], v[124:127], v[164:167], v[72:87]
    v_mfma_f32_32x32x16_bf16 v[88:103], v[124:127], v[168:171], v[88:103]
    s_waitcnt vmcnt(17)
    s_waitcnt lgkmcnt(0)
    v_mfma_f32_32x32x16_bf16 v[8:23], v[128:131], v[172:175], v[8:23]
    s_waitcnt vmcnt(3)
    ds_read_b128 v[164:167], v180 offset:0
    ds_read_b128 v[168:171], v180 offset:4096
    v_mfma_f32_32x32x16_bf16 v[24:39], v[128:131], v[176:179], v[24:39]
    s_add_u32 s41, s52, 9216
    buffer_load_dwordx4 v[116:119], v5, s[8:11], s41 offen offset:0
    v_mfma_f32_32x32x16_bf16 v[40:55], v[132:135], v[172:175], v[40:55]
    s_add_u32 s41, s52, 9216
    buffer_load_dwordx4 v[120:123], v5, s[8:11], s41 offen offset:1024
    v_mfma_f32_32x32x16_bf16 v[56:71], v[132:135], v[176:179], v[56:71]
    s_add_u32 s41, s52, 9216
    buffer_load_dwordx4 v[124:127], v5, s[8:11], s41 offen offset:2048
    v_mfma_f32_32x32x16_bf16 v[72:87], v[136:139], v[172:175], v[72:87]
    s_add_u32 s55, s50, 3
    s_and_b32 s55, s55, 7
    s_lshl_b32 s55, s55, 7
    s_add_u32 s55, s55, s45
    s_add_u32 s42, s55, 0
    s_add_u32 m0, s46, 8192
    s_nop 0
    buffer_load_dwordx4 v6, s[4:7], s42 offen lds
    v_mfma_f32_32x32x16_bf16 v[88:103], v[136:139], v[176:179], v[88:103]
    s_add_u32 s42, s55, 32768
    s_add_u32 m0, s46, 9216
    s_nop 0
    buffer_load_dwordx4 v7, s[4:7], s42 offen lds
    s_waitcnt vmcnt(17)
    s_waitcnt lgkmcnt(0)
    v_mfma_f32_32x32x16_bf16 v[8:23], v[140:143], v[164:167], v[8:23]
    ds_read_b128 v[172:175], v181 offset:0
    ds_read_b128 v[176:179], v181 offset:4096
    v_mfma_f32_32x32x16_bf16 v[24:39], v[140:143], v[168:171], v[24:39]
    s_add_u32 s53, s50, 3
    s_and_b32 s53, s53, 7
    s_mul_i32 s53, s53, 12288
    s_add_u32 s53, s53, s44
    buffer_load_dwordx4 v[128:131], v5, s[8:11], s53 offen offset:0
    v_mfma_f32_32x32x16_bf16 v[40:55], v[144:147], v[164:167], v[40:55]
    buffer_load_dwordx4 v[132:135], v5, s[8:11], s53 offen offset:1024
    v_mfma_f32_32x32x16_bf16 v[56:71], v[144:147], v[168:171], v[56:71]
    buffer_load_dwordx4 v[136:139], v5, s[8:11], s53 offen offset:2048
    v_mfma_f32_32x32x16_bf16 v[72:87], v[148:151], v[164:167], v[72:87]
    s_add_u32 s42, s55, 65536
    s_add_u32 m0, s46, 10240
    s_nop 0
    buffer_load_dwordx4 v6, s[4:7], s42 offen lds
    v_mfma_f32_32x32x16_bf16 v[88:103], v[148:151], v[168:171], v[88:103]
    s_add_u32 s42, s55, 98304
    s_add_u32 m0, s46, 11264
    s_nop 0
    buffer_load_dwordx4 v7, s[4:7], s42 offen lds
    s_add_u32 s42, s55, 131072
    s_add_u32 m0, s46, 12288
    s_nop 0
    buffer_load_dwordx4 v6, s[4:7], s42 offen lds
    s_waitcnt vmcnt(17)
    s_waitcnt lgkmcnt(0)
    v_mfma_f32_32x32x16_bf16 v[8:23], v[152:155], v[172:175], v[8:23]
    ds_read_b128 v[164:167], v182 offset:0
    ds_read_b128 v[168:171], v182 offset:4096
    v_mfma_f32_32x32x16_bf16 v[24:39], v[152:155], v[176:179], v[24:39]
    s_add_u32 s41, s53, 3072
    buffer_load_dwordx4 v[140:143], v5, s[8:11], s41 offen offset:0
    v_mfma_f32_32x32x16_bf16 v[40:55], v[156:159], v[172:175], v[40:55]
    s_add_u32 s41, s53, 3072
    buffer_load_dwordx4 v[144:147], v5, s[8:11], s41 offen offset:1024
    v_mfma_f32_32x32x16_bf16 v[56:71], v[156:159], v[176:179], v[56:71]
    s_add_u32 s41, s53, 3072
    buffer_load_dwordx4 v[148:151], v5, s[8:11], s41 offen offset:2048
    v_mfma_f32_32x32x16_bf16 v[72:87], v[160:163], v[172:175], v[72:87]
    s_add_u32 s42, s55, 163840
    s_add_u32 m0, s46, 13312
    s_nop 0
    buffer_load_dwordx4 v7, s[4:7], s42 offen lds
    v_mfma_f32_32x32x16_bf16 v[88:103], v[160:163], v[176:179], v[88:103]
    s_add_u32 s42, s55, 196608
    s_add_u32 m0, s46, 14336
    s_nop 0
    buffer_load_dwordx4 v6, s[4:7], s42 offen lds
    s_add_u32 s42, s55, 229376
    s_add_u32 m0, s46, 15360
    s_nop 0
    buffer_load_dwordx4 v7, s[4:7], s42 offen lds
    s_waitcnt vmcnt(17)
    s_waitcnt lgkmcnt(0)
    v_mfma_f32_32x32x16_bf16 v[8:23], v[104:107], v[164:167], v[8:23]
    ds_read_b128 v[172:175], v183 offset:0
    ds_read_b128 v[176:179], v183 offset:4096
    v_mfma_f32_32x32x16_bf16 v[24:39], v[104:107], v[168:171], v[24:39]
    s_add_u32 s41, s53, 6144
    buffer_load_dwordx4 v[152:155], v5, s[8:11], s41 offen offset:0
    v_mfma_f32_32x32x16_bf16 v[40:55], v[108:111], v[164:167], v[40:55]
    s_add_u32 s41, s53, 6144
    buffer_load_dwordx4 v[156:159], v5, s[8:11], s41 offen offset:1024
    v_mfma_f32_32x32x16_bf16 v[56:71], v[108:111], v[168:171], v[56:71]
    s_add_u32 s41, s53, 6144
    buffer_load_dwordx4 v[160:163], v5, s[8:11], s41 offen offset:2048
    v_mfma_f32_32x32x16_bf16 v[72:87], v[112:115], v[164:167], v[72:87]
    v_mfma_f32_32x32x16_bf16 v[88:103], v[112:115], v[168:171], v[88:103]
    s_waitcnt vmcnt(17)
    s_waitcnt lgkmcnt(0)
    v_mfma_f32_32x32x16_bf16 v[8:23], v[116:119], v[172:175], v[8:23]
    s_waitcnt vmcnt(3)
    ds_read_b128 v[164:167], v180 offset:8192
    ds_read_b128 v[168:171], v180 offset:12288
    v_mfma_f32_32x32x16_bf16 v[24:39], v[116:119], v[176:179], v[24:39]
    s_add_u32 s41, s53, 9216
    buffer_load_dwordx4 v[104:107], v5, s[8:11], s41 offen offset:0
    v_mfma_f32_32x32x16_bf16 v[40:55], v[120:123], v[172:175], v[40:55]
    s_add_u32 s41, s53, 9216
    buffer_load_dwordx4 v[108:111], v5, s[8:11], s41 offen offset:1024
    v_mfma_f32_32x32x16_bf16 v[56:71], v[120:123], v[176:179], v[56:71]
    s_add_u32 s41, s53, 9216
    buffer_load_dwordx4 v[112:115], v5, s[8:11], s41 offen offset:2048
    v_mfma_f32_32x32x16_bf16 v[72:87], v[124:127], v[172:175], v[72:87]
    s_add_u32 s54, s50, 4
    s_and_b32 s54, s54, 7
    s_lshl_b32 s54, s54, 7
    s_add_u32 s54, s54, s45
    s_add_u32 s42, s54, 0
    s_add_u32 m0, s46, 0
    s_nop 0
    buffer_load_dwordx4 v6, s[4:7], s42 offen lds
    v_mfma_f32_32x32x16_bf16 v[88:103], v[124:127], v[176:179], v[88:103]
    s_add_u32 s42, s54, 32768
    s_add_u32 m0, s46, 1024
    s_nop 0
    buffer_load_dwordx4 v7, s[4:7], s42 offen lds
    s_waitcnt vmcnt(17)
    s_waitcnt lgkmcnt(0)
    v_mfma_f32_32x32x16_bf16 v[8:23], v[128:131], v[164:167], v[8:23]
    ds_read_b128 v[172:175], v181 offset:8192
    ds_read_b128 v[176:179], v181 offset:12288
    v_mfma_f32_32x32x16_bf16 v[24:39], v[128:131], v[168:171], v[24:39]
    s_add_u32 s52, s50, 4
    s_and_b32 s52, s52, 7
    s_mul_i32 s52, s52, 12288
    s_add_u32 s52, s52, s44
    buffer_load_dwordx4 v[116:119], v5, s[8:11], s52 offen offset:0
    v_mfma_f32_32x32x16_bf16 v[40:55], v[132:135], v[164:167], v[40:55]
    buffer_load_dwordx4 v[120:123], v5, s[8:11], s52 offen offset:1024
    v_mfma_f32_32x32x16_bf16 v[56:71], v[132:135], v[168:171], v[56:71]
    buffer_load_dwordx4 v[124:127], v5, s[8:11], s52 offen offset:2048
    v_mfma_f32_32x32x16_bf16 v[72:87], v[136:139], v[164:167], v[72:87]
    s_add_u32 s42, s54, 65536
    s_add_u32 m0, s46, 2048
    s_nop 0
    buffer_load_dwordx4 v6, s[4:7], s42 offen lds
    v_mfma_f32_32x32x16_bf16 v[88:103], v[136:139], v[168:171], v[88:103]
    s_add_u32 s42, s54, 98304
    s_add_u32 m0, s46, 3072
    s_nop 0
    buffer_load_dwordx4 v7, s[4:7], s42 offen lds
    s_add_u32 s42, s54, 131072
    s_add_u32 m0, s46, 4096
    s_nop 0
    buffer_load_dwordx4 v6, s[4:7], s42 offen lds
    s_waitcnt vmcnt(17)
    s_waitcnt lgkmcnt(0)
    v_mfma_f32_32x32x16_bf16 v[8:23], v[140:143], v[172:175], v[8:23]
    ds_read_b128 v[164:167], v182 offset:8192
    ds_read_b128 v[168:171], v182 offset:12288
    v_mfma_f32_32x32x16_bf16 v[24:39], v[140:143], v[176:179], v[24:39]
    s_add_u32 s41, s52, 3072
    buffer_load_dwordx4 v[128:131], v5, s[8:11], s41 offen offset:0
    v_mfma_f32_32x32x16_bf16 v[40:55], v[144:147], v[172:175], v[40:55]
    s_add_u32 s41, s52, 3072
    buffer_load_dwordx4 v[132:135], v5, s[8:11], s41 offen offset:1024
    v_mfma_f32_32x32x16_bf16 v[56:71], v[144:147], v[176:179], v[56:71]
    s_add_u32 s41, s52, 3072
    buffer_load_dwordx4 v[136:139], v5, s[8:11], s41 offen offset:2048
    v_mfma_f32_32x32x16_bf16 v[72:87], v[148:151], v[172:175], v[72:87]
    s_add_u32 s42, s54, 163840
    s_add_u32 m0, s46, 5120
    s_nop 0
    buffer_load_dwordx4 v7, s[4:7], s42 offen lds
    v_mfma_f32_32x32x16_bf16 v[88:103], v[148:151], v[176:179], v[88:103]
    s_add_u32 s42, s54, 196608
    s_add_u32 m0, s46, 6144
    s_nop 0
    buffer_load_dwordx4 v6, s[4:7], s42 offen lds
    s_add_u32 s42, s54, 229376
    s_add_u32 m0, s46, 7168
    s_nop 0
    buffer_load_dwordx4 v7, s[4:7], s42 offen lds
    s_waitcnt vmcnt(17)
    s_waitcnt lgkmcnt(0)
    v_mfma_f32_32x32x16_bf16 v[8:23], v[152:155], v[164:167], v[8:23]
    ds_read_b128 v[172:175], v183 offset:8192
    ds_read_b128 v[176:179], v183 offset:12288
    v_mfma_f32_32x32x16_bf16 v[24:39], v[152:155], v[168:171], v[24:39]
    s_add_u32 s41, s52, 6144
    buffer_load_dwordx4 v[140:143], v5, s[8:11], s41 offen offset:0
    v_mfma_f32_32x32x16_bf16 v[40:55], v[156:159], v[164:167], v[40:55]
    s_add_u32 s41, s52, 6144
    buffer_load_dwordx4 v[144:147], v5, s[8:11], s41 offen offset:1024
    v_mfma_f32_32x32x16_bf16 v[56:71], v[156:159], v[168:171], v[56:71]
    s_add_u32 s41, s52, 6144
    buffer_load_dwordx4 v[148:151], v5, s[8:11], s41 offen offset:2048
    v_mfma_f32_32x32x16_bf16 v[72:87], v[160:163], v[164:167], v[72:87]
    v_mfma_f32_32x32x16_bf16 v[88:103], v[160:163], v[168:171], v[88:103]
    s_waitcnt vmcnt(17)
    s_waitcnt lgkmcnt(0)
    v_mfma_f32_32x32x16_bf16 v[8:23], v[104:107], v[172:175], v[8:23]
    s_waitcnt vmcnt(3)
    ds_read_b128 v[164:167], v180 offset:0
    ds_read_b128 v[168:171], v180 offset:4096
    v_mfma_f32_32x32x16_bf16 v[24:39], v[104:107], v[176:179], v[24:39]
    s_add_u32 s41, s52, 9216
    buffer_load_dwordx4 v[152:155], v5, s[8:11], s41 offen offset:0
    v_mfma_f32_32x32x16_bf16 v[40:55], v[108:111], v[172:175], v[40:55]
    s_add_u32 s41, s52, 9216
    buffer_load_dwordx4 v[156:159], v5, s[8:11], s41 offen offset:1024
    v_mfma_f32_32x32x16_bf16 v[56:71], v[108:111], v[176:179], v[56:71]
    s_add_u32 s41, s52, 9216
    buffer_load_dwordx4 v[160:163], v5, s[8:11], s41 offen offset:2048
    v_mfma_f32_32x32x16_bf16 v[72:87], v[112:115], v[172:175], v[72:87]
    s_add_u32 s55, s50, 5
    s_and_b32 s55, s55, 7
    s_lshl_b32 s55, s55, 7
    s_add_u32 s55, s55, s45
    s_add_u32 s42, s55, 0
    s_add_u32 m0, s46, 8192
    s_nop 0
    buffer_load_dwordx4 v6, s[4:7], s42 offen lds
    v_mfma_f32_32x32x16_bf16 v[88:103], v[112:115], v[176:179], v[88:103]
    s_add_u32 s42, s55, 32768
    s_add_u32 m0, s46, 9216
    s_nop 0
    buffer_load_dwordx4 v7, s[4:7], s42 offen lds
    s_waitcnt vmcnt(17)
    s_waitcnt lgkmcnt(0)
    v_mfma_f32_32x32x16_bf16 v[8:23], v[116:119], v[164:167], v[8:23]
    ds_read_b128 v[172:175], v181 offset:0
    ds_read_b128 v[176:179], v181 offset:4096
    v_mfma_f32_32x32x16_bf16 v[24:39], v[116:119], v[168:171], v[24:39]
    s_add_u32 s53, s50, 5
    s_and_b32 s53, s53, 7
    s_mul_i32 s53, s53, 12288
    s_add_u32 s53, s53, s44
    buffer_load_dwordx4 v[104:107], v5, s[8:11], s53 offen offset:0
    v_mfma_f32_32x32x16_bf16 v[40:55], v[120:123], v[164:167], v[40:55]
    buffer_load_dwordx4 v[108:111], v5, s[8:11], s53 offen offset:1024
    v_mfma_f32_32x32x16_bf16 v[56:71], v[120:123], v[168:171], v[56:71]
    buffer_load_dwordx4 v[112:115], v5, s[8:11], s53 offen offset:2048
    v_mfma_f32_32x32x16_bf16 v[72:87], v[124:127], v[164:167], v[72:87]
    s_add_u32 s42, s55, 65536
    s_add_u32 m0, s46, 10240
    s_nop 0
    buffer_load_dwordx4 v6, s[4:7], s42 offen lds
    v_mfma_f32_32x32x16_bf16 v[88:103], v[124:127], v[168:171], v[88:103]
    s_add_u32 s42, s55, 98304
    s_add_u32 m0, s46, 11264
    s_nop 0
    buffer_load_dwordx4 v7, s[4:7], s42 offen lds
    s_add_u32 s42, s55, 131072
    s_add_u32 m0, s46, 12288
    s_nop 0
    buffer_load_dwordx4 v6, s[4:7], s42 offen lds
    s_waitcnt vmcnt(17)
    s_waitcnt lgkmcnt(0)
    v_mfma_f32_32x32x16_bf16 v[8:23], v[128:131], v[172:175], v[8:23]
    ds_read_b128 v[164:167], v182 offset:0
    ds_read_b128 v[168:171], v182 offset:4096
    v_mfma_f32_32x32x16_bf16 v[24:39], v[128:131], v[176:179], v[24:39]
    s_add_u32 s41, s53, 3072
    buffer_load_dwordx4 v[116:119], v5, s[8:11], s41 offen offset:0
    v_mfma_f32_32x32x16_bf16 v[40:55], v[132:135], v[172:175], v[40:55]
    s_add_u32 s41, s53, 3072
    buffer_load_dwordx4 v[120:123], v5, s[8:11], s41 offen offset:1024
    v_mfma_f32_32x32x16_bf16 v[56:71], v[132:135], v[176:179], v[56:71]
    s_add_u32 s41, s53, 3072
    buffer_load_dwordx4 v[124:127], v5, s[8:11], s41 offen offset:2048
    v_mfma_f32_32x32x16_bf16 v[72:87], v[136:139], v[172:175], v[72:87]
    s_add_u32 s42, s55, 163840
    s_add_u32 m0, s46, 13312
    s_nop 0
    buffer_load_dwordx4 v7, s[4:7], s42 offen lds
    v_mfma_f32_32x32x16_bf16 v[88:103], v[136:139], v[176:179], v[88:103]
    s_add_u32 s42, s55, 196608
    s_add_u32 m0, s46, 14336
    s_nop 0
    buffer_load_dwordx4 v6, s[4:7], s42 offen lds
    s_add_u32 s42, s55, 229376
    s_add_u32 m0, s46, 15360
    s_nop 0
    buffer_load_dwordx4 v7, s[4:7], s42 offen lds
    s_waitcnt vmcnt(17)
    s_waitcnt lgkmcnt(0)
    v_mfma_f32_32x32x16_bf16 v[8:23], v[140:143], v[164:167], v[8:23]
    ds_read_b128 v[172:175], v183 offset:0
    ds_read_b128 v[176:179], v183 offset:4096
    v_mfma_f32_32x32x16_bf16 v[24:39], v[140:143], v[168:171], v[24:39]
    s_add_u32 s41, s53, 6144
    buffer_load_dwordx4 v[128:131], v5, s[8:11], s41 offen offset:0
    v_mfma_f32_32x32x16_bf16 v[40:55], v[144:147], v[164:167], v[40:55]
    s_add_u32 s41, s53, 6144
    buffer_load_dwordx4 v[132:135], v5, s[8:11], s41 offen offset:1024
    v_mfma_f32_32x32x16_bf16 v[56:71], v[144:147], v[168:171], v[56:71]
    s_add_u32 s41, s53, 6144
    buffer_load_dwordx4 v[136:139], v5, s[8:11], s41 offen offset:2048
    v_mfma_f32_32x32x16_bf16 v[72:87], v[148:151], v[164:167], v[72:87]
    v_mfma_f32_32x32x16_bf16 v[88:103], v[148:151], v[168:171], v[88:103]
    s_waitcnt vmcnt(17)
    s_waitcnt lgkmcnt(0)
    v_mfma_f32_32x32x16_bf16 v[8:23], v[152:155], v[172:175], v[8:23]
    s_waitcnt vmcnt(3)
    ds_read_b128 v[164:167], v180 offset:8192
    ds_read_b128 v[168:171], v180 offset:12288
    v_mfma_f32_32x32x16_bf16 v[24:39], v[152:155], v[176:179], v[24:39]
    s_add_u32 s41, s53, 9216
    buffer_load_dwordx4 v[140:143], v5, s[8:11], s41 offen offset:0
    v_mfma_f32_32x32x16_bf16 v[40:55], v[156:159], v[172:175], v[40:55]
    s_add_u32 s41, s53, 9216
    buffer_load_dwordx4 v[144:147], v5, s[8:11], s41 offen offset:1024
    v_mfma_f32_32x32x16_bf16 v[56:71], v[156:159], v[176:179], v[56:71]
    s_add_u32 s41, s53, 9216
    buffer_load_dwordx4 v[148:151], v5, s[8:11], s41 offen offset:2048
    v_mfma_f32_32x32x16_bf16 v[72:87], v[160:163], v[172:175], v[72:87]
    s_add_u32 s54, s50, 6
    s_and_b32 s54, s54, 7
    s_lshl_b32 s54, s54, 7
    s_add_u32 s54, s54, s45
    s_add_u32 s42, s54, 0
    s_add_u32 m0, s46, 0
    s_nop 0
    buffer_load_dwordx4 v6, s[4:7], s42 offen lds
    v_mfma_f32_32x32x16_bf16 v[88:103], v[160:163], v[176:179], v[88:103]
    s_add_u32 s42, s54, 32768
    s_add_u32 m0, s46, 1024
    s_nop 0
    buffer_load_dwordx4 v7, s[4:7], s42 offen lds
    s_waitcnt vmcnt(17)
    s_waitcnt lgkmcnt(0)
    v_mfma_f32_32x32x16_bf16 v[8:23], v[104:107], v[164:167], v[8:23]
    ds_read_b128 v[172:175], v181 offset:8192
    ds_read_b128 v[176:179], v181 offset:12288
    v_mfma_f32_32x32x16_bf16 v[24:39], v[104:107], v[168:171], v[24:39]
    s_add_u32 s52, s50, 6
    s_and_b32 s52, s52, 7
    s_mul_i32 s52, s52, 12288
    s_add_u32 s52, s52, s44
    buffer_load_dwordx4 v[152:155], v5, s[8:11], s52 offen offset:0
    v_mfma_f32_32x32x16_bf16 v[40:55], v[108:111], v[164:167], v[40:55]
    buffer_load_dwordx4 v[156:159], v5, s[8:11], s52 offen offset:1024
    v_mfma_f32_32x32x16_bf16 v[56:71], v[108:111], v[168:171], v[56:71]
    buffer_load_dwordx4 v[160:163], v5, s[8:11], s52 offen offset:2048
    v_mfma_f32_32x32x16_bf16 v[72:87], v[112:115], v[164:167], v[72:87]
    s_add_u32 s42, s54, 65536
    s_add_u32 m0, s46, 2048
    s_nop 0
    buffer_load_dwordx4 v6, s[4:7], s42 offen lds
    v_mfma_f32_32x32x16_bf16 v[88:103], v[112:115], v[168:171], v[88:103]
    s_add_u32 s42, s54, 98304
    s_add_u32 m0, s46, 3072
    s_nop 0
    buffer_load_dwordx4 v7, s[4:7], s42 offen lds
    s_add_u32 s42, s54, 131072
    s_add_u32 m0, s46, 4096
    s_nop 0
    buffer_load_dwordx4 v6, s[4:7], s42 offen lds
    s_waitcnt vmcnt(17)
    s_waitcnt lgkmcnt(0)
    v_mfma_f32_32x32x16_bf16 v[8:23], v[116:119], v[172:175], v[8:23]
    ds_read_b128 v[164:167], v182 offset:8192
    ds_read_b128 v[168:171], v182 offset:12288
    v_mfma_f32_32x32x16_bf16 v[24:39], v[116:119], v[176:179], v[24:39]
    s_add_u32 s41, s52, 3072
    buffer_load_dwordx4 v[104:107], v5, s[8:11], s41 offen offset:0
    v_mfma_f32_32x32x16_bf16 v[40:55], v[120:123], v[172:175], v[40:55]
    s_add_u32 s41, s52, 3072
    buffer_load_dwordx4 v[108:111], v5, s[8:11], s41 offen offset:1024
    v_mfma_f32_32x32x16_bf16 v[56:71], v[120:123], v[176:179], v[56:71]
    s_add_u32 s41, s52, 3072
    buffer_load_dwordx4 v[112:115], v5, s[8:11], s41 offen offset:2048
    v_mfma_f32_32x32x16_bf16 v[72:87], v[124:127], v[172:175], v[72:87]
    s_add_u32 s42, s54, 163840
    s_add_u32 m0, s46, 5120
    s_nop 0
    buffer_load_dwordx4 v7, s[4:7], s42 offen lds
    v_mfma_f32_32x32x16_bf16 v[88:103], v[124:127], v[176:179], v[88:103]
    s_add_u32 s42, s54, 196608
    s_add_u32 m0, s46, 6144
    s_nop 0
    buffer_load_dwordx4 v6, s[4:7], s42 offen lds
    s_add_u32 s42, s54, 229376
    s_add_u32 m0, s46, 7168
    s_nop 0
    buffer_load_dwordx4 v7, s[4:7], s42 offen lds
    s_waitcnt vmcnt(17)
    s_waitcnt lgkmcnt(0)
    v_mfma_f32_32x32x16_bf16 v[8:23], v[128:131], v[164:167], v[8:23]
    ds_read_b128 v[172:175], v183 offset:8192
    ds_read_b128 v[176:179], v183 offset:12288
    v_mfma_f32_32x32x16_bf16 v[24:39], v[128:131], v[168:171], v[24:39]
    s_add_u32 s41, s52, 6144
    buffer_load_dwordx4 v[116:119], v5, s[8:11], s41 offen offset:0
    v_mfma_f32_32x32x16_bf16 v[40:55], v[132:135], v[164:167], v[40:55]
    s_add_u32 s41, s52, 6144
    buffer_load_dwordx4 v[120:123], v5, s[8:11], s41 offen offset:1024
    v_mfma_f32_32x32x16_bf16 v[56:71], v[132:135], v[168:171], v[56:71]
    s_add_u32 s41, s52, 6144
    buffer_load_dwordx4 v[124:127], v5, s[8:11], s41 offen offset:2048
    v_mfma_f32_32x32x16_bf16 v[72:87], v[136:139], v[164:167], v[72:87]
    v_mfma_f32_32x32x16_bf16 v[88:103], v[136:139], v[168:171], v[88:103]
    s_waitcnt vmcnt(17)
    s_waitcnt lgkmcnt(0)
    v_mfma_f32_32x32x16_bf16 v[8:23], v[140:143], v[172:175], v[8:23]
    s_waitcnt vmcnt(3)
    ds_read_b128 v[164:167], v180 offset:0
    ds_read_b128 v[168:171], v180 offset:4096
    v_mfma_f32_32x32x16_bf16 v[24:39], v[140:143], v[176:179], v[24:39]
    s_add_u32 s41, s52, 9216
    buffer_load_dwordx4 v[128:131], v5, s[8:11], s41 offen offset:0
    v_mfma_f32_32x32x16_bf16 v[40:55], v[144:147], v[172:175], v[40:55]
    s_add_u32 s41, s52, 9216
    buffer_load_dwordx4 v[132:135], v5, s[8:11], s41 offen offset:1024
    v_mfma_f32_32x32x16_bf16 v[56:71], v[144:147], v[176:179], v[56:71]
    s_add_u32 s41, s52, 9216
    buffer_load_dwordx4 v[136:139], v5, s[8:11], s41 offen offset:2048
    v_mfma_f32_32x32x16_bf16 v[72:87], v[148:151], v[172:175], v[72:87]
    s_add_u32 s55, s50, 7
    s_and_b32 s55, s55, 7
    s_lshl_b32 s55, s55, 7
    s_add_u32 s55, s55, s45
    s_add_u32 s42, s55, 0
    s_add_u32 m0, s46, 8192
    s_nop 0
    buffer_load_dwordx4 v6, s[4:7], s42 offen lds
    v_mfma_f32_32x32x16_bf16 v[88:103], v[148:151], v[176:179], v[88:103]
    s_add_u32 s42, s55, 32768
    s_add_u32 m0, s46, 9216
    s_nop 0
    buffer_load_dwordx4 v7, s[4:7], s42 offen lds
    s_waitcnt vmcnt(17)
    s_waitcnt lgkmcnt(0)
    v_mfma_f32_32x32x16_bf16 v[8:23], v[152:155], v[164:167], v[8:23]
    ds_read_b128 v[172:175], v181 offset:0
    ds_read_b128 v[176:179], v181 offset:4096
    v_mfma_f32_32x32x16_bf16 v[24:39], v[152:155], v[168:171], v[24:39]
    s_add_u32 s53, s50, 7
    s_and_b32 s53, s53, 7
    s_mul_i32 s53, s53, 12288
    s_add_u32 s53, s53, s44
    buffer_load_dwordx4 v[140:143], v5, s[8:11], s53 offen offset:0
    v_mfma_f32_32x32x16_bf16 v[40:55], v[156:159], v[164:167], v[40:55]
    buffer_load_dwordx4 v[144:147], v5, s[8:11], s53 offen offset:1024
    v_mfma_f32_32x32x16_bf16 v[56:71], v[156:159], v[168:171], v[56:71]
    buffer_load_dwordx4 v[148:151], v5, s[8:11], s53 offen offset:2048
    v_mfma_f32_32x32x16_bf16 v[72:87], v[160:163], v[164:167], v[72:87]
    s_add_u32 s42, s55, 65536
    s_add_u32 m0, s46, 10240
    s_nop 0
    buffer_load_dwordx4 v6, s[4:7], s42 offen lds
    v_mfma_f32_32x32x16_bf16 v[88:103], v[160:163], v[168:171], v[88:103]
    s_add_u32 s42, s55, 98304
    s_add_u32 m0, s46, 11264
    s_nop 0
    buffer_load_dwordx4 v7, s[4:7], s42 offen lds
    s_add_u32 s42, s55, 131072
    s_add_u32 m0, s46, 12288
    s_nop 0
    buffer_load_dwordx4 v6, s[4:7], s42 offen lds
    s_waitcnt vmcnt(17)
    s_waitcnt lgkmcnt(0)
    v_mfma_f32_32x32x16_bf16 v[8:23], v[104:107], v[172:175], v[8:23]
    ds_read_b128 v[164:167], v182 offset:0
    ds_read_b128 v[168:171], v182 offset:4096
    v_mfma_f32_32x32x16_bf16 v[24:39], v[104:107], v[176:179], v[24:39]
    s_add_u32 s41, s53, 3072
    buffer_load_dwordx4 v[152:155], v5, s[8:11], s41 offen offset:0
    v_mfma_f32_32x32x16_bf16 v[40:55], v[108:111], v[172:175], v[40:55]
    s_add_u32 s41, s53, 3072
    buffer_load_dwordx4 v[156:159], v5, s[8:11], s41 offen offset:1024
    v_mfma_f32_32x32x16_bf16 v[56:71], v[108:111], v[176:179], v[56:71]
    s_add_u32 s41, s53, 3072
    buffer_load_dwordx4 v[160:163], v5, s[8:11], s41 offen offset:2048
    v_mfma_f32_32x32x16_bf16 v[72:87], v[112:115], v[172:175], v[72:87]
    s_add_u32 s42, s55, 163840
    s_add_u32 m0, s46, 13312
    s_nop 0
    buffer_load_dwordx4 v7, s[4:7], s42 offen lds
    v_mfma_f32_32x32x16_bf16 v[88:103], v[112:115], v[176:179], v[88:103]
    s_add_u32 s42, s55, 196608
    s_add_u32 m0, s46, 14336
    s_nop 0
    buffer_load_dwordx4 v6, s[4:7], s42 offen lds
    s_add_u32 s42, s55, 229376
    s_add_u32 m0, s46, 15360
    s_nop 0
    buffer_load_dwordx4 v7, s[4:7], s42 offen lds
    s_waitcnt vmcnt(17)
    s_waitcnt lgkmcnt(0)
    v_mfma_f32_32x32x16_bf16 v[8:23], v[116:119], v[164:167], v[8:23]
    ds_read_b128 v[172:175], v183 offset:0
    ds_read_b128 v[176:179], v183 offset:4096
    v_mfma_f32_32x32x16_bf16 v[24:39], v[116:119], v[168:171], v[24:39]
    s_add_u32 s41, s53, 6144
    buffer_load_dwordx4 v[104:107], v5, s[8:11], s41 offen offset:0
    v_mfma_f32_32x32x16_bf16 v[40:55], v[120:123], v[164:167], v[40:55]
    s_add_u32 s41, s53, 6144
    buffer_load_dwordx4 v[108:111], v5, s[8:11], s41 offen offset:1024
    v_mfma_f32_32x32x16_bf16 v[56:71], v[120:123], v[168:171], v[56:71]
    s_add_u32 s41, s53, 6144
    buffer_load_dwordx4 v[112:115], v5, s[8:11], s41 offen offset:2048
    v_mfma_f32_32x32x16_bf16 v[72:87], v[124:127], v[164:167], v[72:87]
    v_mfma_f32_32x32x16_bf16 v[88:103], v[124:127], v[168:171], v[88:103]
    s_waitcnt vmcnt(17)
    s_waitcnt lgkmcnt(0)
    v_mfma_f32_32x32x16_bf16 v[8:23], v[128:131], v[172:175], v[8:23]
    s_waitcnt vmcnt(3)
    ds_read_b128 v[164:167], v180 offset:8192
    ds_read_b128 v[168:171], v180 offset:12288
    v_mfma_f32_32x32x16_bf16 v[24:39], v[128:131], v[176:179], v[24:39]
    s_add_u32 s41, s53, 9216
    buffer_load_dwordx4 v[116:119], v5, s[8:11], s41 offen offset:0
    v_mfma_f32_32x32x16_bf16 v[40:55], v[132:135], v[172:175], v[40:55]
    s_add_u32 s41, s53, 9216
    buffer_load_dwordx4 v[120:123], v5, s[8:11], s41 offen offset:1024
    v_mfma_f32_32x32x16_bf16 v[56:71], v[132:135], v[176:179], v[56:71]
    s_add_u32 s41, s53, 9216
    buffer_load_dwordx4 v[124:127], v5, s[8:11], s41 offen offset:2048
    v_mfma_f32_32x32x16_bf16 v[72:87], v[136:139], v[172:175], v[72:87]
    v_mfma_f32_32x32x16_bf16 v[88:103], v[136:139], v[176:179], v[88:103]
    s_waitcnt vmcnt(15)
    s_waitcnt lgkmcnt(0)
    v_mfma_f32_32x32x16_bf16 v[8:23], v[140:143], v[164:167], v[8:23]
    ds_read_b128 v[172:175], v181 offset:8192
    ds_read_b128 v[176:179], v181 offset:12288
    v_mfma_f32_32x32x16_bf16 v[24:39], v[140:143], v[168:171], v[24:39]
    v_mfma_f32_32x32x16_bf16 v[40:55], v[144:147], v[164:167], v[40:55]
    v_mfma_f32_32x32x16_bf16 v[56:71], v[144:147], v[168:171], v[56:71]
    v_mfma_f32_32x32x16_bf16 v[72:87], v[148:151], v[164:167], v[72:87]
    v_mfma_f32_32x32x16_bf16 v[88:103], v[148:151], v[168:171], v[88:103]
    s_waitcnt vmcnt(9)
    s_waitcnt lgkmcnt(0)
    v_mfma_f32_32x32x16_bf16 v[8:23], v[152:155], v[172:175], v[8:23]
    ds_read_b128 v[164:167], v182 offset:8192
    ds_read_b128 v[168:171], v182 offset:12288
    v_mfma_f32_32x32x16_bf16 v[24:39], v[152:155], v[176:179], v[24:39]
    v_mfma_f32_32x32x16_bf16 v[40:55], v[156:159], v[172:175], v[40:55]
    v_mfma_f32_32x32x16_bf16 v[56:71], v[156:159], v[176:179], v[56:71]
    v_mfma_f32_32x32x16_bf16 v[72:87], v[160:163], v[172:175], v[72:87]
    v_mfma_f32_32x32x16_bf16 v[88:103], v[160:163], v[176:179], v[88:103]
    s_waitcnt vmcnt(3)
    s_waitcnt lgkmcnt(0)
    v_mfma_f32_32x32x16_bf16 v[8:23], v[104:107], v[164:167], v[8:23]
    ds_read_b128 v[172:175], v183 offset:8192
    ds_read_b128 v[176:179], v183 offset:12288
    v_mfma_f32_32x32x16_bf16 v[24:39], v[104:107], v[168:171], v[24:39]
    s_lshl_b32 s40, s32, 3
    s_add_u32 s40, s40, s33
    s_lshl_b32 s40, s40, 2
    s_add_u32 s40, s40, s34
    s_mul_i32 s40, s40, 3072
    s_add_u32 s40, s40, 3145728
    buffer_load_dwordx4 v[184:187], v5, s[8:11], s40 offen offset:0
    v_mfma_f32_32x32x16_bf16 v[40:55], v[108:111], v[164:167], v[40:55]
    buffer_load_dwordx4 v[188:191], v5, s[8:11], s40 offen offset:1024
    v_mfma_f32_32x32x16_bf16 v[56:71], v[108:111], v[168:171], v[56:71]
    buffer_load_dwordx4 v[192:195], v5, s[8:11], s40 offen offset:2048
    v_mfma_f32_32x32x16_bf16 v[72:87], v[112:115], v[164:167], v[72:87]
    v_and_b32 v2, 31, v1
    v_lshlrev_b32 v2, 1, v2
    s_lshr_b32 s40, s34, 1
    s_lshl_b32 s40, s40, 6
    s_lshl_b32 s43, s32, 7
    s_add_u32 s40, s40, s43
    buffer_load_ushort v196, v2, s[12:15], s40 offen
    v_mfma_f32_32x32x16_bf16 v[88:103], v[112:115], v[168:171], v[88:103]
    s_waitcnt vmcnt(4)
    s_waitcnt lgkmcnt(0)
    v_mfma_f32_32x32x16_bf16 v[8:23], v[116:119], v[172:175], v[8:23]
    v_mfma_f32_32x32x16_bf16 v[24:39], v[116:119], v[176:179], v[24:39]
    v_mfma_f32_32x32x16_bf16 v[40:55], v[120:123], v[172:175], v[40:55]
    v_mfma_f32_32x32x16_bf16 v[56:71], v[120:123], v[176:179], v[56:71]
    v_mfma_f32_32x32x16_bf16 v[72:87], v[124:127], v[172:175], v[72:87]
    v_mfma_f32_32x32x16_bf16 v[88:103], v[124:127], v[176:179], v[88:103]
    s_setprio 0
    v_add_u32 v4, 0x10000, v5
    s_nop 15
    s_barrier
    s_cmp_lg_u32 s34, 0
    s_cbranch_scc1 g_epi_2
    ds_write_b128 v5, v[12:15] offset:30720
    ds_write_b128 v5, v[20:23] offset:31744
    ds_write_b128 v5, v[44:47] offset:32768
    ds_write_b128 v5, v[52:55] offset:33792
    ds_write_b128 v5, v[76:79] offset:34816
    ds_write_b128 v5, v[84:87] offset:35840
    ds_write_b128 v5, v[24:27] offset:43008
    ds_write_b128 v5, v[32:35] offset:44032
    ds_write_b128 v5, v[56:59] offset:45056
    ds_write_b128 v5, v[64:67] offset:46080
    ds_write_b128 v5, v[88:91] offset:47104
    ds_write_b128 v5, v[96:99] offset:48128
    ds_write_b128 v5, v[28:31] offset:55296
    ds_write_b128 v5, v[36:39] offset:56320
    ds_write_b128 v5, v[60:63] offset:57344
    ds_write_b128 v5, v[68:71] offset:58368
    ds_write_b128 v5, v[92:95] offset:59392
    ds_write_b128 v5, v[100:103] offset:60416
    v_pk_add_f32 v[104:105], v[8:9], 0
    v_pk_add_f32 v[106:107], v[10:11], 0
    v_pk_add_f32 v[108:109], v[16:17], 0
    v_pk_add_f32 v[110:111], v[18:19], 0
    v_pk_add_f32 v[112:113], v[40:41], 0
    v_pk_add_f32 v[114:115], v[42:43], 0
    v_pk_add_f32 v[116:117], v[48:49], 0
    v_pk_add_f32 v[118:119], v[50:51], 0
    v_pk_add_f32 v[120:121], v[72:73], 0
    v_pk_add_f32 v[122:123], v[74:75], 0
    v_pk_add_f32 v[124:125], v[80:81], 0
    v_pk_add_f32 v[126:127], v[82:83], 0
    s_branch g_epi_end_1
g_epi_2:
    s_cmp_lg_u32 s34, 1
    s_cbranch_scc1 g_epi_3
    ds_write_b128 v5, v[8:11] offset:0
    ds_write_b128 v5, v[16:19] offset:1024
    ds_write_b128 v5, v[40:43] offset:2048
    ds_write_b128 v5, v[48:51] offset:3072
    ds_write_b128 v5, v[72:75] offset:4096
    ds_write_b128 v5, v[80:83] offset:5120
    ds_write_b128 v5, v[24:27] offset:49152
    ds_write_b128 v5, v[32:35] offset:50176
    ds_write_b128 v5, v[56:59] offset:51200
    ds_write_b128 v5, v[64:67] offset:52224
    ds_write_b128 v5, v[88:91] offset:53248
    ds_write_b128 v5, v[96:99] offset:54272
    ds_write_b128 v5, v[28:31] offset:61440
    ds_write_b128 v5, v[36:39] offset:62464
    ds_write_b128 v5, v[60:63] offset:63488
    ds_write_b128 v5, v[68:71] offset:64512
    ds_write_b128 v4, v[92:95] offset:0
    ds_write_b128 v4, v[100:103] offset:1024
    v_pk_add_f32 v[104:105], v[12:13], 0
    v_pk_add_f32 v[106:107], v[14:15], 0
    v_pk_add_f32 v[108:109], v[20:21], 0
    v_pk_add_f32 v[110:111], v[22:23], 0
    v_pk_add_f32 v[112:113], v[44:45], 0
    v_pk_add_f32 v[114:115], v[46:47], 0
    v_pk_add_f32 v[116:117], v[52:53], 0
    v_pk_add_f32 v[118:119], v[54:55], 0
    v_pk_add_f32 v[120:121], v[76:77], 0
    v_pk_add_f32 v[122:123], v[78:79], 0
    v_pk_add_f32 v[124:125], v[84:85], 0
    v_pk_add_f32 v[126:127], v[86:87], 0
    s_branch g_epi_end_1
g_epi_3:
    s_cmp_lg_u32 s34, 2
    s_cbranch_scc1 g_epi_4
    ds_write_b128 v5, v[8:11] offset:6144
    ds_write_b128 v5, v[16:19] offset:7168
    ds_write_b128 v5, v[40:43] offset:8192
    ds_write_b128 v5, v[48:51] offset:9216
    ds_write_b128 v5, v[72:75] offset:10240
    ds_write_b128 v5, v[80:83] offset:11264
    ds_write_b128 v5, v[12:15] offset:18432
    ds_write_b128 v5, v[20:23] offset:19456
    ds_write_b128 v5, v[44:47] offset:20480
    ds_write_b128 v5, v[52:55] offset:21504
    ds_write_b128 v5, v[76:79] offset:22528
    ds_write_b128 v5, v[84:87] offset:23552
    ds_write_b128 v4, v[28:31] offset:2048
    ds_write_b128 v4, v[36:39] offset:3072
    ds_write_b128 v4, v[60:63] offset:4096
    ds_write_b128 v4, v[68:71] offset:5120
    ds_write_b128 v4, v[92:95] offset:6144
    ds_write_b128 v4, v[100:103] offset:7168
    v_pk_add_f32 v[104:105], v[24:25], 0
    v_pk_add_f32 v[106:107], v[26:27], 0
    v_pk_add_f32 v[108:109], v[32:33], 0
    v_pk_add_f32 v[110:111], v[34:35], 0
    v_pk_add_f32 v[112:113], v[56:57], 0
    v_pk_add_f32 v[114:115], v[58:59], 0
    v_pk_add_f32 v[116:117], v[64:65], 0
    v_pk_add_f32 v[118:119], v[66:67], 0
    v_pk_add_f32 v[120:121], v[88:89], 0
    v_pk_add_f32 v[122:123], v[90:91], 0
    v_pk_add_f32 v[124:125], v[96:97], 0
    v_pk_add_f32 v[126:127], v[98:99], 0
    s_branch g_epi_end_1
g_epi_4:
    ds_write_b128 v5, v[8:11] offset:12288
    ds_write_b128 v5, v[16:19] offset:13312
    ds_write_b128 v5, v[40:43] offset:14336
    ds_write_b128 v5, v[48:51] offset:15360
    ds_write_b128 v5, v[72:75] offset:16384
    ds_write_b128 v5, v[80:83] offset:17408
    ds_write_b128 v5, v[12:15] offset:24576
    ds_write_b128 v5, v[20:23] offset:25600
    ds_write_b128 v5, v[44:47] offset:26624
    ds_write_b128 v5, v[52:55] offset:27648
    ds_write_b128 v5, v[76:79] offset:28672
    ds_write_b128 v5, v[84:87] offset:29696
    ds_write_b128 v5, v[24:27] offset:36864
    ds_write_b128 v5, v[32:35] offset:37888
    ds_write_b128 v5, v[56:59] offset:38912
    ds_write_b128 v5, v[64:67] offset:39936
    ds_write_b128 v5, v[88:91] offset:40960
    ds_write_b128 v5, v[96:99] offset:41984
    v_pk_add_f32 v[104:105], v[28:29], 0
    v_pk_add_f32 v[106:107], v[30:31], 0
    v_pk_add_f32 v[108:109], v[36:37], 0
    v_pk_add_f32 v[110:111], v[38:39], 0
    v_pk_add_f32 v[112:113], v[60:61], 0
    v_pk_add_f32 v[114:115], v[62:63], 0
    v_pk_add_f32 v[116:117], v[68:69], 0
    v_pk_add_f32 v[118:119], v[70:71], 0
    v_pk_add_f32 v[120:121], v[92:93], 0
    v_pk_add_f32 v[122:123], v[94:95], 0
    v_pk_add_f32 v[124:125], v[100:101], 0
    v_pk_add_f32 v[126:127], v[102:103], 0
g_epi_end_1:
    s_waitcnt lgkmcnt(0)
    s_barrier
    s_mul_i32 s40, s34, 18432
    v_add_u32 v2, s40, v5
    ds_read_b128 v[8:11], v2 offset:0
    ds_read_b128 v[12:15], v2 offset:1024
    ds_read_b128 v[16:19], v2 offset:2048
    ds_read_b128 v[20:23], v2 offset:3072
    ds_read_b128 v[24:27], v2 offset:4096
    ds_read_b128 v[28:31], v2 offset:5120
    ds_read_b128 v[32:35], v2 offset:6144
    ds_read_b128 v[36:39], v2 offset:7168
    ds_read_b128 v[40:43], v2 offset:8192
    ds_read_b128 v[44:47], v2 offset:9216
    ds_read_b128 v[48:51], v2 offset:10240
    ds_read_b128 v[52:55], v2 offset:11264
    ds_read_b128 v[56:59], v2 offset:12288
    ds_read_b128 v[60:63], v2 offset:13312
    ds_read_b128 v[64:67], v2 offset:14336
    ds_read_b128 v[68:71], v2 offset:15360
    ds_read_b128 v[72:75], v2 offset:16384
    ds_read_b128 v[76:79], v2 offset:17408
    v_lshrrev_b32 v6, 4, v1
    v_and_b32 v6, 1, v6
    v_mul_u32_u24 v6, 24576, v6
    v_and_b32 v3, 15, v1
    v_lshrrev_b32 v4, 5, v1
    v_lshl_add_u32 v3, v4, 4, v3
    v_lshl_add_u32 v6, v3, 4, v6
    s_mul_i32 s40, s32, 98304
    s_lshr_b32 s41, s34, 1
    s_mul_i32 s41, s41, 49152
    s_add_u32 s40, s40, s41
    s_mul_i32 s41, s33, 3072
    s_add_u32 s40, s40, s41
    s_and_b32 s41, s34, 1
    s_lshl_b32 s41, s41, 9
    s_add_u32 s40, s40, s41
    s_add_u32 s40, s40, 11534336
    s_waitcnt vmcnt(0)
    v_lshlrev_b32 v180, 16, v196
    v_lshlrev_b32 v80, 16, v184
    v_and_b32 v81, 0xffff0000, v184
    v_lshlrev_b32 v82, 16, v185
    v_and_b32 v83, 0xffff0000, v185
    v_lshlrev_b32 v84, 16, v186
    v_and_b32 v85, 0xffff0000, v186
    v_lshlrev_b32 v86, 16, v187
    v_and_b32 v87, 0xffff0000, v187
    v_lshlrev_b32 v88, 16, v188
    v_and_b32 v89, 0xffff0000, v188
    v_lshlrev_b32 v90, 16, v189
    v_and_b32 v91, 0xffff0000, v189
    v_lshlrev_b32 v92, 16, v190
    v_and_b32 v93, 0xffff0000, v190
    v_lshlrev_b32 v94, 16, v191
    v_and_b32 v95, 0xffff0000, v191
    v_lshlrev_b32 v96, 16, v192
    v_and_b32 v97, 0xffff0000, v192
    v_lshlrev_b32 v98, 16, v193
    v_and_b32 v99, 0xffff0000, v193
    v_lshlrev_b32 v100, 16, v194
    v_and_b32 v101, 0xffff0000, v194
    v_lshlrev_b32 v102, 16, v195
    v_and_b32 v103, 0xffff0000, v195
    s_waitcnt lgkmcnt(12)
    v_pk_add_f32 v[104:105], v[104:105], v[8:9]
    v_pk_add_f32 v[106:107], v[106:107], v[10:11]
    v_pk_add_f32 v[108:109], v[108:109], v[12:13]
    v_pk_add_f32 v[110:111], v[110:111], v[14:15]
    v_pk_add_f32 v[112:113], v[112:113], v[16:17]
    v_pk_add_f32 v[114:115], v[114:115], v[18:19]
    v_pk_add_f32 v[116:117], v[116:117], v[20:21]
    v_pk_add_f32 v[118:119], v[118:119], v[22:23]
    v_pk_add_f32 v[120:121], v[120:121], v[24:25]
    v_pk_add_f32 v[122:123], v[122:123], v[26:27]
    v_pk_add_f32 v[124:125], v[124:125], v[28:29]
    v_pk_add_f32 v[126:127], v[126:127], v[30:31]
    s_waitcnt lgkmcnt(6)
    v_pk_add_f32 v[104:105], v[104:105], v[32:33]
    v_pk_add_f32 v[106:107], v[106:107], v[34:35]
    v_pk_add_f32 v[108:109], v[108:109], v[36:37]
    v_pk_add_f32 v[110:111], v[110:111], v[38:39]
    v_pk_add_f32 v[112:113], v[112:113], v[40:41]
    v_pk_add_f32 v[114:115], v[114:115], v[42:43]
    v_pk_add_f32 v[116:117], v[116:117], v[44:45]
    v_pk_add_f32 v[118:119], v[118:119], v[46:47]
    v_pk_add_f32 v[120:121], v[120:121], v[48:49]
    v_pk_add_f32 v[122:123], v[122:123], v[50:51]
    v_pk_add_f32 v[124:125], v[124:125], v[52:53]
    v_pk_add_f32 v[126:127], v[126:127], v[54:55]
    s_waitcnt lgkmcnt(0)
    v_pk_add_f32 v[104:105], v[104:105], v[56:57]
    v_pk_add_f32 v[106:107], v[106:107], v[58:59]
    v_pk_add_f32 v[108:109], v[108:109], v[60:61]
    v_pk_add_f32 v[110:111], v[110:111], v[62:63]
    v_pk_add_f32 v[112:113], v[112:113], v[64:65]
    v_pk_add_f32 v[114:115], v[114:115], v[66:67]
    v_pk_add_f32 v[116:117], v[116:117], v[68:69]
    v_pk_add_f32 v[118:119], v[118:119], v[70:71]
    v_pk_add_f32 v[120:121], v[120:121], v[72:73]
    v_pk_add_f32 v[122:123], v[122:123], v[74:75]
    v_pk_add_f32 v[124:125], v[124:125], v[76:77]
    v_pk_add_f32 v[126:127], v[126:127], v[78:79]
    v_pk_add_f32 v[104:105], v[104:105], v[180:181] op_sel_hi:[1,0]
    v_pk_add_f32 v[106:107], v[106:107], v[180:181] op_sel_hi:[1,0]
    v_pk_add_f32 v[108:109], v[108:109], v[180:181] op_sel_hi:[1,0]
    v_pk_add_f32 v[110:111], v[110:111], v[180:181] op_sel_hi:[1,0]
    v_pk_add_f32 v[112:113], v[112:113], v[180:181] op_sel_hi:[1,0]
    v_pk_add_f32 v[114:115], v[114:115], v[180:181] op_sel_hi:[1,0]
    v_pk_add_f32 v[116:117], v[116:117], v[180:181] op_sel_hi:[1,0]
    v_pk_add_f32 v[118:119], v[118:119], v[180:181] op_sel_hi:[1,0]
    v_pk_add_f32 v[120:121], v[120:121], v[180:181] op_sel_hi:[1,0]
    v_pk_add_f32 v[122:123], v[122:123], v[180:181] op_sel_hi:[1,0]
    v_pk_add_f32 v[124:125], v[124:125], v[180:181] op_sel_hi:[1,0]
    v_pk_add_f32 v[126:127], v[126:127], v[180:181] op_sel_hi:[1,0]
    v_pk_mul_f32 v[104:105], v[104:105], v[80:81]
    v_pk_mul_f32 v[106:107], v[106:107], v[82:83]
    v_pk_mul_f32 v[108:109], v[108:109], v[84:85]
    v_pk_mul_f32 v[110:111], v[110:111], v[86:87]
    v_pk_mul_f32 v[112:113], v[112:113], v[88:89]
    v_pk_mul_f32 v[114:115], v[114:115], v[90:91]
    v_pk_mul_f32 v[116:117], v[116:117], v[92:93]
    v_pk_mul_f32 v[118:119], v[118:119], v[94:95]
    v_pk_mul_f32 v[120:121], v[120:121], v[96:97]
    v_pk_mul_f32 v[122:123], v[122:123], v[98:99]
    v_pk_mul_f32 v[124:125], v[124:125], v[100:101]
    v_pk_mul_f32 v[126:127], v[126:127], v[102:103]
    v_cvt_pk_bf16_f32 v8, v104, v105
    v_cvt_pk_bf16_f32 v9, v106, v107
    v_cvt_pk_bf16_f32 v10, v108, v109
    v_cvt_pk_bf16_f32 v11, v110, v111
    buffer_store_dwordx4 v[8:11], v6, s[8:11], s40 offen offset:0 sc1
    v_cvt_pk_bf16_f32 v12, v112, v113
    v_cvt_pk_bf16_f32 v13, v114, v115
    v_cvt_pk_bf16_f32 v14, v116, v117
    v_cvt_pk_bf16_f32 v15, v118, v119
    buffer_store_dwordx4 v[12:15], v6, s[8:11], s40 offen offset:1024 sc1
    v_cvt_pk_bf16_f32 v16, v120, v121
    v_cvt_pk_bf16_f32 v17, v122, v123
    v_cvt_pk_bf16_f32 v18, v124, v125
    v_cvt_pk_bf16_f32 v19, v126, v127
    buffer_store_dwordx4 v[16:19], v6, s[8:11], s40 offen offset:2048 sc1
    s_endpgm
k2_kernel_conv:
    s_load_dwordx2 s[4:5], s[0:1], 32
    s_load_dwordx2 s[8:9], s[0:1], 104
    s_load_dwordx2 s[12:13], s[0:1], 40
    s_load_dwordx2 s[16:17], s[0:1], 64
    s_load_dwordx2 s[20:21], s[0:1], 80
    v_lshrrev_b32 v3, 6, v0
    v_and_b32 v1, 63, v0
    v_readfirstlane_b32 s34, v3
    s_mov_b32 s6, 2621440
    s_mov_b32 s7, 0x20000
    s_mov_b32 s10, 15990784
    s_mov_b32 s11, 0x20000
    s_mov_b32 s14, 1280
    s_mov_b32 s15, 0x20000
    s_mov_b32 s18, 8388608
    s_mov_b32 s19, 0x20000
    s_mov_b32 s22, 983040
    s_mov_b32 s23, 0x20000
    s_mov_b32 s32, s2
    v_lshlrev_b32 v2, 4, v0
    v_subrev_u32 v47, 16, v2
    s_mov_b32 s56, s2
    s_add_u32 s57, s2, 256
    s_lshr_b32 s58, s2, 1
    s_add_u32 s58, s58, 512
    s_waitcnt lgkmcnt(0)
    s_lshl_b32 s40, s56, 12
    buffer_load_dwordx4 v[12:15], v2, s[4:7], s40 offen
    buffer_load_dwordx4 v[8:11], v47, s[4:7], s40 offen
    s_add_u32 s40, s40, 6291456
    buffer_load_dwordx4 v[32:35], v2, s[8:11], s40 offen
    s_lshl_b32 s40, s56, 1
    v_mov_b32 v3, 0
    buffer_load_ushort v44, v3, s[12:15], s40 offen
    s_lshr_b32 s47, s2, 3
    s_lshl_b32 s47, s47, 2
    s_add_u32 s47, s47, s34
    s_mul_i32 s40, s47, 12
    v_add_u32 v3, s40, v1
    v_mul_u32_u24 v4, 43691, v3
    v_lshrrev_b32 v4, 22, v4
    v_mul_u32_u24 v5, 96, v4
    v_sub_u32 v3, v3, v5
    v_mul_u32_u24 v4, 98304, v4
    v_lshl_add_u32 v49, v3, 7, v4
    s_and_b32 s40, s2, 7
    s_lshr_b32 s52, s40, 1
    s_lshl_b32 s52, s52, 21
    s_and_b32 s53, s40, 1
    s_mul_i32 s53, s53, 1572864
    s_add_u32 s53, s53, 0
    s_lshl_b32 s40, s47, 4
    v_add_u32 v3, s40, v1
    v_lshrrev_b32 v4, 2, v3
    v_lshlrev_b32 v4, 12, v4
    v_and_b32 v3, 3, v3
    v_lshl_add_u32 v48, v3, 10, v4
    v_mov_b32 v52, 0
    v_mov_b32 v53, 0
    v_mov_b32 v54, 0
    v_mov_b32 v55, 0
    v_mul_u32_u24 v3, 4160, v0
    v_cmp_gt_u32 vcc, 64, v0
    s_nop 0
    s_and_saveexec_b64 s[50:51], vcc
    s_cbranch_execz c_z_6
    v_subrev_u32 v4, -32768, v2
    v_cmp_gt_u32 vcc, 8, v0
    s_nop 1
    v_cndmask_b32 v4, v4, v3, vcc
    v_add_u32 v5, -8, v0
    v_cmp_lt_u32 vcc, 23, v5
    s_nop 0
    s_and_b64 exec, exec, vcc
    ds_write_b128 v4, v[52:55]
c_z_6:
    s_mov_b64 exec, s[50:51]
    v_add_u32 v56, 16, v2
    v_add_u32 v57, 33792, v2
    v_and_b32 v3, 7, v1
    v_mul_u32_u24 v3, 4160, v3
    v_bfe_u32 v4, v1, 3, 1
    v_lshrrev_b32 v5, 4, v1
    v_sub_u32 v4, v4, v5
    v_add_u32 v4, 3, v4
    v_lshl_add_u32 v58, v4, 4, v3
    v_and_b32 v3, 15, v1
    v_lshl_add_u32 v3, v3, 1, v5
    v_lshlrev_b32 v59, 4, v3
    v_add_u32 v59, 33280, v59
    v_and_b32 v3, 15, v1
    v_lshlrev_b32 v4, 3, v5
    v_sub_u32 v4, v4, v3
    v_add_u32 v4, -9, v4
    v_mov_b32 v64, 0xffff
    v_mov_b32 v65, 0xffff0000
    v_cmp_eq_u32 vcc, 0, v4
    s_nop 1
    v_cndmask_b32 v60, 0, v64, vcc
    v_cmp_eq_u32 vcc, 1, v4
    s_nop 1
    v_cndmask_b32 v60, v60, v65, vcc
    v_cmp_eq_u32 vcc, 2, v4
    s_nop 1
    v_cndmask_b32 v61, 0, v64, vcc
    v_cmp_eq_u32 vcc, 3, v4
    s_nop 1
    v_cndmask_b32 v61, v61, v65, vcc
    v_cmp_eq_u32 vcc, 4, v4
    s_nop 1
    v_cndmask_b32 v62, 0, v64, vcc
    v_cmp_eq_u32 vcc, 5, v4
    s_nop 1
    v_cndmask_b32 v62, v62, v65, vcc
    v_cmp_eq_u32 vcc, 6, v4
    s_nop 1
    v_cndmask_b32 v63, 0, v64, vcc
    v_cmp_eq_u32 vcc, 7, v4
    s_nop 1
    v_cndmask_b32 v63, v63, v65, vcc
    v_and_b32 v3, 15, v1
    v_lshlrev_b32 v3, 6, v3
    v_lshl_add_u32 v3, v5, 4, v3
    s_lshl_b32 s40, s34, 13
    s_add_u32 s40, s40, 37888
    v_add_u32 v66, s40, v3
    v_lshlrev_b32 v67, 5, v0
    v_add_u32 v67, 37888, v67
    s_waitcnt vmcnt(0)
    v_cmp_ne_u32 vcc, 0, v0
    s_nop 1
    v_cndmask_b32 v8, 0, v8, vcc
    v_cndmask_b32 v9, 0, v9, vcc
    v_cndmask_b32 v10, 0, v10, vcc
    v_cndmask_b32 v11, 0, v11, vcc
    v_alignbit_b32 v176, v9, v8, 16
    v_alignbit_b32 v177, v10, v9, 16
    v_alignbit_b32 v178, v11, v10, 16
    v_alignbit_b32 v179, v12, v11, 16
    v_alignbit_b32 v180, v13, v12, 16
    v_alignbit_b32 v181, v14, v13, 16
    v_alignbit_b32 v182, v15, v14, 16
    ds_write_b128 v56, v[176:179] offset:0
    v_mov_b32 v184, v9
    v_mov_b32 v185, v10
    v_mov_b32 v186, v11
    v_mov_b32 v187, v12
    ds_write_b128 v56, v[184:187] offset:4160
    s_nop 1
    v_mov_b32 v184, v177
    v_mov_b32 v185, v178
    v_mov_b32 v186, v179
    v_mov_b32 v187, v180
    ds_write_b128 v56, v[184:187] offset:8320
    s_nop 1
    ds_write_b128 v56, v[10:13] offset:12480
    ds_write_b128 v56, v[178:181] offset:16640
    v_mov_b32 v184, v11
    v_mov_b32 v185, v12
    v_mov_b32 v186, v13
    v_mov_b32 v187, v14
    ds_write_b128 v56, v[184:187] offset:20800
    s_nop 1
    v_mov_b32 v184, v179
    v_mov_b32 v185, v180
    v_mov_b32 v186, v181
    v_mov_b32 v187, v182
    ds_write_b128 v56, v[184:187] offset:24960
    s_nop 1
    ds_write_b128 v56, v[12:15] offset:29120
    ds_write_b128 v57, v[32:35]
    v_lshlrev_b32 v3, 16, v44
    v_or_b32 v3, v3, v44
    v_and_b32 v188, v60, v3
    v_and_b32 v189, v61, v3
    v_and_b32 v190, v62, v3
    v_and_b32 v191, v63, v3
    s_cmp_ge_u32 s2, 192
    s_cbranch_scc1 c_wj_7
    s_mul_i32 s40, s2, 2731
    s_lshr_b32 s40, s40, 16
    s_mul_i32 s41, s40, 24
    s_sub_u32 s41, s2, s41
    s_mul_i32 s41, s41, 40960
    s_mul_i32 s40, s40, 160
    s_add_u32 s54, s40, s41
    v_mov_b32 v3, v0
    v_mul_u32_u24 v4, 6554, v3
    v_lshrrev_b32 v4, 16, v4
    v_mul_u32_u24 v5, 10, v4
    v_sub_u32 v3, v3, v5
    v_lshlrev_b32 v3, 4, v3
    v_mul_u32_u24 v4, 1280, v4
    v_add_u32 v3, v3, v4
    s_lshl_b32 s40, s34, 10
    s_add_u32 m0, s40, 70656
    s_nop 0
    buffer_load_dwordx4 v3, s[20:23], s54 offen lds
    s_cmp_lg_u32 s34, 0
    s_cbranch_scc1 c_wj2_8
    v_add_u32 v3, 256, v1
    v_mul_u32_u24 v4, 6554, v3
    v_lshrrev_b32 v4, 16, v4
    v_mul_u32_u24 v5, 10, v4
    v_sub_u32 v3, v3, v5
    v_lshlrev_b32 v3, 4, v3
    v_mul_u32_u24 v4, 1280, v4
    v_add_u32 v3, v3, v4
    s_mov_b32 m0, 74752
    s_nop 0
    buffer_load_dwordx4 v3, s[20:23], s54 offen lds
c_wj2_8:
c_wj_7:
    s_lshl_b32 s40, s57, 12
    buffer_load_dwordx4 v[20:23], v2, s[4:7], s40 offen
    buffer_load_dwordx4 v[16:19], v47, s[4:7], s40 offen
    s_add_u32 s40, s40, 6291456
    buffer_load_dwordx4 v[36:39], v2, s[8:11], s40 offen
    s_lshl_b32 s40, s57, 1
    v_mov_b32 v3, 0
    buffer_load_ushort v45, v3, s[12:15], s40 offen
    s_lshl_b32 s40, s58, 12
    buffer_load_dwordx4 v[28:31], v2, s[4:7], s40 offen
    buffer_load_dwordx4 v[24:27], v47, s[4:7], s40 offen
    s_add_u32 s40, s40, 6291456
    buffer_load_dwordx4 v[40:43], v2, s[8:11], s40 offen
    s_lshl_b32 s40, s58, 1
    v_mov_b32 v3, 0
    buffer_load_ushort v46, v3, s[12:15], s40 offen
    s_waitcnt lgkmcnt(0)
    s_barrier
    s_cmp_lg_u32 s34, 0
    s_cbranch_scc1 c_pw_10
    ds_read_b128 v[100:103], v58 offset:0
    ds_read_b128 v[112:115], v59 offset:480
    ds_read_b128 v[116:119], v59 offset:992
    ds_read_b128 v[120:123], v59 offset:1504
    ds_read_b128 v[124:127], v59 offset:2016
    ds_read_b128 v[128:131], v59 offset:2528
    ds_read_b128 v[132:135], v59 offset:3040
    ds_read_b128 v[136:139], v59 offset:3552
    ds_read_b128 v[140:143], v59 offset:4064
    ds_read_b128 v[104:107], v58 offset:512
    ds_read_b128 v[108:111], v58 offset:1024
    s_waitcnt lgkmcnt(2)
    v_mfma_f32_16x16x32_bf16 v[96:99], v[100:103], v[140:143], 0
    v_mfma_f32_16x16x32_bf16 v[92:95], v[100:103], v[136:139], 0
    v_mfma_f32_16x16x32_bf16 v[88:91], v[100:103], v[132:135], 0
    v_mfma_f32_16x16x32_bf16 v[84:87], v[100:103], v[128:131], 0
    v_mfma_f32_16x16x32_bf16 v[80:83], v[100:103], v[124:127], 0
    v_mfma_f32_16x16x32_bf16 v[76:79], v[100:103], v[120:123], 0
    v_mfma_f32_16x16x32_bf16 v[72:75], v[100:103], v[116:119], 0
    v_mfma_f32_16x16x32_bf16 v[68:71], v[100:103], v[112:115], 0
    v_mfma_f32_16x16x32_bf16 v[68:71], v[188:191], v[112:115], v[68:71]
    v_mfma_f32_16x16x32_bf16 v[72:75], v[188:191], v[116:119], v[72:75]
    v_mfma_f32_16x16x32_bf16 v[76:79], v[188:191], v[120:123], v[76:79]
    v_mfma_f32_16x16x32_bf16 v[80:83], v[188:191], v[124:127], v[80:83]
    v_mfma_f32_16x16x32_bf16 v[84:87], v[188:191], v[128:131], v[84:87]
    v_mfma_f32_16x16x32_bf16 v[88:91], v[188:191], v[132:135], v[88:91]
    v_mfma_f32_16x16x32_bf16 v[92:95], v[188:191], v[136:139], v[92:95]
    v_mfma_f32_16x16x32_bf16 v[96:99], v[188:191], v[140:143], v[96:99]
    ds_read_b128 v[100:103], v58 offset:1536
    s_waitcnt lgkmcnt(2)
    v_mfma_f32_16x16x32_bf16 v[96:99], v[104:107], v[136:139], v[96:99]
    v_mfma_f32_16x16x32_bf16 v[92:95], v[104:107], v[132:135], v[92:95]
    v_mfma_f32_16x16x32_bf16 v[88:91], v[104:107], v[128:131], v[88:91]
    v_mfma_f32_16x16x32_bf16 v[84:87], v[104:107], v[124:127], v[84:87]
    v_mfma_f32_16x16x32_bf16 v[80:83], v[104:107], v[120:123], v[80:83]
    v_mfma_f32_16x16x32_bf16 v[76:79], v[104:107], v[116:119], v[76:79]
    v_mfma_f32_16x16x32_bf16 v[72:75], v[104:107], v[112:115], v[72:75]
    ds_read_b128 v[104:107], v58 offset:2048
    ds_read_b128 v[144:147], v59 offset:416
    ds_read_b128 v[148:151], v59 offset:928
    ds_read_b128 v[152:155], v59 offset:1440
    ds_read_b128 v[156:159], v59 offset:1952
    ds_read_b128 v[160:163], v59 offset:2464
    ds_read_b128 v[164:167], v59 offset:2976
    ds_read_b128 v[168:171], v59 offset:3488
    ds_read_b128 v[172:175], v59 offset:4000
    s_waitcnt lgkmcnt(10)
    v_mfma_f32_16x16x32_bf16 v[96:99], v[108:111], v[132:135], v[96:99]
    v_mfma_f32_16x16x32_bf16 v[92:95], v[108:111], v[128:131], v[92:95]
    v_mfma_f32_16x16x32_bf16 v[88:91], v[108:111], v[124:127], v[88:91]
    v_mfma_f32_16x16x32_bf16 v[84:87], v[108:111], v[120:123], v[84:87]
    v_mfma_f32_16x16x32_bf16 v[80:83], v[108:111], v[116:119], v[80:83]
    v_mfma_f32_16x16x32_bf16 v[76:79], v[108:111], v[112:115], v[76:79]
    ds_read_b128 v[108:111], v58 offset:2560
    s_waitcnt lgkmcnt(10)
    v_mfma_f32_16x16x32_bf16 v[96:99], v[100:103], v[128:131], v[96:99]
    v_mfma_f32_16x16x32_bf16 v[92:95], v[100:103], v[124:127], v[92:95]
    v_mfma_f32_16x16x32_bf16 v[88:91], v[100:103], v[120:123], v[88:91]
    v_mfma_f32_16x16x32_bf16 v[84:87], v[100:103], v[116:119], v[84:87]
    v_mfma_f32_16x16x32_bf16 v[80:83], v[100:103], v[112:115], v[80:83]
    ds_read_b128 v[100:103], v58 offset:3072
    s_waitcnt lgkmcnt(10)
    v_mfma_f32_16x16x32_bf16 v[96:99], v[104:107], v[124:127], v[96:99]
    v_mfma_f32_16x16x32_bf16 v[92:95], v[104:107], v[120:123], v[92:95]
    v_mfma_f32_16x16x32_bf16 v[88:91], v[104:107], v[116:119], v[88:91]
    v_mfma_f32_16x16x32_bf16 v[84:87], v[104:107], v[112:115], v[84:87]
    ds_read_b128 v[104:107], v58 offset:3584
    s_waitcnt lgkmcnt(2)
    v_mfma_f32_16x16x32_bf16 v[96:99], v[108:111], v[120:123], v[96:99]
    v_mfma_f32_16x16x32_bf16 v[92:95], v[108:111], v[116:119], v[92:95]
    v_mfma_f32_16x16x32_bf16 v[88:91], v[108:111], v[112:115], v[88:91]
    ds_read_b128 v[108:111], v58 offset:64
    s_waitcnt lgkmcnt(2)
    v_mfma_f32_16x16x32_bf16 v[96:99], v[100:103], v[116:119], v[96:99]
    v_mfma_f32_16x16x32_bf16 v[92:95], v[100:103], v[112:115], v[92:95]
    ds_read_b128 v[100:103], v58 offset:576
    s_waitcnt lgkmcnt(2)
    v_mfma_f32_16x16x32_bf16 v[96:99], v[104:107], v[112:115], v[96:99]
    ds_read_b128 v[104:107], v58 offset:1088
    s_waitcnt lgkmcnt(2)
    v_mfma_f32_16x16x32_bf16 v[96:99], v[108:111], v[172:175], v[96:99]
    v_mfma_f32_16x16x32_bf16 v[92:95], v[108:111], v[168:171], v[92:95]
    v_mfma_f32_16x16x32_bf16 v[88:91], v[108:111], v[164:167], v[88:91]
    v_mfma_f32_16x16x32_bf16 v[84:87], v[108:111], v[160:163], v[84:87]
    v_mfma_f32_16x16x32_bf16 v[80:83], v[108:111], v[156:159], v[80:83]
    v_mfma_f32_16x16x32_bf16 v[76:79], v[108:111], v[152:155], v[76:79]
    v_mfma_f32_16x16x32_bf16 v[72:75], v[108:111], v[148:151], v[72:75]
    v_mfma_f32_16x16x32_bf16 v[68:71], v[108:111], v[144:147], v[68:71]
    ds_read_b128 v[108:111], v58 offset:1600
    s_waitcnt lgkmcnt(2)
    v_mfma_f32_16x16x32_bf16 v[96:99], v[100:103], v[168:171], v[96:99]
    v_mfma_f32_16x16x32_bf16 v[92:95], v[100:103], v[164:167], v[92:95]
    v_mfma_f32_16x16x32_bf16 v[88:91], v[100:103], v[160:163], v[88:91]
    v_mfma_f32_16x16x32_bf16 v[84:87], v[100:103], v[156:159], v[84:87]
    v_mfma_f32_16x16x32_bf16 v[80:83], v[100:103], v[152:155], v[80:83]
    v_mfma_f32_16x16x32_bf16 v[76:79], v[100:103], v[148:151], v[76:79]
    v_mfma_f32_16x16x32_bf16 v[72:75], v[100:103], v[144:147], v[72:75]
    ds_read_b128 v[100:103], v58 offset:2112
    s_waitcnt lgkmcnt(2)
    v_mfma_f32_16x16x32_bf16 v[96:99], v[104:107], v[164:167], v[96:99]
    v_mfma_f32_16x16x32_bf16 v[92:95], v[104:107], v[160:163], v[92:95]
    v_mfma_f32_16x16x32_bf16 v[88:91], v[104:107], v[156:159], v[88:91]
    v_mfma_f32_16x16x32_bf16 v[84:87], v[104:107], v[152:155], v[84:87]
    v_mfma_f32_16x16x32_bf16 v[80:83], v[104:107], v[148:151], v[80:83]
    v_mfma_f32_16x16x32_bf16 v[76:79], v[104:107], v[144:147], v[76:79]
    ds_read_b128 v[104:107], v58 offset:2624
    s_waitcnt lgkmcnt(2)
    v_mfma_f32_16x16x32_bf16 v[96:99], v[108:111], v[160:163], v[96:99]
    v_mfma_f32_16x16x32_bf16 v[92:95], v[108:111], v[156:159], v[92:95]
    v_mfma_f32_16x16x32_bf16 v[88:91], v[108:111], v[152:155], v[88:91]
    v_mfma_f32_16x16x32_bf16 v[84:87], v[108:111], v[148:151], v[84:87]
    v_mfma_f32_16x16x32_bf16 v[80:83], v[108:111], v[144:147], v[80:83]
    ds_read_b128 v[108:111], v58 offset:3136
    s_waitcnt lgkmcnt(2)
    v_mfma_f32_16x16x32_bf16 v[96:99], v[100:103], v[156:159], v[96:99]
    v_mfma_f32_16x16x32_bf16 v[92:95], v[100:103], v[152:155], v[92:95]
    v_mfma_f32_16x16x32_bf16 v[88:91], v[100:103], v[148:151], v[88:91]
    v_mfma_f32_16x16x32_bf16 v[84:87], v[100:103], v[144:147], v[84:87]
    ds_read_b128 v[100:103], v58 offset:3648
    s_waitcnt lgkmcnt(2)
    v_mfma_f32_16x16x32_bf16 v[96:99], v[104:107], v[152:155], v[96:99]
    v_mfma_f32_16x16x32_bf16 v[92:95], v[104:107], v[148:151], v[92:95]
    v_mfma_f32_16x16x32_bf16 v[88:91], v[104:107], v[144:147], v[88:91]
    s_waitcnt lgkmcnt(1)
    v_mfma_f32_16x16x32_bf16 v[96:99], v[108:111], v[148:151], v[96:99]
    v_mfma_f32_16x16x32_bf16 v[92:95], v[108:111], v[144:147], v[92:95]
    s_waitcnt lgkmcnt(0)
    v_mfma_f32_16x16x32_bf16 v[96:99], v[100:103], v[144:147], v[96:99]
    ds_write_b128 v66, v[68:71] offset:0
    ds_write_b128 v66, v[72:75] offset:1024
    ds_write_b128 v66, v[76:79] offset:2048
    ds_write_b128 v66, v[80:83] offset:3072
    ds_write_b128 v66, v[84:87] offset:4096
    ds_write_b128 v66, v[88:91] offset:5120
    ds_write_b128 v66, v[92:95] offset:6144
    s_nop 0
    ds_write_b128 v66, v[96:99] offset:7168
    s_branch c_pw_end_9
c_pw_10:
    s_cmp_lg_u32 s34, 1
    s_cbranch_scc1 c_pw_11
    ds_read_b128 v[100:103], v58 offset:128
    ds_read_b128 v[112:115], v59 offset:352
    ds_read_b128 v[116:119], v59 offset:864
    ds_read_b128 v[120:123], v59 offset:1376
    ds_read_b128 v[124:127], v59 offset:1888
    ds_read_b128 v[128:131], v59 offset:2400
    ds_read_b128 v[132:135], v59 offset:2912
    ds_read_b128 v[136:139], v59 offset:3424
    ds_read_b128 v[140:143], v59 offset:3936
    ds_read_b128 v[104:107], v58 offset:640
    ds_read_b128 v[108:111], v58 offset:1152
    s_waitcnt lgkmcnt(2)
    v_mfma_f32_16x16x32_bf16 v[96:99], v[100:103], v[140:143], 0
    v_mfma_f32_16x16x32_bf16 v[92:95], v[100:103], v[136:139], 0
    v_mfma_f32_16x16x32_bf16 v[88:91], v[100:103], v[132:135], 0
    v_mfma_f32_16x16x32_bf16 v[84:87], v[100:103], v[128:131], 0
    v_mfma_f32_16x16x32_bf16 v[80:83], v[100:103], v[124:127], 0
    v_mfma_f32_16x16x32_bf16 v[76:79], v[100:103], v[120:123], 0
    v_mfma_f32_16x16x32_bf16 v[72:75], v[100:103], v[116:119], 0
    v_mfma_f32_16x16x32_bf16 v[68:71], v[100:103], v[112:115], 0
    ds_read_b128 v[100:103], v58 offset:1664
    s_waitcnt lgkmcnt(2)
    v_mfma_f32_16x16x32_bf16 v[96:99], v[104:107], v[136:139], v[96:99]
    v_mfma_f32_16x16x32_bf16 v[92:95], v[104:107], v[132:135], v[92:95]
    v_mfma_f32_16x16x32_bf16 v[88:91], v[104:107], v[128:131], v[88:91]
    v_mfma_f32_16x16x32_bf16 v[84:87], v[104:107], v[124:127], v[84:87]
    v_mfma_f32_16x16x32_bf16 v[80:83], v[104:107], v[120:123], v[80:83]
    v_mfma_f32_16x16x32_bf16 v[76:79], v[104:107], v[116:119], v[76:79]
    v_mfma_f32_16x16x32_bf16 v[72:75], v[104:107], v[112:115], v[72:75]
    ds_read_b128 v[104:107], v58 offset:2176
    ds_read_b128 v[144:147], v59 offset:288
    ds_read_b128 v[148:151], v59 offset:800
    ds_read_b128 v[152:155], v59 offset:1312
    ds_read_b128 v[156:159], v59 offset:1824
    ds_read_b128 v[160:163], v59 offset:2336
    ds_read_b128 v[164:167], v59 offset:2848
    ds_read_b128 v[168:171], v59 offset:3360
    ds_read_b128 v[172:175], v59 offset:3872
    s_waitcnt lgkmcnt(10)
    v_mfma_f32_16x16x32_bf16 v[96:99], v[108:111], v[132:135], v[96:99]
    v_mfma_f32_16x16x32_bf16 v[92:95], v[108:111], v[128:131], v[92:95]
    v_mfma_f32_16x16x32_bf16 v[88:91], v[108:111], v[124:127], v[88:91]
    v_mfma_f32_16x16x32_bf16 v[84:87], v[108:111], v[120:123], v[84:87]
    v_mfma_f32_16x16x32_bf16 v[80:83], v[108:111], v[116:119], v[80:83]
    v_mfma_f32_16x16x32_bf16 v[76:79], v[108:111], v[112:115], v[76:79]
    ds_read_b128 v[108:111], v58 offset:2688
    s_waitcnt lgkmcnt(10)
    v_mfma_f32_16x16x32_bf16 v[96:99], v[100:103], v[128:131], v[96:99]
    v_mfma_f32_16x16x32_bf16 v[92:95], v[100:103], v[124:127], v[92:95]
    v_mfma_f32_16x16x32_bf16 v[88:91], v[100:103], v[120:123], v[88:91]
    v_mfma_f32_16x16x32_bf16 v[84:87], v[100:103], v[116:119], v[84:87]
    v_mfma_f32_16x16x32_bf16 v[80:83], v[100:103], v[112:115], v[80:83]
    ds_read_b128 v[100:103], v58 offset:3200
    s_waitcnt lgkmcnt(10)
    v_mfma_f32_16x16x32_bf16 v[96:99], v[104:107], v[124:127], v[96:99]
    v_mfma_f32_16x16x32_bf16 v[92:95], v[104:107], v[120:123], v[92:95]
    v_mfma_f32_16x16x32_bf16 v[88:91], v[104:107], v[116:119], v[88:91]
    v_mfma_f32_16x16x32_bf16 v[84:87], v[104:107], v[112:115], v[84:87]
    ds_read_b128 v[104:107], v58 offset:3712
    s_waitcnt lgkmcnt(2)
    v_mfma_f32_16x16x32_bf16 v[96:99], v[108:111], v[120:123], v[96:99]
    v_mfma_f32_16x16x32_bf16 v[92:95], v[108:111], v[116:119], v[92:95]
    v_mfma_f32_16x16x32_bf16 v[88:91], v[108:111], v[112:115], v[88:91]
    ds_read_b128 v[108:111], v58 offset:192
    s_waitcnt lgkmcnt(2)
    v_mfma_f32_16x16x32_bf16 v[96:99], v[100:103], v[116:119], v[96:99]
    v_mfma_f32_16x16x32_bf16 v[92:95], v[100:103], v[112:115], v[92:95]
    ds_read_b128 v[100:103], v58 offset:704
    s_waitcnt lgkmcnt(2)
    v_mfma_f32_16x16x32_bf16 v[96:99], v[104:107], v[112:115], v[96:99]
    ds_read_b128 v[104:107], v58 offset:1216
    s_waitcnt lgkmcnt(2)
    v_mfma_f32_16x16x32_bf16 v[96:99], v[108:111], v[172:175], v[96:99]
    v_mfma_f32_16x16x32_bf16 v[92:95], v[108:111], v[168:171], v[92:95]
    v_mfma_f32_16x16x32_bf16 v[88:91], v[108:111], v[164:167], v[88:91]
    v_mfma_f32_16x16x32_bf16 v[84:87], v[108:111], v[160:163], v[84:87]
    v_mfma_f32_16x16x32_bf16 v[80:83], v[108:111], v[156:159], v[80:83]
    v_mfma_f32_16x16x32_bf16 v[76:79], v[108:111], v[152:155], v[76:79]
    v_mfma_f32_16x16x32_bf16 v[72:75], v[108:111], v[148:151], v[72:75]
    v_mfma_f32_16x16x32_bf16 v[68:71], v[108:111], v[144:147], v[68:71]
    ds_read_b128 v[108:111], v58 offset:1728
    s_waitcnt lgkmcnt(2)
    v_mfma_f32_16x16x32_bf16 v[96:99], v[100:103], v[168:171], v[96:99]
    v_mfma_f32_16x16x32_bf16 v[92:95], v[100:103], v[164:167], v[92:95]
    v_mfma_f32_16x16x32_bf16 v[88:91], v[100:103], v[160:163], v[88:91]
    v_mfma_f32_16x16x32_bf16 v[84:87], v[100:103], v[156:159], v[84:87]
    v_mfma_f32_16x16x32_bf16 v[80:83], v[100:103], v[152:155], v[80:83]
    v_mfma_f32_16x16x32_bf16 v[76:79], v[100:103], v[148:151], v[76:79]
    v_mfma_f32_16x16x32_bf16 v[72:75], v[100:103], v[144:147], v[72:75]
    ds_read_b128 v[100:103], v58 offset:2240
    s_waitcnt lgkmcnt(2)
    v_mfma_f32_16x16x32_bf16 v[96:99], v[104:107], v[164:167], v[96:99]
    v_mfma_f32_16x16x32_bf16 v[92:95], v[104:107], v[160:163], v[92:95]
    v_mfma_f32_16x16x32_bf16 v[88:91], v[104:107], v[156:159], v[88:91]
    v_mfma_f32_16x16x32_bf16 v[84:87], v[104:107], v[152:155], v[84:87]
    v_mfma_f32_16x16x32_bf16 v[80:83], v[104:107], v[148:151], v[80:83]
    v_mfma_f32_16x16x32_bf16 v[76:79], v[104:107], v[144:147], v[76:79]
    ds_read_b128 v[104:107], v58 offset:2752
    s_waitcnt lgkmcnt(2)
    v_mfma_f32_16x16x32_bf16 v[96:99], v[108:111], v[160:163], v[96:99]
    v_mfma_f32_16x16x32_bf16 v[92:95], v[108:111], v[156:159], v[92:95]
    v_mfma_f32_16x16x32_bf16 v[88:91], v[108:111], v[152:155], v[88:91]
    v_mfma_f32_16x16x32_bf16 v[84:87], v[108:111], v[148:151], v[84:87]
    v_mfma_f32_16x16x32_bf16 v[80:83], v[108:111], v[144:147], v[80:83]
    ds_read_b128 v[108:111], v58 offset:3264
    s_waitcnt lgkmcnt(2)
    v_mfma_f32_16x16x32_bf16 v[96:99], v[100:103], v[156:159], v[96:99]
    v_mfma_f32_16x16x32_bf16 v[92:95], v[100:103], v[152:155], v[92:95]
    v_mfma_f32_16x16x32_bf16 v[88:91], v[100:103], v[148:151], v[88:91]
    v_mfma_f32_16x16x32_bf16 v[84:87], v[100:103], v[144:147], v[84:87]
    ds_read_b128 v[100:103], v58 offset:3776
    s_waitcnt lgkmcnt(2)
    v_mfma_f32_16x16x32_bf16 v[96:99], v[104:107], v[152:155], v[96:99]
    v_mfma_f32_16x16x32_bf16 v[92:95], v[104:107], v[148:151], v[92:95]
    v_mfma_f32_16x16x32_bf16 v[88:91], v[104:107], v[144:147], v[88:91]
    s_waitcnt lgkmcnt(1)
    v_mfma_f32_16x16x32_bf16 v[96:99], v[108:111], v[148:151], v[96:99]
    v_mfma_f32_16x16x32_bf16 v[92:95], v[108:111], v[144:147], v[92:95]
    s_waitcnt lgkmcnt(0)
    v_mfma_f32_16x16x32_bf16 v[96:99], v[100:103], v[144:147], v[96:99]
    ds_write_b128 v66, v[68:71] offset:0
    ds_write_b128 v66, v[72:75] offset:1024
    ds_write_b128 v66, v[76:79] offset:2048
    ds_write_b128 v66, v[80:83] offset:3072
    ds_write_b128 v66, v[84:87] offset:4096
    ds_write_b128 v66, v[88:91] offset:5120
    ds_write_b128 v66, v[92:95] offset:6144
    s_nop 0
    ds_write_b128 v66, v[96:99] offset:7168
    s_branch c_pw_end_9
c_pw_11:
    s_cmp_lg_u32 s34, 2
    s_cbranch_scc1 c_pw_12
    ds_read_b128 v[100:103], v58 offset:256
    ds_read_b128 v[112:115], v59 offset:224
    ds_read_b128 v[116:119], v59 offset:736
    ds_read_b128 v[120:123], v59 offset:1248
    ds_read_b128 v[124:127], v59 offset:1760
    ds_read_b128 v[128:131], v59 offset:2272
    ds_read_b128 v[132:135], v59 offset:2784
    ds_read_b128 v[136:139], v59 offset:3296
    ds_read_b128 v[140:143], v59 offset:3808
    ds_read_b128 v[104:107], v58 offset:768
    ds_read_b128 v[108:111], v58 offset:1280
    s_waitcnt lgkmcnt(2)
    v_mfma_f32_16x16x32_bf16 v[96:99], v[100:103], v[140:143], 0
    v_mfma_f32_16x16x32_bf16 v[92:95], v[100:103], v[136:139], 0
    v_mfma_f32_16x16x32_bf16 v[88:91], v[100:103], v[132:135], 0
    v_mfma_f32_16x16x32_bf16 v[84:87], v[100:103], v[128:131], 0
    v_mfma_f32_16x16x32_bf16 v[80:83], v[100:103], v[124:127], 0
    v_mfma_f32_16x16x32_bf16 v[76:79], v[100:103], v[120:123], 0
    v_mfma_f32_16x16x32_bf16 v[72:75], v[100:103], v[116:119], 0
    v_mfma_f32_16x16x32_bf16 v[68:71], v[100:103], v[112:115], 0
    ds_read_b128 v[100:103], v58 offset:1792
    s_waitcnt lgkmcnt(2)
    v_mfma_f32_16x16x32_bf16 v[96:99], v[104:107], v[136:139], v[96:99]
    v_mfma_f32_16x16x32_bf16 v[92:95], v[104:107], v[132:135], v[92:95]
    v_mfma_f32_16x16x32_bf16 v[88:91], v[104:107], v[128:131], v[88:91]
    v_mfma_f32_16x16x32_bf16 v[84:87], v[104:107], v[124:127], v[84:87]
    v_mfma_f32_16x16x32_bf16 v[80:83], v[104:107], v[120:123], v[80:83]
    v_mfma_f32_16x16x32_bf16 v[76:79], v[104:107], v[116:119], v[76:79]
    v_mfma_f32_16x16x32_bf16 v[72:75], v[104:107], v[112:115], v[72:75]
    ds_read_b128 v[104:107], v58 offset:2304
    ds_read_b128 v[144:147], v59 offset:160
    ds_read_b128 v[148:151], v59 offset:672
    ds_read_b128 v[152:155], v59 offset:1184
    ds_read_b128 v[156:159], v59 offset:1696
    ds_read_b128 v[160:163], v59 offset:2208
    ds_read_b128 v[164:167], v59 offset:2720
    ds_read_b128 v[168:171], v59 offset:3232
    ds_read_b128 v[172:175], v59 offset:3744
    s_waitcnt lgkmcnt(10)
    v_mfma_f32_16x16x32_bf16 v[96:99], v[108:111], v[132:135], v[96:99]
    v_mfma_f32_16x16x32_bf16 v[92:95], v[108:111], v[128:131], v[92:95]
    v_mfma_f32_16x16x32_bf16 v[88:91], v[108:111], v[124:127], v[88:91]
    v_mfma_f32_16x16x32_bf16 v[84:87], v[108:111], v[120:123], v[84:87]
    v_mfma_f32_16x16x32_bf16 v[80:83], v[108:111], v[116:119], v[80:83]
    v_mfma_f32_16x16x32_bf16 v[76:79], v[108:111], v[112:115], v[76:79]
    ds_read_b128 v[108:111], v58 offset:2816
    s_waitcnt lgkmcnt(10)
    v_mfma_f32_16x16x32_bf16 v[96:99], v[100:103], v[128:131], v[96:99]
    v_mfma_f32_16x16x32_bf16 v[92:95], v[100:103], v[124:127], v[92:95]
    v_mfma_f32_16x16x32_bf16 v[88:91], v[100:103], v[120:123], v[88:91]
    v_mfma_f32_16x16x32_bf16 v[84:87], v[100:103], v[116:119], v[84:87]
    v_mfma_f32_16x16x32_bf16 v[80:83], v[100:103], v[112:115], v[80:83]
    ds_read_b128 v[100:103], v58 offset:3328
    s_waitcnt lgkmcnt(10)
    v_mfma_f32_16x16x32_bf16 v[96:99], v[104:107], v[124:127], v[96:99]
    v_mfma_f32_16x16x32_bf16 v[92:95], v[104:107], v[120:123], v[92:95]
    v_mfma_f32_16x16x32_bf16 v[88:91], v[104:107], v[116:119], v[88:91]
    v_mfma_f32_16x16x32_bf16 v[84:87], v[104:107], v[112:115], v[84:87]
    ds_read_b128 v[104:107], v58 offset:3840
    s_waitcnt lgkmcnt(2)
    v_mfma_f32_16x16x32_bf16 v[96:99], v[108:111], v[120:123], v[96:99]
    v_mfma_f32_16x16x32_bf16 v[92:95], v[108:111], v[116:119], v[92:95]
    v_mfma_f32_16x16x32_bf16 v[88:91], v[108:111], v[112:115], v[88:91]
    ds_read_b128 v[108:111], v58 offset:320
    s_waitcnt lgkmcnt(2)
    v_mfma_f32_16x16x32_bf16 v[96:99], v[100:103], v[116:119], v[96:99]
    v_mfma_f32_16x16x32_bf16 v[92:95], v[100:103], v[112:115], v[92:95]
    ds_read_b128 v[100:103], v58 offset:832
    s_waitcnt lgkmcnt(2)
    v_mfma_f32_16x16x32_bf16 v[96:99], v[104:107], v[112:115], v[96:99]
    ds_read_b128 v[104:107], v58 offset:1344
    s_waitcnt lgkmcnt(2)
    v_mfma_f32_16x16x32_bf16 v[96:99], v[108:111], v[172:175], v[96:99]
    v_mfma_f32_16x16x32_bf16 v[92:95], v[108:111], v[168:171], v[92:95]
    v_mfma_f32_16x16x32_bf16 v[88:91], v[108:111], v[164:167], v[88:91]
    v_mfma_f32_16x16x32_bf16 v[84:87], v[108:111], v[160:163], v[84:87]
    v_mfma_f32_16x16x32_bf16 v[80:83], v[108:111], v[156:159], v[80:83]
    v_mfma_f32_16x16x32_bf16 v[76:79], v[108:111], v[152:155], v[76:79]
    v_mfma_f32_16x16x32_bf16 v[72:75], v[108:111], v[148:151], v[72:75]
    v_mfma_f32_16x16x32_bf16 v[68:71], v[108:111], v[144:147], v[68:71]
    ds_read_b128 v[108:111], v58 offset:1856
    s_waitcnt lgkmcnt(2)
    v_mfma_f32_16x16x32_bf16 v[96:99], v[100:103], v[168:171], v[96:99]
    v_mfma_f32_16x16x32_bf16 v[92:95], v[100:103], v[164:167], v[92:95]
    v_mfma_f32_16x16x32_bf16 v[88:91], v[100:103], v[160:163], v[88:91]
    v_mfma_f32_16x16x32_bf16 v[84:87], v[100:103], v[156:159], v[84:87]
    v_mfma_f32_16x16x32_bf16 v[80:83], v[100:103], v[152:155], v[80:83]
    v_mfma_f32_16x16x32_bf16 v[76:79], v[100:103], v[148:151], v[76:79]
    v_mfma_f32_16x16x32_bf16 v[72:75], v[100:103], v[144:147], v[72:75]
    ds_read_b128 v[100:103], v58 offset:2368
    s_waitcnt lgkmcnt(2)
    v_mfma_f32_16x16x32_bf16 v[96:99], v[104:107], v[164:167], v[96:99]
    v_mfma_f32_16x16x32_bf16 v[92:95], v[104:107], v[160:163], v[92:95]
    v_mfma_f32_16x16x32_bf16 v[88:91], v[104:107], v[156:159], v[88:91]
    v_mfma_f32_16x16x32_bf16 v[84:87], v[104:107], v[152:155], v[84:87]
    v_mfma_f32_16x16x32_bf16 v[80:83], v[104:107], v[148:151], v[80:83]
    v_mfma_f32_16x16x32_bf16 v[76:79], v[104:107], v[144:147], v[76:79]
    ds_read_b128 v[104:107], v58 offset:2880
    s_waitcnt lgkmcnt(2)
    v_mfma_f32_16x16x32_bf16 v[96:99], v[108:111], v[160:163], v[96:99]
    v_mfma_f32_16x16x32_bf16 v[92:95], v[108:111], v[156:159], v[92:95]
    v_mfma_f32_16x16x32_bf16 v[88:91], v[108:111], v[152:155], v[88:91]
    v_mfma_f32_16x16x32_bf16 v[84:87], v[108:111], v[148:151], v[84:87]
    v_mfma_f32_16x16x32_bf16 v[80:83], v[108:111], v[144:147], v[80:83]
    ds_read_b128 v[108:111], v58 offset:3392
    s_waitcnt lgkmcnt(2)
    v_mfma_f32_16x16x32_bf16 v[96:99], v[100:103], v[156:159], v[96:99]
    v_mfma_f32_16x16x32_bf16 v[92:95], v[100:103], v[152:155], v[92:95]
    v_mfma_f32_16x16x32_bf16 v[88:91], v[100:103], v[148:151], v[88:91]
    v_mfma_f32_16x16x32_bf16 v[84:87], v[100:103], v[144:147], v[84:87]
    ds_read_b128 v[100:103], v58 offset:3904
    s_waitcnt lgkmcnt(2)
    v_mfma_f32_16x16x32_bf16 v[96:99], v[104:107], v[152:155], v[96:99]
    v_mfma_f32_16x16x32_bf16 v[92:95], v[104:107], v[148:151], v[92:95]
    v_mfma_f32_16x16x32_bf16 v[88:91], v[104:107], v[144:147], v[88:91]
    s_waitcnt lgkmcnt(1)
    v_mfma_f32_16x16x32_bf16 v[96:99], v[108:111], v[148:151], v[96:99]
    v_mfma_f32_16x16x32_bf16 v[92:95], v[108:111], v[144:147], v[92:95]
    s_waitcnt lgkmcnt(0)
    v_mfma_f32_16x16x32_bf16 v[96:99], v[100:103], v[144:147], v[96:99]
    ds_write_b128 v66, v[68:71] offset:0
    ds_write_b128 v66, v[72:75] offset:1024
    ds_write_b128 v66, v[76:79] offset:2048
    ds_write_b128 v66, v[80:83] offset:3072
    ds_write_b128 v66, v[84:87] offset:4096
    ds_write_b128 v66, v[88:91] offset:5120
    ds_write_b128 v66, v[92:95] offset:6144
    s_nop 0
    ds_write_b128 v66, v[96:99] offset:7168
    s_branch c_pw_end_9
c_pw_12:
    ds_read_b128 v[100:103], v58 offset:384
    ds_read_b128 v[112:115], v59 offset:96
    ds_read_b128 v[116:119], v59 offset:608
    ds_read_b128 v[120:123], v59 offset:1120
    ds_read_b128 v[124:127], v59 offset:1632
    ds_read_b128 v[128:131], v59 offset:2144
    ds_read_b128 v[132:135], v59 offset:2656
    ds_read_b128 v[136:139], v59 offset:3168
    ds_read_b128 v[140:143], v59 offset:3680
    ds_read_b128 v[104:107], v58 offset:896
    ds_read_b128 v[108:111], v58 offset:1408
    s_waitcnt lgkmcnt(2)
    v_mfma_f32_16x16x32_bf16 v[96:99], v[100:103], v[140:143], 0
    v_mfma_f32_16x16x32_bf16 v[92:95], v[100:103], v[136:139], 0
    v_mfma_f32_16x16x32_bf16 v[88:91], v[100:103], v[132:135], 0
    v_mfma_f32_16x16x32_bf16 v[84:87], v[100:103], v[128:131], 0
    v_mfma_f32_16x16x32_bf16 v[80:83], v[100:103], v[124:127], 0
    v_mfma_f32_16x16x32_bf16 v[76:79], v[100:103], v[120:123], 0
    v_mfma_f32_16x16x32_bf16 v[72:75], v[100:103], v[116:119], 0
    v_mfma_f32_16x16x32_bf16 v[68:71], v[100:103], v[112:115], 0
    ds_read_b128 v[100:103], v58 offset:1920
    s_waitcnt lgkmcnt(2)
    v_mfma_f32_16x16x32_bf16 v[96:99], v[104:107], v[136:139], v[96:99]
    v_mfma_f32_16x16x32_bf16 v[92:95], v[104:107], v[132:135], v[92:95]
    v_mfma_f32_16x16x32_bf16 v[88:91], v[104:107], v[128:131], v[88:91]
    v_mfma_f32_16x16x32_bf16 v[84:87], v[104:107], v[124:127], v[84:87]
    v_mfma_f32_16x16x32_bf16 v[80:83], v[104:107], v[120:123], v[80:83]
    v_mfma_f32_16x16x32_bf16 v[76:79], v[104:107], v[116:119], v[76:79]
    v_mfma_f32_16x16x32_bf16 v[72:75], v[104:107], v[112:115], v[72:75]
    ds_read_b128 v[104:107], v58 offset:2432
    ds_read_b128 v[144:147], v59 offset:32
    ds_read_b128 v[148:151], v59 offset:544
    ds_read_b128 v[152:155], v59 offset:1056
    ds_read_b128 v[156:159], v59 offset:1568
    ds_read_b128 v[160:163], v59 offset:2080
    ds_read_b128 v[164:167], v59 offset:2592
    ds_read_b128 v[168:171], v59 offset:3104
    ds_read_b128 v[172:175], v59 offset:3616
    s_waitcnt lgkmcnt(10)
    v_mfma_f32_16x16x32_bf16 v[96:99], v[108:111], v[132:135], v[96:99]
    v_mfma_f32_16x16x32_bf16 v[92:95], v[108:111], v[128:131], v[92:95]
    v_mfma_f32_16x16x32_bf16 v[88:91], v[108:111], v[124:127], v[88:91]
    v_mfma_f32_16x16x32_bf16 v[84:87], v[108:111], v[120:123], v[84:87]
    v_mfma_f32_16x16x32_bf16 v[80:83], v[108:111], v[116:119], v[80:83]
    v_mfma_f32_16x16x32_bf16 v[76:79], v[108:111], v[112:115], v[76:79]
    ds_read_b128 v[108:111], v58 offset:2944
    s_waitcnt lgkmcnt(10)
    v_mfma_f32_16x16x32_bf16 v[96:99], v[100:103], v[128:131], v[96:99]
    v_mfma_f32_16x16x32_bf16 v[92:95], v[100:103], v[124:127], v[92:95]
    v_mfma_f32_16x16x32_bf16 v[88:91], v[100:103], v[120:123], v[88:91]
    v_mfma_f32_16x16x32_bf16 v[84:87], v[100:103], v[116:119], v[84:87]
    v_mfma_f32_16x16x32_bf16 v[80:83], v[100:103], v[112:115], v[80:83]
    ds_read_b128 v[100:103], v58 offset:3456
    s_waitcnt lgkmcnt(10)
    v_mfma_f32_16x16x32_bf16 v[96:99], v[104:107], v[124:127], v[96:99]
    v_mfma_f32_16x16x32_bf16 v[92:95], v[104:107], v[120:123], v[92:95]
    v_mfma_f32_16x16x32_bf16 v[88:91], v[104:107], v[116:119], v[88:91]
    v_mfma_f32_16x16x32_bf16 v[84:87], v[104:107], v[112:115], v[84:87]
    ds_read_b128 v[104:107], v58 offset:3968
    s_waitcnt lgkmcnt(2)
    v_mfma_f32_16x16x32_bf16 v[96:99], v[108:111], v[120:123], v[96:99]
    v_mfma_f32_16x16x32_bf16 v[92:95], v[108:111], v[116:119], v[92:95]
    v_mfma_f32_16x16x32_bf16 v[88:91], v[108:111], v[112:115], v[88:91]
    ds_read_b128 v[108:111], v58 offset:448
    s_waitcnt lgkmcnt(2)
    v_mfma_f32_16x16x32_bf16 v[96:99], v[100:103], v[116:119], v[96:99]
    v_mfma_f32_16x16x32_bf16 v[92:95], v[100:103], v[112:115], v[92:95]
    ds_read_b128 v[100:103], v58 offset:960
    s_waitcnt lgkmcnt(2)
    v_mfma_f32_16x16x32_bf16 v[96:99], v[104:107], v[112:115], v[96:99]
    ds_read_b128 v[104:107], v58 offset:1472
    s_waitcnt lgkmcnt(2)
    v_mfma_f32_16x16x32_bf16 v[96:99], v[108:111], v[172:175], v[96:99]
    v_mfma_f32_16x16x32_bf16 v[92:95], v[108:111], v[168:171], v[92:95]
    v_mfma_f32_16x16x32_bf16 v[88:91], v[108:111], v[164:167], v[88:91]
    v_mfma_f32_16x16x32_bf16 v[84:87], v[108:111], v[160:163], v[84:87]
    v_mfma_f32_16x16x32_bf16 v[80:83], v[108:111], v[156:159], v[80:83]
    v_mfma_f32_16x16x32_bf16 v[76:79], v[108:111], v[152:155], v[76:79]
    v_mfma_f32_16x16x32_bf16 v[72:75], v[108:111], v[148:151], v[72:75]
    v_mfma_f32_16x16x32_bf16 v[68:71], v[108:111], v[144:147], v[68:71]
    ds_read_b128 v[108:111], v58 offset:1984
    s_waitcnt lgkmcnt(2)
    v_mfma_f32_16x16x32_bf16 v[96:99], v[100:103], v[168:171], v[96:99]
    v_mfma_f32_16x16x32_bf16 v[92:95], v[100:103], v[164:167], v[92:95]
    v_mfma_f32_16x16x32_bf16 v[88:91], v[100:103], v[160:163], v[88:91]
    v_mfma_f32_16x16x32_bf16 v[84:87], v[100:103], v[156:159], v[84:87]
    v_mfma_f32_16x16x32_bf16 v[80:83], v[100:103], v[152:155], v[80:83]
    v_mfma_f32_16x16x32_bf16 v[76:79], v[100:103], v[148:151], v[76:79]
    v_mfma_f32_16x16x32_bf16 v[72:75], v[100:103], v[144:147], v[72:75]
    ds_read_b128 v[100:103], v58 offset:2496
    s_waitcnt lgkmcnt(2)
    v_mfma_f32_16x16x32_bf16 v[96:99], v[104:107], v[164:167], v[96:99]
    v_mfma_f32_16x16x32_bf16 v[92:95], v[104:107], v[160:163], v[92:95]
    v_mfma_f32_16x16x32_bf16 v[88:91], v[104:107], v[156:159], v[88:91]
    v_mfma_f32_16x16x32_bf16 v[84:87], v[104:107], v[152:155], v[84:87]
    v_mfma_f32_16x16x32_bf16 v[80:83], v[104:107], v[148:151], v[80:83]
    v_mfma_f32_16x16x32_bf16 v[76:79], v[104:107], v[144:147], v[76:79]
    ds_read_b128 v[104:107], v58 offset:3008
    s_waitcnt lgkmcnt(2)
    v_mfma_f32_16x16x32_bf16 v[96:99], v[108:111], v[160:163], v[96:99]
    v_mfma_f32_16x16x32_bf16 v[92:95], v[108:111], v[156:159], v[92:95]
    v_mfma_f32_16x16x32_bf16 v[88:91], v[108:111], v[152:155], v[88:91]
    v_mfma_f32_16x16x32_bf16 v[84:87], v[108:111], v[148:151], v[84:87]
    v_mfma_f32_16x16x32_bf16 v[80:83], v[108:111], v[144:147], v[80:83]
    ds_read_b128 v[108:111], v58 offset:3520
    s_waitcnt lgkmcnt(2)
    v_mfma_f32_16x16x32_bf16 v[96:99], v[100:103], v[156:159], v[96:99]
    v_mfma_f32_16x16x32_bf16 v[92:95], v[100:103], v[152:155], v[92:95]
    v_mfma_f32_16x16x32_bf16 v[88:91], v[100:103], v[148:151], v[88:91]
    v_mfma_f32_16x16x32_bf16 v[84:87], v[100:103], v[144:147], v[84:87]
    ds_read_b128 v[100:103], v58 offset:4032
    s_waitcnt lgkmcnt(2)
    v_mfma_f32_16x16x32_bf16 v[96:99], v[104:107], v[152:155], v[96:99]
    v_mfma_f32_16x16x32_bf16 v[92:95], v[104:107], v[148:151], v[92:95]
    v_mfma_f32_16x16x32_bf16 v[88:91], v[104:107], v[144:147], v[88:91]
    s_waitcnt lgkmcnt(1)
    v_mfma_f32_16x16x32_bf16 v[96:99], v[108:111], v[148:151], v[96:99]
    v_mfma_f32_16x16x32_bf16 v[92:95], v[108:111], v[144:147], v[92:95]
    s_waitcnt lgkmcnt(0)
    v_mfma_f32_16x16x32_bf16 v[96:99], v[100:103], v[144:147], v[96:99]
    ds_write_b128 v66, v[68:71] offset:0
    ds_write_b128 v66, v[72:75] offset:1024
    ds_write_b128 v66, v[76:79] offset:2048
    ds_write_b128 v66, v[80:83] offset:3072
    ds_write_b128 v66, v[84:87] offset:4096
    ds_write_b128 v66, v[88:91] offset:5120
    ds_write_b128 v66, v[92:95] offset:6144
    s_nop 0
    ds_write_b128 v66, v[96:99] offset:7168
c_pw_end_9:
    s_waitcnt lgkmcnt(0)
    s_barrier
    ds_read_b128 v[112:115], v67 offset:0
    ds_read_b128 v[116:119], v67 offset:16
    ds_read_b128 v[120:123], v67 offset:8192
    ds_read_b128 v[124:127], v67 offset:8208
    ds_read_b128 v[128:131], v67 offset:16384
    ds_read_b128 v[132:135], v67 offset:16400
    ds_read_b128 v[136:139], v67 offset:24576
    ds_read_b128 v[140:143], v67 offset:24592
    s_lshl_b32 s40, s56, 12
    s_add_u32 s40, s40, 8912896
    s_waitcnt lgkmcnt(0)
    v_pk_add_f32 v[112:113], v[112:113], v[120:121]
    v_pk_add_f32 v[128:129], v[128:129], v[136:137]
    v_pk_add_f32 v[114:115], v[114:115], v[122:123]
    v_pk_add_f32 v[130:131], v[130:131], v[138:139]
    v_pk_add_f32 v[116:117], v[116:117], v[124:125]
    v_pk_add_f32 v[132:133], v[132:133], v[140:141]
    v_pk_add_f32 v[118:119], v[118:119], v[126:127]
    v_pk_add_f32 v[134:135], v[134:135], v[142:143]
    v_pk_add_f32 v[112:113], v[112:113], v[128:129]
    v_pk_add_f32 v[114:115], v[114:115], v[130:131]
    v_pk_add_f32 v[116:117], v[116:117], v[132:133]
    v_pk_add_f32 v[118:119], v[118:119], v[134:135]
    v_cvt_pk_bf16_f32 v184, v112, v113
    v_cvt_pk_bf16_f32 v185, v114, v115
    v_cvt_pk_bf16_f32 v186, v116, v117
    v_cvt_pk_bf16_f32 v187, v118, v119
    buffer_store_dwordx4 v[184:187], v2, s[8:11], s40 offen sc1
    s_nop 1
    s_waitcnt vmcnt(4)
    v_cmp_ne_u32 vcc, 0, v0
    s_nop 1
    v_cndmask_b32 v16, 0, v16, vcc
    v_cndmask_b32 v17, 0, v17, vcc
    v_cndmask_b32 v18, 0, v18, vcc
    v_cndmask_b32 v19, 0, v19, vcc
    v_alignbit_b32 v176, v17, v16, 16
    v_alignbit_b32 v177, v18, v17, 16
    v_alignbit_b32 v178, v19, v18, 16
    v_alignbit_b32 v179, v20, v19, 16
    v_alignbit_b32 v180, v21, v20, 16
    v_alignbit_b32 v181, v22, v21, 16
    v_alignbit_b32 v182, v23, v22, 16
    ds_write_b128 v56, v[176:179] offset:0
    v_mov_b32 v184, v17
    v_mov_b32 v185, v18
    v_mov_b32 v186, v19
    v_mov_b32 v187, v20
    ds_write_b128 v56, v[184:187] offset:4160
    s_nop 1
    v_mov_b32 v184, v177
    v_mov_b32 v185, v178
    v_mov_b32 v186, v179
    v_mov_b32 v187, v180
    ds_write_b128 v56, v[184:187] offset:8320
    s_nop 1
    ds_write_b128 v56, v[18:21] offset:12480
    ds_write_b128 v56, v[178:181] offset:16640
    v_mov_b32 v184, v19
    v_mov_b32 v185, v20
    v_mov_b32 v186, v21
    v_mov_b32 v187, v22
    ds_write_b128 v56, v[184:187] offset:20800
    s_nop 1
    v_mov_b32 v184, v179
    v_mov_b32 v185, v180
    v_mov_b32 v186, v181
    v_mov_b32 v187, v182
    ds_write_b128 v56, v[184:187] offset:24960
    s_nop 1
    ds_write_b128 v56, v[20:23] offset:29120
    ds_write_b128 v57, v[36:39]
    v_lshlrev_b32 v3, 16, v45
    v_or_b32 v3, v3, v45
    v_and_b32 v188, v60, v3
    v_and_b32 v189, v61, v3
    v_and_b32 v190, v62, v3
    v_and_b32 v191, v63, v3
    s_waitcnt lgkmcnt(0)
    s_barrier
    s_cmp_ge_u32 s2, 192
    s_cbranch_scc1 c_wj3_14
    v_lshrrev_b32 v3, 4, v1
    v_and_b32 v5, 15, v1
    v_lshrrev_b32 v4, 2, v5
    v_lshl_add_u32 v3, v3, 2, v4
    v_mul_u32_u24 v3, 160, v3
    v_and_b32 v4, 3, v5
    v_lshl_add_u32 v3, v4, 3, v3
    v_lshlrev_b32 v5, 4, v1
    s_lshl_b32 s40, s34, 5
    s_add_u32 s41, s40, 70656
    v_add_u32 v4, s41, v3
    ds_read_b64_tr_b16 v[184:185], v4
    ds_read_b64_tr_b16 v[186:187], v4 offset:2560
    s_mul_i32 s41, s2, 5120
    s_lshl_b32 s40, s40, 5
    s_add_u32 s41, s41, s40
    s_add_u32 s41, s41, 15007744
    s_waitcnt lgkmcnt(0)
    buffer_store_dwordx4 v[184:187], v5, s[8:11], s41 offen sc1
    s_nop 1
    s_cmp_lg_u32 s34, 0
    s_cbranch_scc1 c_wj4_15
    s_mov_b32 s40, 128
    s_add_u32 s41, s40, 70656
    v_add_u32 v4, s41, v3
    ds_read_b64_tr_b16 v[184:185], v4
    ds_read_b64_tr_b16 v[186:187], v4 offset:2560
    s_mul_i32 s41, s2, 5120
    s_lshl_b32 s40, s40, 5
    s_add_u32 s41, s41, s40
    s_add_u32 s41, s41, 15007744
    s_waitcnt lgkmcnt(0)
    buffer_store_dwordx4 v[184:187], v5, s[8:11], s41 offen sc1
    s_nop 1
c_wj4_15:
c_wj3_14:
    s_cmp_lg_u32 s34, 0
    s_cbranch_scc1 c_pw_17
    ds_read_b128 v[100:103], v58 offset:0
    ds_read_b128 v[112:115], v59 offset:480
    ds_read_b128 v[116:119], v59 offset:992
    ds_read_b128 v[120:123], v59 offset:1504
    ds_read_b128 v[124:127], v59 offset:2016
    ds_read_b128 v[128:131], v59 offset:2528
    ds_read_b128 v[132:135], v59 offset:3040
    ds_read_b128 v[136:139], v59 offset:3552
    ds_read_b128 v[140:143], v59 offset:4064
    ds_read_b128 v[104:107], v58 offset:512
    ds_read_b128 v[108:111], v58 offset:1024
    s_waitcnt lgkmcnt(2)
    v_mfma_f32_16x16x32_bf16 v[96:99], v[100:103], v[140:143], 0
    v_mfma_f32_16x16x32_bf16 v[92:95], v[100:103], v[136:139], 0
    v_mfma_f32_16x16x32_bf16 v[88:91], v[100:103], v[132:135], 0
    v_mfma_f32_16x16x32_bf16 v[84:87], v[100:103], v[128:131], 0
    v_mfma_f32_16x16x32_bf16 v[80:83], v[100:103], v[124:127], 0
    v_mfma_f32_16x16x32_bf16 v[76:79], v[100:103], v[120:123], 0
    v_mfma_f32_16x16x32_bf16 v[72:75], v[100:103], v[116:119], 0
    v_mfma_f32_16x16x32_bf16 v[68:71], v[100:103], v[112:115], 0
    v_mfma_f32_16x16x32_bf16 v[68:71], v[188:191], v[112:115], v[68:71]
    v_mfma_f32_16x16x32_bf16 v[72:75], v[188:191], v[116:119], v[72:75]
    v_mfma_f32_16x16x32_bf16 v[76:79], v[188:191], v[120:123], v[76:79]
    v_mfma_f32_16x16x32_bf16 v[80:83], v[188:191], v[124:127], v[80:83]
    v_mfma_f32_16x16x32_bf16 v[84:87], v[188:191], v[128:131], v[84:87]
    v_mfma_f32_16x16x32_bf16 v[88:91], v[188:191], v[132:135], v[88:91]
    v_mfma_f32_16x16x32_bf16 v[92:95], v[188:191], v[136:139], v[92:95]
    v_mfma_f32_16x16x32_bf16 v[96:99], v[188:191], v[140:143], v[96:99]
    ds_read_b128 v[100:103], v58 offset:1536
    s_waitcnt lgkmcnt(2)
    v_mfma_f32_16x16x32_bf16 v[96:99], v[104:107], v[136:139], v[96:99]
    v_mfma_f32_16x16x32_bf16 v[92:95], v[104:107], v[132:135], v[92:95]
    v_mfma_f32_16x16x32_bf16 v[88:91], v[104:107], v[128:131], v[88:91]
    v_mfma_f32_16x16x32_bf16 v[84:87], v[104:107], v[124:127], v[84:87]
    v_mfma_f32_16x16x32_bf16 v[80:83], v[104:107], v[120:123], v[80:83]
    v_mfma_f32_16x16x32_bf16 v[76:79], v[104:107], v[116:119], v[76:79]
    v_mfma_f32_16x16x32_bf16 v[72:75], v[104:107], v[112:115], v[72:75]
    ds_read_b128 v[104:107], v58 offset:2048
    ds_read_b128 v[144:147], v59 offset:416
    ds_read_b128 v[148:151], v59 offset:928
    ds_read_b128 v[152:155], v59 offset:1440
    ds_read_b128 v[156:159], v59 offset:1952
    ds_read_b128 v[160:163], v59 offset:2464
    ds_read_b128 v[164:167], v59 offset:2976
    ds_read_b128 v[168:171], v59 offset:3488
    ds_read_b128 v[172:175], v59 offset:4000
    s_waitcnt lgkmcnt(10)
    v_mfma_f32_16x16x32_bf16 v[96:99], v[108:111], v[132:135], v[96:99]
    v_mfma_f32_16x16x32_bf16 v[92:95], v[108:111], v[128:131], v[92:95]
    v_mfma_f32_16x16x32_bf16 v[88:91], v[108:111], v[124:127], v[88:91]
    v_mfma_f32_16x16x32_bf16 v[84:87], v[108:111], v[120:123], v[84:87]
    v_mfma_f32_16x16x32_bf16 v[80:83], v[108:111], v[116:119], v[80:83]
    v_mfma_f32_16x16x32_bf16 v[76:79], v[108:111], v[112:115], v[76:79]
    ds_read_b128 v[108:111], v58 offset:2560
    s_waitcnt lgkmcnt(10)
    v_mfma_f32_16x16x32_bf16 v[96:99], v[100:103], v[128:131], v[96:99]
    v_mfma_f32_16x16x32_bf16 v[92:95], v[100:103], v[124:127], v[92:95]
    v_mfma_f32_16x16x32_bf16 v[88:91], v[100:103], v[120:123], v[88:91]
    v_mfma_f32_16x16x32_bf16 v[84:87], v[100:103], v[116:119], v[84:87]
    v_mfma_f32_16x16x32_bf16 v[80:83], v[100:103], v[112:115], v[80:83]
    ds_read_b128 v[100:103], v58 offset:3072
    s_waitcnt lgkmcnt(10)
    v_mfma_f32_16x16x32_bf16 v[96:99], v[104:107], v[124:127], v[96:99]
    v_mfma_f32_16x16x32_bf16 v[92:95], v[104:107], v[120:123], v[92:95]
    v_mfma_f32_16x16x32_bf16 v[88:91], v[104:107], v[116:119], v[88:91]
    v_mfma_f32_16x16x32_bf16 v[84:87], v[104:107], v[112:115], v[84:87]
    ds_read_b128 v[104:107], v58 offset:3584
    s_waitcnt lgkmcnt(2)
    v_mfma_f32_16x16x32_bf16 v[96:99], v[108:111], v[120:123], v[96:99]
    v_mfma_f32_16x16x32_bf16 v[92:95], v[108:111], v[116:119], v[92:95]
    v_mfma_f32_16x16x32_bf16 v[88:91], v[108:111], v[112:115], v[88:91]
    ds_read_b128 v[108:111], v58 offset:64
    s_waitcnt lgkmcnt(2)
    v_mfma_f32_16x16x32_bf16 v[96:99], v[100:103], v[116:119], v[96:99]
    v_mfma_f32_16x16x32_bf16 v[92:95], v[100:103], v[112:115], v[92:95]
    ds_read_b128 v[100:103], v58 offset:576
    s_waitcnt lgkmcnt(2)
    v_mfma_f32_16x16x32_bf16 v[96:99], v[104:107], v[112:115], v[96:99]
    ds_read_b128 v[104:107], v58 offset:1088
    s_waitcnt lgkmcnt(2)
    v_mfma_f32_16x16x32_bf16 v[96:99], v[108:111], v[172:175], v[96:99]
    v_mfma_f32_16x16x32_bf16 v[92:95], v[108:111], v[168:171], v[92:95]
    v_mfma_f32_16x16x32_bf16 v[88:91], v[108:111], v[164:167], v[88:91]
    v_mfma_f32_16x16x32_bf16 v[84:87], v[108:111], v[160:163], v[84:87]
    v_mfma_f32_16x16x32_bf16 v[80:83], v[108:111], v[156:159], v[80:83]
    v_mfma_f32_16x16x32_bf16 v[76:79], v[108:111], v[152:155], v[76:79]
    v_mfma_f32_16x16x32_bf16 v[72:75], v[108:111], v[148:151], v[72:75]
    v_mfma_f32_16x16x32_bf16 v[68:71], v[108:111], v[144:147], v[68:71]
    ds_read_b128 v[108:111], v58 offset:1600
    s_waitcnt lgkmcnt(2)
    v_mfma_f32_16x16x32_bf16 v[96:99], v[100:103], v[168:171], v[96:99]
    v_mfma_f32_16x16x32_bf16 v[92:95], v[100:103], v[164:167], v[92:95]
    v_mfma_f32_16x16x32_bf16 v[88:91], v[100:103], v[160:163], v[88:91]
    v_mfma_f32_16x16x32_bf16 v[84:87], v[100:103], v[156:159], v[84:87]
    v_mfma_f32_16x16x32_bf16 v[80:83], v[100:103], v[152:155], v[80:83]
    v_mfma_f32_16x16x32_bf16 v[76:79], v[100:103], v[148:151], v[76:79]
    v_mfma_f32_16x16x32_bf16 v[72:75], v[100:103], v[144:147], v[72:75]
    ds_read_b128 v[100:103], v58 offset:2112
    s_waitcnt lgkmcnt(2)
    v_mfma_f32_16x16x32_bf16 v[96:99], v[104:107], v[164:167], v[96:99]
    v_mfma_f32_16x16x32_bf16 v[92:95], v[104:107], v[160:163], v[92:95]
    v_mfma_f32_16x16x32_bf16 v[88:91], v[104:107], v[156:159], v[88:91]
    v_mfma_f32_16x16x32_bf16 v[84:87], v[104:107], v[152:155], v[84:87]
    v_mfma_f32_16x16x32_bf16 v[80:83], v[104:107], v[148:151], v[80:83]
    v_mfma_f32_16x16x32_bf16 v[76:79], v[104:107], v[144:147], v[76:79]
    ds_read_b128 v[104:107], v58 offset:2624
    s_waitcnt lgkmcnt(2)
    v_mfma_f32_16x16x32_bf16 v[96:99], v[108:111], v[160:163], v[96:99]
    v_mfma_f32_16x16x32_bf16 v[92:95], v[108:111], v[156:159], v[92:95]
    v_mfma_f32_16x16x32_bf16 v[88:91], v[108:111], v[152:155], v[88:91]
    v_mfma_f32_16x16x32_bf16 v[84:87], v[108:111], v[148:151], v[84:87]
    v_mfma_f32_16x16x32_bf16 v[80:83], v[108:111], v[144:147], v[80:83]
    ds_read_b128 v[108:111], v58 offset:3136
    s_waitcnt lgkmcnt(2)
    v_mfma_f32_16x16x32_bf16 v[96:99], v[100:103], v[156:159], v[96:99]
    v_mfma_f32_16x16x32_bf16 v[92:95], v[100:103], v[152:155], v[92:95]
    v_mfma_f32_16x16x32_bf16 v[88:91], v[100:103], v[148:151], v[88:91]
    v_mfma_f32_16x16x32_bf16 v[84:87], v[100:103], v[144:147], v[84:87]
    ds_read_b128 v[100:103], v58 offset:3648
    s_waitcnt lgkmcnt(2)
    v_mfma_f32_16x16x32_bf16 v[96:99], v[104:107], v[152:155], v[96:99]
    v_mfma_f32_16x16x32_bf16 v[92:95], v[104:107], v[148:151], v[92:95]
    v_mfma_f32_16x16x32_bf16 v[88:91], v[104:107], v[144:147], v[88:91]
    s_waitcnt lgkmcnt(1)
    v_mfma_f32_16x16x32_bf16 v[96:99], v[108:111], v[148:151], v[96:99]
    v_mfma_f32_16x16x32_bf16 v[92:95], v[108:111], v[144:147], v[92:95]
    s_waitcnt lgkmcnt(0)
    v_mfma_f32_16x16x32_bf16 v[96:99], v[100:103], v[144:147], v[96:99]
    ds_write_b128 v66, v[68:71] offset:0
    ds_write_b128 v66, v[72:75] offset:1024
    ds_write_b128 v66, v[76:79] offset:2048
    ds_write_b128 v66, v[80:83] offset:3072
    ds_write_b128 v66, v[84:87] offset:4096
    ds_write_b128 v66, v[88:91] offset:5120
    ds_write_b128 v66, v[92:95] offset:6144
    s_nop 0
    ds_write_b128 v66, v[96:99] offset:7168
    s_branch c_pw_end_16
c_pw_17:
    s_cmp_lg_u32 s34, 1
    s_cbranch_scc1 c_pw_18
    ds_read_b128 v[100:103], v58 offset:128
    ds_read_b128 v[112:115], v59 offset:352
    ds_read_b128 v[116:119], v59 offset:864
    ds_read_b128 v[120:123], v59 offset:1376
    ds_read_b128 v[124:127], v59 offset:1888
    ds_read_b128 v[128:131], v59 offset:2400
    ds_read_b128 v[132:135], v59 offset:2912
    ds_read_b128 v[136:139], v59 offset:3424
    ds_read_b128 v[140:143], v59 offset:3936
    ds_read_b128 v[104:107], v58 offset:640
    ds_read_b128 v[108:111], v58 offset:1152
    s_waitcnt lgkmcnt(2)
    v_mfma_f32_16x16x32_bf16 v[96:99], v[100:103], v[140:143], 0
    v_mfma_f32_16x16x32_bf16 v[92:95], v[100:103], v[136:139], 0
    v_mfma_f32_16x16x32_bf16 v[88:91], v[100:103], v[132:135], 0
    v_mfma_f32_16x16x32_bf16 v[84:87], v[100:103], v[128:131], 0
    v_mfma_f32_16x16x32_bf16 v[80:83], v[100:103], v[124:127], 0
    v_mfma_f32_16x16x32_bf16 v[76:79], v[100:103], v[120:123], 0
    v_mfma_f32_16x16x32_bf16 v[72:75], v[100:103], v[116:119], 0
    v_mfma_f32_16x16x32_bf16 v[68:71], v[100:103], v[112:115], 0
    ds_read_b128 v[100:103], v58 offset:1664
    s_waitcnt lgkmcnt(2)
    v_mfma_f32_16x16x32_bf16 v[96:99], v[104:107], v[136:139], v[96:99]
    v_mfma_f32_16x16x32_bf16 v[92:95], v[104:107], v[132:135], v[92:95]
    v_mfma_f32_16x16x32_bf16 v[88:91], v[104:107], v[128:131], v[88:91]
    v_mfma_f32_16x16x32_bf16 v[84:87], v[104:107], v[124:127], v[84:87]
    v_mfma_f32_16x16x32_bf16 v[80:83], v[104:107], v[120:123], v[80:83]
    v_mfma_f32_16x16x32_bf16 v[76:79], v[104:107], v[116:119], v[76:79]
    v_mfma_f32_16x16x32_bf16 v[72:75], v[104:107], v[112:115], v[72:75]
    ds_read_b128 v[104:107], v58 offset:2176
    ds_read_b128 v[144:147], v59 offset:288
    ds_read_b128 v[148:151], v59 offset:800
    ds_read_b128 v[152:155], v59 offset:1312
    ds_read_b128 v[156:159], v59 offset:1824
    ds_read_b128 v[160:163], v59 offset:2336
    ds_read_b128 v[164:167], v59 offset:2848
    ds_read_b128 v[168:171], v59 offset:3360
    ds_read_b128 v[172:175], v59 offset:3872
    s_waitcnt lgkmcnt(10)
    v_mfma_f32_16x16x32_bf16 v[96:99], v[108:111], v[132:135], v[96:99]
    v_mfma_f32_16x16x32_bf16 v[92:95], v[108:111], v[128:131], v[92:95]
    v_mfma_f32_16x16x32_bf16 v[88:91], v[108:111], v[124:127], v[88:91]
    v_mfma_f32_16x16x32_bf16 v[84:87], v[108:111], v[120:123], v[84:87]
    v_mfma_f32_16x16x32_bf16 v[80:83], v[108:111], v[116:119], v[80:83]
    v_mfma_f32_16x16x32_bf16 v[76:79], v[108:111], v[112:115], v[76:79]
    ds_read_b128 v[108:111], v58 offset:2688
    s_waitcnt lgkmcnt(10)
    v_mfma_f32_16x16x32_bf16 v[96:99], v[100:103], v[128:131], v[96:99]
    v_mfma_f32_16x16x32_bf16 v[92:95], v[100:103], v[124:127], v[92:95]
    v_mfma_f32_16x16x32_bf16 v[88:91], v[100:103], v[120:123], v[88:91]
    v_mfma_f32_16x16x32_bf16 v[84:87], v[100:103], v[116:119], v[84:87]
    v_mfma_f32_16x16x32_bf16 v[80:83], v[100:103], v[112:115], v[80:83]
    ds_read_b128 v[100:103], v58 offset:3200
    s_waitcnt lgkmcnt(10)
    v_mfma_f32_16x16x32_bf16 v[96:99], v[104:107], v[124:127], v[96:99]
    v_mfma_f32_16x16x32_bf16 v[92:95], v[104:107], v[120:123], v[92:95]
    v_mfma_f32_16x16x32_bf16 v[88:91], v[104:107], v[116:119], v[88:91]
    v_mfma_f32_16x16x32_bf16 v[84:87], v[104:107], v[112:115], v[84:87]
    ds_read_b128 v[104:107], v58 offset:3712
    s_waitcnt lgkmcnt(2)
    v_mfma_f32_16x16x32_bf16 v[96:99], v[108:111], v[120:123], v[96:99]
    v_mfma_f32_16x16x32_bf16 v[92:95], v[108:111], v[116:119], v[92:95]
    v_mfma_f32_16x16x32_bf16 v[88:91], v[108:111], v[112:115], v[88:91]
    ds_read_b128 v[108:111], v58 offset:192
    s_waitcnt lgkmcnt(2)
    v_mfma_f32_16x16x32_bf16 v[96:99], v[100:103], v[116:119], v[96:99]
    v_mfma_f32_16x16x32_bf16 v[92:95], v[100:103], v[112:115], v[92:95]
    ds_read_b128 v[100:103], v58 offset:704
    s_waitcnt lgkmcnt(2)
    v_mfma_f32_16x16x32_bf16 v[96:99], v[104:107], v[112:115], v[96:99]
    ds_read_b128 v[104:107], v58 offset:1216
    s_waitcnt lgkmcnt(2)
    v_mfma_f32_16x16x32_bf16 v[96:99], v[108:111], v[172:175], v[96:99]
    v_mfma_f32_16x16x32_bf16 v[92:95], v[108:111], v[168:171], v[92:95]
    v_mfma_f32_16x16x32_bf16 v[88:91], v[108:111], v[164:167], v[88:91]
    v_mfma_f32_16x16x32_bf16 v[84:87], v[108:111], v[160:163], v[84:87]
    v_mfma_f32_16x16x32_bf16 v[80:83], v[108:111], v[156:159], v[80:83]
    v_mfma_f32_16x16x32_bf16 v[76:79], v[108:111], v[152:155], v[76:79]
    v_mfma_f32_16x16x32_bf16 v[72:75], v[108:111], v[148:151], v[72:75]
    v_mfma_f32_16x16x32_bf16 v[68:71], v[108:111], v[144:147], v[68:71]
    ds_read_b128 v[108:111], v58 offset:1728
    s_waitcnt lgkmcnt(2)
    v_mfma_f32_16x16x32_bf16 v[96:99], v[100:103], v[168:171], v[96:99]
    v_mfma_f32_16x16x32_bf16 v[92:95], v[100:103], v[164:167], v[92:95]
    v_mfma_f32_16x16x32_bf16 v[88:91], v[100:103], v[160:163], v[88:91]
    v_mfma_f32_16x16x32_bf16 v[84:87], v[100:103], v[156:159], v[84:87]
    v_mfma_f32_16x16x32_bf16 v[80:83], v[100:103], v[152:155], v[80:83]
    v_mfma_f32_16x16x32_bf16 v[76:79], v[100:103], v[148:151], v[76:79]
    v_mfma_f32_16x16x32_bf16 v[72:75], v[100:103], v[144:147], v[72:75]
    ds_read_b128 v[100:103], v58 offset:2240
    s_waitcnt lgkmcnt(2)
    v_mfma_f32_16x16x32_bf16 v[96:99], v[104:107], v[164:167], v[96:99]
    v_mfma_f32_16x16x32_bf16 v[92:95], v[104:107], v[160:163], v[92:95]
    v_mfma_f32_16x16x32_bf16 v[88:91], v[104:107], v[156:159], v[88:91]
    v_mfma_f32_16x16x32_bf16 v[84:87], v[104:107], v[152:155], v[84:87]
    v_mfma_f32_16x16x32_bf16 v[80:83], v[104:107], v[148:151], v[80:83]
    v_mfma_f32_16x16x32_bf16 v[76:79], v[104:107], v[144:147], v[76:79]
    ds_read_b128 v[104:107], v58 offset:2752
    s_waitcnt lgkmcnt(2)
    v_mfma_f32_16x16x32_bf16 v[96:99], v[108:111], v[160:163], v[96:99]
    v_mfma_f32_16x16x32_bf16 v[92:95], v[108:111], v[156:159], v[92:95]
    v_mfma_f32_16x16x32_bf16 v[88:91], v[108:111], v[152:155], v[88:91]
    v_mfma_f32_16x16x32_bf16 v[84:87], v[108:111], v[148:151], v[84:87]
    v_mfma_f32_16x16x32_bf16 v[80:83], v[108:111], v[144:147], v[80:83]
    ds_read_b128 v[108:111], v58 offset:3264
    s_waitcnt lgkmcnt(2)
    v_mfma_f32_16x16x32_bf16 v[96:99], v[100:103], v[156:159], v[96:99]
    v_mfma_f32_16x16x32_bf16 v[92:95], v[100:103], v[152:155], v[92:95]
    v_mfma_f32_16x16x32_bf16 v[88:91], v[100:103], v[148:151], v[88:91]
    v_mfma_f32_16x16x32_bf16 v[84:87], v[100:103], v[144:147], v[84:87]
    ds_read_b128 v[100:103], v58 offset:3776
    s_waitcnt lgkmcnt(2)
    v_mfma_f32_16x16x32_bf16 v[96:99], v[104:107], v[152:155], v[96:99]
    v_mfma_f32_16x16x32_bf16 v[92:95], v[104:107], v[148:151], v[92:95]
    v_mfma_f32_16x16x32_bf16 v[88:91], v[104:107], v[144:147], v[88:91]
    s_waitcnt lgkmcnt(1)
    v_mfma_f32_16x16x32_bf16 v[96:99], v[108:111], v[148:151], v[96:99]
    v_mfma_f32_16x16x32_bf16 v[92:95], v[108:111], v[144:147], v[92:95]
    s_waitcnt lgkmcnt(0)
    v_mfma_f32_16x16x32_bf16 v[96:99], v[100:103], v[144:147], v[96:99]
    ds_write_b128 v66, v[68:71] offset:0
    ds_write_b128 v66, v[72:75] offset:1024
    ds_write_b128 v66, v[76:79] offset:2048
    ds_write_b128 v66, v[80:83] offset:3072
    ds_write_b128 v66, v[84:87] offset:4096
    ds_write_b128 v66, v[88:91] offset:5120
    ds_write_b128 v66, v[92:95] offset:6144
    s_nop 0
    ds_write_b128 v66, v[96:99] offset:7168
    s_branch c_pw_end_16
c_pw_18:
    s_cmp_lg_u32 s34, 2
    s_cbranch_scc1 c_pw_19
    ds_read_b128 v[100:103], v58 offset:256
    ds_read_b128 v[112:115], v59 offset:224
    ds_read_b128 v[116:119], v59 offset:736
    ds_read_b128 v[120:123], v59 offset:1248
    ds_read_b128 v[124:127], v59 offset:1760
    ds_read_b128 v[128:131], v59 offset:2272
    ds_read_b128 v[132:135], v59 offset:2784
    ds_read_b128 v[136:139], v59 offset:3296
    ds_read_b128 v[140:143], v59 offset:3808
    ds_read_b128 v[104:107], v58 offset:768
    ds_read_b128 v[108:111], v58 offset:1280
    s_waitcnt lgkmcnt(2)
    v_mfma_f32_16x16x32_bf16 v[96:99], v[100:103], v[140:143], 0
    v_mfma_f32_16x16x32_bf16 v[92:95], v[100:103], v[136:139], 0
    v_mfma_f32_16x16x32_bf16 v[88:91], v[100:103], v[132:135], 0
    v_mfma_f32_16x16x32_bf16 v[84:87], v[100:103], v[128:131], 0
    v_mfma_f32_16x16x32_bf16 v[80:83], v[100:103], v[124:127], 0
    v_mfma_f32_16x16x32_bf16 v[76:79], v[100:103], v[120:123], 0
    v_mfma_f32_16x16x32_bf16 v[72:75], v[100:103], v[116:119], 0
    v_mfma_f32_16x16x32_bf16 v[68:71], v[100:103], v[112:115], 0
    ds_read_b128 v[100:103], v58 offset:1792
    s_waitcnt lgkmcnt(2)
    v_mfma_f32_16x16x32_bf16 v[96:99], v[104:107], v[136:139], v[96:99]
    v_mfma_f32_16x16x32_bf16 v[92:95], v[104:107], v[132:135], v[92:95]
    v_mfma_f32_16x16x32_bf16 v[88:91], v[104:107], v[128:131], v[88:91]
    v_mfma_f32_16x16x32_bf16 v[84:87], v[104:107], v[124:127], v[84:87]
    v_mfma_f32_16x16x32_bf16 v[80:83], v[104:107], v[120:123], v[80:83]
    v_mfma_f32_16x16x32_bf16 v[76:79], v[104:107], v[116:119], v[76:79]
    v_mfma_f32_16x16x32_bf16 v[72:75], v[104:107], v[112:115], v[72:75]
    ds_read_b128 v[104:107], v58 offset:2304
    ds_read_b128 v[144:147], v59 offset:160
    ds_read_b128 v[148:151], v59 offset:672
    ds_read_b128 v[152:155], v59 offset:1184
    ds_read_b128 v[156:159], v59 offset:1696
    ds_read_b128 v[160:163], v59 offset:2208
    ds_read_b128 v[164:167], v59 offset:2720
    ds_read_b128 v[168:171], v59 offset:3232
    ds_read_b128 v[172:175], v59 offset:3744
    s_waitcnt lgkmcnt(10)
    v_mfma_f32_16x16x32_bf16 v[96:99], v[108:111], v[132:135], v[96:99]
    v_mfma_f32_16x16x32_bf16 v[92:95], v[108:111], v[128:131], v[92:95]
    v_mfma_f32_16x16x32_bf16 v[88:91], v[108:111], v[124:127], v[88:91]
    v_mfma_f32_16x16x32_bf16 v[84:87], v[108:111], v[120:123], v[84:87]
    v_mfma_f32_16x16x32_bf16 v[80:83], v[108:111], v[116:119], v[80:83]
    v_mfma_f32_16x16x32_bf16 v[76:79], v[108:111], v[112:115], v[76:79]
    ds_read_b128 v[108:111], v58 offset:2816
    s_waitcnt lgkmcnt(10)
    v_mfma_f32_16x16x32_bf16 v[96:99], v[100:103], v[128:131], v[96:99]
    v_mfma_f32_16x16x32_bf16 v[92:95], v[100:103], v[124:127], v[92:95]
    v_mfma_f32_16x16x32_bf16 v[88:91], v[100:103], v[120:123], v[88:91]
    v_mfma_f32_16x16x32_bf16 v[84:87], v[100:103], v[116:119], v[84:87]
    v_mfma_f32_16x16x32_bf16 v[80:83], v[100:103], v[112:115], v[80:83]
    ds_read_b128 v[100:103], v58 offset:3328
    s_waitcnt lgkmcnt(10)
    v_mfma_f32_16x16x32_bf16 v[96:99], v[104:107], v[124:127], v[96:99]
    v_mfma_f32_16x16x32_bf16 v[92:95], v[104:107], v[120:123], v[92:95]
    v_mfma_f32_16x16x32_bf16 v[88:91], v[104:107], v[116:119], v[88:91]
    v_mfma_f32_16x16x32_bf16 v[84:87], v[104:107], v[112:115], v[84:87]
    ds_read_b128 v[104:107], v58 offset:3840
    s_waitcnt lgkmcnt(2)
    v_mfma_f32_16x16x32_bf16 v[96:99], v[108:111], v[120:123], v[96:99]
    v_mfma_f32_16x16x32_bf16 v[92:95], v[108:111], v[116:119], v[92:95]
    v_mfma_f32_16x16x32_bf16 v[88:91], v[108:111], v[112:115], v[88:91]
    ds_read_b128 v[108:111], v58 offset:320
    s_waitcnt lgkmcnt(2)
    v_mfma_f32_16x16x32_bf16 v[96:99], v[100:103], v[116:119], v[96:99]
    v_mfma_f32_16x16x32_bf16 v[92:95], v[100:103], v[112:115], v[92:95]
    ds_read_b128 v[100:103], v58 offset:832
    s_waitcnt lgkmcnt(2)
    v_mfma_f32_16x16x32_bf16 v[96:99], v[104:107], v[112:115], v[96:99]
    ds_read_b128 v[104:107], v58 offset:1344
    s_waitcnt lgkmcnt(2)
    v_mfma_f32_16x16x32_bf16 v[96:99], v[108:111], v[172:175], v[96:99]
    v_mfma_f32_16x16x32_bf16 v[92:95], v[108:111], v[168:171], v[92:95]
    v_mfma_f32_16x16x32_bf16 v[88:91], v[108:111], v[164:167], v[88:91]
    v_mfma_f32_16x16x32_bf16 v[84:87], v[108:111], v[160:163], v[84:87]
    v_mfma_f32_16x16x32_bf16 v[80:83], v[108:111], v[156:159], v[80:83]
    v_mfma_f32_16x16x32_bf16 v[76:79], v[108:111], v[152:155], v[76:79]
    v_mfma_f32_16x16x32_bf16 v[72:75], v[108:111], v[148:151], v[72:75]
    v_mfma_f32_16x16x32_bf16 v[68:71], v[108:111], v[144:147], v[68:71]
    ds_read_b128 v[108:111], v58 offset:1856
    s_waitcnt lgkmcnt(2)
    v_mfma_f32_16x16x32_bf16 v[96:99], v[100:103], v[168:171], v[96:99]
    v_mfma_f32_16x16x32_bf16 v[92:95], v[100:103], v[164:167], v[92:95]
    v_mfma_f32_16x16x32_bf16 v[88:91], v[100:103], v[160:163], v[88:91]
    v_mfma_f32_16x16x32_bf16 v[84:87], v[100:103], v[156:159], v[84:87]
    v_mfma_f32_16x16x32_bf16 v[80:83], v[100:103], v[152:155], v[80:83]
    v_mfma_f32_16x16x32_bf16 v[76:79], v[100:103], v[148:151], v[76:79]
    v_mfma_f32_16x16x32_bf16 v[72:75], v[100:103], v[144:147], v[72:75]
    ds_read_b128 v[100:103], v58 offset:2368
    s_waitcnt lgkmcnt(2)
    v_mfma_f32_16x16x32_bf16 v[96:99], v[104:107], v[164:167], v[96:99]
    v_mfma_f32_16x16x32_bf16 v[92:95], v[104:107], v[160:163], v[92:95]
    v_mfma_f32_16x16x32_bf16 v[88:91], v[104:107], v[156:159], v[88:91]
    v_mfma_f32_16x16x32_bf16 v[84:87], v[104:107], v[152:155], v[84:87]
    v_mfma_f32_16x16x32_bf16 v[80:83], v[104:107], v[148:151], v[80:83]
    v_mfma_f32_16x16x32_bf16 v[76:79], v[104:107], v[144:147], v[76:79]
    ds_read_b128 v[104:107], v58 offset:2880
    s_waitcnt lgkmcnt(2)
    v_mfma_f32_16x16x32_bf16 v[96:99], v[108:111], v[160:163], v[96:99]
    v_mfma_f32_16x16x32_bf16 v[92:95], v[108:111], v[156:159], v[92:95]
    v_mfma_f32_16x16x32_bf16 v[88:91], v[108:111], v[152:155], v[88:91]
    v_mfma_f32_16x16x32_bf16 v[84:87], v[108:111], v[148:151], v[84:87]
    v_mfma_f32_16x16x32_bf16 v[80:83], v[108:111], v[144:147], v[80:83]
    ds_read_b128 v[108:111], v58 offset:3392
    s_waitcnt lgkmcnt(2)
    v_mfma_f32_16x16x32_bf16 v[96:99], v[100:103], v[156:159], v[96:99]
    v_mfma_f32_16x16x32_bf16 v[92:95], v[100:103], v[152:155], v[92:95]
    v_mfma_f32_16x16x32_bf16 v[88:91], v[100:103], v[148:151], v[88:91]
    v_mfma_f32_16x16x32_bf16 v[84:87], v[100:103], v[144:147], v[84:87]
    ds_read_b128 v[100:103], v58 offset:3904
    s_waitcnt lgkmcnt(2)
    v_mfma_f32_16x16x32_bf16 v[96:99], v[104:107], v[152:155], v[96:99]
    v_mfma_f32_16x16x32_bf16 v[92:95], v[104:107], v[148:151], v[92:95]
    v_mfma_f32_16x16x32_bf16 v[88:91], v[104:107], v[144:147], v[88:91]
    s_waitcnt lgkmcnt(1)
    v_mfma_f32_16x16x32_bf16 v[96:99], v[108:111], v[148:151], v[96:99]
    v_mfma_f32_16x16x32_bf16 v[92:95], v[108:111], v[144:147], v[92:95]
    s_waitcnt lgkmcnt(0)
    v_mfma_f32_16x16x32_bf16 v[96:99], v[100:103], v[144:147], v[96:99]
    ds_write_b128 v66, v[68:71] offset:0
    ds_write_b128 v66, v[72:75] offset:1024
    ds_write_b128 v66, v[76:79] offset:2048
    ds_write_b128 v66, v[80:83] offset:3072
    ds_write_b128 v66, v[84:87] offset:4096
    ds_write_b128 v66, v[88:91] offset:5120
    ds_write_b128 v66, v[92:95] offset:6144
    s_nop 0
    ds_write_b128 v66, v[96:99] offset:7168
    s_branch c_pw_end_16
c_pw_19:
    ds_read_b128 v[100:103], v58 offset:384
    ds_read_b128 v[112:115], v59 offset:96
    ds_read_b128 v[116:119], v59 offset:608
    ds_read_b128 v[120:123], v59 offset:1120
    ds_read_b128 v[124:127], v59 offset:1632
    ds_read_b128 v[128:131], v59 offset:2144
    ds_read_b128 v[132:135], v59 offset:2656
    ds_read_b128 v[136:139], v59 offset:3168
    ds_read_b128 v[140:143], v59 offset:3680
    ds_read_b128 v[104:107], v58 offset:896
    ds_read_b128 v[108:111], v58 offset:1408
    s_waitcnt lgkmcnt(2)
    v_mfma_f32_16x16x32_bf16 v[96:99], v[100:103], v[140:143], 0
    v_mfma_f32_16x16x32_bf16 v[92:95], v[100:103], v[136:139], 0
    v_mfma_f32_16x16x32_bf16 v[88:91], v[100:103], v[132:135], 0
    v_mfma_f32_16x16x32_bf16 v[84:87], v[100:103], v[128:131], 0
    v_mfma_f32_16x16x32_bf16 v[80:83], v[100:103], v[124:127], 0
    v_mfma_f32_16x16x32_bf16 v[76:79], v[100:103], v[120:123], 0
    v_mfma_f32_16x16x32_bf16 v[72:75], v[100:103], v[116:119], 0
    v_mfma_f32_16x16x32_bf16 v[68:71], v[100:103], v[112:115], 0
    ds_read_b128 v[100:103], v58 offset:1920
    s_waitcnt lgkmcnt(2)
    v_mfma_f32_16x16x32_bf16 v[96:99], v[104:107], v[136:139], v[96:99]
    v_mfma_f32_16x16x32_bf16 v[92:95], v[104:107], v[132:135], v[92:95]
    v_mfma_f32_16x16x32_bf16 v[88:91], v[104:107], v[128:131], v[88:91]
    v_mfma_f32_16x16x32_bf16 v[84:87], v[104:107], v[124:127], v[84:87]
    v_mfma_f32_16x16x32_bf16 v[80:83], v[104:107], v[120:123], v[80:83]
    v_mfma_f32_16x16x32_bf16 v[76:79], v[104:107], v[116:119], v[76:79]
    v_mfma_f32_16x16x32_bf16 v[72:75], v[104:107], v[112:115], v[72:75]
    ds_read_b128 v[104:107], v58 offset:2432
    ds_read_b128 v[144:147], v59 offset:32
    ds_read_b128 v[148:151], v59 offset:544
    ds_read_b128 v[152:155], v59 offset:1056
    ds_read_b128 v[156:159], v59 offset:1568
    ds_read_b128 v[160:163], v59 offset:2080
    ds_read_b128 v[164:167], v59 offset:2592
    ds_read_b128 v[168:171], v59 offset:3104
    ds_read_b128 v[172:175], v59 offset:3616
    s_waitcnt lgkmcnt(10)
    v_mfma_f32_16x16x32_bf16 v[96:99], v[108:111], v[132:135], v[96:99]
    v_mfma_f32_16x16x32_bf16 v[92:95], v[108:111], v[128:131], v[92:95]
    v_mfma_f32_16x16x32_bf16 v[88:91], v[108:111], v[124:127], v[88:91]
    v_mfma_f32_16x16x32_bf16 v[84:87], v[108:111], v[120:123], v[84:87]
    v_mfma_f32_16x16x32_bf16 v[80:83], v[108:111], v[116:119], v[80:83]
    v_mfma_f32_16x16x32_bf16 v[76:79], v[108:111], v[112:115], v[76:79]
    ds_read_b128 v[108:111], v58 offset:2944
    s_waitcnt lgkmcnt(10)
    v_mfma_f32_16x16x32_bf16 v[96:99], v[100:103], v[128:131], v[96:99]
    v_mfma_f32_16x16x32_bf16 v[92:95], v[100:103], v[124:127], v[92:95]
    v_mfma_f32_16x16x32_bf16 v[88:91], v[100:103], v[120:123], v[88:91]
    v_mfma_f32_16x16x32_bf16 v[84:87], v[100:103], v[116:119], v[84:87]
    v_mfma_f32_16x16x32_bf16 v[80:83], v[100:103], v[112:115], v[80:83]
    ds_read_b128 v[100:103], v58 offset:3456
    s_waitcnt lgkmcnt(10)
    v_mfma_f32_16x16x32_bf16 v[96:99], v[104:107], v[124:127], v[96:99]
    v_mfma_f32_16x16x32_bf16 v[92:95], v[104:107], v[120:123], v[92:95]
    v_mfma_f32_16x16x32_bf16 v[88:91], v[104:107], v[116:119], v[88:91]
    v_mfma_f32_16x16x32_bf16 v[84:87], v[104:107], v[112:115], v[84:87]
    ds_read_b128 v[104:107], v58 offset:3968
    s_waitcnt lgkmcnt(2)
    v_mfma_f32_16x16x32_bf16 v[96:99], v[108:111], v[120:123], v[96:99]
    v_mfma_f32_16x16x32_bf16 v[92:95], v[108:111], v[116:119], v[92:95]
    v_mfma_f32_16x16x32_bf16 v[88:91], v[108:111], v[112:115], v[88:91]
    ds_read_b128 v[108:111], v58 offset:448
    s_waitcnt lgkmcnt(2)
    v_mfma_f32_16x16x32_bf16 v[96:99], v[100:103], v[116:119], v[96:99]
    v_mfma_f32_16x16x32_bf16 v[92:95], v[100:103], v[112:115], v[92:95]
    ds_read_b128 v[100:103], v58 offset:960
    s_waitcnt lgkmcnt(2)
    v_mfma_f32_16x16x32_bf16 v[96:99], v[104:107], v[112:115], v[96:99]
    ds_read_b128 v[104:107], v58 offset:1472
    s_waitcnt lgkmcnt(2)
    v_mfma_f32_16x16x32_bf16 v[96:99], v[108:111], v[172:175], v[96:99]
    v_mfma_f32_16x16x32_bf16 v[92:95], v[108:111], v[168:171], v[92:95]
    v_mfma_f32_16x16x32_bf16 v[88:91], v[108:111], v[164:167], v[88:91]
    v_mfma_f32_16x16x32_bf16 v[84:87], v[108:111], v[160:163], v[84:87]
    v_mfma_f32_16x16x32_bf16 v[80:83], v[108:111], v[156:159], v[80:83]
    v_mfma_f32_16x16x32_bf16 v[76:79], v[108:111], v[152:155], v[76:79]
    v_mfma_f32_16x16x32_bf16 v[72:75], v[108:111], v[148:151], v[72:75]
    v_mfma_f32_16x16x32_bf16 v[68:71], v[108:111], v[144:147], v[68:71]
    ds_read_b128 v[108:111], v58 offset:1984
    s_waitcnt lgkmcnt(2)
    v_mfma_f32_16x16x32_bf16 v[96:99], v[100:103], v[168:171], v[96:99]
    v_mfma_f32_16x16x32_bf16 v[92:95], v[100:103], v[164:167], v[92:95]
    v_mfma_f32_16x16x32_bf16 v[88:91], v[100:103], v[160:163], v[88:91]
    v_mfma_f32_16x16x32_bf16 v[84:87], v[100:103], v[156:159], v[84:87]
    v_mfma_f32_16x16x32_bf16 v[80:83], v[100:103], v[152:155], v[80:83]
    v_mfma_f32_16x16x32_bf16 v[76:79], v[100:103], v[148:151], v[76:79]
    v_mfma_f32_16x16x32_bf16 v[72:75], v[100:103], v[144:147], v[72:75]
    ds_read_b128 v[100:103], v58 offset:2496
    s_waitcnt lgkmcnt(2)
    v_mfma_f32_16x16x32_bf16 v[96:99], v[104:107], v[164:167], v[96:99]
    v_mfma_f32_16x16x32_bf16 v[92:95], v[104:107], v[160:163], v[92:95]
    v_mfma_f32_16x16x32_bf16 v[88:91], v[104:107], v[156:159], v[88:91]
    v_mfma_f32_16x16x32_bf16 v[84:87], v[104:107], v[152:155], v[84:87]
    v_mfma_f32_16x16x32_bf16 v[80:83], v[104:107], v[148:151], v[80:83]
    v_mfma_f32_16x16x32_bf16 v[76:79], v[104:107], v[144:147], v[76:79]
    ds_read_b128 v[104:107], v58 offset:3008
    s_waitcnt lgkmcnt(2)
    v_mfma_f32_16x16x32_bf16 v[96:99], v[108:111], v[160:163], v[96:99]
    v_mfma_f32_16x16x32_bf16 v[92:95], v[108:111], v[156:159], v[92:95]
    v_mfma_f32_16x16x32_bf16 v[88:91], v[108:111], v[152:155], v[88:91]
    v_mfma_f32_16x16x32_bf16 v[84:87], v[108:111], v[148:151], v[84:87]
    v_mfma_f32_16x16x32_bf16 v[80:83], v[108:111], v[144:147], v[80:83]
    ds_read_b128 v[108:111], v58 offset:3520
    s_waitcnt lgkmcnt(2)
    v_mfma_f32_16x16x32_bf16 v[96:99], v[100:103], v[156:159], v[96:99]
    v_mfma_f32_16x16x32_bf16 v[92:95], v[100:103], v[152:155], v[92:95]
    v_mfma_f32_16x16x32_bf16 v[88:91], v[100:103], v[148:151], v[88:91]
    v_mfma_f32_16x16x32_bf16 v[84:87], v[100:103], v[144:147], v[84:87]
    ds_read_b128 v[100:103], v58 offset:4032
    s_waitcnt lgkmcnt(2)
    v_mfma_f32_16x16x32_bf16 v[96:99], v[104:107], v[152:155], v[96:99]
    v_mfma_f32_16x16x32_bf16 v[92:95], v[104:107], v[148:151], v[92:95]
    v_mfma_f32_16x16x32_bf16 v[88:91], v[104:107], v[144:147], v[88:91]
    s_waitcnt lgkmcnt(1)
    v_mfma_f32_16x16x32_bf16 v[96:99], v[108:111], v[148:151], v[96:99]
    v_mfma_f32_16x16x32_bf16 v[92:95], v[108:111], v[144:147], v[92:95]
    s_waitcnt lgkmcnt(0)
    v_mfma_f32_16x16x32_bf16 v[96:99], v[100:103], v[144:147], v[96:99]
    ds_write_b128 v66, v[68:71] offset:0
    ds_write_b128 v66, v[72:75] offset:1024
    ds_write_b128 v66, v[76:79] offset:2048
    ds_write_b128 v66, v[80:83] offset:3072
    ds_write_b128 v66, v[84:87] offset:4096
    ds_write_b128 v66, v[88:91] offset:5120
    ds_write_b128 v66, v[92:95] offset:6144
    s_nop 0
    ds_write_b128 v66, v[96:99] offset:7168
c_pw_end_16:
    s_waitcnt lgkmcnt(0)
    s_barrier
    ds_read_b128 v[112:115], v67 offset:0
    ds_read_b128 v[116:119], v67 offset:16
    ds_read_b128 v[120:123], v67 offset:8192
    ds_read_b128 v[124:127], v67 offset:8208
    ds_read_b128 v[128:131], v67 offset:16384
    ds_read_b128 v[132:135], v67 offset:16400
    ds_read_b128 v[136:139], v67 offset:24576
    ds_read_b128 v[140:143], v67 offset:24592
    s_lshl_b32 s40, s57, 12
    s_add_u32 s40, s40, 8912896
    s_waitcnt lgkmcnt(0)
    v_pk_add_f32 v[112:113], v[112:113], v[120:121]
    v_pk_add_f32 v[128:129], v[128:129], v[136:137]
    v_pk_add_f32 v[114:115], v[114:115], v[122:123]
    v_pk_add_f32 v[130:131], v[130:131], v[138:139]
    v_pk_add_f32 v[116:117], v[116:117], v[124:125]
    v_pk_add_f32 v[132:133], v[132:133], v[140:141]
    v_pk_add_f32 v[118:119], v[118:119], v[126:127]
    v_pk_add_f32 v[134:135], v[134:135], v[142:143]
    v_pk_add_f32 v[112:113], v[112:113], v[128:129]
    v_pk_add_f32 v[114:115], v[114:115], v[130:131]
    v_pk_add_f32 v[116:117], v[116:117], v[132:133]
    v_pk_add_f32 v[118:119], v[118:119], v[134:135]
    v_cvt_pk_bf16_f32 v184, v112, v113
    v_cvt_pk_bf16_f32 v185, v114, v115
    v_cvt_pk_bf16_f32 v186, v116, v117
    v_cvt_pk_bf16_f32 v187, v118, v119
    buffer_store_dwordx4 v[184:187], v2, s[8:11], s40 offen sc1
    s_nop 1
    s_waitcnt vmcnt(0)
    v_cmp_ne_u32 vcc, 0, v0
    s_nop 1
    v_cndmask_b32 v24, 0, v24, vcc
    v_cndmask_b32 v25, 0, v25, vcc
    v_cndmask_b32 v26, 0, v26, vcc
    v_cndmask_b32 v27, 0, v27, vcc
    v_alignbit_b32 v176, v25, v24, 16
    v_alignbit_b32 v177, v26, v25, 16
    v_alignbit_b32 v178, v27, v26, 16
    v_alignbit_b32 v179, v28, v27, 16
    v_alignbit_b32 v180, v29, v28, 16
    v_alignbit_b32 v181, v30, v29, 16
    v_alignbit_b32 v182, v31, v30, 16
    ds_write_b128 v56, v[176:179] offset:0
    v_mov_b32 v184, v25
    v_mov_b32 v185, v26
    v_mov_b32 v186, v27
    v_mov_b32 v187, v28
    ds_write_b128 v56, v[184:187] offset:4160
    s_nop 1
    v_mov_b32 v184, v177
    v_mov_b32 v185, v178
    v_mov_b32 v186, v179
    v_mov_b32 v187, v180
    ds_write_b128 v56, v[184:187] offset:8320
    s_nop 1
    ds_write_b128 v56, v[26:29] offset:12480
    ds_write_b128 v56, v[178:181] offset:16640
    v_mov_b32 v184, v27
    v_mov_b32 v185, v28
    v_mov_b32 v186, v29
    v_mov_b32 v187, v30
    ds_write_b128 v56, v[184:187] offset:20800
    s_nop 1
    v_mov_b32 v184, v179
    v_mov_b32 v185, v180
    v_mov_b32 v186, v181
    v_mov_b32 v187, v182
    ds_write_b128 v56, v[184:187] offset:24960
    s_nop 1
    ds_write_b128 v56, v[28:31] offset:29120
    ds_write_b128 v57, v[40:43]
    v_lshlrev_b32 v3, 16, v46
    v_or_b32 v3, v3, v46
    v_and_b32 v188, v60, v3
    v_and_b32 v189, v61, v3
    v_and_b32 v190, v62, v3
    v_and_b32 v191, v63, v3
    s_waitcnt lgkmcnt(0)
    s_barrier
    s_bitcmp1_b32 s2, 0
    s_cbranch_scc1 c_halfB_21
    s_cmp_lg_u32 s34, 0
    s_cbranch_scc1 c_pw_24
    ds_read_b128 v[100:103], v58 offset:0
    ds_read_b128 v[112:115], v59 offset:480
    ds_read_b128 v[116:119], v59 offset:992
    ds_read_b128 v[120:123], v59 offset:1504
    ds_read_b128 v[124:127], v59 offset:2016
    ds_read_b128 v[128:131], v59 offset:2528
    ds_read_b128 v[132:135], v59 offset:3040
    ds_read_b128 v[136:139], v59 offset:3552
    ds_read_b128 v[140:143], v59 offset:4064
    ds_read_b128 v[104:107], v58 offset:512
    ds_read_b128 v[108:111], v58 offset:1024
    s_waitcnt lgkmcnt(2)
    v_mfma_f32_16x16x32_bf16 v[96:99], v[100:103], v[140:143], 0
    v_mfma_f32_16x16x32_bf16 v[92:95], v[100:103], v[136:139], 0
    v_mfma_f32_16x16x32_bf16 v[76:79], v[100:103], v[120:123], 0
    v_mfma_f32_16x16x32_bf16 v[76:79], v[188:191], v[120:123], v[76:79]
    v_mfma_f32_16x16x32_bf16 v[92:95], v[188:191], v[136:139], v[92:95]
    v_mfma_f32_16x16x32_bf16 v[96:99], v[188:191], v[140:143], v[96:99]
    ds_read_b128 v[100:103], v58 offset:1536
    s_waitcnt lgkmcnt(2)
    v_mfma_f32_16x16x32_bf16 v[96:99], v[104:107], v[136:139], v[96:99]
    v_mfma_f32_16x16x32_bf16 v[92:95], v[104:107], v[132:135], v[92:95]
    v_mfma_f32_16x16x32_bf16 v[76:79], v[104:107], v[116:119], v[76:79]
    ds_read_b128 v[104:107], v58 offset:2048
    ds_read_b128 v[144:147], v59 offset:416
    ds_read_b128 v[148:151], v59 offset:928
    ds_read_b128 v[152:155], v59 offset:1440
    ds_read_b128 v[156:159], v59 offset:1952
    ds_read_b128 v[160:163], v59 offset:2464
    ds_read_b128 v[164:167], v59 offset:2976
    ds_read_b128 v[168:171], v59 offset:3488
    ds_read_b128 v[172:175], v59 offset:4000
    s_waitcnt lgkmcnt(10)
    v_mfma_f32_16x16x32_bf16 v[96:99], v[108:111], v[132:135], v[96:99]
    v_mfma_f32_16x16x32_bf16 v[92:95], v[108:111], v[128:131], v[92:95]
    v_mfma_f32_16x16x32_bf16 v[76:79], v[108:111], v[112:115], v[76:79]
    ds_read_b128 v[108:111], v58 offset:2560
    s_waitcnt lgkmcnt(10)
    v_mfma_f32_16x16x32_bf16 v[96:99], v[100:103], v[128:131], v[96:99]
    v_mfma_f32_16x16x32_bf16 v[92:95], v[100:103], v[124:127], v[92:95]
    ds_read_b128 v[100:103], v58 offset:3072
    s_waitcnt lgkmcnt(10)
    v_mfma_f32_16x16x32_bf16 v[96:99], v[104:107], v[124:127], v[96:99]
    v_mfma_f32_16x16x32_bf16 v[92:95], v[104:107], v[120:123], v[92:95]
    ds_read_b128 v[104:107], v58 offset:3584
    s_waitcnt lgkmcnt(2)
    v_mfma_f32_16x16x32_bf16 v[96:99], v[108:111], v[120:123], v[96:99]
    v_mfma_f32_16x16x32_bf16 v[92:95], v[108:111], v[116:119], v[92:95]
    ds_read_b128 v[108:111], v58 offset:64
    s_waitcnt lgkmcnt(2)
    v_mfma_f32_16x16x32_bf16 v[96:99], v[100:103], v[116:119], v[96:99]
    v_mfma_f32_16x16x32_bf16 v[92:95], v[100:103], v[112:115], v[92:95]
    ds_read_b128 v[100:103], v58 offset:576
    s_waitcnt lgkmcnt(2)
    v_mfma_f32_16x16x32_bf16 v[96:99], v[104:107], v[112:115], v[96:99]
    ds_read_b128 v[104:107], v58 offset:1088
    s_waitcnt lgkmcnt(2)
    v_mfma_f32_16x16x32_bf16 v[96:99], v[108:111], v[172:175], v[96:99]
    v_mfma_f32_16x16x32_bf16 v[92:95], v[108:111], v[168:171], v[92:95]
    v_mfma_f32_16x16x32_bf16 v[76:79], v[108:111], v[152:155], v[76:79]
    ds_read_b128 v[108:111], v58 offset:1600
    s_waitcnt lgkmcnt(2)
    v_mfma_f32_16x16x32_bf16 v[96:99], v[100:103], v[168:171], v[96:99]
    v_mfma_f32_16x16x32_bf16 v[92:95], v[100:103], v[164:167], v[92:95]
    v_mfma_f32_16x16x32_bf16 v[76:79], v[100:103], v[148:151], v[76:79]
    ds_read_b128 v[100:103], v58 offset:2112
    s_waitcnt lgkmcnt(2)
    v_mfma_f32_16x16x32_bf16 v[96:99], v[104:107], v[164:167], v[96:99]
    v_mfma_f32_16x16x32_bf16 v[92:95], v[104:107], v[160:163], v[92:95]
    v_mfma_f32_16x16x32_bf16 v[76:79], v[104:107], v[144:147], v[76:79]
    ds_read_b128 v[104:107], v58 offset:2624
    s_waitcnt lgkmcnt(2)
    v_mfma_f32_16x16x32_bf16 v[96:99], v[108:111], v[160:163], v[96:99]
    v_mfma_f32_16x16x32_bf16 v[92:95], v[108:111], v[156:159], v[92:95]
    ds_read_b128 v[108:111], v58 offset:3136
    s_waitcnt lgkmcnt(2)
    v_mfma_f32_16x16x32_bf16 v[96:99], v[100:103], v[156:159], v[96:99]
    v_mfma_f32_16x16x32_bf16 v[92:95], v[100:103], v[152:155], v[92:95]
    ds_read_b128 v[100:103], v58 offset:3648
    s_waitcnt lgkmcnt(2)
    v_mfma_f32_16x16x32_bf16 v[96:99], v[104:107], v[152:155], v[96:99]
    v_mfma_f32_16x16x32_bf16 v[92:95], v[104:107], v[148:151], v[92:95]
    s_waitcnt lgkmcnt(1)
    v_mfma_f32_16x16x32_bf16 v[96:99], v[108:111], v[148:151], v[96:99]
    v_mfma_f32_16x16x32_bf16 v[92:95], v[108:111], v[144:147], v[92:95]
    s_waitcnt lgkmcnt(0)
    v_mfma_f32_16x16x32_bf16 v[96:99], v[100:103], v[144:147], v[96:99]
    ds_write_b128 v66, v[76:79] offset:2048
    s_nop 4
    ds_write_b128 v66, v[92:95] offset:6144
    s_nop 0
    ds_write_b128 v66, v[96:99] offset:7168
    s_branch c_pw_end_23
c_pw_24:
    s_cmp_lg_u32 s34, 1
    s_cbranch_scc1 c_pw_25
    ds_read_b128 v[100:103], v58 offset:128
    ds_read_b128 v[112:115], v59 offset:352
    ds_read_b128 v[116:119], v59 offset:864
    ds_read_b128 v[120:123], v59 offset:1376
    ds_read_b128 v[124:127], v59 offset:1888
    ds_read_b128 v[128:131], v59 offset:2400
    ds_read_b128 v[132:135], v59 offset:2912
    ds_read_b128 v[136:139], v59 offset:3424
    ds_read_b128 v[140:143], v59 offset:3936
    ds_read_b128 v[104:107], v58 offset:640
    ds_read_b128 v[108:111], v58 offset:1152
    s_waitcnt lgkmcnt(2)
    v_mfma_f32_16x16x32_bf16 v[96:99], v[100:103], v[140:143], 0
    v_mfma_f32_16x16x32_bf16 v[92:95], v[100:103], v[136:139], 0
    v_mfma_f32_16x16x32_bf16 v[76:79], v[100:103], v[120:123], 0
    ds_read_b128 v[100:103], v58 offset:1664
    s_waitcnt lgkmcnt(2)
    v_mfma_f32_16x16x32_bf16 v[96:99], v[104:107], v[136:139], v[96:99]
    v_mfma_f32_16x16x32_bf16 v[92:95], v[104:107], v[132:135], v[92:95]
    v_mfma_f32_16x16x32_bf16 v[76:79], v[104:107], v[116:119], v[76:79]
    ds_read_b128 v[104:107], v58 offset:2176
    ds_read_b128 v[144:147], v59 offset:288
    ds_read_b128 v[148:151], v59 offset:800
    ds_read_b128 v[152:155], v59 offset:1312
    ds_read_b128 v[156:159], v59 offset:1824
    ds_read_b128 v[160:163], v59 offset:2336
    ds_read_b128 v[164:167], v59 offset:2848
    ds_read_b128 v[168:171], v59 offset:3360
    ds_read_b128 v[172:175], v59 offset:3872
    s_waitcnt lgkmcnt(10)
    v_mfma_f32_16x16x32_bf16 v[96:99], v[108:111], v[132:135], v[96:99]
    v_mfma_f32_16x16x32_bf16 v[92:95], v[108:111], v[128:131], v[92:95]
    v_mfma_f32_16x16x32_bf16 v[76:79], v[108:111], v[112:115], v[76:79]
    ds_read_b128 v[108:111], v58 offset:2688
    s_waitcnt lgkmcnt(10)
    v_mfma_f32_16x16x32_bf16 v[96:99], v[100:103], v[128:131], v[96:99]
    v_mfma_f32_16x16x32_bf16 v[92:95], v[100:103], v[124:127], v[92:95]
    ds_read_b128 v[100:103], v58 offset:3200
    s_waitcnt lgkmcnt(10)
    v_mfma_f32_16x16x32_bf16 v[96:99], v[104:107], v[124:127], v[96:99]
    v_mfma_f32_16x16x32_bf16 v[92:95], v[104:107], v[120:123], v[92:95]
    ds_read_b128 v[104:107], v58 offset:3712
    s_waitcnt lgkmcnt(2)
    v_mfma_f32_16x16x32_bf16 v[96:99], v[108:111], v[120:123], v[96:99]
    v_mfma_f32_16x16x32_bf16 v[92:95], v[108:111], v[116:119], v[92:95]
    ds_read_b128 v[108:111], v58 offset:192
    s_waitcnt lgkmcnt(2)
    v_mfma_f32_16x16x32_bf16 v[96:99], v[100:103], v[116:119], v[96:99]
    v_mfma_f32_16x16x32_bf16 v[92:95], v[100:103], v[112:115], v[92:95]
    ds_read_b128 v[100:103], v58 offset:704
    s_waitcnt lgkmcnt(2)
    v_mfma_f32_16x16x32_bf16 v[96:99], v[104:107], v[112:115], v[96:99]
    ds_read_b128 v[104:107], v58 offset:1216
    s_waitcnt lgkmcnt(2)
    v_mfma_f32_16x16x32_bf16 v[96:99], v[108:111], v[172:175], v[96:99]
    v_mfma_f32_16x16x32_bf16 v[92:95], v[108:111], v[168:171], v[92:95]
    v_mfma_f32_16x16x32_bf16 v[76:79], v[108:111], v[152:155], v[76:79]
    ds_read_b128 v[108:111], v58 offset:1728
    s_waitcnt lgkmcnt(2)
    v_mfma_f32_16x16x32_bf16 v[96:99], v[100:103], v[168:171], v[96:99]
    v_mfma_f32_16x16x32_bf16 v[92:95], v[100:103], v[164:167], v[92:95]
    v_mfma_f32_16x16x32_bf16 v[76:79], v[100:103], v[148:151], v[76:79]
    ds_read_b128 v[100:103], v58 offset:2240
    s_waitcnt lgkmcnt(2)
    v_mfma_f32_16x16x32_bf16 v[96:99], v[104:107], v[164:167], v[96:99]
    v_mfma_f32_16x16x32_bf16 v[92:95], v[104:107], v[160:163], v[92:95]
    v_mfma_f32_16x16x32_bf16 v[76:79], v[104:107], v[144:147], v[76:79]
    ds_read_b128 v[104:107], v58 offset:2752
    s_waitcnt lgkmcnt(2)
    v_mfma_f32_16x16x32_bf16 v[96:99], v[108:111], v[160:163], v[96:99]
    v_mfma_f32_16x16x32_bf16 v[92:95], v[108:111], v[156:159], v[92:95]
    ds_read_b128 v[108:111], v58 offset:3264
    s_waitcnt lgkmcnt(2)
    v_mfma_f32_16x16x32_bf16 v[96:99], v[100:103], v[156:159], v[96:99]
    v_mfma_f32_16x16x32_bf16 v[92:95], v[100:103], v[152:155], v[92:95]
    ds_read_b128 v[100:103], v58 offset:3776
    s_waitcnt lgkmcnt(2)
    v_mfma_f32_16x16x32_bf16 v[96:99], v[104:107], v[152:155], v[96:99]
    v_mfma_f32_16x16x32_bf16 v[92:95], v[104:107], v[148:151], v[92:95]
    s_waitcnt lgkmcnt(1)
    v_mfma_f32_16x16x32_bf16 v[96:99], v[108:111], v[148:151], v[96:99]
    v_mfma_f32_16x16x32_bf16 v[92:95], v[108:111], v[144:147], v[92:95]
    s_waitcnt lgkmcnt(0)
    v_mfma_f32_16x16x32_bf16 v[96:99], v[100:103], v[144:147], v[96:99]
    ds_write_b128 v66, v[76:79] offset:2048
    s_nop 4
    ds_write_b128 v66, v[92:95] offset:6144
    s_nop 0
    ds_write_b128 v66, v[96:99] offset:7168
    s_branch c_pw_end_23
c_pw_25:
    s_cmp_lg_u32 s34, 2
    s_cbranch_scc1 c_pw_26
    ds_read_b128 v[100:103], v58 offset:256
    ds_read_b128 v[112:115], v59 offset:224
    ds_read_b128 v[116:119], v59 offset:736
    ds_read_b128 v[120:123], v59 offset:1248
    ds_read_b128 v[124:127], v59 offset:1760
    ds_read_b128 v[128:131], v59 offset:2272
    ds_read_b128 v[132:135], v59 offset:2784
    ds_read_b128 v[136:139], v59 offset:3296
    ds_read_b128 v[140:143], v59 offset:3808
    ds_read_b128 v[104:107], v58 offset:768
    ds_read_b128 v[108:111], v58 offset:1280
    s_waitcnt lgkmcnt(2)
    v_mfma_f32_16x16x32_bf16 v[96:99], v[100:103], v[140:143], 0
    v_mfma_f32_16x16x32_bf16 v[92:95], v[100:103], v[136:139], 0
    v_mfma_f32_16x16x32_bf16 v[76:79], v[100:103], v[120:123], 0
    ds_read_b128 v[100:103], v58 offset:1792
    s_waitcnt lgkmcnt(2)
    v_mfma_f32_16x16x32_bf16 v[96:99], v[104:107], v[136:139], v[96:99]
    v_mfma_f32_16x16x32_bf16 v[92:95], v[104:107], v[132:135], v[92:95]
    v_mfma_f32_16x16x32_bf16 v[76:79], v[104:107], v[116:119], v[76:79]
    ds_read_b128 v[104:107], v58 offset:2304
    ds_read_b128 v[144:147], v59 offset:160
    ds_read_b128 v[148:151], v59 offset:672
    ds_read_b128 v[152:155], v59 offset:1184
    ds_read_b128 v[156:159], v59 offset:1696
    ds_read_b128 v[160:163], v59 offset:2208
    ds_read_b128 v[164:167], v59 offset:2720
    ds_read_b128 v[168:171], v59 offset:3232
    ds_read_b128 v[172:175], v59 offset:3744
    s_waitcnt lgkmcnt(10)
    v_mfma_f32_16x16x32_bf16 v[96:99], v[108:111], v[132:135], v[96:99]
    v_mfma_f32_16x16x32_bf16 v[92:95], v[108:111], v[128:131], v[92:95]
    v_mfma_f32_16x16x32_bf16 v[76:79], v[108:111], v[112:115], v[76:79]
    ds_read_b128 v[108:111], v58 offset:2816
    s_waitcnt lgkmcnt(10)
    v_mfma_f32_16x16x32_bf16 v[96:99], v[100:103], v[128:131], v[96:99]
    v_mfma_f32_16x16x32_bf16 v[92:95], v[100:103], v[124:127], v[92:95]
    ds_read_b128 v[100:103], v58 offset:3328
    s_waitcnt lgkmcnt(10)
    v_mfma_f32_16x16x32_bf16 v[96:99], v[104:107], v[124:127], v[96:99]
    v_mfma_f32_16x16x32_bf16 v[92:95], v[104:107], v[120:123], v[92:95]
    ds_read_b128 v[104:107], v58 offset:3840
    s_waitcnt lgkmcnt(2)
    v_mfma_f32_16x16x32_bf16 v[96:99], v[108:111], v[120:123], v[96:99]
    v_mfma_f32_16x16x32_bf16 v[92:95], v[108:111], v[116:119], v[92:95]
    ds_read_b128 v[108:111], v58 offset:320
    s_waitcnt lgkmcnt(2)
    v_mfma_f32_16x16x32_bf16 v[96:99], v[100:103], v[116:119], v[96:99]
    v_mfma_f32_16x16x32_bf16 v[92:95], v[100:103], v[112:115], v[92:95]
    ds_read_b128 v[100:103], v58 offset:832
    s_waitcnt lgkmcnt(2)
    v_mfma_f32_16x16x32_bf16 v[96:99], v[104:107], v[112:115], v[96:99]
    ds_read_b128 v[104:107], v58 offset:1344
    s_waitcnt lgkmcnt(2)
    v_mfma_f32_16x16x32_bf16 v[96:99], v[108:111], v[172:175], v[96:99]
    v_mfma_f32_16x16x32_bf16 v[92:95], v[108:111], v[168:171], v[92:95]
    v_mfma_f32_16x16x32_bf16 v[76:79], v[108:111], v[152:155], v[76:79]
    ds_read_b128 v[108:111], v58 offset:1856
    s_waitcnt lgkmcnt(2)
    v_mfma_f32_16x16x32_bf16 v[96:99], v[100:103], v[168:171], v[96:99]
    v_mfma_f32_16x16x32_bf16 v[92:95], v[100:103], v[164:167], v[92:95]
    v_mfma_f32_16x16x32_bf16 v[76:79], v[100:103], v[148:151], v[76:79]
    ds_read_b128 v[100:103], v58 offset:2368
    s_waitcnt lgkmcnt(2)
    v_mfma_f32_16x16x32_bf16 v[96:99], v[104:107], v[164:167], v[96:99]
    v_mfma_f32_16x16x32_bf16 v[92:95], v[104:107], v[160:163], v[92:95]
    v_mfma_f32_16x16x32_bf16 v[76:79], v[104:107], v[144:147], v[76:79]
    ds_read_b128 v[104:107], v58 offset:2880
    s_waitcnt lgkmcnt(2)
    v_mfma_f32_16x16x32_bf16 v[96:99], v[108:111], v[160:163], v[96:99]
    v_mfma_f32_16x16x32_bf16 v[92:95], v[108:111], v[156:159], v[92:95]
    ds_read_b128 v[108:111], v58 offset:3392
    s_waitcnt lgkmcnt(2)
    v_mfma_f32_16x16x32_bf16 v[96:99], v[100:103], v[156:159], v[96:99]
    v_mfma_f32_16x16x32_bf16 v[92:95], v[100:103], v[152:155], v[92:95]
    ds_read_b128 v[100:103], v58 offset:3904
    s_waitcnt lgkmcnt(2)
    v_mfma_f32_16x16x32_bf16 v[96:99], v[104:107], v[152:155], v[96:99]
    v_mfma_f32_16x16x32_bf16 v[92:95], v[104:107], v[148:151], v[92:95]
    s_waitcnt lgkmcnt(1)
    v_mfma_f32_16x16x32_bf16 v[96:99], v[108:111], v[148:151], v[96:99]
    v_mfma_f32_16x16x32_bf16 v[92:95], v[108:111], v[144:147], v[92:95]
    s_waitcnt lgkmcnt(0)
    v_mfma_f32_16x16x32_bf16 v[96:99], v[100:103], v[144:147], v[96:99]
    ds_write_b128 v66, v[76:79] offset:2048
    s_nop 4
    ds_write_b128 v66, v[92:95] offset:6144
    s_nop 0
    ds_write_b128 v66, v[96:99] offset:7168
    s_branch c_pw_end_23
c_pw_26:
    ds_read_b128 v[100:103], v58 offset:384
    ds_read_b128 v[112:115], v59 offset:96
    ds_read_b128 v[116:119], v59 offset:608
    ds_read_b128 v[120:123], v59 offset:1120
    ds_read_b128 v[124:127], v59 offset:1632
    ds_read_b128 v[128:131], v59 offset:2144
    ds_read_b128 v[132:135], v59 offset:2656
    ds_read_b128 v[136:139], v59 offset:3168
    ds_read_b128 v[140:143], v59 offset:3680
    ds_read_b128 v[104:107], v58 offset:896
    ds_read_b128 v[108:111], v58 offset:1408
    s_waitcnt lgkmcnt(2)
    v_mfma_f32_16x16x32_bf16 v[96:99], v[100:103], v[140:143], 0
    v_mfma_f32_16x16x32_bf16 v[92:95], v[100:103], v[136:139], 0
    v_mfma_f32_16x16x32_bf16 v[76:79], v[100:103], v[120:123], 0
    ds_read_b128 v[100:103], v58 offset:1920
    s_waitcnt lgkmcnt(2)
    v_mfma_f32_16x16x32_bf16 v[96:99], v[104:107], v[136:139], v[96:99]
    v_mfma_f32_16x16x32_bf16 v[92:95], v[104:107], v[132:135], v[92:95]
    v_mfma_f32_16x16x32_bf16 v[76:79], v[104:107], v[116:119], v[76:79]
    ds_read_b128 v[104:107], v58 offset:2432
    ds_read_b128 v[144:147], v59 offset:32
    ds_read_b128 v[148:151], v59 offset:544
    ds_read_b128 v[152:155], v59 offset:1056
    ds_read_b128 v[156:159], v59 offset:1568
    ds_read_b128 v[160:163], v59 offset:2080
    ds_read_b128 v[164:167], v59 offset:2592
    ds_read_b128 v[168:171], v59 offset:3104
    ds_read_b128 v[172:175], v59 offset:3616
    s_waitcnt lgkmcnt(10)
    v_mfma_f32_16x16x32_bf16 v[96:99], v[108:111], v[132:135], v[96:99]
    v_mfma_f32_16x16x32_bf16 v[92:95], v[108:111], v[128:131], v[92:95]
    v_mfma_f32_16x16x32_bf16 v[76:79], v[108:111], v[112:115], v[76:79]
    ds_read_b128 v[108:111], v58 offset:2944
    s_waitcnt lgkmcnt(10)
    v_mfma_f32_16x16x32_bf16 v[96:99], v[100:103], v[128:131], v[96:99]
    v_mfma_f32_16x16x32_bf16 v[92:95], v[100:103], v[124:127], v[92:95]
    ds_read_b128 v[100:103], v58 offset:3456
    s_waitcnt lgkmcnt(10)
    v_mfma_f32_16x16x32_bf16 v[96:99], v[104:107], v[124:127], v[96:99]
    v_mfma_f32_16x16x32_bf16 v[92:95], v[104:107], v[120:123], v[92:95]
    ds_read_b128 v[104:107], v58 offset:3968
    s_waitcnt lgkmcnt(2)
    v_mfma_f32_16x16x32_bf16 v[96:99], v[108:111], v[120:123], v[96:99]
    v_mfma_f32_16x16x32_bf16 v[92:95], v[108:111], v[116:119], v[92:95]
    ds_read_b128 v[108:111], v58 offset:448
    s_waitcnt lgkmcnt(2)
    v_mfma_f32_16x16x32_bf16 v[96:99], v[100:103], v[116:119], v[96:99]
    v_mfma_f32_16x16x32_bf16 v[92:95], v[100:103], v[112:115], v[92:95]
    ds_read_b128 v[100:103], v58 offset:960
    s_waitcnt lgkmcnt(2)
    v_mfma_f32_16x16x32_bf16 v[96:99], v[104:107], v[112:115], v[96:99]
    ds_read_b128 v[104:107], v58 offset:1472
    s_waitcnt lgkmcnt(2)
    v_mfma_f32_16x16x32_bf16 v[96:99], v[108:111], v[172:175], v[96:99]
    v_mfma_f32_16x16x32_bf16 v[92:95], v[108:111], v[168:171], v[92:95]
    v_mfma_f32_16x16x32_bf16 v[76:79], v[108:111], v[152:155], v[76:79]
    ds_read_b128 v[108:111], v58 offset:1984
    s_waitcnt lgkmcnt(2)
    v_mfma_f32_16x16x32_bf16 v[96:99], v[100:103], v[168:171], v[96:99]
    v_mfma_f32_16x16x32_bf16 v[92:95], v[100:103], v[164:167], v[92:95]
    v_mfma_f32_16x16x32_bf16 v[76:79], v[100:103], v[148:151], v[76:79]
    ds_read_b128 v[100:103], v58 offset:2496
    s_waitcnt lgkmcnt(2)
    v_mfma_f32_16x16x32_bf16 v[96:99], v[104:107], v[164:167], v[96:99]
    v_mfma_f32_16x16x32_bf16 v[92:95], v[104:107], v[160:163], v[92:95]
    v_mfma_f32_16x16x32_bf16 v[76:79], v[104:107], v[144:147], v[76:79]
    ds_read_b128 v[104:107], v58 offset:3008
    s_waitcnt lgkmcnt(2)
    v_mfma_f32_16x16x32_bf16 v[96:99], v[108:111], v[160:163], v[96:99]
    v_mfma_f32_16x16x32_bf16 v[92:95], v[108:111], v[156:159], v[92:95]
    ds_read_b128 v[108:111], v58 offset:3520
    s_waitcnt lgkmcnt(2)
    v_mfma_f32_16x16x32_bf16 v[96:99], v[100:103], v[156:159], v[96:99]
    v_mfma_f32_16x16x32_bf16 v[92:95], v[100:103], v[152:155], v[92:95]
    ds_read_b128 v[100:103], v58 offset:4032
    s_waitcnt lgkmcnt(2)
    v_mfma_f32_16x16x32_bf16 v[96:99], v[104:107], v[152:155], v[96:99]
    v_mfma_f32_16x16x32_bf16 v[92:95], v[104:107], v[148:151], v[92:95]
    s_waitcnt lgkmcnt(1)
    v_mfma_f32_16x16x32_bf16 v[96:99], v[108:111], v[148:151], v[96:99]
    v_mfma_f32_16x16x32_bf16 v[92:95], v[108:111], v[144:147], v[92:95]
    s_waitcnt lgkmcnt(0)
    v_mfma_f32_16x16x32_bf16 v[96:99], v[100:103], v[144:147], v[96:99]
    ds_write_b128 v66, v[76:79] offset:2048
    s_nop 4
    ds_write_b128 v66, v[92:95] offset:6144
    s_nop 0
    ds_write_b128 v66, v[96:99] offset:7168
c_pw_end_23:
    s_waitcnt lgkmcnt(0)
    s_barrier
    s_mov_b64 exec, 0
    s_cmp_eq_u32 s34, 0
    s_cselect_b32 exec_lo, 0, exec_lo
    s_cselect_b32 exec_hi, 0, exec_hi
    s_cmp_eq_u32 s34, 1
    s_cselect_b32 exec_lo, -1, exec_lo
    s_cselect_b32 exec_hi, 0, exec_hi
    s_cmp_eq_u32 s34, 2
    s_cselect_b32 exec_lo, 0, exec_lo
    s_cselect_b32 exec_hi, 0, exec_hi
    s_cmp_eq_u32 s34, 3
    s_cselect_b32 exec_lo, -1, exec_lo
    s_cselect_b32 exec_hi, -1, exec_hi
    s_cbranch_execz c_fskip_29
    ds_read_b128 v[112:115], v67 offset:0
    ds_read_b128 v[116:119], v67 offset:16
    ds_read_b128 v[120:123], v67 offset:8192
    ds_read_b128 v[124:127], v67 offset:8208
    ds_read_b128 v[128:131], v67 offset:16384
    ds_read_b128 v[132:135], v67 offset:16400
    ds_read_b128 v[136:139], v67 offset:24576
    ds_read_b128 v[140:143], v67 offset:24592
    s_lshl_b32 s40, s58, 12
    s_add_u32 s40, s40, 8912896
    s_waitcnt lgkmcnt(0)
    v_pk_add_f32 v[112:113], v[112:113], v[120:121]
    v_pk_add_f32 v[128:129], v[128:129], v[136:137]
    v_pk_add_f32 v[114:115], v[114:115], v[122:123]
    v_pk_add_f32 v[130:131], v[130:131], v[138:139]
    v_pk_add_f32 v[116:117], v[116:117], v[124:125]
    v_pk_add_f32 v[132:133], v[132:133], v[140:141]
    v_pk_add_f32 v[118:119], v[118:119], v[126:127]
    v_pk_add_f32 v[134:135], v[134:135], v[142:143]
    v_pk_add_f32 v[112:113], v[112:113], v[128:129]
    v_pk_add_f32 v[114:115], v[114:115], v[130:131]
    v_pk_add_f32 v[116:117], v[116:117], v[132:133]
    v_pk_add_f32 v[118:119], v[118:119], v[134:135]
    v_cvt_pk_bf16_f32 v184, v112, v113
    v_cvt_pk_bf16_f32 v185, v114, v115
    v_cvt_pk_bf16_f32 v186, v116, v117
    v_cvt_pk_bf16_f32 v187, v118, v119
    buffer_store_dwordx4 v[184:187], v2, s[8:11], s40 offen sc1
c_fskip_29:
    s_mov_b64 exec, -1
    s_nop 1
    s_branch c_halfE_22
c_halfB_21:
    s_cmp_lg_u32 s34, 0
    s_cbranch_scc1 c_pw_31
    ds_read_b128 v[100:103], v58 offset:0
    ds_read_b128 v[112:115], v59 offset:480
    ds_read_b128 v[116:119], v59 offset:992
    ds_read_b128 v[120:123], v59 offset:1504
    ds_read_b128 v[124:127], v59 offset:2016
    ds_read_b128 v[128:131], v59 offset:2528
    ds_read_b128 v[132:135], v59 offset:3040
    ds_read_b128 v[104:107], v58 offset:512
    ds_read_b128 v[108:111], v58 offset:1024
    s_waitcnt lgkmcnt(2)
    v_mfma_f32_16x16x32_bf16 v[88:91], v[100:103], v[132:135], 0
    v_mfma_f32_16x16x32_bf16 v[84:87], v[100:103], v[128:131], 0
    v_mfma_f32_16x16x32_bf16 v[80:83], v[100:103], v[124:127], 0
    v_mfma_f32_16x16x32_bf16 v[72:75], v[100:103], v[116:119], 0
    v_mfma_f32_16x16x32_bf16 v[68:71], v[100:103], v[112:115], 0
    v_mfma_f32_16x16x32_bf16 v[68:71], v[188:191], v[112:115], v[68:71]
    v_mfma_f32_16x16x32_bf16 v[72:75], v[188:191], v[116:119], v[72:75]
    v_mfma_f32_16x16x32_bf16 v[80:83], v[188:191], v[124:127], v[80:83]
    v_mfma_f32_16x16x32_bf16 v[84:87], v[188:191], v[128:131], v[84:87]
    v_mfma_f32_16x16x32_bf16 v[88:91], v[188:191], v[132:135], v[88:91]
    ds_read_b128 v[100:103], v58 offset:1536
    s_waitcnt lgkmcnt(2)
    v_mfma_f32_16x16x32_bf16 v[88:91], v[104:107], v[128:131], v[88:91]
    v_mfma_f32_16x16x32_bf16 v[84:87], v[104:107], v[124:127], v[84:87]
    v_mfma_f32_16x16x32_bf16 v[80:83], v[104:107], v[120:123], v[80:83]
    v_mfma_f32_16x16x32_bf16 v[72:75], v[104:107], v[112:115], v[72:75]
    ds_read_b128 v[104:107], v58 offset:2048
    ds_read_b128 v[144:147], v59 offset:416
    ds_read_b128 v[148:151], v59 offset:928
    ds_read_b128 v[152:155], v59 offset:1440
    ds_read_b128 v[156:159], v59 offset:1952
    ds_read_b128 v[160:163], v59 offset:2464
    ds_read_b128 v[164:167], v59 offset:2976
    s_waitcnt lgkmcnt(8)
    v_mfma_f32_16x16x32_bf16 v[88:91], v[108:111], v[124:127], v[88:91]
    v_mfma_f32_16x16x32_bf16 v[84:87], v[108:111], v[120:123], v[84:87]
    v_mfma_f32_16x16x32_bf16 v[80:83], v[108:111], v[116:119], v[80:83]
    ds_read_b128 v[108:111], v58 offset:2560
    s_waitcnt lgkmcnt(8)
    v_mfma_f32_16x16x32_bf16 v[88:91], v[100:103], v[120:123], v[88:91]
    v_mfma_f32_16x16x32_bf16 v[84:87], v[100:103], v[116:119], v[84:87]
    v_mfma_f32_16x16x32_bf16 v[80:83], v[100:103], v[112:115], v[80:83]
    ds_read_b128 v[100:103], v58 offset:64
    s_waitcnt lgkmcnt(8)
    v_mfma_f32_16x16x32_bf16 v[88:91], v[104:107], v[116:119], v[88:91]
    v_mfma_f32_16x16x32_bf16 v[84:87], v[104:107], v[112:115], v[84:87]
    ds_read_b128 v[104:107], v58 offset:576
    s_waitcnt lgkmcnt(2)
    v_mfma_f32_16x16x32_bf16 v[88:91], v[108:111], v[112:115], v[88:91]
    ds_read_b128 v[108:111], v58 offset:1088
    s_waitcnt lgkmcnt(2)
    v_mfma_f32_16x16x32_bf16 v[88:91], v[100:103], v[164:167], v[88:91]
    v_mfma_f32_16x16x32_bf16 v[84:87], v[100:103], v[160:163], v[84:87]
    v_mfma_f32_16x16x32_bf16 v[80:83], v[100:103], v[156:159], v[80:83]
    v_mfma_f32_16x16x32_bf16 v[72:75], v[100:103], v[148:151], v[72:75]
    v_mfma_f32_16x16x32_bf16 v[68:71], v[100:103], v[144:147], v[68:71]
    ds_read_b128 v[100:103], v58 offset:1600
    s_waitcnt lgkmcnt(2)
    v_mfma_f32_16x16x32_bf16 v[88:91], v[104:107], v[160:163], v[88:91]
    v_mfma_f32_16x16x32_bf16 v[84:87], v[104:107], v[156:159], v[84:87]
    v_mfma_f32_16x16x32_bf16 v[80:83], v[104:107], v[152:155], v[80:83]
    v_mfma_f32_16x16x32_bf16 v[72:75], v[104:107], v[144:147], v[72:75]
    ds_read_b128 v[104:107], v58 offset:2112
    s_waitcnt lgkmcnt(2)
    v_mfma_f32_16x16x32_bf16 v[88:91], v[108:111], v[156:159], v[88:91]
    v_mfma_f32_16x16x32_bf16 v[84:87], v[108:111], v[152:155], v[84:87]
    v_mfma_f32_16x16x32_bf16 v[80:83], v[108:111], v[148:151], v[80:83]
    ds_read_b128 v[108:111], v58 offset:2624
    s_waitcnt lgkmcnt(2)
    v_mfma_f32_16x16x32_bf16 v[88:91], v[100:103], v[152:155], v[88:91]
    v_mfma_f32_16x16x32_bf16 v[84:87], v[100:103], v[148:151], v[84:87]
    v_mfma_f32_16x16x32_bf16 v[80:83], v[100:103], v[144:147], v[80:83]
    s_waitcnt lgkmcnt(1)
    v_mfma_f32_16x16x32_bf16 v[88:91], v[104:107], v[148:151], v[88:91]
    v_mfma_f32_16x16x32_bf16 v[84:87], v[104:107], v[144:147], v[84:87]
    s_waitcnt lgkmcnt(0)
    v_mfma_f32_16x16x32_bf16 v[88:91], v[108:111], v[144:147], v[88:91]
    ds_write_b128 v66, v[68:71] offset:0
    ds_write_b128 v66, v[72:75] offset:1024
    s_nop 0
    ds_write_b128 v66, v[80:83] offset:3072
    s_nop 1
    ds_write_b128 v66, v[84:87] offset:4096
    s_nop 0
    ds_write_b128 v66, v[88:91] offset:5120
    s_branch c_pw_end_30
c_pw_31:
    s_cmp_lg_u32 s34, 1
    s_cbranch_scc1 c_pw_32
    ds_read_b128 v[100:103], v58 offset:128
    ds_read_b128 v[112:115], v59 offset:352
    ds_read_b128 v[116:119], v59 offset:864
    ds_read_b128 v[120:123], v59 offset:1376
    ds_read_b128 v[124:127], v59 offset:1888
    ds_read_b128 v[128:131], v59 offset:2400
    ds_read_b128 v[132:135], v59 offset:2912
    ds_read_b128 v[104:107], v58 offset:640
    ds_read_b128 v[108:111], v58 offset:1152
    s_waitcnt lgkmcnt(2)
    v_mfma_f32_16x16x32_bf16 v[88:91], v[100:103], v[132:135], 0
    v_mfma_f32_16x16x32_bf16 v[84:87], v[100:103], v[128:131], 0
    v_mfma_f32_16x16x32_bf16 v[80:83], v[100:103], v[124:127], 0
    v_mfma_f32_16x16x32_bf16 v[72:75], v[100:103], v[116:119], 0
    v_mfma_f32_16x16x32_bf16 v[68:71], v[100:103], v[112:115], 0
    ds_read_b128 v[100:103], v58 offset:1664
    s_waitcnt lgkmcnt(2)
    v_mfma_f32_16x16x32_bf16 v[88:91], v[104:107], v[128:131], v[88:91]
    v_mfma_f32_16x16x32_bf16 v[84:87], v[104:107], v[124:127], v[84:87]
    v_mfma_f32_16x16x32_bf16 v[80:83], v[104:107], v[120:123], v[80:83]
    v_mfma_f32_16x16x32_bf16 v[72:75], v[104:107], v[112:115], v[72:75]
    ds_read_b128 v[104:107], v58 offset:2176
    ds_read_b128 v[144:147], v59 offset:288
    ds_read_b128 v[148:151], v59 offset:800
    ds_read_b128 v[152:155], v59 offset:1312
    ds_read_b128 v[156:159], v59 offset:1824
    ds_read_b128 v[160:163], v59 offset:2336
    ds_read_b128 v[164:167], v59 offset:2848
    s_waitcnt lgkmcnt(8)
    v_mfma_f32_16x16x32_bf16 v[88:91], v[108:111], v[124:127], v[88:91]
    v_mfma_f32_16x16x32_bf16 v[84:87], v[108:111], v[120:123], v[84:87]
    v_mfma_f32_16x16x32_bf16 v[80:83], v[108:111], v[116:119], v[80:83]
    ds_read_b128 v[108:111], v58 offset:2688
    s_waitcnt lgkmcnt(8)
    v_mfma_f32_16x16x32_bf16 v[88:91], v[100:103], v[120:123], v[88:91]
    v_mfma_f32_16x16x32_bf16 v[84:87], v[100:103], v[116:119], v[84:87]
    v_mfma_f32_16x16x32_bf16 v[80:83], v[100:103], v[112:115], v[80:83]
    ds_read_b128 v[100:103], v58 offset:192
    s_waitcnt lgkmcnt(8)
    v_mfma_f32_16x16x32_bf16 v[88:91], v[104:107], v[116:119], v[88:91]
    v_mfma_f32_16x16x32_bf16 v[84:87], v[104:107], v[112:115], v[84:87]
    ds_read_b128 v[104:107], v58 offset:704
    s_waitcnt lgkmcnt(2)
    v_mfma_f32_16x16x32_bf16 v[88:91], v[108:111], v[112:115], v[88:91]
    ds_read_b128 v[108:111], v58 offset:1216
    s_waitcnt lgkmcnt(2)
    v_mfma_f32_16x16x32_bf16 v[88:91], v[100:103], v[164:167], v[88:91]
    v_mfma_f32_16x16x32_bf16 v[84:87], v[100:103], v[160:163], v[84:87]
    v_mfma_f32_16x16x32_bf16 v[80:83], v[100:103], v[156:159], v[80:83]
    v_mfma_f32_16x16x32_bf16 v[72:75], v[100:103], v[148:151], v[72:75]
    v_mfma_f32_16x16x32_bf16 v[68:71], v[100:103], v[144:147], v[68:71]
    ds_read_b128 v[100:103], v58 offset:1728
    s_waitcnt lgkmcnt(2)
    v_mfma_f32_16x16x32_bf16 v[88:91], v[104:107], v[160:163], v[88:91]
    v_mfma_f32_16x16x32_bf16 v[84:87], v[104:107], v[156:159], v[84:87]
    v_mfma_f32_16x16x32_bf16 v[80:83], v[104:107], v[152:155], v[80:83]
    v_mfma_f32_16x16x32_bf16 v[72:75], v[104:107], v[144:147], v[72:75]
    ds_read_b128 v[104:107], v58 offset:2240
    s_waitcnt lgkmcnt(2)
    v_mfma_f32_16x16x32_bf16 v[88:91], v[108:111], v[156:159], v[88:91]
    v_mfma_f32_16x16x32_bf16 v[84:87], v[108:111], v[152:155], v[84:87]
    v_mfma_f32_16x16x32_bf16 v[80:83], v[108:111], v[148:151], v[80:83]
    ds_read_b128 v[108:111], v58 offset:2752
    s_waitcnt lgkmcnt(2)
    v_mfma_f32_16x16x32_bf16 v[88:91], v[100:103], v[152:155], v[88:91]
    v_mfma_f32_16x16x32_bf16 v[84:87], v[100:103], v[148:151], v[84:87]
    v_mfma_f32_16x16x32_bf16 v[80:83], v[100:103], v[144:147], v[80:83]
    s_waitcnt lgkmcnt(1)
    v_mfma_f32_16x16x32_bf16 v[88:91], v[104:107], v[148:151], v[88:91]
    v_mfma_f32_16x16x32_bf16 v[84:87], v[104:107], v[144:147], v[84:87]
    s_waitcnt lgkmcnt(0)
    v_mfma_f32_16x16x32_bf16 v[88:91], v[108:111], v[144:147], v[88:91]
    ds_write_b128 v66, v[68:71] offset:0
    ds_write_b128 v66, v[72:75] offset:1024
    s_nop 0
    ds_write_b128 v66, v[80:83] offset:3072
    s_nop 1
    ds_write_b128 v66, v[84:87] offset:4096
    s_nop 0
    ds_write_b128 v66, v[88:91] offset:5120
    s_branch c_pw_end_30
c_pw_32:
    s_cmp_lg_u32 s34, 2
    s_cbranch_scc1 c_pw_33
    ds_read_b128 v[100:103], v58 offset:256
    ds_read_b128 v[112:115], v59 offset:224
    ds_read_b128 v[116:119], v59 offset:736
    ds_read_b128 v[120:123], v59 offset:1248
    ds_read_b128 v[124:127], v59 offset:1760
    ds_read_b128 v[128:131], v59 offset:2272
    ds_read_b128 v[132:135], v59 offset:2784
    ds_read_b128 v[104:107], v58 offset:768
    ds_read_b128 v[108:111], v58 offset:1280
    s_waitcnt lgkmcnt(2)
    v_mfma_f32_16x16x32_bf16 v[88:91], v[100:103], v[132:135], 0
    v_mfma_f32_16x16x32_bf16 v[84:87], v[100:103], v[128:131], 0
    v_mfma_f32_16x16x32_bf16 v[80:83], v[100:103], v[124:127], 0
    v_mfma_f32_16x16x32_bf16 v[72:75], v[100:103], v[116:119], 0
    v_mfma_f32_16x16x32_bf16 v[68:71], v[100:103], v[112:115], 0
    ds_read_b128 v[100:103], v58 offset:1792
    s_waitcnt lgkmcnt(2)
    v_mfma_f32_16x16x32_bf16 v[88:91], v[104:107], v[128:131], v[88:91]
    v_mfma_f32_16x16x32_bf16 v[84:87], v[104:107], v[124:127], v[84:87]
    v_mfma_f32_16x16x32_bf16 v[80:83], v[104:107], v[120:123], v[80:83]
    v_mfma_f32_16x16x32_bf16 v[72:75], v[104:107], v[112:115], v[72:75]
    ds_read_b128 v[104:107], v58 offset:2304
    ds_read_b128 v[144:147], v59 offset:160
    ds_read_b128 v[148:151], v59 offset:672
    ds_read_b128 v[152:155], v59 offset:1184
    ds_read_b128 v[156:159], v59 offset:1696
    ds_read_b128 v[160:163], v59 offset:2208
    ds_read_b128 v[164:167], v59 offset:2720
    s_waitcnt lgkmcnt(8)
    v_mfma_f32_16x16x32_bf16 v[88:91], v[108:111], v[124:127], v[88:91]
    v_mfma_f32_16x16x32_bf16 v[84:87], v[108:111], v[120:123], v[84:87]
    v_mfma_f32_16x16x32_bf16 v[80:83], v[108:111], v[116:119], v[80:83]
    ds_read_b128 v[108:111], v58 offset:2816
    s_waitcnt lgkmcnt(8)
    v_mfma_f32_16x16x32_bf16 v[88:91], v[100:103], v[120:123], v[88:91]
    v_mfma_f32_16x16x32_bf16 v[84:87], v[100:103], v[116:119], v[84:87]
    v_mfma_f32_16x16x32_bf16 v[80:83], v[100:103], v[112:115], v[80:83]
    ds_read_b128 v[100:103], v58 offset:320
    s_waitcnt lgkmcnt(8)
    v_mfma_f32_16x16x32_bf16 v[88:91], v[104:107], v[116:119], v[88:91]
    v_mfma_f32_16x16x32_bf16 v[84:87], v[104:107], v[112:115], v[84:87]
    ds_read_b128 v[104:107], v58 offset:832
    s_waitcnt lgkmcnt(2)
    v_mfma_f32_16x16x32_bf16 v[88:91], v[108:111], v[112:115], v[88:91]
    ds_read_b128 v[108:111], v58 offset:1344
    s_waitcnt lgkmcnt(2)
    v_mfma_f32_16x16x32_bf16 v[88:91], v[100:103], v[164:167], v[88:91]
    v_mfma_f32_16x16x32_bf16 v[84:87], v[100:103], v[160:163], v[84:87]
    v_mfma_f32_16x16x32_bf16 v[80:83], v[100:103], v[156:159], v[80:83]
    v_mfma_f32_16x16x32_bf16 v[72:75], v[100:103], v[148:151], v[72:75]
    v_mfma_f32_16x16x32_bf16 v[68:71], v[100:103], v[144:147], v[68:71]
    ds_read_b128 v[100:103], v58 offset:1856
    s_waitcnt lgkmcnt(2)
    v_mfma_f32_16x16x32_bf16 v[88:91], v[104:107], v[160:163], v[88:91]
    v_mfma_f32_16x16x32_bf16 v[84:87], v[104:107], v[156:159], v[84:87]
    v_mfma_f32_16x16x32_bf16 v[80:83], v[104:107], v[152:155], v[80:83]
    v_mfma_f32_16x16x32_bf16 v[72:75], v[104:107], v[144:147], v[72:75]
    ds_read_b128 v[104:107], v58 offset:2368
    s_waitcnt lgkmcnt(2)
    v_mfma_f32_16x16x32_bf16 v[88:91], v[108:111], v[156:159], v[88:91]
    v_mfma_f32_16x16x32_bf16 v[84:87], v[108:111], v[152:155], v[84:87]
    v_mfma_f32_16x16x32_bf16 v[80:83], v[108:111], v[148:151], v[80:83]
    ds_read_b128 v[108:111], v58 offset:2880
    s_waitcnt lgkmcnt(2)
    v_mfma_f32_16x16x32_bf16 v[88:91], v[100:103], v[152:155], v[88:91]
    v_mfma_f32_16x16x32_bf16 v[84:87], v[100:103], v[148:151], v[84:87]
    v_mfma_f32_16x16x32_bf16 v[80:83], v[100:103], v[144:147], v[80:83]
    s_waitcnt lgkmcnt(1)
    v_mfma_f32_16x16x32_bf16 v[88:91], v[104:107], v[148:151], v[88:91]
    v_mfma_f32_16x16x32_bf16 v[84:87], v[104:107], v[144:147], v[84:87]
    s_waitcnt lgkmcnt(0)
    v_mfma_f32_16x16x32_bf16 v[88:91], v[108:111], v[144:147], v[88:91]
    ds_write_b128 v66, v[68:71] offset:0
    ds_write_b128 v66, v[72:75] offset:1024
    s_nop 0
    ds_write_b128 v66, v[80:83] offset:3072
    s_nop 1
    ds_write_b128 v66, v[84:87] offset:4096
    s_nop 0
    ds_write_b128 v66, v[88:91] offset:5120
    s_branch c_pw_end_30
c_pw_33:
    ds_read_b128 v[100:103], v58 offset:384
    ds_read_b128 v[112:115], v59 offset:96
    ds_read_b128 v[116:119], v59 offset:608
    ds_read_b128 v[120:123], v59 offset:1120
    ds_read_b128 v[124:127], v59 offset:1632
    ds_read_b128 v[128:131], v59 offset:2144
    ds_read_b128 v[132:135], v59 offset:2656
    ds_read_b128 v[104:107], v58 offset:896
    ds_read_b128 v[108:111], v58 offset:1408
    s_waitcnt lgkmcnt(2)
    v_mfma_f32_16x16x32_bf16 v[88:91], v[100:103], v[132:135], 0
    v_mfma_f32_16x16x32_bf16 v[84:87], v[100:103], v[128:131], 0
    v_mfma_f32_16x16x32_bf16 v[80:83], v[100:103], v[124:127], 0
    v_mfma_f32_16x16x32_bf16 v[72:75], v[100:103], v[116:119], 0
    v_mfma_f32_16x16x32_bf16 v[68:71], v[100:103], v[112:115], 0
    ds_read_b128 v[100:103], v58 offset:1920
    s_waitcnt lgkmcnt(2)
    v_mfma_f32_16x16x32_bf16 v[88:91], v[104:107], v[128:131], v[88:91]
    v_mfma_f32_16x16x32_bf16 v[84:87], v[104:107], v[124:127], v[84:87]
    v_mfma_f32_16x16x32_bf16 v[80:83], v[104:107], v[120:123], v[80:83]
    v_mfma_f32_16x16x32_bf16 v[72:75], v[104:107], v[112:115], v[72:75]
    ds_read_b128 v[104:107], v58 offset:2432
    ds_read_b128 v[144:147], v59 offset:32
    ds_read_b128 v[148:151], v59 offset:544
    ds_read_b128 v[152:155], v59 offset:1056
    ds_read_b128 v[156:159], v59 offset:1568
    ds_read_b128 v[160:163], v59 offset:2080
    ds_read_b128 v[164:167], v59 offset:2592
    s_waitcnt lgkmcnt(8)
    v_mfma_f32_16x16x32_bf16 v[88:91], v[108:111], v[124:127], v[88:91]
    v_mfma_f32_16x16x32_bf16 v[84:87], v[108:111], v[120:123], v[84:87]
    v_mfma_f32_16x16x32_bf16 v[80:83], v[108:111], v[116:119], v[80:83]
    ds_read_b128 v[108:111], v58 offset:2944
    s_waitcnt lgkmcnt(8)
    v_mfma_f32_16x16x32_bf16 v[88:91], v[100:103], v[120:123], v[88:91]
    v_mfma_f32_16x16x32_bf16 v[84:87], v[100:103], v[116:119], v[84:87]
    v_mfma_f32_16x16x32_bf16 v[80:83], v[100:103], v[112:115], v[80:83]
    ds_read_b128 v[100:103], v58 offset:448
    s_waitcnt lgkmcnt(8)
    v_mfma_f32_16x16x32_bf16 v[88:91], v[104:107], v[116:119], v[88:91]
    v_mfma_f32_16x16x32_bf16 v[84:87], v[104:107], v[112:115], v[84:87]
    ds_read_b128 v[104:107], v58 offset:960
    s_waitcnt lgkmcnt(2)
    v_mfma_f32_16x16x32_bf16 v[88:91], v[108:111], v[112:115], v[88:91]
    ds_read_b128 v[108:111], v58 offset:1472
    s_waitcnt lgkmcnt(2)
    v_mfma_f32_16x16x32_bf16 v[88:91], v[100:103], v[164:167], v[88:91]
    v_mfma_f32_16x16x32_bf16 v[84:87], v[100:103], v[160:163], v[84:87]
    v_mfma_f32_16x16x32_bf16 v[80:83], v[100:103], v[156:159], v[80:83]
    v_mfma_f32_16x16x32_bf16 v[72:75], v[100:103], v[148:151], v[72:75]
    v_mfma_f32_16x16x32_bf16 v[68:71], v[100:103], v[144:147], v[68:71]
    ds_read_b128 v[100:103], v58 offset:1984
    s_waitcnt lgkmcnt(2)
    v_mfma_f32_16x16x32_bf16 v[88:91], v[104:107], v[160:163], v[88:91]
    v_mfma_f32_16x16x32_bf16 v[84:87], v[104:107], v[156:159], v[84:87]
    v_mfma_f32_16x16x32_bf16 v[80:83], v[104:107], v[152:155], v[80:83]
    v_mfma_f32_16x16x32_bf16 v[72:75], v[104:107], v[144:147], v[72:75]
    ds_read_b128 v[104:107], v58 offset:2496
    s_waitcnt lgkmcnt(2)
    v_mfma_f32_16x16x32_bf16 v[88:91], v[108:111], v[156:159], v[88:91]
    v_mfma_f32_16x16x32_bf16 v[84:87], v[108:111], v[152:155], v[84:87]
    v_mfma_f32_16x16x32_bf16 v[80:83], v[108:111], v[148:151], v[80:83]
    ds_read_b128 v[108:111], v58 offset:3008
    s_waitcnt lgkmcnt(2)
    v_mfma_f32_16x16x32_bf16 v[88:91], v[100:103], v[152:155], v[88:91]
    v_mfma_f32_16x16x32_bf16 v[84:87], v[100:103], v[148:151], v[84:87]
    v_mfma_f32_16x16x32_bf16 v[80:83], v[100:103], v[144:147], v[80:83]
    s_waitcnt lgkmcnt(1)
    v_mfma_f32_16x16x32_bf16 v[88:91], v[104:107], v[148:151], v[88:91]
    v_mfma_f32_16x16x32_bf16 v[84:87], v[104:107], v[144:147], v[84:87]
    s_waitcnt lgkmcnt(0)
    v_mfma_f32_16x16x32_bf16 v[88:91], v[108:111], v[144:147], v[88:91]
    ds_write_b128 v66, v[68:71] offset:0
    ds_write_b128 v66, v[72:75] offset:1024
    s_nop 0
    ds_write_b128 v66, v[80:83] offset:3072
    s_nop 1
    ds_write_b128 v66, v[84:87] offset:4096
    s_nop 0
    ds_write_b128 v66, v[88:91] offset:5120
c_pw_end_30:
    s_waitcnt lgkmcnt(0)
    s_barrier
    s_mov_b64 exec, 0
    s_cmp_eq_u32 s34, 0
    s_cselect_b32 exec_lo, -1, exec_lo
    s_cselect_b32 exec_hi, -1, exec_hi
    s_cmp_eq_u32 s34, 1
    s_cselect_b32 exec_lo, 0, exec_lo
    s_cselect_b32 exec_hi, -1, exec_hi
    s_cmp_eq_u32 s34, 2
    s_cselect_b32 exec_lo, -1, exec_lo
    s_cselect_b32 exec_hi, -1, exec_hi
    s_cmp_eq_u32 s34, 3
    s_cselect_b32 exec_lo, 0, exec_lo
    s_cselect_b32 exec_hi, 0, exec_hi
    s_cbranch_execz c_fskip_36
    ds_read_b128 v[112:115], v67 offset:0
    ds_read_b128 v[116:119], v67 offset:16
    ds_read_b128 v[120:123], v67 offset:8192
    ds_read_b128 v[124:127], v67 offset:8208
    ds_read_b128 v[128:131], v67 offset:16384
    ds_read_b128 v[132:135], v67 offset:16400
    ds_read_b128 v[136:139], v67 offset:24576
    ds_read_b128 v[140:143], v67 offset:24592
    s_lshl_b32 s40, s58, 12
    s_add_u32 s40, s40, 8912896
    s_waitcnt lgkmcnt(0)
    v_pk_add_f32 v[112:113], v[112:113], v[120:121]
    v_pk_add_f32 v[128:129], v[128:129], v[136:137]
    v_pk_add_f32 v[114:115], v[114:115], v[122:123]
    v_pk_add_f32 v[130:131], v[130:131], v[138:139]
    v_pk_add_f32 v[116:117], v[116:117], v[124:125]
    v_pk_add_f32 v[132:133], v[132:133], v[140:141]
    v_pk_add_f32 v[118:119], v[118:119], v[126:127]
    v_pk_add_f32 v[134:135], v[134:135], v[142:143]
    v_pk_add_f32 v[112:113], v[112:113], v[128:129]
    v_pk_add_f32 v[114:115], v[114:115], v[130:131]
    v_pk_add_f32 v[116:117], v[116:117], v[132:133]
    v_pk_add_f32 v[118:119], v[118:119], v[134:135]
    v_cvt_pk_bf16_f32 v184, v112, v113
    v_cvt_pk_bf16_f32 v185, v114, v115
    v_cvt_pk_bf16_f32 v186, v116, v117
    v_cvt_pk_bf16_f32 v187, v118, v119
    buffer_store_dwordx4 v[184:187], v2, s[8:11], s40 offen sc1
c_fskip_36:
    s_mov_b64 exec, -1
    s_nop 1
c_halfE_22:
k2_kernel_end:
    s_endpgm

.globl k3_kernel
.p2align 8
.type k3_kernel,@function
k3_kernel:
    s_cmp_ge_u32 s2, 256
    s_cbranch_scc1 k3_kernel_end
    s_load_dwordx2 s[12:13], s[0:1], 104
    s_load_dwordx2 s[8:9], s[0:1], 0
    s_load_dwordx2 s[16:17], s[0:1], 88
    s_mov_b32 s10, 2621440
    s_mov_b32 s11, 0x20000
    s_mov_b32 s14, 15990784
    s_mov_b32 s15, 0x20000
    s_mov_b32 s18, 2621440
    s_mov_b32 s19, 0x20000
    v_lshrrev_b32 v4, 6, v0
    v_and_b32 v1, 63, v0
    v_readfirstlane_b32 s34, v4
    v_lshlrev_b32 v7, 4, v1
    s_and_b32 s40, s2, 7
    s_lshr_b32 s41, s2, 3
    s_lshr_b32 s32, s40, 1
    s_lshl_b32 s32, s32, 3
    s_and_b32 s42, s41, 7
    s_add_u32 s32, s32, s42
    s_and_b32 s33, s40, 1
    s_lshl_b32 s33, s33, 2
    s_lshr_b32 s42, s41, 3
    s_add_u32 s33, s33, s42
    s_add_u32 s40, s32, s33
    s_mul_i32 s41, s40, 43
    s_lshr_b32 s41, s41, 8
    s_mul_i32 s41, s41, 6
    s_sub_u32 s48, s40, s41
    s_mul_i32 s46, s33, 122880
    s_add_u32 s46, s46, 15007744
    s_mul_i32 s40, s34, 5120
    s_add_u32 s46, s46, s40
    s_mul_i32 s47, s32, 98304
    s_mul_i32 s41, s34, 24576
    s_add_u32 s47, s47, s41
    s_add_u32 s47, s47, 11534336
    s_add_u32 s40, s48, 0
    s_sub_u32 s41, s40, 6
    s_cmp_ge_u32 s40, 6
    s_cselect_b32 s50, s41, s40
    s_add_u32 s40, s48, 1
    s_sub_u32 s41, s40, 6
    s_cmp_ge_u32 s40, 6
    s_cselect_b32 s51, s41, s40
    s_add_u32 s40, s48, 2
    s_sub_u32 s41, s40, 6
    s_cmp_ge_u32 s40, 6
    s_cselect_b32 s52, s41, s40
    s_add_u32 s40, s48, 3
    s_sub_u32 s41, s40, 6
    s_cmp_ge_u32 s40, 6
    s_cselect_b32 s53, s41, s40
    s_add_u32 s40, s48, 4
    s_sub_u32 s41, s40, 6
    s_cmp_ge_u32 s40, 6
    s_cselect_b32 s54, s41, s40
    s_add_u32 s40, s48, 5
    s_sub_u32 s41, s40, 6
    s_cmp_ge_u32 s40, 6
    s_cselect_b32 s55, s41, s40
    s_waitcnt lgkmcnt(0)
    s_mul_i32 s40, s50, 20480
    s_add_u32 s40, s40, s46
    s_add_u32 s40, s40, 0
    s_mul_i32 s41, s34, 5120
    s_add_u32 m0, s41, 0
    s_nop 0
    buffer_load_dwordx4 v7, s[12:15], s40 offen lds
    s_mul_i32 s40, s50, 20480
    s_add_u32 s40, s40, s46
    s_add_u32 s40, s40, 1024
    s_mul_i32 s41, s34, 5120
    s_add_u32 m0, s41, 1024
    s_nop 0
    buffer_load_dwordx4 v7, s[12:15], s40 offen lds
    s_mul_i32 s40, s50, 20480
    s_add_u32 s40, s40, s46
    s_add_u32 s40, s40, 2048
    s_mul_i32 s41, s34, 5120
    s_add_u32 m0, s41, 2048
    s_nop 0
    buffer_load_dwordx4 v7, s[12:15], s40 offen lds
    s_mul_i32 s40, s50, 20480
    s_add_u32 s40, s40, s46
    s_add_u32 s40, s40, 3072
    s_mul_i32 s41, s34, 5120
    s_add_u32 m0, s41, 3072
    s_nop 0
    buffer_load_dwordx4 v7, s[12:15], s40 offen lds
    s_mul_i32 s40, s50, 20480
    s_add_u32 s40, s40, s46
    s_add_u32 s40, s40, 4096
    s_mul_i32 s41, s34, 5120
    s_add_u32 m0, s41, 4096
    s_nop 0
    buffer_load_dwordx4 v7, s[12:15], s40 offen lds
    s_lshl_b32 s42, s50, 12
    s_add_u32 s42, s42, s47
    buffer_load_dwordx4 v[8:11], v7, s[12:15], s42 offen offset:0
    s_lshl_b32 s42, s50, 12
    s_add_u32 s42, s42, s47
    buffer_load_dwordx4 v[12:15], v7, s[12:15], s42 offen offset:1024
    s_lshl_b32 s42, s50, 12
    s_add_u32 s42, s42, s47
    buffer_load_dwordx4 v[16:19], v7, s[12:15], s42 offen offset:2048
    s_lshl_b32 s42, s50, 12
    s_add_u32 s42, s42, s47
    buffer_load_dwordx4 v[20:23], v7, s[12:15], s42 offen offset:3072
    s_barrier
    s_mul_i32 s40, s51, 20480
    s_add_u32 s40, s40, s46
    s_add_u32 s40, s40, 0
    s_mul_i32 s41, s34, 5120
    s_add_u32 m0, s41, 20480
    s_nop 0
    buffer_load_dwordx4 v7, s[12:15], s40 offen lds
    s_mul_i32 s40, s51, 20480
    s_add_u32 s40, s40, s46
    s_add_u32 s40, s40, 1024
    s_mul_i32 s41, s34, 5120
    s_add_u32 m0, s41, 21504
    s_nop 0
    buffer_load_dwordx4 v7, s[12:15], s40 offen lds
    s_mul_i32 s40, s51, 20480
    s_add_u32 s40, s40, s46
    s_add_u32 s40, s40, 2048
    s_mul_i32 s41, s34, 5120
    s_add_u32 m0, s41, 22528
    s_nop 0
    buffer_load_dwordx4 v7, s[12:15], s40 offen lds
    s_mul_i32 s40, s51, 20480
    s_add_u32 s40, s40, s46
    s_add_u32 s40, s40, 3072
    s_mul_i32 s41, s34, 5120
    s_add_u32 m0, s41, 23552
    s_nop 0
    buffer_load_dwordx4 v7, s[12:15], s40 offen lds
    s_mul_i32 s40, s51, 20480
    s_add_u32 s40, s40, s46
    s_add_u32 s40, s40, 4096
    s_mul_i32 s41, s34, 5120
    s_add_u32 m0, s41, 24576
    s_nop 0
    buffer_load_dwordx4 v7, s[12:15], s40 offen lds
    s_lshl_b32 s42, s51, 12
    s_add_u32 s42, s42, s47
    buffer_load_dwordx4 v[24:27], v7, s[12:15], s42 offen offset:0
    s_lshl_b32 s42, s51, 12
    s_add_u32 s42, s42, s47
    buffer_load_dwordx4 v[28:31], v7, s[12:15], s42 offen offset:1024
    s_lshl_b32 s42, s51, 12
    s_add_u32 s42, s42, s47
    buffer_load_dwordx4 v[32:35], v7, s[12:15], s42 offen offset:2048
    s_lshl_b32 s42, s51, 12
    s_add_u32 s42, s42, s47
    buffer_load_dwordx4 v[36:39], v7, s[12:15], s42 offen offset:3072
    s_mul_i32 s44, s33, 160
    s_mul_i32 s45, s32, 81920
    s_add_u32 s45, s45, s44
    v_add_u32 v4, 0, v1
    v_mul_u32_u24 v5, 6554, v4
    v_lshrrev_b32 v5, 16, v5
    v_mul_u32_u24 v6, 10, v5
    v_sub_u32 v4, v4, v6
    v_lshlrev_b32 v4, 4, v4
    v_mul_u32_u24 v5, 1280, v5
    v_add_u32 v104, v4, v5
    v_add_u32 v4, 64, v1
    v_mul_u32_u24 v5, 6554, v4
    v_lshrrev_b32 v5, 16, v5
    v_mul_u32_u24 v6, 10, v5
    v_sub_u32 v4, v4, v6
    v_lshlrev_b32 v4, 4, v4
    v_mul_u32_u24 v5, 1280, v5
    v_add_u32 v105, v4, v5
    v_add_u32 v4, 128, v1
    v_mul_u32_u24 v5, 6554, v4
    v_lshrrev_b32 v5, 16, v5
    v_mul_u32_u24 v6, 10, v5
    v_sub_u32 v4, v4, v6
    v_lshlrev_b32 v4, 4, v4
    v_mul_u32_u24 v5, 1280, v5
    v_add_u32 v106, v4, v5
    v_add_u32 v4, 192, v1
    v_mul_u32_u24 v5, 6554, v4
    v_lshrrev_b32 v5, 16, v5
    v_mul_u32_u24 v6, 10, v5
    v_sub_u32 v4, v4, v6
    v_lshlrev_b32 v4, 4, v4
    v_mul_u32_u24 v5, 1280, v5
    v_add_u32 v107, v4, v5
    v_add_u32 v4, 256, v1
    v_mul_u32_u24 v5, 6554, v4
    v_lshrrev_b32 v5, 16, v5
    v_mul_u32_u24 v6, 10, v5
    v_sub_u32 v4, v4, v6
    v_lshlrev_b32 v4, 4, v4
    v_mul_u32_u24 v5, 1280, v5
    v_add_u32 v108, v4, v5
    v_lshrrev_b32 v2, 4, v1
    v_and_b32 v3, 15, v1
    v_mov_b32 v113, v7
    v_add_u32 v114, 61440, v7
    s_waitcnt vmcnt(13)
    s_barrier
    ds_read_b128 v[136:139], v113 offset:0
    ds_read_b128 v[140:143], v113 offset:1024
    ds_read_b128 v[144:147], v113 offset:2048
    ds_read_b128 v[148:151], v113 offset:3072
    ds_read_b128 v[152:155], v113 offset:4096
    ds_read_b128 v[156:159], v113 offset:5120
    ds_read_b128 v[160:163], v113 offset:6144
    ds_read_b128 v[164:167], v113 offset:7168
    ds_read_b128 v[168:171], v113 offset:8192
    ds_read_b128 v[172:175], v113 offset:9216
    s_waitcnt vmcnt(12)
    s_waitcnt lgkmcnt(9)
    v_mfma_f32_16x16x32_bf16 v[116:119], v[136:139], v[8:11], 0
    s_mul_i32 s40, s52, 20480
    s_add_u32 s40, s40, s46
    s_add_u32 s40, s40, 0
    s_mul_i32 s41, s34, 5120
    s_add_u32 m0, s41, 40960
    s_nop 0
    buffer_load_dwordx4 v7, s[12:15], s40 offen lds
    s_waitcnt lgkmcnt(8)
    v_mfma_f32_16x16x32_bf16 v[120:123], v[140:143], v[8:11], 0
    s_waitcnt lgkmcnt(7)
    v_mfma_f32_16x16x32_bf16 v[124:127], v[144:147], v[8:11], 0
    s_mul_i32 s40, s52, 20480
    s_add_u32 s40, s40, s46
    s_add_u32 s40, s40, 1024
    s_mul_i32 s41, s34, 5120
    s_add_u32 m0, s41, 41984
    s_nop 0
    buffer_load_dwordx4 v7, s[12:15], s40 offen lds
    s_waitcnt lgkmcnt(6)
    v_mfma_f32_16x16x32_bf16 v[128:131], v[148:151], v[8:11], 0
    s_waitcnt lgkmcnt(5)
    v_mfma_f32_16x16x32_bf16 v[132:135], v[152:155], v[8:11], 0
    s_mul_i32 s40, s52, 20480
    s_add_u32 s40, s40, s46
    s_add_u32 s40, s40, 2048
    s_mul_i32 s41, s34, 5120
    s_add_u32 m0, s41, 43008
    s_nop 0
    buffer_load_dwordx4 v7, s[12:15], s40 offen lds
    ds_read_b128 v[136:139], v113 offset:10240
    ds_read_b128 v[140:143], v113 offset:11264
    ds_read_b128 v[144:147], v113 offset:12288
    ds_read_b128 v[148:151], v113 offset:13312
    ds_read_b128 v[152:155], v113 offset:14336
    s_waitcnt vmcnt(14)
    s_waitcnt lgkmcnt(9)
    v_mfma_f32_16x16x32_bf16 v[116:119], v[156:159], v[12:15], v[116:119]
    s_mul_i32 s40, s52, 20480
    s_add_u32 s40, s40, s46
    s_add_u32 s40, s40, 3072
    s_mul_i32 s41, s34, 5120
    s_add_u32 m0, s41, 44032
    s_nop 0
    buffer_load_dwordx4 v7, s[12:15], s40 offen lds
    s_waitcnt lgkmcnt(8)
    v_mfma_f32_16x16x32_bf16 v[120:123], v[160:163], v[12:15], v[120:123]
    s_waitcnt lgkmcnt(7)
    v_mfma_f32_16x16x32_bf16 v[124:127], v[164:167], v[12:15], v[124:127]
    s_mul_i32 s40, s52, 20480
    s_add_u32 s40, s40, s46
    s_add_u32 s40, s40, 4096
    s_mul_i32 s41, s34, 5120
    s_add_u32 m0, s41, 45056
    s_nop 0
    buffer_load_dwordx4 v7, s[12:15], s40 offen lds
    s_waitcnt lgkmcnt(6)
    v_mfma_f32_16x16x32_bf16 v[128:131], v[168:171], v[12:15], v[128:131]
    s_waitcnt lgkmcnt(5)
    v_mfma_f32_16x16x32_bf16 v[132:135], v[172:175], v[12:15], v[132:135]
    s_lshl_b32 s42, s52, 12
    s_add_u32 s42, s42, s47
    buffer_load_dwordx4 v[40:43], v7, s[12:15], s42 offen offset:0
    ds_read_b128 v[156:159], v113 offset:15360
    ds_read_b128 v[160:163], v113 offset:16384
    ds_read_b128 v[164:167], v113 offset:17408
    ds_read_b128 v[168:171], v113 offset:18432
    ds_read_b128 v[172:175], v113 offset:19456
    s_waitcnt vmcnt(16)
    s_waitcnt lgkmcnt(9)
    v_mfma_f32_16x16x32_bf16 v[116:119], v[136:139], v[16:19], v[116:119]
    s_lshl_b32 s42, s52, 12
    s_add_u32 s42, s42, s47
    buffer_load_dwordx4 v[44:47], v7, s[12:15], s42 offen offset:1024
    s_waitcnt lgkmcnt(8)
    v_mfma_f32_16x16x32_bf16 v[120:123], v[140:143], v[16:19], v[120:123]
    s_waitcnt lgkmcnt(7)
    v_mfma_f32_16x16x32_bf16 v[124:127], v[144:147], v[16:19], v[124:127]
    s_lshl_b32 s42, s52, 12
    s_add_u32 s42, s42, s47
    buffer_load_dwordx4 v[48:51], v7, s[12:15], s42 offen offset:2048
    s_waitcnt lgkmcnt(6)
    v_mfma_f32_16x16x32_bf16 v[128:131], v[148:151], v[16:19], v[128:131]
    s_waitcnt lgkmcnt(5)
    v_mfma_f32_16x16x32_bf16 v[132:135], v[152:155], v[16:19], v[132:135]
    s_lshl_b32 s42, s52, 12
    s_add_u32 s42, s42, s47
    buffer_load_dwordx4 v[52:55], v7, s[12:15], s42 offen offset:3072
    s_waitcnt vmcnt(18)
    s_waitcnt lgkmcnt(4)
    v_mfma_f32_16x16x32_bf16 v[116:119], v[156:159], v[20:23], v[116:119]
    s_waitcnt lgkmcnt(3)
    v_mfma_f32_16x16x32_bf16 v[120:123], v[160:163], v[20:23], v[120:123]
    s_waitcnt lgkmcnt(2)
    v_mfma_f32_16x16x32_bf16 v[124:127], v[164:167], v[20:23], v[124:127]
    s_waitcnt lgkmcnt(1)
    v_mfma_f32_16x16x32_bf16 v[128:131], v[168:171], v[20:23], v[128:131]
    s_waitcnt lgkmcnt(0)
    v_mfma_f32_16x16x32_bf16 v[132:135], v[172:175], v[20:23], v[132:135]
    s_waitcnt vmcnt(13)
    s_barrier
    ds_read_b128 v[136:139], v113 offset:20480
    ds_read_b128 v[140:143], v113 offset:21504
    ds_read_b128 v[144:147], v113 offset:22528
    ds_read_b128 v[148:151], v113 offset:23552
    ds_read_b128 v[152:155], v113 offset:24576
    ds_read_b128 v[156:159], v113 offset:25600
    ds_read_b128 v[160:163], v113 offset:26624
    ds_read_b128 v[164:167], v113 offset:27648
    ds_read_b128 v[168:171], v113 offset:28672
    ds_read_b128 v[172:175], v113 offset:29696
    s_waitcnt vmcnt(12)
    s_waitcnt lgkmcnt(9)
    v_mfma_f32_16x16x32_bf16 v[116:119], v[136:139], v[24:27], v[116:119]
    s_mul_i32 s40, s53, 20480
    s_add_u32 s40, s40, s46
    s_add_u32 s40, s40, 0
    s_mul_i32 s41, s34, 5120
    s_add_u32 m0, s41, 61440
    s_nop 0
    buffer_load_dwordx4 v7, s[12:15], s40 offen lds
    s_waitcnt lgkmcnt(8)
    v_mfma_f32_16x16x32_bf16 v[120:123], v[140:143], v[24:27], v[120:123]
    s_waitcnt lgkmcnt(7)
    v_mfma_f32_16x16x32_bf16 v[124:127], v[144:147], v[24:27], v[124:127]
    s_mul_i32 s40, s53, 20480
    s_add_u32 s40, s40, s46
    s_add_u32 s40, s40, 1024
    s_mul_i32 s41, s34, 5120
    s_add_u32 m0, s41, 62464
    s_nop 0
    buffer_load_dwordx4 v7, s[12:15], s40 offen lds
    s_waitcnt lgkmcnt(6)
    v_mfma_f32_16x16x32_bf16 v[128:131], v[148:151], v[24:27], v[128:131]
    s_waitcnt lgkmcnt(5)
    v_mfma_f32_16x16x32_bf16 v[132:135], v[152:155], v[24:27], v[132:135]
    s_mul_i32 s40, s53, 20480
    s_add_u32 s40, s40, s46
    s_add_u32 s40, s40, 2048
    s_mul_i32 s41, s34, 5120
    s_add_u32 m0, s41, 63488
    s_nop 0
    buffer_load_dwordx4 v7, s[12:15], s40 offen lds
    ds_read_b128 v[136:139], v113 offset:30720
    ds_read_b128 v[140:143], v113 offset:31744
    ds_read_b128 v[144:147], v113 offset:32768
    ds_read_b128 v[148:151], v113 offset:33792
    ds_read_b128 v[152:155], v113 offset:34816
    s_waitcnt vmcnt(14)
    s_waitcnt lgkmcnt(9)
    v_mfma_f32_16x16x32_bf16 v[116:119], v[156:159], v[28:31], v[116:119]
    s_mul_i32 s40, s53, 20480
    s_add_u32 s40, s40, s46
    s_add_u32 s40, s40, 3072
    s_mul_i32 s41, s34, 5120
    s_add_u32 m0, s41, 64512
    s_nop 0
    buffer_load_dwordx4 v7, s[12:15], s40 offen lds
    s_waitcnt lgkmcnt(8)
    v_mfma_f32_16x16x32_bf16 v[120:123], v[160:163], v[28:31], v[120:123]
    s_waitcnt lgkmcnt(7)
    v_mfma_f32_16x16x32_bf16 v[124:127], v[164:167], v[28:31], v[124:127]
    s_mul_i32 s40, s53, 20480
    s_add_u32 s40, s40, s46
    s_add_u32 s40, s40, 4096
    s_mul_i32 s41, s34, 5120
    s_add_u32 m0, s41, 65536
    s_nop 0
    buffer_load_dwordx4 v7, s[12:15], s40 offen lds
    s_waitcnt lgkmcnt(6)
    v_mfma_f32_16x16x32_bf16 v[128:131], v[168:171], v[28:31], v[128:131]
    s_waitcnt lgkmcnt(5)
    v_mfma_f32_16x16x32_bf16 v[132:135], v[172:175], v[28:31], v[132:135]
    s_lshl_b32 s42, s53, 12
    s_add_u32 s42, s42, s47
    buffer_load_dwordx4 v[56:59], v7, s[12:15], s42 offen offset:0
    ds_read_b128 v[156:159], v113 offset:35840
    ds_read_b128 v[160:163], v113 offset:36864
    ds_read_b128 v[164:167], v113 offset:37888
    ds_read_b128 v[168:171], v113 offset:38912
    ds_read_b128 v[172:175], v113 offset:39936
    s_waitcnt vmcnt(16)
    s_waitcnt lgkmcnt(9)
    v_mfma_f32_16x16x32_bf16 v[116:119], v[136:139], v[32:35], v[116:119]
    s_lshl_b32 s42, s53, 12
    s_add_u32 s42, s42, s47
    buffer_load_dwordx4 v[60:63], v7, s[12:15], s42 offen offset:1024
    s_waitcnt lgkmcnt(8)
    v_mfma_f32_16x16x32_bf16 v[120:123], v[140:143], v[32:35], v[120:123]
    s_waitcnt lgkmcnt(7)
    v_mfma_f32_16x16x32_bf16 v[124:127], v[144:147], v[32:35], v[124:127]
    s_lshl_b32 s42, s53, 12
    s_add_u32 s42, s42, s47
    buffer_load_dwordx4 v[64:67], v7, s[12:15], s42 offen offset:2048
    s_waitcnt lgkmcnt(6)
    v_mfma_f32_16x16x32_bf16 v[128:131], v[148:151], v[32:35], v[128:131]
    s_waitcnt lgkmcnt(5)
    v_mfma_f32_16x16x32_bf16 v[132:135], v[152:155], v[32:35], v[132:135]
    s_lshl_b32 s42, s53, 12
    s_add_u32 s42, s42, s47
    buffer_load_dwordx4 v[68:71], v7, s[12:15], s42 offen offset:3072
    s_waitcnt vmcnt(18)
    s_waitcnt lgkmcnt(4)
    v_mfma_f32_16x16x32_bf16 v[116:119], v[156:159], v[36:39], v[116:119]
    s_waitcnt lgkmcnt(3)
    v_mfma_f32_16x16x32_bf16 v[120:123], v[160:163], v[36:39], v[120:123]
    s_waitcnt lgkmcnt(2)
    v_mfma_f32_16x16x32_bf16 v[124:127], v[164:167], v[36:39], v[124:127]
    s_waitcnt lgkmcnt(1)
    v_mfma_f32_16x16x32_bf16 v[128:131], v[168:171], v[36:39], v[128:131]
    s_waitcnt lgkmcnt(0)
    v_mfma_f32_16x16x32_bf16 v[132:135], v[172:175], v[36:39], v[132:135]
    s_waitcnt vmcnt(13)
    s_barrier
    ds_read_b128 v[136:139], v113 offset:40960
    ds_read_b128 v[140:143], v113 offset:41984
    ds_read_b128 v[144:147], v113 offset:43008
    ds_read_b128 v[148:151], v113 offset:44032
    ds_read_b128 v[152:155], v113 offset:45056
    ds_read_b128 v[156:159], v113 offset:46080
    ds_read_b128 v[160:163], v113 offset:47104
    ds_read_b128 v[164:167], v113 offset:48128
    ds_read_b128 v[168:171], v113 offset:49152
    ds_read_b128 v[172:175], v113 offset:50176
    s_waitcnt vmcnt(12)
    s_waitcnt lgkmcnt(9)
    v_mfma_f32_16x16x32_bf16 v[116:119], v[136:139], v[40:43], v[116:119]
    s_mul_i32 s40, s54, 20480
    s_add_u32 s40, s40, s46
    s_add_u32 s40, s40, 0
    s_mul_i32 s41, s34, 5120
    s_add_u32 m0, s41, 81920
    s_nop 0
    buffer_load_dwordx4 v7, s[12:15], s40 offen lds
    s_waitcnt lgkmcnt(8)
    v_mfma_f32_16x16x32_bf16 v[120:123], v[140:143], v[40:43], v[120:123]
    s_waitcnt lgkmcnt(7)
    v_mfma_f32_16x16x32_bf16 v[124:127], v[144:147], v[40:43], v[124:127]
    s_mul_i32 s40, s54, 20480
    s_add_u32 s40, s40, s46
    s_add_u32 s40, s40, 1024
    s_mul_i32 s41, s34, 5120
    s_add_u32 m0, s41, 82944
    s_nop 0
    buffer_load_dwordx4 v7, s[12:15], s40 offen lds
    s_waitcnt lgkmcnt(6)
    v_mfma_f32_16x16x32_bf16 v[128:131], v[148:151], v[40:43], v[128:131]
    s_waitcnt lgkmcnt(5)
    v_mfma_f32_16x16x32_bf16 v[132:135], v[152:155], v[40:43], v[132:135]
    s_mul_i32 s40, s54, 20480
    s_add_u32 s40, s40, s46
    s_add_u32 s40, s40, 2048
    s_mul_i32 s41, s34, 5120
    s_add_u32 m0, s41, 83968
    s_nop 0
    buffer_load_dwordx4 v7, s[12:15], s40 offen lds
    ds_read_b128 v[136:139], v113 offset:51200
    ds_read_b128 v[140:143], v113 offset:52224
    ds_read_b128 v[144:147], v113 offset:53248
    ds_read_b128 v[148:151], v113 offset:54272
    ds_read_b128 v[152:155], v113 offset:55296
    s_waitcnt vmcnt(14)
    s_waitcnt lgkmcnt(9)
    v_mfma_f32_16x16x32_bf16 v[116:119], v[156:159], v[44:47], v[116:119]
    s_mul_i32 s40, s54, 20480
    s_add_u32 s40, s40, s46
    s_add_u32 s40, s40, 3072
    s_mul_i32 s41, s34, 5120
    s_add_u32 m0, s41, 84992
    s_nop 0
    buffer_load_dwordx4 v7, s[12:15], s40 offen lds
    s_waitcnt lgkmcnt(8)
    v_mfma_f32_16x16x32_bf16 v[120:123], v[160:163], v[44:47], v[120:123]
    s_waitcnt lgkmcnt(7)
    v_mfma_f32_16x16x32_bf16 v[124:127], v[164:167], v[44:47], v[124:127]
    s_mul_i32 s40, s54, 20480
    s_add_u32 s40, s40, s46
    s_add_u32 s40, s40, 4096
    s_mul_i32 s41, s34, 5120
    s_add_u32 m0, s41, 86016
    s_nop 0
    buffer_load_dwordx4 v7, s[12:15], s40 offen lds
    s_waitcnt lgkmcnt(6)
    v_mfma_f32_16x16x32_bf16 v[128:131], v[168:171], v[44:47], v[128:131]
    s_waitcnt lgkmcnt(5)
    v_mfma_f32_16x16x32_bf16 v[132:135], v[172:175], v[44:47], v[132:135]
    s_lshl_b32 s42, s54, 12
    s_add_u32 s42, s42, s47
    buffer_load_dwordx4 v[72:75], v7, s[12:15], s42 offen offset:0
    ds_read_b128 v[156:159], v113 offset:56320
    ds_read_b128 v[160:163], v113 offset:57344
    ds_read_b128 v[164:167], v113 offset:58368
    ds_read_b128 v[168:171], v113 offset:59392
    ds_read_b128 v[172:175], v113 offset:60416
    s_waitcnt vmcnt(16)
    s_waitcnt lgkmcnt(9)
    v_mfma_f32_16x16x32_bf16 v[116:119], v[136:139], v[48:51], v[116:119]
    s_lshl_b32 s42, s54, 12
    s_add_u32 s42, s42, s47
    buffer_load_dwordx4 v[76:79], v7, s[12:15], s42 offen offset:1024
    s_waitcnt lgkmcnt(8)
    v_mfma_f32_16x16x32_bf16 v[120:123], v[140:143], v[48:51], v[120:123]
    s_waitcnt lgkmcnt(7)
    v_mfma_f32_16x16x32_bf16 v[124:127], v[144:147], v[48:51], v[124:127]
    s_lshl_b32 s42, s54, 12
    s_add_u32 s42, s42, s47
    buffer_load_dwordx4 v[80:83], v7, s[12:15], s42 offen offset:2048
    s_waitcnt lgkmcnt(6)
    v_mfma_f32_16x16x32_bf16 v[128:131], v[148:151], v[48:51], v[128:131]
    s_waitcnt lgkmcnt(5)
    v_mfma_f32_16x16x32_bf16 v[132:135], v[152:155], v[48:51], v[132:135]
    s_lshl_b32 s42, s54, 12
    s_add_u32 s42, s42, s47
    buffer_load_dwordx4 v[84:87], v7, s[12:15], s42 offen offset:3072
    s_waitcnt vmcnt(18)
    s_waitcnt lgkmcnt(4)
    v_mfma_f32_16x16x32_bf16 v[116:119], v[156:159], v[52:55], v[116:119]
    s_waitcnt lgkmcnt(3)
    v_mfma_f32_16x16x32_bf16 v[120:123], v[160:163], v[52:55], v[120:123]
    s_waitcnt lgkmcnt(2)
    v_mfma_f32_16x16x32_bf16 v[124:127], v[164:167], v[52:55], v[124:127]
    s_waitcnt lgkmcnt(1)
    v_mfma_f32_16x16x32_bf16 v[128:131], v[168:171], v[52:55], v[128:131]
    s_waitcnt lgkmcnt(0)
    v_mfma_f32_16x16x32_bf16 v[132:135], v[172:175], v[52:55], v[132:135]
    s_waitcnt vmcnt(13)
    s_barrier
    ds_read_b128 v[136:139], v114 offset:0
    ds_read_b128 v[140:143], v114 offset:1024
    ds_read_b128 v[144:147], v114 offset:2048
    ds_read_b128 v[148:151], v114 offset:3072
    ds_read_b128 v[152:155], v114 offset:4096
    ds_read_b128 v[156:159], v114 offset:5120
    ds_read_b128 v[160:163], v114 offset:6144
    ds_read_b128 v[164:167], v114 offset:7168
    ds_read_b128 v[168:171], v114 offset:8192
    ds_read_b128 v[172:175], v114 offset:9216
    s_waitcnt vmcnt(12)
    s_waitcnt lgkmcnt(9)
    v_mfma_f32_16x16x32_bf16 v[116:119], v[136:139], v[56:59], v[116:119]
    s_mul_i32 s40, s55, 20480
    s_add_u32 s40, s40, s46
    s_add_u32 s40, s40, 0
    s_mul_i32 s41, s34, 5120
    s_add_u32 m0, s41, 102400
    s_nop 0
    buffer_load_dwordx4 v7, s[12:15], s40 offen lds
    s_waitcnt lgkmcnt(8)
    v_mfma_f32_16x16x32_bf16 v[120:123], v[140:143], v[56:59], v[120:123]
    s_waitcnt lgkmcnt(7)
    v_mfma_f32_16x16x32_bf16 v[124:127], v[144:147], v[56:59], v[124:127]
    s_mul_i32 s40, s55, 20480
    s_add_u32 s40, s40, s46
    s_add_u32 s40, s40, 1024
    s_mul_i32 s41, s34, 5120
    s_add_u32 m0, s41, 103424
    s_nop 0
    buffer_load_dwordx4 v7, s[12:15], s40 offen lds
    s_waitcnt lgkmcnt(6)
    v_mfma_f32_16x16x32_bf16 v[128:131], v[148:151], v[56:59], v[128:131]
    s_waitcnt lgkmcnt(5)
    v_mfma_f32_16x16x32_bf16 v[132:135], v[152:155], v[56:59], v[132:135]
    s_mul_i32 s40, s55, 20480
    s_add_u32 s40, s40, s46
    s_add_u32 s40, s40, 2048
    s_mul_i32 s41, s34, 5120
    s_add_u32 m0, s41, 104448
    s_nop 0
    buffer_load_dwordx4 v7, s[12:15], s40 offen lds
    ds_read_b128 v[136:139], v114 offset:10240
    ds_read_b128 v[140:143], v114 offset:11264
    ds_read_b128 v[144:147], v114 offset:12288
    ds_read_b128 v[148:151], v114 offset:13312
    ds_read_b128 v[152:155], v114 offset:14336
    s_waitcnt vmcnt(14)
    s_waitcnt lgkmcnt(9)
    v_mfma_f32_16x16x32_bf16 v[116:119], v[156:159], v[60:63], v[116:119]
    s_mul_i32 s40, s55, 20480
    s_add_u32 s40, s40, s46
    s_add_u32 s40, s40, 3072
    s_mul_i32 s41, s34, 5120
    s_add_u32 m0, s41, 105472
    s_nop 0
    buffer_load_dwordx4 v7, s[12:15], s40 offen lds
    s_waitcnt lgkmcnt(8)
    v_mfma_f32_16x16x32_bf16 v[120:123], v[160:163], v[60:63], v[120:123]
    s_waitcnt lgkmcnt(7)
    v_mfma_f32_16x16x32_bf16 v[124:127], v[164:167], v[60:63], v[124:127]
    s_mul_i32 s40, s55, 20480
    s_add_u32 s40, s40, s46
    s_add_u32 s40, s40, 4096
    s_mul_i32 s41, s34, 5120
    s_add_u32 m0, s41, 106496
    s_nop 0
    buffer_load_dwordx4 v7, s[12:15], s40 offen lds
    s_waitcnt lgkmcnt(6)
    v_mfma_f32_16x16x32_bf16 v[128:131], v[168:171], v[60:63], v[128:131]
    s_waitcnt lgkmcnt(5)
    v_mfma_f32_16x16x32_bf16 v[132:135], v[172:175], v[60:63], v[132:135]
    s_lshl_b32 s42, s55, 12
    s_add_u32 s42, s42, s47
    buffer_load_dwordx4 v[88:91], v7, s[12:15], s42 offen offset:0
    ds_read_b128 v[156:159], v114 offset:15360
    ds_read_b128 v[160:163], v114 offset:16384
    ds_read_b128 v[164:167], v114 offset:17408
    ds_read_b128 v[168:171], v114 offset:18432
    ds_read_b128 v[172:175], v114 offset:19456
    s_waitcnt vmcnt(16)
    s_waitcnt lgkmcnt(9)
    v_mfma_f32_16x16x32_bf16 v[116:119], v[136:139], v[64:67], v[116:119]
    s_lshl_b32 s42, s55, 12
    s_add_u32 s42, s42, s47
    buffer_load_dwordx4 v[92:95], v7, s[12:15], s42 offen offset:1024
    s_waitcnt lgkmcnt(8)
    v_mfma_f32_16x16x32_bf16 v[120:123], v[140:143], v[64:67], v[120:123]
    s_waitcnt lgkmcnt(7)
    v_mfma_f32_16x16x32_bf16 v[124:127], v[144:147], v[64:67], v[124:127]
    s_lshl_b32 s42, s55, 12
    s_add_u32 s42, s42, s47
    buffer_load_dwordx4 v[96:99], v7, s[12:15], s42 offen offset:2048
    s_waitcnt lgkmcnt(6)
    v_mfma_f32_16x16x32_bf16 v[128:131], v[148:151], v[64:67], v[128:131]
    s_waitcnt lgkmcnt(5)
    v_mfma_f32_16x16x32_bf16 v[132:135], v[152:155], v[64:67], v[132:135]
    s_lshl_b32 s42, s55, 12
    s_add_u32 s42, s42, s47
    buffer_load_dwordx4 v[100:103], v7, s[12:15], s42 offen offset:3072
    s_waitcnt vmcnt(18)
    s_waitcnt lgkmcnt(4)
    v_mfma_f32_16x16x32_bf16 v[116:119], v[156:159], v[68:71], v[116:119]
    s_cmp_ge_u32 s34, 2
    s_cbranch_scc1 k3_y_1
    s_mul_i32 s40, s34, 40960
    s_add_u32 s40, s40, s45
    s_mul_i32 s41, s34, 5120
    s_add_u32 m0, s41, 122880
    s_nop 0
    buffer_load_dwordx4 v104, s[8:11], s40 offen lds
    s_add_u32 m0, s41, 123904
    s_nop 0
    buffer_load_dwordx4 v105, s[8:11], s40 offen lds
    s_add_u32 m0, s41, 124928
    s_nop 0
    buffer_load_dwordx4 v106, s[8:11], s40 offen lds
    s_add_u32 m0, s41, 125952
    s_nop 0
    buffer_load_dwordx4 v107, s[8:11], s40 offen lds
    s_add_u32 m0, s41, 126976
    s_nop 0
    buffer_load_dwordx4 v108, s[8:11], s40 offen lds
    s_branch k3_xy_2
k3_y_1:
    v_lshrrev_b32 v4, 3, v1
    v_lshlrev_b32 v4, 12, v4
    v_and_b32 v5, 7, v1
    v_lshl_add_u32 v112, v5, 4, v4
    s_sub_u32 s42, s34, 2
    s_mul_i32 s40, s42, 40
    s_mul_i32 s41, s33, 80
    s_add_u32 s40, s40, s41
    s_lshl_b32 s40, s40, 12
    s_lshl_b32 s41, s32, 7
    s_add_u32 s40, s40, s41
    s_add_u32 s40, s40, 8912896
    s_mul_i32 s41, s42, 5120
    s_add_u32 m0, s41, 133120
    s_nop 0
    buffer_load_dwordx4 v112, s[12:15], s40 offen lds
    s_add_u32 s40, s40, 32768
    s_add_u32 m0, s41, 134144
    s_nop 0
    buffer_load_dwordx4 v112, s[12:15], s40 offen lds
    s_add_u32 s40, s40, 32768
    s_add_u32 m0, s41, 135168
    s_nop 0
    buffer_load_dwordx4 v112, s[12:15], s40 offen lds
    s_add_u32 s40, s40, 32768
    s_add_u32 m0, s41, 136192
    s_nop 0
    buffer_load_dwordx4 v112, s[12:15], s40 offen lds
    s_add_u32 s40, s40, 32768
    s_add_u32 m0, s41, 137216
    s_nop 0
    buffer_load_dwordx4 v112, s[12:15], s40 offen lds
    s_add_u32 s40, s40, 32768
k3_xy_2:
    s_lshl_b32 s40, s32, 9
    s_lshl_b32 s41, s34, 7
    s_add_u32 s40, s40, s41
    s_add_u32 s40, s40, 14680064
    v_lshlrev_b32 v4, 3, v3
    buffer_load_dwordx2 v[110:111], v4, s[12:15], s40 offen
    s_waitcnt lgkmcnt(3)
    v_mfma_f32_16x16x32_bf16 v[120:123], v[160:163], v[68:71], v[120:123]
    s_waitcnt lgkmcnt(2)
    v_mfma_f32_16x16x32_bf16 v[124:127], v[164:167], v[68:71], v[124:127]
    s_waitcnt lgkmcnt(1)
    v_mfma_f32_16x16x32_bf16 v[128:131], v[168:171], v[68:71], v[128:131]
    s_waitcnt lgkmcnt(0)
    v_mfma_f32_16x16x32_bf16 v[132:135], v[172:175], v[68:71], v[132:135]
    s_waitcnt vmcnt(19)
    s_barrier
    ds_read_b128 v[136:139], v114 offset:20480
    ds_read_b128 v[140:143], v114 offset:21504
    ds_read_b128 v[144:147], v114 offset:22528
    ds_read_b128 v[148:151], v114 offset:23552
    ds_read_b128 v[152:155], v114 offset:24576
    ds_read_b128 v[156:159], v114 offset:25600
    ds_read_b128 v[160:163], v114 offset:26624
    ds_read_b128 v[164:167], v114 offset:27648
    ds_read_b128 v[168:171], v114 offset:28672
    ds_read_b128 v[172:175], v114 offset:29696
    s_waitcnt vmcnt(18)
    s_waitcnt lgkmcnt(9)
    v_mfma_f32_16x16x32_bf16 v[116:119], v[136:139], v[72:75], v[116:119]
    s_waitcnt lgkmcnt(8)
    v_mfma_f32_16x16x32_bf16 v[120:123], v[140:143], v[72:75], v[120:123]
    s_waitcnt lgkmcnt(7)
    v_mfma_f32_16x16x32_bf16 v[124:127], v[144:147], v[72:75], v[124:127]
    s_waitcnt lgkmcnt(6)
    v_mfma_f32_16x16x32_bf16 v[128:131], v[148:151], v[72:75], v[128:131]
    s_waitcnt lgkmcnt(5)
    v_mfma_f32_16x16x32_bf16 v[132:135], v[152:155], v[72:75], v[132:135]
    ds_read_b128 v[136:139], v114 offset:30720
    ds_read_b128 v[140:143], v114 offset:31744
    ds_read_b128 v[144:147], v114 offset:32768
    ds_read_b128 v[148:151], v114 offset:33792
    ds_read_b128 v[152:155], v114 offset:34816
    s_waitcnt vmcnt(17)
    s_waitcnt lgkmcnt(9)
    v_mfma_f32_16x16x32_bf16 v[116:119], v[156:159], v[76:79], v[116:119]
    s_waitcnt lgkmcnt(8)
    v_mfma_f32_16x16x32_bf16 v[120:123], v[160:163], v[76:79], v[120:123]
    s_waitcnt lgkmcnt(7)
    v_mfma_f32_16x16x32_bf16 v[124:127], v[164:167], v[76:79], v[124:127]
    s_waitcnt lgkmcnt(6)
    v_mfma_f32_16x16x32_bf16 v[128:131], v[168:171], v[76:79], v[128:131]
    s_waitcnt lgkmcnt(5)
    v_mfma_f32_16x16x32_bf16 v[132:135], v[172:175], v[76:79], v[132:135]
    ds_read_b128 v[156:159], v114 offset:35840
    ds_read_b128 v[160:163], v114 offset:36864
    ds_read_b128 v[164:167], v114 offset:37888
    ds_read_b128 v[168:171], v114 offset:38912
    ds_read_b128 v[172:175], v114 offset:39936
    s_waitcnt vmcnt(16)
    s_waitcnt lgkmcnt(9)
    v_mfma_f32_16x16x32_bf16 v[116:119], v[136:139], v[80:83], v[116:119]
    s_waitcnt lgkmcnt(8)
    v_mfma_f32_16x16x32_bf16 v[120:123], v[140:143], v[80:83], v[120:123]
    s_waitcnt lgkmcnt(7)
    v_mfma_f32_16x16x32_bf16 v[124:127], v[144:147], v[80:83], v[124:127]
    s_waitcnt lgkmcnt(6)
    v_mfma_f32_16x16x32_bf16 v[128:131], v[148:151], v[80:83], v[128:131]
    s_waitcnt lgkmcnt(5)
    v_mfma_f32_16x16x32_bf16 v[132:135], v[152:155], v[80:83], v[132:135]
    s_waitcnt vmcnt(15)
    s_waitcnt lgkmcnt(4)
    v_mfma_f32_16x16x32_bf16 v[116:119], v[156:159], v[84:87], v[116:119]
    s_waitcnt lgkmcnt(3)
    v_mfma_f32_16x16x32_bf16 v[120:123], v[160:163], v[84:87], v[120:123]
    s_waitcnt lgkmcnt(2)
    v_mfma_f32_16x16x32_bf16 v[124:127], v[164:167], v[84:87], v[124:127]
    s_waitcnt lgkmcnt(1)
    v_mfma_f32_16x16x32_bf16 v[128:131], v[168:171], v[84:87], v[128:131]
    s_waitcnt lgkmcnt(0)
    v_mfma_f32_16x16x32_bf16 v[132:135], v[172:175], v[84:87], v[132:135]
    s_waitcnt vmcnt(10)
    s_barrier
    ds_read_b128 v[136:139], v114 offset:40960
    ds_read_b128 v[140:143], v114 offset:41984
    ds_read_b128 v[144:147], v114 offset:43008
    ds_read_b128 v[148:151], v114 offset:44032
    ds_read_b128 v[152:155], v114 offset:45056
    ds_read_b128 v[156:159], v114 offset:46080
    ds_read_b128 v[160:163], v114 offset:47104
    ds_read_b128 v[164:167], v114 offset:48128
    ds_read_b128 v[168:171], v114 offset:49152
    ds_read_b128 v[172:175], v114 offset:50176
    s_waitcnt vmcnt(9)
    s_waitcnt lgkmcnt(9)
    v_mfma_f32_16x16x32_bf16 v[116:119], v[136:139], v[88:91], v[116:119]
    s_waitcnt lgkmcnt(8)
    v_mfma_f32_16x16x32_bf16 v[120:123], v[140:143], v[88:91], v[120:123]
    s_waitcnt lgkmcnt(7)
    v_mfma_f32_16x16x32_bf16 v[124:127], v[144:147], v[88:91], v[124:127]
    s_waitcnt lgkmcnt(6)
    v_mfma_f32_16x16x32_bf16 v[128:131], v[148:151], v[88:91], v[128:131]
    s_waitcnt lgkmcnt(5)
    v_mfma_f32_16x16x32_bf16 v[132:135], v[152:155], v[88:91], v[132:135]
    ds_read_b128 v[136:139], v114 offset:51200
    ds_read_b128 v[140:143], v114 offset:52224
    ds_read_b128 v[144:147], v114 offset:53248
    ds_read_b128 v[148:151], v114 offset:54272
    ds_read_b128 v[152:155], v114 offset:55296
    s_waitcnt vmcnt(8)
    s_waitcnt lgkmcnt(9)
    v_mfma_f32_16x16x32_bf16 v[116:119], v[156:159], v[92:95], v[116:119]
    s_waitcnt lgkmcnt(8)
    v_mfma_f32_16x16x32_bf16 v[120:123], v[160:163], v[92:95], v[120:123]
    s_waitcnt lgkmcnt(7)
    v_mfma_f32_16x16x32_bf16 v[124:127], v[164:167], v[92:95], v[124:127]
    s_waitcnt lgkmcnt(6)
    v_mfma_f32_16x16x32_bf16 v[128:131], v[168:171], v[92:95], v[128:131]
    s_waitcnt lgkmcnt(5)
    v_mfma_f32_16x16x32_bf16 v[132:135], v[172:175], v[92:95], v[132:135]
    ds_read_b128 v[156:159], v114 offset:56320
    ds_read_b128 v[160:163], v114 offset:57344
    ds_read_b128 v[164:167], v114 offset:58368
    ds_read_b128 v[168:171], v114 offset:59392
    ds_read_b128 v[172:175], v114 offset:60416
    s_waitcnt vmcnt(7)
    s_waitcnt lgkmcnt(9)
    v_mfma_f32_16x16x32_bf16 v[116:119], v[136:139], v[96:99], v[116:119]
    s_waitcnt lgkmcnt(8)
    v_mfma_f32_16x16x32_bf16 v[120:123], v[140:143], v[96:99], v[120:123]
    s_waitcnt lgkmcnt(7)
    v_mfma_f32_16x16x32_bf16 v[124:127], v[144:147], v[96:99], v[124:127]
    s_waitcnt lgkmcnt(6)
    v_mfma_f32_16x16x32_bf16 v[128:131], v[148:151], v[96:99], v[128:131]
    s_waitcnt lgkmcnt(5)
    v_mfma_f32_16x16x32_bf16 v[132:135], v[152:155], v[96:99], v[132:135]
    s_waitcnt vmcnt(6)
    s_waitcnt lgkmcnt(4)
    v_mfma_f32_16x16x32_bf16 v[116:119], v[156:159], v[100:103], v[116:119]
    s_waitcnt lgkmcnt(3)
    v_mfma_f32_16x16x32_bf16 v[120:123], v[160:163], v[100:103], v[120:123]
    s_waitcnt lgkmcnt(2)
    v_mfma_f32_16x16x32_bf16 v[124:127], v[164:167], v[100:103], v[124:127]
    s_waitcnt lgkmcnt(1)
    v_mfma_f32_16x16x32_bf16 v[128:131], v[168:171], v[100:103], v[128:131]
    s_waitcnt lgkmcnt(0)
    v_mfma_f32_16x16x32_bf16 v[132:135], v[172:175], v[100:103], v[132:135]
    s_lshl_b32 s40, s34, 4
    v_add_u32 v4, s40, v3
    v_mul_u32_u24 v4, 160, v4
    v_lshl_add_u32 v176, v2, 3, v4
    v_add_u32 v177, 122880, v176
    v_lshrrev_b32 v5, 2, v3
    v_lshl_add_u32 v4, v2, 2, v5
    v_lshlrev_b32 v4, 7, v4
    v_and_b32 v5, 3, v3
    v_lshl_add_u32 v4, v5, 3, v4
    s_lshl_b32 s40, s34, 5
    s_add_u32 s40, s40, 133120
    v_add_u32 v178, s40, v4
    s_mov_b32 s46, 0xbfb8aa3b
    s_mov_b32 s47, 0xbfb8aa3b
    v_pk_mul_f32 v[8:9], v[116:117], s[46:47]
    v_pk_mul_f32 v[10:11], v[118:119], s[46:47]
    v_pk_mul_f32 v[12:13], v[120:121], s[46:47]
    v_pk_mul_f32 v[14:15], v[122:123], s[46:47]
    v_pk_mul_f32 v[16:17], v[124:125], s[46:47]
    v_pk_mul_f32 v[18:19], v[126:127], s[46:47]
    v_pk_mul_f32 v[20:21], v[128:129], s[46:47]
    v_pk_mul_f32 v[22:23], v[130:131], s[46:47]
    v_pk_mul_f32 v[24:25], v[132:133], s[46:47]
    v_pk_mul_f32 v[26:27], v[134:135], s[46:47]
    s_waitcnt vmcnt(0)
    s_barrier
    ds_read_b64 v[136:137], v177 offset:0
    ds_read_b64 v[138:139], v177 offset:32
    ds_read_b64 v[140:141], v177 offset:64
    ds_read_b64 v[142:143], v177 offset:96
    ds_read_b64 v[144:145], v177 offset:128
    ds_read_b64_tr_b16 v[146:147], v178 offset:0
    ds_read_b64_tr_b16 v[148:149], v178 offset:2048
    ds_read_b64_tr_b16 v[150:151], v178 offset:4096
    ds_read_b64_tr_b16 v[152:153], v178 offset:6144
    ds_read_b64_tr_b16 v[154:155], v178 offset:8192
    v_exp_f32 v8, v8
    v_exp_f32 v9, v9
    v_exp_f32 v10, v10
    v_exp_f32 v11, v11
    v_exp_f32 v12, v12
    v_exp_f32 v13, v13
    v_exp_f32 v14, v14
    v_exp_f32 v15, v15
    v_exp_f32 v16, v16
    v_exp_f32 v17, v17
    v_exp_f32 v18, v18
    v_exp_f32 v19, v19
    v_exp_f32 v20, v20
    v_exp_f32 v21, v21
    v_exp_f32 v22, v22
    v_exp_f32 v23, v23
    v_exp_f32 v24, v24
    v_exp_f32 v25, v25
    v_exp_f32 v26, v26
    v_exp_f32 v27, v27
    v_pk_add_f32 v[8:9], v[8:9], 1.0 op_sel_hi:[1,0]
    v_pk_add_f32 v[10:11], v[10:11], 1.0 op_sel_hi:[1,0]
    v_pk_add_f32 v[12:13], v[12:13], 1.0 op_sel_hi:[1,0]
    v_pk_add_f32 v[14:15], v[14:15], 1.0 op_sel_hi:[1,0]
    v_pk_add_f32 v[16:17], v[16:17], 1.0 op_sel_hi:[1,0]
    v_pk_add_f32 v[18:19], v[18:19], 1.0 op_sel_hi:[1,0]
    v_pk_add_f32 v[20:21], v[20:21], 1.0 op_sel_hi:[1,0]
    v_pk_add_f32 v[22:23], v[22:23], 1.0 op_sel_hi:[1,0]
    v_pk_add_f32 v[24:25], v[24:25], 1.0 op_sel_hi:[1,0]
    v_pk_add_f32 v[26:27], v[26:27], 1.0 op_sel_hi:[1,0]
    v_rcp_f32 v8, v8
    v_rcp_f32 v9, v9
    v_rcp_f32 v10, v10
    v_rcp_f32 v11, v11
    v_rcp_f32 v12, v12
    v_rcp_f32 v13, v13
    v_rcp_f32 v14, v14
    v_rcp_f32 v15, v15
    v_rcp_f32 v16, v16
    v_rcp_f32 v17, v17
    v_rcp_f32 v18, v18
    v_rcp_f32 v19, v19
    v_rcp_f32 v20, v20
    v_rcp_f32 v21, v21
    v_rcp_f32 v22, v22
    v_rcp_f32 v23, v23
    v_rcp_f32 v24, v24
    v_rcp_f32 v25, v25
    v_rcp_f32 v26, v26
    v_rcp_f32 v27, v27
    v_pk_mul_f32 v[8:9], v[8:9], v[116:117]
    v_pk_mul_f32 v[10:11], v[10:11], v[118:119]
    v_pk_mul_f32 v[12:13], v[12:13], v[120:121]
    v_pk_mul_f32 v[14:15], v[14:15], v[122:123]
    v_pk_mul_f32 v[16:17], v[16:17], v[124:125]
    v_pk_mul_f32 v[18:19], v[18:19], v[126:127]
    v_pk_mul_f32 v[20:21], v[20:21], v[128:129]
    v_pk_mul_f32 v[22:23], v[22:23], v[130:131]
    v_pk_mul_f32 v[24:25], v[24:25], v[132:133]
    v_pk_mul_f32 v[26:27], v[26:27], v[134:135]
    s_waitcnt lgkmcnt(0)
    v_lshlrev_b32 v28, 16, v136
    v_and_b32 v29, 0xffff0000, v136
    v_lshlrev_b32 v48, 16, v146
    v_and_b32 v49, 0xffff0000, v146
    v_lshlrev_b32 v30, 16, v137
    v_and_b32 v31, 0xffff0000, v137
    v_lshlrev_b32 v50, 16, v147
    v_and_b32 v51, 0xffff0000, v147
    v_lshlrev_b32 v32, 16, v138
    v_and_b32 v33, 0xffff0000, v138
    v_lshlrev_b32 v52, 16, v148
    v_and_b32 v53, 0xffff0000, v148
    v_lshlrev_b32 v34, 16, v139
    v_and_b32 v35, 0xffff0000, v139
    v_lshlrev_b32 v54, 16, v149
    v_and_b32 v55, 0xffff0000, v149
    v_lshlrev_b32 v36, 16, v140
    v_and_b32 v37, 0xffff0000, v140
    v_lshlrev_b32 v56, 16, v150
    v_and_b32 v57, 0xffff0000, v150
    v_lshlrev_b32 v38, 16, v141
    v_and_b32 v39, 0xffff0000, v141
    v_lshlrev_b32 v58, 16, v151
    v_and_b32 v59, 0xffff0000, v151
    v_lshlrev_b32 v40, 16, v142
    v_and_b32 v41, 0xffff0000, v142
    v_lshlrev_b32 v60, 16, v152
    v_and_b32 v61, 0xffff0000, v152
    v_lshlrev_b32 v42, 16, v143
    v_and_b32 v43, 0xffff0000, v143
    v_lshlrev_b32 v62, 16, v153
    v_and_b32 v63, 0xffff0000, v153
    v_lshlrev_b32 v44, 16, v144
    v_and_b32 v45, 0xffff0000, v144
    v_lshlrev_b32 v64, 16, v154
    v_and_b32 v65, 0xffff0000, v154
    v_lshlrev_b32 v46, 16, v145
    v_and_b32 v47, 0xffff0000, v145
    v_lshlrev_b32 v66, 16, v155
    v_and_b32 v67, 0xffff0000, v155
    v_mov_b32 v180, v111
    v_pk_add_f32 v[68:69], v[28:29], v[110:111] op_sel_hi:[1,0] neg_lo:[0,1] neg_hi:[0,1]
    v_pk_add_f32 v[70:71], v[30:31], v[110:111] op_sel_hi:[1,0] neg_lo:[0,1] neg_hi:[0,1]
    v_pk_add_f32 v[72:73], v[32:33], v[110:111] op_sel_hi:[1,0] neg_lo:[0,1] neg_hi:[0,1]
    v_pk_add_f32 v[74:75], v[34:35], v[110:111] op_sel_hi:[1,0] neg_lo:[0,1] neg_hi:[0,1]
    v_pk_add_f32 v[76:77], v[36:37], v[110:111] op_sel_hi:[1,0] neg_lo:[0,1] neg_hi:[0,1]
    v_pk_add_f32 v[78:79], v[38:39], v[110:111] op_sel_hi:[1,0] neg_lo:[0,1] neg_hi:[0,1]
    v_pk_add_f32 v[80:81], v[40:41], v[110:111] op_sel_hi:[1,0] neg_lo:[0,1] neg_hi:[0,1]
    v_pk_add_f32 v[82:83], v[42:43], v[110:111] op_sel_hi:[1,0] neg_lo:[0,1] neg_hi:[0,1]
    v_pk_add_f32 v[84:85], v[44:45], v[110:111] op_sel_hi:[1,0] neg_lo:[0,1] neg_hi:[0,1]
    v_pk_add_f32 v[86:87], v[46:47], v[110:111] op_sel_hi:[1,0] neg_lo:[0,1] neg_hi:[0,1]
    v_pk_mul_f32 v[68:69], v[68:69], v[180:181] op_sel_hi:[1,0]
    v_pk_mul_f32 v[70:71], v[70:71], v[180:181] op_sel_hi:[1,0]
    v_pk_mul_f32 v[72:73], v[72:73], v[180:181] op_sel_hi:[1,0]
    v_pk_mul_f32 v[74:75], v[74:75], v[180:181] op_sel_hi:[1,0]
    v_pk_mul_f32 v[76:77], v[76:77], v[180:181] op_sel_hi:[1,0]
    v_pk_mul_f32 v[78:79], v[78:79], v[180:181] op_sel_hi:[1,0]
    v_pk_mul_f32 v[80:81], v[80:81], v[180:181] op_sel_hi:[1,0]
    v_pk_mul_f32 v[82:83], v[82:83], v[180:181] op_sel_hi:[1,0]
    v_pk_mul_f32 v[84:85], v[84:85], v[180:181] op_sel_hi:[1,0]
    v_pk_mul_f32 v[86:87], v[86:87], v[180:181] op_sel_hi:[1,0]
    v_pk_mul_f32 v[68:69], v[68:69], v[48:49]
    v_pk_mul_f32 v[70:71], v[70:71], v[50:51]
    v_pk_mul_f32 v[72:73], v[72:73], v[52:53]
    v_pk_mul_f32 v[74:75], v[74:75], v[54:55]
    v_pk_mul_f32 v[76:77], v[76:77], v[56:57]
    v_pk_mul_f32 v[78:79], v[78:79], v[58:59]
    v_pk_mul_f32 v[80:81], v[80:81], v[60:61]
    v_pk_mul_f32 v[82:83], v[82:83], v[62:63]
    v_pk_mul_f32 v[84:85], v[84:85], v[64:65]
    v_pk_mul_f32 v[86:87], v[86:87], v[66:67]
    v_pk_fma_f32 v[68:69], v[68:69], v[8:9], v[28:29]
    v_pk_fma_f32 v[70:71], v[70:71], v[10:11], v[30:31]
    v_pk_fma_f32 v[72:73], v[72:73], v[12:13], v[32:33]
    v_pk_fma_f32 v[74:75], v[74:75], v[14:15], v[34:35]
    v_pk_fma_f32 v[76:77], v[76:77], v[16:17], v[36:37]
    v_pk_fma_f32 v[78:79], v[78:79], v[18:19], v[38:39]
    v_pk_fma_f32 v[80:81], v[80:81], v[20:21], v[40:41]
    v_pk_fma_f32 v[82:83], v[82:83], v[22:23], v[42:43]
    v_pk_fma_f32 v[84:85], v[84:85], v[24:25], v[44:45]
    v_pk_fma_f32 v[86:87], v[86:87], v[26:27], v[46:47]
    v_cvt_pk_bf16_f32 v136, v68, v69
    v_cvt_pk_bf16_f32 v137, v70, v71
    v_cvt_pk_bf16_f32 v138, v72, v73
    v_cvt_pk_bf16_f32 v139, v74, v75
    v_cvt_pk_bf16_f32 v140, v76, v77
    v_cvt_pk_bf16_f32 v141, v78, v79
    v_cvt_pk_bf16_f32 v142, v80, v81
    v_cvt_pk_bf16_f32 v143, v82, v83
    v_cvt_pk_bf16_f32 v144, v84, v85
    v_cvt_pk_bf16_f32 v145, v86, v87
    v_add_u32 v182, 143360, v176
    ds_write_b64 v182, v[136:137] offset:0
    ds_write_b64 v182, v[138:139] offset:32
    ds_write_b64 v182, v[140:141] offset:64
    ds_write_b64 v182, v[142:143] offset:96
    ds_write_b64 v182, v[144:145] offset:128
    s_mul_i32 s40, s34, 2560
    s_add_u32 s40, s40, 143360
    v_add_u32 v4, s40, v7
    s_waitcnt lgkmcnt(0)
    ds_read_b128 v[8:11], v4 offset:0
    ds_read_b128 v[12:15], v4 offset:1024
    ds_read_b128 v[16:19], v4 offset:2048
    s_mul_i32 s40, s34, 20480
    s_add_u32 s40, s40, s45
    s_waitcnt lgkmcnt(0)
    buffer_store_dwordx4 v[8:11], v104, s[16:19], s40 offen
    buffer_store_dwordx4 v[12:15], v105, s[16:19], s40 offen
    s_mov_b32 exec_hi, 0
    buffer_store_dwordx4 v[16:19], v106, s[16:19], s40 offen
    s_mov_b64 exec, -1
k3_kernel_end:
    s_endpgm
.section .rodata,"a"
.p2align 6
.amdhsa_kernel k1_kernel
  .amdhsa_next_free_vgpr 248
  .amdhsa_next_free_sgpr 102
  .amdhsa_accum_offset 248
  .amdhsa_group_segment_fixed_size 0
  .amdhsa_kernarg_size 112
  .amdhsa_user_sgpr_count 2
  .amdhsa_user_sgpr_kernarg_segment_ptr 1
  .amdhsa_system_sgpr_workgroup_id_x 1
.end_amdhsa_kernel
.p2align 6
.amdhsa_kernel k2_kernel
  .amdhsa_next_free_vgpr 197
  .amdhsa_next_free_sgpr 102
  .amdhsa_accum_offset 200
  .amdhsa_group_segment_fixed_size 0
  .amdhsa_kernarg_size 112
  .amdhsa_user_sgpr_count 2
  .amdhsa_user_sgpr_kernarg_segment_ptr 1
  .amdhsa_system_sgpr_workgroup_id_x 1
.end_amdhsa_kernel
.p2align 6
.amdhsa_kernel k3_kernel
  .amdhsa_next_free_vgpr 183
  .amdhsa_next_free_sgpr 102
  .amdhsa_accum_offset 184
  .amdhsa_group_segment_fixed_size 0
  .amdhsa_kernarg_size 112
  .amdhsa_user_sgpr_count 2
  .amdhsa_user_sgpr_kernarg_segment_ptr 1
  .amdhsa_system_sgpr_workgroup_id_x 1
.end_amdhsa_kernel
```

```asm
; @launch kernel=k1_kernel grid=(256,1,1) block=(512,1,1) lds=163840
; @launch kernel=k2_kernel grid=(512,1,1) block=(256,1,1) lds=81920
; @launch kernel=k3_kernel grid=(256,1,1) block=(256,1,1) lds=153600
.amdgcn_target "amdgcn-amd-amdhsa--gfx950"
.text
.globl k1_kernel
.p2align 8
.type k1_kernel,@function
k1_kernel:
    s_cmp_ge_u32 s2, 256
    s_cbranch_scc1 k1_kernel_end
    s_load_dwordx2 s[4:5], s[0:1], 0
    s_load_dwordx2 s[8:9], s[0:1], 56
    s_load_dwordx2 s[12:13], s[0:1], 8
    s_load_dwordx2 s[16:17], s[0:1], 16
    s_load_dwordx2 s[20:21], s[0:1], 24
    s_load_dwordx2 s[24:25], s[0:1], 104
    s_load_dwordx2 s[28:29], s[0:1], 96
    s_load_dwordx2 s[32:33], s[0:1], 64
    s_load_dwordx2 s[36:37], s[0:1], 32
    s_load_dwordx2 s[84:85], s[0:1], 80
    v_lshrrev_b32 v2, 6, v0
    v_and_b32 v1, 63, v0
    v_readfirstlane_b32 s42, v2
    v_lshrrev_b32 v2, 4, v1
    v_and_b32 v3, 15, v1
    s_and_b32 s48, s2, 7
    s_lshr_b32 s49, s2, 3
    s_lshr_b32 s66, s48, 1
    s_and_b32 s67, s48, 1
    s_lshl_b32 s40, s66, 3
    s_and_b32 s48, s49, 7
    s_add_u32 s40, s40, s48
    s_lshl_b32 s41, s67, 2
    s_lshr_b32 s48, s49, 3
    s_add_u32 s41, s41, s48
    s_mul_i32 s52, s40, 81920
    s_mul_i32 s54, s41, 192
    s_add_u32 s53, s54, 1536
    s_lshl_b32 s60, s42, 11
    s_mul_i32 s61, s42, 3072
    s_mov_b32 s6, 2621440
    s_mov_b32 s7, 0x20000
    s_mov_b32 s10, 1966080
    s_mov_b32 s11, 0x20000
    s_lshl_b32 s48, s42, 3
    v_add_u32 v4, s48, v2
    v_and_b32 v5, 15, v4
    v_xor_b32 v5, v5, v3
    v_mul_u32_u24 v4, 1280, v4
    v_lshl_add_u32 v38, v5, 4, v4
    v_add_u32 v4, s48, v2
    v_add_u32 v4, 4, v4
    v_and_b32 v5, 15, v4
    v_xor_b32 v5, v5, v3
    v_mul_u32_u24 v4, 1280, v4
    v_lshl_add_u32 v39, v5, 4, v4
    s_mul_i32 s48, s42, 192
    v_add_u32 v4, s48, v1
    v_mul_u32_u24 v5, 43691, v4
    v_lshrrev_b32 v5, 19, v5
    v_mul_u32_u24 v6, 12, v5
    v_sub_u32 v4, v4, v6
    v_lshrrev_b32 v6, 2, v5
    v_and_b32 v6, 2, v6
    v_xor_b32 v4, v4, v6
    v_mul_u32_u24 v5, 3072, v5
    v_lshl_add_u32 v40, v4, 4, v5
    v_add_u32 v4, s48, v1
    v_add_u32 v4, 64, v4
    v_mul_u32_u24 v5, 43691, v4
    v_lshrrev_b32 v5, 19, v5
    v_mul_u32_u24 v6, 12, v5
    v_sub_u32 v4, v4, v6
    v_lshrrev_b32 v6, 2, v5
    v_and_b32 v6, 2, v6
    v_xor_b32 v4, v4, v6
    v_mul_u32_u24 v5, 3072, v5
    v_lshl_add_u32 v41, v4, 4, v5
    v_add_u32 v4, s48, v1
    v_add_u32 v4, 128, v4
    v_mul_u32_u24 v5, 43691, v4
    v_lshrrev_b32 v5, 19, v5
    v_mul_u32_u24 v6, 12, v5
    v_sub_u32 v4, v4, v6
    v_lshrrev_b32 v6, 2, v5
    v_and_b32 v6, 2, v6
    v_xor_b32 v4, v4, v6
    v_mul_u32_u24 v5, 3072, v5
    v_lshl_add_u32 v42, v4, 4, v5
    s_add_u32 s48, s40, s41
    s_mul_i32 s49, s48, 52
    s_lshr_b32 s49, s49, 8
    s_mul_i32 s49, s49, 5
    s_sub_u32 s51, s48, s49
    s_add_u32 s49, s51, 0
    s_sub_u32 s50, s49, 5
    s_cmp_ge_u32 s49, 5
    s_cselect_b32 s49, s50, s49
    s_lshl_b32 s90, s49, 8
    s_mul_i32 s95, s49, 393216
    s_add_u32 s49, s51, 1
    s_sub_u32 s50, s49, 5
    s_cmp_ge_u32 s49, 5
    s_cselect_b32 s49, s50, s49
    s_lshl_b32 s91, s49, 8
    s_mul_i32 s96, s49, 393216
    s_waitcnt lgkmcnt(0)
    s_add_u32 s65, s52, s90
    s_add_u32 m0, s60, 0
    s_nop 0
    buffer_load_dwordx4 v38, s[4:7], s65 offen lds
    s_add_u32 s65, s52, s90
    s_add_u32 m0, s60, 1024
    s_nop 0
    buffer_load_dwordx4 v39, s[4:7], s65 offen lds
    s_add_u32 s65, s53, s95
    s_add_u32 m0, s61, 81920
    s_nop 0
    buffer_load_dwordx4 v40, s[8:11], s65 offen lds
    s_add_u32 s65, s53, s95
    s_add_u32 m0, s61, 82944
    s_nop 0
    buffer_load_dwordx4 v41, s[8:11], s65 offen lds
    s_add_u32 s65, s53, s95
    s_add_u32 m0, s61, 83968
    s_nop 0
    buffer_load_dwordx4 v42, s[8:11], s65 offen lds
    s_mov_b32 s48, 14712832
    s_load_dwordx2 s[100:101], s[24:25], s48
    s_add_u32 s49, s51, 2
    s_sub_u32 s50, s49, 5
    s_cmp_ge_u32 s49, 5
    s_cselect_b32 s49, s50, s49
    s_lshl_b32 s92, s49, 8
    s_mul_i32 s97, s49, 393216
    s_add_u32 s49, s51, 3
    s_sub_u32 s50, s49, 5
    s_cmp_ge_u32 s49, 5
    s_cselect_b32 s49, s50, s49
    s_lshl_b32 s93, s49, 8
    s_mul_i32 s98, s49, 393216
    s_add_u32 s49, s51, 4
    s_sub_u32 s50, s49, 5
    s_cmp_ge_u32 s49, 5
    s_cselect_b32 s49, s50, s49
    s_lshl_b32 s94, s49, 8
    s_mul_i32 s99, s49, 393216
    s_mov_b32 s14, 2621440
    s_mov_b32 s15, 0x20000
    s_mov_b32 s18, 2621440
    s_mov_b32 s19, 0x20000
    s_mov_b32 s22, 5120
    s_mov_b32 s23, 0x20000
    s_mov_b32 s26, 15990784
    s_mov_b32 s27, 0x20000
    s_mov_b32 s30, 256
    s_mov_b32 s31, 0x20000
    s_mov_b32 s34, 8388608
    s_mov_b32 s35, 0x20000
    s_mov_b32 s38, 2621440
    s_mov_b32 s39, 0x20000
    s_mov_b32 s86, 983040
    s_mov_b32 s87, 0x20000
    v_lshlrev_b32 v36, 7, v1
    s_barrier
    s_add_u32 s65, s52, s91
    s_add_u32 m0, s60, 16384
    s_nop 0
    buffer_load_dwordx4 v38, s[4:7], s65 offen lds
    s_add_u32 s65, s52, s91
    s_add_u32 m0, s60, 17408
    s_nop 0
    buffer_load_dwordx4 v39, s[4:7], s65 offen lds
    s_add_u32 s65, s53, s96
    s_add_u32 m0, s61, 106496
    s_nop 0
    buffer_load_dwordx4 v40, s[8:11], s65 offen lds
    s_add_u32 s65, s53, s96
    s_add_u32 m0, s61, 107520
    s_nop 0
    buffer_load_dwordx4 v41, s[8:11], s65 offen lds
    s_add_u32 s65, s53, s96
    s_add_u32 m0, s61, 108544
    s_nop 0
    buffer_load_dwordx4 v42, s[8:11], s65 offen lds
    s_cmp_lg_u32 s42, 7
    s_cbranch_scc1 k1_shk_1
    v_lshlrev_b32 v4, 4, v1
    s_mul_i32 s48, s41, 640
    s_mov_b32 m0, 160768
    s_mov_b32 exec_lo, -1
    s_mov_b32 exec_hi, 0xff
    buffer_load_dwordx4 v4, s[20:23], s48 offen lds
    s_mov_b64 exec, -1
k1_shk_1:
    s_and_b32 s43, s42, 1
    s_lshr_b32 s44, s42, 1
    s_and_b32 s44, s44, 1
    s_lshr_b32 s45, s42, 2
    s_xor_b32 s46, s43, s45
    s_lshl_b32 s47, s44, 1
    s_add_u32 s47, s47, s46
    s_mov_b32 s55, 0x3727c5ac
    s_mov_b32 s56, 0x3f803f80
    s_mov_b32 s58, 0xbdd2d3e8
    s_mov_b32 s59, 0xbdd2d3e8
    s_lshl_b32 s48, s45, 1
    s_add_u32 s63, s48, s44
    s_xor_b32 s64, s63, 1
    v_xor_b32 v4, v2, v3
    v_lshlrev_b32 v6, 8, v3
    s_lshl_b32 s48, s44, 13
    s_lshl_b32 s49, s46, 12
    s_add_u32 s50, s48, s49
    s_xor_b32 s49, s49, 4096
    s_add_u32 s51, s48, s49
    s_lshl_b32 s48, s63, 2
    v_xor_b32 v5, s48, v4
    v_lshl_add_u32 v5, v5, 4, v6
    v_add_u32 v45, s50, v5
    v_add_u32 v46, s51, v5
    s_lshl_b32 s48, s64, 2
    v_xor_b32 v5, s48, v4
    v_lshl_add_u32 v5, v5, 4, v6
    v_add_u32 v47, s50, v5
    v_add_u32 v216, s51, v5
    v_lshrrev_b32 v5, 2, v3
    v_lshl_add_u32 v4, v2, 3, v5
    v_mul_u32_u24 v4, 192, v4
    v_and_b32 v5, 3, v3
    v_lshl_add_u32 v4, v5, 3, v4
    v_and_b32 v5, 1, v2
    s_mul_i32 s51, s43, 3
    s_mul_i32 s49, s63, 6144
    s_add_u32 s49, s49, 81920
    s_mul_i32 s50, s64, 6144
    s_add_u32 s50, s50, 81920
    s_add_u32 s48, s51, 0
    v_xor_b32 v6, s48, v5
    v_lshl_add_u32 v6, v6, 5, v4
    v_add_u32 v217, s49, v6
    v_add_u32 v220, s50, v6
    s_add_u32 s48, s51, 1
    v_xor_b32 v6, s48, v5
    v_lshl_add_u32 v6, v6, 5, v4
    v_add_u32 v218, s49, v6
    v_add_u32 v221, s50, v6
    s_add_u32 s48, s51, 2
    v_xor_b32 v6, s48, v5
    v_lshl_add_u32 v6, v6, 5, v4
    v_add_u32 v219, s49, v6
    v_add_u32 v222, s50, v6
    v_mov_b32 v244, s56
    v_mov_b32 v245, s56
    v_mov_b32 v246, s56
    v_mov_b32 v247, s56
    v_mul_u32_u24 v43, 205, v1
    v_lshrrev_b32 v43, 11, v43
    v_mul_u32_u24 v4, 10, v43
    v_sub_u32 v44, v1, v4
    s_lshl_b32 s48, s42, 3
    v_lshl_add_u32 v4, v43, 1, s48
    v_min_u32 v4, 62, v4
    v_mul_u32_u24 v4, 160, v4
    v_lshl_add_u32 v7, v44, 4, v4
    v_lshlrev_b32 v215, 10, v1
    s_lshl_b32 s89, s2, 3
    s_add_u32 s89, s89, s42
    s_mul_i32 s70, s42, 3072
    s_add_u32 s70, s70, 16384
    s_xor_b32 s48, s42, 4
    s_mul_i32 s71, s48, 3072
    s_add_u32 s71, s71, 16384
    s_lshl_b32 s48, s43, 2
    s_lshl_b32 s49, s44, 1
    s_add_u32 s48, s48, s49
    s_add_u32 s48, s48, s45
    s_mul_i32 s72, s48, 192
    s_add_u32 s72, s72, 155648
    s_mul_i32 s73, s43, 768
    s_add_u32 s73, s73, 155648
    s_lshl_b32 s48, s47, 1
    s_add_u32 s48, s48, s45
    s_lshl_b32 s48, s48, 7
    s_add_u32 s74, s48, 158720
    s_lshl_b32 s48, s47, 8
    s_add_u32 s75, s48, 158720
    s_lshl_b32 s48, s47, 7
    s_lshl_b32 s49, s43, 9
    s_add_u32 s48, s48, s49
    s_add_u32 s76, s48, 159744
    s_lshl_b32 s48, s40, 3
    s_add_u32 s48, s48, s41
    s_lshl_b32 s49, s48, 10
    s_add_u32 s77, s49, 14745600
    s_mul_i32 s48, s48, 12288
    s_lshr_b32 s49, s47, 1
    s_mul_i32 s49, s49, 6144
    s_add_u32 s48, s48, s49
    s_and_b32 s49, s47, 1
    s_lshl_b32 s49, s49, 8
    s_add_u32 s48, s48, s49
    s_add_u32 s48, s48, 3145728
    s_mul_i32 s49, s43, 3
    s_add_u32 s49, s49, 0
    s_lshr_b32 s50, s49, 1
    s_lshl_b32 s50, s50, 10
    s_and_b32 s49, s49, 1
    s_lshl_b32 s49, s49, 3
    s_add_u32 s80, s48, s49
    s_add_u32 s80, s80, s50
    s_mul_i32 s49, s43, 3
    s_add_u32 s49, s49, 1
    s_lshr_b32 s50, s49, 1
    s_lshl_b32 s50, s50, 10
    s_and_b32 s49, s49, 1
    s_lshl_b32 s49, s49, 3
    s_add_u32 s81, s48, s49
    s_add_u32 s81, s81, s50
    s_mul_i32 s49, s43, 3
    s_add_u32 s49, s49, 2
    s_lshr_b32 s50, s49, 1
    s_lshl_b32 s50, s50, 10
    s_and_b32 s49, s49, 1
    s_lshl_b32 s49, s49, 3
    s_add_u32 s82, s48, s49
    s_add_u32 s82, s82, s50
    s_lshl_b32 s48, s40, 13
    s_lshl_b32 s49, s47, 8
    s_add_u32 s48, s48, s49
    s_add_u32 s78, s48, 14745600
    s_lshl_b32 s48, s40, 9
    s_lshl_b32 s49, s47, 7
    s_add_u32 s48, s48, s49
    s_add_u32 s79, s48, 14680064
    s_mul_i32 s48, s41, 327680
    s_lshl_b32 s49, s40, 7
    s_add_u32 s48, s48, s49
    s_add_u32 s83, s48, 6291456
    s_lshr_b32 s48, s2, 3
    s_lshl_b32 s48, s48, 3
    s_add_u32 s48, s48, s42
    s_lshl_b32 s48, s48, 13
    s_lshl_b32 s49, s66, 21
    s_add_u32 s66, s48, s49
    s_add_u32 s51, s42, 0
    s_mul_i32 s48, s51, 43
    s_lshr_b32 s48, s48, 7
    s_mul_i32 s49, s48, 3
    s_sub_u32 s49, s51, s49
    s_mul_i32 s48, s48, 3200
    s_lshl_b32 s49, s49, 6
    s_add_u32 s48, s48, s49
    s_add_u32 s88, s48, 0
    s_lshl_b32 s48, s41, 7
    s_lshl_b32 s49, s40, 2
    s_add_u32 s48, s48, s49
    s_mul_i32 s48, s48, 3
    s_add_u32 s48, s48, s51
    s_lshl_b32 s48, s48, 10
    s_add_u32 s64, s48, 0
    s_add_u32 s51, s42, 8
    s_mul_i32 s48, s51, 43
    s_lshr_b32 s48, s48, 7
    s_mul_i32 s49, s48, 3
    s_sub_u32 s49, s51, s49
    s_mul_i32 s48, s48, 3200
    s_lshl_b32 s49, s49, 6
    s_add_u32 s48, s48, s49
    s_add_u32 s63, s48, 0
    s_lshl_b32 s48, s41, 7
    s_lshl_b32 s49, s40, 2
    s_add_u32 s48, s48, s49
    s_mul_i32 s48, s48, 3
    s_add_u32 s48, s48, s51
    s_lshl_b32 s48, s48, 10
    s_add_u32 s67, s48, 0
    s_waitcnt vmcnt(5)
    s_waitcnt lgkmcnt(0)
    s_add_u32 s100, s100, 1
    s_addc_u32 s101, s101, 0
    s_barrier
    ds_read_b64_tr_b16 v[128:129], v217 offset:0
    ds_read_b64_tr_b16 v[130:131], v217 offset:768
    ds_read_b64_tr_b16 v[132:133], v218 offset:0
    ds_read_b64_tr_b16 v[134:135], v218 offset:768
    ds_read_b64_tr_b16 v[136:137], v219 offset:0
    ds_read_b64_tr_b16 v[138:139], v219 offset:768
    ds_read_b64_tr_b16 v[140:141], v220 offset:0
    ds_read_b64_tr_b16 v[142:143], v220 offset:768
    ds_read_b64_tr_b16 v[144:145], v221 offset:0
    ds_read_b64_tr_b16 v[146:147], v221 offset:768
    ds_read_b64_tr_b16 v[148:149], v222 offset:0
    ds_read_b64_tr_b16 v[150:151], v222 offset:768
    ds_read_b128 v[48:51], v45 offset:0
    ds_read_b128 v[52:55], v46 offset:0
    ds_read_b128 v[56:59], v47 offset:0
    ds_read_b128 v[60:63], v216 offset:0
    s_add_u32 s65, s52, s92
    s_add_u32 m0, s60, 32768
    s_nop 0
    buffer_load_dwordx4 v38, s[4:7], s65 offen lds
    s_add_u32 s65, s52, s92
    s_add_u32 m0, s60, 33792
    s_nop 0
    buffer_load_dwordx4 v39, s[4:7], s65 offen lds
    s_add_u32 s65, s53, s97
    s_add_u32 m0, s61, 131072
    s_nop 0
    buffer_load_dwordx4 v40, s[8:11], s65 offen lds
    s_add_u32 s65, s53, s97
    s_add_u32 m0, s61, 132096
    s_nop 0
    buffer_load_dwordx4 v41, s[8:11], s65 offen lds
    s_add_u32 s65, s53, s97
    s_add_u32 m0, s61, 133120
    s_nop 0
    buffer_load_dwordx4 v42, s[8:11], s65 offen lds
    s_waitcnt vmcnt(5)
    s_waitcnt lgkmcnt(0)
    s_barrier
    v_mfma_f32_16x16x32_bf16 v[176:179], v[128:131], v[48:51], 0
    ds_read_b64_tr_b16 v[152:153], v217 offset:24576
    ds_read_b64_tr_b16 v[154:155], v217 offset:25344
    v_mfma_f32_16x16x32_bf16 v[180:183], v[128:131], v[52:55], 0
    s_add_u32 s65, s52, s93
    s_add_u32 m0, s60, 49152
    s_nop 0
    buffer_load_dwordx4 v38, s[4:7], s65 offen lds
    ds_read_b64_tr_b16 v[156:157], v218 offset:24576
    ds_read_b64_tr_b16 v[158:159], v218 offset:25344
    v_mfma_f32_16x16x32_bf16 v[224:227], v[128:131], v[244:247], 0
    ds_read_b64_tr_b16 v[160:161], v219 offset:24576
    ds_read_b64_tr_b16 v[162:163], v219 offset:25344
    v_mfma_f32_16x16x32_bf16 v[184:187], v[132:135], v[48:51], 0
    ds_read_b64_tr_b16 v[164:165], v220 offset:24576
    ds_read_b64_tr_b16 v[166:167], v220 offset:25344
    v_mfma_f32_16x16x32_bf16 v[188:191], v[132:135], v[52:55], 0
    s_add_u32 s65, s52, s93
    s_add_u32 m0, s60, 50176
    s_nop 0
    buffer_load_dwordx4 v39, s[4:7], s65 offen lds
    ds_read_b64_tr_b16 v[168:169], v221 offset:24576
    ds_read_b64_tr_b16 v[170:171], v221 offset:25344
    v_mfma_f32_16x16x32_bf16 v[228:231], v[132:135], v[244:247], 0
    ds_read_b64_tr_b16 v[172:173], v222 offset:24576
    ds_read_b64_tr_b16 v[174:175], v222 offset:25344
    v_mfma_f32_16x16x32_bf16 v[192:195], v[136:139], v[48:51], 0
    ds_read_b128 v[64:67], v45 offset:16384
    ds_read_b128 v[68:71], v46 offset:16384
    v_mfma_f32_16x16x32_bf16 v[196:199], v[136:139], v[52:55], 0
    s_add_u32 s65, s53, s98
    s_add_u32 m0, s61, 81920
    s_nop 0
    buffer_load_dwordx4 v40, s[8:11], s65 offen lds
    ds_read_b128 v[72:75], v47 offset:16384
    ds_read_b128 v[76:79], v216 offset:16384
    v_mfma_f32_16x16x32_bf16 v[232:235], v[136:139], v[244:247], 0
    v_mfma_f32_16x16x32_bf16 v[236:239], v[244:247], v[48:51], 0
    v_mfma_f32_16x16x32_bf16 v[240:243], v[48:51], v[48:51], 0
    s_add_u32 s65, s53, s98
    s_add_u32 m0, s61, 82944
    s_nop 0
    buffer_load_dwordx4 v41, s[8:11], s65 offen lds
    v_mfma_f32_16x16x32_bf16 v[176:179], v[140:143], v[56:59], v[176:179]
    v_mfma_f32_16x16x32_bf16 v[180:183], v[140:143], v[60:63], v[180:183]
    v_mfma_f32_16x16x32_bf16 v[184:187], v[144:147], v[56:59], v[184:187]
    s_add_u32 s65, s53, s98
    s_add_u32 m0, s61, 83968
    s_nop 0
    buffer_load_dwordx4 v42, s[8:11], s65 offen lds
    v_mfma_f32_16x16x32_bf16 v[188:191], v[144:147], v[60:63], v[188:191]
    v_mfma_f32_16x16x32_bf16 v[192:195], v[148:151], v[56:59], v[192:195]
    v_mfma_f32_16x16x32_bf16 v[196:199], v[148:151], v[60:63], v[196:199]
    v_mfma_f32_16x16x32_bf16 v[236:239], v[244:247], v[56:59], v[236:239]
    v_mfma_f32_16x16x32_bf16 v[240:243], v[56:59], v[56:59], v[240:243]
    s_waitcnt vmcnt(5)
    s_waitcnt lgkmcnt(0)
    s_barrier
    v_mfma_f32_16x16x32_bf16 v[176:179], v[152:155], v[64:67], v[176:179]
    ds_read_b64_tr_b16 v[128:129], v217 offset:49152
    ds_read_b64_tr_b16 v[130:131], v217 offset:49920
    v_mfma_f32_16x16x32_bf16 v[180:183], v[152:155], v[68:71], v[180:183]
    s_add_u32 s65, s52, s94
    s_add_u32 m0, s60, 65536
    s_nop 0
    buffer_load_dwordx4 v38, s[4:7], s65 offen lds
    ds_read_b64_tr_b16 v[132:133], v218 offset:49152
    ds_read_b64_tr_b16 v[134:135], v218 offset:49920
    v_mfma_f32_16x16x32_bf16 v[224:227], v[152:155], v[244:247], v[224:227]
    ds_read_b64_tr_b16 v[136:137], v219 offset:49152
    ds_read_b64_tr_b16 v[138:139], v219 offset:49920
    v_mfma_f32_16x16x32_bf16 v[184:187], v[156:159], v[64:67], v[184:187]
    ds_read_b64_tr_b16 v[140:141], v220 offset:49152
    ds_read_b64_tr_b16 v[142:143], v220 offset:49920
    v_mfma_f32_16x16x32_bf16 v[188:191], v[156:159], v[68:71], v[188:191]
    s_add_u32 s65, s52, s94
    s_add_u32 m0, s60, 66560
    s_nop 0
    buffer_load_dwordx4 v39, s[4:7], s65 offen lds
    ds_read_b64_tr_b16 v[144:145], v221 offset:49152
    ds_read_b64_tr_b16 v[146:147], v221 offset:49920
    v_mfma_f32_16x16x32_bf16 v[228:231], v[156:159], v[244:247], v[228:231]
    ds_read_b64_tr_b16 v[148:149], v222 offset:49152
    ds_read_b64_tr_b16 v[150:151], v222 offset:49920
    v_mfma_f32_16x16x32_bf16 v[192:195], v[160:163], v[64:67], v[192:195]
    ds_read_b128 v[80:83], v45 offset:32768
    ds_read_b128 v[84:87], v46 offset:32768
    v_mfma_f32_16x16x32_bf16 v[196:199], v[160:163], v[68:71], v[196:199]
    s_add_u32 s65, s53, s99
    s_add_u32 m0, s61, 106496
    s_nop 0
    buffer_load_dwordx4 v40, s[8:11], s65 offen lds
    ds_read_b128 v[88:91], v47 offset:32768
    ds_read_b128 v[92:95], v216 offset:32768
    v_mfma_f32_16x16x32_bf16 v[232:235], v[160:163], v[244:247], v[232:235]
    v_mfma_f32_16x16x32_bf16 v[236:239], v[244:247], v[64:67], v[236:239]
    v_mfma_f32_16x16x32_bf16 v[240:243], v[64:67], v[64:67], v[240:243]
    s_add_u32 s65, s53, s99
    s_add_u32 m0, s61, 107520
    s_nop 0
    buffer_load_dwordx4 v41, s[8:11], s65 offen lds
    v_mfma_f32_16x16x32_bf16 v[176:179], v[164:167], v[72:75], v[176:179]
    v_mfma_f32_16x16x32_bf16 v[180:183], v[164:167], v[76:79], v[180:183]
    v_mfma_f32_16x16x32_bf16 v[184:187], v[168:171], v[72:75], v[184:187]
    s_add_u32 s65, s53, s99
    s_add_u32 m0, s61, 108544
    s_nop 0
    buffer_load_dwordx4 v42, s[8:11], s65 offen lds
    v_mfma_f32_16x16x32_bf16 v[188:191], v[168:171], v[76:79], v[188:191]
    v_mfma_f32_16x16x32_bf16 v[192:195], v[172:175], v[72:75], v[192:195]
    v_mfma_f32_16x16x32_bf16 v[196:199], v[172:175], v[76:79], v[196:199]
    s_add_u32 s48, s66, 0
    s_mov_b64 exec, 0xff
    buffer_load_dword v37, v215, s[32:35], s48 offen
    s_mov_b64 exec, -1
    v_mfma_f32_16x16x32_bf16 v[236:239], v[244:247], v[72:75], v[236:239]
    v_mfma_f32_16x16x32_bf16 v[240:243], v[72:75], v[72:75], v[240:243]
    s_waitcnt vmcnt(6)
    s_waitcnt lgkmcnt(0)
    s_barrier
    v_mfma_f32_16x16x32_bf16 v[176:179], v[128:131], v[80:83], v[176:179]
    ds_read_b64_tr_b16 v[152:153], v217 offset:0
    ds_read_b64_tr_b16 v[154:155], v217 offset:768
    v_mfma_f32_16x16x32_bf16 v[180:183], v[128:131], v[84:87], v[180:183]
    s_add_u32 s65, s54, s95
    s_add_u32 m0, s61, 131072
    s_nop 0
    buffer_load_dwordx4 v40, s[8:11], s65 offen lds
    ds_read_b64_tr_b16 v[156:157], v218 offset:0
    ds_read_b64_tr_b16 v[158:159], v218 offset:768
    v_mfma_f32_16x16x32_bf16 v[224:227], v[128:131], v[244:247], v[224:227]
    ds_read_b64_tr_b16 v[160:161], v219 offset:0
    ds_read_b64_tr_b16 v[162:163], v219 offset:768
    v_mfma_f32_16x16x32_bf16 v[184:187], v[132:135], v[80:83], v[184:187]
    ds_read_b64_tr_b16 v[164:165], v220 offset:0
    ds_read_b64_tr_b16 v[166:167], v220 offset:768
    v_mfma_f32_16x16x32_bf16 v[188:191], v[132:135], v[84:87], v[188:191]
    s_add_u32 s65, s54, s95
    s_add_u32 m0, s61, 132096
    s_nop 0
    buffer_load_dwordx4 v41, s[8:11], s65 offen lds
    ds_read_b64_tr_b16 v[168:169], v221 offset:0
    ds_read_b64_tr_b16 v[170:171], v221 offset:768
    v_mfma_f32_16x16x32_bf16 v[228:231], v[132:135], v[244:247], v[228:231]
    ds_read_b64_tr_b16 v[172:173], v222 offset:0
    ds_read_b64_tr_b16 v[174:175], v222 offset:768
    v_mfma_f32_16x16x32_bf16 v[192:195], v[136:139], v[80:83], v[192:195]
    ds_read_b128 v[96:99], v45 offset:49152
    ds_read_b128 v[100:103], v46 offset:49152
    v_mfma_f32_16x16x32_bf16 v[196:199], v[136:139], v[84:87], v[196:199]
    s_add_u32 s65, s54, s95
    s_add_u32 m0, s61, 133120
    s_nop 0
    buffer_load_dwordx4 v42, s[8:11], s65 offen lds
    ds_read_b128 v[104:107], v47 offset:49152
    ds_read_b128 v[108:111], v216 offset:49152
    v_mfma_f32_16x16x32_bf16 v[232:235], v[136:139], v[244:247], v[232:235]
    v_mfma_f32_16x16x32_bf16 v[236:239], v[244:247], v[80:83], v[236:239]
    v_mfma_f32_16x16x32_bf16 v[240:243], v[80:83], v[80:83], v[240:243]
    s_add_u32 s48, s66, 128
    s_mov_b64 exec, 0xff
    buffer_load_dword v37, v215, s[32:35], s48 offen
    s_mov_b64 exec, -1
    v_mfma_f32_16x16x32_bf16 v[176:179], v[140:143], v[88:91], v[176:179]
    v_mfma_f32_16x16x32_bf16 v[180:183], v[140:143], v[92:95], v[180:183]
    v_mfma_f32_16x16x32_bf16 v[184:187], v[144:147], v[88:91], v[184:187]
    s_mul_i32 s48, s89, 1280
    s_add_u32 s48, s48, 0
    s_mov_b64 exec, 0x1f
    buffer_load_dword v37, v36, s[36:39], s48 offen
    s_mov_b64 exec, -1
    v_mfma_f32_16x16x32_bf16 v[188:191], v[144:147], v[92:95], v[188:191]
    v_mfma_f32_16x16x32_bf16 v[192:195], v[148:151], v[88:91], v[192:195]
    v_mfma_f32_16x16x32_bf16 v[196:199], v[148:151], v[92:95], v[196:199]
    v_mfma_f32_16x16x32_bf16 v[236:239], v[244:247], v[88:91], v[236:239]
    v_mfma_f32_16x16x32_bf16 v[240:243], v[88:91], v[88:91], v[240:243]
    s_waitcnt vmcnt(6)
    s_waitcnt lgkmcnt(0)
    s_barrier
    v_mfma_f32_16x16x32_bf16 v[176:179], v[152:155], v[96:99], v[176:179]
    ds_read_b64_tr_b16 v[128:129], v217 offset:24576
    ds_read_b64_tr_b16 v[130:131], v217 offset:25344
    v_mfma_f32_16x16x32_bf16 v[180:183], v[152:155], v[100:103], v[180:183]
    s_add_u32 s65, s54, s96
    s_add_u32 m0, s61, 81920
    s_nop 0
    buffer_load_dwordx4 v40, s[8:11], s65 offen lds
    ds_read_b64_tr_b16 v[132:133], v218 offset:24576
    ds_read_b64_tr_b16 v[134:135], v218 offset:25344
    v_mfma_f32_16x16x32_bf16 v[224:227], v[152:155], v[244:247], v[224:227]
    ds_read_b64_tr_b16 v[136:137], v219 offset:24576
    ds_read_b64_tr_b16 v[138:139], v219 offset:25344
    v_mfma_f32_16x16x32_bf16 v[184:187], v[156:159], v[96:99], v[184:187]
    ds_read_b64_tr_b16 v[140:141], v220 offset:24576
    ds_read_b64_tr_b16 v[142:143], v220 offset:25344
    v_mfma_f32_16x16x32_bf16 v[188:191], v[156:159], v[100:103], v[188:191]
    s_add_u32 s65, s54, s96
    s_add_u32 m0, s61, 82944
    s_nop 0
    buffer_load_dwordx4 v41, s[8:11], s65 offen lds
    ds_read_b64_tr_b16 v[144:145], v221 offset:24576
    ds_read_b64_tr_b16 v[146:147], v221 offset:25344
    v_mfma_f32_16x16x32_bf16 v[228:231], v[156:159], v[244:247], v[228:231]
    ds_read_b64_tr_b16 v[148:149], v222 offset:24576
    ds_read_b64_tr_b16 v[150:151], v222 offset:25344
    v_mfma_f32_16x16x32_bf16 v[192:195], v[160:163], v[96:99], v[192:195]
    v_add_u32 v45, 0x10000, v45
    v_add_u32 v46, 0x10000, v46
    v_add_u32 v47, 0x10000, v47
    v_add_u32 v216, 0x10000, v216
    ds_read_b128 v[112:115], v45 offset:0
    ds_read_b128 v[116:119], v46 offset:0
    v_mfma_f32_16x16x32_bf16 v[196:199], v[160:163], v[100:103], v[196:199]
    s_add_u32 s65, s54, s96
    s_add_u32 m0, s61, 83968
    s_nop 0
    buffer_load_dwordx4 v42, s[8:11], s65 offen lds
    ds_read_b128 v[120:123], v47 offset:0
    ds_read_b128 v[124:127], v216 offset:0
    v_mfma_f32_16x16x32_bf16 v[232:235], v[160:163], v[244:247], v[232:235]
    v_mfma_f32_16x16x32_bf16 v[236:239], v[244:247], v[96:99], v[236:239]
    v_mfma_f32_16x16x32_bf16 v[240:243], v[96:99], v[96:99], v[240:243]
    s_add_u32 s48, s66, 256
    s_mov_b64 exec, 0xff
    buffer_load_dword v37, v215, s[32:35], s48 offen
    s_mov_b64 exec, -1
    v_mfma_f32_16x16x32_bf16 v[176:179], v[164:167], v[104:107], v[176:179]
    v_mfma_f32_16x16x32_bf16 v[180:183], v[164:167], v[108:111], v[180:183]
    v_mfma_f32_16x16x32_bf16 v[184:187], v[168:171], v[104:107], v[184:187]
    v_mfma_f32_16x16x32_bf16 v[188:191], v[168:171], v[108:111], v[188:191]
    v_mfma_f32_16x16x32_bf16 v[192:195], v[172:175], v[104:107], v[192:195]
    v_mfma_f32_16x16x32_bf16 v[196:199], v[172:175], v[108:111], v[196:199]
    v_mfma_f32_16x16x32_bf16 v[236:239], v[244:247], v[104:107], v[236:239]
    v_mfma_f32_16x16x32_bf16 v[240:243], v[104:107], v[104:107], v[240:243]
    s_waitcnt vmcnt(6)
    s_waitcnt lgkmcnt(0)
    s_barrier
    v_mfma_f32_16x16x32_bf16 v[176:179], v[128:131], v[112:115], v[176:179]
    ds_read_b64_tr_b16 v[152:153], v217 offset:49152
    ds_read_b64_tr_b16 v[154:155], v217 offset:49920
    v_mfma_f32_16x16x32_bf16 v[180:183], v[128:131], v[116:119], v[180:183]
    s_add_u32 s65, s54, s97
    s_add_u32 m0, s61, 106496
    s_nop 0
    buffer_load_dwordx4 v40, s[8:11], s65 offen lds
    ds_read_b64_tr_b16 v[156:157], v218 offset:49152
    ds_read_b64_tr_b16 v[158:159], v218 offset:49920
    v_mfma_f32_16x16x32_bf16 v[224:227], v[128:131], v[244:247], v[224:227]
    ds_read_b64_tr_b16 v[160:161], v219 offset:49152
    ds_read_b64_tr_b16 v[162:163], v219 offset:49920
    v_mfma_f32_16x16x32_bf16 v[184:187], v[132:135], v[112:115], v[184:187]
    ds_read_b64_tr_b16 v[164:165], v220 offset:49152
    ds_read_b64_tr_b16 v[166:167], v220 offset:49920
    v_mfma_f32_16x16x32_bf16 v[188:191], v[132:135], v[116:119], v[188:191]
    s_add_u32 s65, s54, s97
    s_add_u32 m0, s61, 107520
    s_nop 0
    buffer_load_dwordx4 v41, s[8:11], s65 offen lds
    ds_read_b64_tr_b16 v[168:169], v221 offset:49152
    ds_read_b64_tr_b16 v[170:171], v221 offset:49920
    v_mfma_f32_16x16x32_bf16 v[228:231], v[132:135], v[244:247], v[228:231]
    ds_read_b64_tr_b16 v[172:173], v222 offset:49152
    ds_read_b64_tr_b16 v[174:175], v222 offset:49920
    v_mfma_f32_16x16x32_bf16 v[192:195], v[136:139], v[112:115], v[192:195]
    v_mfma_f32_16x16x32_bf16 v[196:199], v[136:139], v[116:119], v[196:199]
    s_add_u32 s65, s54, s97
    s_add_u32 m0, s61, 108544
    s_nop 0
    buffer_load_dwordx4 v42, s[8:11], s65 offen lds
    v_mfma_f32_16x16x32_bf16 v[232:235], v[136:139], v[244:247], v[232:235]
    v_mfma_f32_16x16x32_bf16 v[236:239], v[244:247], v[112:115], v[236:239]
    v_mfma_f32_16x16x32_bf16 v[240:243], v[112:115], v[112:115], v[240:243]
    s_add_u32 s48, s66, 384
    s_mov_b64 exec, 0xff
    buffer_load_dword v37, v215, s[32:35], s48 offen
    s_mov_b64 exec, -1
    v_mfma_f32_16x16x32_bf16 v[176:179], v[140:143], v[120:123], v[176:179]
    v_mfma_f32_16x16x32_bf16 v[180:183], v[140:143], v[124:127], v[180:183]
    v_mfma_f32_16x16x32_bf16 v[184:187], v[144:147], v[120:123], v[184:187]
    v_mfma_f32_16x16x32_bf16 v[188:191], v[144:147], v[124:127], v[188:191]
    v_mfma_f32_16x16x32_bf16 v[192:195], v[148:151], v[120:123], v[192:195]
    v_mfma_f32_16x16x32_bf16 v[196:199], v[148:151], v[124:127], v[196:199]
    v_mfma_f32_16x16x32_bf16 v[236:239], v[244:247], v[120:123], v[236:239]
    v_mfma_f32_16x16x32_bf16 v[240:243], v[120:123], v[120:123], v[240:243]
    v_lshl_add_u32 v4, v1, 4, s70
    v_lshl_add_u32 v5, v2, 4, s72
    ds_write_b128 v4, v[180:183] offset:0
    s_nop 0
    ds_write_b128 v4, v[188:191] offset:1024
    s_nop 0
    ds_write_b128 v4, v[196:199] offset:2048
    s_mov_b32 exec_lo, 0x00010001
    s_mov_b32 exec_hi, 0x00010001
    ds_write_b128 v5, v[224:227] offset:0
    ds_write_b128 v5, v[228:231] offset:64
    ds_write_b128 v5, v[232:235] offset:128
    s_mov_b64 exec, -1
    v_and_b32 v8, 3, v3
    v_cmp_eq_u32 vcc, 1, v8
    s_nop 1
    v_cndmask_b32 v237, v240, v241, vcc
    v_cmp_eq_u32 vcc, 2, v8
    s_nop 1
    v_cndmask_b32 v237, v237, v242, vcc
    v_cmp_eq_u32 vcc, 3, v8
    s_nop 1
    v_cndmask_b32 v237, v237, v243, vcc
    v_lshl_add_u32 v6, v3, 3, s74
    s_mov_b32 exec_lo, 0x00F0000F
    s_mov_b32 exec_hi, 0xF0000F00
    ds_write_b64 v6, v[236:237]
    s_mov_b64 exec, -1
    v_pk_add_f32 v[200:201], v[176:177], 0
    v_pk_add_f32 v[202:203], v[178:179], 0
    v_pk_add_f32 v[204:205], v[184:185], 0
    v_pk_add_f32 v[206:207], v[186:187], 0
    v_pk_add_f32 v[208:209], v[192:193], 0
    v_pk_add_f32 v[210:211], v[194:195], 0
    v_mov_b32 v238, 0xc0135761
    v_mov_b32 v239, 0xc0135761
    s_waitcnt vmcnt(5)
    s_waitcnt lgkmcnt(0)
    s_barrier
    v_lshl_add_u32 v4, v1, 4, s71
    v_lshl_add_u32 v5, v3, 3, s75
    ds_read_b64 v[20:21], v5
    ds_read_b64 v[22:23], v5 offset:128
    ds_read_b128 v[8:11], v4 offset:0
    ds_read_b128 v[12:15], v4 offset:1024
    ds_read_b128 v[16:19], v4 offset:2048
    v_lshl_add_u32 v6, v2, 4, s73
    ds_read_b128 v[24:27], v6 offset:0
    ds_read_b128 v[28:31], v6 offset:64
    ds_read_b128 v[32:35], v6 offset:128
    ds_read_b128 v[176:179], v6 offset:192
    ds_read_b128 v[180:183], v6 offset:256
    ds_read_b128 v[184:187], v6 offset:320
    ds_read_b128 v[188:191], v6 offset:384
    ds_read_b128 v[192:195], v6 offset:448
    ds_read_b128 v[196:199], v6 offset:512
    ds_read_b128 v[224:227], v6 offset:576
    ds_read_b128 v[228:231], v6 offset:640
    ds_read_b128 v[232:235], v6 offset:704
    s_waitcnt lgkmcnt(15)
    v_pk_add_f32 v[240:241], v[20:21], v[22:23]
    v_mul_f32 v240, 0x3acccccd, v240
    v_mul_f32 v241, 0x3acccccd, v241
    v_fma_f32 v241, -v240, v240, v241
    v_max_f32 v241, 0, v241
    v_cvt_pk_bf16_f32 v241, v241, v240
    v_and_b32 v240, 0xffff0000, v241
    v_lshlrev_b32 v241, 16, v241
    v_add_f32 v241, s55, v241
    v_cvt_pk_bf16_f32 v241, v241, v241
    v_and_b32 v241, 0xffff0000, v241
    v_sqrt_f32 v241, v241
    s_nop 0
    v_cvt_pk_bf16_f32 v241, v241, v241
    v_and_b32 v241, 0xffff0000, v241
    v_rcp_f32 v241, v241
    s_nop 0
    v_mov_b32 v242, v241
    s_waitcnt lgkmcnt(12)
    v_pk_add_f32 v[200:201], v[200:201], v[8:9]
    v_pk_add_f32 v[202:203], v[202:203], v[10:11]
    v_pk_add_f32 v[204:205], v[204:205], v[12:13]
    v_pk_add_f32 v[206:207], v[206:207], v[14:15]
    v_pk_add_f32 v[208:209], v[208:209], v[16:17]
    v_pk_add_f32 v[210:211], v[210:211], v[18:19]
    s_waitcnt lgkmcnt(6)
    v_pk_add_f32 v[24:25], v[24:25], v[176:177]
    v_pk_add_f32 v[26:27], v[26:27], v[178:179]
    v_pk_add_f32 v[28:29], v[28:29], v[180:181]
    v_pk_add_f32 v[30:31], v[30:31], v[182:183]
    v_pk_add_f32 v[32:33], v[32:33], v[184:185]
    v_pk_add_f32 v[34:35], v[34:35], v[186:187]
    s_waitcnt lgkmcnt(0)
    v_pk_add_f32 v[188:189], v[188:189], v[224:225]
    v_pk_add_f32 v[190:191], v[190:191], v[226:227]
    v_pk_add_f32 v[192:193], v[192:193], v[228:229]
    v_pk_add_f32 v[194:195], v[194:195], v[230:231]
    v_pk_add_f32 v[196:197], v[196:197], v[232:233]
    v_pk_add_f32 v[198:199], v[198:199], v[234:235]
    v_pk_add_f32 v[24:25], v[24:25], v[188:189]
    v_pk_add_f32 v[26:27], v[26:27], v[190:191]
    v_pk_add_f32 v[28:29], v[28:29], v[192:193]
    v_pk_add_f32 v[30:31], v[30:31], v[194:195]
    v_pk_add_f32 v[32:33], v[32:33], v[196:197]
    v_pk_add_f32 v[34:35], v[34:35], v[198:199]
    v_pk_fma_f32 v[200:201], v[24:25], v[240:241], v[200:201] op_sel_hi:[1,0,1] neg_lo:[0,1,0] neg_hi:[0,1,0]
    v_pk_fma_f32 v[202:203], v[26:27], v[240:241], v[202:203] op_sel_hi:[1,0,1] neg_lo:[0,1,0] neg_hi:[0,1,0]
    v_pk_fma_f32 v[204:205], v[28:29], v[240:241], v[204:205] op_sel_hi:[1,0,1] neg_lo:[0,1,0] neg_hi:[0,1,0]
    v_pk_fma_f32 v[206:207], v[30:31], v[240:241], v[206:207] op_sel_hi:[1,0,1] neg_lo:[0,1,0] neg_hi:[0,1,0]
    v_pk_fma_f32 v[208:209], v[32:33], v[240:241], v[208:209] op_sel_hi:[1,0,1] neg_lo:[0,1,0] neg_hi:[0,1,0]
    v_pk_fma_f32 v[210:211], v[34:35], v[240:241], v[210:211] op_sel_hi:[1,0,1] neg_lo:[0,1,0] neg_hi:[0,1,0]
    v_pk_mul_f32 v[200:201], v[200:201], v[242:243] op_sel_hi:[1,0]
    v_pk_mul_f32 v[202:203], v[202:203], v[242:243] op_sel_hi:[1,0]
    v_pk_mul_f32 v[204:205], v[204:205], v[242:243] op_sel_hi:[1,0]
    v_pk_mul_f32 v[206:207], v[206:207], v[242:243] op_sel_hi:[1,0]
    v_pk_mul_f32 v[208:209], v[208:209], v[242:243] op_sel_hi:[1,0]
    v_pk_mul_f32 v[210:211], v[210:211], v[242:243] op_sel_hi:[1,0]
    v_pk_mul_f32 v[8:9], v[200:201], v[200:201]
    v_pk_mul_f32 v[10:11], v[202:203], v[202:203]
    v_pk_mul_f32 v[12:13], v[204:205], v[204:205]
    v_pk_mul_f32 v[14:15], v[206:207], v[206:207]
    v_pk_mul_f32 v[16:17], v[208:209], v[208:209]
    v_pk_mul_f32 v[18:19], v[210:211], v[210:211]
    v_pk_fma_f32 v[8:9], v[8:9], s[58:59], v[238:239]
    v_pk_fma_f32 v[10:11], v[10:11], s[58:59], v[238:239]
    v_pk_fma_f32 v[12:13], v[12:13], s[58:59], v[238:239]
    v_pk_fma_f32 v[14:15], v[14:15], s[58:59], v[238:239]
    v_pk_fma_f32 v[16:17], v[16:17], s[58:59], v[238:239]
    v_pk_fma_f32 v[18:19], v[18:19], s[58:59], v[238:239]
    v_pk_mul_f32 v[8:9], v[8:9], v[200:201]
    v_pk_mul_f32 v[10:11], v[10:11], v[202:203]
    v_pk_mul_f32 v[12:13], v[12:13], v[204:205]
    v_pk_mul_f32 v[14:15], v[14:15], v[206:207]
    v_pk_mul_f32 v[16:17], v[16:17], v[208:209]
    v_pk_mul_f32 v[18:19], v[18:19], v[210:211]
    v_exp_f32 v8, v8
    v_exp_f32 v9, v9
    v_exp_f32 v10, v10
    v_exp_f32 v11, v11
    v_exp_f32 v12, v12
    v_exp_f32 v13, v13
    v_exp_f32 v14, v14
    v_exp_f32 v15, v15
    v_exp_f32 v16, v16
    v_exp_f32 v17, v17
    v_exp_f32 v18, v18
    v_exp_f32 v19, v19
    v_pk_add_f32 v[8:9], v[8:9], 1.0 op_sel_hi:[1,0]
    v_pk_add_f32 v[10:11], v[10:11], 1.0 op_sel_hi:[1,0]
    v_pk_add_f32 v[12:13], v[12:13], 1.0 op_sel_hi:[1,0]
    v_pk_add_f32 v[14:15], v[14:15], 1.0 op_sel_hi:[1,0]
    v_pk_add_f32 v[16:17], v[16:17], 1.0 op_sel_hi:[1,0]
    v_pk_add_f32 v[18:19], v[18:19], 1.0 op_sel_hi:[1,0]
    v_rcp_f32 v8, v8
    v_rcp_f32 v9, v9
    v_rcp_f32 v10, v10
    v_rcp_f32 v11, v11
    v_rcp_f32 v12, v12
    v_rcp_f32 v13, v13
    v_rcp_f32 v14, v14
    v_rcp_f32 v15, v15
    v_rcp_f32 v16, v16
    v_rcp_f32 v17, v17
    v_rcp_f32 v18, v18
    v_rcp_f32 v19, v19
    v_pk_mul_f32 v[200:201], v[200:201], v[8:9]
    v_pk_mul_f32 v[202:203], v[202:203], v[10:11]
    v_pk_mul_f32 v[204:205], v[204:205], v[12:13]
    v_pk_mul_f32 v[206:207], v[206:207], v[14:15]
    v_pk_mul_f32 v[208:209], v[208:209], v[16:17]
    v_pk_mul_f32 v[210:211], v[210:211], v[18:19]
    v_pk_add_f32 v[14:15], v[200:201], v[202:203]
    v_pk_mul_f32 v[16:17], v[200:201], v[200:201]
    v_pk_add_f32 v[18:19], v[204:205], v[206:207]
    v_pk_fma_f32 v[16:17], v[202:203], v[202:203], v[16:17]
    v_pk_add_f32 v[20:21], v[208:209], v[210:211]
    v_pk_fma_f32 v[16:17], v[204:205], v[204:205], v[16:17]
    v_pk_add_f32 v[14:15], v[14:15], v[18:19]
    v_pk_fma_f32 v[16:17], v[206:207], v[206:207], v[16:17]
    v_pk_add_f32 v[14:15], v[14:15], v[20:21]
    v_pk_fma_f32 v[16:17], v[208:209], v[208:209], v[16:17]
    v_pk_fma_f32 v[16:17], v[210:211], v[210:211], v[16:17]
    v_add_f32 v8, v14, v15
    v_add_f32 v9, v16, v17
    v_lshl_add_u32 v4, v3, 3, s76
    v_mov_b32 v12, v8
    v_mov_b32 v13, v9
    s_nop 0
    v_permlane16_swap_b32 v8, v12
    v_permlane16_swap_b32 v9, v13
    v_add_f32 v8, v8, v12
    v_add_f32 v9, v9, v13
    v_mov_b32 v12, v8
    v_mov_b32 v13, v9
    s_nop 0
    v_permlane32_swap_b32 v8, v12
    v_permlane32_swap_b32 v9, v13
    v_add_f32 v8, v8, v12
    v_add_f32 v9, v9, v13
    s_mov_b64 exec, 0xffff
    ds_write_b64 v4, v[8:9]
    s_mov_b64 exec, -1
    s_or_b32 s48, s41, s43
    s_cmp_eq_u32 s48, 0
    v_lshlrev_b32 v4, 3, v3
    s_cselect_b64 exec, 0xffff, 0
    buffer_store_dwordx2 v[240:241], v4, s[24:27], s79 offen
    s_mov_b64 exec, -1
    v_mfma_f32_16x16x32_bf16 v[176:179], v[152:155], v[48:51], 0
    ds_read_b64_tr_b16 v[128:129], v217 offset:0
    ds_read_b64_tr_b16 v[130:131], v217 offset:768
    v_mfma_f32_16x16x32_bf16 v[180:183], v[152:155], v[52:55], 0
    s_add_u32 s65, s54, s98
    s_add_u32 m0, s61, 131072
    s_nop 0
    buffer_load_dwordx4 v40, s[8:11], s65 offen lds
    ds_read_b64_tr_b16 v[132:133], v218 offset:0
    ds_read_b64_tr_b16 v[134:135], v218 offset:768
    v_mfma_f32_16x16x32_bf16 v[224:227], v[152:155], v[244:247], 0
    ds_read_b64_tr_b16 v[136:137], v219 offset:0
    ds_read_b64_tr_b16 v[138:139], v219 offset:768
    v_mfma_f32_16x16x32_bf16 v[184:187], v[156:159], v[48:51], 0
    ds_read_b64_tr_b16 v[140:141], v220 offset:0
    ds_read_b64_tr_b16 v[142:143], v220 offset:768
    v_mfma_f32_16x16x32_bf16 v[188:191], v[156:159], v[52:55], 0
    s_add_u32 s65, s54, s98
    s_add_u32 m0, s61, 132096
    s_nop 0
    buffer_load_dwordx4 v41, s[8:11], s65 offen lds
    ds_read_b64_tr_b16 v[144:145], v221 offset:0
    ds_read_b64_tr_b16 v[146:147], v221 offset:768
    v_mfma_f32_16x16x32_bf16 v[228:231], v[156:159], v[244:247], 0
    ds_read_b64_tr_b16 v[148:149], v222 offset:0
    ds_read_b64_tr_b16 v[150:151], v222 offset:768
    v_mfma_f32_16x16x32_bf16 v[192:195], v[160:163], v[48:51], 0
    v_mfma_f32_16x16x32_bf16 v[196:199], v[160:163], v[52:55], 0
    s_add_u32 s65, s54, s98
    s_add_u32 m0, s61, 133120
    s_nop 0
    buffer_load_dwordx4 v42, s[8:11], s65 offen lds
    v_mfma_f32_16x16x32_bf16 v[232:235], v[160:163], v[244:247], 0
    v_mfma_f32_16x16x32_bf16 v[176:179], v[164:167], v[56:59], v[176:179]
    v_mfma_f32_16x16x32_bf16 v[180:183], v[164:167], v[60:63], v[180:183]
    v_mul_u32_u24 v4, 1280, v43
    v_lshl_add_u32 v4, v44, 4, v4
    s_mul_i32 s51, s41, 160
    s_add_u32 s51, s51, s52
    s_mul_i32 s48, s42, 7680
    s_add_u32 s48, s48, s51
    s_sub_i32 s48, s48, 3840
    s_cmp_lt_i32 s48, 0
    s_cselect_b32 s49, 3840, 0
    s_add_u32 s48, s48, s49
    v_subrev_u32 v5, s49, v4
    s_mul_i32 s50, s42, 960
    s_add_u32 m0, s50, 65536
    s_mov_b32 exec_lo, -1
    s_mov_b32 exec_hi, 0xfffffff
    buffer_load_dwordx4 v5, s[12:15], s48 offen lds
    s_mov_b64 exec, -1
    v_mfma_f32_16x16x32_bf16 v[184:187], v[168:171], v[56:59], v[184:187]
    v_mfma_f32_16x16x32_bf16 v[188:191], v[168:171], v[60:63], v[188:191]
    v_mfma_f32_16x16x32_bf16 v[192:195], v[172:175], v[56:59], v[192:195]
    s_cmp_ge_u32 s42, 4
    s_mov_b32 exec_lo, -1
    s_mov_b32 exec_hi, 0xfffffff
    s_cbranch_scc1 k1_kvv_2
    s_mul_i32 s48, s42, 7680
    s_add_u32 s48, s48, s51
    s_add_u32 s48, s48, 57600
    s_mul_i32 s50, s42, 960
    s_add_u32 m0, s50, 73216
    s_nop 0
    buffer_load_dwordx4 v4, s[12:15], s48 offen lds
    s_branch k1_kve_3
k1_kvv_2:
    s_sub_u32 s49, s42, 4
    s_mul_i32 s48, s49, 7680
    s_add_u32 s48, s48, s51
    s_mul_i32 s50, s49, 960
    s_add_u32 m0, s50, 49152
    s_nop 0
    buffer_load_dwordx4 v4, s[16:19], s48 offen lds
k1_kve_3:
    s_mov_b64 exec, -1
    v_mfma_f32_16x16x32_bf16 v[196:199], v[172:175], v[60:63], v[196:199]
    s_add_u32 s49, s42, 4
    s_mul_i32 s48, s49, 7680
    s_add_u32 s48, s48, s51
    s_mul_i32 s50, s49, 960
    s_add_u32 m0, s50, 49152
    s_mov_b32 exec_lo, -1
    s_mov_b32 exec_hi, 0xfffffff
    buffer_load_dwordx4 v4, s[16:19], s48 offen lds
    s_mov_b64 exec, -1
    s_add_u32 s48, s66, 512
    s_mov_b64 exec, 0xff
    buffer_load_dword v37, v215, s[32:35], s48 offen
    s_mov_b64 exec, -1
    s_mul_i32 s48, s89, 1280
    s_add_u32 s48, s48, 640
    s_mov_b64 exec, 0x1f
    buffer_load_dword v37, v36, s[36:39], s48 offen
    s_mov_b64 exec, -1
    s_waitcnt vmcnt(10)
    s_waitcnt lgkmcnt(0)
    s_barrier
    s_cmp_lg_u32 s42, 0
    s_cbranch_scc1 k1_pub_4
    v_lshlrev_b32 v4, 3, v1
    v_add_u32 v5, 159744, v4
    ds_read_b64 v[8:9], v5
    ds_read_b64 v[12:13], v5 offset:512
    v_lshlrev_b32 v4, 4, v1
    v_mov_b32 v10, s100
    v_mov_b32 v11, s101
    s_waitcnt lgkmcnt(0)
    v_pk_add_f32 v[8:9], v[8:9], v[12:13]
k1_pub_4:
    s_cmp_eq_u32 s42, 0
    s_cselect_b64 exec, -1, 0
    buffer_store_dwordx4 v[8:11], v4, s[24:27], s77 offen sc1
    s_mov_b64 exec, -1
    v_mfma_f32_16x16x32_bf16 v[176:179], v[128:131], v[64:67], v[176:179]
    ds_read_b64_tr_b16 v[152:153], v217 offset:24576
    ds_read_b64_tr_b16 v[154:155], v217 offset:25344
    v_mfma_f32_16x16x32_bf16 v[180:183], v[128:131], v[68:71], v[180:183]
    s_add_u32 s65, s54, s99
    s_add_u32 m0, s61, 81920
    s_nop 0
    buffer_load_dwordx4 v40, s[8:11], s65 offen lds
    ds_read_b64_tr_b16 v[156:157], v218 offset:24576
    ds_read_b64_tr_b16 v[158:159], v218 offset:25344
    v_mfma_f32_16x16x32_bf16 v[224:227], v[128:131], v[244:247], v[224:227]
    ds_read_b64_tr_b16 v[160:161], v219 offset:24576
    ds_read_b64_tr_b16 v[162:163], v219 offset:25344
    v_mfma_f32_16x16x32_bf16 v[184:187], v[132:135], v[64:67], v[184:187]
    ds_read_b64_tr_b16 v[164:165], v220 offset:24576
    ds_read_b64_tr_b16 v[166:167], v220 offset:25344
    v_mfma_f32_16x16x32_bf16 v[188:191], v[132:135], v[68:71], v[188:191]
    s_add_u32 s65, s54, s99
    s_add_u32 m0, s61, 82944
    s_nop 0
    buffer_load_dwordx4 v41, s[8:11], s65 offen lds
    ds_read_b64_tr_b16 v[168:169], v221 offset:24576
    ds_read_b64_tr_b16 v[170:171], v221 offset:25344
    v_mfma_f32_16x16x32_bf16 v[228:231], v[132:135], v[244:247], v[228:231]
    ds_read_b64_tr_b16 v[172:173], v222 offset:24576
    ds_read_b64_tr_b16 v[174:175], v222 offset:25344
    v_mfma_f32_16x16x32_bf16 v[192:195], v[136:139], v[64:67], v[192:195]
    v_mfma_f32_16x16x32_bf16 v[196:199], v[136:139], v[68:71], v[196:199]
    s_add_u32 s65, s54, s99
    s_add_u32 m0, s61, 83968
    s_nop 0
    buffer_load_dwordx4 v42, s[8:11], s65 offen lds
    v_mfma_f32_16x16x32_bf16 v[232:235], v[136:139], v[244:247], v[232:235]
    v_mfma_f32_16x16x32_bf16 v[176:179], v[140:143], v[72:75], v[176:179]
    v_mfma_f32_16x16x32_bf16 v[180:183], v[140:143], v[76:79], v[180:183]
    s_add_u32 s48, s66, 640
    s_mov_b64 exec, 0xff
    buffer_load_dword v37, v215, s[32:35], s48 offen
    s_mov_b64 exec, -1
    v_mfma_f32_16x16x32_bf16 v[184:187], v[144:147], v[72:75], v[184:187]
    v_mfma_f32_16x16x32_bf16 v[188:191], v[144:147], v[76:79], v[188:191]
    v_mfma_f32_16x16x32_bf16 v[192:195], v[148:151], v[72:75], v[192:195]
    v_mfma_f32_16x16x32_bf16 v[196:199], v[148:151], v[76:79], v[196:199]
    s_waitcnt vmcnt(10)
    s_waitcnt lgkmcnt(0)
    s_barrier
    v_mfma_f32_16x16x32_bf16 v[176:179], v[152:155], v[80:83], v[176:179]
    ds_read_b64_tr_b16 v[128:129], v217 offset:49152
    ds_read_b64_tr_b16 v[130:131], v217 offset:49920
    v_mfma_f32_16x16x32_bf16 v[180:183], v[152:155], v[84:87], v[180:183]
    s_add_u32 s48, s66, 768
    s_mov_b64 exec, 0xff
    buffer_load_dword v37, v215, s[32:35], s48 offen
    s_mov_b64 exec, -1
    ds_read_b64_tr_b16 v[132:133], v218 offset:49152
    ds_read_b64_tr_b16 v[134:135], v218 offset:49920
    v_mfma_f32_16x16x32_bf16 v[224:227], v[152:155], v[244:247], v[224:227]
    ds_read_b64_tr_b16 v[136:137], v219 offset:49152
    ds_read_b64_tr_b16 v[138:139], v219 offset:49920
    v_mfma_f32_16x16x32_bf16 v[184:187], v[156:159], v[80:83], v[184:187]
    ds_read_b64_tr_b16 v[140:141], v220 offset:49152
    ds_read_b64_tr_b16 v[142:143], v220 offset:49920
    v_mfma_f32_16x16x32_bf16 v[188:191], v[156:159], v[84:87], v[188:191]
    s_mul_i32 s48, s89, 512
    s_add_u32 s48, s48, 0
    s_mov_b64 exec, 0xf
    buffer_load_dword v37, v36, s[84:87], s48 offen
    s_mov_b64 exec, -1
    ds_read_b64_tr_b16 v[144:145], v221 offset:49152
    ds_read_b64_tr_b16 v[146:147], v221 offset:49920
    v_mfma_f32_16x16x32_bf16 v[228:231], v[156:159], v[244:247], v[228:231]
    ds_read_b64_tr_b16 v[148:149], v222 offset:49152
    ds_read_b64_tr_b16 v[150:151], v222 offset:49920
    v_mfma_f32_16x16x32_bf16 v[192:195], v[160:163], v[80:83], v[192:195]
    v_mfma_f32_16x16x32_bf16 v[196:199], v[160:163], v[84:87], v[196:199]
    v_mfma_f32_16x16x32_bf16 v[232:235], v[160:163], v[244:247], v[232:235]
    v_mfma_f32_16x16x32_bf16 v[176:179], v[164:167], v[88:91], v[176:179]
    v_mfma_f32_16x16x32_bf16 v[180:183], v[164:167], v[92:95], v[180:183]
    v_mfma_f32_16x16x32_bf16 v[184:187], v[168:171], v[88:91], v[184:187]
    v_mfma_f32_16x16x32_bf16 v[188:191], v[168:171], v[92:95], v[188:191]
    v_mfma_f32_16x16x32_bf16 v[192:195], v[172:175], v[88:91], v[192:195]
    v_mfma_f32_16x16x32_bf16 v[196:199], v[172:175], v[92:95], v[196:199]
    s_waitcnt vmcnt(3)
    s_waitcnt lgkmcnt(0)
    s_barrier
    v_mfma_f32_16x16x32_bf16 v[176:179], v[128:131], v[96:99], v[176:179]
    ds_read_b64_tr_b16 v[152:153], v217 offset:0
    ds_read_b64_tr_b16 v[154:155], v217 offset:768
    v_mfma_f32_16x16x32_bf16 v[180:183], v[128:131], v[100:103], v[180:183]
    s_add_u32 s48, s66, 896
    s_mov_b64 exec, 0xff
    buffer_load_dword v37, v215, s[32:35], s48 offen
    s_mov_b64 exec, -1
    ds_read_b64_tr_b16 v[156:157], v218 offset:0
    ds_read_b64_tr_b16 v[158:159], v218 offset:768
    v_mfma_f32_16x16x32_bf16 v[224:227], v[128:131], v[244:247], v[224:227]
    ds_read_b64_tr_b16 v[160:161], v219 offset:0
    ds_read_b64_tr_b16 v[162:163], v219 offset:768
    v_mfma_f32_16x16x32_bf16 v[184:187], v[132:135], v[96:99], v[184:187]
    ds_read_b64_tr_b16 v[164:165], v220 offset:0
    ds_read_b64_tr_b16 v[166:167], v220 offset:768
    v_mfma_f32_16x16x32_bf16 v[188:191], v[132:135], v[100:103], v[188:191]
    ds_read_b64_tr_b16 v[168:169], v221 offset:0
    ds_read_b64_tr_b16 v[170:171], v221 offset:768
    v_mfma_f32_16x16x32_bf16 v[228:231], v[132:135], v[244:247], v[228:231]
    ds_read_b64_tr_b16 v[172:173], v222 offset:0
    ds_read_b64_tr_b16 v[174:175], v222 offset:768
    v_mfma_f32_16x16x32_bf16 v[192:195], v[136:139], v[96:99], v[192:195]
    v_mfma_f32_16x16x32_bf16 v[196:199], v[136:139], v[100:103], v[196:199]
    v_mfma_f32_16x16x32_bf16 v[232:235], v[136:139], v[244:247], v[232:235]
    v_mfma_f32_16x16x32_bf16 v[176:179], v[140:143], v[104:107], v[176:179]
    v_mfma_f32_16x16x32_bf16 v[180:183], v[140:143], v[108:111], v[180:183]
    v_mfma_f32_16x16x32_bf16 v[184:187], v[144:147], v[104:107], v[184:187]
    v_mfma_f32_16x16x32_bf16 v[188:191], v[144:147], v[108:111], v[188:191]
    v_mfma_f32_16x16x32_bf16 v[192:195], v[148:151], v[104:107], v[192:195]
    v_mfma_f32_16x16x32_bf16 v[196:199], v[148:151], v[108:111], v[196:199]
    s_waitcnt lgkmcnt(0)
    s_barrier
    v_lshlrev_b32 v38, 4, v3
    v_lshl_add_u32 v38, v2, 11, v38
    buffer_load_dwordx4 v[28:31], v38, s[24:27], s78 offen sc1
    buffer_load_dwordx4 v[32:35], v38, s[24:27], s78 offen offset:1024 sc1
    v_mfma_f32_16x16x32_bf16 v[176:179], v[152:155], v[112:115], v[176:179]
    v_mfma_f32_16x16x32_bf16 v[180:183], v[152:155], v[116:119], v[180:183]
    v_mfma_f32_16x16x32_bf16 v[224:227], v[152:155], v[244:247], v[224:227]
    v_mfma_f32_16x16x32_bf16 v[184:187], v[156:159], v[112:115], v[184:187]
    v_mfma_f32_16x16x32_bf16 v[188:191], v[156:159], v[116:119], v[188:191]
    v_mfma_f32_16x16x32_bf16 v[228:231], v[156:159], v[244:247], v[228:231]
    v_mfma_f32_16x16x32_bf16 v[192:195], v[160:163], v[112:115], v[192:195]
    v_mfma_f32_16x16x32_bf16 v[196:199], v[160:163], v[116:119], v[196:199]
    v_mfma_f32_16x16x32_bf16 v[232:235], v[160:163], v[244:247], v[232:235]
    v_mfma_f32_16x16x32_bf16 v[176:179], v[164:167], v[120:123], v[176:179]
    v_mfma_f32_16x16x32_bf16 v[180:183], v[164:167], v[124:127], v[180:183]
    v_mfma_f32_16x16x32_bf16 v[184:187], v[168:171], v[120:123], v[184:187]
    v_mfma_f32_16x16x32_bf16 v[188:191], v[168:171], v[124:127], v[188:191]
    v_mfma_f32_16x16x32_bf16 v[192:195], v[172:175], v[120:123], v[192:195]
    v_mfma_f32_16x16x32_bf16 v[196:199], v[172:175], v[124:127], v[196:199]
    v_lshl_add_u32 v4, v1, 4, s70
    v_lshl_add_u32 v5, v2, 4, s72
    s_nop 1
    ds_write_b128 v4, v[180:183] offset:0
    s_nop 0
    ds_write_b128 v4, v[188:191] offset:1024
    s_nop 0
    ds_write_b128 v4, v[196:199] offset:2048
    s_mov_b32 exec_lo, 0x00010001
    s_mov_b32 exec_hi, 0x00010001
    ds_write_b128 v5, v[224:227] offset:1536
    ds_write_b128 v5, v[228:231] offset:1600
    ds_write_b128 v5, v[232:235] offset:1664
    s_mov_b64 exec, -1
    v_pk_add_f32 v[128:129], v[176:177], 0
    v_pk_add_f32 v[130:131], v[178:179], 0
    v_pk_add_f32 v[132:133], v[184:185], 0
    v_pk_add_f32 v[134:135], v[186:187], 0
    v_pk_add_f32 v[136:137], v[192:193], 0
    v_pk_add_f32 v[138:139], v[194:195], 0
    v_add_u32 v4, 65536, v7
    ds_read_b128 v[48:51], v4 offset:0
    ds_read_b128 v[52:55], v4 offset:160
    ds_read_b128 v[56:59], v4 offset:320
    ds_read_b128 v[60:63], v4 offset:480
    ds_read_b128 v[64:67], v4 offset:640
    v_add_u32 v4, 49152, v7
    ds_read_b128 v[68:71], v4
    ds_read_b128 v[72:75], v4 offset:160
    s_waitcnt lgkmcnt(0)
    v_mul_u32_u24 v7, 1152, v44
    v_lshlrev_b32 v106, 2, v43
    v_sub_u32 v7, v7, v106
    s_lshl_b32 s48, s42, 4
    s_add_u32 s48, s48, 106508
    v_add_u32 v7, s48, v7
    v_lshlrev_b32 v44, 6, v44
    v_add_u32 v44, 160768, v44
    ds_read_b128 v[108:111], v44 offset:0
    ds_read_b128 v[112:115], v44 offset:16
    v_lshlrev_b32 v80, 16, v48
    v_and_b32 v81, 0xffff0000, v48
    v_lshlrev_b32 v82, 16, v52
    v_and_b32 v83, 0xffff0000, v52
    v_lshlrev_b32 v84, 16, v56
    v_and_b32 v85, 0xffff0000, v56
    v_lshlrev_b32 v86, 16, v60
    v_and_b32 v87, 0xffff0000, v60
    v_lshlrev_b32 v88, 16, v64
    v_and_b32 v89, 0xffff0000, v64
    s_waitcnt lgkmcnt(0)
    v_lshlrev_b32 v90, 16, v108
    v_lshlrev_b32 v91, 16, v110
    v_and_b32 v92, 0xffff0000, v108
    v_and_b32 v93, 0xffff0000, v110
    v_lshlrev_b32 v94, 16, v109
    v_lshlrev_b32 v95, 16, v111
    v_and_b32 v96, 0xffff0000, v109
    v_and_b32 v97, 0xffff0000, v111
    v_pk_mul_f32 v[98:99], v[86:87], v[90:91]
    v_pk_mul_f32 v[100:101], v[88:89], v[90:91]
    v_pk_fma_f32 v[98:99], v[84:85], v[92:93], v[98:99]
    v_pk_fma_f32 v[100:101], v[86:87], v[92:93], v[100:101]
    v_pk_fma_f32 v[98:99], v[82:83], v[94:95], v[98:99]
    v_pk_fma_f32 v[100:101], v[84:85], v[94:95], v[100:101]
    v_pk_fma_f32 v[98:99], v[80:81], v[96:97], v[98:99]
    v_pk_fma_f32 v[100:101], v[82:83], v[96:97], v[100:101]
    v_lshlrev_b32 v102, 16, v68
    v_and_b32 v103, 0xffff0000, v68
    v_lshlrev_b32 v104, 16, v72
    v_and_b32 v105, 0xffff0000, v72
    v_pk_mul_f32 v[98:99], v[98:99], v[102:103]
    v_pk_mul_f32 v[100:101], v[100:101], v[104:105]
    v_cvt_pk_bf16_f32 v106, v100, v98
    v_cvt_pk_bf16_f32 v107, v101, v99
    s_mov_b32 exec_hi, 0xff
    ds_write_b32 v7, v106 offset:0
    ds_write_b32 v7, v107 offset:144
    s_mov_b32 exec_hi, -1
    v_lshlrev_b32 v80, 16, v49
    v_and_b32 v81, 0xffff0000, v49
    v_lshlrev_b32 v82, 16, v53
    v_and_b32 v83, 0xffff0000, v53
    v_lshlrev_b32 v84, 16, v57
    v_and_b32 v85, 0xffff0000, v57
    v_lshlrev_b32 v86, 16, v61
    v_and_b32 v87, 0xffff0000, v61
    v_lshlrev_b32 v88, 16, v65
    v_and_b32 v89, 0xffff0000, v65
    v_lshlrev_b32 v90, 16, v112
    v_lshlrev_b32 v91, 16, v114
    v_and_b32 v92, 0xffff0000, v112
    v_and_b32 v93, 0xffff0000, v114
    v_lshlrev_b32 v94, 16, v113
    v_lshlrev_b32 v95, 16, v115
    v_and_b32 v96, 0xffff0000, v113
    v_and_b32 v97, 0xffff0000, v115
    v_pk_mul_f32 v[98:99], v[86:87], v[90:91]
    v_pk_mul_f32 v[100:101], v[88:89], v[90:91]
    v_pk_fma_f32 v[98:99], v[84:85], v[92:93], v[98:99]
    v_pk_fma_f32 v[100:101], v[86:87], v[92:93], v[100:101]
    v_pk_fma_f32 v[98:99], v[82:83], v[94:95], v[98:99]
    v_pk_fma_f32 v[100:101], v[84:85], v[94:95], v[100:101]
    v_pk_fma_f32 v[98:99], v[80:81], v[96:97], v[98:99]
    v_pk_fma_f32 v[100:101], v[82:83], v[96:97], v[100:101]
    v_lshlrev_b32 v102, 16, v69
    v_and_b32 v103, 0xffff0000, v69
    v_lshlrev_b32 v104, 16, v73
    v_and_b32 v105, 0xffff0000, v73
    v_pk_mul_f32 v[98:99], v[98:99], v[102:103]
    v_pk_mul_f32 v[100:101], v[100:101], v[104:105]
    v_cvt_pk_bf16_f32 v106, v100, v98
    v_cvt_pk_bf16_f32 v107, v101, v99
    s_mov_b32 exec_hi, 0xff
    ds_write_b32 v7, v106 offset:288
    ds_write_b32 v7, v107 offset:432
    s_mov_b32 exec_hi, -1
    ds_read_b128 v[108:111], v44 offset:32
    ds_read_b128 v[112:115], v44 offset:48
    v_lshlrev_b32 v80, 16, v50
    v_and_b32 v81, 0xffff0000, v50
    v_lshlrev_b32 v82, 16, v54
    v_and_b32 v83, 0xffff0000, v54
    v_lshlrev_b32 v84, 16, v58
    v_and_b32 v85, 0xffff0000, v58
    v_lshlrev_b32 v86, 16, v62
    v_and_b32 v87, 0xffff0000, v62
    v_lshlrev_b32 v88, 16, v66
    v_and_b32 v89, 0xffff0000, v66
    s_waitcnt lgkmcnt(0)
    v_lshlrev_b32 v90, 16, v108
    v_lshlrev_b32 v91, 16, v110
    v_and_b32 v92, 0xffff0000, v108
    v_and_b32 v93, 0xffff0000, v110
    v_lshlrev_b32 v94, 16, v109
    v_lshlrev_b32 v95, 16, v111
    v_and_b32 v96, 0xffff0000, v109
    v_and_b32 v97, 0xffff0000, v111
    v_pk_mul_f32 v[98:99], v[86:87], v[90:91]
    v_pk_mul_f32 v[100:101], v[88:89], v[90:91]
    v_pk_fma_f32 v[98:99], v[84:85], v[92:93], v[98:99]
    v_pk_fma_f32 v[100:101], v[86:87], v[92:93], v[100:101]
    v_pk_fma_f32 v[98:99], v[82:83], v[94:95], v[98:99]
    v_pk_fma_f32 v[100:101], v[84:85], v[94:95], v[100:101]
    v_pk_fma_f32 v[98:99], v[80:81], v[96:97], v[98:99]
    v_pk_fma_f32 v[100:101], v[82:83], v[96:97], v[100:101]
    v_lshlrev_b32 v102, 16, v70
    v_and_b32 v103, 0xffff0000, v70
    v_lshlrev_b32 v104, 16, v74
    v_and_b32 v105, 0xffff0000, v74
    v_pk_mul_f32 v[98:99], v[98:99], v[102:103]
    v_pk_mul_f32 v[100:101], v[100:101], v[104:105]
    v_cvt_pk_bf16_f32 v106, v100, v98
    v_cvt_pk_bf16_f32 v107, v101, v99
    s_mov_b32 exec_hi, 0xff
    ds_write_b32 v7, v106 offset:576
    ds_write_b32 v7, v107 offset:720
    s_mov_b32 exec_hi, -1
    v_lshlrev_b32 v80, 16, v51
    v_and_b32 v81, 0xffff0000, v51
    v_lshlrev_b32 v82, 16, v55
    v_and_b32 v83, 0xffff0000, v55
    v_lshlrev_b32 v84, 16, v59
    v_and_b32 v85, 0xffff0000, v59
    v_lshlrev_b32 v86, 16, v63
    v_and_b32 v87, 0xffff0000, v63
    v_lshlrev_b32 v88, 16, v67
    v_and_b32 v89, 0xffff0000, v67
    v_lshlrev_b32 v90, 16, v112
    v_lshlrev_b32 v91, 16, v114
    v_and_b32 v92, 0xffff0000, v112
    v_and_b32 v93, 0xffff0000, v114
    v_lshlrev_b32 v94, 16, v113
    v_lshlrev_b32 v95, 16, v115
    v_and_b32 v96, 0xffff0000, v113
    v_and_b32 v97, 0xffff0000, v115
    v_pk_mul_f32 v[98:99], v[86:87], v[90:91]
    v_pk_mul_f32 v[100:101], v[88:89], v[90:91]
    v_pk_fma_f32 v[98:99], v[84:85], v[92:93], v[98:99]
    v_pk_fma_f32 v[100:101], v[86:87], v[92:93], v[100:101]
    v_pk_fma_f32 v[98:99], v[82:83], v[94:95], v[98:99]
    v_pk_fma_f32 v[100:101], v[84:85], v[94:95], v[100:101]
    v_pk_fma_f32 v[98:99], v[80:81], v[96:97], v[98:99]
    v_pk_fma_f32 v[100:101], v[82:83], v[96:97], v[100:101]
    v_lshlrev_b32 v102, 16, v71
    v_and_b32 v103, 0xffff0000, v71
    v_lshlrev_b32 v104, 16, v75
    v_and_b32 v105, 0xffff0000, v75
    v_pk_mul_f32 v[98:99], v[98:99], v[102:103]
    v_pk_mul_f32 v[100:101], v[100:101], v[104:105]
    v_cvt_pk_bf16_f32 v106, v100, v98
    v_cvt_pk_bf16_f32 v107, v101, v99
    s_mov_b32 exec_hi, 0xff
    ds_write_b32 v7, v106 offset:864
    ds_write_b32 v7, v107 offset:1008
    s_mov_b32 exec_hi, -1
    s_lshl_b32 s48, s47, 4
    v_add_u32 v43, s48, v3
    v_mul_u32_u24 v43, 200, v43
    v_lshl_add_u32 v43, v2, 3, v43
    s_mul_i32 s48, s43, 96
    s_add_u32 s48, s48, 0
    v_add_u32 v43, s48, v43
    s_waitcnt vmcnt(0)
    s_mov_b32 s65, 0
k1_poll_5:
    s_add_u32 s65, s65, 1
    s_cmp_gt_u32 s65, 100000
    s_cbranch_scc1 k1_polled_6
    v_cmp_ne_u32 vcc, s100, v30
    v_cmp_ne_u32 s[50:51], s101, v31
    s_nop 0
    s_or_b64 vcc, vcc, s[50:51]
    v_cmp_ne_u32 s[50:51], s100, v34
    s_nop 0
    s_or_b64 vcc, vcc, s[50:51]
    v_cmp_ne_u32 s[50:51], s101, v35
    s_nop 0
    s_or_b64 vcc, vcc, s[50:51]
    s_cmp_eq_u64 vcc, 0
    s_cbranch_scc1 k1_polled_6
    s_sleep 4
    buffer_load_dwordx4 v[28:31], v38, s[24:27], s78 offen sc1
    buffer_load_dwordx4 v[32:35], v38, s[24:27], s78 offen offset:1024 sc1
    s_waitcnt vmcnt(0)
    s_branch k1_poll_5
k1_polled_6:
    s_xor_b32 s48, s42, 1
    s_or_b32 s48, s48, s41
    s_cmp_lg_u32 s48, 0
    s_cbranch_scc1 k1_ep_7
    v_mov_b32 v4, 0
    v_mov_b32 v44, 1
    s_mov_b64 exec, 1
    buffer_atomic_add v44, v4, s[28:31], 0 offen sc0
    s_mov_b64 exec, -1
k1_ep_7:
    v_pk_add_f32 v[8:9], v[28:29], v[32:33]
    v_mov_b32 v10, v8
    v_mov_b32 v11, v9
    s_nop 0
    v_permlane16_swap_b32 v8, v10
    v_permlane16_swap_b32 v9, v11
    v_add_f32 v8, v8, v10
    v_add_f32 v9, v9, v11
    v_mov_b32 v10, v8
    v_mov_b32 v11, v9
    s_nop 0
    v_permlane32_swap_b32 v8, v10
    v_permlane32_swap_b32 v9, v11
    v_add_f32 v8, v8, v10
    v_add_f32 v9, v9, v11
    v_mul_f32 v8, 0x3aaaaaab, v8
    v_mul_f32 v9, 0x3aaaaaab, v9
    v_fma_f32 v9, -v8, v8, v9
    v_max_f32 v9, 0, v9
    v_cvt_pk_bf16_f32 v9, v9, v8
    v_and_b32 v8, 0xffff0000, v9
    v_lshlrev_b32 v9, 16, v9
    v_add_f32 v9, s55, v9
    v_cvt_pk_bf16_f32 v9, v9, v9
    v_and_b32 v9, 0xffff0000, v9
    v_sqrt_f32 v9, v9
    s_nop 0
    v_cvt_pk_bf16_f32 v9, v9, v9
    v_and_b32 v9, 0xffff0000, v9
    v_rcp_f32 v9, v9
    s_nop 0
    v_mov_b32 v10, v9
    v_pk_add_f32 v[200:201], v[200:201], v[8:9] op_sel_hi:[1,0] neg_lo:[0,1] neg_hi:[0,1]
    v_pk_add_f32 v[202:203], v[202:203], v[8:9] op_sel_hi:[1,0] neg_lo:[0,1] neg_hi:[0,1]
    v_pk_add_f32 v[204:205], v[204:205], v[8:9] op_sel_hi:[1,0] neg_lo:[0,1] neg_hi:[0,1]
    v_pk_add_f32 v[206:207], v[206:207], v[8:9] op_sel_hi:[1,0] neg_lo:[0,1] neg_hi:[0,1]
    v_pk_add_f32 v[208:209], v[208:209], v[8:9] op_sel_hi:[1,0] neg_lo:[0,1] neg_hi:[0,1]
    v_pk_add_f32 v[210:211], v[210:211], v[8:9] op_sel_hi:[1,0] neg_lo:[0,1] neg_hi:[0,1]
    v_pk_mul_f32 v[200:201], v[200:201], v[10:11] op_sel_hi:[1,0]
    v_pk_mul_f32 v[202:203], v[202:203], v[10:11] op_sel_hi:[1,0]
    v_pk_mul_f32 v[204:205], v[204:205], v[10:11] op_sel_hi:[1,0]
    v_pk_mul_f32 v[206:207], v[206:207], v[10:11] op_sel_hi:[1,0]
    v_pk_mul_f32 v[208:209], v[208:209], v[10:11] op_sel_hi:[1,0]
    v_pk_mul_f32 v[210:211], v[210:211], v[10:11] op_sel_hi:[1,0]
    v_cvt_pk_bf16_f32 v16, v200, v201
    v_cvt_pk_bf16_f32 v17, v202, v203
    ds_write_b64 v43, v[16:17] offset:0
    v_cvt_pk_bf16_f32 v18, v204, v205
    v_cvt_pk_bf16_f32 v19, v206, v207
    ds_write_b64 v43, v[18:19] offset:32
    v_cvt_pk_bf16_f32 v20, v208, v209
    v_cvt_pk_bf16_f32 v21, v210, v211
    ds_write_b64 v43, v[20:21] offset:64
    v_lshrrev_b32 v218, 1, v2
    v_lshrrev_b32 v5, 2, v3
    v_lshl_add_u32 v218, v218, 3, v5
    v_mul_u32_u24 v218, 200, v218
    v_and_b32 v5, 1, v2
    v_lshl_add_u32 v218, v5, 5, v218
    v_and_b32 v5, 3, v3
    v_lshl_add_u32 v218, v5, 3, v218
    v_lshlrev_b32 v219, 4, v1
    s_waitcnt lgkmcnt(0)
    s_barrier
    v_add_u32 v5, s88, v218
    ds_read_b64_tr_b16 v[8:9], v5
    ds_read_b64_tr_b16 v[10:11], v5 offset:800
    s_waitcnt lgkmcnt(0)
    buffer_store_dwordx4 v[8:11], v219, s[24:27], s64 offen sc1
    s_cmp_ge_u32 s42, 4
    s_cbranch_scc1 k1_fr_8
    v_add_u32 v5, s63, v218
    ds_read_b64_tr_b16 v[12:13], v5
    ds_read_b64_tr_b16 v[14:15], v5 offset:800
    s_waitcnt lgkmcnt(0)
    buffer_store_dwordx4 v[12:15], v219, s[24:27], s67 offen sc1
k1_fr_8:
    s_lshl_b32 s48, s42, 3
    v_lshrrev_b32 v4, 3, v1
    v_add_u32 v4, s48, v4
    v_and_b32 v5, 7, v1
    v_lshlrev_b32 v5, 4, v5
    v_mul_u32_u24 v6, 144, v4
    v_add_u32 v6, v6, v5
    v_add_u32 v6, 106496, v6
    ds_read_b128 v[120:123], v6
    v_lshlrev_b32 v4, 12, v4
    v_add_u32 v4, v4, v5
    s_waitcnt lgkmcnt(0)
    buffer_store_dwordx4 v[120:123], v4, s[24:27], s83 offen sc1
    s_lshl_b32 s48, s42, 3
    s_add_u32 s48, s48, 64
    v_lshrrev_b32 v4, 3, v1
    v_add_u32 v4, s48, v4
    v_and_b32 v5, 7, v1
    v_lshlrev_b32 v5, 4, v5
    v_mul_u32_u24 v6, 144, v4
    v_add_u32 v6, v6, v5
    v_add_u32 v6, 106496, v6
    ds_read_b128 v[124:127], v6
    v_lshlrev_b32 v4, 12, v4
    v_add_u32 v4, v4, v5
    s_waitcnt lgkmcnt(0)
    s_cmp_ge_u32 s42, 2
    s_cbranch_scc1 k1_kvskip_9
    buffer_store_dwordx4 v[124:127], v4, s[24:27], s83 offen sc1
k1_kvskip_9:
    v_lshl_add_u32 v4, v1, 4, s71
    ds_read_b128 v[48:51], v4 offset:0
    ds_read_b128 v[52:55], v4 offset:1024
    ds_read_b128 v[56:59], v4 offset:2048
    v_lshl_add_u32 v6, v2, 4, s73
    ds_read_b128 v[64:67], v6 offset:1536
    ds_read_b128 v[68:71], v6 offset:1600
    ds_read_b128 v[72:75], v6 offset:1664
    ds_read_b128 v[76:79], v6 offset:1728
    ds_read_b128 v[80:83], v6 offset:1792
    ds_read_b128 v[84:87], v6 offset:1856
    ds_read_b128 v[88:91], v6 offset:1920
    ds_read_b128 v[92:95], v6 offset:1984
    ds_read_b128 v[96:99], v6 offset:2048
    ds_read_b128 v[100:103], v6 offset:2112
    ds_read_b128 v[104:107], v6 offset:2176
    ds_read_b128 v[108:111], v6 offset:2240
    s_waitcnt lgkmcnt(12)
    v_pk_add_f32 v[128:129], v[128:129], v[48:49]
    v_pk_add_f32 v[130:131], v[130:131], v[50:51]
    v_pk_add_f32 v[132:133], v[132:133], v[52:53]
    v_pk_add_f32 v[134:135], v[134:135], v[54:55]
    v_pk_add_f32 v[136:137], v[136:137], v[56:57]
    v_pk_add_f32 v[138:139], v[138:139], v[58:59]
    s_waitcnt lgkmcnt(6)
    v_pk_add_f32 v[64:65], v[64:65], v[76:77]
    v_pk_add_f32 v[66:67], v[66:67], v[78:79]
    v_pk_add_f32 v[68:69], v[68:69], v[80:81]
    v_pk_add_f32 v[70:71], v[70:71], v[82:83]
    v_pk_add_f32 v[72:73], v[72:73], v[84:85]
    v_pk_add_f32 v[74:75], v[74:75], v[86:87]
    s_waitcnt lgkmcnt(0)
    v_pk_add_f32 v[88:89], v[88:89], v[100:101]
    v_pk_add_f32 v[90:91], v[90:91], v[102:103]
    v_pk_add_f32 v[92:93], v[92:93], v[104:105]
    v_pk_add_f32 v[94:95], v[94:95], v[106:107]
    v_pk_add_f32 v[96:97], v[96:97], v[108:109]
    v_pk_add_f32 v[98:99], v[98:99], v[110:111]
    v_pk_add_f32 v[64:65], v[64:65], v[88:89]
    v_pk_add_f32 v[66:67], v[66:67], v[90:91]
    v_pk_add_f32 v[68:69], v[68:69], v[92:93]
    v_pk_add_f32 v[70:71], v[70:71], v[94:95]
    v_pk_add_f32 v[72:73], v[72:73], v[96:97]
    v_pk_add_f32 v[74:75], v[74:75], v[98:99]
    v_pk_fma_f32 v[128:129], v[64:65], v[240:241], v[128:129] op_sel_hi:[1,0,1] neg_lo:[0,1,0] neg_hi:[0,1,0]
    v_pk_fma_f32 v[130:131], v[66:67], v[240:241], v[130:131] op_sel_hi:[1,0,1] neg_lo:[0,1,0] neg_hi:[0,1,0]
    v_pk_fma_f32 v[132:133], v[68:69], v[240:241], v[132:133] op_sel_hi:[1,0,1] neg_lo:[0,1,0] neg_hi:[0,1,0]
    v_pk_fma_f32 v[134:135], v[70:71], v[240:241], v[134:135] op_sel_hi:[1,0,1] neg_lo:[0,1,0] neg_hi:[0,1,0]
    v_pk_fma_f32 v[136:137], v[72:73], v[240:241], v[136:137] op_sel_hi:[1,0,1] neg_lo:[0,1,0] neg_hi:[0,1,0]
    v_pk_fma_f32 v[138:139], v[74:75], v[240:241], v[138:139] op_sel_hi:[1,0,1] neg_lo:[0,1,0] neg_hi:[0,1,0]
    v_pk_mul_f32 v[128:129], v[128:129], v[242:243] op_sel_hi:[1,0]
    v_pk_mul_f32 v[130:131], v[130:131], v[242:243] op_sel_hi:[1,0]
    v_pk_mul_f32 v[132:133], v[132:133], v[242:243] op_sel_hi:[1,0]
    v_pk_mul_f32 v[134:135], v[134:135], v[242:243] op_sel_hi:[1,0]
    v_pk_mul_f32 v[136:137], v[136:137], v[242:243] op_sel_hi:[1,0]
    v_pk_mul_f32 v[138:139], v[138:139], v[242:243] op_sel_hi:[1,0]
    v_pk_mul_f32 v[48:49], v[128:129], v[128:129]
    v_pk_mul_f32 v[50:51], v[130:131], v[130:131]
    v_pk_mul_f32 v[52:53], v[132:133], v[132:133]
    v_pk_mul_f32 v[54:55], v[134:135], v[134:135]
    v_pk_mul_f32 v[56:57], v[136:137], v[136:137]
    v_pk_mul_f32 v[58:59], v[138:139], v[138:139]
    v_pk_fma_f32 v[48:49], v[48:49], s[58:59], v[238:239]
    v_pk_fma_f32 v[50:51], v[50:51], s[58:59], v[238:239]
    v_pk_fma_f32 v[52:53], v[52:53], s[58:59], v[238:239]
    v_pk_fma_f32 v[54:55], v[54:55], s[58:59], v[238:239]
    v_pk_fma_f32 v[56:57], v[56:57], s[58:59], v[238:239]
    v_pk_fma_f32 v[58:59], v[58:59], s[58:59], v[238:239]
    v_pk_mul_f32 v[48:49], v[48:49], v[128:129]
    v_pk_mul_f32 v[50:51], v[50:51], v[130:131]
    v_pk_mul_f32 v[52:53], v[52:53], v[132:133]
    v_pk_mul_f32 v[54:55], v[54:55], v[134:135]
    v_pk_mul_f32 v[56:57], v[56:57], v[136:137]
    v_pk_mul_f32 v[58:59], v[58:59], v[138:139]
    v_exp_f32 v48, v48
    v_exp_f32 v49, v49
    v_exp_f32 v50, v50
    v_exp_f32 v51, v51
    v_exp_f32 v52, v52
    v_exp_f32 v53, v53
    v_exp_f32 v54, v54
    v_exp_f32 v55, v55
    v_exp_f32 v56, v56
    v_exp_f32 v57, v57
    v_exp_f32 v58, v58
    v_exp_f32 v59, v59
    v_pk_add_f32 v[48:49], v[48:49], 1.0 op_sel_hi:[1,0]
    v_pk_add_f32 v[50:51], v[50:51], 1.0 op_sel_hi:[1,0]
    v_pk_add_f32 v[52:53], v[52:53], 1.0 op_sel_hi:[1,0]
    v_pk_add_f32 v[54:55], v[54:55], 1.0 op_sel_hi:[1,0]
    v_pk_add_f32 v[56:57], v[56:57], 1.0 op_sel_hi:[1,0]
    v_pk_add_f32 v[58:59], v[58:59], 1.0 op_sel_hi:[1,0]
    v_rcp_f32 v48, v48
    v_rcp_f32 v49, v49
    v_rcp_f32 v50, v50
    v_rcp_f32 v51, v51
    v_rcp_f32 v52, v52
    v_rcp_f32 v53, v53
    v_rcp_f32 v54, v54
    v_rcp_f32 v55, v55
    v_rcp_f32 v56, v56
    v_rcp_f32 v57, v57
    v_rcp_f32 v58, v58
    v_rcp_f32 v59, v59
    v_pk_mul_f32 v[128:129], v[128:129], v[48:49]
    v_pk_mul_f32 v[130:131], v[130:131], v[50:51]
    v_pk_mul_f32 v[132:133], v[132:133], v[52:53]
    v_pk_mul_f32 v[134:135], v[134:135], v[54:55]
    v_pk_mul_f32 v[136:137], v[136:137], v[56:57]
    v_pk_mul_f32 v[138:139], v[138:139], v[58:59]
    v_lshrrev_b32 v4, 1, v2
    v_mul_u32_u24 v4, 3072, v4
    v_and_b32 v5, 1, v2
    v_lshlrev_b32 v5, 5, v5
    v_add_u32 v5, v5, v3
    v_lshl_add_u32 v4, v5, 4, v4
    v_cvt_pk_bf16_f32 v48, v128, v129
    v_cvt_pk_bf16_f32 v49, v130, v131
    buffer_store_dwordx2 v[48:49], v4, s[24:27], s80 offen
    v_cvt_pk_bf16_f32 v50, v132, v133
    v_cvt_pk_bf16_f32 v51, v134, v135
    buffer_store_dwordx2 v[50:51], v4, s[24:27], s81 offen
    v_cvt_pk_bf16_f32 v52, v136, v137
    v_cvt_pk_bf16_f32 v53, v138, v139
    buffer_store_dwordx2 v[52:53], v4, s[24:27], s82 offen
    s_xor_b32 s48, s42, 1
    s_or_b32 s48, s48, s41
    s_cmp_lg_u32 s48, 0
    s_cbranch_scc1 k1_ep2_10
    s_waitcnt vmcnt(0)
    v_readfirstlane_b32 s48, v44
    s_nop 0
    s_cmp_lg_u32 s48, 31
    s_cbranch_scc1 k1_ep2_10
    v_mov_b32 v8, s100
    v_mov_b32 v9, s101
    v_mov_b32 v4, 14712832
    s_mov_b64 exec, 1
    buffer_store_dwordx2 v[8:9], v4, s[24:27], 0 offen sc1
    s_mov_b64 exec, -1
k1_ep2_10:
k1_kernel_end:
    s_endpgm

.globl k2_kernel
.p2align 8
.type k2_kernel,@function
k2_kernel:
    s_cmp_ge_u32 s2, 512
    s_cbranch_scc1 k2_kernel_end
    s_cmp_lt_u32 s2, 256
    s_cbranch_scc1 k2_kernel_conv
    s_load_dwordx2 s[4:5], s[0:1], 64
    s_load_dwordx2 s[8:9], s[0:1], 104
    s_load_dwordx2 s[12:13], s[0:1], 72
    v_lshrrev_b32 v2, 6, v0
    v_and_b32 v1, 63, v0
    v_readfirstlane_b32 s34, v2
    s_mov_b32 s6, 8388608
    s_mov_b32 s7, 0x20000
    s_mov_b32 s10, 15990784
    s_mov_b32 s11, 0x20000
    s_mov_b32 s14, 4096
    s_mov_b32 s15, 0x20000
    s_and_b32 s40, s2, 7
    s_lshr_b32 s41, s2, 3
    s_and_b32 s41, s41, 31
    s_lshr_b32 s32, s40, 1
    s_lshl_b32 s32, s32, 3
    s_and_b32 s42, s41, 7
    s_add_u32 s32, s32, s42
    s_and_b32 s33, s40, 1
    s_lshl_b32 s33, s33, 2
    s_lshr_b32 s42, s41, 3
    s_add_u32 s33, s33, s42
    s_lshl_b32 s44, s33, 7
    s_lshl_b32 s40, s34, 5
    s_add_u32 s44, s44, s40
    s_mul_i32 s44, s44, 3072
    s_add_u32 s44, s44, 0
    s_lshl_b32 s45, s32, 18
    s_lshl_b32 s40, s34, 10
    s_add_u32 s45, s45, s40
    s_lshl_b32 s46, s34, 14
    v_lshlrev_b32 v5, 4, v1
    v_lshrrev_b32 v2, 3, v1
    v_lshlrev_b32 v2, 12, v2
    v_and_b32 v3, 7, v1
    v_lshrrev_b32 v4, 4, v1
    v_xor_b32 v3, v3, v4
    v_lshl_add_u32 v6, v3, 4, v2
    v_xor_b32 v7, 64, v6
    s_mov_b32 s50, 0
    s_waitcnt lgkmcnt(0)
    s_add_u32 s52, s50, 0
    s_and_b32 s52, s52, 7
    s_mul_i32 s52, s52, 12288
    s_add_u32 s52, s52, s44
    buffer_load_dwordx4 v[104:107], v5, s[8:11], s52 offen offset:0
    buffer_load_dwordx4 v[108:111], v5, s[8:11], s52 offen offset:1024
    buffer_load_dwordx4 v[112:115], v5, s[8:11], s52 offen offset:2048
    s_add_u32 s54, s50, 0
    s_and_b32 s54, s54, 7
    s_lshl_b32 s54, s54, 7
    s_add_u32 s54, s54, s45
    s_add_u32 s42, s54, 0
    s_add_u32 m0, s46, 0
    s_nop 0
    buffer_load_dwordx4 v6, s[4:7], s42 offen lds
    s_add_u32 s42, s54, 32768
    s_add_u32 m0, s46, 1024
    s_nop 0
    buffer_load_dwordx4 v7, s[4:7], s42 offen lds
    s_add_u32 s42, s54, 65536
    s_add_u32 m0, s46, 2048
    s_nop 0
    buffer_load_dwordx4 v6, s[4:7], s42 offen lds
    s_add_u32 s42, s54, 98304
    s_add_u32 m0, s46, 3072
    s_nop 0
    buffer_load_dwordx4 v7, s[4:7], s42 offen lds
    s_add_u32 s42, s54, 131072
    s_add_u32 m0, s46, 4096
    s_nop 0
    buffer_load_dwordx4 v6, s[4:7], s42 offen lds
    s_add_u32 s42, s54, 163840
    s_add_u32 m0, s46, 5120
    s_nop 0
    buffer_load_dwordx4 v7, s[4:7], s42 offen lds
    s_add_u32 s42, s54, 196608
    s_add_u32 m0, s46, 6144
    s_nop 0
    buffer_load_dwordx4 v6, s[4:7], s42 offen lds
    s_add_u32 s42, s54, 229376
    s_add_u32 m0, s46, 7168
    s_nop 0
    buffer_load_dwordx4 v7, s[4:7], s42 offen lds
    s_add_u32 s41, s52, 3072
    buffer_load_dwordx4 v[116:119], v5, s[8:11], s41 offen offset:0
    s_add_u32 s41, s52, 3072
    buffer_load_dwordx4 v[120:123], v5, s[8:11], s41 offen offset:1024
    s_add_u32 s41, s52, 3072
    buffer_load_dwordx4 v[124:127], v5, s[8:11], s41 offen offset:2048
    s_add_u32 s41, s52, 6144
    buffer_load_dwordx4 v[128:131], v5, s[8:11], s41 offen offset:0
    s_add_u32 s41, s52, 6144
    buffer_load_dwordx4 v[132:135], v5, s[8:11], s41 offen offset:1024
    s_add_u32 s41, s52, 6144
    buffer_load_dwordx4 v[136:139], v5, s[8:11], s41 offen offset:2048
    s_add_u32 s41, s52, 9216
    buffer_load_dwordx4 v[140:143], v5, s[8:11], s41 offen offset:0
    s_add_u32 s41, s52, 9216
    buffer_load_dwordx4 v[144:147], v5, s[8:11], s41 offen offset:1024
    s_add_u32 s41, s52, 9216
    buffer_load_dwordx4 v[148:151], v5, s[8:11], s41 offen offset:2048
    v_and_b32 v2, 31, v1
    v_lshrrev_b32 v3, 1, v2
    v_and_b32 v3, 7, v3
    v_lshrrev_b32 v4, 5, v1
    v_xor_b32 v3, v3, v4
    v_lshl_add_u32 v2, v2, 7, s46
    v_xor_b32 v4, 0, v3
    v_lshl_add_u32 v180, v4, 4, v2
    v_xor_b32 v4, 2, v3
    v_lshl_add_u32 v181, v4, 4, v2
    v_xor_b32 v4, 4, v3
    v_lshl_add_u32 v182, v4, 4, v2
    v_xor_b32 v4, 6, v3
    v_lshl_add_u32 v183, v4, 4, v2
    s_waitcnt vmcnt(9)
    s_setprio 2
    ds_read_b128 v[164:167], v180 offset:0
    ds_read_b128 v[168:171], v180 offset:4096
    s_waitcnt vmcnt(17)
    s_waitcnt lgkmcnt(0)
    v_mfma_f32_32x32x16_bf16 v[8:23], v[104:107], v[164:167], 0
    ds_read_b128 v[172:175], v181 offset:0
    ds_read_b128 v[176:179], v181 offset:4096
    v_mfma_f32_32x32x16_bf16 v[24:39], v[104:107], v[168:171], 0
    s_add_u32 s53, s50, 1
    s_and_b32 s53, s53, 7
    s_mul_i32 s53, s53, 12288
    s_add_u32 s53, s53, s44
    buffer_load_dwordx4 v[152:155], v5, s[8:11], s53 offen offset:0
    v_mfma_f32_32x32x16_bf16 v[40:55], v[108:111], v[164:167], 0
    buffer_load_dwordx4 v[156:159], v5, s[8:11], s53 offen offset:1024
    v_mfma_f32_32x32x16_bf16 v[56:71], v[108:111], v[168:171], 0
    buffer_load_dwordx4 v[160:163], v5, s[8:11], s53 offen offset:2048
    v_mfma_f32_32x32x16_bf16 v[72:87], v[112:115], v[164:167], 0
    s_add_u32 s55, s50, 1
    s_and_b32 s55, s55, 7
    s_lshl_b32 s55, s55, 7
    s_add_u32 s55, s55, s45
    s_add_u32 s42, s55, 0
    s_add_u32 m0, s46, 8192
    s_nop 0
    buffer_load_dwordx4 v6, s[4:7], s42 offen lds
    v_mfma_f32_32x32x16_bf16 v[88:103], v[112:115], v[168:171], 0
    s_add_u32 s42, s55, 32768
    s_add_u32 m0, s46, 9216
    s_nop 0
    buffer_load_dwordx4 v7, s[4:7], s42 offen lds
    s_add_u32 s42, s55, 65536
    s_add_u32 m0, s46, 10240
    s_nop 0
    buffer_load_dwordx4 v6, s[4:7], s42 offen lds
    s_add_u32 s42, s55, 98304
    s_add_u32 m0, s46, 11264
    s_nop 0
    buffer_load_dwordx4 v7, s[4:7], s42 offen lds
    s_waitcnt vmcnt(13)
    s_waitcnt lgkmcnt(0)
    v_mfma_f32_32x32x16_bf16 v[8:23], v[116:119], v[172:175], v[8:23]
    ds_read_b128 v[164:167], v182 offset:0
    ds_read_b128 v[168:171], v182 offset:4096
    v_mfma_f32_32x32x16_bf16 v[24:39], v[116:119], v[176:179], v[24:39]
    s_add_u32 s41, s53, 3072
    buffer_load_dwordx4 v[104:107], v5, s[8:11], s41 offen offset:0
    v_mfma_f32_32x32x16_bf16 v[40:55], v[120:123], v[172:175], v[40:55]
    s_add_u32 s41, s53, 3072
    buffer_load_dwordx4 v[108:111], v5, s[8:11], s41 offen offset:1024
    v_mfma_f32_32x32x16_bf16 v[56:71], v[120:123], v[176:179], v[56:71]
    s_add_u32 s41, s53, 3072
    buffer_load_dwordx4 v[112:115], v5, s[8:11], s41 offen offset:2048
    v_mfma_f32_32x32x16_bf16 v[72:87], v[124:127], v[172:175], v[72:87]
    s_add_u32 s42, s55, 131072
    s_add_u32 m0, s46, 12288
    s_nop 0
    buffer_load_dwordx4 v6, s[4:7], s42 offen lds
    v_mfma_f32_32x32x16_bf16 v[88:103], v[124:127], v[176:179], v[88:103]
    s_add_u32 s42, s55, 163840
    s_add_u32 m0, s46, 13312
    s_nop 0
    buffer_load_dwordx4 v7, s[4:7], s42 offen lds
    s_add_u32 s42, s55, 196608
    s_add_u32 m0, s46, 14336
    s_nop 0
    buffer_load_dwordx4 v6, s[4:7], s42 offen lds
    s_add_u32 s42, s55, 229376
    s_add_u32 m0, s46, 15360
    s_nop 0
    buffer_load_dwordx4 v7, s[4:7], s42 offen lds
    s_waitcnt vmcnt(17)
    s_waitcnt lgkmcnt(0)
    v_mfma_f32_32x32x16_bf16 v[8:23], v[128:131], v[164:167], v[8:23]
    ds_read_b128 v[172:175], v183 offset:0
    ds_read_b128 v[176:179], v183 offset:4096
    v_mfma_f32_32x32x16_bf16 v[24:39], v[128:131], v[168:171], v[24:39]
    s_add_u32 s41, s53, 6144
    buffer_load_dwordx4 v[116:119], v5, s[8:11], s41 offen offset:0
    v_mfma_f32_32x32x16_bf16 v[40:55], v[132:135], v[164:167], v[40:55]
    s_add_u32 s41, s53, 6144
    buffer_load_dwordx4 v[120:123], v5, s[8:11], s41 offen offset:1024
    v_mfma_f32_32x32x16_bf16 v[56:71], v[132:135], v[168:171], v[56:71]
    s_add_u32 s41, s53, 6144
    buffer_load_dwordx4 v[124:127], v5, s[8:11], s41 offen offset:2048
    v_mfma_f32_32x32x16_bf16 v[72:87], v[136:139], v[164:167], v[72:87]
    v_mfma_f32_32x32x16_bf16 v[88:103], v[136:139], v[168:171], v[88:103]
    s_waitcnt vmcnt(17)
    s_waitcnt lgkmcnt(0)
    v_mfma_f32_32x32x16_bf16 v[8:23], v[140:143], v[172:175], v[8:23]
    s_waitcnt vmcnt(3)
    ds_read_b128 v[164:167], v180 offset:8192
    ds_read_b128 v[168:171], v180 offset:12288
    v_mfma_f32_32x32x16_bf16 v[24:39], v[140:143], v[176:179], v[24:39]
    s_add_u32 s41, s53, 9216
    buffer_load_dwordx4 v[128:131], v5, s[8:11], s41 offen offset:0
    v_mfma_f32_32x32x16_bf16 v[40:55], v[144:147], v[172:175], v[40:55]
    s_add_u32 s41, s53, 9216
    buffer_load_dwordx4 v[132:135], v5, s[8:11], s41 offen offset:1024
    v_mfma_f32_32x32x16_bf16 v[56:71], v[144:147], v[176:179], v[56:71]
    s_add_u32 s41, s53, 9216
    buffer_load_dwordx4 v[136:139], v5, s[8:11], s41 offen offset:2048
    v_mfma_f32_32x32x16_bf16 v[72:87], v[148:151], v[172:175], v[72:87]
    s_add_u32 s54, s50, 2
    s_and_b32 s54, s54, 7
    s_lshl_b32 s54, s54, 7
    s_add_u32 s54, s54, s45
    s_add_u32 s42, s54, 0
    s_add_u32 m0, s46, 0
    s_nop 0
    buffer_load_dwordx4 v6, s[4:7], s42 offen lds
    v_mfma_f32_32x32x16_bf16 v[88:103], v[148:151], v[176:179], v[88:103]
    s_add_u32 s42, s54, 32768
    s_add_u32 m0, s46, 1024
    s_nop 0
    buffer_load_dwordx4 v7, s[4:7], s42 offen lds
    s_waitcnt vmcnt(19)
    s_waitcnt lgkmcnt(0)
    v_mfma_f32_32x32x16_bf16 v[8:23], v[152:155], v[164:167], v[8:23]
    ds_read_b128 v[172:175], v181 offset:8192
    ds_read_b128 v[176:179], v181 offset:12288
    v_mfma_f32_32x32x16_bf16 v[24:39], v[152:155], v[168:171], v[24:39]
    s_add_u32 s52, s50, 2
    s_and_b32 s52, s52, 7
    s_mul_i32 s52, s52, 12288
    s_add_u32 s52, s52, s44
    buffer_load_dwordx4 v[140:143], v5, s[8:11], s52 offen offset:0
    v_mfma_f32_32x32x16_bf16 v[40:55], v[156:159], v[164:167], v[40:55]
    buffer_load_dwordx4 v[144:147], v5, s[8:11], s52 offen offset:1024
    v_mfma_f32_32x32x16_bf16 v[56:71], v[156:159], v[168:171], v[56:71]
    buffer_load_dwordx4 v[148:151], v5, s[8:11], s52 offen offset:2048
    v_mfma_f32_32x32x16_bf16 v[72:87], v[160:163], v[164:167], v[72:87]
    s_add_u32 s42, s54, 65536
    s_add_u32 m0, s46, 2048
    s_nop 0
    buffer_load_dwordx4 v6, s[4:7], s42 offen lds
    v_mfma_f32_32x32x16_bf16 v[88:103], v[160:163], v[168:171], v[88:103]
    s_add_u32 s42, s54, 98304
    s_add_u32 m0, s46, 3072
    s_nop 0
    buffer_load_dwordx4 v7, s[4:7], s42 offen lds
    s_add_u32 s42, s54, 131072
    s_add_u32 m0, s46, 4096
    s_nop 0
    buffer_load_dwordx4 v6, s[4:7], s42 offen lds
    s_waitcnt vmcnt(18)
    s_waitcnt lgkmcnt(0)
    v_mfma_f32_32x32x16_bf16 v[8:23], v[104:107], v[172:175], v[8:23]
    ds_read_b128 v[164:167], v182 offset:8192
    ds_read_b128 v[168:171], v182 offset:12288
    v_mfma_f32_32x32x16_bf16 v[24:39], v[104:107], v[176:179], v[24:39]
    s_add_u32 s41, s52, 3072
    buffer_load_dwordx4 v[152:155], v5, s[8:11], s41 offen offset:0
    v_mfma_f32_32x32x16_bf16 v[40:55], v[108:111], v[172:175], v[40:55]
    s_add_u32 s41, s52, 3072
    buffer_load_dwordx4 v[156:159], v5, s[8:11], s41 offen offset:1024
    v_mfma_f32_32x32x16_bf16 v[56:71], v[108:111], v[176:179], v[56:71]
    s_add_u32 s41, s52, 3072
    buffer_load_dwordx4 v[160:163], v5, s[8:11], s41 offen offset:2048
    v_mfma_f32_32x32x16_bf16 v[72:87], v[112:115], v[172:175], v[72:87]
    s_add_u32 s42, s54, 163840
    s_add_u32 m0, s46, 5120
    s_nop 0
    buffer_load_dwordx4 v7, s[4:7], s42 offen lds
    v_mfma_f32_32x32x16_bf16 v[88:103], v[112:115], v[176:179], v[88:103]
    s_add_u32 s42, s54, 196608
    s_add_u32 m0, s46, 6144
    s_nop 0
    buffer_load_dwordx4 v6, s[4:7], s42 offen lds
    s_add_u32 s42, s54, 229376
    s_add_u32 m0, s46, 7168
    s_nop 0
    buffer_load_dwordx4 v7, s[4:7], s42 offen lds
    s_waitcnt vmcnt(17)
    s_waitcnt lgkmcnt(0)
    v_mfma_f32_32x32x16_bf16 v[8:23], v[116:119], v[164:167], v[8:23]
    ds_read_b128 v[172:175], v183 offset:8192
    ds_read_b128 v[176:179], v183 offset:12288
    v_mfma_f32_32x32x16_bf16 v[24:39], v[116:119], v[168:171], v[24:39]
    s_add_u32 s41, s52, 6144
    buffer_load_dwordx4 v[104:107], v5, s[8:11], s41 offen offset:0
    v_mfma_f32_32x32x16_bf16 v[40:55], v[120:123], v[164:167], v[40:55]
    s_add_u32 s41, s52, 6144
    buffer_load_dwordx4 v[108:111], v5, s[8:11], s41 offen offset:1024
    v_mfma_f32_32x32x16_bf16 v[56:71], v[120:123], v[168:171], v[56:71]
    s_add_u32 s41, s52, 6144
    buffer_load_dwordx4 v[112:115], v5, s[8:11], s41 offen offset:2048
    v_mfma_f32_32x32x16_bf16 v[72:87], v[124:127], v[164:167], v[72:87]
    v_mfma_f32_32x32x16_bf16 v[88:103], v[124:127], v[168:171], v[88:103]
    s_waitcnt vmcnt(17)
    s_waitcnt lgkmcnt(0)
    v_mfma_f32_32x32x16_bf16 v[8:23], v[128:131], v[172:175], v[8:23]
    s_waitcnt vmcnt(3)
    ds_read_b128 v[164:167], v180 offset:0
    ds_read_b128 v[168:171], v180 offset:4096
    v_mfma_f32_32x32x16_bf16 v[24:39], v[128:131], v[176:179], v[24:39]
    s_add_u32 s41, s52, 9216
    buffer_load_dwordx4 v[116:119], v5, s[8:11], s41 offen offset:0
    v_mfma_f32_32x32x16_bf16 v[40:55], v[132:135], v[172:175], v[40:55]
    s_add_u32 s41, s52, 9216
    buffer_load_dwordx4 v[120:123], v5, s[8:11], s41 offen offset:1024
    v_mfma_f32_32x32x16_bf16 v[56:71], v[132:135], v[176:179], v[56:71]
    s_add_u32 s41, s52, 9216
    buffer_load_dwordx4 v[124:127], v5, s[8:11], s41 offen offset:2048
    v_mfma_f32_32x32x16_bf16 v[72:87], v[136:139], v[172:175], v[72:87]
    s_add_u32 s55, s50, 3
    s_and_b32 s55, s55, 7
    s_lshl_b32 s55, s55, 7
    s_add_u32 s55, s55, s45
    s_add_u32 s42, s55, 0
    s_add_u32 m0, s46, 8192
    s_nop 0
    buffer_load_dwordx4 v6, s[4:7], s42 offen lds
    v_mfma_f32_32x32x16_bf16 v[88:103], v[136:139], v[176:179], v[88:103]
    s_add_u32 s42, s55, 32768
    s_add_u32 m0, s46, 9216
    s_nop 0
    buffer_load_dwordx4 v7, s[4:7], s42 offen lds
    s_waitcnt vmcnt(17)
    s_waitcnt lgkmcnt(0)
    v_mfma_f32_32x32x16_bf16 v[8:23], v[140:143], v[164:167], v[8:23]
    ds_read_b128 v[172:175], v181 offset:0
    ds_read_b128 v[176:179], v181 offset:4096
    v_mfma_f32_32x32x16_bf16 v[24:39], v[140:143], v[168:171], v[24:39]
    s_add_u32 s53, s50, 3
    s_and_b32 s53, s53, 7
    s_mul_i32 s53, s53, 12288
    s_add_u32 s53, s53, s44
    buffer_load_dwordx4 v[128:131], v5, s[8:11], s53 offen offset:0
    v_mfma_f32_32x32x16_bf16 v[40:55], v[144:147], v[164:167], v[40:55]
    buffer_load_dwordx4 v[132:135], v5, s[8:11], s53 offen offset:1024
    v_mfma_f32_32x32x16_bf16 v[56:71], v[144:147], v[168:171], v[56:71]
    buffer_load_dwordx4 v[136:139], v5, s[8:11], s53 offen offset:2048
    v_mfma_f32_32x32x16_bf16 v[72:87], v[148:151], v[164:167], v[72:87]
    s_add_u32 s42, s55, 65536
    s_add_u32 m0, s46, 10240
    s_nop 0
    buffer_load_dwordx4 v6, s[4:7], s42 offen lds
    v_mfma_f32_32x32x16_bf16 v[88:103], v[148:151], v[168:171], v[88:103]
    s_add_u32 s42, s55, 98304
    s_add_u32 m0, s46, 11264
    s_nop 0
    buffer_load_dwordx4 v7, s[4:7], s42 offen lds
    s_add_u32 s42, s55, 131072
    s_add_u32 m0, s46, 12288
    s_nop 0
    buffer_load_dwordx4 v6, s[4:7], s42 offen lds
    s_waitcnt vmcnt(17)
    s_waitcnt lgkmcnt(0)
    v_mfma_f32_32x32x16_bf16 v[8:23], v[152:155], v[172:175], v[8:23]
    ds_read_b128 v[164:167], v182 offset:0
    ds_read_b128 v[168:171], v182 offset:4096
    v_mfma_f32_32x32x16_bf16 v[24:39], v[152:155], v[176:179], v[24:39]
    s_add_u32 s41, s53, 3072
    buffer_load_dwordx4 v[140:143], v5, s[8:11], s41 offen offset:0
    v_mfma_f32_32x32x16_bf16 v[40:55], v[156:159], v[172:175], v[40:55]
    s_add_u32 s41, s53, 3072
    buffer_load_dwordx4 v[144:147], v5, s[8:11], s41 offen offset:1024
    v_mfma_f32_32x32x16_bf16 v[56:71], v[156:159], v[176:179], v[56:71]
    s_add_u32 s41, s53, 3072
    buffer_load_dwordx4 v[148:151], v5, s[8:11], s41 offen offset:2048
    v_mfma_f32_32x32x16_bf16 v[72:87], v[160:163], v[172:175], v[72:87]
    s_add_u32 s42, s55, 163840
    s_add_u32 m0, s46, 13312
    s_nop 0
    buffer_load_dwordx4 v7, s[4:7], s42 offen lds
    v_mfma_f32_32x32x16_bf16 v[88:103], v[160:163], v[176:179], v[88:103]
    s_add_u32 s42, s55, 196608
    s_add_u32 m0, s46, 14336
    s_nop 0
    buffer_load_dwordx4 v6, s[4:7], s42 offen lds
    s_add_u32 s42, s55, 229376
    s_add_u32 m0, s46, 15360
    s_nop 0
    buffer_load_dwordx4 v7, s[4:7], s42 offen lds
    s_waitcnt vmcnt(17)
    s_waitcnt lgkmcnt(0)
    v_mfma_f32_32x32x16_bf16 v[8:23], v[104:107], v[164:167], v[8:23]
    ds_read_b128 v[172:175], v183 offset:0
    ds_read_b128 v[176:179], v183 offset:4096
    v_mfma_f32_32x32x16_bf16 v[24:39], v[104:107], v[168:171], v[24:39]
    s_add_u32 s41, s53, 6144
    buffer_load_dwordx4 v[152:155], v5, s[8:11], s41 offen offset:0
    v_mfma_f32_32x32x16_bf16 v[40:55], v[108:111], v[164:167], v[40:55]
    s_add_u32 s41, s53, 6144
    buffer_load_dwordx4 v[156:159], v5, s[8:11], s41 offen offset:1024
    v_mfma_f32_32x32x16_bf16 v[56:71], v[108:111], v[168:171], v[56:71]
    s_add_u32 s41, s53, 6144
    buffer_load_dwordx4 v[160:163], v5, s[8:11], s41 offen offset:2048
    v_mfma_f32_32x32x16_bf16 v[72:87], v[112:115], v[164:167], v[72:87]
    v_mfma_f32_32x32x16_bf16 v[88:103], v[112:115], v[168:171], v[88:103]
    s_waitcnt vmcnt(17)
    s_waitcnt lgkmcnt(0)
    v_mfma_f32_32x32x16_bf16 v[8:23], v[116:119], v[172:175], v[8:23]
    s_waitcnt vmcnt(3)
    ds_read_b128 v[164:167], v180 offset:8192
    ds_read_b128 v[168:171], v180 offset:12288
    v_mfma_f32_32x32x16_bf16 v[24:39], v[116:119], v[176:179], v[24:39]
    s_add_u32 s41, s53, 9216
    buffer_load_dwordx4 v[104:107], v5, s[8:11], s41 offen offset:0
    v_mfma_f32_32x32x16_bf16 v[40:55], v[120:123], v[172:175], v[40:55]
    s_add_u32 s41, s53, 9216
    buffer_load_dwordx4 v[108:111], v5, s[8:11], s41 offen offset:1024
    v_mfma_f32_32x32x16_bf16 v[56:71], v[120:123], v[176:179], v[56:71]
    s_add_u32 s41, s53, 9216
    buffer_load_dwordx4 v[112:115], v5, s[8:11], s41 offen offset:2048
    v_mfma_f32_32x32x16_bf16 v[72:87], v[124:127], v[172:175], v[72:87]
    s_add_u32 s54, s50, 4
    s_and_b32 s54, s54, 7
    s_lshl_b32 s54, s54, 7
    s_add_u32 s54, s54, s45
    s_add_u32 s42, s54, 0
    s_add_u32 m0, s46, 0
    s_nop 0
    buffer_load_dwordx4 v6, s[4:7], s42 offen lds
    v_mfma_f32_32x32x16_bf16 v[88:103], v[124:127], v[176:179], v[88:103]
    s_add_u32 s42, s54, 32768
    s_add_u32 m0, s46, 1024
    s_nop 0
    buffer_load_dwordx4 v7, s[4:7], s42 offen lds
    s_waitcnt vmcnt(17)
    s_waitcnt lgkmcnt(0)
    v_mfma_f32_32x32x16_bf16 v[8:23], v[128:131], v[164:167], v[8:23]
    ds_read_b128 v[172:175], v181 offset:8192
    ds_read_b128 v[176:179], v181 offset:12288
    v_mfma_f32_32x32x16_bf16 v[24:39], v[128:131], v[168:171], v[24:39]
    s_add_u32 s52, s50, 4
    s_and_b32 s52, s52, 7
    s_mul_i32 s52, s52, 12288
    s_add_u32 s52, s52, s44
    buffer_load_dwordx4 v[116:119], v5, s[8:11], s52 offen offset:0
    v_mfma_f32_32x32x16_bf16 v[40:55], v[132:135], v[164:167], v[40:55]
    buffer_load_dwordx4 v[120:123], v5, s[8:11], s52 offen offset:1024
    v_mfma_f32_32x32x16_bf16 v[56:71], v[132:135], v[168:171], v[56:71]
    buffer_load_dwordx4 v[124:127], v5, s[8:11], s52 offen offset:2048
    v_mfma_f32_32x32x16_bf16 v[72:87], v[136:139], v[164:167], v[72:87]
    s_add_u32 s42, s54, 65536
    s_add_u32 m0, s46, 2048
    s_nop 0
    buffer_load_dwordx4 v6, s[4:7], s42 offen lds
    v_mfma_f32_32x32x16_bf16 v[88:103], v[136:139], v[168:171], v[88:103]
    s_add_u32 s42, s54, 98304
    s_add_u32 m0, s46, 3072
    s_nop 0
    buffer_load_dwordx4 v7, s[4:7], s42 offen lds
    s_add_u32 s42, s54, 131072
    s_add_u32 m0, s46, 4096
    s_nop 0
    buffer_load_dwordx4 v6, s[4:7], s42 offen lds
    s_waitcnt vmcnt(17)
    s_waitcnt lgkmcnt(0)
    v_mfma_f32_32x32x16_bf16 v[8:23], v[140:143], v[172:175], v[8:23]
    ds_read_b128 v[164:167], v182 offset:8192
    ds_read_b128 v[168:171], v182 offset:12288
    v_mfma_f32_32x32x16_bf16 v[24:39], v[140:143], v[176:179], v[24:39]
    s_add_u32 s41, s52, 3072
    buffer_load_dwordx4 v[128:131], v5, s[8:11], s41 offen offset:0
    v_mfma_f32_32x32x16_bf16 v[40:55], v[144:147], v[172:175], v[40:55]
    s_add_u32 s41, s52, 3072
    buffer_load_dwordx4 v[132:135], v5, s[8:11], s41 offen offset:1024
    v_mfma_f32_32x32x16_bf16 v[56:71], v[144:147], v[176:179], v[56:71]
    s_add_u32 s41, s52, 3072
    buffer_load_dwordx4 v[136:139], v5, s[8:11], s41 offen offset:2048
    v_mfma_f32_32x32x16_bf16 v[72:87], v[148:151], v[172:175], v[72:87]
    s_add_u32 s42, s54, 163840
    s_add_u32 m0, s46, 5120
    s_nop 0
    buffer_load_dwordx4 v7, s[4:7], s42 offen lds
    v_mfma_f32_32x32x16_bf16 v[88:103], v[148:151], v[176:179], v[88:103]
    s_add_u32 s42, s54, 196608
    s_add_u32 m0, s46, 6144
    s_nop 0
    buffer_load_dwordx4 v6, s[4:7], s42 offen lds
    s_add_u32 s42, s54, 229376
    s_add_u32 m0, s46, 7168
    s_nop 0
    buffer_load_dwordx4 v7, s[4:7], s42 offen lds
    s_waitcnt vmcnt(17)
    s_waitcnt lgkmcnt(0)
    v_mfma_f32_32x32x16_bf16 v[8:23], v[152:155], v[164:167], v[8:23]
    ds_read_b128 v[172:175], v183 offset:8192
    ds_read_b128 v[176:179], v183 offset:12288
    v_mfma_f32_32x32x16_bf16 v[24:39], v[152:155], v[168:171], v[24:39]
    s_add_u32 s41, s52, 6144
    buffer_load_dwordx4 v[140:143], v5, s[8:11], s41 offen offset:0
    v_mfma_f32_32x32x16_bf16 v[40:55], v[156:159], v[164:167], v[40:55]
    s_add_u32 s41, s52, 6144
    buffer_load_dwordx4 v[144:147], v5, s[8:11], s41 offen offset:1024
    v_mfma_f32_32x32x16_bf16 v[56:71], v[156:159], v[168:171], v[56:71]
    s_add_u32 s41, s52, 6144
    buffer_load_dwordx4 v[148:151], v5, s[8:11], s41 offen offset:2048
    v_mfma_f32_32x32x16_bf16 v[72:87], v[160:163], v[164:167], v[72:87]
    v_mfma_f32_32x32x16_bf16 v[88:103], v[160:163], v[168:171], v[88:103]
    s_waitcnt vmcnt(17)
    s_waitcnt lgkmcnt(0)
    v_mfma_f32_32x32x16_bf16 v[8:23], v[104:107], v[172:175], v[8:23]
    s_waitcnt vmcnt(3)
    ds_read_b128 v[164:167], v180 offset:0
    ds_read_b128 v[168:171], v180 offset:4096
    v_mfma_f32_32x32x16_bf16 v[24:39], v[104:107], v[176:179], v[24:39]
    s_add_u32 s41, s52, 9216
    buffer_load_dwordx4 v[152:155], v5, s[8:11], s41 offen offset:0
    v_mfma_f32_32x32x16_bf16 v[40:55], v[108:111], v[172:175], v[40:55]
    s_add_u32 s41, s52, 9216
    buffer_load_dwordx4 v[156:159], v5, s[8:11], s41 offen offset:1024
    v_mfma_f32_32x32x16_bf16 v[56:71], v[108:111], v[176:179], v[56:71]
    s_add_u32 s41, s52, 9216
    buffer_load_dwordx4 v[160:163], v5, s[8:11], s41 offen offset:2048
    v_mfma_f32_32x32x16_bf16 v[72:87], v[112:115], v[172:175], v[72:87]
    s_add_u32 s55, s50, 5
    s_and_b32 s55, s55, 7
    s_lshl_b32 s55, s55, 7
    s_add_u32 s55, s55, s45
    s_add_u32 s42, s55, 0
    s_add_u32 m0, s46, 8192
    s_nop 0
    buffer_load_dwordx4 v6, s[4:7], s42 offen lds
    v_mfma_f32_32x32x16_bf16 v[88:103], v[112:115], v[176:179], v[88:103]
    s_add_u32 s42, s55, 32768
    s_add_u32 m0, s46, 9216
    s_nop 0
    buffer_load_dwordx4 v7, s[4:7], s42 offen lds
    s_waitcnt vmcnt(17)
    s_waitcnt lgkmcnt(0)
    v_mfma_f32_32x32x16_bf16 v[8:23], v[116:119], v[164:167], v[8:23]
    ds_read_b128 v[172:175], v181 offset:0
    ds_read_b128 v[176:179], v181 offset:4096
    v_mfma_f32_32x32x16_bf16 v[24:39], v[116:119], v[168:171], v[24:39]
    s_add_u32 s53, s50, 5
    s_and_b32 s53, s53, 7
    s_mul_i32 s53, s53, 12288
    s_add_u32 s53, s53, s44
    buffer_load_dwordx4 v[104:107], v5, s[8:11], s53 offen offset:0
    v_mfma_f32_32x32x16_bf16 v[40:55], v[120:123], v[164:167], v[40:55]
    buffer_load_dwordx4 v[108:111], v5, s[8:11], s53 offen offset:1024
    v_mfma_f32_32x32x16_bf16 v[56:71], v[120:123], v[168:171], v[56:71]
    buffer_load_dwordx4 v[112:115], v5, s[8:11], s53 offen offset:2048
    v_mfma_f32_32x32x16_bf16 v[72:87], v[124:127], v[164:167], v[72:87]
    s_add_u32 s42, s55, 65536
    s_add_u32 m0, s46, 10240
    s_nop 0
    buffer_load_dwordx4 v6, s[4:7], s42 offen lds
    v_mfma_f32_32x32x16_bf16 v[88:103], v[124:127], v[168:171], v[88:103]
    s_add_u32 s42, s55, 98304
    s_add_u32 m0, s46, 11264
    s_nop 0
    buffer_load_dwordx4 v7, s[4:7], s42 offen lds
    s_add_u32 s42, s55, 131072
    s_add_u32 m0, s46, 12288
    s_nop 0
    buffer_load_dwordx4 v6, s[4:7], s42 offen lds
    s_waitcnt vmcnt(17)
    s_waitcnt lgkmcnt(0)
    v_mfma_f32_32x32x16_bf16 v[8:23], v[128:131], v[172:175], v[8:23]
    ds_read_b128 v[164:167], v182 offset:0
    ds_read_b128 v[168:171], v182 offset:4096
    v_mfma_f32_32x32x16_bf16 v[24:39], v[128:131], v[176:179], v[24:39]
    s_add_u32 s41, s53, 3072
    buffer_load_dwordx4 v[116:119], v5, s[8:11], s41 offen offset:0
    v_mfma_f32_32x32x16_bf16 v[40:55], v[132:135], v[172:175], v[40:55]
    s_add_u32 s41, s53, 3072
    buffer_load_dwordx4 v[120:123], v5, s[8:11], s41 offen offset:1024
    v_mfma_f32_32x32x16_bf16 v[56:71], v[132:135], v[176:179], v[56:71]
    s_add_u32 s41, s53, 3072
    buffer_load_dwordx4 v[124:127], v5, s[8:11], s41 offen offset:2048
    v_mfma_f32_32x32x16_bf16 v[72:87], v[136:139], v[172:175], v[72:87]
    s_add_u32 s42, s55, 163840
    s_add_u32 m0, s46, 13312
    s_nop 0
    buffer_load_dwordx4 v7, s[4:7], s42 offen lds
    v_mfma_f32_32x32x16_bf16 v[88:103], v[136:139], v[176:179], v[88:103]
    s_add_u32 s42, s55, 196608
    s_add_u32 m0, s46, 14336
    s_nop 0
    buffer_load_dwordx4 v6, s[4:7], s42 offen lds
    s_add_u32 s42, s55, 229376
    s_add_u32 m0, s46, 15360
    s_nop 0
    buffer_load_dwordx4 v7, s[4:7], s42 offen lds
    s_waitcnt vmcnt(17)
    s_waitcnt lgkmcnt(0)
    v_mfma_f32_32x32x16_bf16 v[8:23], v[140:143], v[164:167], v[8:23]
    ds_read_b128 v[172:175], v183 offset:0
    ds_read_b128 v[176:179], v183 offset:4096
    v_mfma_f32_32x32x16_bf16 v[24:39], v[140:143], v[168:171], v[24:39]
    s_add_u32 s41, s53, 6144
    buffer_load_dwordx4 v[128:131], v5, s[8:11], s41 offen offset:0
    v_mfma_f32_32x32x16_bf16 v[40:55], v[144:147], v[164:167], v[40:55]
    s_add_u32 s41, s53, 6144
    buffer_load_dwordx4 v[132:135], v5, s[8:11], s41 offen offset:1024
    v_mfma_f32_32x32x16_bf16 v[56:71], v[144:147], v[168:171], v[56:71]
    s_add_u32 s41, s53, 6144
    buffer_load_dwordx4 v[136:139], v5, s[8:11], s41 offen offset:2048
    v_mfma_f32_32x32x16_bf16 v[72:87], v[148:151], v[164:167], v[72:87]
    v_mfma_f32_32x32x16_bf16 v[88:103], v[148:151], v[168:171], v[88:103]
    s_waitcnt vmcnt(17)
    s_waitcnt lgkmcnt(0)
    v_mfma_f32_32x32x16_bf16 v[8:23], v[152:155], v[172:175], v[8:23]
    s_waitcnt vmcnt(3)
    ds_read_b128 v[164:167], v180 offset:8192
    ds_read_b128 v[168:171], v180 offset:12288
    v_mfma_f32_32x32x16_bf16 v[24:39], v[152:155], v[176:179], v[24:39]
    s_add_u32 s41, s53, 9216
    buffer_load_dwordx4 v[140:143], v5, s[8:11], s41 offen offset:0
    v_mfma_f32_32x32x16_bf16 v[40:55], v[156:159], v[172:175], v[40:55]
    s_add_u32 s41, s53, 9216
    buffer_load_dwordx4 v[144:147], v5, s[8:11], s41 offen offset:1024
    v_mfma_f32_32x32x16_bf16 v[56:71], v[156:159], v[176:179], v[56:71]
    s_add_u32 s41, s53, 9216
    buffer_load_dwordx4 v[148:151], v5, s[8:11], s41 offen offset:2048
    v_mfma_f32_32x32x16_bf16 v[72:87], v[160:163], v[172:175], v[72:87]
    s_add_u32 s54, s50, 6
    s_and_b32 s54, s54, 7
    s_lshl_b32 s54, s54, 7
    s_add_u32 s54, s54, s45
    s_add_u32 s42, s54, 0
    s_add_u32 m0, s46, 0
    s_nop 0
    buffer_load_dwordx4 v6, s[4:7], s42 offen lds
    v_mfma_f32_32x32x16_bf16 v[88:103], v[160:163], v[176:179], v[88:103]
    s_add_u32 s42, s54, 32768
    s_add_u32 m0, s46, 1024
    s_nop 0
    buffer_load_dwordx4 v7, s[4:7], s42 offen lds
    s_waitcnt vmcnt(17)
    s_waitcnt lgkmcnt(0)
    v_mfma_f32_32x32x16_bf16 v[8:23], v[104:107], v[164:167], v[8:23]
    ds_read_b128 v[172:175], v181 offset:8192
    ds_read_b128 v[176:179], v181 offset:12288
    v_mfma_f32_32x32x16_bf16 v[24:39], v[104:107], v[168:171], v[24:39]
    s_add_u32 s52, s50, 6
    s_and_b32 s52, s52, 7
    s_mul_i32 s52, s52, 12288
    s_add_u32 s52, s52, s44
    buffer_load_dwordx4 v[152:155], v5, s[8:11], s52 offen offset:0
    v_mfma_f32_32x32x16_bf16 v[40:55], v[108:111], v[164:167], v[40:55]
    buffer_load_dwordx4 v[156:159], v5, s[8:11], s52 offen offset:1024
    v_mfma_f32_32x32x16_bf16 v[56:71], v[108:111], v[168:171], v[56:71]
    buffer_load_dwordx4 v[160:163], v5, s[8:11], s52 offen offset:2048
    v_mfma_f32_32x32x16_bf16 v[72:87], v[112:115], v[164:167], v[72:87]
    s_add_u32 s42, s54, 65536
    s_add_u32 m0, s46, 2048
    s_nop 0
    buffer_load_dwordx4 v6, s[4:7], s42 offen lds
    v_mfma_f32_32x32x16_bf16 v[88:103], v[112:115], v[168:171], v[88:103]
    s_add_u32 s42, s54, 98304
    s_add_u32 m0, s46, 3072
    s_nop 0
    buffer_load_dwordx4 v7, s[4:7], s42 offen lds
    s_add_u32 s42, s54, 131072
    s_add_u32 m0, s46, 4096
    s_nop 0
    buffer_load_dwordx4 v6, s[4:7], s42 offen lds
    s_waitcnt vmcnt(17)
    s_waitcnt lgkmcnt(0)
    v_mfma_f32_32x32x16_bf16 v[8:23], v[116:119], v[172:175], v[8:23]
    ds_read_b128 v[164:167], v182 offset:8192
    ds_read_b128 v[168:171], v182 offset:12288
    v_mfma_f32_32x32x16_bf16 v[24:39], v[116:119], v[176:179], v[24:39]
    s_add_u32 s41, s52, 3072
    buffer_load_dwordx4 v[104:107], v5, s[8:11], s41 offen offset:0
    v_mfma_f32_32x32x16_bf16 v[40:55], v[120:123], v[172:175], v[40:55]
    s_add_u32 s41, s52, 3072
    buffer_load_dwordx4 v[108:111], v5, s[8:11], s41 offen offset:1024
    v_mfma_f32_32x32x16_bf16 v[56:71], v[120:123], v[176:179], v[56:71]
    s_add_u32 s41, s52, 3072
    buffer_load_dwordx4 v[112:115], v5, s[8:11], s41 offen offset:2048
    v_mfma_f32_32x32x16_bf16 v[72:87], v[124:127], v[172:175], v[72:87]
    s_add_u32 s42, s54, 163840
    s_add_u32 m0, s46, 5120
    s_nop 0
    buffer_load_dwordx4 v7, s[4:7], s42 offen lds
    v_mfma_f32_32x32x16_bf16 v[88:103], v[124:127], v[176:179], v[88:103]
    s_add_u32 s42, s54, 196608
    s_add_u32 m0, s46, 6144
    s_nop 0
    buffer_load_dwordx4 v6, s[4:7], s42 offen lds
    s_add_u32 s42, s54, 229376
    s_add_u32 m0, s46, 7168
    s_nop 0
    buffer_load_dwordx4 v7, s[4:7], s42 offen lds
    s_waitcnt vmcnt(17)
    s_waitcnt lgkmcnt(0)
    v_mfma_f32_32x32x16_bf16 v[8:23], v[128:131], v[164:167], v[8:23]
    ds_read_b128 v[172:175], v183 offset:8192
    ds_read_b128 v[176:179], v183 offset:12288
    v_mfma_f32_32x32x16_bf16 v[24:39], v[128:131], v[168:171], v[24:39]
    s_add_u32 s41, s52, 6144
    buffer_load_dwordx4 v[116:119], v5, s[8:11], s41 offen offset:0
    v_mfma_f32_32x32x16_bf16 v[40:55], v[132:135], v[164:167], v[40:55]
    s_add_u32 s41, s52, 6144
    buffer_load_dwordx4 v[120:123], v5, s[8:11], s41 offen offset:1024
    v_mfma_f32_32x32x16_bf16 v[56:71], v[132:135], v[168:171], v[56:71]
    s_add_u32 s41, s52, 6144
    buffer_load_dwordx4 v[124:127], v5, s[8:11], s41 offen offset:2048
    v_mfma_f32_32x32x16_bf16 v[72:87], v[136:139], v[164:167], v[72:87]
    v_mfma_f32_32x32x16_bf16 v[88:103], v[136:139], v[168:171], v[88:103]
    s_waitcnt vmcnt(17)
    s_waitcnt lgkmcnt(0)
    v_mfma_f32_32x32x16_bf16 v[8:23], v[140:143], v[172:175], v[8:23]
    s_waitcnt vmcnt(3)
    ds_read_b128 v[164:167], v180 offset:0
    ds_read_b128 v[168:171], v180 offset:4096
    v_mfma_f32_32x32x16_bf16 v[24:39], v[140:143], v[176:179], v[24:39]
    s_add_u32 s41, s52, 9216
    buffer_load_dwordx4 v[128:131], v5, s[8:11], s41 offen offset:0
    v_mfma_f32_32x32x16_bf16 v[40:55], v[144:147], v[172:175], v[40:55]
    s_add_u32 s41, s52, 9216
    buffer_load_dwordx4 v[132:135], v5, s[8:11], s41 offen offset:1024
    v_mfma_f32_32x32x16_bf16 v[56:71], v[144:147], v[176:179], v[56:71]
    s_add_u32 s41, s52, 9216
    buffer_load_dwordx4 v[136:139], v5, s[8:11], s41 offen offset:2048
    v_mfma_f32_32x32x16_bf16 v[72:87], v[148:151], v[172:175], v[72:87]
    s_add_u32 s55, s50, 7
    s_and_b32 s55, s55, 7
    s_lshl_b32 s55, s55, 7
    s_add_u32 s55, s55, s45
    s_add_u32 s42, s55, 0
    s_add_u32 m0, s46, 8192
    s_nop 0
    buffer_load_dwordx4 v6, s[4:7], s42 offen lds
    v_mfma_f32_32x32x16_bf16 v[88:103], v[148:151], v[176:179], v[88:103]
    s_add_u32 s42, s55, 32768
    s_add_u32 m0, s46, 9216
    s_nop 0
    buffer_load_dwordx4 v7, s[4:7], s42 offen lds
    s_waitcnt vmcnt(17)
    s_waitcnt lgkmcnt(0)
    v_mfma_f32_32x32x16_bf16 v[8:23], v[152:155], v[164:167], v[8:23]
    ds_read_b128 v[172:175], v181 offset:0
    ds_read_b128 v[176:179], v181 offset:4096
    v_mfma_f32_32x32x16_bf16 v[24:39], v[152:155], v[168:171], v[24:39]
    s_add_u32 s53, s50, 7
    s_and_b32 s53, s53, 7
    s_mul_i32 s53, s53, 12288
    s_add_u32 s53, s53, s44
    buffer_load_dwordx4 v[140:143], v5, s[8:11], s53 offen offset:0
    v_mfma_f32_32x32x16_bf16 v[40:55], v[156:159], v[164:167], v[40:55]
    buffer_load_dwordx4 v[144:147], v5, s[8:11], s53 offen offset:1024
    v_mfma_f32_32x32x16_bf16 v[56:71], v[156:159], v[168:171], v[56:71]
    buffer_load_dwordx4 v[148:151], v5, s[8:11], s53 offen offset:2048
    v_mfma_f32_32x32x16_bf16 v[72:87], v[160:163], v[164:167], v[72:87]
    s_add_u32 s42, s55, 65536
    s_add_u32 m0, s46, 10240
    s_nop 0
    buffer_load_dwordx4 v6, s[4:7], s42 offen lds
    v_mfma_f32_32x32x16_bf16 v[88:103], v[160:163], v[168:171], v[88:103]
    s_add_u32 s42, s55, 98304
    s_add_u32 m0, s46, 11264
    s_nop 0
    buffer_load_dwordx4 v7, s[4:7], s42 offen lds
    s_add_u32 s42, s55, 131072
    s_add_u32 m0, s46, 12288
    s_nop 0
    buffer_load_dwordx4 v6, s[4:7], s42 offen lds
    s_waitcnt vmcnt(17)
    s_waitcnt lgkmcnt(0)
    v_mfma_f32_32x32x16_bf16 v[8:23], v[104:107], v[172:175], v[8:23]
    ds_read_b128 v[164:167], v182 offset:0
    ds_read_b128 v[168:171], v182 offset:4096
    v_mfma_f32_32x32x16_bf16 v[24:39], v[104:107], v[176:179], v[24:39]
    s_add_u32 s41, s53, 3072
    buffer_load_dwordx4 v[152:155], v5, s[8:11], s41 offen offset:0
    v_mfma_f32_32x32x16_bf16 v[40:55], v[108:111], v[172:175], v[40:55]
    s_add_u32 s41, s53, 3072
    buffer_load_dwordx4 v[156:159], v5, s[8:11], s41 offen offset:1024
    v_mfma_f32_32x32x16_bf16 v[56:71], v[108:111], v[176:179], v[56:71]
    s_add_u32 s41, s53, 3072
    buffer_load_dwordx4 v[160:163], v5, s[8:11], s41 offen offset:2048
    v_mfma_f32_32x32x16_bf16 v[72:87], v[112:115], v[172:175], v[72:87]
    s_add_u32 s42, s55, 163840
    s_add_u32 m0, s46, 13312
    s_nop 0
    buffer_load_dwordx4 v7, s[4:7], s42 offen lds
    v_mfma_f32_32x32x16_bf16 v[88:103], v[112:115], v[176:179], v[88:103]
    s_add_u32 s42, s55, 196608
    s_add_u32 m0, s46, 14336
    s_nop 0
    buffer_load_dwordx4 v6, s[4:7], s42 offen lds
    s_add_u32 s42, s55, 229376
    s_add_u32 m0, s46, 15360
    s_nop 0
    buffer_load_dwordx4 v7, s[4:7], s42 offen lds
    s_waitcnt vmcnt(17)
    s_waitcnt lgkmcnt(0)
    v_mfma_f32_32x32x16_bf16 v[8:23], v[116:119], v[164:167], v[8:23]
    ds_read_b128 v[172:175], v183 offset:0
    ds_read_b128 v[176:179], v183 offset:4096
    v_mfma_f32_32x32x16_bf16 v[24:39], v[116:119], v[168:171], v[24:39]
    s_add_u32 s41, s53, 6144
    buffer_load_dwordx4 v[104:107], v5, s[8:11], s41 offen offset:0
    v_mfma_f32_32x32x16_bf16 v[40:55], v[120:123], v[164:167], v[40:55]
    s_add_u32 s41, s53, 6144
    buffer_load_dwordx4 v[108:111], v5, s[8:11], s41 offen offset:1024
    v_mfma_f32_32x32x16_bf16 v[56:71], v[120:123], v[168:171], v[56:71]
    s_add_u32 s41, s53, 6144
    buffer_load_dwordx4 v[112:115], v5, s[8:11], s41 offen offset:2048
    v_mfma_f32_32x32x16_bf16 v[72:87], v[124:127], v[164:167], v[72:87]
    v_mfma_f32_32x32x16_bf16 v[88:103], v[124:127], v[168:171], v[88:103]
    s_waitcnt vmcnt(17)
    s_waitcnt lgkmcnt(0)
    v_mfma_f32_32x32x16_bf16 v[8:23], v[128:131], v[172:175], v[8:23]
    s_waitcnt vmcnt(3)
    ds_read_b128 v[164:167], v180 offset:8192
    ds_read_b128 v[168:171], v180 offset:12288
    v_mfma_f32_32x32x16_bf16 v[24:39], v[128:131], v[176:179], v[24:39]
    s_add_u32 s41, s53, 9216
    buffer_load_dwordx4 v[116:119], v5, s[8:11], s41 offen offset:0
    v_mfma_f32_32x32x16_bf16 v[40:55], v[132:135], v[172:175], v[40:55]
    s_add_u32 s41, s53, 9216
    buffer_load_dwordx4 v[120:123], v5, s[8:11], s41 offen offset:1024
    v_mfma_f32_32x32x16_bf16 v[56:71], v[132:135], v[176:179], v[56:71]
    s_add_u32 s41, s53, 9216
    buffer_load_dwordx4 v[124:127], v5, s[8:11], s41 offen offset:2048
    v_mfma_f32_32x32x16_bf16 v[72:87], v[136:139], v[172:175], v[72:87]
    v_mfma_f32_32x32x16_bf16 v[88:103], v[136:139], v[176:179], v[88:103]
    s_waitcnt vmcnt(15)
    s_waitcnt lgkmcnt(0)
    v_mfma_f32_32x32x16_bf16 v[8:23], v[140:143], v[164:167], v[8:23]
    ds_read_b128 v[172:175], v181 offset:8192
    ds_read_b128 v[176:179], v181 offset:12288
    v_mfma_f32_32x32x16_bf16 v[24:39], v[140:143], v[168:171], v[24:39]
    v_mfma_f32_32x32x16_bf16 v[40:55], v[144:147], v[164:167], v[40:55]
    v_mfma_f32_32x32x16_bf16 v[56:71], v[144:147], v[168:171], v[56:71]
    v_mfma_f32_32x32x16_bf16 v[72:87], v[148:151], v[164:167], v[72:87]
    v_mfma_f32_32x32x16_bf16 v[88:103], v[148:151], v[168:171], v[88:103]
    s_waitcnt vmcnt(9)
    s_waitcnt lgkmcnt(0)
    v_mfma_f32_32x32x16_bf16 v[8:23], v[152:155], v[172:175], v[8:23]
    ds_read_b128 v[164:167], v182 offset:8192
    ds_read_b128 v[168:171], v182 offset:12288
    v_mfma_f32_32x32x16_bf16 v[24:39], v[152:155], v[176:179], v[24:39]
    v_mfma_f32_32x32x16_bf16 v[40:55], v[156:159], v[172:175], v[40:55]
    v_mfma_f32_32x32x16_bf16 v[56:71], v[156:159], v[176:179], v[56:71]
    v_mfma_f32_32x32x16_bf16 v[72:87], v[160:163], v[172:175], v[72:87]
    v_mfma_f32_32x32x16_bf16 v[88:103], v[160:163], v[176:179], v[88:103]
    s_waitcnt vmcnt(3)
    s_waitcnt lgkmcnt(0)
    v_mfma_f32_32x32x16_bf16 v[8:23], v[104:107], v[164:167], v[8:23]
    ds_read_b128 v[172:175], v183 offset:8192
    ds_read_b128 v[176:179], v183 offset:12288
    v_mfma_f32_32x32x16_bf16 v[24:39], v[104:107], v[168:171], v[24:39]
    s_lshl_b32 s40, s32, 3
    s_add_u32 s40, s40, s33
    s_lshl_b32 s40, s40, 2
    s_add_u32 s40, s40, s34
    s_mul_i32 s40, s40, 3072
    s_add_u32 s40, s40, 3145728
    buffer_load_dwordx4 v[184:187], v5, s[8:11], s40 offen offset:0
    v_mfma_f32_32x32x16_bf16 v[40:55], v[108:111], v[164:167], v[40:55]
    buffer_load_dwordx4 v[188:191], v5, s[8:11], s40 offen offset:1024
    v_mfma_f32_32x32x16_bf16 v[56:71], v[108:111], v[168:171], v[56:71]
    buffer_load_dwordx4 v[192:195], v5, s[8:11], s40 offen offset:2048
    v_mfma_f32_32x32x16_bf16 v[72:87], v[112:115], v[164:167], v[72:87]
    v_and_b32 v2, 31, v1
    v_lshlrev_b32 v2, 1, v2
    s_lshr_b32 s40, s34, 1
    s_lshl_b32 s40, s40, 6
    s_lshl_b32 s43, s32, 7
    s_add_u32 s40, s40, s43
    buffer_load_ushort v196, v2, s[12:15], s40 offen
    v_mfma_f32_32x32x16_bf16 v[88:103], v[112:115], v[168:171], v[88:103]
    s_waitcnt vmcnt(4)
    s_waitcnt lgkmcnt(0)
    v_mfma_f32_32x32x16_bf16 v[8:23], v[116:119], v[172:175], v[8:23]
    v_mfma_f32_32x32x16_bf16 v[24:39], v[116:119], v[176:179], v[24:39]
    v_mfma_f32_32x32x16_bf16 v[40:55], v[120:123], v[172:175], v[40:55]
    v_mfma_f32_32x32x16_bf16 v[56:71], v[120:123], v[176:179], v[56:71]
    v_mfma_f32_32x32x16_bf16 v[72:87], v[124:127], v[172:175], v[72:87]
    v_mfma_f32_32x32x16_bf16 v[88:103], v[124:127], v[176:179], v[88:103]
    s_setprio 0
    v_add_u32 v4, 0x10000, v5
    s_nop 15
    s_barrier
    s_cmp_lg_u32 s34, 0
    s_cbranch_scc1 g_epi_2
    ds_write_b128 v5, v[12:15] offset:30720
    ds_write_b128 v5, v[20:23] offset:31744
    ds_write_b128 v5, v[44:47] offset:32768
    ds_write_b128 v5, v[52:55] offset:33792
    ds_write_b128 v5, v[76:79] offset:34816
    ds_write_b128 v5, v[84:87] offset:35840
    ds_write_b128 v5, v[24:27] offset:43008
    ds_write_b128 v5, v[32:35] offset:44032
    ds_write_b128 v5, v[56:59] offset:45056
    ds_write_b128 v5, v[64:67] offset:46080
    ds_write_b128 v5, v[88:91] offset:47104
    ds_write_b128 v5, v[96:99] offset:48128
    ds_write_b128 v5, v[28:31] offset:55296
    ds_write_b128 v5, v[36:39] offset:56320
    ds_write_b128 v5, v[60:63] offset:57344
    ds_write_b128 v5, v[68:71] offset:58368
    ds_write_b128 v5, v[92:95] offset:59392
    ds_write_b128 v5, v[100:103] offset:60416
    v_pk_add_f32 v[104:105], v[8:9], 0
    v_pk_add_f32 v[106:107], v[10:11], 0
    v_pk_add_f32 v[108:109], v[16:17], 0
    v_pk_add_f32 v[110:111], v[18:19], 0
    v_pk_add_f32 v[112:113], v[40:41], 0
    v_pk_add_f32 v[114:115], v[42:43], 0
    v_pk_add_f32 v[116:117], v[48:49], 0
    v_pk_add_f32 v[118:119], v[50:51], 0
    v_pk_add_f32 v[120:121], v[72:73], 0
    v_pk_add_f32 v[122:123], v[74:75], 0
    v_pk_add_f32 v[124:125], v[80:81], 0
    v_pk_add_f32 v[126:127], v[82:83], 0
    s_branch g_epi_end_1
g_epi_2:
    s_cmp_lg_u32 s34, 1
    s_cbranch_scc1 g_epi_3
    ds_write_b128 v5, v[8:11] offset:0
    ds_write_b128 v5, v[16:19] offset:1024
    ds_write_b128 v5, v[40:43] offset:2048
    ds_write_b128 v5, v[48:51] offset:3072
    ds_write_b128 v5, v[72:75] offset:4096
    ds_write_b128 v5, v[80:83] offset:5120
    ds_write_b128 v5, v[24:27] offset:49152
    ds_write_b128 v5, v[32:35] offset:50176
    ds_write_b128 v5, v[56:59] offset:51200
    ds_write_b128 v5, v[64:67] offset:52224
    ds_write_b128 v5, v[88:91] offset:53248
    ds_write_b128 v5, v[96:99] offset:54272
    ds_write_b128 v5, v[28:31] offset:61440
    ds_write_b128 v5, v[36:39] offset:62464
    ds_write_b128 v5, v[60:63] offset:63488
    ds_write_b128 v5, v[68:71] offset:64512
    ds_write_b128 v4, v[92:95] offset:0
    ds_write_b128 v4, v[100:103] offset:1024
    v_pk_add_f32 v[104:105], v[12:13], 0
    v_pk_add_f32 v[106:107], v[14:15], 0
    v_pk_add_f32 v[108:109], v[20:21], 0
    v_pk_add_f32 v[110:111], v[22:23], 0
    v_pk_add_f32 v[112:113], v[44:45], 0
    v_pk_add_f32 v[114:115], v[46:47], 0
    v_pk_add_f32 v[116:117], v[52:53], 0
    v_pk_add_f32 v[118:119], v[54:55], 0
    v_pk_add_f32 v[120:121], v[76:77], 0
    v_pk_add_f32 v[122:123], v[78:79], 0
    v_pk_add_f32 v[124:125], v[84:85], 0
    v_pk_add_f32 v[126:127], v[86:87], 0
    s_branch g_epi_end_1
g_epi_3:
    s_cmp_lg_u32 s34, 2
    s_cbranch_scc1 g_epi_4
    ds_write_b128 v5, v[8:11] offset:6144
    ds_write_b128 v5, v[16:19] offset:7168
    ds_write_b128 v5, v[40:43] offset:8192
    ds_write_b128 v5, v[48:51] offset:9216
    ds_write_b128 v5, v[72:75] offset:10240
    ds_write_b128 v5, v[80:83] offset:11264
    ds_write_b128 v5, v[12:15] offset:18432
    ds_write_b128 v5, v[20:23] offset:19456
    ds_write_b128 v5, v[44:47] offset:20480
    ds_write_b128 v5, v[52:55] offset:21504
    ds_write_b128 v5, v[76:79] offset:22528
    ds_write_b128 v5, v[84:87] offset:23552
    ds_write_b128 v4, v[28:31] offset:2048
    ds_write_b128 v4, v[36:39] offset:3072
    ds_write_b128 v4, v[60:63] offset:4096
    ds_write_b128 v4, v[68:71] offset:5120
    ds_write_b128 v4, v[92:95] offset:6144
    ds_write_b128 v4, v[100:103] offset:7168
    v_pk_add_f32 v[104:105], v[24:25], 0
    v_pk_add_f32 v[106:107], v[26:27], 0
    v_pk_add_f32 v[108:109], v[32:33], 0
    v_pk_add_f32 v[110:111], v[34:35], 0
    v_pk_add_f32 v[112:113], v[56:57], 0
    v_pk_add_f32 v[114:115], v[58:59], 0
    v_pk_add_f32 v[116:117], v[64:65], 0
    v_pk_add_f32 v[118:119], v[66:67], 0
    v_pk_add_f32 v[120:121], v[88:89], 0
    v_pk_add_f32 v[122:123], v[90:91], 0
    v_pk_add_f32 v[124:125], v[96:97], 0
    v_pk_add_f32 v[126:127], v[98:99], 0
    s_branch g_epi_end_1
g_epi_4:
    ds_write_b128 v5, v[8:11] offset:12288
    ds_write_b128 v5, v[16:19] offset:13312
    ds_write_b128 v5, v[40:43] offset:14336
    ds_write_b128 v5, v[48:51] offset:15360
    ds_write_b128 v5, v[72:75] offset:16384
    ds_write_b128 v5, v[80:83] offset:17408
    ds_write_b128 v5, v[12:15] offset:24576
    ds_write_b128 v5, v[20:23] offset:25600
    ds_write_b128 v5, v[44:47] offset:26624
    ds_write_b128 v5, v[52:55] offset:27648
    ds_write_b128 v5, v[76:79] offset:28672
    ds_write_b128 v5, v[84:87] offset:29696
    ds_write_b128 v5, v[24:27] offset:36864
    ds_write_b128 v5, v[32:35] offset:37888
    ds_write_b128 v5, v[56:59] offset:38912
    ds_write_b128 v5, v[64:67] offset:39936
    ds_write_b128 v5, v[88:91] offset:40960
    ds_write_b128 v5, v[96:99] offset:41984
    v_pk_add_f32 v[104:105], v[28:29], 0
    v_pk_add_f32 v[106:107], v[30:31], 0
    v_pk_add_f32 v[108:109], v[36:37], 0
    v_pk_add_f32 v[110:111], v[38:39], 0
    v_pk_add_f32 v[112:113], v[60:61], 0
    v_pk_add_f32 v[114:115], v[62:63], 0
    v_pk_add_f32 v[116:117], v[68:69], 0
    v_pk_add_f32 v[118:119], v[70:71], 0
    v_pk_add_f32 v[120:121], v[92:93], 0
    v_pk_add_f32 v[122:123], v[94:95], 0
    v_pk_add_f32 v[124:125], v[100:101], 0
    v_pk_add_f32 v[126:127], v[102:103], 0
g_epi_end_1:
    s_waitcnt lgkmcnt(0)
    s_barrier
    s_mul_i32 s40, s34, 18432
    v_add_u32 v2, s40, v5
    ds_read_b128 v[8:11], v2 offset:0
    ds_read_b128 v[12:15], v2 offset:1024
    ds_read_b128 v[16:19], v2 offset:2048
    ds_read_b128 v[20:23], v2 offset:3072
    ds_read_b128 v[24:27], v2 offset:4096
    ds_read_b128 v[28:31], v2 offset:5120
    ds_read_b128 v[32:35], v2 offset:6144
    ds_read_b128 v[36:39], v2 offset:7168
    ds_read_b128 v[40:43], v2 offset:8192
    ds_read_b128 v[44:47], v2 offset:9216
    ds_read_b128 v[48:51], v2 offset:10240
    ds_read_b128 v[52:55], v2 offset:11264
    ds_read_b128 v[56:59], v2 offset:12288
    ds_read_b128 v[60:63], v2 offset:13312
    ds_read_b128 v[64:67], v2 offset:14336
    ds_read_b128 v[68:71], v2 offset:15360
    ds_read_b128 v[72:75], v2 offset:16384
    ds_read_b128 v[76:79], v2 offset:17408
    v_lshrrev_b32 v6, 4, v1
    v_and_b32 v6, 1, v6
    v_mul_u32_u24 v6, 24576, v6
    v_and_b32 v3, 15, v1
    v_lshrrev_b32 v4, 5, v1
    v_lshl_add_u32 v3, v4, 4, v3
    v_lshl_add_u32 v6, v3, 4, v6
    s_mul_i32 s40, s32, 98304
    s_lshr_b32 s41, s34, 1
    s_mul_i32 s41, s41, 49152
    s_add_u32 s40, s40, s41
    s_mul_i32 s41, s33, 3072
    s_add_u32 s40, s40, s41
    s_and_b32 s41, s34, 1
    s_lshl_b32 s41, s41, 9
    s_add_u32 s40, s40, s41
    s_add_u32 s40, s40, 11534336
    s_waitcnt vmcnt(0)
    v_lshlrev_b32 v180, 16, v196
    v_lshlrev_b32 v80, 16, v184
    v_and_b32 v81, 0xffff0000, v184
    v_lshlrev_b32 v82, 16, v185
    v_and_b32 v83, 0xffff0000, v185
    v_lshlrev_b32 v84, 16, v186
    v_and_b32 v85, 0xffff0000, v186
    v_lshlrev_b32 v86, 16, v187
    v_and_b32 v87, 0xffff0000, v187
    v_lshlrev_b32 v88, 16, v188
    v_and_b32 v89, 0xffff0000, v188
    v_lshlrev_b32 v90, 16, v189
    v_and_b32 v91, 0xffff0000, v189
    v_lshlrev_b32 v92, 16, v190
    v_and_b32 v93, 0xffff0000, v190
    v_lshlrev_b32 v94, 16, v191
    v_and_b32 v95, 0xffff0000, v191
    v_lshlrev_b32 v96, 16, v192
    v_and_b32 v97, 0xffff0000, v192
    v_lshlrev_b32 v98, 16, v193
    v_and_b32 v99, 0xffff0000, v193
    v_lshlrev_b32 v100, 16, v194
    v_and_b32 v101, 0xffff0000, v194
    v_lshlrev_b32 v102, 16, v195
    v_and_b32 v103, 0xffff0000, v195
    s_waitcnt lgkmcnt(12)
    v_pk_add_f32 v[104:105], v[104:105], v[8:9]
    v_pk_add_f32 v[106:107], v[106:107], v[10:11]
    v_pk_add_f32 v[108:109], v[108:109], v[12:13]
    v_pk_add_f32 v[110:111], v[110:111], v[14:15]
    v_pk_add_f32 v[112:113], v[112:113], v[16:17]
    v_pk_add_f32 v[114:115], v[114:115], v[18:19]
    v_pk_add_f32 v[116:117], v[116:117], v[20:21]
    v_pk_add_f32 v[118:119], v[118:119], v[22:23]
    v_pk_add_f32 v[120:121], v[120:121], v[24:25]
    v_pk_add_f32 v[122:123], v[122:123], v[26:27]
    v_pk_add_f32 v[124:125], v[124:125], v[28:29]
    v_pk_add_f32 v[126:127], v[126:127], v[30:31]
    s_waitcnt lgkmcnt(6)
    v_pk_add_f32 v[104:105], v[104:105], v[32:33]
    v_pk_add_f32 v[106:107], v[106:107], v[34:35]
    v_pk_add_f32 v[108:109], v[108:109], v[36:37]
    v_pk_add_f32 v[110:111], v[110:111], v[38:39]
    v_pk_add_f32 v[112:113], v[112:113], v[40:41]
    v_pk_add_f32 v[114:115], v[114:115], v[42:43]
    v_pk_add_f32 v[116:117], v[116:117], v[44:45]
    v_pk_add_f32 v[118:119], v[118:119], v[46:47]
    v_pk_add_f32 v[120:121], v[120:121], v[48:49]
    v_pk_add_f32 v[122:123], v[122:123], v[50:51]
    v_pk_add_f32 v[124:125], v[124:125], v[52:53]
    v_pk_add_f32 v[126:127], v[126:127], v[54:55]
    s_waitcnt lgkmcnt(0)
    v_pk_add_f32 v[104:105], v[104:105], v[56:57]
    v_pk_add_f32 v[106:107], v[106:107], v[58:59]
    v_pk_add_f32 v[108:109], v[108:109], v[60:61]
    v_pk_add_f32 v[110:111], v[110:111], v[62:63]
    v_pk_add_f32 v[112:113], v[112:113], v[64:65]
    v_pk_add_f32 v[114:115], v[114:115], v[66:67]
    v_pk_add_f32 v[116:117], v[116:117], v[68:69]
    v_pk_add_f32 v[118:119], v[118:119], v[70:71]
    v_pk_add_f32 v[120:121], v[120:121], v[72:73]
    v_pk_add_f32 v[122:123], v[122:123], v[74:75]
    v_pk_add_f32 v[124:125], v[124:125], v[76:77]
    v_pk_add_f32 v[126:127], v[126:127], v[78:79]
    v_pk_add_f32 v[104:105], v[104:105], v[180:181] op_sel_hi:[1,0]
    v_pk_add_f32 v[106:107], v[106:107], v[180:181] op_sel_hi:[1,0]
    v_pk_add_f32 v[108:109], v[108:109], v[180:181] op_sel_hi:[1,0]
    v_pk_add_f32 v[110:111], v[110:111], v[180:181] op_sel_hi:[1,0]
    v_pk_add_f32 v[112:113], v[112:113], v[180:181] op_sel_hi:[1,0]
    v_pk_add_f32 v[114:115], v[114:115], v[180:181] op_sel_hi:[1,0]
    v_pk_add_f32 v[116:117], v[116:117], v[180:181] op_sel_hi:[1,0]
    v_pk_add_f32 v[118:119], v[118:119], v[180:181] op_sel_hi:[1,0]
    v_pk_add_f32 v[120:121], v[120:121], v[180:181] op_sel_hi:[1,0]
    v_pk_add_f32 v[122:123], v[122:123], v[180:181] op_sel_hi:[1,0]
    v_pk_add_f32 v[124:125], v[124:125], v[180:181] op_sel_hi:[1,0]
    v_pk_add_f32 v[126:127], v[126:127], v[180:181] op_sel_hi:[1,0]
    v_pk_mul_f32 v[104:105], v[104:105], v[80:81]
    v_pk_mul_f32 v[106:107], v[106:107], v[82:83]
    v_pk_mul_f32 v[108:109], v[108:109], v[84:85]
    v_pk_mul_f32 v[110:111], v[110:111], v[86:87]
    v_pk_mul_f32 v[112:113], v[112:113], v[88:89]
    v_pk_mul_f32 v[114:115], v[114:115], v[90:91]
    v_pk_mul_f32 v[116:117], v[116:117], v[92:93]
    v_pk_mul_f32 v[118:119], v[118:119], v[94:95]
    v_pk_mul_f32 v[120:121], v[120:121], v[96:97]
    v_pk_mul_f32 v[122:123], v[122:123], v[98:99]
    v_pk_mul_f32 v[124:125], v[124:125], v[100:101]
    v_pk_mul_f32 v[126:127], v[126:127], v[102:103]
    v_cvt_pk_bf16_f32 v8, v104, v105
    v_cvt_pk_bf16_f32 v9, v106, v107
    v_cvt_pk_bf16_f32 v10, v108, v109
    v_cvt_pk_bf16_f32 v11, v110, v111
    buffer_store_dwordx4 v[8:11], v6, s[8:11], s40 offen offset:0 sc1
    v_cvt_pk_bf16_f32 v12, v112, v113
    v_cvt_pk_bf16_f32 v13, v114, v115
    v_cvt_pk_bf16_f32 v14, v116, v117
    v_cvt_pk_bf16_f32 v15, v118, v119
    buffer_store_dwordx4 v[12:15], v6, s[8:11], s40 offen offset:1024 sc1
    v_cvt_pk_bf16_f32 v16, v120, v121
    v_cvt_pk_bf16_f32 v17, v122, v123
    v_cvt_pk_bf16_f32 v18, v124, v125
    v_cvt_pk_bf16_f32 v19, v126, v127
    buffer_store_dwordx4 v[16:19], v6, s[8:11], s40 offen offset:2048 sc1
    s_endpgm
k2_kernel_conv:
    s_load_dwordx2 s[4:5], s[0:1], 32
    s_load_dwordx2 s[8:9], s[0:1], 104
    s_load_dwordx2 s[12:13], s[0:1], 40
    s_load_dwordx2 s[16:17], s[0:1], 64
    s_load_dwordx2 s[20:21], s[0:1], 80
    v_lshrrev_b32 v3, 6, v0
    v_and_b32 v1, 63, v0
    v_readfirstlane_b32 s34, v3
    s_mov_b32 s6, 2621440
    s_mov_b32 s7, 0x20000
    s_mov_b32 s10, 15990784
    s_mov_b32 s11, 0x20000
    s_mov_b32 s14, 1280
    s_mov_b32 s15, 0x20000
    s_mov_b32 s18, 8388608
    s_mov_b32 s19, 0x20000
    s_mov_b32 s22, 983040
    s_mov_b32 s23, 0x20000
    s_mov_b32 s32, s2
    v_lshlrev_b32 v2, 4, v0
    v_subrev_u32 v47, 16, v2
    s_mov_b32 s56, s2
    s_add_u32 s57, s2, 256
    s_lshr_b32 s58, s2, 1
    s_add_u32 s58, s58, 512
    s_waitcnt lgkmcnt(0)
    s_lshl_b32 s40, s56, 12
    buffer_load_dwordx4 v[12:15], v2, s[4:7], s40 offen
    buffer_load_dwordx4 v[8:11], v47, s[4:7], s40 offen
    s_add_u32 s40, s40, 6291456
    buffer_load_dwordx4 v[32:35], v2, s[8:11], s40 offen
    s_lshl_b32 s40, s56, 1
    v_mov_b32 v3, 0
    buffer_load_ushort v44, v3, s[12:15], s40 offen
    s_lshr_b32 s47, s2, 3
    s_lshl_b32 s47, s47, 2
    s_add_u32 s47, s47, s34
    s_mul_i32 s40, s47, 12
    v_add_u32 v3, s40, v1
    v_mul_u32_u24 v4, 43691, v3
    v_lshrrev_b32 v4, 22, v4
    v_mul_u32_u24 v5, 96, v4
    v_sub_u32 v3, v3, v5
    v_mul_u32_u24 v4, 98304, v4
    v_lshl_add_u32 v49, v3, 7, v4
    s_and_b32 s40, s2, 7
    s_lshr_b32 s52, s40, 1
    s_lshl_b32 s52, s52, 21
    s_and_b32 s53, s40, 1
    s_mul_i32 s53, s53, 1572864
    s_add_u32 s53, s53, 0
    s_lshl_b32 s40, s47, 4
    v_add_u32 v3, s40, v1
    v_lshrrev_b32 v4, 2, v3
    v_lshlrev_b32 v4, 12, v4
    v_and_b32 v3, 3, v3
    v_lshl_add_u32 v48, v3, 10, v4
    v_mov_b32 v52, 0
    v_mov_b32 v53, 0
    v_mov_b32 v54, 0
    v_mov_b32 v55, 0
    v_mul_u32_u24 v3, 4160, v0
    v_cmp_gt_u32 vcc, 64, v0
    s_nop 0
    s_and_saveexec_b64 s[50:51], vcc
    s_cbranch_execz c_z_6
    v_subrev_u32 v4, -32768, v2
    v_cmp_gt_u32 vcc, 8, v0
    s_nop 1
    v_cndmask_b32 v4, v4, v3, vcc
    v_add_u32 v5, -8, v0
    v_cmp_lt_u32 vcc, 23, v5
    s_nop 0
    s_and_b64 exec, exec, vcc
    ds_write_b128 v4, v[52:55]
c_z_6:
    s_mov_b64 exec, s[50:51]
    v_add_u32 v56, 16, v2
    v_add_u32 v57, 33792, v2
    v_and_b32 v3, 7, v1
    v_mul_u32_u24 v3, 4160, v3
    v_bfe_u32 v4, v1, 3, 1
    v_lshrrev_b32 v5, 4, v1
    v_sub_u32 v4, v4, v5
    v_add_u32 v4, 3, v4
    v_lshl_add_u32 v58, v4, 4, v3
    v_and_b32 v3, 15, v1
    v_lshl_add_u32 v3, v3, 1, v5
    v_lshlrev_b32 v59, 4, v3
    v_add_u32 v59, 33280, v59
    v_and_b32 v3, 15, v1
    v_lshlrev_b32 v4, 3, v5
    v_sub_u32 v4, v4, v3
    v_add_u32 v4, -9, v4
    v_mov_b32 v64, 0xffff
    v_mov_b32 v65, 0xffff0000
    v_cmp_eq_u32 vcc, 0, v4
    s_nop 1
    v_cndmask_b32 v60, 0, v64, vcc
    v_cmp_eq_u32 vcc, 1, v4
    s_nop 1
    v_cndmask_b32 v60, v60, v65, vcc
    v_cmp_eq_u32 vcc, 2, v4
    s_nop 1
    v_cndmask_b32 v61, 0, v64, vcc
    v_cmp_eq_u32 vcc, 3, v4
    s_nop 1
    v_cndmask_b32 v61, v61, v65, vcc
    v_cmp_eq_u32 vcc, 4, v4
    s_nop 1
    v_cndmask_b32 v62, 0, v64, vcc
    v_cmp_eq_u32 vcc, 5, v4
    s_nop 1
    v_cndmask_b32 v62, v62, v65, vcc
    v_cmp_eq_u32 vcc, 6, v4
    s_nop 1
    v_cndmask_b32 v63, 0, v64, vcc
    v_cmp_eq_u32 vcc, 7, v4
    s_nop 1
    v_cndmask_b32 v63, v63, v65, vcc
    v_and_b32 v3, 15, v1
    v_lshlrev_b32 v3, 6, v3
    v_lshl_add_u32 v3, v5, 4, v3
    s_lshl_b32 s40, s34, 13
    s_add_u32 s40, s40, 37888
    v_add_u32 v66, s40, v3
    v_lshlrev_b32 v67, 5, v0
    v_add_u32 v67, 37888, v67
    s_waitcnt vmcnt(0)
    v_cmp_ne_u32 vcc, 0, v0
    s_nop 1
    v_cndmask_b32 v8, 0, v8, vcc
    v_cndmask_b32 v9, 0, v9, vcc
    v_cndmask_b32 v10, 0, v10, vcc
    v_cndmask_b32 v11, 0, v11, vcc
    v_alignbit_b32 v176, v9, v8, 16
    v_alignbit_b32 v177, v10, v9, 16
    v_alignbit_b32 v178, v11, v10, 16
    v_alignbit_b32 v179, v12, v11, 16
    v_alignbit_b32 v180, v13, v12, 16
    v_alignbit_b32 v181, v14, v13, 16
    v_alignbit_b32 v182, v15, v14, 16
    ds_write_b128 v56, v[176:179] offset:0
    v_mov_b32 v184, v9
    v_mov_b32 v185, v10
    v_mov_b32 v186, v11
    v_mov_b32 v187, v12
    ds_write_b128 v56, v[184:187] offset:4160
    s_nop 1
    v_mov_b32 v184, v177
    v_mov_b32 v185, v178
    v_mov_b32 v186, v179
    v_mov_b32 v187, v180
    ds_write_b128 v56, v[184:187] offset:8320
    s_nop 1
    ds_write_b128 v56, v[10:13] offset:12480
    ds_write_b128 v56, v[178:181] offset:16640
    v_mov_b32 v184, v11
    v_mov_b32 v185, v12
    v_mov_b32 v186, v13
    v_mov_b32 v187, v14
    ds_write_b128 v56, v[184:187] offset:20800
    s_nop 1
    v_mov_b32 v184, v179
    v_mov_b32 v185, v180
    v_mov_b32 v186, v181
    v_mov_b32 v187, v182
    ds_write_b128 v56, v[184:187] offset:24960
    s_nop 1
    ds_write_b128 v56, v[12:15] offset:29120
    ds_write_b128 v57, v[32:35]
    v_lshlrev_b32 v3, 16, v44
    v_or_b32 v3, v3, v44
    v_and_b32 v188, v60, v3
    v_and_b32 v189, v61, v3
    v_and_b32 v190, v62, v3
    v_and_b32 v191, v63, v3
    s_cmp_ge_u32 s2, 192
    s_cbranch_scc1 c_wj_7
    s_mul_i32 s40, s2, 2731
    s_lshr_b32 s40, s40, 16
    s_mul_i32 s41, s40, 24
    s_sub_u32 s41, s2, s41
    s_mul_i32 s41, s41, 40960
    s_mul_i32 s40, s40, 160
    s_add_u32 s54, s40, s41
    v_mov_b32 v3, v0
    v_mul_u32_u24 v4, 6554, v3
    v_lshrrev_b32 v4, 16, v4
    v_mul_u32_u24 v5, 10, v4
    v_sub_u32 v3, v3, v5
    v_lshlrev_b32 v3, 4, v3
    v_mul_u32_u24 v4, 1280, v4
    v_add_u32 v3, v3, v4
    s_lshl_b32 s40, s34, 10
    s_add_u32 m0, s40, 70656
    s_nop 0
    buffer_load_dwordx4 v3, s[20:23], s54 offen lds
    s_cmp_lg_u32 s34, 0
    s_cbranch_scc1 c_wj2_8
    v_add_u32 v3, 256, v1
    v_mul_u32_u24 v4, 6554, v3
    v_lshrrev_b32 v4, 16, v4
    v_mul_u32_u24 v5, 10, v4
    v_sub_u32 v3, v3, v5
    v_lshlrev_b32 v3, 4, v3
    v_mul_u32_u24 v4, 1280, v4
    v_add_u32 v3, v3, v4
    s_mov_b32 m0, 74752
    s_nop 0
    buffer_load_dwordx4 v3, s[20:23], s54 offen lds
c_wj2_8:
c_wj_7:
    s_lshl_b32 s40, s57, 12
    buffer_load_dwordx4 v[20:23], v2, s[4:7], s40 offen
    buffer_load_dwordx4 v[16:19], v47, s[4:7], s40 offen
    s_add_u32 s40, s40, 6291456
    buffer_load_dwordx4 v[36:39], v2, s[8:11], s40 offen
    s_lshl_b32 s40, s57, 1
    v_mov_b32 v3, 0
    buffer_load_ushort v45, v3, s[12:15], s40 offen
    s_lshl_b32 s40, s58, 12
    buffer_load_dwordx4 v[28:31], v2, s[4:7], s40 offen
    buffer_load_dwordx4 v[24:27], v47, s[4:7], s40 offen
    s_add_u32 s40, s40, 6291456
    buffer_load_dwordx4 v[40:43], v2, s[8:11], s40 offen
    s_lshl_b32 s40, s58, 1
    v_mov_b32 v3, 0
    buffer_load_ushort v46, v3, s[12:15], s40 offen
    s_waitcnt lgkmcnt(0)
    s_barrier
    s_cmp_lg_u32 s34, 0
    s_cbranch_scc1 c_pw_10
    ds_read_b128 v[100:103], v58 offset:0
    ds_read_b128 v[112:115], v59 offset:480
    ds_read_b128 v[116:119], v59 offset:992
    ds_read_b128 v[120:123], v59 offset:1504
    ds_read_b128 v[124:127], v59 offset:2016
    ds_read_b128 v[128:131], v59 offset:2528
    ds_read_b128 v[132:135], v59 offset:3040
    ds_read_b128 v[136:139], v59 offset:3552
    ds_read_b128 v[140:143], v59 offset:4064
    ds_read_b128 v[104:107], v58 offset:512
    ds_read_b128 v[108:111], v58 offset:1024
    s_waitcnt lgkmcnt(2)
    v_mfma_f32_16x16x32_bf16 v[96:99], v[100:103], v[140:143], 0
    v_mfma_f32_16x16x32_bf16 v[92:95], v[100:103], v[136:139], 0
    v_mfma_f32_16x16x32_bf16 v[88:91], v[100:103], v[132:135], 0
    v_mfma_f32_16x16x32_bf16 v[84:87], v[100:103], v[128:131], 0
    v_mfma_f32_16x16x32_bf16 v[80:83], v[100:103], v[124:127], 0
    v_mfma_f32_16x16x32_bf16 v[76:79], v[100:103], v[120:123], 0
    v_mfma_f32_16x16x32_bf16 v[72:75], v[100:103], v[116:119], 0
    v_mfma_f32_16x16x32_bf16 v[68:71], v[100:103], v[112:115], 0
    v_mfma_f32_16x16x32_bf16 v[68:71], v[188:191], v[112:115], v[68:71]
    v_mfma_f32_16x16x32_bf16 v[72:75], v[188:191], v[116:119], v[72:75]
    v_mfma_f32_16x16x32_bf16 v[76:79], v[188:191], v[120:123], v[76:79]
    v_mfma_f32_16x16x32_bf16 v[80:83], v[188:191], v[124:127], v[80:83]
    v_mfma_f32_16x16x32_bf16 v[84:87], v[188:191], v[128:131], v[84:87]
    v_mfma_f32_16x16x32_bf16 v[88:91], v[188:191], v[132:135], v[88:91]
    v_mfma_f32_16x16x32_bf16 v[92:95], v[188:191], v[136:139], v[92:95]
    v_mfma_f32_16x16x32_bf16 v[96:99], v[188:191], v[140:143], v[96:99]
    ds_read_b128 v[100:103], v58 offset:1536
    s_waitcnt lgkmcnt(2)
    v_mfma_f32_16x16x32_bf16 v[96:99], v[104:107], v[136:139], v[96:99]
    v_mfma_f32_16x16x32_bf16 v[92:95], v[104:107], v[132:135], v[92:95]
    v_mfma_f32_16x16x32_bf16 v[88:91], v[104:107], v[128:131], v[88:91]
    v_mfma_f32_16x16x32_bf16 v[84:87], v[104:107], v[124:127], v[84:87]
    v_mfma_f32_16x16x32_bf16 v[80:83], v[104:107], v[120:123], v[80:83]
    v_mfma_f32_16x16x32_bf16 v[76:79], v[104:107], v[116:119], v[76:79]
    v_mfma_f32_16x16x32_bf16 v[72:75], v[104:107], v[112:115], v[72:75]
    ds_read_b128 v[104:107], v58 offset:2048
    ds_read_b128 v[144:147], v59 offset:416
    ds_read_b128 v[148:151], v59 offset:928
    ds_read_b128 v[152:155], v59 offset:1440
    ds_read_b128 v[156:159], v59 offset:1952
    ds_read_b128 v[160:163], v59 offset:2464
    ds_read_b128 v[164:167], v59 offset:2976
    ds_read_b128 v[168:171], v59 offset:3488
    ds_read_b128 v[172:175], v59 offset:4000
    s_waitcnt lgkmcnt(10)
    v_mfma_f32_16x16x32_bf16 v[96:99], v[108:111], v[132:135], v[96:99]
    v_mfma_f32_16x16x32_bf16 v[92:95], v[108:111], v[128:131], v[92:95]
    v_mfma_f32_16x16x32_bf16 v[88:91], v[108:111], v[124:127], v[88:91]
    v_mfma_f32_16x16x32_bf16 v[84:87], v[108:111], v[120:123], v[84:87]
    v_mfma_f32_16x16x32_bf16 v[80:83], v[108:111], v[116:119], v[80:83]
    v_mfma_f32_16x16x32_bf16 v[76:79], v[108:111], v[112:115], v[76:79]
    ds_read_b128 v[108:111], v58 offset:2560
    s_waitcnt lgkmcnt(10)
    v_mfma_f32_16x16x32_bf16 v[96:99], v[100:103], v[128:131], v[96:99]
    v_mfma_f32_16x16x32_bf16 v[92:95], v[100:103], v[124:127], v[92:95]
    v_mfma_f32_16x16x32_bf16 v[88:91], v[100:103], v[120:123], v[88:91]
    v_mfma_f32_16x16x32_bf16 v[84:87], v[100:103], v[116:119], v[84:87]
    v_mfma_f32_16x16x32_bf16 v[80:83], v[100:103], v[112:115], v[80:83]
    ds_read_b128 v[100:103], v58 offset:3072
    s_waitcnt lgkmcnt(10)
    v_mfma_f32_16x16x32_bf16 v[96:99], v[104:107], v[124:127], v[96:99]
    v_mfma_f32_16x16x32_bf16 v[92:95], v[104:107], v[120:123], v[92:95]
    v_mfma_f32_16x16x32_bf16 v[88:91], v[104:107], v[116:119], v[88:91]
    v_mfma_f32_16x16x32_bf16 v[84:87], v[104:107], v[112:115], v[84:87]
    ds_read_b128 v[104:107], v58 offset:3584
    s_waitcnt lgkmcnt(2)
    v_mfma_f32_16x16x32_bf16 v[96:99], v[108:111], v[120:123], v[96:99]
    v_mfma_f32_16x16x32_bf16 v[92:95], v[108:111], v[116:119], v[92:95]
    v_mfma_f32_16x16x32_bf16 v[88:91], v[108:111], v[112:115], v[88:91]
    ds_read_b128 v[108:111], v58 offset:64
    s_waitcnt lgkmcnt(2)
    v_mfma_f32_16x16x32_bf16 v[96:99], v[100:103], v[116:119], v[96:99]
    v_mfma_f32_16x16x32_bf16 v[92:95], v[100:103], v[112:115], v[92:95]
    ds_read_b128 v[100:103], v58 offset:576
    s_waitcnt lgkmcnt(2)
    v_mfma_f32_16x16x32_bf16 v[96:99], v[104:107], v[112:115], v[96:99]
    ds_read_b128 v[104:107], v58 offset:1088
    s_waitcnt lgkmcnt(2)
    v_mfma_f32_16x16x32_bf16 v[96:99], v[108:111], v[172:175], v[96:99]
    v_mfma_f32_16x16x32_bf16 v[92:95], v[108:111], v[168:171], v[92:95]
    v_mfma_f32_16x16x32_bf16 v[88:91], v[108:111], v[164:167], v[88:91]
    v_mfma_f32_16x16x32_bf16 v[84:87], v[108:111], v[160:163], v[84:87]
    v_mfma_f32_16x16x32_bf16 v[80:83], v[108:111], v[156:159], v[80:83]
    v_mfma_f32_16x16x32_bf16 v[76:79], v[108:111], v[152:155], v[76:79]
    v_mfma_f32_16x16x32_bf16 v[72:75], v[108:111], v[148:151], v[72:75]
    v_mfma_f32_16x16x32_bf16 v[68:71], v[108:111], v[144:147], v[68:71]
    ds_read_b128 v[108:111], v58 offset:1600
    s_waitcnt lgkmcnt(2)
    v_mfma_f32_16x16x32_bf16 v[96:99], v[100:103], v[168:171], v[96:99]
    v_mfma_f32_16x16x32_bf16 v[92:95], v[100:103], v[164:167], v[92:95]
    v_mfma_f32_16x16x32_bf16 v[88:91], v[100:103], v[160:163], v[88:91]
    v_mfma_f32_16x16x32_bf16 v[84:87], v[100:103], v[156:159], v[84:87]
    v_mfma_f32_16x16x32_bf16 v[80:83], v[100:103], v[152:155], v[80:83]
    v_mfma_f32_16x16x32_bf16 v[76:79], v[100:103], v[148:151], v[76:79]
    v_mfma_f32_16x16x32_bf16 v[72:75], v[100:103], v[144:147], v[72:75]
    ds_read_b128 v[100:103], v58 offset:2112
    s_waitcnt lgkmcnt(2)
    v_mfma_f32_16x16x32_bf16 v[96:99], v[104:107], v[164:167], v[96:99]
    v_mfma_f32_16x16x32_bf16 v[92:95], v[104:107], v[160:163], v[92:95]
    v_mfma_f32_16x16x32_bf16 v[88:91], v[104:107], v[156:159], v[88:91]
    v_mfma_f32_16x16x32_bf16 v[84:87], v[104:107], v[152:155], v[84:87]
    v_mfma_f32_16x16x32_bf16 v[80:83], v[104:107], v[148:151], v[80:83]
    v_mfma_f32_16x16x32_bf16 v[76:79], v[104:107], v[144:147], v[76:79]
    ds_read_b128 v[104:107], v58 offset:2624
    s_waitcnt lgkmcnt(2)
    v_mfma_f32_16x16x32_bf16 v[96:99], v[108:111], v[160:163], v[96:99]
    v_mfma_f32_16x16x32_bf16 v[92:95], v[108:111], v[156:159], v[92:95]
    v_mfma_f32_16x16x32_bf16 v[88:91], v[108:111], v[152:155], v[88:91]
    v_mfma_f32_16x16x32_bf16 v[84:87], v[108:111], v[148:151], v[84:87]
    v_mfma_f32_16x16x32_bf16 v[80:83], v[108:111], v[144:147], v[80:83]
    ds_read_b128 v[108:111], v58 offset:3136
    s_waitcnt lgkmcnt(2)
    v_mfma_f32_16x16x32_bf16 v[96:99], v[100:103], v[156:159], v[96:99]
    v_mfma_f32_16x16x32_bf16 v[92:95], v[100:103], v[152:155], v[92:95]
    v_mfma_f32_16x16x32_bf16 v[88:91], v[100:103], v[148:151], v[88:91]
    v_mfma_f32_16x16x32_bf16 v[84:87], v[100:103], v[144:147], v[84:87]
    ds_read_b128 v[100:103], v58 offset:3648
    s_waitcnt lgkmcnt(2)
    v_mfma_f32_16x16x32_bf16 v[96:99], v[104:107], v[152:155], v[96:99]
    v_mfma_f32_16x16x32_bf16 v[92:95], v[104:107], v[148:151], v[92:95]
    v_mfma_f32_16x16x32_bf16 v[88:91], v[104:107], v[144:147], v[88:91]
    s_waitcnt lgkmcnt(1)
    v_mfma_f32_16x16x32_bf16 v[96:99], v[108:111], v[148:151], v[96:99]
    v_mfma_f32_16x16x32_bf16 v[92:95], v[108:111], v[144:147], v[92:95]
    s_waitcnt lgkmcnt(0)
    v_mfma_f32_16x16x32_bf16 v[96:99], v[100:103], v[144:147], v[96:99]
    ds_write_b128 v66, v[68:71] offset:0
    ds_write_b128 v66, v[72:75] offset:1024
    ds_write_b128 v66, v[76:79] offset:2048
    ds_write_b128 v66, v[80:83] offset:3072
    ds_write_b128 v66, v[84:87] offset:4096
    ds_write_b128 v66, v[88:91] offset:5120
    ds_write_b128 v66, v[92:95] offset:6144
    s_nop 0
    ds_write_b128 v66, v[96:99] offset:7168
    s_branch c_pw_end_9
c_pw_10:
    s_cmp_lg_u32 s34, 1
    s_cbranch_scc1 c_pw_11
    ds_read_b128 v[100:103], v58 offset:128
    ds_read_b128 v[112:115], v59 offset:352
    ds_read_b128 v[116:119], v59 offset:864
    ds_read_b128 v[120:123], v59 offset:1376
    ds_read_b128 v[124:127], v59 offset:1888
    ds_read_b128 v[128:131], v59 offset:2400
    ds_read_b128 v[132:135], v59 offset:2912
    ds_read_b128 v[136:139], v59 offset:3424
    ds_read_b128 v[140:143], v59 offset:3936
    ds_read_b128 v[104:107], v58 offset:640
    ds_read_b128 v[108:111], v58 offset:1152
    s_waitcnt lgkmcnt(2)
    v_mfma_f32_16x16x32_bf16 v[96:99], v[100:103], v[140:143], 0
    v_mfma_f32_16x16x32_bf16 v[92:95], v[100:103], v[136:139], 0
    v_mfma_f32_16x16x32_bf16 v[88:91], v[100:103], v[132:135], 0
    v_mfma_f32_16x16x32_bf16 v[84:87], v[100:103], v[128:131], 0
    v_mfma_f32_16x16x32_bf16 v[80:83], v[100:103], v[124:127], 0
    v_mfma_f32_16x16x32_bf16 v[76:79], v[100:103], v[120:123], 0
    v_mfma_f32_16x16x32_bf16 v[72:75], v[100:103], v[116:119], 0
    v_mfma_f32_16x16x32_bf16 v[68:71], v[100:103], v[112:115], 0
    ds_read_b128 v[100:103], v58 offset:1664
    s_waitcnt lgkmcnt(2)
    v_mfma_f32_16x16x32_bf16 v[96:99], v[104:107], v[136:139], v[96:99]
    v_mfma_f32_16x16x32_bf16 v[92:95], v[104:107], v[132:135], v[92:95]
    v_mfma_f32_16x16x32_bf16 v[88:91], v[104:107], v[128:131], v[88:91]
    v_mfma_f32_16x16x32_bf16 v[84:87], v[104:107], v[124:127], v[84:87]
    v_mfma_f32_16x16x32_bf16 v[80:83], v[104:107], v[120:123], v[80:83]
    v_mfma_f32_16x16x32_bf16 v[76:79], v[104:107], v[116:119], v[76:79]
    v_mfma_f32_16x16x32_bf16 v[72:75], v[104:107], v[112:115], v[72:75]
    ds_read_b128 v[104:107], v58 offset:2176
    ds_read_b128 v[144:147], v59 offset:288
    ds_read_b128 v[148:151], v59 offset:800
    ds_read_b128 v[152:155], v59 offset:1312
    ds_read_b128 v[156:159], v59 offset:1824
    ds_read_b128 v[160:163], v59 offset:2336
    ds_read_b128 v[164:167], v59 offset:2848
    ds_read_b128 v[168:171], v59 offset:3360
    ds_read_b128 v[172:175], v59 offset:3872
    s_waitcnt lgkmcnt(10)
    v_mfma_f32_16x16x32_bf16 v[96:99], v[108:111], v[132:135], v[96:99]
    v_mfma_f32_16x16x32_bf16 v[92:95], v[108:111], v[128:131], v[92:95]
    v_mfma_f32_16x16x32_bf16 v[88:91], v[108:111], v[124:127], v[88:91]
    v_mfma_f32_16x16x32_bf16 v[84:87], v[108:111], v[120:123], v[84:87]
    v_mfma_f32_16x16x32_bf16 v[80:83], v[108:111], v[116:119], v[80:83]
    v_mfma_f32_16x16x32_bf16 v[76:79], v[108:111], v[112:115], v[76:79]
    ds_read_b128 v[108:111], v58 offset:2688
    s_waitcnt lgkmcnt(10)
    v_mfma_f32_16x16x32_bf16 v[96:99], v[100:103], v[128:131], v[96:99]
    v_mfma_f32_16x16x32_bf16 v[92:95], v[100:103], v[124:127], v[92:95]
    v_mfma_f32_16x16x32_bf16 v[88:91], v[100:103], v[120:123], v[88:91]
    v_mfma_f32_16x16x32_bf16 v[84:87], v[100:103], v[116:119], v[84:87]
    v_mfma_f32_16x16x32_bf16 v[80:83], v[100:103], v[112:115], v[80:83]
    ds_read_b128 v[100:103], v58 offset:3200
    s_waitcnt lgkmcnt(10)
    v_mfma_f32_16x16x32_bf16 v[96:99], v[104:107], v[124:127], v[96:99]
    v_mfma_f32_16x16x32_bf16 v[92:95], v[104:107], v[120:123], v[92:95]
    v_mfma_f32_16x16x32_bf16 v[88:91], v[104:107], v[116:119], v[88:91]
    v_mfma_f32_16x16x32_bf16 v[84:87], v[104:107], v[112:115], v[84:87]
    ds_read_b128 v[104:107], v58 offset:3712
    s_waitcnt lgkmcnt(2)
    v_mfma_f32_16x16x32_bf16 v[96:99], v[108:111], v[120:123], v[96:99]
    v_mfma_f32_16x16x32_bf16 v[92:95], v[108:111], v[116:119], v[92:95]
    v_mfma_f32_16x16x32_bf16 v[88:91], v[108:111], v[112:115], v[88:91]
    ds_read_b128 v[108:111], v58 offset:192
    s_waitcnt lgkmcnt(2)
    v_mfma_f32_16x16x32_bf16 v[96:99], v[100:103], v[116:119], v[96:99]
    v_mfma_f32_16x16x32_bf16 v[92:95], v[100:103], v[112:115], v[92:95]
    ds_read_b128 v[100:103], v58 offset:704
    s_waitcnt lgkmcnt(2)
    v_mfma_f32_16x16x32_bf16 v[96:99], v[104:107], v[112:115], v[96:99]
    ds_read_b128 v[104:107], v58 offset:1216
    s_waitcnt lgkmcnt(2)
    v_mfma_f32_16x16x32_bf16 v[96:99], v[108:111], v[172:175], v[96:99]
    v_mfma_f32_16x16x32_bf16 v[92:95], v[108:111], v[168:171], v[92:95]
    v_mfma_f32_16x16x32_bf16 v[88:91], v[108:111], v[164:167], v[88:91]
    v_mfma_f32_16x16x32_bf16 v[84:87], v[108:111], v[160:163], v[84:87]
    v_mfma_f32_16x16x32_bf16 v[80:83], v[108:111], v[156:159], v[80:83]
    v_mfma_f32_16x16x32_bf16 v[76:79], v[108:111], v[152:155], v[76:79]
    v_mfma_f32_16x16x32_bf16 v[72:75], v[108:111], v[148:151], v[72:75]
    v_mfma_f32_16x16x32_bf16 v[68:71], v[108:111], v[144:147], v[68:71]
    ds_read_b128 v[108:111], v58 offset:1728
    s_waitcnt lgkmcnt(2)
    v_mfma_f32_16x16x32_bf16 v[96:99], v[100:103], v[168:171], v[96:99]
    v_mfma_f32_16x16x32_bf16 v[92:95], v[100:103], v[164:167], v[92:95]
    v_mfma_f32_16x16x32_bf16 v[88:91], v[100:103], v[160:163], v[88:91]
    v_mfma_f32_16x16x32_bf16 v[84:87], v[100:103], v[156:159], v[84:87]
    v_mfma_f32_16x16x32_bf16 v[80:83], v[100:103], v[152:155], v[80:83]
    v_mfma_f32_16x16x32_bf16 v[76:79], v[100:103], v[148:151], v[76:79]
    v_mfma_f32_16x16x32_bf16 v[72:75], v[100:103], v[144:147], v[72:75]
    ds_read_b128 v[100:103], v58 offset:2240
    s_waitcnt lgkmcnt(2)
    v_mfma_f32_16x16x32_bf16 v[96:99], v[104:107], v[164:167], v[96:99]
    v_mfma_f32_16x16x32_bf16 v[92:95], v[104:107], v[160:163], v[92:95]
    v_mfma_f32_16x16x32_bf16 v[88:91], v[104:107], v[156:159], v[88:91]
    v_mfma_f32_16x16x32_bf16 v[84:87], v[104:107], v[152:155], v[84:87]
    v_mfma_f32_16x16x32_bf16 v[80:83], v[104:107], v[148:151], v[80:83]
    v_mfma_f32_16x16x32_bf16 v[76:79], v[104:107], v[144:147], v[76:79]
    ds_read_b128 v[104:107], v58 offset:2752
    s_waitcnt lgkmcnt(2)
    v_mfma_f32_16x16x32_bf16 v[96:99], v[108:111], v[160:163], v[96:99]
    v_mfma_f32_16x16x32_bf16 v[92:95], v[108:111], v[156:159], v[92:95]
    v_mfma_f32_16x16x32_bf16 v[88:91], v[108:111], v[152:155], v[88:91]
    v_mfma_f32_16x16x32_bf16 v[84:87], v[108:111], v[148:151], v[84:87]
    v_mfma_f32_16x16x32_bf16 v[80:83], v[108:111], v[144:147], v[80:83]
    ds_read_b128 v[108:111], v58 offset:3264
    s_waitcnt lgkmcnt(2)
    v_mfma_f32_16x16x32_bf16 v[96:99], v[100:103], v[156:159], v[96:99]
    v_mfma_f32_16x16x32_bf16 v[92:95], v[100:103], v[152:155], v[92:95]
    v_mfma_f32_16x16x32_bf16 v[88:91], v[100:103], v[148:151], v[88:91]
    v_mfma_f32_16x16x32_bf16 v[84:87], v[100:103], v[144:147], v[84:87]
    ds_read_b128 v[100:103], v58 offset:3776
    s_waitcnt lgkmcnt(2)
    v_mfma_f32_16x16x32_bf16 v[96:99], v[104:107], v[152:155], v[96:99]
    v_mfma_f32_16x16x32_bf16 v[92:95], v[104:107], v[148:151], v[92:95]
    v_mfma_f32_16x16x32_bf16 v[88:91], v[104:107], v[144:147], v[88:91]
    s_waitcnt lgkmcnt(1)
    v_mfma_f32_16x16x32_bf16 v[96:99], v[108:111], v[148:151], v[96:99]
    v_mfma_f32_16x16x32_bf16 v[92:95], v[108:111], v[144:147], v[92:95]
    s_waitcnt lgkmcnt(0)
    v_mfma_f32_16x16x32_bf16 v[96:99], v[100:103], v[144:147], v[96:99]
    ds_write_b128 v66, v[68:71] offset:0
    ds_write_b128 v66, v[72:75] offset:1024
    ds_write_b128 v66, v[76:79] offset:2048
    ds_write_b128 v66, v[80:83] offset:3072
    ds_write_b128 v66, v[84:87] offset:4096
    ds_write_b128 v66, v[88:91] offset:5120
    ds_write_b128 v66, v[92:95] offset:6144
    s_nop 0
    ds_write_b128 v66, v[96:99] offset:7168
    s_branch c_pw_end_9
c_pw_11:
    s_cmp_lg_u32 s34, 2
    s_cbranch_scc1 c_pw_12
    ds_read_b128 v[100:103], v58 offset:256
    ds_read_b128 v[112:115], v59 offset:224
    ds_read_b128 v[116:119], v59 offset:736
    ds_read_b128 v[120:123], v59 offset:1248
    ds_read_b128 v[124:127], v59 offset:1760
    ds_read_b128 v[128:131], v59 offset:2272
    ds_read_b128 v[132:135], v59 offset:2784
    ds_read_b128 v[136:139], v59 offset:3296
    ds_read_b128 v[140:143], v59 offset:3808
    ds_read_b128 v[104:107], v58 offset:768
    ds_read_b128 v[108:111], v58 offset:1280
    s_waitcnt lgkmcnt(2)
    v_mfma_f32_16x16x32_bf16 v[96:99], v[100:103], v[140:143], 0
    v_mfma_f32_16x16x32_bf16 v[92:95], v[100:103], v[136:139], 0
    v_mfma_f32_16x16x32_bf16 v[88:91], v[100:103], v[132:135], 0
    v_mfma_f32_16x16x32_bf16 v[84:87], v[100:103], v[128:131], 0
    v_mfma_f32_16x16x32_bf16 v[80:83], v[100:103], v[124:127], 0
    v_mfma_f32_16x16x32_bf16 v[76:79], v[100:103], v[120:123], 0
    v_mfma_f32_16x16x32_bf16 v[72:75], v[100:103], v[116:119], 0
    v_mfma_f32_16x16x32_bf16 v[68:71], v[100:103], v[112:115], 0
    ds_read_b128 v[100:103], v58 offset:1792
    s_waitcnt lgkmcnt(2)
    v_mfma_f32_16x16x32_bf16 v[96:99], v[104:107], v[136:139], v[96:99]
    v_mfma_f32_16x16x32_bf16 v[92:95], v[104:107], v[132:135], v[92:95]
    v_mfma_f32_16x16x32_bf16 v[88:91], v[104:107], v[128:131], v[88:91]
    v_mfma_f32_16x16x32_bf16 v[84:87], v[104:107], v[124:127], v[84:87]
    v_mfma_f32_16x16x32_bf16 v[80:83], v[104:107], v[120:123], v[80:83]
    v_mfma_f32_16x16x32_bf16 v[76:79], v[104:107], v[116:119], v[76:79]
    v_mfma_f32_16x16x32_bf16 v[72:75], v[104:107], v[112:115], v[72:75]
    ds_read_b128 v[104:107], v58 offset:2304
    ds_read_b128 v[144:147], v59 offset:160
    ds_read_b128 v[148:151], v59 offset:672
    ds_read_b128 v[152:155], v59 offset:1184
    ds_read_b128 v[156:159], v59 offset:1696
    ds_read_b128 v[160:163], v59 offset:2208
    ds_read_b128 v[164:167], v59 offset:2720
    ds_read_b128 v[168:171], v59 offset:3232
    ds_read_b128 v[172:175], v59 offset:3744
    s_waitcnt lgkmcnt(10)
    v_mfma_f32_16x16x32_bf16 v[96:99], v[108:111], v[132:135], v[96:99]
    v_mfma_f32_16x16x32_bf16 v[92:95], v[108:111], v[128:131], v[92:95]
    v_mfma_f32_16x16x32_bf16 v[88:91], v[108:111], v[124:127], v[88:91]
    v_mfma_f32_16x16x32_bf16 v[84:87], v[108:111], v[120:123], v[84:87]
    v_mfma_f32_16x16x32_bf16 v[80:83], v[108:111], v[116:119], v[80:83]
    v_mfma_f32_16x16x32_bf16 v[76:79], v[108:111], v[112:115], v[76:79]
    ds_read_b128 v[108:111], v58 offset:2816
    s_waitcnt lgkmcnt(10)
    v_mfma_f32_16x16x32_bf16 v[96:99], v[100:103], v[128:131], v[96:99]
    v_mfma_f32_16x16x32_bf16 v[92:95], v[100:103], v[124:127], v[92:95]
    v_mfma_f32_16x16x32_bf16 v[88:91], v[100:103], v[120:123], v[88:91]
    v_mfma_f32_16x16x32_bf16 v[84:87], v[100:103], v[116:119], v[84:87]
    v_mfma_f32_16x16x32_bf16 v[80:83], v[100:103], v[112:115], v[80:83]
    ds_read_b128 v[100:103], v58 offset:3328
    s_waitcnt lgkmcnt(10)
    v_mfma_f32_16x16x32_bf16 v[96:99], v[104:107], v[124:127], v[96:99]
    v_mfma_f32_16x16x32_bf16 v[92:95], v[104:107], v[120:123], v[92:95]
    v_mfma_f32_16x16x32_bf16 v[88:91], v[104:107], v[116:119], v[88:91]
    v_mfma_f32_16x16x32_bf16 v[84:87], v[104:107], v[112:115], v[84:87]
    ds_read_b128 v[104:107], v58 offset:3840
    s_waitcnt lgkmcnt(2)
    v_mfma_f32_16x16x32_bf16 v[96:99], v[108:111], v[120:123], v[96:99]
    v_mfma_f32_16x16x32_bf16 v[92:95], v[108:111], v[116:119], v[92:95]
    v_mfma_f32_16x16x32_bf16 v[88:91], v[108:111], v[112:115], v[88:91]
    ds_read_b128 v[108:111], v58 offset:320
    s_waitcnt lgkmcnt(2)
    v_mfma_f32_16x16x32_bf16 v[96:99], v[100:103], v[116:119], v[96:99]
    v_mfma_f32_16x16x32_bf16 v[92:95], v[100:103], v[112:115], v[92:95]
    ds_read_b128 v[100:103], v58 offset:832
    s_waitcnt lgkmcnt(2)
    v_mfma_f32_16x16x32_bf16 v[96:99], v[104:107], v[112:115], v[96:99]
    ds_read_b128 v[104:107], v58 offset:1344
    s_waitcnt lgkmcnt(2)
    v_mfma_f32_16x16x32_bf16 v[96:99], v[108:111], v[172:175], v[96:99]
    v_mfma_f32_16x16x32_bf16 v[92:95], v[108:111], v[168:171], v[92:95]
    v_mfma_f32_16x16x32_bf16 v[88:91], v[108:111], v[164:167], v[88:91]
    v_mfma_f32_16x16x32_bf16 v[84:87], v[108:111], v[160:163], v[84:87]
    v_mfma_f32_16x16x32_bf16 v[80:83], v[108:111], v[156:159], v[80:83]
    v_mfma_f32_16x16x32_bf16 v[76:79], v[108:111], v[152:155], v[76:79]
    v_mfma_f32_16x16x32_bf16 v[72:75], v[108:111], v[148:151], v[72:75]
    v_mfma_f32_16x16x32_bf16 v[68:71], v[108:111], v[144:147], v[68:71]
    ds_read_b128 v[108:111], v58 offset:1856
    s_waitcnt lgkmcnt(2)
    v_mfma_f32_16x16x32_bf16 v[96:99], v[100:103], v[168:171], v[96:99]
    v_mfma_f32_16x16x32_bf16 v[92:95], v[100:103], v[164:167], v[92:95]
    v_mfma_f32_16x16x32_bf16 v[88:91], v[100:103], v[160:163], v[88:91]
    v_mfma_f32_16x16x32_bf16 v[84:87], v[100:103], v[156:159], v[84:87]
    v_mfma_f32_16x16x32_bf16 v[80:83], v[100:103], v[152:155], v[80:83]
    v_mfma_f32_16x16x32_bf16 v[76:79], v[100:103], v[148:151], v[76:79]
    v_mfma_f32_16x16x32_bf16 v[72:75], v[100:103], v[144:147], v[72:75]
    ds_read_b128 v[100:103], v58 offset:2368
    s_waitcnt lgkmcnt(2)
    v_mfma_f32_16x16x32_bf16 v[96:99], v[104:107], v[164:167], v[96:99]
    v_mfma_f32_16x16x32_bf16 v[92:95], v[104:107], v[160:163], v[92:95]
    v_mfma_f32_16x16x32_bf16 v[88:91], v[104:107], v[156:159], v[88:91]
    v_mfma_f32_16x16x32_bf16 v[84:87], v[104:107], v[152:155], v[84:87]
    v_mfma_f32_16x16x32_bf16 v[80:83], v[104:107], v[148:151], v[80:83]
    v_mfma_f32_16x16x32_bf16 v[76:79], v[104:107], v[144:147], v[76:79]
    ds_read_b128 v[104:107], v58 offset:2880
    s_waitcnt lgkmcnt(2)
    v_mfma_f32_16x16x32_bf16 v[96:99], v[108:111], v[160:163], v[96:99]
    v_mfma_f32_16x16x32_bf16 v[92:95], v[108:111], v[156:159], v[92:95]
    v_mfma_f32_16x16x32_bf16 v[88:91], v[108:111], v[152:155], v[88:91]
    v_mfma_f32_16x16x32_bf16 v[84:87], v[108:111], v[148:151], v[84:87]
    v_mfma_f32_16x16x32_bf16 v[80:83], v[108:111], v[144:147], v[80:83]
    ds_read_b128 v[108:111], v58 offset:3392
    s_waitcnt lgkmcnt(2)
    v_mfma_f32_16x16x32_bf16 v[96:99], v[100:103], v[156:159], v[96:99]
    v_mfma_f32_16x16x32_bf16 v[92:95], v[100:103], v[152:155], v[92:95]
    v_mfma_f32_16x16x32_bf16 v[88:91], v[100:103], v[148:151], v[88:91]
    v_mfma_f32_16x16x32_bf16 v[84:87], v[100:103], v[144:147], v[84:87]
    ds_read_b128 v[100:103], v58 offset:3904
    s_waitcnt lgkmcnt(2)
    v_mfma_f32_16x16x32_bf16 v[96:99], v[104:107], v[152:155], v[96:99]
    v_mfma_f32_16x16x32_bf16 v[92:95], v[104:107], v[148:151], v[92:95]
    v_mfma_f32_16x16x32_bf16 v[88:91], v[104:107], v[144:147], v[88:91]
    s_waitcnt lgkmcnt(1)
    v_mfma_f32_16x16x32_bf16 v[96:99], v[108:111], v[148:151], v[96:99]
    v_mfma_f32_16x16x32_bf16 v[92:95], v[108:111], v[144:147], v[92:95]
    s_waitcnt lgkmcnt(0)
    v_mfma_f32_16x16x32_bf16 v[96:99], v[100:103], v[144:147], v[96:99]
    ds_write_b128 v66, v[68:71] offset:0
    ds_write_b128 v66, v[72:75] offset:1024
    ds_write_b128 v66, v[76:79] offset:2048
    ds_write_b128 v66, v[80:83] offset:3072
    ds_write_b128 v66, v[84:87] offset:4096
    ds_write_b128 v66, v[88:91] offset:5120
    ds_write_b128 v66, v[92:95] offset:6144
    s_nop 0
    ds_write_b128 v66, v[96:99] offset:7168
    s_branch c_pw_end_9
c_pw_12:
    ds_read_b128 v[100:103], v58 offset:384
    ds_read_b128 v[112:115], v59 offset:96
    ds_read_b128 v[116:119], v59 offset:608
    ds_read_b128 v[120:123], v59 offset:1120
    ds_read_b128 v[124:127], v59 offset:1632
    ds_read_b128 v[128:131], v59 offset:2144
    ds_read_b128 v[132:135], v59 offset:2656
    ds_read_b128 v[136:139], v59 offset:3168
    ds_read_b128 v[140:143], v59 offset:3680
    ds_read_b128 v[104:107], v58 offset:896
    ds_read_b128 v[108:111], v58 offset:1408
    s_waitcnt lgkmcnt(2)
    v_mfma_f32_16x16x32_bf16 v[96:99], v[100:103], v[140:143], 0
    v_mfma_f32_16x16x32_bf16 v[92:95], v[100:103], v[136:139], 0
    v_mfma_f32_16x16x32_bf16 v[88:91], v[100:103], v[132:135], 0
    v_mfma_f32_16x16x32_bf16 v[84:87], v[100:103], v[128:131], 0
    v_mfma_f32_16x16x32_bf16 v[80:83], v[100:103], v[124:127], 0
    v_mfma_f32_16x16x32_bf16 v[76:79], v[100:103], v[120:123], 0
    v_mfma_f32_16x16x32_bf16 v[72:75], v[100:103], v[116:119], 0
    v_mfma_f32_16x16x32_bf16 v[68:71], v[100:103], v[112:115], 0
    ds_read_b128 v[100:103], v58 offset:1920
    s_waitcnt lgkmcnt(2)
    v_mfma_f32_16x16x32_bf16 v[96:99], v[104:107], v[136:139], v[96:99]
    v_mfma_f32_16x16x32_bf16 v[92:95], v[104:107], v[132:135], v[92:95]
    v_mfma_f32_16x16x32_bf16 v[88:91], v[104:107], v[128:131], v[88:91]
    v_mfma_f32_16x16x32_bf16 v[84:87], v[104:107], v[124:127], v[84:87]
    v_mfma_f32_16x16x32_bf16 v[80:83], v[104:107], v[120:123], v[80:83]
    v_mfma_f32_16x16x32_bf16 v[76:79], v[104:107], v[116:119], v[76:79]
    v_mfma_f32_16x16x32_bf16 v[72:75], v[104:107], v[112:115], v[72:75]
    ds_read_b128 v[104:107], v58 offset:2432
    ds_read_b128 v[144:147], v59 offset:32
    ds_read_b128 v[148:151], v59 offset:544
    ds_read_b128 v[152:155], v59 offset:1056
    ds_read_b128 v[156:159], v59 offset:1568
    ds_read_b128 v[160:163], v59 offset:2080
    ds_read_b128 v[164:167], v59 offset:2592
    ds_read_b128 v[168:171], v59 offset:3104
    ds_read_b128 v[172:175], v59 offset:3616
    s_waitcnt lgkmcnt(10)
    v_mfma_f32_16x16x32_bf16 v[96:99], v[108:111], v[132:135], v[96:99]
    v_mfma_f32_16x16x32_bf16 v[92:95], v[108:111], v[128:131], v[92:95]
    v_mfma_f32_16x16x32_bf16 v[88:91], v[108:111], v[124:127], v[88:91]
    v_mfma_f32_16x16x32_bf16 v[84:87], v[108:111], v[120:123], v[84:87]
    v_mfma_f32_16x16x32_bf16 v[80:83], v[108:111], v[116:119], v[80:83]
    v_mfma_f32_16x16x32_bf16 v[76:79], v[108:111], v[112:115], v[76:79]
    ds_read_b128 v[108:111], v58 offset:2944
    s_waitcnt lgkmcnt(10)
    v_mfma_f32_16x16x32_bf16 v[96:99], v[100:103], v[128:131], v[96:99]
    v_mfma_f32_16x16x32_bf16 v[92:95], v[100:103], v[124:127], v[92:95]
    v_mfma_f32_16x16x32_bf16 v[88:91], v[100:103], v[120:123], v[88:91]
    v_mfma_f32_16x16x32_bf16 v[84:87], v[100:103], v[116:119], v[84:87]
    v_mfma_f32_16x16x32_bf16 v[80:83], v[100:103], v[112:115], v[80:83]
    ds_read_b128 v[100:103], v58 offset:3456
    s_waitcnt lgkmcnt(10)
    v_mfma_f32_16x16x32_bf16 v[96:99], v[104:107], v[124:127], v[96:99]
    v_mfma_f32_16x16x32_bf16 v[92:95], v[104:107], v[120:123], v[92:95]
    v_mfma_f32_16x16x32_bf16 v[88:91], v[104:107], v[116:119], v[88:91]
    v_mfma_f32_16x16x32_bf16 v[84:87], v[104:107], v[112:115], v[84:87]
    ds_read_b128 v[104:107], v58 offset:3968
    s_waitcnt lgkmcnt(2)
    v_mfma_f32_16x16x32_bf16 v[96:99], v[108:111], v[120:123], v[96:99]
    v_mfma_f32_16x16x32_bf16 v[92:95], v[108:111], v[116:119], v[92:95]
    v_mfma_f32_16x16x32_bf16 v[88:91], v[108:111], v[112:115], v[88:91]
    ds_read_b128 v[108:111], v58 offset:448
    s_waitcnt lgkmcnt(2)
    v_mfma_f32_16x16x32_bf16 v[96:99], v[100:103], v[116:119], v[96:99]
    v_mfma_f32_16x16x32_bf16 v[92:95], v[100:103], v[112:115], v[92:95]
    ds_read_b128 v[100:103], v58 offset:960
    s_waitcnt lgkmcnt(2)
    v_mfma_f32_16x16x32_bf16 v[96:99], v[104:107], v[112:115], v[96:99]
    ds_read_b128 v[104:107], v58 offset:1472
    s_waitcnt lgkmcnt(2)
    v_mfma_f32_16x16x32_bf16 v[96:99], v[108:111], v[172:175], v[96:99]
    v_mfma_f32_16x16x32_bf16 v[92:95], v[108:111], v[168:171], v[92:95]
    v_mfma_f32_16x16x32_bf16 v[88:91], v[108:111], v[164:167], v[88:91]
    v_mfma_f32_16x16x32_bf16 v[84:87], v[108:111], v[160:163], v[84:87]
    v_mfma_f32_16x16x32_bf16 v[80:83], v[108:111], v[156:159], v[80:83]
    v_mfma_f32_16x16x32_bf16 v[76:79], v[108:111], v[152:155], v[76:79]
    v_mfma_f32_16x16x32_bf16 v[72:75], v[108:111], v[148:151], v[72:75]
    v_mfma_f32_16x16x32_bf16 v[68:71], v[108:111], v[144:147], v[68:71]
    ds_read_b128 v[108:111], v58 offset:1984
    s_waitcnt lgkmcnt(2)
    v_mfma_f32_16x16x32_bf16 v[96:99], v[100:103], v[168:171], v[96:99]
    v_mfma_f32_16x16x32_bf16 v[92:95], v[100:103], v[164:167], v[92:95]
    v_mfma_f32_16x16x32_bf16 v[88:91], v[100:103], v[160:163], v[88:91]
    v_mfma_f32_16x16x32_bf16 v[84:87], v[100:103], v[156:159], v[84:87]
    v_mfma_f32_16x16x32_bf16 v[80:83], v[100:103], v[152:155], v[80:83]
    v_mfma_f32_16x16x32_bf16 v[76:79], v[100:103], v[148:151], v[76:79]
    v_mfma_f32_16x16x32_bf16 v[72:75], v[100:103], v[144:147], v[72:75]
    ds_read_b128 v[100:103], v58 offset:2496
    s_waitcnt lgkmcnt(2)
    v_mfma_f32_16x16x32_bf16 v[96:99], v[104:107], v[164:167], v[96:99]
    v_mfma_f32_16x16x32_bf16 v[92:95], v[104:107], v[160:163], v[92:95]
    v_mfma_f32_16x16x32_bf16 v[88:91], v[104:107], v[156:159], v[88:91]
    v_mfma_f32_16x16x32_bf16 v[84:87], v[104:107], v[152:155], v[84:87]
    v_mfma_f32_16x16x32_bf16 v[80:83], v[104:107], v[148:151], v[80:83]
    v_mfma_f32_16x16x32_bf16 v[76:79], v[104:107], v[144:147], v[76:79]
    ds_read_b128 v[104:107], v58 offset:3008
    s_waitcnt lgkmcnt(2)
    v_mfma_f32_16x16x32_bf16 v[96:99], v[108:111], v[160:163], v[96:99]
    v_mfma_f32_16x16x32_bf16 v[92:95], v[108:111], v[156:159], v[92:95]
    v_mfma_f32_16x16x32_bf16 v[88:91], v[108:111], v[152:155], v[88:91]
    v_mfma_f32_16x16x32_bf16 v[84:87], v[108:111], v[148:151], v[84:87]
    v_mfma_f32_16x16x32_bf16 v[80:83], v[108:111], v[144:147], v[80:83]
    ds_read_b128 v[108:111], v58 offset:3520
    s_waitcnt lgkmcnt(2)
    v_mfma_f32_16x16x32_bf16 v[96:99], v[100:103], v[156:159], v[96:99]
    v_mfma_f32_16x16x32_bf16 v[92:95], v[100:103], v[152:155], v[92:95]
    v_mfma_f32_16x16x32_bf16 v[88:91], v[100:103], v[148:151], v[88:91]
    v_mfma_f32_16x16x32_bf16 v[84:87], v[100:103], v[144:147], v[84:87]
    ds_read_b128 v[100:103], v58 offset:4032
    s_waitcnt lgkmcnt(2)
    v_mfma_f32_16x16x32_bf16 v[96:99], v[104:107], v[152:155], v[96:99]
    v_mfma_f32_16x16x32_bf16 v[92:95], v[104:107], v[148:151], v[92:95]
    v_mfma_f32_16x16x32_bf16 v[88:91], v[104:107], v[144:147], v[88:91]
    s_waitcnt lgkmcnt(1)
    v_mfma_f32_16x16x32_bf16 v[96:99], v[108:111], v[148:151], v[96:99]
    v_mfma_f32_16x16x32_bf16 v[92:95], v[108:111], v[144:147], v[92:95]
    s_waitcnt lgkmcnt(0)
    v_mfma_f32_16x16x32_bf16 v[96:99], v[100:103], v[144:147], v[96:99]
    ds_write_b128 v66, v[68:71] offset:0
    ds_write_b128 v66, v[72:75] offset:1024
    ds_write_b128 v66, v[76:79] offset:2048
    ds_write_b128 v66, v[80:83] offset:3072
    ds_write_b128 v66, v[84:87] offset:4096
    ds_write_b128 v66, v[88:91] offset:5120
    ds_write_b128 v66, v[92:95] offset:6144
    s_nop 0
    ds_write_b128 v66, v[96:99] offset:7168
c_pw_end_9:
    s_waitcnt lgkmcnt(0)
    s_barrier
    ds_read_b128 v[112:115], v67 offset:0
    ds_read_b128 v[116:119], v67 offset:16
    ds_read_b128 v[120:123], v67 offset:8192
    ds_read_b128 v[124:127], v67 offset:8208
    ds_read_b128 v[128:131], v67 offset:16384
    ds_read_b128 v[132:135], v67 offset:16400
    ds_read_b128 v[136:139], v67 offset:24576
    ds_read_b128 v[140:143], v67 offset:24592
    s_lshl_b32 s40, s56, 12
    s_add_u32 s40, s40, 8912896
    s_waitcnt lgkmcnt(0)
    v_pk_add_f32 v[112:113], v[112:113], v[120:121]
    v_pk_add_f32 v[128:129], v[128:129], v[136:137]
    v_pk_add_f32 v[114:115], v[114:115], v[122:123]
    v_pk_add_f32 v[130:131], v[130:131], v[138:139]
    v_pk_add_f32 v[116:117], v[116:117], v[124:125]
    v_pk_add_f32 v[132:133], v[132:133], v[140:141]
    v_pk_add_f32 v[118:119], v[118:119], v[126:127]
    v_pk_add_f32 v[134:135], v[134:135], v[142:143]
    v_pk_add_f32 v[112:113], v[112:113], v[128:129]
    v_pk_add_f32 v[114:115], v[114:115], v[130:131]
    v_pk_add_f32 v[116:117], v[116:117], v[132:133]
    v_pk_add_f32 v[118:119], v[118:119], v[134:135]
    v_cvt_pk_bf16_f32 v184, v112, v113
    v_cvt_pk_bf16_f32 v185, v114, v115
    v_cvt_pk_bf16_f32 v186, v116, v117
    v_cvt_pk_bf16_f32 v187, v118, v119
    buffer_store_dwordx4 v[184:187], v2, s[8:11], s40 offen sc1
    s_nop 1
    s_waitcnt vmcnt(4)
    v_cmp_ne_u32 vcc, 0, v0
    s_nop 1
    v_cndmask_b32 v16, 0, v16, vcc
    v_cndmask_b32 v17, 0, v17, vcc
    v_cndmask_b32 v18, 0, v18, vcc
    v_cndmask_b32 v19, 0, v19, vcc
    v_alignbit_b32 v176, v17, v16, 16
    v_alignbit_b32 v177, v18, v17, 16
    v_alignbit_b32 v178, v19, v18, 16
    v_alignbit_b32 v179, v20, v19, 16
    v_alignbit_b32 v180, v21, v20, 16
    v_alignbit_b32 v181, v22, v21, 16
    v_alignbit_b32 v182, v23, v22, 16
    ds_write_b128 v56, v[176:179] offset:0
    v_mov_b32 v184, v17
    v_mov_b32 v185, v18
    v_mov_b32 v186, v19
    v_mov_b32 v187, v20
    ds_write_b128 v56, v[184:187] offset:4160
    s_nop 1
    v_mov_b32 v184, v177
    v_mov_b32 v185, v178
    v_mov_b32 v186, v179
    v_mov_b32 v187, v180
    ds_write_b128 v56, v[184:187] offset:8320
    s_nop 1
    ds_write_b128 v56, v[18:21] offset:12480
    ds_write_b128 v56, v[178:181] offset:16640
    v_mov_b32 v184, v19
    v_mov_b32 v185, v20
    v_mov_b32 v186, v21
    v_mov_b32 v187, v22
    ds_write_b128 v56, v[184:187] offset:20800
    s_nop 1
    v_mov_b32 v184, v179
    v_mov_b32 v185, v180
    v_mov_b32 v186, v181
    v_mov_b32 v187, v182
    ds_write_b128 v56, v[184:187] offset:24960
    s_nop 1
    ds_write_b128 v56, v[20:23] offset:29120
    ds_write_b128 v57, v[36:39]
    v_lshlrev_b32 v3, 16, v45
    v_or_b32 v3, v3, v45
    v_and_b32 v188, v60, v3
    v_and_b32 v189, v61, v3
    v_and_b32 v190, v62, v3
    v_and_b32 v191, v63, v3
    s_waitcnt lgkmcnt(0)
    s_barrier
    s_cmp_ge_u32 s2, 192
    s_cbranch_scc1 c_wj3_14
    v_lshrrev_b32 v3, 4, v1
    v_and_b32 v5, 15, v1
    v_lshrrev_b32 v4, 2, v5
    v_lshl_add_u32 v3, v3, 2, v4
    v_mul_u32_u24 v3, 160, v3
    v_and_b32 v4, 3, v5
    v_lshl_add_u32 v3, v4, 3, v3
    v_lshlrev_b32 v5, 4, v1
    s_lshl_b32 s40, s34, 5
    s_add_u32 s41, s40, 70656
    v_add_u32 v4, s41, v3
    ds_read_b64_tr_b16 v[184:185], v4
    ds_read_b64_tr_b16 v[186:187], v4 offset:2560
    s_mul_i32 s41, s2, 5120
    s_lshl_b32 s40, s40, 5
    s_add_u32 s41, s41, s40
    s_add_u32 s41, s41, 15007744
    s_waitcnt lgkmcnt(0)
    buffer_store_dwordx4 v[184:187], v5, s[8:11], s41 offen sc1
    s_nop 1
    s_cmp_lg_u32 s34, 0
    s_cbranch_scc1 c_wj4_15
    s_mov_b32 s40, 128
    s_add_u32 s41, s40, 70656
    v_add_u32 v4, s41, v3
    ds_read_b64_tr_b16 v[184:185], v4
    ds_read_b64_tr_b16 v[186:187], v4 offset:2560
    s_mul_i32 s41, s2, 5120
    s_lshl_b32 s40, s40, 5
    s_add_u32 s41, s41, s40
    s_add_u32 s41, s41, 15007744
    s_waitcnt lgkmcnt(0)
    buffer_store_dwordx4 v[184:187], v5, s[8:11], s41 offen sc1
    s_nop 1
c_wj4_15:
c_wj3_14:
    s_cmp_lg_u32 s34, 0
    s_cbranch_scc1 c_pw_17
    ds_read_b128 v[100:103], v58 offset:0
    ds_read_b128 v[112:115], v59 offset:480
    ds_read_b128 v[116:119], v59 offset:992
    ds_read_b128 v[120:123], v59 offset:1504
    ds_read_b128 v[124:127], v59 offset:2016
    ds_read_b128 v[128:131], v59 offset:2528
    ds_read_b128 v[132:135], v59 offset:3040
    ds_read_b128 v[136:139], v59 offset:3552
    ds_read_b128 v[140:143], v59 offset:4064
    ds_read_b128 v[104:107], v58 offset:512
    ds_read_b128 v[108:111], v58 offset:1024
    s_waitcnt lgkmcnt(2)
    v_mfma_f32_16x16x32_bf16 v[96:99], v[100:103], v[140:143], 0
    v_mfma_f32_16x16x32_bf16 v[92:95], v[100:103], v[136:139], 0
    v_mfma_f32_16x16x32_bf16 v[88:91], v[100:103], v[132:135], 0
    v_mfma_f32_16x16x32_bf16 v[84:87], v[100:103], v[128:131], 0
    v_mfma_f32_16x16x32_bf16 v[80:83], v[100:103], v[124:127], 0
    v_mfma_f32_16x16x32_bf16 v[76:79], v[100:103], v[120:123], 0
    v_mfma_f32_16x16x32_bf16 v[72:75], v[100:103], v[116:119], 0
    v_mfma_f32_16x16x32_bf16 v[68:71], v[100:103], v[112:115], 0
    v_mfma_f32_16x16x32_bf16 v[68:71], v[188:191], v[112:115], v[68:71]
    v_mfma_f32_16x16x32_bf16 v[72:75], v[188:191], v[116:119], v[72:75]
    v_mfma_f32_16x16x32_bf16 v[76:79], v[188:191], v[120:123], v[76:79]
    v_mfma_f32_16x16x32_bf16 v[80:83], v[188:191], v[124:127], v[80:83]
    v_mfma_f32_16x16x32_bf16 v[84:87], v[188:191], v[128:131], v[84:87]
    v_mfma_f32_16x16x32_bf16 v[88:91], v[188:191], v[132:135], v[88:91]
    v_mfma_f32_16x16x32_bf16 v[92:95], v[188:191], v[136:139], v[92:95]
    v_mfma_f32_16x16x32_bf16 v[96:99], v[188:191], v[140:143], v[96:99]
    ds_read_b128 v[100:103], v58 offset:1536
    s_waitcnt lgkmcnt(2)
    v_mfma_f32_16x16x32_bf16 v[96:99], v[104:107], v[136:139], v[96:99]
    v_mfma_f32_16x16x32_bf16 v[92:95], v[104:107], v[132:135], v[92:95]
    v_mfma_f32_16x16x32_bf16 v[88:91], v[104:107], v[128:131], v[88:91]
    v_mfma_f32_16x16x32_bf16 v[84:87], v[104:107], v[124:127], v[84:87]
    v_mfma_f32_16x16x32_bf16 v[80:83], v[104:107], v[120:123], v[80:83]
    v_mfma_f32_16x16x32_bf16 v[76:79], v[104:107], v[116:119], v[76:79]
    v_mfma_f32_16x16x32_bf16 v[72:75], v[104:107], v[112:115], v[72:75]
    ds_read_b128 v[104:107], v58 offset:2048
    ds_read_b128 v[144:147], v59 offset:416
    ds_read_b128 v[148:151], v59 offset:928
    ds_read_b128 v[152:155], v59 offset:1440
    ds_read_b128 v[156:159], v59 offset:1952
    ds_read_b128 v[160:163], v59 offset:2464
    ds_read_b128 v[164:167], v59 offset:2976
    ds_read_b128 v[168:171], v59 offset:3488
    ds_read_b128 v[172:175], v59 offset:4000
    s_waitcnt lgkmcnt(10)
    v_mfma_f32_16x16x32_bf16 v[96:99], v[108:111], v[132:135], v[96:99]
    v_mfma_f32_16x16x32_bf16 v[92:95], v[108:111], v[128:131], v[92:95]
    v_mfma_f32_16x16x32_bf16 v[88:91], v[108:111], v[124:127], v[88:91]
    v_mfma_f32_16x16x32_bf16 v[84:87], v[108:111], v[120:123], v[84:87]
    v_mfma_f32_16x16x32_bf16 v[80:83], v[108:111], v[116:119], v[80:83]
    v_mfma_f32_16x16x32_bf16 v[76:79], v[108:111], v[112:115], v[76:79]
    ds_read_b128 v[108:111], v58 offset:2560
    s_waitcnt lgkmcnt(10)
    v_mfma_f32_16x16x32_bf16 v[96:99], v[100:103], v[128:131], v[96:99]
    v_mfma_f32_16x16x32_bf16 v[92:95], v[100:103], v[124:127], v[92:95]
    v_mfma_f32_16x16x32_bf16 v[88:91], v[100:103], v[120:123], v[88:91]
    v_mfma_f32_16x16x32_bf16 v[84:87], v[100:103], v[116:119], v[84:87]
    v_mfma_f32_16x16x32_bf16 v[80:83], v[100:103], v[112:115], v[80:83]
    ds_read_b128 v[100:103], v58 offset:3072
    s_waitcnt lgkmcnt(10)
    v_mfma_f32_16x16x32_bf16 v[96:99], v[104:107], v[124:127], v[96:99]
    v_mfma_f32_16x16x32_bf16 v[92:95], v[104:107], v[120:123], v[92:95]
    v_mfma_f32_16x16x32_bf16 v[88:91], v[104:107], v[116:119], v[88:91]
    v_mfma_f32_16x16x32_bf16 v[84:87], v[104:107], v[112:115], v[84:87]
    ds_read_b128 v[104:107], v58 offset:3584
    s_waitcnt lgkmcnt(2)
    v_mfma_f32_16x16x32_bf16 v[96:99], v[108:111], v[120:123], v[96:99]
    v_mfma_f32_16x16x32_bf16 v[92:95], v[108:111], v[116:119], v[92:95]
    v_mfma_f32_16x16x32_bf16 v[88:91], v[108:111], v[112:115], v[88:91]
    ds_read_b128 v[108:111], v58 offset:64
    s_waitcnt lgkmcnt(2)
    v_mfma_f32_16x16x32_bf16 v[96:99], v[100:103], v[116:119], v[96:99]
    v_mfma_f32_16x16x32_bf16 v[92:95], v[100:103], v[112:115], v[92:95]
    ds_read_b128 v[100:103], v58 offset:576
    s_waitcnt lgkmcnt(2)
    v_mfma_f32_16x16x32_bf16 v[96:99], v[104:107], v[112:115], v[96:99]
    ds_read_b128 v[104:107], v58 offset:1088
    s_waitcnt lgkmcnt(2)
    v_mfma_f32_16x16x32_bf16 v[96:99], v[108:111], v[172:175], v[96:99]
    v_mfma_f32_16x16x32_bf16 v[92:95], v[108:111], v[168:171], v[92:95]
    v_mfma_f32_16x16x32_bf16 v[88:91], v[108:111], v[164:167], v[88:91]
    v_mfma_f32_16x16x32_bf16 v[84:87], v[108:111], v[160:163], v[84:87]
    v_mfma_f32_16x16x32_bf16 v[80:83], v[108:111], v[156:159], v[80:83]
    v_mfma_f32_16x16x32_bf16 v[76:79], v[108:111], v[152:155], v[76:79]
    v_mfma_f32_16x16x32_bf16 v[72:75], v[108:111], v[148:151], v[72:75]
    v_mfma_f32_16x16x32_bf16 v[68:71], v[108:111], v[144:147], v[68:71]
    ds_read_b128 v[108:111], v58 offset:1600
    s_waitcnt lgkmcnt(2)
    v_mfma_f32_16x16x32_bf16 v[96:99], v[100:103], v[168:171], v[96:99]
    v_mfma_f32_16x16x32_bf16 v[92:95], v[100:103], v[164:167], v[92:95]
    v_mfma_f32_16x16x32_bf16 v[88:91], v[100:103], v[160:163], v[88:91]
    v_mfma_f32_16x16x32_bf16 v[84:87], v[100:103], v[156:159], v[84:87]
    v_mfma_f32_16x16x32_bf16 v[80:83], v[100:103], v[152:155], v[80:83]
    v_mfma_f32_16x16x32_bf16 v[76:79], v[100:103], v[148:151], v[76:79]
    v_mfma_f32_16x16x32_bf16 v[72:75], v[100:103], v[144:147], v[72:75]
    ds_read_b128 v[100:103], v58 offset:2112
    s_waitcnt lgkmcnt(2)
    v_mfma_f32_16x16x32_bf16 v[96:99], v[104:107], v[164:167], v[96:99]
    v_mfma_f32_16x16x32_bf16 v[92:95], v[104:107], v[160:163], v[92:95]
    v_mfma_f32_16x16x32_bf16 v[88:91], v[104:107], v[156:159], v[88:91]
    v_mfma_f32_16x16x32_bf16 v[84:87], v[104:107], v[152:155], v[84:87]
    v_mfma_f32_16x16x32_bf16 v[80:83], v[104:107], v[148:151], v[80:83]
    v_mfma_f32_16x16x32_bf16 v[76:79], v[104:107], v[144:147], v[76:79]
    ds_read_b128 v[104:107], v58 offset:2624
    s_waitcnt lgkmcnt(2)
    v_mfma_f32_16x16x32_bf16 v[96:99], v[108:111], v[160:163], v[96:99]
    v_mfma_f32_16x16x32_bf16 v[92:95], v[108:111], v[156:159], v[92:95]
    v_mfma_f32_16x16x32_bf16 v[88:91], v[108:111], v[152:155], v[88:91]
    v_mfma_f32_16x16x32_bf16 v[84:87], v[108:111], v[148:151], v[84:87]
    v_mfma_f32_16x16x32_bf16 v[80:83], v[108:111], v[144:147], v[80:83]
    ds_read_b128 v[108:111], v58 offset:3136
    s_waitcnt lgkmcnt(2)
    v_mfma_f32_16x16x32_bf16 v[96:99], v[100:103], v[156:159], v[96:99]
    v_mfma_f32_16x16x32_bf16 v[92:95], v[100:103], v[152:155], v[92:95]
    v_mfma_f32_16x16x32_bf16 v[88:91], v[100:103], v[148:151], v[88:91]
    v_mfma_f32_16x16x32_bf16 v[84:87], v[100:103], v[144:147], v[84:87]
    ds_read_b128 v[100:103], v58 offset:3648
    s_waitcnt lgkmcnt(2)
    v_mfma_f32_16x16x32_bf16 v[96:99], v[104:107], v[152:155], v[96:99]
    v_mfma_f32_16x16x32_bf16 v[92:95], v[104:107], v[148:151], v[92:95]
    v_mfma_f32_16x16x32_bf16 v[88:91], v[104:107], v[144:147], v[88:91]
    s_waitcnt lgkmcnt(1)
    v_mfma_f32_16x16x32_bf16 v[96:99], v[108:111], v[148:151], v[96:99]
    v_mfma_f32_16x16x32_bf16 v[92:95], v[108:111], v[144:147], v[92:95]
    s_waitcnt lgkmcnt(0)
    v_mfma_f32_16x16x32_bf16 v[96:99], v[100:103], v[144:147], v[96:99]
    ds_write_b128 v66, v[68:71] offset:0
    ds_write_b128 v66, v[72:75] offset:1024
    ds_write_b128 v66, v[76:79] offset:2048
    ds_write_b128 v66, v[80:83] offset:3072
    ds_write_b128 v66, v[84:87] offset:4096
    ds_write_b128 v66, v[88:91] offset:5120
    ds_write_b128 v66, v[92:95] offset:6144
    s_nop 0
    ds_write_b128 v66, v[96:99] offset:7168
    s_branch c_pw_end_16
c_pw_17:
    s_cmp_lg_u32 s34, 1
    s_cbranch_scc1 c_pw_18
    ds_read_b128 v[100:103], v58 offset:128
    ds_read_b128 v[112:115], v59 offset:352
    ds_read_b128 v[116:119], v59 offset:864
    ds_read_b128 v[120:123], v59 offset:1376
    ds_read_b128 v[124:127], v59 offset:1888
    ds_read_b128 v[128:131], v59 offset:2400
    ds_read_b128 v[132:135], v59 offset:2912
    ds_read_b128 v[136:139], v59 offset:3424
    ds_read_b128 v[140:143], v59 offset:3936
    ds_read_b128 v[104:107], v58 offset:640
    ds_read_b128 v[108:111], v58 offset:1152
    s_waitcnt lgkmcnt(2)
    v_mfma_f32_16x16x32_bf16 v[96:99], v[100:103], v[140:143], 0
    v_mfma_f32_16x16x32_bf16 v[92:95], v[100:103], v[136:139], 0
    v_mfma_f32_16x16x32_bf16 v[88:91], v[100:103], v[132:135], 0
    v_mfma_f32_16x16x32_bf16 v[84:87], v[100:103], v[128:131], 0
    v_mfma_f32_16x16x32_bf16 v[80:83], v[100:103], v[124:127], 0
    v_mfma_f32_16x16x32_bf16 v[76:79], v[100:103], v[120:123], 0
    v_mfma_f32_16x16x32_bf16 v[72:75], v[100:103], v[116:119], 0
    v_mfma_f32_16x16x32_bf16 v[68:71], v[100:103], v[112:115], 0
    ds_read_b128 v[100:103], v58 offset:1664
    s_waitcnt lgkmcnt(2)
    v_mfma_f32_16x16x32_bf16 v[96:99], v[104:107], v[136:139], v[96:99]
    v_mfma_f32_16x16x32_bf16 v[92:95], v[104:107], v[132:135], v[92:95]
    v_mfma_f32_16x16x32_bf16 v[88:91], v[104:107], v[128:131], v[88:91]
    v_mfma_f32_16x16x32_bf16 v[84:87], v[104:107], v[124:127], v[84:87]
    v_mfma_f32_16x16x32_bf16 v[80:83], v[104:107], v[120:123], v[80:83]
    v_mfma_f32_16x16x32_bf16 v[76:79], v[104:107], v[116:119], v[76:79]
    v_mfma_f32_16x16x32_bf16 v[72:75], v[104:107], v[112:115], v[72:75]
    ds_read_b128 v[104:107], v58 offset:2176
    ds_read_b128 v[144:147], v59 offset:288
    ds_read_b128 v[148:151], v59 offset:800
    ds_read_b128 v[152:155], v59 offset:1312
    ds_read_b128 v[156:159], v59 offset:1824
    ds_read_b128 v[160:163], v59 offset:2336
    ds_read_b128 v[164:167], v59 offset:2848
    ds_read_b128 v[168:171], v59 offset:3360
    ds_read_b128 v[172:175], v59 offset:3872
    s_waitcnt lgkmcnt(10)
    v_mfma_f32_16x16x32_bf16 v[96:99], v[108:111], v[132:135], v[96:99]
    v_mfma_f32_16x16x32_bf16 v[92:95], v[108:111], v[128:131], v[92:95]
    v_mfma_f32_16x16x32_bf16 v[88:91], v[108:111], v[124:127], v[88:91]
    v_mfma_f32_16x16x32_bf16 v[84:87], v[108:111], v[120:123], v[84:87]
    v_mfma_f32_16x16x32_bf16 v[80:83], v[108:111], v[116:119], v[80:83]
    v_mfma_f32_16x16x32_bf16 v[76:79], v[108:111], v[112:115], v[76:79]
    ds_read_b128 v[108:111], v58 offset:2688
    s_waitcnt lgkmcnt(10)
    v_mfma_f32_16x16x32_bf16 v[96:99], v[100:103], v[128:131], v[96:99]
    v_mfma_f32_16x16x32_bf16 v[92:95], v[100:103], v[124:127], v[92:95]
    v_mfma_f32_16x16x32_bf16 v[88:91], v[100:103], v[120:123], v[88:91]
    v_mfma_f32_16x16x32_bf16 v[84:87], v[100:103], v[116:119], v[84:87]
    v_mfma_f32_16x16x32_bf16 v[80:83], v[100:103], v[112:115], v[80:83]
    ds_read_b128 v[100:103], v58 offset:3200
    s_waitcnt lgkmcnt(10)
    v_mfma_f32_16x16x32_bf16 v[96:99], v[104:107], v[124:127], v[96:99]
    v_mfma_f32_16x16x32_bf16 v[92:95], v[104:107], v[120:123], v[92:95]
    v_mfma_f32_16x16x32_bf16 v[88:91], v[104:107], v[116:119], v[88:91]
    v_mfma_f32_16x16x32_bf16 v[84:87], v[104:107], v[112:115], v[84:87]
    ds_read_b128 v[104:107], v58 offset:3712
    s_waitcnt lgkmcnt(2)
    v_mfma_f32_16x16x32_bf16 v[96:99], v[108:111], v[120:123], v[96:99]
    v_mfma_f32_16x16x32_bf16 v[92:95], v[108:111], v[116:119], v[92:95]
    v_mfma_f32_16x16x32_bf16 v[88:91], v[108:111], v[112:115], v[88:91]
    ds_read_b128 v[108:111], v58 offset:192
    s_waitcnt lgkmcnt(2)
    v_mfma_f32_16x16x32_bf16 v[96:99], v[100:103], v[116:119], v[96:99]
    v_mfma_f32_16x16x32_bf16 v[92:95], v[100:103], v[112:115], v[92:95]
    ds_read_b128 v[100:103], v58 offset:704
    s_waitcnt lgkmcnt(2)
    v_mfma_f32_16x16x32_bf16 v[96:99], v[104:107], v[112:115], v[96:99]
    ds_read_b128 v[104:107], v58 offset:1216
    s_waitcnt lgkmcnt(2)
    v_mfma_f32_16x16x32_bf16 v[96:99], v[108:111], v[172:175], v[96:99]
    v_mfma_f32_16x16x32_bf16 v[92:95], v[108:111], v[168:171], v[92:95]
    v_mfma_f32_16x16x32_bf16 v[88:91], v[108:111], v[164:167], v[88:91]
    v_mfma_f32_16x16x32_bf16 v[84:87], v[108:111], v[160:163], v[84:87]
    v_mfma_f32_16x16x32_bf16 v[80:83], v[108:111], v[156:159], v[80:83]
    v_mfma_f32_16x16x32_bf16 v[76:79], v[108:111], v[152:155], v[76:79]
    v_mfma_f32_16x16x32_bf16 v[72:75], v[108:111], v[148:151], v[72:75]
    v_mfma_f32_16x16x32_bf16 v[68:71], v[108:111], v[144:147], v[68:71]
    ds_read_b128 v[108:111], v58 offset:1728
    s_waitcnt lgkmcnt(2)
    v_mfma_f32_16x16x32_bf16 v[96:99], v[100:103], v[168:171], v[96:99]
    v_mfma_f32_16x16x32_bf16 v[92:95], v[100:103], v[164:167], v[92:95]
    v_mfma_f32_16x16x32_bf16 v[88:91], v[100:103], v[160:163], v[88:91]
    v_mfma_f32_16x16x32_bf16 v[84:87], v[100:103], v[156:159], v[84:87]
    v_mfma_f32_16x16x32_bf16 v[80:83], v[100:103], v[152:155], v[80:83]
    v_mfma_f32_16x16x32_bf16 v[76:79], v[100:103], v[148:151], v[76:79]
    v_mfma_f32_16x16x32_bf16 v[72:75], v[100:103], v[144:147], v[72:75]
    ds_read_b128 v[100:103], v58 offset:2240
    s_waitcnt lgkmcnt(2)
    v_mfma_f32_16x16x32_bf16 v[96:99], v[104:107], v[164:167], v[96:99]
    v_mfma_f32_16x16x32_bf16 v[92:95], v[104:107], v[160:163], v[92:95]
    v_mfma_f32_16x16x32_bf16 v[88:91], v[104:107], v[156:159], v[88:91]
    v_mfma_f32_16x16x32_bf16 v[84:87], v[104:107], v[152:155], v[84:87]
    v_mfma_f32_16x16x32_bf16 v[80:83], v[104:107], v[148:151], v[80:83]
    v_mfma_f32_16x16x32_bf16 v[76:79], v[104:107], v[144:147], v[76:79]
    ds_read_b128 v[104:107], v58 offset:2752
    s_waitcnt lgkmcnt(2)
    v_mfma_f32_16x16x32_bf16 v[96:99], v[108:111], v[160:163], v[96:99]
    v_mfma_f32_16x16x32_bf16 v[92:95], v[108:111], v[156:159], v[92:95]
    v_mfma_f32_16x16x32_bf16 v[88:91], v[108:111], v[152:155], v[88:91]
    v_mfma_f32_16x16x32_bf16 v[84:87], v[108:111], v[148:151], v[84:87]
    v_mfma_f32_16x16x32_bf16 v[80:83], v[108:111], v[144:147], v[80:83]
    ds_read_b128 v[108:111], v58 offset:3264
    s_waitcnt lgkmcnt(2)
    v_mfma_f32_16x16x32_bf16 v[96:99], v[100:103], v[156:159], v[96:99]
    v_mfma_f32_16x16x32_bf16 v[92:95], v[100:103], v[152:155], v[92:95]
    v_mfma_f32_16x16x32_bf16 v[88:91], v[100:103], v[148:151], v[88:91]
    v_mfma_f32_16x16x32_bf16 v[84:87], v[100:103], v[144:147], v[84:87]
    ds_read_b128 v[100:103], v58 offset:3776
    s_waitcnt lgkmcnt(2)
    v_mfma_f32_16x16x32_bf16 v[96:99], v[104:107], v[152:155], v[96:99]
    v_mfma_f32_16x16x32_bf16 v[92:95], v[104:107], v[148:151], v[92:95]
    v_mfma_f32_16x16x32_bf16 v[88:91], v[104:107], v[144:147], v[88:91]
    s_waitcnt lgkmcnt(1)
    v_mfma_f32_16x16x32_bf16 v[96:99], v[108:111], v[148:151], v[96:99]
    v_mfma_f32_16x16x32_bf16 v[92:95], v[108:111], v[144:147], v[92:95]
    s_waitcnt lgkmcnt(0)
    v_mfma_f32_16x16x32_bf16 v[96:99], v[100:103], v[144:147], v[96:99]
    ds_write_b128 v66, v[68:71] offset:0
    ds_write_b128 v66, v[72:75] offset:1024
    ds_write_b128 v66, v[76:79] offset:2048
    ds_write_b128 v66, v[80:83] offset:3072
    ds_write_b128 v66, v[84:87] offset:4096
    ds_write_b128 v66, v[88:91] offset:5120
    ds_write_b128 v66, v[92:95] offset:6144
    s_nop 0
    ds_write_b128 v66, v[96:99] offset:7168
    s_branch c_pw_end_16
c_pw_18:
    s_cmp_lg_u32 s34, 2
    s_cbranch_scc1 c_pw_19
    ds_read_b128 v[100:103], v58 offset:256
    ds_read_b128 v[112:115], v59 offset:224
    ds_read_b128 v[116:119], v59 offset:736
    ds_read_b128 v[120:123], v59 offset:1248
    ds_read_b128 v[124:127], v59 offset:1760
    ds_read_b128 v[128:131], v59 offset:2272
    ds_read_b128 v[132:135], v59 offset:2784
    ds_read_b128 v[136:139], v59 offset:3296
    ds_read_b128 v[140:143], v59 offset:3808
    ds_read_b128 v[104:107], v58 offset:768
    ds_read_b128 v[108:111], v58 offset:1280
    s_waitcnt lgkmcnt(2)
    v_mfma_f32_16x16x32_bf16 v[96:99], v[100:103], v[140:143], 0
    v_mfma_f32_16x16x32_bf16 v[92:95], v[100:103], v[136:139], 0
    v_mfma_f32_16x16x32_bf16 v[88:91], v[100:103], v[132:135], 0
    v_mfma_f32_16x16x32_bf16 v[84:87], v[100:103], v[128:131], 0
    v_mfma_f32_16x16x32_bf16 v[80:83], v[100:103], v[124:127], 0
    v_mfma_f32_16x16x32_bf16 v[76:79], v[100:103], v[120:123], 0
    v_mfma_f32_16x16x32_bf16 v[72:75], v[100:103], v[116:119], 0
    v_mfma_f32_16x16x32_bf16 v[68:71], v[100:103], v[112:115], 0
    ds_read_b128 v[100:103], v58 offset:1792
    s_waitcnt lgkmcnt(2)
    v_mfma_f32_16x16x32_bf16 v[96:99], v[104:107], v[136:139], v[96:99]
    v_mfma_f32_16x16x32_bf16 v[92:95], v[104:107], v[132:135], v[92:95]
    v_mfma_f32_16x16x32_bf16 v[88:91], v[104:107], v[128:131], v[88:91]
    v_mfma_f32_16x16x32_bf16 v[84:87], v[104:107], v[124:127], v[84:87]
    v_mfma_f32_16x16x32_bf16 v[80:83], v[104:107], v[120:123], v[80:83]
    v_mfma_f32_16x16x32_bf16 v[76:79], v[104:107], v[116:119], v[76:79]
    v_mfma_f32_16x16x32_bf16 v[72:75], v[104:107], v[112:115], v[72:75]
    ds_read_b128 v[104:107], v58 offset:2304
    ds_read_b128 v[144:147], v59 offset:160
    ds_read_b128 v[148:151], v59 offset:672
    ds_read_b128 v[152:155], v59 offset:1184
    ds_read_b128 v[156:159], v59 offset:1696
    ds_read_b128 v[160:163], v59 offset:2208
    ds_read_b128 v[164:167], v59 offset:2720
    ds_read_b128 v[168:171], v59 offset:3232
    ds_read_b128 v[172:175], v59 offset:3744
    s_waitcnt lgkmcnt(10)
    v_mfma_f32_16x16x32_bf16 v[96:99], v[108:111], v[132:135], v[96:99]
    v_mfma_f32_16x16x32_bf16 v[92:95], v[108:111], v[128:131], v[92:95]
    v_mfma_f32_16x16x32_bf16 v[88:91], v[108:111], v[124:127], v[88:91]
    v_mfma_f32_16x16x32_bf16 v[84:87], v[108:111], v[120:123], v[84:87]
    v_mfma_f32_16x16x32_bf16 v[80:83], v[108:111], v[116:119], v[80:83]
    v_mfma_f32_16x16x32_bf16 v[76:79], v[108:111], v[112:115], v[76:79]
    ds_read_b128 v[108:111], v58 offset:2816
    s_waitcnt lgkmcnt(10)
    v_mfma_f32_16x16x32_bf16 v[96:99], v[100:103], v[128:131], v[96:99]
    v_mfma_f32_16x16x32_bf16 v[92:95], v[100:103], v[124:127], v[92:95]
    v_mfma_f32_16x16x32_bf16 v[88:91], v[100:103], v[120:123], v[88:91]
    v_mfma_f32_16x16x32_bf16 v[84:87], v[100:103], v[116:119], v[84:87]
    v_mfma_f32_16x16x32_bf16 v[80:83], v[100:103], v[112:115], v[80:83]
    ds_read_b128 v[100:103], v58 offset:3328
    s_waitcnt lgkmcnt(10)
    v_mfma_f32_16x16x32_bf16 v[96:99], v[104:107], v[124:127], v[96:99]
    v_mfma_f32_16x16x32_bf16 v[92:95], v[104:107], v[120:123], v[92:95]
    v_mfma_f32_16x16x32_bf16 v[88:91], v[104:107], v[116:119], v[88:91]
    v_mfma_f32_16x16x32_bf16 v[84:87], v[104:107], v[112:115], v[84:87]
    ds_read_b128 v[104:107], v58 offset:3840
    s_waitcnt lgkmcnt(2)
    v_mfma_f32_16x16x32_bf16 v[96:99], v[108:111], v[120:123], v[96:99]
    v_mfma_f32_16x16x32_bf16 v[92:95], v[108:111], v[116:119], v[92:95]
    v_mfma_f32_16x16x32_bf16 v[88:91], v[108:111], v[112:115], v[88:91]
    ds_read_b128 v[108:111], v58 offset:320
    s_waitcnt lgkmcnt(2)
    v_mfma_f32_16x16x32_bf16 v[96:99], v[100:103], v[116:119], v[96:99]
    v_mfma_f32_16x16x32_bf16 v[92:95], v[100:103], v[112:115], v[92:95]
    ds_read_b128 v[100:103], v58 offset:832
    s_waitcnt lgkmcnt(2)
    v_mfma_f32_16x16x32_bf16 v[96:99], v[104:107], v[112:115], v[96:99]
    ds_read_b128 v[104:107], v58 offset:1344
    s_waitcnt lgkmcnt(2)
    v_mfma_f32_16x16x32_bf16 v[96:99], v[108:111], v[172:175], v[96:99]
    v_mfma_f32_16x16x32_bf16 v[92:95], v[108:111], v[168:171], v[92:95]
    v_mfma_f32_16x16x32_bf16 v[88:91], v[108:111], v[164:167], v[88:91]
    v_mfma_f32_16x16x32_bf16 v[84:87], v[108:111], v[160:163], v[84:87]
    v_mfma_f32_16x16x32_bf16 v[80:83], v[108:111], v[156:159], v[80:83]
    v_mfma_f32_16x16x32_bf16 v[76:79], v[108:111], v[152:155], v[76:79]
    v_mfma_f32_16x16x32_bf16 v[72:75], v[108:111], v[148:151], v[72:75]
    v_mfma_f32_16x16x32_bf16 v[68:71], v[108:111], v[144:147], v[68:71]
    ds_read_b128 v[108:111], v58 offset:1856
    s_waitcnt lgkmcnt(2)
    v_mfma_f32_16x16x32_bf16 v[96:99], v[100:103], v[168:171], v[96:99]
    v_mfma_f32_16x16x32_bf16 v[92:95], v[100:103], v[164:167], v[92:95]
    v_mfma_f32_16x16x32_bf16 v[88:91], v[100:103], v[160:163], v[88:91]
    v_mfma_f32_16x16x32_bf16 v[84:87], v[100:103], v[156:159], v[84:87]
    v_mfma_f32_16x16x32_bf16 v[80:83], v[100:103], v[152:155], v[80:83]
    v_mfma_f32_16x16x32_bf16 v[76:79], v[100:103], v[148:151], v[76:79]
    v_mfma_f32_16x16x32_bf16 v[72:75], v[100:103], v[144:147], v[72:75]
    ds_read_b128 v[100:103], v58 offset:2368
    s_waitcnt lgkmcnt(2)
    v_mfma_f32_16x16x32_bf16 v[96:99], v[104:107], v[164:167], v[96:99]
    v_mfma_f32_16x16x32_bf16 v[92:95], v[104:107], v[160:163], v[92:95]
    v_mfma_f32_16x16x32_bf16 v[88:91], v[104:107], v[156:159], v[88:91]
    v_mfma_f32_16x16x32_bf16 v[84:87], v[104:107], v[152:155], v[84:87]
    v_mfma_f32_16x16x32_bf16 v[80:83], v[104:107], v[148:151], v[80:83]
    v_mfma_f32_16x16x32_bf16 v[76:79], v[104:107], v[144:147], v[76:79]
    ds_read_b128 v[104:107], v58 offset:2880
    s_waitcnt lgkmcnt(2)
    v_mfma_f32_16x16x32_bf16 v[96:99], v[108:111], v[160:163], v[96:99]
    v_mfma_f32_16x16x32_bf16 v[92:95], v[108:111], v[156:159], v[92:95]
    v_mfma_f32_16x16x32_bf16 v[88:91], v[108:111], v[152:155], v[88:91]
    v_mfma_f32_16x16x32_bf16 v[84:87], v[108:111], v[148:151], v[84:87]
    v_mfma_f32_16x16x32_bf16 v[80:83], v[108:111], v[144:147], v[80:83]
    ds_read_b128 v[108:111], v58 offset:3392
    s_waitcnt lgkmcnt(2)
    v_mfma_f32_16x16x32_bf16 v[96:99], v[100:103], v[156:159], v[96:99]
    v_mfma_f32_16x16x32_bf16 v[92:95], v[100:103], v[152:155], v[92:95]
    v_mfma_f32_16x16x32_bf16 v[88:91], v[100:103], v[148:151], v[88:91]
    v_mfma_f32_16x16x32_bf16 v[84:87], v[100:103], v[144:147], v[84:87]
    ds_read_b128 v[100:103], v58 offset:3904
    s_waitcnt lgkmcnt(2)
    v_mfma_f32_16x16x32_bf16 v[96:99], v[104:107], v[152:155], v[96:99]
    v_mfma_f32_16x16x32_bf16 v[92:95], v[104:107], v[148:151], v[92:95]
    v_mfma_f32_16x16x32_bf16 v[88:91], v[104:107], v[144:147], v[88:91]
    s_waitcnt lgkmcnt(1)
    v_mfma_f32_16x16x32_bf16 v[96:99], v[108:111], v[148:151], v[96:99]
    v_mfma_f32_16x16x32_bf16 v[92:95], v[108:111], v[144:147], v[92:95]
    s_waitcnt lgkmcnt(0)
    v_mfma_f32_16x16x32_bf16 v[96:99], v[100:103], v[144:147], v[96:99]
    ds_write_b128 v66, v[68:71] offset:0
    ds_write_b128 v66, v[72:75] offset:1024
    ds_write_b128 v66, v[76:79] offset:2048
    ds_write_b128 v66, v[80:83] offset:3072
    ds_write_b128 v66, v[84:87] offset:4096
    ds_write_b128 v66, v[88:91] offset:5120
    ds_write_b128 v66, v[92:95] offset:6144
    s_nop 0
    ds_write_b128 v66, v[96:99] offset:7168
    s_branch c_pw_end_16
c_pw_19:
    ds_read_b128 v[100:103], v58 offset:384
    ds_read_b128 v[112:115], v59 offset:96
    ds_read_b128 v[116:119], v59 offset:608
    ds_read_b128 v[120:123], v59 offset:1120
    ds_read_b128 v[124:127], v59 offset:1632
    ds_read_b128 v[128:131], v59 offset:2144
    ds_read_b128 v[132:135], v59 offset:2656
    ds_read_b128 v[136:139], v59 offset:3168
    ds_read_b128 v[140:143], v59 offset:3680
    ds_read_b128 v[104:107], v58 offset:896
    ds_read_b128 v[108:111], v58 offset:1408
    s_waitcnt lgkmcnt(2)
    v_mfma_f32_16x16x32_bf16 v[96:99], v[100:103], v[140:143], 0
    v_mfma_f32_16x16x32_bf16 v[92:95], v[100:103], v[136:139], 0
    v_mfma_f32_16x16x32_bf16 v[88:91], v[100:103], v[132:135], 0
    v_mfma_f32_16x16x32_bf16 v[84:87], v[100:103], v[128:131], 0
    v_mfma_f32_16x16x32_bf16 v[80:83], v[100:103], v[124:127], 0
    v_mfma_f32_16x16x32_bf16 v[76:79], v[100:103], v[120:123], 0
    v_mfma_f32_16x16x32_bf16 v[72:75], v[100:103], v[116:119], 0
    v_mfma_f32_16x16x32_bf16 v[68:71], v[100:103], v[112:115], 0
    ds_read_b128 v[100:103], v58 offset:1920
    s_waitcnt lgkmcnt(2)
    v_mfma_f32_16x16x32_bf16 v[96:99], v[104:107], v[136:139], v[96:99]
    v_mfma_f32_16x16x32_bf16 v[92:95], v[104:107], v[132:135], v[92:95]
    v_mfma_f32_16x16x32_bf16 v[88:91], v[104:107], v[128:131], v[88:91]
    v_mfma_f32_16x16x32_bf16 v[84:87], v[104:107], v[124:127], v[84:87]
    v_mfma_f32_16x16x32_bf16 v[80:83], v[104:107], v[120:123], v[80:83]
    v_mfma_f32_16x16x32_bf16 v[76:79], v[104:107], v[116:119], v[76:79]
    v_mfma_f32_16x16x32_bf16 v[72:75], v[104:107], v[112:115], v[72:75]
    ds_read_b128 v[104:107], v58 offset:2432
    ds_read_b128 v[144:147], v59 offset:32
    ds_read_b128 v[148:151], v59 offset:544
    ds_read_b128 v[152:155], v59 offset:1056
    ds_read_b128 v[156:159], v59 offset:1568
    ds_read_b128 v[160:163], v59 offset:2080
    ds_read_b128 v[164:167], v59 offset:2592
    ds_read_b128 v[168:171], v59 offset:3104
    ds_read_b128 v[172:175], v59 offset:3616
    s_waitcnt lgkmcnt(10)
    v_mfma_f32_16x16x32_bf16 v[96:99], v[108:111], v[132:135], v[96:99]
    v_mfma_f32_16x16x32_bf16 v[92:95], v[108:111], v[128:131], v[92:95]
    v_mfma_f32_16x16x32_bf16 v[88:91], v[108:111], v[124:127], v[88:91]
    v_mfma_f32_16x16x32_bf16 v[84:87], v[108:111], v[120:123], v[84:87]
    v_mfma_f32_16x16x32_bf16 v[80:83], v[108:111], v[116:119], v[80:83]
    v_mfma_f32_16x16x32_bf16 v[76:79], v[108:111], v[112:115], v[76:79]
    ds_read_b128 v[108:111], v58 offset:2944
    s_waitcnt lgkmcnt(10)
    v_mfma_f32_16x16x32_bf16 v[96:99], v[100:103], v[128:131], v[96:99]
    v_mfma_f32_16x16x32_bf16 v[92:95], v[100:103], v[124:127], v[92:95]
    v_mfma_f32_16x16x32_bf16 v[88:91], v[100:103], v[120:123], v[88:91]
    v_mfma_f32_16x16x32_bf16 v[84:87], v[100:103], v[116:119], v[84:87]
    v_mfma_f32_16x16x32_bf16 v[80:83], v[100:103], v[112:115], v[80:83]
    ds_read_b128 v[100:103], v58 offset:3456
    s_waitcnt lgkmcnt(10)
    v_mfma_f32_16x16x32_bf16 v[96:99], v[104:107], v[124:127], v[96:99]
    v_mfma_f32_16x16x32_bf16 v[92:95], v[104:107], v[120:123], v[92:95]
    v_mfma_f32_16x16x32_bf16 v[88:91], v[104:107], v[116:119], v[88:91]
    v_mfma_f32_16x16x32_bf16 v[84:87], v[104:107], v[112:115], v[84:87]
    ds_read_b128 v[104:107], v58 offset:3968
    s_waitcnt lgkmcnt(2)
    v_mfma_f32_16x16x32_bf16 v[96:99], v[108:111], v[120:123], v[96:99]
    v_mfma_f32_16x16x32_bf16 v[92:95], v[108:111], v[116:119], v[92:95]
    v_mfma_f32_16x16x32_bf16 v[88:91], v[108:111], v[112:115], v[88:91]
    ds_read_b128 v[108:111], v58 offset:448
    s_waitcnt lgkmcnt(2)
    v_mfma_f32_16x16x32_bf16 v[96:99], v[100:103], v[116:119], v[96:99]
    v_mfma_f32_16x16x32_bf16 v[92:95], v[100:103], v[112:115], v[92:95]
    ds_read_b128 v[100:103], v58 offset:960
    s_waitcnt lgkmcnt(2)
    v_mfma_f32_16x16x32_bf16 v[96:99], v[104:107], v[112:115], v[96:99]
    ds_read_b128 v[104:107], v58 offset:1472
    s_waitcnt lgkmcnt(2)
    v_mfma_f32_16x16x32_bf16 v[96:99], v[108:111], v[172:175], v[96:99]
    v_mfma_f32_16x16x32_bf16 v[92:95], v[108:111], v[168:171], v[92:95]
    v_mfma_f32_16x16x32_bf16 v[88:91], v[108:111], v[164:167], v[88:91]
    v_mfma_f32_16x16x32_bf16 v[84:87], v[108:111], v[160:163], v[84:87]
    v_mfma_f32_16x16x32_bf16 v[80:83], v[108:111], v[156:159], v[80:83]
    v_mfma_f32_16x16x32_bf16 v[76:79], v[108:111], v[152:155], v[76:79]
    v_mfma_f32_16x16x32_bf16 v[72:75], v[108:111], v[148:151], v[72:75]
    v_mfma_f32_16x16x32_bf16 v[68:71], v[108:111], v[144:147], v[68:71]
    ds_read_b128 v[108:111], v58 offset:1984
    s_waitcnt lgkmcnt(2)
    v_mfma_f32_16x16x32_bf16 v[96:99], v[100:103], v[168:171], v[96:99]
    v_mfma_f32_16x16x32_bf16 v[92:95], v[100:103], v[164:167], v[92:95]
    v_mfma_f32_16x16x32_bf16 v[88:91], v[100:103], v[160:163], v[88:91]
    v_mfma_f32_16x16x32_bf16 v[84:87], v[100:103], v[156:159], v[84:87]
    v_mfma_f32_16x16x32_bf16 v[80:83], v[100:103], v[152:155], v[80:83]
    v_mfma_f32_16x16x32_bf16 v[76:79], v[100:103], v[148:151], v[76:79]
    v_mfma_f32_16x16x32_bf16 v[72:75], v[100:103], v[144:147], v[72:75]
    ds_read_b128 v[100:103], v58 offset:2496
    s_waitcnt lgkmcnt(2)
    v_mfma_f32_16x16x32_bf16 v[96:99], v[104:107], v[164:167], v[96:99]
    v_mfma_f32_16x16x32_bf16 v[92:95], v[104:107], v[160:163], v[92:95]
    v_mfma_f32_16x16x32_bf16 v[88:91], v[104:107], v[156:159], v[88:91]
    v_mfma_f32_16x16x32_bf16 v[84:87], v[104:107], v[152:155], v[84:87]
    v_mfma_f32_16x16x32_bf16 v[80:83], v[104:107], v[148:151], v[80:83]
    v_mfma_f32_16x16x32_bf16 v[76:79], v[104:107], v[144:147], v[76:79]
    ds_read_b128 v[104:107], v58 offset:3008
    s_waitcnt lgkmcnt(2)
    v_mfma_f32_16x16x32_bf16 v[96:99], v[108:111], v[160:163], v[96:99]
    v_mfma_f32_16x16x32_bf16 v[92:95], v[108:111], v[156:159], v[92:95]
    v_mfma_f32_16x16x32_bf16 v[88:91], v[108:111], v[152:155], v[88:91]
    v_mfma_f32_16x16x32_bf16 v[84:87], v[108:111], v[148:151], v[84:87]
    v_mfma_f32_16x16x32_bf16 v[80:83], v[108:111], v[144:147], v[80:83]
    ds_read_b128 v[108:111], v58 offset:3520
    s_waitcnt lgkmcnt(2)
    v_mfma_f32_16x16x32_bf16 v[96:99], v[100:103], v[156:159], v[96:99]
    v_mfma_f32_16x16x32_bf16 v[92:95], v[100:103], v[152:155], v[92:95]
    v_mfma_f32_16x16x32_bf16 v[88:91], v[100:103], v[148:151], v[88:91]
    v_mfma_f32_16x16x32_bf16 v[84:87], v[100:103], v[144:147], v[84:87]
    ds_read_b128 v[100:103], v58 offset:4032
    s_waitcnt lgkmcnt(2)
    v_mfma_f32_16x16x32_bf16 v[96:99], v[104:107], v[152:155], v[96:99]
    v_mfma_f32_16x16x32_bf16 v[92:95], v[104:107], v[148:151], v[92:95]
    v_mfma_f32_16x16x32_bf16 v[88:91], v[104:107], v[144:147], v[88:91]
    s_waitcnt lgkmcnt(1)
    v_mfma_f32_16x16x32_bf16 v[96:99], v[108:111], v[148:151], v[96:99]
    v_mfma_f32_16x16x32_bf16 v[92:95], v[108:111], v[144:147], v[92:95]
    s_waitcnt lgkmcnt(0)
    v_mfma_f32_16x16x32_bf16 v[96:99], v[100:103], v[144:147], v[96:99]
    ds_write_b128 v66, v[68:71] offset:0
    ds_write_b128 v66, v[72:75] offset:1024
    ds_write_b128 v66, v[76:79] offset:2048
    ds_write_b128 v66, v[80:83] offset:3072
    ds_write_b128 v66, v[84:87] offset:4096
    ds_write_b128 v66, v[88:91] offset:5120
    ds_write_b128 v66, v[92:95] offset:6144
    s_nop 0
    ds_write_b128 v66, v[96:99] offset:7168
c_pw_end_16:
    s_waitcnt lgkmcnt(0)
    s_barrier
    ds_read_b128 v[112:115], v67 offset:0
    ds_read_b128 v[116:119], v67 offset:16
    ds_read_b128 v[120:123], v67 offset:8192
    ds_read_b128 v[124:127], v67 offset:8208
    ds_read_b128 v[128:131], v67 offset:16384
    ds_read_b128 v[132:135], v67 offset:16400
    ds_read_b128 v[136:139], v67 offset:24576
    ds_read_b128 v[140:143], v67 offset:24592
    s_lshl_b32 s40, s57, 12
    s_add_u32 s40, s40, 8912896
    s_waitcnt lgkmcnt(0)
    v_pk_add_f32 v[112:113], v[112:113], v[120:121]
    v_pk_add_f32 v[128:129], v[128:129], v[136:137]
    v_pk_add_f32 v[114:115], v[114:115], v[122:123]
    v_pk_add_f32 v[130:131], v[130:131], v[138:139]
    v_pk_add_f32 v[116:117], v[116:117], v[124:125]
    v_pk_add_f32 v[132:133], v[132:133], v[140:141]
    v_pk_add_f32 v[118:119], v[118:119], v[126:127]
    v_pk_add_f32 v[134:135], v[134:135], v[142:143]
    v_pk_add_f32 v[112:113], v[112:113], v[128:129]
    v_pk_add_f32 v[114:115], v[114:115], v[130:131]
    v_pk_add_f32 v[116:117], v[116:117], v[132:133]
    v_pk_add_f32 v[118:119], v[118:119], v[134:135]
    v_cvt_pk_bf16_f32 v184, v112, v113
    v_cvt_pk_bf16_f32 v185, v114, v115
    v_cvt_pk_bf16_f32 v186, v116, v117
    v_cvt_pk_bf16_f32 v187, v118, v119
    buffer_store_dwordx4 v[184:187], v2, s[8:11], s40 offen sc1
    s_nop 1
    s_waitcnt vmcnt(0)
    v_cmp_ne_u32 vcc, 0, v0
    s_nop 1
    v_cndmask_b32 v24, 0, v24, vcc
    v_cndmask_b32 v25, 0, v25, vcc
    v_cndmask_b32 v26, 0, v26, vcc
    v_cndmask_b32 v27, 0, v27, vcc
    v_alignbit_b32 v176, v25, v24, 16
    v_alignbit_b32 v177, v26, v25, 16
    v_alignbit_b32 v178, v27, v26, 16
    v_alignbit_b32 v179, v28, v27, 16
    v_alignbit_b32 v180, v29, v28, 16
    v_alignbit_b32 v181, v30, v29, 16
    v_alignbit_b32 v182, v31, v30, 16
    ds_write_b128 v56, v[176:179] offset:0
    v_mov_b32 v184, v25
    v_mov_b32 v185, v26
    v_mov_b32 v186, v27
    v_mov_b32 v187, v28
    ds_write_b128 v56, v[184:187] offset:4160
    s_nop 1
    v_mov_b32 v184, v177
    v_mov_b32 v185, v178
    v_mov_b32 v186, v179
    v_mov_b32 v187, v180
    ds_write_b128 v56, v[184:187] offset:8320
    s_nop 1
    ds_write_b128 v56, v[26:29] offset:12480
    ds_write_b128 v56, v[178:181] offset:16640
    v_mov_b32 v184, v27
    v_mov_b32 v185, v28
    v_mov_b32 v186, v29
    v_mov_b32 v187, v30
    ds_write_b128 v56, v[184:187] offset:20800
    s_nop 1
    v_mov_b32 v184, v179
    v_mov_b32 v185, v180
    v_mov_b32 v186, v181
    v_mov_b32 v187, v182
    ds_write_b128 v56, v[184:187] offset:24960
    s_nop 1
    ds_write_b128 v56, v[28:31] offset:29120
    ds_write_b128 v57, v[40:43]
    v_lshlrev_b32 v3, 16, v46
    v_or_b32 v3, v3, v46
    v_and_b32 v188, v60, v3
    v_and_b32 v189, v61, v3
    v_and_b32 v190, v62, v3
    v_and_b32 v191, v63, v3
    s_waitcnt lgkmcnt(0)
    s_barrier
    s_bitcmp1_b32 s2, 0
    s_cbranch_scc1 c_halfB_21
    s_cmp_lg_u32 s34, 0
    s_cbranch_scc1 c_pw_24
    ds_read_b128 v[100:103], v58 offset:0
    ds_read_b128 v[112:115], v59 offset:480
    ds_read_b128 v[116:119], v59 offset:992
    ds_read_b128 v[120:123], v59 offset:1504
    ds_read_b128 v[124:127], v59 offset:2016
    ds_read_b128 v[128:131], v59 offset:2528
    ds_read_b128 v[132:135], v59 offset:3040
    ds_read_b128 v[136:139], v59 offset:3552
    ds_read_b128 v[140:143], v59 offset:4064
    ds_read_b128 v[104:107], v58 offset:512
    ds_read_b128 v[108:111], v58 offset:1024
    s_waitcnt lgkmcnt(2)
    v_mfma_f32_16x16x32_bf16 v[96:99], v[100:103], v[140:143], 0
    v_mfma_f32_16x16x32_bf16 v[92:95], v[100:103], v[136:139], 0
    v_mfma_f32_16x16x32_bf16 v[76:79], v[100:103], v[120:123], 0
    v_mfma_f32_16x16x32_bf16 v[76:79], v[188:191], v[120:123], v[76:79]
    v_mfma_f32_16x16x32_bf16 v[92:95], v[188:191], v[136:139], v[92:95]
    v_mfma_f32_16x16x32_bf16 v[96:99], v[188:191], v[140:143], v[96:99]
    ds_read_b128 v[100:103], v58 offset:1536
    s_waitcnt lgkmcnt(2)
    v_mfma_f32_16x16x32_bf16 v[96:99], v[104:107], v[136:139], v[96:99]
    v_mfma_f32_16x16x32_bf16 v[92:95], v[104:107], v[132:135], v[92:95]
    v_mfma_f32_16x16x32_bf16 v[76:79], v[104:107], v[116:119], v[76:79]
    ds_read_b128 v[104:107], v58 offset:2048
    ds_read_b128 v[144:147], v59 offset:416
    ds_read_b128 v[148:151], v59 offset:928
    ds_read_b128 v[152:155], v59 offset:1440
    ds_read_b128 v[156:159], v59 offset:1952
    ds_read_b128 v[160:163], v59 offset:2464
    ds_read_b128 v[164:167], v59 offset:2976
    ds_read_b128 v[168:171], v59 offset:3488
    ds_read_b128 v[172:175], v59 offset:4000
    s_waitcnt lgkmcnt(10)
    v_mfma_f32_16x16x32_bf16 v[96:99], v[108:111], v[132:135], v[96:99]
    v_mfma_f32_16x16x32_bf16 v[92:95], v[108:111], v[128:131], v[92:95]
    v_mfma_f32_16x16x32_bf16 v[76:79], v[108:111], v[112:115], v[76:79]
    ds_read_b128 v[108:111], v58 offset:2560
    s_waitcnt lgkmcnt(10)
    v_mfma_f32_16x16x32_bf16 v[96:99], v[100:103], v[128:131], v[96:99]
    v_mfma_f32_16x16x32_bf16 v[92:95], v[100:103], v[124:127], v[92:95]
    ds_read_b128 v[100:103], v58 offset:3072
    s_waitcnt lgkmcnt(10)
    v_mfma_f32_16x16x32_bf16 v[96:99], v[104:107], v[124:127], v[96:99]
    v_mfma_f32_16x16x32_bf16 v[92:95], v[104:107], v[120:123], v[92:95]
    ds_read_b128 v[104:107], v58 offset:3584
    s_waitcnt lgkmcnt(2)
    v_mfma_f32_16x16x32_bf16 v[96:99], v[108:111], v[120:123], v[96:99]
    v_mfma_f32_16x16x32_bf16 v[92:95], v[108:111], v[116:119], v[92:95]
    ds_read_b128 v[108:111], v58 offset:64
    s_waitcnt lgkmcnt(2)
    v_mfma_f32_16x16x32_bf16 v[96:99], v[100:103], v[116:119], v[96:99]
    v_mfma_f32_16x16x32_bf16 v[92:95], v[100:103], v[112:115], v[92:95]
    ds_read_b128 v[100:103], v58 offset:576
    s_waitcnt lgkmcnt(2)
    v_mfma_f32_16x16x32_bf16 v[96:99], v[104:107], v[112:115], v[96:99]
    ds_read_b128 v[104:107], v58 offset:1088
    s_waitcnt lgkmcnt(2)
    v_mfma_f32_16x16x32_bf16 v[96:99], v[108:111], v[172:175], v[96:99]
    v_mfma_f32_16x16x32_bf16 v[92:95], v[108:111], v[168:171], v[92:95]
    v_mfma_f32_16x16x32_bf16 v[76:79], v[108:111], v[152:155], v[76:79]
    ds_read_b128 v[108:111], v58 offset:1600
    s_waitcnt lgkmcnt(2)
    v_mfma_f32_16x16x32_bf16 v[96:99], v[100:103], v[168:171], v[96:99]
    v_mfma_f32_16x16x32_bf16 v[92:95], v[100:103], v[164:167], v[92:95]
    v_mfma_f32_16x16x32_bf16 v[76:79], v[100:103], v[148:151], v[76:79]
    ds_read_b128 v[100:103], v58 offset:2112
    s_waitcnt lgkmcnt(2)
    v_mfma_f32_16x16x32_bf16 v[96:99], v[104:107], v[164:167], v[96:99]
    v_mfma_f32_16x16x32_bf16 v[92:95], v[104:107], v[160:163], v[92:95]
    v_mfma_f32_16x16x32_bf16 v[76:79], v[104:107], v[144:147], v[76:79]
    ds_read_b128 v[104:107], v58 offset:2624
    s_waitcnt lgkmcnt(2)
    v_mfma_f32_16x16x32_bf16 v[96:99], v[108:111], v[160:163], v[96:99]
    v_mfma_f32_16x16x32_bf16 v[92:95], v[108:111], v[156:159], v[92:95]
    ds_read_b128 v[108:111], v58 offset:3136
    s_waitcnt lgkmcnt(2)
    v_mfma_f32_16x16x32_bf16 v[96:99], v[100:103], v[156:159], v[96:99]
    v_mfma_f32_16x16x32_bf16 v[92:95], v[100:103], v[152:155], v[92:95]
    ds_read_b128 v[100:103], v58 offset:3648
    s_waitcnt lgkmcnt(2)
    v_mfma_f32_16x16x32_bf16 v[96:99], v[104:107], v[152:155], v[96:99]
    v_mfma_f32_16x16x32_bf16 v[92:95], v[104:107], v[148:151], v[92:95]
    s_waitcnt lgkmcnt(1)
    v_mfma_f32_16x16x32_bf16 v[96:99], v[108:111], v[148:151], v[96:99]
    v_mfma_f32_16x16x32_bf16 v[92:95], v[108:111], v[144:147], v[92:95]
    s_waitcnt lgkmcnt(0)
    v_mfma_f32_16x16x32_bf16 v[96:99], v[100:103], v[144:147], v[96:99]
    ds_write_b128 v66, v[76:79] offset:2048
    s_nop 4
    ds_write_b128 v66, v[92:95] offset:6144
    s_nop 0
    ds_write_b128 v66, v[96:99] offset:7168
    s_branch c_pw_end_23
c_pw_24:
    s_cmp_lg_u32 s34, 1
    s_cbranch_scc1 c_pw_25
    ds_read_b128 v[100:103], v58 offset:128
    ds_read_b128 v[112:115], v59 offset:352
    ds_read_b128 v[116:119], v59 offset:864
    ds_read_b128 v[120:123], v59 offset:1376
    ds_read_b128 v[124:127], v59 offset:1888
    ds_read_b128 v[128:131], v59 offset:2400
    ds_read_b128 v[132:135], v59 offset:2912
    ds_read_b128 v[136:139], v59 offset:3424
    ds_read_b128 v[140:143], v59 offset:3936
    ds_read_b128 v[104:107], v58 offset:640
    ds_read_b128 v[108:111], v58 offset:1152
    s_waitcnt lgkmcnt(2)
    v_mfma_f32_16x16x32_bf16 v[96:99], v[100:103], v[140:143], 0
    v_mfma_f32_16x16x32_bf16 v[92:95], v[100:103], v[136:139], 0
    v_mfma_f32_16x16x32_bf16 v[76:79], v[100:103], v[120:123], 0
    ds_read_b128 v[100:103], v58 offset:1664
    s_waitcnt lgkmcnt(2)
    v_mfma_f32_16x16x32_bf16 v[96:99], v[104:107], v[136:139], v[96:99]
    v_mfma_f32_16x16x32_bf16 v[92:95], v[104:107], v[132:135], v[92:95]
    v_mfma_f32_16x16x32_bf16 v[76:79], v[104:107], v[116:119], v[76:79]
    ds_read_b128 v[104:107], v58 offset:2176
    ds_read_b128 v[144:147], v59 offset:288
    ds_read_b128 v[148:151], v59 offset:800
    ds_read_b128 v[152:155], v59 offset:1312
    ds_read_b128 v[156:159], v59 offset:1824
    ds_read_b128 v[160:163], v59 offset:2336
    ds_read_b128 v[164:167], v59 offset:2848
    ds_read_b128 v[168:171], v59 offset:3360
    ds_read_b128 v[172:175], v59 offset:3872
    s_waitcnt lgkmcnt(10)
    v_mfma_f32_16x16x32_bf16 v[96:99], v[108:111], v[132:135], v[96:99]
    v_mfma_f32_16x16x32_bf16 v[92:95], v[108:111], v[128:131], v[92:95]
    v_mfma_f32_16x16x32_bf16 v[76:79], v[108:111], v[112:115], v[76:79]
    ds_read_b128 v[108:111], v58 offset:2688
    s_waitcnt lgkmcnt(10)
    v_mfma_f32_16x16x32_bf16 v[96:99], v[100:103], v[128:131], v[96:99]
    v_mfma_f32_16x16x32_bf16 v[92:95], v[100:103], v[124:127], v[92:95]
    ds_read_b128 v[100:103], v58 offset:3200
    s_waitcnt lgkmcnt(10)
    v_mfma_f32_16x16x32_bf16 v[96:99], v[104:107], v[124:127], v[96:99]
    v_mfma_f32_16x16x32_bf16 v[92:95], v[104:107], v[120:123], v[92:95]
    ds_read_b128 v[104:107], v58 offset:3712
    s_waitcnt lgkmcnt(2)
    v_mfma_f32_16x16x32_bf16 v[96:99], v[108:111], v[120:123], v[96:99]
    v_mfma_f32_16x16x32_bf16 v[92:95], v[108:111], v[116:119], v[92:95]
    ds_read_b128 v[108:111], v58 offset:192
    s_waitcnt lgkmcnt(2)
    v_mfma_f32_16x16x32_bf16 v[96:99], v[100:103], v[116:119], v[96:99]
    v_mfma_f32_16x16x32_bf16 v[92:95], v[100:103], v[112:115], v[92:95]
    ds_read_b128 v[100:103], v58 offset:704
    s_waitcnt lgkmcnt(2)
    v_mfma_f32_16x16x32_bf16 v[96:99], v[104:107], v[112:115], v[96:99]
    ds_read_b128 v[104:107], v58 offset:1216
    s_waitcnt lgkmcnt(2)
    v_mfma_f32_16x16x32_bf16 v[96:99], v[108:111], v[172:175], v[96:99]
    v_mfma_f32_16x16x32_bf16 v[92:95], v[108:111], v[168:171], v[92:95]
    v_mfma_f32_16x16x32_bf16 v[76:79], v[108:111], v[152:155], v[76:79]
    ds_read_b128 v[108:111], v58 offset:1728
    s_waitcnt lgkmcnt(2)
    v_mfma_f32_16x16x32_bf16 v[96:99], v[100:103], v[168:171], v[96:99]
    v_mfma_f32_16x16x32_bf16 v[92:95], v[100:103], v[164:167], v[92:95]
    v_mfma_f32_16x16x32_bf16 v[76:79], v[100:103], v[148:151], v[76:79]
    ds_read_b128 v[100:103], v58 offset:2240
    s_waitcnt lgkmcnt(2)
    v_mfma_f32_16x16x32_bf16 v[96:99], v[104:107], v[164:167], v[96:99]
    v_mfma_f32_16x16x32_bf16 v[92:95], v[104:107], v[160:163], v[92:95]
    v_mfma_f32_16x16x32_bf16 v[76:79], v[104:107], v[144:147], v[76:79]
    ds_read_b128 v[104:107], v58 offset:2752
    s_waitcnt lgkmcnt(2)
    v_mfma_f32_16x16x32_bf16 v[96:99], v[108:111], v[160:163], v[96:99]
    v_mfma_f32_16x16x32_bf16 v[92:95], v[108:111], v[156:159], v[92:95]
    ds_read_b128 v[108:111], v58 offset:3264
    s_waitcnt lgkmcnt(2)
    v_mfma_f32_16x16x32_bf16 v[96:99], v[100:103], v[156:159], v[96:99]
    v_mfma_f32_16x16x32_bf16 v[92:95], v[100:103], v[152:155], v[92:95]
    ds_read_b128 v[100:103], v58 offset:3776
    s_waitcnt lgkmcnt(2)
    v_mfma_f32_16x16x32_bf16 v[96:99], v[104:107], v[152:155], v[96:99]
    v_mfma_f32_16x16x32_bf16 v[92:95], v[104:107], v[148:151], v[92:95]
    s_waitcnt lgkmcnt(1)
    v_mfma_f32_16x16x32_bf16 v[96:99], v[108:111], v[148:151], v[96:99]
    v_mfma_f32_16x16x32_bf16 v[92:95], v[108:111], v[144:147], v[92:95]
    s_waitcnt lgkmcnt(0)
    v_mfma_f32_16x16x32_bf16 v[96:99], v[100:103], v[144:147], v[96:99]
    ds_write_b128 v66, v[76:79] offset:2048
    s_nop 4
    ds_write_b128 v66, v[92:95] offset:6144
    s_nop 0
    ds_write_b128 v66, v[96:99] offset:7168
    s_branch c_pw_end_23
c_pw_25:
    s_cmp_lg_u32 s34, 2
    s_cbranch_scc1 c_pw_26
    ds_read_b128 v[100:103], v58 offset:256
    ds_read_b128 v[112:115], v59 offset:224
    ds_read_b128 v[116:119], v59 offset:736
    ds_read_b128 v[120:123], v59 offset:1248
    ds_read_b128 v[124:127], v59 offset:1760
    ds_read_b128 v[128:131], v59 offset:2272
    ds_read_b128 v[132:135], v59 offset:2784
    ds_read_b128 v[136:139], v59 offset:3296
    ds_read_b128 v[140:143], v59 offset:3808
    ds_read_b128 v[104:107], v58 offset:768
    ds_read_b128 v[108:111], v58 offset:1280
    s_waitcnt lgkmcnt(2)
    v_mfma_f32_16x16x32_bf16 v[96:99], v[100:103], v[140:143], 0
    v_mfma_f32_16x16x32_bf16 v[92:95], v[100:103], v[136:139], 0
    v_mfma_f32_16x16x32_bf16 v[76:79], v[100:103], v[120:123], 0
    ds_read_b128 v[100:103], v58 offset:1792
    s_waitcnt lgkmcnt(2)
    v_mfma_f32_16x16x32_bf16 v[96:99], v[104:107], v[136:139], v[96:99]
    v_mfma_f32_16x16x32_bf16 v[92:95], v[104:107], v[132:135], v[92:95]
    v_mfma_f32_16x16x32_bf16 v[76:79], v[104:107], v[116:119], v[76:79]
    ds_read_b128 v[104:107], v58 offset:2304
    ds_read_b128 v[144:147], v59 offset:160
    ds_read_b128 v[148:151], v59 offset:672
    ds_read_b128 v[152:155], v59 offset:1184
    ds_read_b128 v[156:159], v59 offset:1696
    ds_read_b128 v[160:163], v59 offset:2208
    ds_read_b128 v[164:167], v59 offset:2720
    ds_read_b128 v[168:171], v59 offset:3232
    ds_read_b128 v[172:175], v59 offset:3744
    s_waitcnt lgkmcnt(10)
    v_mfma_f32_16x16x32_bf16 v[96:99], v[108:111], v[132:135], v[96:99]
    v_mfma_f32_16x16x32_bf16 v[92:95], v[108:111], v[128:131], v[92:95]
    v_mfma_f32_16x16x32_bf16 v[76:79], v[108:111], v[112:115], v[76:79]
    ds_read_b128 v[108:111], v58 offset:2816
    s_waitcnt lgkmcnt(10)
    v_mfma_f32_16x16x32_bf16 v[96:99], v[100:103], v[128:131], v[96:99]
    v_mfma_f32_16x16x32_bf16 v[92:95], v[100:103], v[124:127], v[92:95]
    ds_read_b128 v[100:103], v58 offset:3328
    s_waitcnt lgkmcnt(10)
    v_mfma_f32_16x16x32_bf16 v[96:99], v[104:107], v[124:127], v[96:99]
    v_mfma_f32_16x16x32_bf16 v[92:95], v[104:107], v[120:123], v[92:95]
    ds_read_b128 v[104:107], v58 offset:3840
    s_waitcnt lgkmcnt(2)
    v_mfma_f32_16x16x32_bf16 v[96:99], v[108:111], v[120:123], v[96:99]
    v_mfma_f32_16x16x32_bf16 v[92:95], v[108:111], v[116:119], v[92:95]
    ds_read_b128 v[108:111], v58 offset:320
    s_waitcnt lgkmcnt(2)
    v_mfma_f32_16x16x32_bf16 v[96:99], v[100:103], v[116:119], v[96:99]
    v_mfma_f32_16x16x32_bf16 v[92:95], v[100:103], v[112:115], v[92:95]
    ds_read_b128 v[100:103], v58 offset:832
    s_waitcnt lgkmcnt(2)
    v_mfma_f32_16x16x32_bf16 v[96:99], v[104:107], v[112:115], v[96:99]
    ds_read_b128 v[104:107], v58 offset:1344
    s_waitcnt lgkmcnt(2)
    v_mfma_f32_16x16x32_bf16 v[96:99], v[108:111], v[172:175], v[96:99]
    v_mfma_f32_16x16x32_bf16 v[92:95], v[108:111], v[168:171], v[92:95]
    v_mfma_f32_16x16x32_bf16 v[76:79], v[108:111], v[152:155], v[76:79]
    ds_read_b128 v[108:111], v58 offset:1856
    s_waitcnt lgkmcnt(2)
    v_mfma_f32_16x16x32_bf16 v[96:99], v[100:103], v[168:171], v[96:99]
    v_mfma_f32_16x16x32_bf16 v[92:95], v[100:103], v[164:167], v[92:95]
    v_mfma_f32_16x16x32_bf16 v[76:79], v[100:103], v[148:151], v[76:79]
    ds_read_b128 v[100:103], v58 offset:2368
    s_waitcnt lgkmcnt(2)
    v_mfma_f32_16x16x32_bf16 v[96:99], v[104:107], v[164:167], v[96:99]
    v_mfma_f32_16x16x32_bf16 v[92:95], v[104:107], v[160:163], v[92:95]
    v_mfma_f32_16x16x32_bf16 v[76:79], v[104:107], v[144:147], v[76:79]
    ds_read_b128 v[104:107], v58 offset:2880
    s_waitcnt lgkmcnt(2)
    v_mfma_f32_16x16x32_bf16 v[96:99], v[108:111], v[160:163], v[96:99]
    v_mfma_f32_16x16x32_bf16 v[92:95], v[108:111], v[156:159], v[92:95]
    ds_read_b128 v[108:111], v58 offset:3392
    s_waitcnt lgkmcnt(2)
    v_mfma_f32_16x16x32_bf16 v[96:99], v[100:103], v[156:159], v[96:99]
    v_mfma_f32_16x16x32_bf16 v[92:95], v[100:103], v[152:155], v[92:95]
    ds_read_b128 v[100:103], v58 offset:3904
    s_waitcnt lgkmcnt(2)
    v_mfma_f32_16x16x32_bf16 v[96:99], v[104:107], v[152:155], v[96:99]
    v_mfma_f32_16x16x32_bf16 v[92:95], v[104:107], v[148:151], v[92:95]
    s_waitcnt lgkmcnt(1)
    v_mfma_f32_16x16x32_bf16 v[96:99], v[108:111], v[148:151], v[96:99]
    v_mfma_f32_16x16x32_bf16 v[92:95], v[108:111], v[144:147], v[92:95]
    s_waitcnt lgkmcnt(0)
    v_mfma_f32_16x16x32_bf16 v[96:99], v[100:103], v[144:147], v[96:99]
    ds_write_b128 v66, v[76:79] offset:2048
    s_nop 4
    ds_write_b128 v66, v[92:95] offset:6144
    s_nop 0
    ds_write_b128 v66, v[96:99] offset:7168
    s_branch c_pw_end_23
c_pw_26:
    ds_read_b128 v[100:103], v58 offset:384
    ds_read_b128 v[112:115], v59 offset:96
    ds_read_b128 v[116:119], v59 offset:608
    ds_read_b128 v[120:123], v59 offset:1120
    ds_read_b128 v[124:127], v59 offset:1632
    ds_read_b128 v[128:131], v59 offset:2144
    ds_read_b128 v[132:135], v59 offset:2656
    ds_read_b128 v[136:139], v59 offset:3168
    ds_read_b128 v[140:143], v59 offset:3680
    ds_read_b128 v[104:107], v58 offset:896
    ds_read_b128 v[108:111], v58 offset:1408
    s_waitcnt lgkmcnt(2)
    v_mfma_f32_16x16x32_bf16 v[96:99], v[100:103], v[140:143], 0
    v_mfma_f32_16x16x32_bf16 v[92:95], v[100:103], v[136:139], 0
    v_mfma_f32_16x16x32_bf16 v[76:79], v[100:103], v[120:123], 0
    ds_read_b128 v[100:103], v58 offset:1920
    s_waitcnt lgkmcnt(2)
    v_mfma_f32_16x16x32_bf16 v[96:99], v[104:107], v[136:139], v[96:99]
    v_mfma_f32_16x16x32_bf16 v[92:95], v[104:107], v[132:135], v[92:95]
    v_mfma_f32_16x16x32_bf16 v[76:79], v[104:107], v[116:119], v[76:79]
    ds_read_b128 v[104:107], v58 offset:2432
    ds_read_b128 v[144:147], v59 offset:32
    ds_read_b128 v[148:151], v59 offset:544
    ds_read_b128 v[152:155], v59 offset:1056
    ds_read_b128 v[156:159], v59 offset:1568
    ds_read_b128 v[160:163], v59 offset:2080
    ds_read_b128 v[164:167], v59 offset:2592
    ds_read_b128 v[168:171], v59 offset:3104
    ds_read_b128 v[172:175], v59 offset:3616
    s_waitcnt lgkmcnt(10)
    v_mfma_f32_16x16x32_bf16 v[96:99], v[108:111], v[132:135], v[96:99]
    v_mfma_f32_16x16x32_bf16 v[92:95], v[108:111], v[128:131], v[92:95]
    v_mfma_f32_16x16x32_bf16 v[76:79], v[108:111], v[112:115], v[76:79]
    ds_read_b128 v[108:111], v58 offset:2944
    s_waitcnt lgkmcnt(10)
    v_mfma_f32_16x16x32_bf16 v[96:99], v[100:103], v[128:131], v[96:99]
    v_mfma_f32_16x16x32_bf16 v[92:95], v[100:103], v[124:127], v[92:95]
    ds_read_b128 v[100:103], v58 offset:3456
    s_waitcnt lgkmcnt(10)
    v_mfma_f32_16x16x32_bf16 v[96:99], v[104:107], v[124:127], v[96:99]
    v_mfma_f32_16x16x32_bf16 v[92:95], v[104:107], v[120:123], v[92:95]
    ds_read_b128 v[104:107], v58 offset:3968
    s_waitcnt lgkmcnt(2)
    v_mfma_f32_16x16x32_bf16 v[96:99], v[108:111], v[120:123], v[96:99]
    v_mfma_f32_16x16x32_bf16 v[92:95], v[108:111], v[116:119], v[92:95]
    ds_read_b128 v[108:111], v58 offset:448
    s_waitcnt lgkmcnt(2)
    v_mfma_f32_16x16x32_bf16 v[96:99], v[100:103], v[116:119], v[96:99]
    v_mfma_f32_16x16x32_bf16 v[92:95], v[100:103], v[112:115], v[92:95]
    ds_read_b128 v[100:103], v58 offset:960
    s_waitcnt lgkmcnt(2)
    v_mfma_f32_16x16x32_bf16 v[96:99], v[104:107], v[112:115], v[96:99]
    ds_read_b128 v[104:107], v58 offset:1472
    s_waitcnt lgkmcnt(2)
    v_mfma_f32_16x16x32_bf16 v[96:99], v[108:111], v[172:175], v[96:99]
    v_mfma_f32_16x16x32_bf16 v[92:95], v[108:111], v[168:171], v[92:95]
    v_mfma_f32_16x16x32_bf16 v[76:79], v[108:111], v[152:155], v[76:79]
    ds_read_b128 v[108:111], v58 offset:1984
    s_waitcnt lgkmcnt(2)
    v_mfma_f32_16x16x32_bf16 v[96:99], v[100:103], v[168:171], v[96:99]
    v_mfma_f32_16x16x32_bf16 v[92:95], v[100:103], v[164:167], v[92:95]
    v_mfma_f32_16x16x32_bf16 v[76:79], v[100:103], v[148:151], v[76:79]
    ds_read_b128 v[100:103], v58 offset:2496
    s_waitcnt lgkmcnt(2)
    v_mfma_f32_16x16x32_bf16 v[96:99], v[104:107], v[164:167], v[96:99]
    v_mfma_f32_16x16x32_bf16 v[92:95], v[104:107], v[160:163], v[92:95]
    v_mfma_f32_16x16x32_bf16 v[76:79], v[104:107], v[144:147], v[76:79]
    ds_read_b128 v[104:107], v58 offset:3008
    s_waitcnt lgkmcnt(2)
    v_mfma_f32_16x16x32_bf16 v[96:99], v[108:111], v[160:163], v[96:99]
    v_mfma_f32_16x16x32_bf16 v[92:95], v[108:111], v[156:159], v[92:95]
    ds_read_b128 v[108:111], v58 offset:3520
    s_waitcnt lgkmcnt(2)
    v_mfma_f32_16x16x32_bf16 v[96:99], v[100:103], v[156:159], v[96:99]
    v_mfma_f32_16x16x32_bf16 v[92:95], v[100:103], v[152:155], v[92:95]
    ds_read_b128 v[100:103], v58 offset:4032
    s_waitcnt lgkmcnt(2)
    v_mfma_f32_16x16x32_bf16 v[96:99], v[104:107], v[152:155], v[96:99]
    v_mfma_f32_16x16x32_bf16 v[92:95], v[104:107], v[148:151], v[92:95]
    s_waitcnt lgkmcnt(1)
    v_mfma_f32_16x16x32_bf16 v[96:99], v[108:111], v[148:151], v[96:99]
    v_mfma_f32_16x16x32_bf16 v[92:95], v[108:111], v[144:147], v[92:95]
    s_waitcnt lgkmcnt(0)
    v_mfma_f32_16x16x32_bf16 v[96:99], v[100:103], v[144:147], v[96:99]
    ds_write_b128 v66, v[76:79] offset:2048
    s_nop 4
    ds_write_b128 v66, v[92:95] offset:6144
    s_nop 0
    ds_write_b128 v66, v[96:99] offset:7168
c_pw_end_23:
    s_waitcnt lgkmcnt(0)
    s_barrier
    s_mov_b64 exec, 0
    s_cmp_eq_u32 s34, 0
    s_cselect_b32 exec_lo, 0, exec_lo
    s_cselect_b32 exec_hi, 0, exec_hi
    s_cmp_eq_u32 s34, 1
    s_cselect_b32 exec_lo, -1, exec_lo
    s_cselect_b32 exec_hi, 0, exec_hi
    s_cmp_eq_u32 s34, 2
    s_cselect_b32 exec_lo, 0, exec_lo
    s_cselect_b32 exec_hi, 0, exec_hi
    s_cmp_eq_u32 s34, 3
    s_cselect_b32 exec_lo, -1, exec_lo
    s_cselect_b32 exec_hi, -1, exec_hi
    s_cbranch_execz c_fskip_29
    ds_read_b128 v[112:115], v67 offset:0
    ds_read_b128 v[116:119], v67 offset:16
    ds_read_b128 v[120:123], v67 offset:8192
    ds_read_b128 v[124:127], v67 offset:8208
    ds_read_b128 v[128:131], v67 offset:16384
    ds_read_b128 v[132:135], v67 offset:16400
    ds_read_b128 v[136:139], v67 offset:24576
    ds_read_b128 v[140:143], v67 offset:24592
    s_lshl_b32 s40, s58, 12
    s_add_u32 s40, s40, 8912896
    s_waitcnt lgkmcnt(0)
    v_pk_add_f32 v[112:113], v[112:113], v[120:121]
    v_pk_add_f32 v[128:129], v[128:129], v[136:137]
    v_pk_add_f32 v[114:115], v[114:115], v[122:123]
    v_pk_add_f32 v[130:131], v[130:131], v[138:139]
    v_pk_add_f32 v[116:117], v[116:117], v[124:125]
    v_pk_add_f32 v[132:133], v[132:133], v[140:141]
    v_pk_add_f32 v[118:119], v[118:119], v[126:127]
    v_pk_add_f32 v[134:135], v[134:135], v[142:143]
    v_pk_add_f32 v[112:113], v[112:113], v[128:129]
    v_pk_add_f32 v[114:115], v[114:115], v[130:131]
    v_pk_add_f32 v[116:117], v[116:117], v[132:133]
    v_pk_add_f32 v[118:119], v[118:119], v[134:135]
    v_cvt_pk_bf16_f32 v184, v112, v113
    v_cvt_pk_bf16_f32 v185, v114, v115
    v_cvt_pk_bf16_f32 v186, v116, v117
    v_cvt_pk_bf16_f32 v187, v118, v119
    buffer_store_dwordx4 v[184:187], v2, s[8:11], s40 offen sc1
c_fskip_29:
    s_mov_b64 exec, -1
    s_nop 1
    s_branch c_halfE_22
c_halfB_21:
    s_cmp_lg_u32 s34, 0
    s_cbranch_scc1 c_pw_31
    ds_read_b128 v[100:103], v58 offset:0
    ds_read_b128 v[112:115], v59 offset:480
    ds_read_b128 v[116:119], v59 offset:992
    ds_read_b128 v[120:123], v59 offset:1504
    ds_read_b128 v[124:127], v59 offset:2016
    ds_read_b128 v[128:131], v59 offset:2528
    ds_read_b128 v[132:135], v59 offset:3040
    ds_read_b128 v[104:107], v58 offset:512
    ds_read_b128 v[108:111], v58 offset:1024
    s_waitcnt lgkmcnt(2)
    v_mfma_f32_16x16x32_bf16 v[88:91], v[100:103], v[132:135], 0
    v_mfma_f32_16x16x32_bf16 v[84:87], v[100:103], v[128:131], 0
    v_mfma_f32_16x16x32_bf16 v[80:83], v[100:103], v[124:127], 0
    v_mfma_f32_16x16x32_bf16 v[72:75], v[100:103], v[116:119], 0
    v_mfma_f32_16x16x32_bf16 v[68:71], v[100:103], v[112:115], 0
    v_mfma_f32_16x16x32_bf16 v[68:71], v[188:191], v[112:115], v[68:71]
    v_mfma_f32_16x16x32_bf16 v[72:75], v[188:191], v[116:119], v[72:75]
    v_mfma_f32_16x16x32_bf16 v[80:83], v[188:191], v[124:127], v[80:83]
    v_mfma_f32_16x16x32_bf16 v[84:87], v[188:191], v[128:131], v[84:87]
    v_mfma_f32_16x16x32_bf16 v[88:91], v[188:191], v[132:135], v[88:91]
    ds_read_b128 v[100:103], v58 offset:1536
    s_waitcnt lgkmcnt(2)
    v_mfma_f32_16x16x32_bf16 v[88:91], v[104:107], v[128:131], v[88:91]
    v_mfma_f32_16x16x32_bf16 v[84:87], v[104:107], v[124:127], v[84:87]
    v_mfma_f32_16x16x32_bf16 v[80:83], v[104:107], v[120:123], v[80:83]
    v_mfma_f32_16x16x32_bf16 v[72:75], v[104:107], v[112:115], v[72:75]
    ds_read_b128 v[104:107], v58 offset:2048
    ds_read_b128 v[144:147], v59 offset:416
    ds_read_b128 v[148:151], v59 offset:928
    ds_read_b128 v[152:155], v59 offset:1440
    ds_read_b128 v[156:159], v59 offset:1952
    ds_read_b128 v[160:163], v59 offset:2464
    ds_read_b128 v[164:167], v59 offset:2976
    s_waitcnt lgkmcnt(8)
    v_mfma_f32_16x16x32_bf16 v[88:91], v[108:111], v[124:127], v[88:91]
    v_mfma_f32_16x16x32_bf16 v[84:87], v[108:111], v[120:123], v[84:87]
    v_mfma_f32_16x16x32_bf16 v[80:83], v[108:111], v[116:119], v[80:83]
    ds_read_b128 v[108:111], v58 offset:2560
    s_waitcnt lgkmcnt(8)
    v_mfma_f32_16x16x32_bf16 v[88:91], v[100:103], v[120:123], v[88:91]
    v_mfma_f32_16x16x32_bf16 v[84:87], v[100:103], v[116:119], v[84:87]
    v_mfma_f32_16x16x32_bf16 v[80:83], v[100:103], v[112:115], v[80:83]
    ds_read_b128 v[100:103], v58 offset:64
    s_waitcnt lgkmcnt(8)
    v_mfma_f32_16x16x32_bf16 v[88:91], v[104:107], v[116:119], v[88:91]
    v_mfma_f32_16x16x32_bf16 v[84:87], v[104:107], v[112:115], v[84:87]
    ds_read_b128 v[104:107], v58 offset:576
    s_waitcnt lgkmcnt(2)
    v_mfma_f32_16x16x32_bf16 v[88:91], v[108:111], v[112:115], v[88:91]
    ds_read_b128 v[108:111], v58 offset:1088
    s_waitcnt lgkmcnt(2)
    v_mfma_f32_16x16x32_bf16 v[88:91], v[100:103], v[164:167], v[88:91]
    v_mfma_f32_16x16x32_bf16 v[84:87], v[100:103], v[160:163], v[84:87]
    v_mfma_f32_16x16x32_bf16 v[80:83], v[100:103], v[156:159], v[80:83]
    v_mfma_f32_16x16x32_bf16 v[72:75], v[100:103], v[148:151], v[72:75]
    v_mfma_f32_16x16x32_bf16 v[68:71], v[100:103], v[144:147], v[68:71]
    ds_read_b128 v[100:103], v58 offset:1600
    s_waitcnt lgkmcnt(2)
    v_mfma_f32_16x16x32_bf16 v[88:91], v[104:107], v[160:163], v[88:91]
    v_mfma_f32_16x16x32_bf16 v[84:87], v[104:107], v[156:159], v[84:87]
    v_mfma_f32_16x16x32_bf16 v[80:83], v[104:107], v[152:155], v[80:83]
    v_mfma_f32_16x16x32_bf16 v[72:75], v[104:107], v[144:147], v[72:75]
    ds_read_b128 v[104:107], v58 offset:2112
    s_waitcnt lgkmcnt(2)
    v_mfma_f32_16x16x32_bf16 v[88:91], v[108:111], v[156:159], v[88:91]
    v_mfma_f32_16x16x32_bf16 v[84:87], v[108:111], v[152:155], v[84:87]
    v_mfma_f32_16x16x32_bf16 v[80:83], v[108:111], v[148:151], v[80:83]
    ds_read_b128 v[108:111], v58 offset:2624
    s_waitcnt lgkmcnt(2)
    v_mfma_f32_16x16x32_bf16 v[88:91], v[100:103], v[152:155], v[88:91]
    v_mfma_f32_16x16x32_bf16 v[84:87], v[100:103], v[148:151], v[84:87]
    v_mfma_f32_16x16x32_bf16 v[80:83], v[100:103], v[144:147], v[80:83]
    s_waitcnt lgkmcnt(1)
    v_mfma_f32_16x16x32_bf16 v[88:91], v[104:107], v[148:151], v[88:91]
    v_mfma_f32_16x16x32_bf16 v[84:87], v[104:107], v[144:147], v[84:87]
    s_waitcnt lgkmcnt(0)
    v_mfma_f32_16x16x32_bf16 v[88:91], v[108:111], v[144:147], v[88:91]
    ds_write_b128 v66, v[68:71] offset:0
    ds_write_b128 v66, v[72:75] offset:1024
    s_nop 0
    ds_write_b128 v66, v[80:83] offset:3072
    s_nop 1
    ds_write_b128 v66, v[84:87] offset:4096
    s_nop 0
    ds_write_b128 v66, v[88:91] offset:5120
    s_branch c_pw_end_30
c_pw_31:
    s_cmp_lg_u32 s34, 1
    s_cbranch_scc1 c_pw_32
    ds_read_b128 v[100:103], v58 offset:128
    ds_read_b128 v[112:115], v59 offset:352
    ds_read_b128 v[116:119], v59 offset:864
    ds_read_b128 v[120:123], v59 offset:1376
    ds_read_b128 v[124:127], v59 offset:1888
    ds_read_b128 v[128:131], v59 offset:2400
    ds_read_b128 v[132:135], v59 offset:2912
    ds_read_b128 v[104:107], v58 offset:640
    ds_read_b128 v[108:111], v58 offset:1152
    s_waitcnt lgkmcnt(2)
    v_mfma_f32_16x16x32_bf16 v[88:91], v[100:103], v[132:135], 0
    v_mfma_f32_16x16x32_bf16 v[84:87], v[100:103], v[128:131], 0
    v_mfma_f32_16x16x32_bf16 v[80:83], v[100:103], v[124:127], 0
    v_mfma_f32_16x16x32_bf16 v[72:75], v[100:103], v[116:119], 0
    v_mfma_f32_16x16x32_bf16 v[68:71], v[100:103], v[112:115], 0
    ds_read_b128 v[100:103], v58 offset:1664
    s_waitcnt lgkmcnt(2)
    v_mfma_f32_16x16x32_bf16 v[88:91], v[104:107], v[128:131], v[88:91]
    v_mfma_f32_16x16x32_bf16 v[84:87], v[104:107], v[124:127], v[84:87]
    v_mfma_f32_16x16x32_bf16 v[80:83], v[104:107], v[120:123], v[80:83]
    v_mfma_f32_16x16x32_bf16 v[72:75], v[104:107], v[112:115], v[72:75]
    ds_read_b128 v[104:107], v58 offset:2176
    ds_read_b128 v[144:147], v59 offset:288
    ds_read_b128 v[148:151], v59 offset:800
    ds_read_b128 v[152:155], v59 offset:1312
    ds_read_b128 v[156:159], v59 offset:1824
    ds_read_b128 v[160:163], v59 offset:2336
    ds_read_b128 v[164:167], v59 offset:2848
    s_waitcnt lgkmcnt(8)
    v_mfma_f32_16x16x32_bf16 v[88:91], v[108:111], v[124:127], v[88:91]
    v_mfma_f32_16x16x32_bf16 v[84:87], v[108:111], v[120:123], v[84:87]
    v_mfma_f32_16x16x32_bf16 v[80:83], v[108:111], v[116:119], v[80:83]
    ds_read_b128 v[108:111], v58 offset:2688
    s_waitcnt lgkmcnt(8)
    v_mfma_f32_16x16x32_bf16 v[88:91], v[100:103], v[120:123], v[88:91]
    v_mfma_f32_16x16x32_bf16 v[84:87], v[100:103], v[116:119], v[84:87]
    v_mfma_f32_16x16x32_bf16 v[80:83], v[100:103], v[112:115], v[80:83]
    ds_read_b128 v[100:103], v58 offset:192
    s_waitcnt lgkmcnt(8)
    v_mfma_f32_16x16x32_bf16 v[88:91], v[104:107], v[116:119], v[88:91]
    v_mfma_f32_16x16x32_bf16 v[84:87], v[104:107], v[112:115], v[84:87]
    ds_read_b128 v[104:107], v58 offset:704
    s_waitcnt lgkmcnt(2)
    v_mfma_f32_16x16x32_bf16 v[88:91], v[108:111], v[112:115], v[88:91]
    ds_read_b128 v[108:111], v58 offset:1216
    s_waitcnt lgkmcnt(2)
    v_mfma_f32_16x16x32_bf16 v[88:91], v[100:103], v[164:167], v[88:91]
    v_mfma_f32_16x16x32_bf16 v[84:87], v[100:103], v[160:163], v[84:87]
    v_mfma_f32_16x16x32_bf16 v[80:83], v[100:103], v[156:159], v[80:83]
    v_mfma_f32_16x16x32_bf16 v[72:75], v[100:103], v[148:151], v[72:75]
    v_mfma_f32_16x16x32_bf16 v[68:71], v[100:103], v[144:147], v[68:71]
    ds_read_b128 v[100:103], v58 offset:1728
    s_waitcnt lgkmcnt(2)
    v_mfma_f32_16x16x32_bf16 v[88:91], v[104:107], v[160:163], v[88:91]
    v_mfma_f32_16x16x32_bf16 v[84:87], v[104:107], v[156:159], v[84:87]
    v_mfma_f32_16x16x32_bf16 v[80:83], v[104:107], v[152:155], v[80:83]
    v_mfma_f32_16x16x32_bf16 v[72:75], v[104:107], v[144:147], v[72:75]
    ds_read_b128 v[104:107], v58 offset:2240
    s_waitcnt lgkmcnt(2)
    v_mfma_f32_16x16x32_bf16 v[88:91], v[108:111], v[156:159], v[88:91]
    v_mfma_f32_16x16x32_bf16 v[84:87], v[108:111], v[152:155], v[84:87]
    v_mfma_f32_16x16x32_bf16 v[80:83], v[108:111], v[148:151], v[80:83]
    ds_read_b128 v[108:111], v58 offset:2752
    s_waitcnt lgkmcnt(2)
    v_mfma_f32_16x16x32_bf16 v[88:91], v[100:103], v[152:155], v[88:91]
    v_mfma_f32_16x16x32_bf16 v[84:87], v[100:103], v[148:151], v[84:87]
    v_mfma_f32_16x16x32_bf16 v[80:83], v[100:103], v[144:147], v[80:83]
    s_waitcnt lgkmcnt(1)
    v_mfma_f32_16x16x32_bf16 v[88:91], v[104:107], v[148:151], v[88:91]
    v_mfma_f32_16x16x32_bf16 v[84:87], v[104:107], v[144:147], v[84:87]
    s_waitcnt lgkmcnt(0)
    v_mfma_f32_16x16x32_bf16 v[88:91], v[108:111], v[144:147], v[88:91]
    ds_write_b128 v66, v[68:71] offset:0
    ds_write_b128 v66, v[72:75] offset:1024
    s_nop 0
    ds_write_b128 v66, v[80:83] offset:3072
    s_nop 1
    ds_write_b128 v66, v[84:87] offset:4096
    s_nop 0
    ds_write_b128 v66, v[88:91] offset:5120
    s_branch c_pw_end_30
c_pw_32:
    s_cmp_lg_u32 s34, 2
    s_cbranch_scc1 c_pw_33
    ds_read_b128 v[100:103], v58 offset:256
    ds_read_b128 v[112:115], v59 offset:224
    ds_read_b128 v[116:119], v59 offset:736
    ds_read_b128 v[120:123], v59 offset:1248
    ds_read_b128 v[124:127], v59 offset:1760
    ds_read_b128 v[128:131], v59 offset:2272
    ds_read_b128 v[132:135], v59 offset:2784
    ds_read_b128 v[104:107], v58 offset:768
    ds_read_b128 v[108:111], v58 offset:1280
    s_waitcnt lgkmcnt(2)
    v_mfma_f32_16x16x32_bf16 v[88:91], v[100:103], v[132:135], 0
    v_mfma_f32_16x16x32_bf16 v[84:87], v[100:103], v[128:131], 0
    v_mfma_f32_16x16x32_bf16 v[80:83], v[100:103], v[124:127], 0
    v_mfma_f32_16x16x32_bf16 v[72:75], v[100:103], v[116:119], 0
    v_mfma_f32_16x16x32_bf16 v[68:71], v[100:103], v[112:115], 0
    ds_read_b128 v[100:103], v58 offset:1792
    s_waitcnt lgkmcnt(2)
    v_mfma_f32_16x16x32_bf16 v[88:91], v[104:107], v[128:131], v[88:91]
    v_mfma_f32_16x16x32_bf16 v[84:87], v[104:107], v[124:127], v[84:87]
    v_mfma_f32_16x16x32_bf16 v[80:83], v[104:107], v[120:123], v[80:83]
    v_mfma_f32_16x16x32_bf16 v[72:75], v[104:107], v[112:115], v[72:75]
    ds_read_b128 v[104:107], v58 offset:2304
    ds_read_b128 v[144:147], v59 offset:160
    ds_read_b128 v[148:151], v59 offset:672
    ds_read_b128 v[152:155], v59 offset:1184
    ds_read_b128 v[156:159], v59 offset:1696
    ds_read_b128 v[160:163], v59 offset:2208
    ds_read_b128 v[164:167], v59 offset:2720
    s_waitcnt lgkmcnt(8)
    v_mfma_f32_16x16x32_bf16 v[88:91], v[108:111], v[124:127], v[88:91]
    v_mfma_f32_16x16x32_bf16 v[84:87], v[108:111], v[120:123], v[84:87]
    v_mfma_f32_16x16x32_bf16 v[80:83], v[108:111], v[116:119], v[80:83]
    ds_read_b128 v[108:111], v58 offset:2816
    s_waitcnt lgkmcnt(8)
    v_mfma_f32_16x16x32_bf16 v[88:91], v[100:103], v[120:123], v[88:91]
    v_mfma_f32_16x16x32_bf16 v[84:87], v[100:103], v[116:119], v[84:87]
    v_mfma_f32_16x16x32_bf16 v[80:83], v[100:103], v[112:115], v[80:83]
    ds_read_b128 v[100:103], v58 offset:320
    s_waitcnt lgkmcnt(8)
    v_mfma_f32_16x16x32_bf16 v[88:91], v[104:107], v[116:119], v[88:91]
    v_mfma_f32_16x16x32_bf16 v[84:87], v[104:107], v[112:115], v[84:87]
    ds_read_b128 v[104:107], v58 offset:832
    s_waitcnt lgkmcnt(2)
    v_mfma_f32_16x16x32_bf16 v[88:91], v[108:111], v[112:115], v[88:91]
    ds_read_b128 v[108:111], v58 offset:1344
    s_waitcnt lgkmcnt(2)
    v_mfma_f32_16x16x32_bf16 v[88:91], v[100:103], v[164:167], v[88:91]
    v_mfma_f32_16x16x32_bf16 v[84:87], v[100:103], v[160:163], v[84:87]
    v_mfma_f32_16x16x32_bf16 v[80:83], v[100:103], v[156:159], v[80:83]
    v_mfma_f32_16x16x32_bf16 v[72:75], v[100:103], v[148:151], v[72:75]
    v_mfma_f32_16x16x32_bf16 v[68:71], v[100:103], v[144:147], v[68:71]
    ds_read_b128 v[100:103], v58 offset:1856
    s_waitcnt lgkmcnt(2)
    v_mfma_f32_16x16x32_bf16 v[88:91], v[104:107], v[160:163], v[88:91]
    v_mfma_f32_16x16x32_bf16 v[84:87], v[104:107], v[156:159], v[84:87]
    v_mfma_f32_16x16x32_bf16 v[80:83], v[104:107], v[152:155], v[80:83]
    v_mfma_f32_16x16x32_bf16 v[72:75], v[104:107], v[144:147], v[72:75]
    ds_read_b128 v[104:107], v58 offset:2368
    s_waitcnt lgkmcnt(2)
    v_mfma_f32_16x16x32_bf16 v[88:91], v[108:111], v[156:159], v[88:91]
    v_mfma_f32_16x16x32_bf16 v[84:87], v[108:111], v[152:155], v[84:87]
    v_mfma_f32_16x16x32_bf16 v[80:83], v[108:111], v[148:151], v[80:83]
    ds_read_b128 v[108:111], v58 offset:2880
    s_waitcnt lgkmcnt(2)
    v_mfma_f32_16x16x32_bf16 v[88:91], v[100:103], v[152:155], v[88:91]
    v_mfma_f32_16x16x32_bf16 v[84:87], v[100:103], v[148:151], v[84:87]
    v_mfma_f32_16x16x32_bf16 v[80:83], v[100:103], v[144:147], v[80:83]
    s_waitcnt lgkmcnt(1)
    v_mfma_f32_16x16x32_bf16 v[88:91], v[104:107], v[148:151], v[88:91]
    v_mfma_f32_16x16x32_bf16 v[84:87], v[104:107], v[144:147], v[84:87]
    s_waitcnt lgkmcnt(0)
    v_mfma_f32_16x16x32_bf16 v[88:91], v[108:111], v[144:147], v[88:91]
    ds_write_b128 v66, v[68:71] offset:0
    ds_write_b128 v66, v[72:75] offset:1024
    s_nop 0
    ds_write_b128 v66, v[80:83] offset:3072
    s_nop 1
    ds_write_b128 v66, v[84:87] offset:4096
    s_nop 0
    ds_write_b128 v66, v[88:91] offset:5120
    s_branch c_pw_end_30
c_pw_33:
    ds_read_b128 v[100:103], v58 offset:384
    ds_read_b128 v[112:115], v59 offset:96
    ds_read_b128 v[116:119], v59 offset:608
    ds_read_b128 v[120:123], v59 offset:1120
    ds_read_b128 v[124:127], v59 offset:1632
    ds_read_b128 v[128:131], v59 offset:2144
    ds_read_b128 v[132:135], v59 offset:2656
    ds_read_b128 v[104:107], v58 offset:896
    ds_read_b128 v[108:111], v58 offset:1408
    s_waitcnt lgkmcnt(2)
    v_mfma_f32_16x16x32_bf16 v[88:91], v[100:103], v[132:135], 0
    v_mfma_f32_16x16x32_bf16 v[84:87], v[100:103], v[128:131], 0
    v_mfma_f32_16x16x32_bf16 v[80:83], v[100:103], v[124:127], 0
    v_mfma_f32_16x16x32_bf16 v[72:75], v[100:103], v[116:119], 0
    v_mfma_f32_16x16x32_bf16 v[68:71], v[100:103], v[112:115], 0
    ds_read_b128 v[100:103], v58 offset:1920
    s_waitcnt lgkmcnt(2)
    v_mfma_f32_16x16x32_bf16 v[88:91], v[104:107], v[128:131], v[88:91]
    v_mfma_f32_16x16x32_bf16 v[84:87], v[104:107], v[124:127], v[84:87]
    v_mfma_f32_16x16x32_bf16 v[80:83], v[104:107], v[120:123], v[80:83]
    v_mfma_f32_16x16x32_bf16 v[72:75], v[104:107], v[112:115], v[72:75]
    ds_read_b128 v[104:107], v58 offset:2432
    ds_read_b128 v[144:147], v59 offset:32
    ds_read_b128 v[148:151], v59 offset:544
    ds_read_b128 v[152:155], v59 offset:1056
    ds_read_b128 v[156:159], v59 offset:1568
    ds_read_b128 v[160:163], v59 offset:2080
    ds_read_b128 v[164:167], v59 offset:2592
    s_waitcnt lgkmcnt(8)
    v_mfma_f32_16x16x32_bf16 v[88:91], v[108:111], v[124:127], v[88:91]
    v_mfma_f32_16x16x32_bf16 v[84:87], v[108:111], v[120:123], v[84:87]
    v_mfma_f32_16x16x32_bf16 v[80:83], v[108:111], v[116:119], v[80:83]
    ds_read_b128 v[108:111], v58 offset:2944
    s_waitcnt lgkmcnt(8)
    v_mfma_f32_16x16x32_bf16 v[88:91], v[100:103], v[120:123], v[88:91]
    v_mfma_f32_16x16x32_bf16 v[84:87], v[100:103], v[116:119], v[84:87]
    v_mfma_f32_16x16x32_bf16 v[80:83], v[100:103], v[112:115], v[80:83]
    ds_read_b128 v[100:103], v58 offset:448
    s_waitcnt lgkmcnt(8)
    v_mfma_f32_16x16x32_bf16 v[88:91], v[104:107], v[116:119], v[88:91]
    v_mfma_f32_16x16x32_bf16 v[84:87], v[104:107], v[112:115], v[84:87]
    ds_read_b128 v[104:107], v58 offset:960
    s_waitcnt lgkmcnt(2)
    v_mfma_f32_16x16x32_bf16 v[88:91], v[108:111], v[112:115], v[88:91]
    ds_read_b128 v[108:111], v58 offset:1472
    s_waitcnt lgkmcnt(2)
    v_mfma_f32_16x16x32_bf16 v[88:91], v[100:103], v[164:167], v[88:91]
    v_mfma_f32_16x16x32_bf16 v[84:87], v[100:103], v[160:163], v[84:87]
    v_mfma_f32_16x16x32_bf16 v[80:83], v[100:103], v[156:159], v[80:83]
    v_mfma_f32_16x16x32_bf16 v[72:75], v[100:103], v[148:151], v[72:75]
    v_mfma_f32_16x16x32_bf16 v[68:71], v[100:103], v[144:147], v[68:71]
    ds_read_b128 v[100:103], v58 offset:1984
    s_waitcnt lgkmcnt(2)
    v_mfma_f32_16x16x32_bf16 v[88:91], v[104:107], v[160:163], v[88:91]
    v_mfma_f32_16x16x32_bf16 v[84:87], v[104:107], v[156:159], v[84:87]
    v_mfma_f32_16x16x32_bf16 v[80:83], v[104:107], v[152:155], v[80:83]
    v_mfma_f32_16x16x32_bf16 v[72:75], v[104:107], v[144:147], v[72:75]
    ds_read_b128 v[104:107], v58 offset:2496
    s_waitcnt lgkmcnt(2)
    v_mfma_f32_16x16x32_bf16 v[88:91], v[108:111], v[156:159], v[88:91]
    v_mfma_f32_16x16x32_bf16 v[84:87], v[108:111], v[152:155], v[84:87]
    v_mfma_f32_16x16x32_bf16 v[80:83], v[108:111], v[148:151], v[80:83]
    ds_read_b128 v[108:111], v58 offset:3008
    s_waitcnt lgkmcnt(2)
    v_mfma_f32_16x16x32_bf16 v[88:91], v[100:103], v[152:155], v[88:91]
    v_mfma_f32_16x16x32_bf16 v[84:87], v[100:103], v[148:151], v[84:87]
    v_mfma_f32_16x16x32_bf16 v[80:83], v[100:103], v[144:147], v[80:83]
    s_waitcnt lgkmcnt(1)
    v_mfma_f32_16x16x32_bf16 v[88:91], v[104:107], v[148:151], v[88:91]
    v_mfma_f32_16x16x32_bf16 v[84:87], v[104:107], v[144:147], v[84:87]
    s_waitcnt lgkmcnt(0)
    v_mfma_f32_16x16x32_bf16 v[88:91], v[108:111], v[144:147], v[88:91]
    ds_write_b128 v66, v[68:71] offset:0
    ds_write_b128 v66, v[72:75] offset:1024
    s_nop 0
    ds_write_b128 v66, v[80:83] offset:3072
    s_nop 1
    ds_write_b128 v66, v[84:87] offset:4096
    s_nop 0
    ds_write_b128 v66, v[88:91] offset:5120
c_pw_end_30:
    s_waitcnt lgkmcnt(0)
    s_barrier
    s_mov_b64 exec, 0
    s_cmp_eq_u32 s34, 0
    s_cselect_b32 exec_lo, -1, exec_lo
    s_cselect_b32 exec_hi, -1, exec_hi
    s_cmp_eq_u32 s34, 1
    s_cselect_b32 exec_lo, 0, exec_lo
    s_cselect_b32 exec_hi, -1, exec_hi
    s_cmp_eq_u32 s34, 2
    s_cselect_b32 exec_lo, -1, exec_lo
    s_cselect_b32 exec_hi, -1, exec_hi
    s_cmp_eq_u32 s34, 3
    s_cselect_b32 exec_lo, 0, exec_lo
    s_cselect_b32 exec_hi, 0, exec_hi
    s_cbranch_execz c_fskip_36
    ds_read_b128 v[112:115], v67 offset:0
    ds_read_b128 v[116:119], v67 offset:16
    ds_read_b128 v[120:123], v67 offset:8192
    ds_read_b128 v[124:127], v67 offset:8208
    ds_read_b128 v[128:131], v67 offset:16384
    ds_read_b128 v[132:135], v67 offset:16400
    ds_read_b128 v[136:139], v67 offset:24576
    ds_read_b128 v[140:143], v67 offset:24592
    s_lshl_b32 s40, s58, 12
    s_add_u32 s40, s40, 8912896
    s_waitcnt lgkmcnt(0)
    v_pk_add_f32 v[112:113], v[112:113], v[120:121]
    v_pk_add_f32 v[128:129], v[128:129], v[136:137]
    v_pk_add_f32 v[114:115], v[114:115], v[122:123]
    v_pk_add_f32 v[130:131], v[130:131], v[138:139]
    v_pk_add_f32 v[116:117], v[116:117], v[124:125]
    v_pk_add_f32 v[132:133], v[132:133], v[140:141]
    v_pk_add_f32 v[118:119], v[118:119], v[126:127]
    v_pk_add_f32 v[134:135], v[134:135], v[142:143]
    v_pk_add_f32 v[112:113], v[112:113], v[128:129]
    v_pk_add_f32 v[114:115], v[114:115], v[130:131]
    v_pk_add_f32 v[116:117], v[116:117], v[132:133]
    v_pk_add_f32 v[118:119], v[118:119], v[134:135]
    v_cvt_pk_bf16_f32 v184, v112, v113
    v_cvt_pk_bf16_f32 v185, v114, v115
    v_cvt_pk_bf16_f32 v186, v116, v117
    v_cvt_pk_bf16_f32 v187, v118, v119
    buffer_store_dwordx4 v[184:187], v2, s[8:11], s40 offen sc1
c_fskip_36:
    s_mov_b64 exec, -1
    s_nop 1
c_halfE_22:
k2_kernel_end:
    s_endpgm

.globl k3_kernel
.p2align 8
.type k3_kernel,@function
k3_kernel:
    s_cmp_ge_u32 s2, 256
    s_cbranch_scc1 k3_kernel_end
    s_load_dwordx2 s[12:13], s[0:1], 104
    s_load_dwordx2 s[8:9], s[0:1], 0
    s_load_dwordx2 s[16:17], s[0:1], 88
    s_mov_b32 s10, 2621440
    s_mov_b32 s11, 0x20000
    s_mov_b32 s14, 15990784
    s_mov_b32 s15, 0x20000
    s_mov_b32 s18, 2621440
    s_mov_b32 s19, 0x20000
    v_lshrrev_b32 v4, 6, v0
    v_and_b32 v1, 63, v0
    v_readfirstlane_b32 s34, v4
    v_lshlrev_b32 v7, 4, v1
    s_and_b32 s40, s2, 7
    s_lshr_b32 s41, s2, 3
    s_lshr_b32 s32, s40, 1
    s_lshl_b32 s32, s32, 3
    s_and_b32 s42, s41, 7
    s_add_u32 s32, s32, s42
    s_and_b32 s33, s40, 1
    s_lshl_b32 s33, s33, 2
    s_lshr_b32 s42, s41, 3
    s_add_u32 s33, s33, s42
    s_add_u32 s40, s32, s33
    s_mul_i32 s41, s40, 43
    s_lshr_b32 s41, s41, 8
    s_mul_i32 s41, s41, 6
    s_sub_u32 s48, s40, s41
    s_mul_i32 s46, s33, 122880
    s_add_u32 s46, s46, 15007744
    s_mul_i32 s40, s34, 5120
    s_add_u32 s46, s46, s40
    s_mul_i32 s47, s32, 98304
    s_mul_i32 s41, s34, 24576
    s_add_u32 s47, s47, s41
    s_add_u32 s47, s47, 11534336
    s_add_u32 s40, s48, 0
    s_sub_u32 s41, s40, 6
    s_cmp_ge_u32 s40, 6
    s_cselect_b32 s50, s41, s40
    s_add_u32 s40, s48, 1
    s_sub_u32 s41, s40, 6
    s_cmp_ge_u32 s40, 6
    s_cselect_b32 s51, s41, s40
    s_add_u32 s40, s48, 2
    s_sub_u32 s41, s40, 6
    s_cmp_ge_u32 s40, 6
    s_cselect_b32 s52, s41, s40
    s_add_u32 s40, s48, 3
    s_sub_u32 s41, s40, 6
    s_cmp_ge_u32 s40, 6
    s_cselect_b32 s53, s41, s40
    s_add_u32 s40, s48, 4
    s_sub_u32 s41, s40, 6
    s_cmp_ge_u32 s40, 6
    s_cselect_b32 s54, s41, s40
    s_add_u32 s40, s48, 5
    s_sub_u32 s41, s40, 6
    s_cmp_ge_u32 s40, 6
    s_cselect_b32 s55, s41, s40
    s_waitcnt lgkmcnt(0)
    s_mul_i32 s40, s50, 20480
    s_add_u32 s40, s40, s46
    s_add_u32 s40, s40, 0
    s_mul_i32 s41, s34, 5120
    s_add_u32 m0, s41, 0
    s_nop 0
    buffer_load_dwordx4 v7, s[12:15], s40 offen lds
    s_mul_i32 s40, s50, 20480
    s_add_u32 s40, s40, s46
    s_add_u32 s40, s40, 1024
    s_mul_i32 s41, s34, 5120
    s_add_u32 m0, s41, 1024
    s_nop 0
    buffer_load_dwordx4 v7, s[12:15], s40 offen lds
    s_mul_i32 s40, s50, 20480
    s_add_u32 s40, s40, s46
    s_add_u32 s40, s40, 2048
    s_mul_i32 s41, s34, 5120
    s_add_u32 m0, s41, 2048
    s_nop 0
    buffer_load_dwordx4 v7, s[12:15], s40 offen lds
    s_mul_i32 s40, s50, 20480
    s_add_u32 s40, s40, s46
    s_add_u32 s40, s40, 3072
    s_mul_i32 s41, s34, 5120
    s_add_u32 m0, s41, 3072
    s_nop 0
    buffer_load_dwordx4 v7, s[12:15], s40 offen lds
    s_mul_i32 s40, s50, 20480
    s_add_u32 s40, s40, s46
    s_add_u32 s40, s40, 4096
    s_mul_i32 s41, s34, 5120
    s_add_u32 m0, s41, 4096
    s_nop 0
    buffer_load_dwordx4 v7, s[12:15], s40 offen lds
    s_lshl_b32 s42, s50, 12
    s_add_u32 s42, s42, s47
    buffer_load_dwordx4 v[8:11], v7, s[12:15], s42 offen offset:0
    s_lshl_b32 s42, s50, 12
    s_add_u32 s42, s42, s47
    buffer_load_dwordx4 v[12:15], v7, s[12:15], s42 offen offset:1024
    s_lshl_b32 s42, s50, 12
    s_add_u32 s42, s42, s47
    buffer_load_dwordx4 v[16:19], v7, s[12:15], s42 offen offset:2048
    s_lshl_b32 s42, s50, 12
    s_add_u32 s42, s42, s47
    buffer_load_dwordx4 v[20:23], v7, s[12:15], s42 offen offset:3072
    s_barrier
    s_mul_i32 s40, s51, 20480
    s_add_u32 s40, s40, s46
    s_add_u32 s40, s40, 0
    s_mul_i32 s41, s34, 5120
    s_add_u32 m0, s41, 20480
    s_nop 0
    buffer_load_dwordx4 v7, s[12:15], s40 offen lds
    s_mul_i32 s40, s51, 20480
    s_add_u32 s40, s40, s46
    s_add_u32 s40, s40, 1024
    s_mul_i32 s41, s34, 5120
    s_add_u32 m0, s41, 21504
    s_nop 0
    buffer_load_dwordx4 v7, s[12:15], s40 offen lds
    s_mul_i32 s40, s51, 20480
    s_add_u32 s40, s40, s46
    s_add_u32 s40, s40, 2048
    s_mul_i32 s41, s34, 5120
    s_add_u32 m0, s41, 22528
    s_nop 0
    buffer_load_dwordx4 v7, s[12:15], s40 offen lds
    s_mul_i32 s40, s51, 20480
    s_add_u32 s40, s40, s46
    s_add_u32 s40, s40, 3072
    s_mul_i32 s41, s34, 5120
    s_add_u32 m0, s41, 23552
    s_nop 0
    buffer_load_dwordx4 v7, s[12:15], s40 offen lds
    s_mul_i32 s40, s51, 20480
    s_add_u32 s40, s40, s46
    s_add_u32 s40, s40, 4096
    s_mul_i32 s41, s34, 5120
    s_add_u32 m0, s41, 24576
    s_nop 0
    buffer_load_dwordx4 v7, s[12:15], s40 offen lds
    s_lshl_b32 s42, s51, 12
    s_add_u32 s42, s42, s47
    buffer_load_dwordx4 v[24:27], v7, s[12:15], s42 offen offset:0
    s_lshl_b32 s42, s51, 12
    s_add_u32 s42, s42, s47
    buffer_load_dwordx4 v[28:31], v7, s[12:15], s42 offen offset:1024
    s_lshl_b32 s42, s51, 12
    s_add_u32 s42, s42, s47
    buffer_load_dwordx4 v[32:35], v7, s[12:15], s42 offen offset:2048
    s_lshl_b32 s42, s51, 12
    s_add_u32 s42, s42, s47
    buffer_load_dwordx4 v[36:39], v7, s[12:15], s42 offen offset:3072
    s_mul_i32 s44, s33, 160
    s_mul_i32 s45, s32, 81920
    s_add_u32 s45, s45, s44
    v_add_u32 v4, 0, v1
    v_mul_u32_u24 v5, 6554, v4
    v_lshrrev_b32 v5, 16, v5
    v_mul_u32_u24 v6, 10, v5
    v_sub_u32 v4, v4, v6
    v_lshlrev_b32 v4, 4, v4
    v_mul_u32_u24 v5, 1280, v5
    v_add_u32 v104, v4, v5
    v_add_u32 v4, 64, v1
    v_mul_u32_u24 v5, 6554, v4
    v_lshrrev_b32 v5, 16, v5
    v_mul_u32_u24 v6, 10, v5
    v_sub_u32 v4, v4, v6
    v_lshlrev_b32 v4, 4, v4
    v_mul_u32_u24 v5, 1280, v5
    v_add_u32 v105, v4, v5
    v_add_u32 v4, 128, v1
    v_mul_u32_u24 v5, 6554, v4
    v_lshrrev_b32 v5, 16, v5
    v_mul_u32_u24 v6, 10, v5
    v_sub_u32 v4, v4, v6
    v_lshlrev_b32 v4, 4, v4
    v_mul_u32_u24 v5, 1280, v5
    v_add_u32 v106, v4, v5
    v_add_u32 v4, 192, v1
    v_mul_u32_u24 v5, 6554, v4
    v_lshrrev_b32 v5, 16, v5
    v_mul_u32_u24 v6, 10, v5
    v_sub_u32 v4, v4, v6
    v_lshlrev_b32 v4, 4, v4
    v_mul_u32_u24 v5, 1280, v5
    v_add_u32 v107, v4, v5
    v_add_u32 v4, 256, v1
    v_mul_u32_u24 v5, 6554, v4
    v_lshrrev_b32 v5, 16, v5
    v_mul_u32_u24 v6, 10, v5
    v_sub_u32 v4, v4, v6
    v_lshlrev_b32 v4, 4, v4
    v_mul_u32_u24 v5, 1280, v5
    v_add_u32 v108, v4, v5
    v_lshrrev_b32 v2, 4, v1
    v_and_b32 v3, 15, v1
    v_mov_b32 v113, v7
    v_add_u32 v114, 61440, v7
    s_waitcnt vmcnt(13)
    s_barrier
    ds_read_b128 v[136:139], v113 offset:0
    ds_read_b128 v[140:143], v113 offset:1024
    ds_read_b128 v[144:147], v113 offset:2048
    ds_read_b128 v[148:151], v113 offset:3072
    ds_read_b128 v[152:155], v113 offset:4096
    ds_read_b128 v[156:159], v113 offset:5120
    ds_read_b128 v[160:163], v113 offset:6144
    ds_read_b128 v[164:167], v113 offset:7168
    ds_read_b128 v[168:171], v113 offset:8192
    ds_read_b128 v[172:175], v113 offset:9216
    s_waitcnt vmcnt(12)
    s_waitcnt lgkmcnt(9)
    v_mfma_f32_16x16x32_bf16 v[116:119], v[136:139], v[8:11], 0
    s_mul_i32 s40, s52, 20480
    s_add_u32 s40, s40, s46
    s_add_u32 s40, s40, 0
    s_mul_i32 s41, s34, 5120
    s_add_u32 m0, s41, 40960
    s_nop 0
    buffer_load_dwordx4 v7, s[12:15], s40 offen lds
    s_waitcnt lgkmcnt(8)
    v_mfma_f32_16x16x32_bf16 v[120:123], v[140:143], v[8:11], 0
    s_waitcnt lgkmcnt(7)
    v_mfma_f32_16x16x32_bf16 v[124:127], v[144:147], v[8:11], 0
    s_mul_i32 s40, s52, 20480
    s_add_u32 s40, s40, s46
    s_add_u32 s40, s40, 1024
    s_mul_i32 s41, s34, 5120
    s_add_u32 m0, s41, 41984
    s_nop 0
    buffer_load_dwordx4 v7, s[12:15], s40 offen lds
    s_waitcnt lgkmcnt(6)
    v_mfma_f32_16x16x32_bf16 v[128:131], v[148:151], v[8:11], 0
    s_waitcnt lgkmcnt(5)
    v_mfma_f32_16x16x32_bf16 v[132:135], v[152:155], v[8:11], 0
    s_mul_i32 s40, s52, 20480
    s_add_u32 s40, s40, s46
    s_add_u32 s40, s40, 2048
    s_mul_i32 s41, s34, 5120
    s_add_u32 m0, s41, 43008
    s_nop 0
    buffer_load_dwordx4 v7, s[12:15], s40 offen lds
    ds_read_b128 v[136:139], v113 offset:10240
    ds_read_b128 v[140:143], v113 offset:11264
    ds_read_b128 v[144:147], v113 offset:12288
    ds_read_b128 v[148:151], v113 offset:13312
    ds_read_b128 v[152:155], v113 offset:14336
    s_waitcnt vmcnt(14)
    s_waitcnt lgkmcnt(9)
    v_mfma_f32_16x16x32_bf16 v[116:119], v[156:159], v[12:15], v[116:119]
    s_mul_i32 s40, s52, 20480
    s_add_u32 s40, s40, s46
    s_add_u32 s40, s40, 3072
    s_mul_i32 s41, s34, 5120
    s_add_u32 m0, s41, 44032
    s_nop 0
    buffer_load_dwordx4 v7, s[12:15], s40 offen lds
    s_waitcnt lgkmcnt(8)
    v_mfma_f32_16x16x32_bf16 v[120:123], v[160:163], v[12:15], v[120:123]
    s_waitcnt lgkmcnt(7)
    v_mfma_f32_16x16x32_bf16 v[124:127], v[164:167], v[12:15], v[124:127]
    s_mul_i32 s40, s52, 20480
    s_add_u32 s40, s40, s46
    s_add_u32 s40, s40, 4096
    s_mul_i32 s41, s34, 5120
    s_add_u32 m0, s41, 45056
    s_nop 0
    buffer_load_dwordx4 v7, s[12:15], s40 offen lds
    s_waitcnt lgkmcnt(6)
    v_mfma_f32_16x16x32_bf16 v[128:131], v[168:171], v[12:15], v[128:131]
    s_waitcnt lgkmcnt(5)
    v_mfma_f32_16x16x32_bf16 v[132:135], v[172:175], v[12:15], v[132:135]
    s_lshl_b32 s42, s52, 12
    s_add_u32 s42, s42, s47
    buffer_load_dwordx4 v[40:43], v7, s[12:15], s42 offen offset:0
    ds_read_b128 v[156:159], v113 offset:15360
    ds_read_b128 v[160:163], v113 offset:16384
    ds_read_b128 v[164:167], v113 offset:17408
    ds_read_b128 v[168:171], v113 offset:18432
    ds_read_b128 v[172:175], v113 offset:19456
    s_waitcnt vmcnt(16)
    s_waitcnt lgkmcnt(9)
    v_mfma_f32_16x16x32_bf16 v[116:119], v[136:139], v[16:19], v[116:119]
    s_lshl_b32 s42, s52, 12
    s_add_u32 s42, s42, s47
    buffer_load_dwordx4 v[44:47], v7, s[12:15], s42 offen offset:1024
    s_waitcnt lgkmcnt(8)
    v_mfma_f32_16x16x32_bf16 v[120:123], v[140:143], v[16:19], v[120:123]
    s_waitcnt lgkmcnt(7)
    v_mfma_f32_16x16x32_bf16 v[124:127], v[144:147], v[16:19], v[124:127]
    s_lshl_b32 s42, s52, 12
    s_add_u32 s42, s42, s47
    buffer_load_dwordx4 v[48:51], v7, s[12:15], s42 offen offset:2048
    s_waitcnt lgkmcnt(6)
    v_mfma_f32_16x16x32_bf16 v[128:131], v[148:151], v[16:19], v[128:131]
    s_waitcnt lgkmcnt(5)
    v_mfma_f32_16x16x32_bf16 v[132:135], v[152:155], v[16:19], v[132:135]
    s_lshl_b32 s42, s52, 12
    s_add_u32 s42, s42, s47
    buffer_load_dwordx4 v[52:55], v7, s[12:15], s42 offen offset:3072
    s_waitcnt vmcnt(18)
    s_waitcnt lgkmcnt(4)
    v_mfma_f32_16x16x32_bf16 v[116:119], v[156:159], v[20:23], v[116:119]
    s_waitcnt lgkmcnt(3)
    v_mfma_f32_16x16x32_bf16 v[120:123], v[160:163], v[20:23], v[120:123]
    s_waitcnt lgkmcnt(2)
    v_mfma_f32_16x16x32_bf16 v[124:127], v[164:167], v[20:23], v[124:127]
    s_waitcnt lgkmcnt(1)
    v_mfma_f32_16x16x32_bf16 v[128:131], v[168:171], v[20:23], v[128:131]
    s_waitcnt lgkmcnt(0)
    v_mfma_f32_16x16x32_bf16 v[132:135], v[172:175], v[20:23], v[132:135]
    s_waitcnt vmcnt(13)
    s_barrier
    ds_read_b128 v[136:139], v113 offset:20480
    ds_read_b128 v[140:143], v113 offset:21504
    ds_read_b128 v[144:147], v113 offset:22528
    ds_read_b128 v[148:151], v113 offset:23552
    ds_read_b128 v[152:155], v113 offset:24576
    ds_read_b128 v[156:159], v113 offset:25600
    ds_read_b128 v[160:163], v113 offset:26624
    ds_read_b128 v[164:167], v113 offset:27648
    ds_read_b128 v[168:171], v113 offset:28672
    ds_read_b128 v[172:175], v113 offset:29696
    s_waitcnt vmcnt(12)
    s_waitcnt lgkmcnt(9)
    v_mfma_f32_16x16x32_bf16 v[116:119], v[136:139], v[24:27], v[116:119]
    s_mul_i32 s40, s53, 20480
    s_add_u32 s40, s40, s46
    s_add_u32 s40, s40, 0
    s_mul_i32 s41, s34, 5120
    s_add_u32 m0, s41, 61440
    s_nop 0
    buffer_load_dwordx4 v7, s[12:15], s40 offen lds
    s_waitcnt lgkmcnt(8)
    v_mfma_f32_16x16x32_bf16 v[120:123], v[140:143], v[24:27], v[120:123]
    s_waitcnt lgkmcnt(7)
    v_mfma_f32_16x16x32_bf16 v[124:127], v[144:147], v[24:27], v[124:127]
    s_mul_i32 s40, s53, 20480
    s_add_u32 s40, s40, s46
    s_add_u32 s40, s40, 1024
    s_mul_i32 s41, s34, 5120
    s_add_u32 m0, s41, 62464
    s_nop 0
    buffer_load_dwordx4 v7, s[12:15], s40 offen lds
    s_waitcnt lgkmcnt(6)
    v_mfma_f32_16x16x32_bf16 v[128:131], v[148:151], v[24:27], v[128:131]
    s_waitcnt lgkmcnt(5)
    v_mfma_f32_16x16x32_bf16 v[132:135], v[152:155], v[24:27], v[132:135]
    s_mul_i32 s40, s53, 20480
    s_add_u32 s40, s40, s46
    s_add_u32 s40, s40, 2048
    s_mul_i32 s41, s34, 5120
    s_add_u32 m0, s41, 63488
    s_nop 0
    buffer_load_dwordx4 v7, s[12:15], s40 offen lds
    ds_read_b128 v[136:139], v113 offset:30720
    ds_read_b128 v[140:143], v113 offset:31744
    ds_read_b128 v[144:147], v113 offset:32768
    ds_read_b128 v[148:151], v113 offset:33792
    ds_read_b128 v[152:155], v113 offset:34816
    s_waitcnt vmcnt(14)
    s_waitcnt lgkmcnt(9)
    v_mfma_f32_16x16x32_bf16 v[116:119], v[156:159], v[28:31], v[116:119]
    s_mul_i32 s40, s53, 20480
    s_add_u32 s40, s40, s46
    s_add_u32 s40, s40, 3072
    s_mul_i32 s41, s34, 5120
    s_add_u32 m0, s41, 64512
    s_nop 0
    buffer_load_dwordx4 v7, s[12:15], s40 offen lds
    s_waitcnt lgkmcnt(8)
    v_mfma_f32_16x16x32_bf16 v[120:123], v[160:163], v[28:31], v[120:123]
    s_waitcnt lgkmcnt(7)
    v_mfma_f32_16x16x32_bf16 v[124:127], v[164:167], v[28:31], v[124:127]
    s_mul_i32 s40, s53, 20480
    s_add_u32 s40, s40, s46
    s_add_u32 s40, s40, 4096
    s_mul_i32 s41, s34, 5120
    s_add_u32 m0, s41, 65536
    s_nop 0
    buffer_load_dwordx4 v7, s[12:15], s40 offen lds
    s_waitcnt lgkmcnt(6)
    v_mfma_f32_16x16x32_bf16 v[128:131], v[168:171], v[28:31], v[128:131]
    s_waitcnt lgkmcnt(5)
    v_mfma_f32_16x16x32_bf16 v[132:135], v[172:175], v[28:31], v[132:135]
    s_lshl_b32 s42, s53, 12
    s_add_u32 s42, s42, s47
    buffer_load_dwordx4 v[56:59], v7, s[12:15], s42 offen offset:0
    ds_read_b128 v[156:159], v113 offset:35840
    ds_read_b128 v[160:163], v113 offset:36864
    ds_read_b128 v[164:167], v113 offset:37888
    ds_read_b128 v[168:171], v113 offset:38912
    ds_read_b128 v[172:175], v113 offset:39936
    s_waitcnt vmcnt(16)
    s_waitcnt lgkmcnt(9)
    v_mfma_f32_16x16x32_bf16 v[116:119], v[136:139], v[32:35], v[116:119]
    s_lshl_b32 s42, s53, 12
    s_add_u32 s42, s42, s47
    buffer_load_dwordx4 v[60:63], v7, s[12:15], s42 offen offset:1024
    s_waitcnt lgkmcnt(8)
    v_mfma_f32_16x16x32_bf16 v[120:123], v[140:143], v[32:35], v[120:123]
    s_waitcnt lgkmcnt(7)
    v_mfma_f32_16x16x32_bf16 v[124:127], v[144:147], v[32:35], v[124:127]
    s_lshl_b32 s42, s53, 12
    s_add_u32 s42, s42, s47
    buffer_load_dwordx4 v[64:67], v7, s[12:15], s42 offen offset:2048
    s_waitcnt lgkmcnt(6)
    v_mfma_f32_16x16x32_bf16 v[128:131], v[148:151], v[32:35], v[128:131]
    s_waitcnt lgkmcnt(5)
    v_mfma_f32_16x16x32_bf16 v[132:135], v[152:155], v[32:35], v[132:135]
    s_lshl_b32 s42, s53, 12
    s_add_u32 s42, s42, s47
    buffer_load_dwordx4 v[68:71], v7, s[12:15], s42 offen offset:3072
    s_waitcnt vmcnt(18)
    s_waitcnt lgkmcnt(4)
    v_mfma_f32_16x16x32_bf16 v[116:119], v[156:159], v[36:39], v[116:119]
    s_waitcnt lgkmcnt(3)
    v_mfma_f32_16x16x32_bf16 v[120:123], v[160:163], v[36:39], v[120:123]
    s_waitcnt lgkmcnt(2)
    v_mfma_f32_16x16x32_bf16 v[124:127], v[164:167], v[36:39], v[124:127]
    s_waitcnt lgkmcnt(1)
    v_mfma_f32_16x16x32_bf16 v[128:131], v[168:171], v[36:39], v[128:131]
    s_waitcnt lgkmcnt(0)
    v_mfma_f32_16x16x32_bf16 v[132:135], v[172:175], v[36:39], v[132:135]
    s_waitcnt vmcnt(13)
    s_barrier
    ds_read_b128 v[136:139], v113 offset:40960
    ds_read_b128 v[140:143], v113 offset:41984
    ds_read_b128 v[144:147], v113 offset:43008
    ds_read_b128 v[148:151], v113 offset:44032
    ds_read_b128 v[152:155], v113 offset:45056
    ds_read_b128 v[156:159], v113 offset:46080
    ds_read_b128 v[160:163], v113 offset:47104
    ds_read_b128 v[164:167], v113 offset:48128
    ds_read_b128 v[168:171], v113 offset:49152
    ds_read_b128 v[172:175], v113 offset:50176
    s_waitcnt vmcnt(12)
    s_waitcnt lgkmcnt(9)
    v_mfma_f32_16x16x32_bf16 v[116:119], v[136:139], v[40:43], v[116:119]
    s_mul_i32 s40, s54, 20480
    s_add_u32 s40, s40, s46
    s_add_u32 s40, s40, 0
    s_mul_i32 s41, s34, 5120
    s_add_u32 m0, s41, 81920
    s_nop 0
    buffer_load_dwordx4 v7, s[12:15], s40 offen lds
    s_waitcnt lgkmcnt(8)
    v_mfma_f32_16x16x32_bf16 v[120:123], v[140:143], v[40:43], v[120:123]
    s_waitcnt lgkmcnt(7)
    v_mfma_f32_16x16x32_bf16 v[124:127], v[144:147], v[40:43], v[124:127]
    s_mul_i32 s40, s54, 20480
    s_add_u32 s40, s40, s46
    s_add_u32 s40, s40, 1024
    s_mul_i32 s41, s34, 5120
    s_add_u32 m0, s41, 82944
    s_nop 0
    buffer_load_dwordx4 v7, s[12:15], s40 offen lds
    s_waitcnt lgkmcnt(6)
    v_mfma_f32_16x16x32_bf16 v[128:131], v[148:151], v[40:43], v[128:131]
    s_waitcnt lgkmcnt(5)
    v_mfma_f32_16x16x32_bf16 v[132:135], v[152:155], v[40:43], v[132:135]
    s_mul_i32 s40, s54, 20480
    s_add_u32 s40, s40, s46
    s_add_u32 s40, s40, 2048
    s_mul_i32 s41, s34, 5120
    s_add_u32 m0, s41, 83968
    s_nop 0
    buffer_load_dwordx4 v7, s[12:15], s40 offen lds
    ds_read_b128 v[136:139], v113 offset:51200
    ds_read_b128 v[140:143], v113 offset:52224
    ds_read_b128 v[144:147], v113 offset:53248
    ds_read_b128 v[148:151], v113 offset:54272
    ds_read_b128 v[152:155], v113 offset:55296
    s_waitcnt vmcnt(14)
    s_waitcnt lgkmcnt(9)
    v_mfma_f32_16x16x32_bf16 v[116:119], v[156:159], v[44:47], v[116:119]
    s_mul_i32 s40, s54, 20480
    s_add_u32 s40, s40, s46
    s_add_u32 s40, s40, 3072
    s_mul_i32 s41, s34, 5120
    s_add_u32 m0, s41, 84992
    s_nop 0
    buffer_load_dwordx4 v7, s[12:15], s40 offen lds
    s_waitcnt lgkmcnt(8)
    v_mfma_f32_16x16x32_bf16 v[120:123], v[160:163], v[44:47], v[120:123]
    s_waitcnt lgkmcnt(7)
    v_mfma_f32_16x16x32_bf16 v[124:127], v[164:167], v[44:47], v[124:127]
    s_mul_i32 s40, s54, 20480
    s_add_u32 s40, s40, s46
    s_add_u32 s40, s40, 4096
    s_mul_i32 s41, s34, 5120
    s_add_u32 m0, s41, 86016
    s_nop 0
    buffer_load_dwordx4 v7, s[12:15], s40 offen lds
    s_waitcnt lgkmcnt(6)
    v_mfma_f32_16x16x32_bf16 v[128:131], v[168:171], v[44:47], v[128:131]
    s_waitcnt lgkmcnt(5)
    v_mfma_f32_16x16x32_bf16 v[132:135], v[172:175], v[44:47], v[132:135]
    s_lshl_b32 s42, s54, 12
    s_add_u32 s42, s42, s47
    buffer_load_dwordx4 v[72:75], v7, s[12:15], s42 offen offset:0
    ds_read_b128 v[156:159], v113 offset:56320
    ds_read_b128 v[160:163], v113 offset:57344
    ds_read_b128 v[164:167], v113 offset:58368
    ds_read_b128 v[168:171], v113 offset:59392
    ds_read_b128 v[172:175], v113 offset:60416
    s_waitcnt vmcnt(16)
    s_waitcnt lgkmcnt(9)
    v_mfma_f32_16x16x32_bf16 v[116:119], v[136:139], v[48:51], v[116:119]
    s_lshl_b32 s42, s54, 12
    s_add_u32 s42, s42, s47
    buffer_load_dwordx4 v[76:79], v7, s[12:15], s42 offen offset:1024
    s_waitcnt lgkmcnt(8)
    v_mfma_f32_16x16x32_bf16 v[120:123], v[140:143], v[48:51], v[120:123]
    s_waitcnt lgkmcnt(7)
    v_mfma_f32_16x16x32_bf16 v[124:127], v[144:147], v[48:51], v[124:127]
    s_lshl_b32 s42, s54, 12
    s_add_u32 s42, s42, s47
    buffer_load_dwordx4 v[80:83], v7, s[12:15], s42 offen offset:2048
    s_waitcnt lgkmcnt(6)
    v_mfma_f32_16x16x32_bf16 v[128:131], v[148:151], v[48:51], v[128:131]
    s_waitcnt lgkmcnt(5)
    v_mfma_f32_16x16x32_bf16 v[132:135], v[152:155], v[48:51], v[132:135]
    s_lshl_b32 s42, s54, 12
    s_add_u32 s42, s42, s47
    buffer_load_dwordx4 v[84:87], v7, s[12:15], s42 offen offset:3072
    s_waitcnt vmcnt(18)
    s_waitcnt lgkmcnt(4)
    v_mfma_f32_16x16x32_bf16 v[116:119], v[156:159], v[52:55], v[116:119]
    s_waitcnt lgkmcnt(3)
    v_mfma_f32_16x16x32_bf16 v[120:123], v[160:163], v[52:55], v[120:123]
    s_waitcnt lgkmcnt(2)
    v_mfma_f32_16x16x32_bf16 v[124:127], v[164:167], v[52:55], v[124:127]
    s_waitcnt lgkmcnt(1)
    v_mfma_f32_16x16x32_bf16 v[128:131], v[168:171], v[52:55], v[128:131]
    s_waitcnt lgkmcnt(0)
    v_mfma_f32_16x16x32_bf16 v[132:135], v[172:175], v[52:55], v[132:135]
    s_waitcnt vmcnt(13)
    s_barrier
    ds_read_b128 v[136:139], v114 offset:0
    ds_read_b128 v[140:143], v114 offset:1024
    ds_read_b128 v[144:147], v114 offset:2048
    ds_read_b128 v[148:151], v114 offset:3072
    ds_read_b128 v[152:155], v114 offset:4096
    ds_read_b128 v[156:159], v114 offset:5120
    ds_read_b128 v[160:163], v114 offset:6144
    ds_read_b128 v[164:167], v114 offset:7168
    ds_read_b128 v[168:171], v114 offset:8192
    ds_read_b128 v[172:175], v114 offset:9216
    s_waitcnt vmcnt(12)
    s_waitcnt lgkmcnt(9)
    v_mfma_f32_16x16x32_bf16 v[116:119], v[136:139], v[56:59], v[116:119]
    s_mul_i32 s40, s55, 20480
    s_add_u32 s40, s40, s46
    s_add_u32 s40, s40, 0
    s_mul_i32 s41, s34, 5120
    s_add_u32 m0, s41, 102400
    s_nop 0
    buffer_load_dwordx4 v7, s[12:15], s40 offen lds
    s_waitcnt lgkmcnt(8)
    v_mfma_f32_16x16x32_bf16 v[120:123], v[140:143], v[56:59], v[120:123]
    s_waitcnt lgkmcnt(7)
    v_mfma_f32_16x16x32_bf16 v[124:127], v[144:147], v[56:59], v[124:127]
    s_mul_i32 s40, s55, 20480
    s_add_u32 s40, s40, s46
    s_add_u32 s40, s40, 1024
    s_mul_i32 s41, s34, 5120
    s_add_u32 m0, s41, 103424
    s_nop 0
    buffer_load_dwordx4 v7, s[12:15], s40 offen lds
    s_waitcnt lgkmcnt(6)
    v_mfma_f32_16x16x32_bf16 v[128:131], v[148:151], v[56:59], v[128:131]
    s_waitcnt lgkmcnt(5)
    v_mfma_f32_16x16x32_bf16 v[132:135], v[152:155], v[56:59], v[132:135]
    s_mul_i32 s40, s55, 20480
    s_add_u32 s40, s40, s46
    s_add_u32 s40, s40, 2048
    s_mul_i32 s41, s34, 5120
    s_add_u32 m0, s41, 104448
    s_nop 0
    buffer_load_dwordx4 v7, s[12:15], s40 offen lds
    ds_read_b128 v[136:139], v114 offset:10240
    ds_read_b128 v[140:143], v114 offset:11264
    ds_read_b128 v[144:147], v114 offset:12288
    ds_read_b128 v[148:151], v114 offset:13312
    ds_read_b128 v[152:155], v114 offset:14336
    s_waitcnt vmcnt(14)
    s_waitcnt lgkmcnt(9)
    v_mfma_f32_16x16x32_bf16 v[116:119], v[156:159], v[60:63], v[116:119]
    s_mul_i32 s40, s55, 20480
    s_add_u32 s40, s40, s46
    s_add_u32 s40, s40, 3072
    s_mul_i32 s41, s34, 5120
    s_add_u32 m0, s41, 105472
    s_nop 0
    buffer_load_dwordx4 v7, s[12:15], s40 offen lds
    s_waitcnt lgkmcnt(8)
    v_mfma_f32_16x16x32_bf16 v[120:123], v[160:163], v[60:63], v[120:123]
    s_waitcnt lgkmcnt(7)
    v_mfma_f32_16x16x32_bf16 v[124:127], v[164:167], v[60:63], v[124:127]
    s_mul_i32 s40, s55, 20480
    s_add_u32 s40, s40, s46
    s_add_u32 s40, s40, 4096
    s_mul_i32 s41, s34, 5120
    s_add_u32 m0, s41, 106496
    s_nop 0
    buffer_load_dwordx4 v7, s[12:15], s40 offen lds
    s_waitcnt lgkmcnt(6)
    v_mfma_f32_16x16x32_bf16 v[128:131], v[168:171], v[60:63], v[128:131]
    s_waitcnt lgkmcnt(5)
    v_mfma_f32_16x16x32_bf16 v[132:135], v[172:175], v[60:63], v[132:135]
    s_lshl_b32 s42, s55, 12
    s_add_u32 s42, s42, s47
    buffer_load_dwordx4 v[88:91], v7, s[12:15], s42 offen offset:0
    ds_read_b128 v[156:159], v114 offset:15360
    ds_read_b128 v[160:163], v114 offset:16384
    ds_read_b128 v[164:167], v114 offset:17408
    ds_read_b128 v[168:171], v114 offset:18432
    ds_read_b128 v[172:175], v114 offset:19456
    s_waitcnt vmcnt(16)
    s_waitcnt lgkmcnt(9)
    v_mfma_f32_16x16x32_bf16 v[116:119], v[136:139], v[64:67], v[116:119]
    s_lshl_b32 s42, s55, 12
    s_add_u32 s42, s42, s47
    buffer_load_dwordx4 v[92:95], v7, s[12:15], s42 offen offset:1024
    s_waitcnt lgkmcnt(8)
    v_mfma_f32_16x16x32_bf16 v[120:123], v[140:143], v[64:67], v[120:123]
    s_waitcnt lgkmcnt(7)
    v_mfma_f32_16x16x32_bf16 v[124:127], v[144:147], v[64:67], v[124:127]
    s_lshl_b32 s42, s55, 12
    s_add_u32 s42, s42, s47
    buffer_load_dwordx4 v[96:99], v7, s[12:15], s42 offen offset:2048
    s_waitcnt lgkmcnt(6)
    v_mfma_f32_16x16x32_bf16 v[128:131], v[148:151], v[64:67], v[128:131]
    s_waitcnt lgkmcnt(5)
    v_mfma_f32_16x16x32_bf16 v[132:135], v[152:155], v[64:67], v[132:135]
    s_lshl_b32 s42, s55, 12
    s_add_u32 s42, s42, s47
    buffer_load_dwordx4 v[100:103], v7, s[12:15], s42 offen offset:3072
    s_waitcnt vmcnt(18)
    s_waitcnt lgkmcnt(4)
    v_mfma_f32_16x16x32_bf16 v[116:119], v[156:159], v[68:71], v[116:119]
    s_cmp_ge_u32 s34, 2
    s_cbranch_scc1 k3_y_1
    s_mul_i32 s40, s34, 40960
    s_add_u32 s40, s40, s45
    s_mul_i32 s41, s34, 5120
    s_add_u32 m0, s41, 122880
    s_nop 0
    buffer_load_dwordx4 v104, s[8:11], s40 offen lds
    s_add_u32 m0, s41, 123904
    s_nop 0
    buffer_load_dwordx4 v105, s[8:11], s40 offen lds
    s_add_u32 m0, s41, 124928
    s_nop 0
    buffer_load_dwordx4 v106, s[8:11], s40 offen lds
    s_add_u32 m0, s41, 125952
    s_nop 0
    buffer_load_dwordx4 v107, s[8:11], s40 offen lds
    s_add_u32 m0, s41, 126976
    s_nop 0
    buffer_load_dwordx4 v108, s[8:11], s40 offen lds
    s_branch k3_xy_2
k3_y_1:
    v_lshrrev_b32 v4, 3, v1
    v_lshlrev_b32 v4, 12, v4
    v_and_b32 v5, 7, v1
    v_lshl_add_u32 v112, v5, 4, v4
    s_sub_u32 s42, s34, 2
    s_mul_i32 s40, s42, 40
    s_mul_i32 s41, s33, 80
    s_add_u32 s40, s40, s41
    s_lshl_b32 s40, s40, 12
    s_lshl_b32 s41, s32, 7
    s_add_u32 s40, s40, s41
    s_add_u32 s40, s40, 8912896
    s_mul_i32 s41, s42, 5120
    s_add_u32 m0, s41, 133120
    s_nop 0
    buffer_load_dwordx4 v112, s[12:15], s40 offen lds
    s_add_u32 s40, s40, 32768
    s_add_u32 m0, s41, 134144
    s_nop 0
    buffer_load_dwordx4 v112, s[12:15], s40 offen lds
    s_add_u32 s40, s40, 32768
    s_add_u32 m0, s41, 135168
    s_nop 0
    buffer_load_dwordx4 v112, s[12:15], s40 offen lds
    s_add_u32 s40, s40, 32768
    s_add_u32 m0, s41, 136192
    s_nop 0
    buffer_load_dwordx4 v112, s[12:15], s40 offen lds
    s_add_u32 s40, s40, 32768
    s_add_u32 m0, s41, 137216
    s_nop 0
    buffer_load_dwordx4 v112, s[12:15], s40 offen lds
    s_add_u32 s40, s40, 32768
k3_xy_2:
    s_lshl_b32 s40, s32, 9
    s_lshl_b32 s41, s34, 7
    s_add_u32 s40, s40, s41
    s_add_u32 s40, s40, 14680064
    v_lshlrev_b32 v4, 3, v3
    buffer_load_dwordx2 v[110:111], v4, s[12:15], s40 offen
    s_waitcnt lgkmcnt(3)
    v_mfma_f32_16x16x32_bf16 v[120:123], v[160:163], v[68:71], v[120:123]
    s_waitcnt lgkmcnt(2)
    v_mfma_f32_16x16x32_bf16 v[124:127], v[164:167], v[68:71], v[124:127]
    s_waitcnt lgkmcnt(1)
    v_mfma_f32_16x16x32_bf16 v[128:131], v[168:171], v[68:71], v[128:131]
    s_waitcnt lgkmcnt(0)
    v_mfma_f32_16x16x32_bf16 v[132:135], v[172:175], v[68:71], v[132:135]
    s_waitcnt vmcnt(19)
    s_barrier
    ds_read_b128 v[136:139], v114 offset:20480
    ds_read_b128 v[140:143], v114 offset:21504
    ds_read_b128 v[144:147], v114 offset:22528
    ds_read_b128 v[148:151], v114 offset:23552
    ds_read_b128 v[152:155], v114 offset:24576
    ds_read_b128 v[156:159], v114 offset:25600
    ds_read_b128 v[160:163], v114 offset:26624
    ds_read_b128 v[164:167], v114 offset:27648
    ds_read_b128 v[168:171], v114 offset:28672
    ds_read_b128 v[172:175], v114 offset:29696
    s_waitcnt vmcnt(18)
    s_waitcnt lgkmcnt(9)
    v_mfma_f32_16x16x32_bf16 v[116:119], v[136:139], v[72:75], v[116:119]
    s_waitcnt lgkmcnt(8)
    v_mfma_f32_16x16x32_bf16 v[120:123], v[140:143], v[72:75], v[120:123]
    s_waitcnt lgkmcnt(7)
    v_mfma_f32_16x16x32_bf16 v[124:127], v[144:147], v[72:75], v[124:127]
    s_waitcnt lgkmcnt(6)
    v_mfma_f32_16x16x32_bf16 v[128:131], v[148:151], v[72:75], v[128:131]
    s_waitcnt lgkmcnt(5)
    v_mfma_f32_16x16x32_bf16 v[132:135], v[152:155], v[72:75], v[132:135]
    ds_read_b128 v[136:139], v114 offset:30720
    ds_read_b128 v[140:143], v114 offset:31744
    ds_read_b128 v[144:147], v114 offset:32768
    ds_read_b128 v[148:151], v114 offset:33792
    ds_read_b128 v[152:155], v114 offset:34816
    s_waitcnt vmcnt(17)
    s_waitcnt lgkmcnt(9)
    v_mfma_f32_16x16x32_bf16 v[116:119], v[156:159], v[76:79], v[116:119]
    s_waitcnt lgkmcnt(8)
    v_mfma_f32_16x16x32_bf16 v[120:123], v[160:163], v[76:79], v[120:123]
    s_waitcnt lgkmcnt(7)
    v_mfma_f32_16x16x32_bf16 v[124:127], v[164:167], v[76:79], v[124:127]
    s_waitcnt lgkmcnt(6)
    v_mfma_f32_16x16x32_bf16 v[128:131], v[168:171], v[76:79], v[128:131]
    s_waitcnt lgkmcnt(5)
    v_mfma_f32_16x16x32_bf16 v[132:135], v[172:175], v[76:79], v[132:135]
    ds_read_b128 v[156:159], v114 offset:35840
    ds_read_b128 v[160:163], v114 offset:36864
    ds_read_b128 v[164:167], v114 offset:37888
    ds_read_b128 v[168:171], v114 offset:38912
    ds_read_b128 v[172:175], v114 offset:39936
    s_waitcnt vmcnt(16)
    s_waitcnt lgkmcnt(9)
    v_mfma_f32_16x16x32_bf16 v[116:119], v[136:139], v[80:83], v[116:119]
    s_waitcnt lgkmcnt(8)
    v_mfma_f32_16x16x32_bf16 v[120:123], v[140:143], v[80:83], v[120:123]
    s_waitcnt lgkmcnt(7)
    v_mfma_f32_16x16x32_bf16 v[124:127], v[144:147], v[80:83], v[124:127]
    s_waitcnt lgkmcnt(6)
    v_mfma_f32_16x16x32_bf16 v[128:131], v[148:151], v[80:83], v[128:131]
    s_waitcnt lgkmcnt(5)
    v_mfma_f32_16x16x32_bf16 v[132:135], v[152:155], v[80:83], v[132:135]
    s_waitcnt vmcnt(15)
    s_waitcnt lgkmcnt(4)
    v_mfma_f32_16x16x32_bf16 v[116:119], v[156:159], v[84:87], v[116:119]
    s_waitcnt lgkmcnt(3)
    v_mfma_f32_16x16x32_bf16 v[120:123], v[160:163], v[84:87], v[120:123]
    s_waitcnt lgkmcnt(2)
    v_mfma_f32_16x16x32_bf16 v[124:127], v[164:167], v[84:87], v[124:127]
    s_waitcnt lgkmcnt(1)
    v_mfma_f32_16x16x32_bf16 v[128:131], v[168:171], v[84:87], v[128:131]
    s_waitcnt lgkmcnt(0)
    v_mfma_f32_16x16x32_bf16 v[132:135], v[172:175], v[84:87], v[132:135]
    s_waitcnt vmcnt(10)
    s_barrier
    ds_read_b128 v[136:139], v114 offset:40960
    ds_read_b128 v[140:143], v114 offset:41984
    ds_read_b128 v[144:147], v114 offset:43008
    ds_read_b128 v[148:151], v114 offset:44032
    ds_read_b128 v[152:155], v114 offset:45056
    ds_read_b128 v[156:159], v114 offset:46080
    ds_read_b128 v[160:163], v114 offset:47104
    ds_read_b128 v[164:167], v114 offset:48128
    ds_read_b128 v[168:171], v114 offset:49152
    ds_read_b128 v[172:175], v114 offset:50176
    s_waitcnt vmcnt(9)
    s_waitcnt lgkmcnt(9)
    v_mfma_f32_16x16x32_bf16 v[116:119], v[136:139], v[88:91], v[116:119]
    s_waitcnt lgkmcnt(8)
    v_mfma_f32_16x16x32_bf16 v[120:123], v[140:143], v[88:91], v[120:123]
    s_waitcnt lgkmcnt(7)
    v_mfma_f32_16x16x32_bf16 v[124:127], v[144:147], v[88:91], v[124:127]
    s_waitcnt lgkmcnt(6)
    v_mfma_f32_16x16x32_bf16 v[128:131], v[148:151], v[88:91], v[128:131]
    s_waitcnt lgkmcnt(5)
    v_mfma_f32_16x16x32_bf16 v[132:135], v[152:155], v[88:91], v[132:135]
    ds_read_b128 v[136:139], v114 offset:51200
    ds_read_b128 v[140:143], v114 offset:52224
    ds_read_b128 v[144:147], v114 offset:53248
    ds_read_b128 v[148:151], v114 offset:54272
    ds_read_b128 v[152:155], v114 offset:55296
    s_waitcnt vmcnt(8)
    s_waitcnt lgkmcnt(9)
    v_mfma_f32_16x16x32_bf16 v[116:119], v[156:159], v[92:95], v[116:119]
    s_waitcnt lgkmcnt(8)
    v_mfma_f32_16x16x32_bf16 v[120:123], v[160:163], v[92:95], v[120:123]
    s_waitcnt lgkmcnt(7)
    v_mfma_f32_16x16x32_bf16 v[124:127], v[164:167], v[92:95], v[124:127]
    s_waitcnt lgkmcnt(6)
    v_mfma_f32_16x16x32_bf16 v[128:131], v[168:171], v[92:95], v[128:131]
    s_waitcnt lgkmcnt(5)
    v_mfma_f32_16x16x32_bf16 v[132:135], v[172:175], v[92:95], v[132:135]
    ds_read_b128 v[156:159], v114 offset:56320
    ds_read_b128 v[160:163], v114 offset:57344
    ds_read_b128 v[164:167], v114 offset:58368
    ds_read_b128 v[168:171], v114 offset:59392
    ds_read_b128 v[172:175], v114 offset:60416
    s_waitcnt vmcnt(7)
    s_waitcnt lgkmcnt(9)
    v_mfma_f32_16x16x32_bf16 v[116:119], v[136:139], v[96:99], v[116:119]
    s_waitcnt lgkmcnt(8)
    v_mfma_f32_16x16x32_bf16 v[120:123], v[140:143], v[96:99], v[120:123]
    s_waitcnt lgkmcnt(7)
    v_mfma_f32_16x16x32_bf16 v[124:127], v[144:147], v[96:99], v[124:127]
    s_waitcnt lgkmcnt(6)
    v_mfma_f32_16x16x32_bf16 v[128:131], v[148:151], v[96:99], v[128:131]
    s_waitcnt lgkmcnt(5)
    v_mfma_f32_16x16x32_bf16 v[132:135], v[152:155], v[96:99], v[132:135]
    s_waitcnt vmcnt(6)
    s_waitcnt lgkmcnt(4)
    v_mfma_f32_16x16x32_bf16 v[116:119], v[156:159], v[100:103], v[116:119]
    s_waitcnt lgkmcnt(3)
    v_mfma_f32_16x16x32_bf16 v[120:123], v[160:163], v[100:103], v[120:123]
    s_waitcnt lgkmcnt(2)
    v_mfma_f32_16x16x32_bf16 v[124:127], v[164:167], v[100:103], v[124:127]
    s_waitcnt lgkmcnt(1)
    v_mfma_f32_16x16x32_bf16 v[128:131], v[168:171], v[100:103], v[128:131]
    s_waitcnt lgkmcnt(0)
    v_mfma_f32_16x16x32_bf16 v[132:135], v[172:175], v[100:103], v[132:135]
    s_lshl_b32 s40, s34, 4
    v_add_u32 v4, s40, v3
    v_mul_u32_u24 v4, 160, v4
    v_lshl_add_u32 v176, v2, 3, v4
    v_add_u32 v177, 122880, v176
    v_lshrrev_b32 v5, 2, v3
    v_lshl_add_u32 v4, v2, 2, v5
    v_lshlrev_b32 v4, 7, v4
    v_and_b32 v5, 3, v3
    v_lshl_add_u32 v4, v5, 3, v4
    s_lshl_b32 s40, s34, 5
    s_add_u32 s40, s40, 133120
    v_add_u32 v178, s40, v4
    s_mov_b32 s46, 0xbfb8aa3b
    s_mov_b32 s47, 0xbfb8aa3b
    v_pk_mul_f32 v[8:9], v[116:117], s[46:47]
    v_pk_mul_f32 v[10:11], v[118:119], s[46:47]
    v_pk_mul_f32 v[12:13], v[120:121], s[46:47]
    v_pk_mul_f32 v[14:15], v[122:123], s[46:47]
    v_pk_mul_f32 v[16:17], v[124:125], s[46:47]
    v_pk_mul_f32 v[18:19], v[126:127], s[46:47]
    v_pk_mul_f32 v[20:21], v[128:129], s[46:47]
    v_pk_mul_f32 v[22:23], v[130:131], s[46:47]
    v_pk_mul_f32 v[24:25], v[132:133], s[46:47]
    v_pk_mul_f32 v[26:27], v[134:135], s[46:47]
    s_waitcnt vmcnt(0)
    s_barrier
    ds_read_b64 v[136:137], v177 offset:0
    ds_read_b64 v[138:139], v177 offset:32
    ds_read_b64 v[140:141], v177 offset:64
    ds_read_b64 v[142:143], v177 offset:96
    ds_read_b64 v[144:145], v177 offset:128
    ds_read_b64_tr_b16 v[146:147], v178 offset:0
    ds_read_b64_tr_b16 v[148:149], v178 offset:2048
    ds_read_b64_tr_b16 v[150:151], v178 offset:4096
    ds_read_b64_tr_b16 v[152:153], v178 offset:6144
    ds_read_b64_tr_b16 v[154:155], v178 offset:8192
    v_exp_f32 v8, v8
    v_exp_f32 v9, v9
    v_exp_f32 v10, v10
    v_exp_f32 v11, v11
    v_exp_f32 v12, v12
    v_exp_f32 v13, v13
    v_exp_f32 v14, v14
    v_exp_f32 v15, v15
    v_exp_f32 v16, v16
    v_exp_f32 v17, v17
    v_exp_f32 v18, v18
    v_exp_f32 v19, v19
    v_exp_f32 v20, v20
    v_exp_f32 v21, v21
    v_exp_f32 v22, v22
    v_exp_f32 v23, v23
    v_exp_f32 v24, v24
    v_exp_f32 v25, v25
    v_exp_f32 v26, v26
    v_exp_f32 v27, v27
    v_pk_add_f32 v[8:9], v[8:9], 1.0 op_sel_hi:[1,0]
    v_pk_add_f32 v[10:11], v[10:11], 1.0 op_sel_hi:[1,0]
    v_pk_add_f32 v[12:13], v[12:13], 1.0 op_sel_hi:[1,0]
    v_pk_add_f32 v[14:15], v[14:15], 1.0 op_sel_hi:[1,0]
    v_pk_add_f32 v[16:17], v[16:17], 1.0 op_sel_hi:[1,0]
    v_pk_add_f32 v[18:19], v[18:19], 1.0 op_sel_hi:[1,0]
    v_pk_add_f32 v[20:21], v[20:21], 1.0 op_sel_hi:[1,0]
    v_pk_add_f32 v[22:23], v[22:23], 1.0 op_sel_hi:[1,0]
    v_pk_add_f32 v[24:25], v[24:25], 1.0 op_sel_hi:[1,0]
    v_pk_add_f32 v[26:27], v[26:27], 1.0 op_sel_hi:[1,0]
    v_rcp_f32 v8, v8
    v_rcp_f32 v9, v9
    v_rcp_f32 v10, v10
    v_rcp_f32 v11, v11
    v_rcp_f32 v12, v12
    v_rcp_f32 v13, v13
    v_rcp_f32 v14, v14
    v_rcp_f32 v15, v15
    v_rcp_f32 v16, v16
    v_rcp_f32 v17, v17
    v_rcp_f32 v18, v18
    v_rcp_f32 v19, v19
    v_rcp_f32 v20, v20
    v_rcp_f32 v21, v21
    v_rcp_f32 v22, v22
    v_rcp_f32 v23, v23
    v_rcp_f32 v24, v24
    v_rcp_f32 v25, v25
    v_rcp_f32 v26, v26
    v_rcp_f32 v27, v27
    v_pk_mul_f32 v[8:9], v[8:9], v[116:117]
    v_pk_mul_f32 v[10:11], v[10:11], v[118:119]
    v_pk_mul_f32 v[12:13], v[12:13], v[120:121]
    v_pk_mul_f32 v[14:15], v[14:15], v[122:123]
    v_pk_mul_f32 v[16:17], v[16:17], v[124:125]
    v_pk_mul_f32 v[18:19], v[18:19], v[126:127]
    v_pk_mul_f32 v[20:21], v[20:21], v[128:129]
    v_pk_mul_f32 v[22:23], v[22:23], v[130:131]
    v_pk_mul_f32 v[24:25], v[24:25], v[132:133]
    v_pk_mul_f32 v[26:27], v[26:27], v[134:135]
    s_waitcnt lgkmcnt(0)
    v_lshlrev_b32 v28, 16, v136
    v_and_b32 v29, 0xffff0000, v136
    v_lshlrev_b32 v48, 16, v146
    v_and_b32 v49, 0xffff0000, v146
    v_lshlrev_b32 v30, 16, v137
    v_and_b32 v31, 0xffff0000, v137
    v_lshlrev_b32 v50, 16, v147
    v_and_b32 v51, 0xffff0000, v147
    v_lshlrev_b32 v32, 16, v138
    v_and_b32 v33, 0xffff0000, v138
    v_lshlrev_b32 v52, 16, v148
    v_and_b32 v53, 0xffff0000, v148
    v_lshlrev_b32 v34, 16, v139
    v_and_b32 v35, 0xffff0000, v139
    v_lshlrev_b32 v54, 16, v149
    v_and_b32 v55, 0xffff0000, v149
    v_lshlrev_b32 v36, 16, v140
    v_and_b32 v37, 0xffff0000, v140
    v_lshlrev_b32 v56, 16, v150
    v_and_b32 v57, 0xffff0000, v150
    v_lshlrev_b32 v38, 16, v141
    v_and_b32 v39, 0xffff0000, v141
    v_lshlrev_b32 v58, 16, v151
    v_and_b32 v59, 0xffff0000, v151
    v_lshlrev_b32 v40, 16, v142
    v_and_b32 v41, 0xffff0000, v142
    v_lshlrev_b32 v60, 16, v152
    v_and_b32 v61, 0xffff0000, v152
    v_lshlrev_b32 v42, 16, v143
    v_and_b32 v43, 0xffff0000, v143
    v_lshlrev_b32 v62, 16, v153
    v_and_b32 v63, 0xffff0000, v153
    v_lshlrev_b32 v44, 16, v144
    v_and_b32 v45, 0xffff0000, v144
    v_lshlrev_b32 v64, 16, v154
    v_and_b32 v65, 0xffff0000, v154
    v_lshlrev_b32 v46, 16, v145
    v_and_b32 v47, 0xffff0000, v145
    v_lshlrev_b32 v66, 16, v155
    v_and_b32 v67, 0xffff0000, v155
    v_mov_b32 v180, v111
    v_pk_add_f32 v[68:69], v[28:29], v[110:111] op_sel_hi:[1,0] neg_lo:[0,1] neg_hi:[0,1]
    v_pk_add_f32 v[70:71], v[30:31], v[110:111] op_sel_hi:[1,0] neg_lo:[0,1] neg_hi:[0,1]
    v_pk_add_f32 v[72:73], v[32:33], v[110:111] op_sel_hi:[1,0] neg_lo:[0,1] neg_hi:[0,1]
    v_pk_add_f32 v[74:75], v[34:35], v[110:111] op_sel_hi:[1,0] neg_lo:[0,1] neg_hi:[0,1]
    v_pk_add_f32 v[76:77], v[36:37], v[110:111] op_sel_hi:[1,0] neg_lo:[0,1] neg_hi:[0,1]
    v_pk_add_f32 v[78:79], v[38:39], v[110:111] op_sel_hi:[1,0] neg_lo:[0,1] neg_hi:[0,1]
    v_pk_add_f32 v[80:81], v[40:41], v[110:111] op_sel_hi:[1,0] neg_lo:[0,1] neg_hi:[0,1]
    v_pk_add_f32 v[82:83], v[42:43], v[110:111] op_sel_hi:[1,0] neg_lo:[0,1] neg_hi:[0,1]
    v_pk_add_f32 v[84:85], v[44:45], v[110:111] op_sel_hi:[1,0] neg_lo:[0,1] neg_hi:[0,1]
    v_pk_add_f32 v[86:87], v[46:47], v[110:111] op_sel_hi:[1,0] neg_lo:[0,1] neg_hi:[0,1]
    v_pk_mul_f32 v[68:69], v[68:69], v[180:181] op_sel_hi:[1,0]
    v_pk_mul_f32 v[70:71], v[70:71], v[180:181] op_sel_hi:[1,0]
    v_pk_mul_f32 v[72:73], v[72:73], v[180:181] op_sel_hi:[1,0]
    v_pk_mul_f32 v[74:75], v[74:75], v[180:181] op_sel_hi:[1,0]
    v_pk_mul_f32 v[76:77], v[76:77], v[180:181] op_sel_hi:[1,0]
    v_pk_mul_f32 v[78:79], v[78:79], v[180:181] op_sel_hi:[1,0]
    v_pk_mul_f32 v[80:81], v[80:81], v[180:181] op_sel_hi:[1,0]
    v_pk_mul_f32 v[82:83], v[82:83], v[180:181] op_sel_hi:[1,0]
    v_pk_mul_f32 v[84:85], v[84:85], v[180:181] op_sel_hi:[1,0]
    v_pk_mul_f32 v[86:87], v[86:87], v[180:181] op_sel_hi:[1,0]
    v_pk_mul_f32 v[68:69], v[68:69], v[48:49]
    v_pk_mul_f32 v[70:71], v[70:71], v[50:51]
    v_pk_mul_f32 v[72:73], v[72:73], v[52:53]
    v_pk_mul_f32 v[74:75], v[74:75], v[54:55]
    v_pk_mul_f32 v[76:77], v[76:77], v[56:57]
    v_pk_mul_f32 v[78:79], v[78:79], v[58:59]
    v_pk_mul_f32 v[80:81], v[80:81], v[60:61]
    v_pk_mul_f32 v[82:83], v[82:83], v[62:63]
    v_pk_mul_f32 v[84:85], v[84:85], v[64:65]
    v_pk_mul_f32 v[86:87], v[86:87], v[66:67]
    v_pk_fma_f32 v[68:69], v[68:69], v[8:9], v[28:29]
    v_pk_fma_f32 v[70:71], v[70:71], v[10:11], v[30:31]
    v_pk_fma_f32 v[72:73], v[72:73], v[12:13], v[32:33]
    v_pk_fma_f32 v[74:75], v[74:75], v[14:15], v[34:35]
    v_pk_fma_f32 v[76:77], v[76:77], v[16:17], v[36:37]
    v_pk_fma_f32 v[78:79], v[78:79], v[18:19], v[38:39]
    v_pk_fma_f32 v[80:81], v[80:81], v[20:21], v[40:41]
    v_pk_fma_f32 v[82:83], v[82:83], v[22:23], v[42:43]
    v_pk_fma_f32 v[84:85], v[84:85], v[24:25], v[44:45]
    v_pk_fma_f32 v[86:87], v[86:87], v[26:27], v[46:47]
    v_cvt_pk_bf16_f32 v136, v68, v69
    v_cvt_pk_bf16_f32 v137, v70, v71
    v_cvt_pk_bf16_f32 v138, v72, v73
    v_cvt_pk_bf16_f32 v139, v74, v75
    v_cvt_pk_bf16_f32 v140, v76, v77
    v_cvt_pk_bf16_f32 v141, v78, v79
    v_cvt_pk_bf16_f32 v142, v80, v81
    v_cvt_pk_bf16_f32 v143, v82, v83
    v_cvt_pk_bf16_f32 v144, v84, v85
    v_cvt_pk_bf16_f32 v145, v86, v87
    v_add_u32 v182, 143360, v176
    ds_write_b64 v182, v[136:137] offset:0
    ds_write_b64 v182, v[138:139] offset:32
    ds_write_b64 v182, v[140:141] offset:64
    ds_write_b64 v182, v[142:143] offset:96
    ds_write_b64 v182, v[144:145] offset:128
    s_mul_i32 s40, s34, 2560
    s_add_u32 s40, s40, 143360
    v_add_u32 v4, s40, v7
    s_waitcnt lgkmcnt(0)
    ds_read_b128 v[8:11], v4 offset:0
    ds_read_b128 v[12:15], v4 offset:1024
    ds_read_b128 v[16:19], v4 offset:2048
    s_mul_i32 s40, s34, 20480
    s_add_u32 s40, s40, s45
    s_waitcnt lgkmcnt(0)
    buffer_store_dwordx4 v[8:11], v104, s[16:19], s40 offen
    buffer_store_dwordx4 v[12:15], v105, s[16:19], s40 offen
    s_mov_b32 exec_hi, 0
    buffer_store_dwordx4 v[16:19], v106, s[16:19], s40 offen
    s_mov_b64 exec, -1
k3_kernel_end:
    s_endpgm
.section .rodata,"a"
.p2align 6
.amdhsa_kernel k1_kernel
  .amdhsa_next_free_vgpr 248
  .amdhsa_next_free_sgpr 102
  .amdhsa_accum_offset 248
  .amdhsa_group_segment_fixed_size 0
  .amdhsa_kernarg_size 112
  .amdhsa_user_sgpr_count 2
  .amdhsa_user_sgpr_kernarg_segment_ptr 1
  .amdhsa_system_sgpr_workgroup_id_x 1
.end_amdhsa_kernel
.p2align 6
.amdhsa_kernel k2_kernel
  .amdhsa_next_free_vgpr 197
  .amdhsa_next_free_sgpr 102
  .amdhsa_accum_offset 200
  .amdhsa_group_segment_fixed_size 0
  .amdhsa_kernarg_size 112
  .amdhsa_user_sgpr_count 2
  .amdhsa_user_sgpr_kernarg_segment_ptr 1
  .amdhsa_system_sgpr_workgroup_id_x 1
.end_amdhsa_kernel
.p2align 6
.amdhsa_kernel k3_kernel
  .amdhsa_next_free_vgpr 183
  .amdhsa_next_free_sgpr 102
  .amdhsa_accum_offset 184
  .amdhsa_group_segment_fixed_size 0
  .amdhsa_kernarg_size 112
  .amdhsa_user_sgpr_count 2
  .amdhsa_user_sgpr_kernarg_segment_ptr 1
  .amdhsa_system_sgpr_workgroup_id_x 1
.end_amdhsa_kernel
```

```asm
; @launch kernel=k12_kernel grid=(256,1,1) block=(512,1,1) lds=163840
; @launch kernel=k3_kernel grid=(256,1,1) block=(256,1,1) lds=153600
.amdgcn_target "amdgcn-amd-amdhsa--gfx950"
.text
.globl k12_kernel
.p2align 8
.type k12_kernel,@function
k12_kernel:
    s_cmp_ge_u32 s2, 256
    s_cbranch_scc1 k12_kernel_end
    s_load_dwordx2 s[4:5], s[0:1], 0
    s_load_dwordx2 s[8:9], s[0:1], 56
    s_load_dwordx2 s[12:13], s[0:1], 8
    s_load_dwordx2 s[16:17], s[0:1], 16
    s_load_dwordx2 s[20:21], s[0:1], 24
    s_load_dwordx2 s[24:25], s[0:1], 104
    s_load_dwordx2 s[28:29], s[0:1], 96
    s_load_dwordx2 s[32:33], s[0:1], 64
    s_load_dwordx2 s[36:37], s[0:1], 32
    s_load_dwordx2 s[84:85], s[0:1], 80
    v_lshrrev_b32 v2, 6, v0
    v_and_b32 v1, 63, v0
    v_readfirstlane_b32 s42, v2
    v_lshrrev_b32 v2, 4, v1
    v_and_b32 v3, 15, v1
    s_and_b32 s48, s2, 7
    s_lshr_b32 s49, s2, 3
    s_lshr_b32 s66, s48, 1
    s_and_b32 s67, s48, 1
    s_lshl_b32 s40, s66, 3
    s_and_b32 s48, s49, 7
    s_add_u32 s40, s40, s48
    s_lshl_b32 s41, s67, 2
    s_lshr_b32 s48, s49, 3
    s_add_u32 s41, s41, s48
    s_mul_i32 s52, s40, 81920
    s_mul_i32 s54, s41, 192
    s_add_u32 s53, s54, 1536
    s_lshl_b32 s60, s42, 11
    s_mul_i32 s61, s42, 3072
    s_mov_b32 s6, 2621440
    s_mov_b32 s7, 0x20000
    s_mov_b32 s10, 1966080
    s_mov_b32 s11, 0x20000
    s_lshl_b32 s48, s42, 3
    v_add_u32 v4, s48, v2
    v_and_b32 v5, 15, v4
    v_xor_b32 v5, v5, v3
    v_mul_u32_u24 v4, 1280, v4
    v_lshl_add_u32 v38, v5, 4, v4
    v_add_u32 v4, s48, v2
    v_add_u32 v4, 4, v4
    v_and_b32 v5, 15, v4
    v_xor_b32 v5, v5, v3
    v_mul_u32_u24 v4, 1280, v4
    v_lshl_add_u32 v39, v5, 4, v4
    s_mul_i32 s48, s42, 192
    v_add_u32 v4, s48, v1
    v_mul_u32_u24 v5, 43691, v4
    v_lshrrev_b32 v5, 19, v5
    v_mul_u32_u24 v6, 12, v5
    v_sub_u32 v4, v4, v6
    v_lshrrev_b32 v6, 2, v5
    v_and_b32 v6, 2, v6
    v_xor_b32 v4, v4, v6
    v_mul_u32_u24 v5, 3072, v5
    v_lshl_add_u32 v40, v4, 4, v5
    v_add_u32 v4, s48, v1
    v_add_u32 v4, 64, v4
    v_mul_u32_u24 v5, 43691, v4
    v_lshrrev_b32 v5, 19, v5
    v_mul_u32_u24 v6, 12, v5
    v_sub_u32 v4, v4, v6
    v_lshrrev_b32 v6, 2, v5
    v_and_b32 v6, 2, v6
    v_xor_b32 v4, v4, v6
    v_mul_u32_u24 v5, 3072, v5
    v_lshl_add_u32 v41, v4, 4, v5
    v_add_u32 v4, s48, v1
    v_add_u32 v4, 128, v4
    v_mul_u32_u24 v5, 43691, v4
    v_lshrrev_b32 v5, 19, v5
    v_mul_u32_u24 v6, 12, v5
    v_sub_u32 v4, v4, v6
    v_lshrrev_b32 v6, 2, v5
    v_and_b32 v6, 2, v6
    v_xor_b32 v4, v4, v6
    v_mul_u32_u24 v5, 3072, v5
    v_lshl_add_u32 v42, v4, 4, v5
    s_add_u32 s48, s40, s41
    s_mul_i32 s49, s48, 52
    s_lshr_b32 s49, s49, 8
    s_mul_i32 s49, s49, 5
    s_sub_u32 s51, s48, s49
    s_add_u32 s49, s51, 0
    s_sub_u32 s50, s49, 5
    s_cmp_ge_u32 s49, 5
    s_cselect_b32 s49, s50, s49
    s_lshl_b32 s90, s49, 8
    s_mul_i32 s95, s49, 393216
    s_add_u32 s49, s51, 1
    s_sub_u32 s50, s49, 5
    s_cmp_ge_u32 s49, 5
    s_cselect_b32 s49, s50, s49
    s_lshl_b32 s91, s49, 8
    s_mul_i32 s96, s49, 393216
    s_waitcnt lgkmcnt(0)
    s_add_u32 s65, s52, s90
    s_add_u32 m0, s60, 0
    s_nop 0
    buffer_load_dwordx4 v38, s[4:7], s65 offen lds
    s_add_u32 s65, s52, s90
    s_add_u32 m0, s60, 1024
    s_nop 0
    buffer_load_dwordx4 v39, s[4:7], s65 offen lds
    s_add_u32 s65, s53, s95
    s_add_u32 m0, s61, 81920
    s_nop 0
    buffer_load_dwordx4 v40, s[8:11], s65 offen lds
    s_add_u32 s65, s53, s95
    s_add_u32 m0, s61, 82944
    s_nop 0
    buffer_load_dwordx4 v41, s[8:11], s65 offen lds
    s_add_u32 s65, s53, s95
    s_add_u32 m0, s61, 83968
    s_nop 0
    buffer_load_dwordx4 v42, s[8:11], s65 offen lds
    s_mov_b32 s48, 14712832
    s_load_dwordx2 s[100:101], s[24:25], s48
    s_add_u32 s49, s51, 2
    s_sub_u32 s50, s49, 5
    s_cmp_ge_u32 s49, 5
    s_cselect_b32 s49, s50, s49
    s_lshl_b32 s92, s49, 8
    s_mul_i32 s97, s49, 393216
    s_add_u32 s49, s51, 3
    s_sub_u32 s50, s49, 5
    s_cmp_ge_u32 s49, 5
    s_cselect_b32 s49, s50, s49
    s_lshl_b32 s93, s49, 8
    s_mul_i32 s98, s49, 393216
    s_add_u32 s49, s51, 4
    s_sub_u32 s50, s49, 5
    s_cmp_ge_u32 s49, 5
    s_cselect_b32 s49, s50, s49
    s_lshl_b32 s94, s49, 8
    s_mul_i32 s99, s49, 393216
    s_mov_b32 s14, 2621440
    s_mov_b32 s15, 0x20000
    s_mov_b32 s18, 2621440
    s_mov_b32 s19, 0x20000
    s_mov_b32 s22, 5120
    s_mov_b32 s23, 0x20000
    s_mov_b32 s26, 15990784
    s_mov_b32 s27, 0x20000
    s_mov_b32 s30, 256
    s_mov_b32 s31, 0x20000
    s_mov_b32 s34, 8388608
    s_mov_b32 s35, 0x20000
    s_mov_b32 s38, 2621440
    s_mov_b32 s39, 0x20000
    s_mov_b32 s86, 983040
    s_mov_b32 s87, 0x20000
    v_lshlrev_b32 v36, 7, v1
    v_mov_b32 v4, 161792
    v_mov_b32 v8, 0
    v_mov_b32 v9, 0
    ds_write_b64 v4, v[8:9]
    s_barrier
    s_add_u32 s65, s52, s91
    s_add_u32 m0, s60, 16384
    s_nop 0
    buffer_load_dwordx4 v38, s[4:7], s65 offen lds
    s_add_u32 s65, s52, s91
    s_add_u32 m0, s60, 17408
    s_nop 0
    buffer_load_dwordx4 v39, s[4:7], s65 offen lds
    s_add_u32 s65, s53, s96
    s_add_u32 m0, s61, 106496
    s_nop 0
    buffer_load_dwordx4 v40, s[8:11], s65 offen lds
    s_add_u32 s65, s53, s96
    s_add_u32 m0, s61, 107520
    s_nop 0
    buffer_load_dwordx4 v41, s[8:11], s65 offen lds
    s_add_u32 s65, s53, s96
    s_add_u32 m0, s61, 108544
    s_nop 0
    buffer_load_dwordx4 v42, s[8:11], s65 offen lds
    s_cmp_lg_u32 s42, 7
    s_cbranch_scc1 k1_shk_1
    v_lshlrev_b32 v4, 4, v1
    s_mul_i32 s48, s41, 640
    s_mov_b32 m0, 160768
    s_mov_b32 exec_lo, -1
    s_mov_b32 exec_hi, 0xff
    buffer_load_dwordx4 v4, s[20:23], s48 offen lds
    s_mov_b64 exec, -1
k1_shk_1:
    s_and_b32 s43, s42, 1
    s_lshr_b32 s44, s42, 1
    s_and_b32 s44, s44, 1
    s_lshr_b32 s45, s42, 2
    s_xor_b32 s46, s43, s45
    s_lshl_b32 s47, s44, 1
    s_add_u32 s47, s47, s46
    s_mov_b32 s55, 0x3727c5ac
    s_mov_b32 s56, 0x3f803f80
    s_mov_b32 s58, 0xbdd2d3e8
    s_mov_b32 s59, 0xbdd2d3e8
    s_lshl_b32 s48, s45, 1
    s_add_u32 s63, s48, s44
    s_xor_b32 s64, s63, 1
    v_xor_b32 v4, v2, v3
    v_lshlrev_b32 v6, 8, v3
    s_lshl_b32 s48, s44, 13
    s_lshl_b32 s49, s46, 12
    s_add_u32 s50, s48, s49
    s_xor_b32 s49, s49, 4096
    s_add_u32 s51, s48, s49
    s_lshl_b32 s48, s63, 2
    v_xor_b32 v5, s48, v4
    v_lshl_add_u32 v5, v5, 4, v6
    v_add_u32 v45, s50, v5
    v_add_u32 v46, s51, v5
    s_lshl_b32 s48, s64, 2
    v_xor_b32 v5, s48, v4
    v_lshl_add_u32 v5, v5, 4, v6
    v_add_u32 v47, s50, v5
    v_add_u32 v216, s51, v5
    v_lshrrev_b32 v5, 2, v3
    v_lshl_add_u32 v4, v2, 3, v5
    v_mul_u32_u24 v4, 192, v4
    v_and_b32 v5, 3, v3
    v_lshl_add_u32 v4, v5, 3, v4
    v_and_b32 v5, 1, v2
    s_mul_i32 s51, s43, 3
    s_mul_i32 s49, s63, 6144
    s_add_u32 s49, s49, 81920
    s_mul_i32 s50, s64, 6144
    s_add_u32 s50, s50, 81920
    s_add_u32 s48, s51, 0
    v_xor_b32 v6, s48, v5
    v_lshl_add_u32 v6, v6, 5, v4
    v_add_u32 v217, s49, v6
    v_add_u32 v220, s50, v6
    s_add_u32 s48, s51, 1
    v_xor_b32 v6, s48, v5
    v_lshl_add_u32 v6, v6, 5, v4
    v_add_u32 v218, s49, v6
    v_add_u32 v221, s50, v6
    s_add_u32 s48, s51, 2
    v_xor_b32 v6, s48, v5
    v_lshl_add_u32 v6, v6, 5, v4
    v_add_u32 v219, s49, v6
    v_add_u32 v222, s50, v6
    v_mov_b32 v244, s56
    v_mov_b32 v245, s56
    v_mov_b32 v246, s56
    v_mov_b32 v247, s56
    v_mul_u32_u24 v43, 205, v1
    v_lshrrev_b32 v43, 11, v43
    v_mul_u32_u24 v4, 10, v43
    v_sub_u32 v44, v1, v4
    s_lshl_b32 s48, s42, 3
    v_lshl_add_u32 v4, v43, 1, s48
    v_min_u32 v4, 62, v4
    v_mul_u32_u24 v4, 160, v4
    v_lshl_add_u32 v7, v44, 4, v4
    v_lshlrev_b32 v215, 10, v1
    s_lshl_b32 s89, s2, 3
    s_add_u32 s89, s89, s42
    s_mul_i32 s70, s42, 3072
    s_add_u32 s70, s70, 16384
    s_xor_b32 s48, s42, 4
    s_mul_i32 s71, s48, 3072
    s_add_u32 s71, s71, 16384
    s_lshl_b32 s48, s43, 2
    s_lshl_b32 s49, s44, 1
    s_add_u32 s48, s48, s49
    s_add_u32 s48, s48, s45
    s_mul_i32 s72, s48, 192
    s_add_u32 s72, s72, 155648
    s_mul_i32 s73, s43, 768
    s_add_u32 s73, s73, 155648
    s_lshl_b32 s48, s47, 1
    s_add_u32 s48, s48, s45
    s_lshl_b32 s48, s48, 7
    s_add_u32 s74, s48, 158720
    s_lshl_b32 s48, s47, 8
    s_add_u32 s75, s48, 158720
    s_lshl_b32 s48, s47, 7
    s_lshl_b32 s49, s43, 9
    s_add_u32 s48, s48, s49
    s_add_u32 s76, s48, 159744
    s_lshl_b32 s48, s40, 3
    s_add_u32 s48, s48, s41
    s_lshl_b32 s49, s48, 10
    s_add_u32 s77, s49, 14745600
    s_mov_b32 s48, 0
    s_lshr_b32 s49, s47, 1
    s_mul_i32 s49, s49, 6144
    s_add_u32 s48, s48, s49
    s_and_b32 s49, s47, 1
    s_lshl_b32 s49, s49, 8
    s_add_u32 s48, s48, s49
    s_add_u32 s48, s48, 73728
    s_mul_i32 s49, s43, 3
    s_add_u32 s49, s49, 0
    s_lshr_b32 s50, s49, 1
    s_lshl_b32 s50, s50, 10
    s_and_b32 s49, s49, 1
    s_lshl_b32 s49, s49, 3
    s_add_u32 s80, s48, s49
    s_add_u32 s80, s80, s50
    s_mul_i32 s49, s43, 3
    s_add_u32 s49, s49, 1
    s_lshr_b32 s50, s49, 1
    s_lshl_b32 s50, s50, 10
    s_and_b32 s49, s49, 1
    s_lshl_b32 s49, s49, 3
    s_add_u32 s81, s48, s49
    s_add_u32 s81, s81, s50
    s_mul_i32 s49, s43, 3
    s_add_u32 s49, s49, 2
    s_lshr_b32 s50, s49, 1
    s_lshl_b32 s50, s50, 10
    s_and_b32 s49, s49, 1
    s_lshl_b32 s49, s49, 3
    s_add_u32 s82, s48, s49
    s_add_u32 s82, s82, s50
    s_lshl_b32 s48, s40, 13
    s_lshl_b32 s49, s47, 8
    s_add_u32 s48, s48, s49
    s_add_u32 s78, s48, 14745600
    s_lshl_b32 s48, s40, 9
    s_lshl_b32 s49, s47, 7
    s_add_u32 s48, s48, s49
    s_add_u32 s79, s48, 14680064
    s_mul_i32 s48, s41, 327680
    s_lshl_b32 s49, s40, 7
    s_add_u32 s48, s48, s49
    s_add_u32 s83, s48, 6291456
    s_lshr_b32 s48, s2, 3
    s_lshl_b32 s48, s48, 3
    s_add_u32 s48, s48, s42
    s_lshl_b32 s48, s48, 13
    s_lshl_b32 s49, s66, 21
    s_add_u32 s66, s48, s49
    s_add_u32 s51, s42, 0
    s_mul_i32 s48, s51, 43
    s_lshr_b32 s48, s48, 7
    s_mul_i32 s49, s48, 3
    s_sub_u32 s49, s51, s49
    s_mul_i32 s48, s48, 3200
    s_lshl_b32 s49, s49, 6
    s_add_u32 s48, s48, s49
    s_add_u32 s88, s48, 0
    s_lshl_b32 s48, s41, 7
    s_lshl_b32 s49, s40, 2
    s_add_u32 s48, s48, s49
    s_mul_i32 s48, s48, 3
    s_add_u32 s48, s48, s51
    s_lshl_b32 s48, s48, 10
    s_add_u32 s64, s48, 0
    s_add_u32 s51, s42, 8
    s_mul_i32 s48, s51, 43
    s_lshr_b32 s48, s48, 7
    s_mul_i32 s49, s48, 3
    s_sub_u32 s49, s51, s49
    s_mul_i32 s48, s48, 3200
    s_lshl_b32 s49, s49, 6
    s_add_u32 s48, s48, s49
    s_add_u32 s63, s48, 0
    s_lshl_b32 s48, s41, 7
    s_lshl_b32 s49, s40, 2
    s_add_u32 s48, s48, s49
    s_mul_i32 s48, s48, 3
    s_add_u32 s48, s48, s51
    s_lshl_b32 s48, s48, 10
    s_add_u32 s67, s48, 0
    s_waitcnt vmcnt(5)
    s_waitcnt lgkmcnt(0)
    s_add_u32 s100, s100, 1
    s_addc_u32 s101, s101, 0
    s_barrier
    ds_read_b64_tr_b16 v[128:129], v217 offset:0
    ds_read_b64_tr_b16 v[130:131], v217 offset:768
    ds_read_b64_tr_b16 v[132:133], v218 offset:0
    ds_read_b64_tr_b16 v[134:135], v218 offset:768
    ds_read_b64_tr_b16 v[136:137], v219 offset:0
    ds_read_b64_tr_b16 v[138:139], v219 offset:768
    ds_read_b64_tr_b16 v[140:141], v220 offset:0
    ds_read_b64_tr_b16 v[142:143], v220 offset:768
    ds_read_b64_tr_b16 v[144:145], v221 offset:0
    ds_read_b64_tr_b16 v[146:147], v221 offset:768
    ds_read_b64_tr_b16 v[148:149], v222 offset:0
    ds_read_b64_tr_b16 v[150:151], v222 offset:768
    ds_read_b128 v[48:51], v45 offset:0
    ds_read_b128 v[52:55], v46 offset:0
    ds_read_b128 v[56:59], v47 offset:0
    ds_read_b128 v[60:63], v216 offset:0
    s_add_u32 s65, s52, s92
    s_add_u32 m0, s60, 32768
    s_nop 0
    buffer_load_dwordx4 v38, s[4:7], s65 offen lds
    s_add_u32 s65, s52, s92
    s_add_u32 m0, s60, 33792
    s_nop 0
    buffer_load_dwordx4 v39, s[4:7], s65 offen lds
    s_add_u32 s65, s53, s97
    s_add_u32 m0, s61, 131072
    s_nop 0
    buffer_load_dwordx4 v40, s[8:11], s65 offen lds
    s_add_u32 s65, s53, s97
    s_add_u32 m0, s61, 132096
    s_nop 0
    buffer_load_dwordx4 v41, s[8:11], s65 offen lds
    s_add_u32 s65, s53, s97
    s_add_u32 m0, s61, 133120
    s_nop 0
    buffer_load_dwordx4 v42, s[8:11], s65 offen lds
    s_waitcnt vmcnt(5)
    s_waitcnt lgkmcnt(0)
    s_barrier
    v_mfma_f32_16x16x32_bf16 v[176:179], v[128:131], v[48:51], 0
    ds_read_b64_tr_b16 v[152:153], v217 offset:24576
    ds_read_b64_tr_b16 v[154:155], v217 offset:25344
    v_mfma_f32_16x16x32_bf16 v[180:183], v[128:131], v[52:55], 0
    s_add_u32 s65, s52, s93
    s_add_u32 m0, s60, 49152
    s_nop 0
    buffer_load_dwordx4 v38, s[4:7], s65 offen lds
    ds_read_b64_tr_b16 v[156:157], v218 offset:24576
    ds_read_b64_tr_b16 v[158:159], v218 offset:25344
    v_mfma_f32_16x16x32_bf16 v[224:227], v[128:131], v[244:247], 0
    ds_read_b64_tr_b16 v[160:161], v219 offset:24576
    ds_read_b64_tr_b16 v[162:163], v219 offset:25344
    v_mfma_f32_16x16x32_bf16 v[184:187], v[132:135], v[48:51], 0
    ds_read_b64_tr_b16 v[164:165], v220 offset:24576
    ds_read_b64_tr_b16 v[166:167], v220 offset:25344
    v_mfma_f32_16x16x32_bf16 v[188:191], v[132:135], v[52:55], 0
    s_add_u32 s65, s52, s93
    s_add_u32 m0, s60, 50176
    s_nop 0
    buffer_load_dwordx4 v39, s[4:7], s65 offen lds
    ds_read_b64_tr_b16 v[168:169], v221 offset:24576
    ds_read_b64_tr_b16 v[170:171], v221 offset:25344
    v_mfma_f32_16x16x32_bf16 v[228:231], v[132:135], v[244:247], 0
    ds_read_b64_tr_b16 v[172:173], v222 offset:24576
    ds_read_b64_tr_b16 v[174:175], v222 offset:25344
    v_mfma_f32_16x16x32_bf16 v[192:195], v[136:139], v[48:51], 0
    ds_read_b128 v[64:67], v45 offset:16384
    ds_read_b128 v[68:71], v46 offset:16384
    v_mfma_f32_16x16x32_bf16 v[196:199], v[136:139], v[52:55], 0
    s_add_u32 s65, s53, s98
    s_add_u32 m0, s61, 81920
    s_nop 0
    buffer_load_dwordx4 v40, s[8:11], s65 offen lds
    ds_read_b128 v[72:75], v47 offset:16384
    ds_read_b128 v[76:79], v216 offset:16384
    v_mfma_f32_16x16x32_bf16 v[232:235], v[136:139], v[244:247], 0
    v_mfma_f32_16x16x32_bf16 v[236:239], v[244:247], v[48:51], 0
    v_mfma_f32_16x16x32_bf16 v[240:243], v[48:51], v[48:51], 0
    s_add_u32 s65, s53, s98
    s_add_u32 m0, s61, 82944
    s_nop 0
    buffer_load_dwordx4 v41, s[8:11], s65 offen lds
    v_mfma_f32_16x16x32_bf16 v[176:179], v[140:143], v[56:59], v[176:179]
    v_mfma_f32_16x16x32_bf16 v[180:183], v[140:143], v[60:63], v[180:183]
    v_mfma_f32_16x16x32_bf16 v[184:187], v[144:147], v[56:59], v[184:187]
    s_add_u32 s65, s53, s98
    s_add_u32 m0, s61, 83968
    s_nop 0
    buffer_load_dwordx4 v42, s[8:11], s65 offen lds
    v_mfma_f32_16x16x32_bf16 v[188:191], v[144:147], v[60:63], v[188:191]
    v_mfma_f32_16x16x32_bf16 v[192:195], v[148:151], v[56:59], v[192:195]
    v_mfma_f32_16x16x32_bf16 v[196:199], v[148:151], v[60:63], v[196:199]
    v_mfma_f32_16x16x32_bf16 v[236:239], v[244:247], v[56:59], v[236:239]
    v_mfma_f32_16x16x32_bf16 v[240:243], v[56:59], v[56:59], v[240:243]
    s_waitcnt vmcnt(5)
    s_waitcnt lgkmcnt(0)
    s_barrier
    v_mfma_f32_16x16x32_bf16 v[176:179], v[152:155], v[64:67], v[176:179]
    ds_read_b64_tr_b16 v[128:129], v217 offset:49152
    ds_read_b64_tr_b16 v[130:131], v217 offset:49920
    v_mfma_f32_16x16x32_bf16 v[180:183], v[152:155], v[68:71], v[180:183]
    s_add_u32 s65, s52, s94
    s_add_u32 m0, s60, 65536
    s_nop 0
    buffer_load_dwordx4 v38, s[4:7], s65 offen lds
    ds_read_b64_tr_b16 v[132:133], v218 offset:49152
    ds_read_b64_tr_b16 v[134:135], v218 offset:49920
    v_mfma_f32_16x16x32_bf16 v[224:227], v[152:155], v[244:247], v[224:227]
    ds_read_b64_tr_b16 v[136:137], v219 offset:49152
    ds_read_b64_tr_b16 v[138:139], v219 offset:49920
    v_mfma_f32_16x16x32_bf16 v[184:187], v[156:159], v[64:67], v[184:187]
    ds_read_b64_tr_b16 v[140:141], v220 offset:49152
    ds_read_b64_tr_b16 v[142:143], v220 offset:49920
    v_mfma_f32_16x16x32_bf16 v[188:191], v[156:159], v[68:71], v[188:191]
    s_add_u32 s65, s52, s94
    s_add_u32 m0, s60, 66560
    s_nop 0
    buffer_load_dwordx4 v39, s[4:7], s65 offen lds
    ds_read_b64_tr_b16 v[144:145], v221 offset:49152
    ds_read_b64_tr_b16 v[146:147], v221 offset:49920
    v_mfma_f32_16x16x32_bf16 v[228:231], v[156:159], v[244:247], v[228:231]
    ds_read_b64_tr_b16 v[148:149], v222 offset:49152
    ds_read_b64_tr_b16 v[150:151], v222 offset:49920
    v_mfma_f32_16x16x32_bf16 v[192:195], v[160:163], v[64:67], v[192:195]
    ds_read_b128 v[80:83], v45 offset:32768
    ds_read_b128 v[84:87], v46 offset:32768
    v_mfma_f32_16x16x32_bf16 v[196:199], v[160:163], v[68:71], v[196:199]
    s_add_u32 s65, s53, s99
    s_add_u32 m0, s61, 106496
    s_nop 0
    buffer_load_dwordx4 v40, s[8:11], s65 offen lds
    ds_read_b128 v[88:91], v47 offset:32768
    ds_read_b128 v[92:95], v216 offset:32768
    v_mfma_f32_16x16x32_bf16 v[232:235], v[160:163], v[244:247], v[232:235]
    v_mfma_f32_16x16x32_bf16 v[236:239], v[244:247], v[64:67], v[236:239]
    v_mfma_f32_16x16x32_bf16 v[240:243], v[64:67], v[64:67], v[240:243]
    s_add_u32 s65, s53, s99
    s_add_u32 m0, s61, 107520
    s_nop 0
    buffer_load_dwordx4 v41, s[8:11], s65 offen lds
    v_mfma_f32_16x16x32_bf16 v[176:179], v[164:167], v[72:75], v[176:179]
    v_mfma_f32_16x16x32_bf16 v[180:183], v[164:167], v[76:79], v[180:183]
    v_mfma_f32_16x16x32_bf16 v[184:187], v[168:171], v[72:75], v[184:187]
    s_add_u32 s65, s53, s99
    s_add_u32 m0, s61, 108544
    s_nop 0
    buffer_load_dwordx4 v42, s[8:11], s65 offen lds
    v_mfma_f32_16x16x32_bf16 v[188:191], v[168:171], v[76:79], v[188:191]
    v_mfma_f32_16x16x32_bf16 v[192:195], v[172:175], v[72:75], v[192:195]
    v_mfma_f32_16x16x32_bf16 v[196:199], v[172:175], v[76:79], v[196:199]
    v_mfma_f32_16x16x32_bf16 v[236:239], v[244:247], v[72:75], v[236:239]
    v_mfma_f32_16x16x32_bf16 v[240:243], v[72:75], v[72:75], v[240:243]
    s_waitcnt vmcnt(5)
    s_waitcnt lgkmcnt(0)
    s_barrier
    v_mfma_f32_16x16x32_bf16 v[176:179], v[128:131], v[80:83], v[176:179]
    ds_read_b64_tr_b16 v[152:153], v217 offset:0
    ds_read_b64_tr_b16 v[154:155], v217 offset:768
    v_mfma_f32_16x16x32_bf16 v[180:183], v[128:131], v[84:87], v[180:183]
    s_add_u32 s65, s54, s95
    s_add_u32 m0, s61, 131072
    s_nop 0
    buffer_load_dwordx4 v40, s[8:11], s65 offen lds
    ds_read_b64_tr_b16 v[156:157], v218 offset:0
    ds_read_b64_tr_b16 v[158:159], v218 offset:768
    v_mfma_f32_16x16x32_bf16 v[224:227], v[128:131], v[244:247], v[224:227]
    ds_read_b64_tr_b16 v[160:161], v219 offset:0
    ds_read_b64_tr_b16 v[162:163], v219 offset:768
    v_mfma_f32_16x16x32_bf16 v[184:187], v[132:135], v[80:83], v[184:187]
    ds_read_b64_tr_b16 v[164:165], v220 offset:0
    ds_read_b64_tr_b16 v[166:167], v220 offset:768
    v_mfma_f32_16x16x32_bf16 v[188:191], v[132:135], v[84:87], v[188:191]
    s_add_u32 s65, s54, s95
    s_add_u32 m0, s61, 132096
    s_nop 0
    buffer_load_dwordx4 v41, s[8:11], s65 offen lds
    ds_read_b64_tr_b16 v[168:169], v221 offset:0
    ds_read_b64_tr_b16 v[170:171], v221 offset:768
    v_mfma_f32_16x16x32_bf16 v[228:231], v[132:135], v[244:247], v[228:231]
    ds_read_b64_tr_b16 v[172:173], v222 offset:0
    ds_read_b64_tr_b16 v[174:175], v222 offset:768
    v_mfma_f32_16x16x32_bf16 v[192:195], v[136:139], v[80:83], v[192:195]
    ds_read_b128 v[96:99], v45 offset:49152
    ds_read_b128 v[100:103], v46 offset:49152
    v_mfma_f32_16x16x32_bf16 v[196:199], v[136:139], v[84:87], v[196:199]
    s_add_u32 s65, s54, s95
    s_add_u32 m0, s61, 133120
    s_nop 0
    buffer_load_dwordx4 v42, s[8:11], s65 offen lds
    ds_read_b128 v[104:107], v47 offset:49152
    ds_read_b128 v[108:111], v216 offset:49152
    v_mfma_f32_16x16x32_bf16 v[232:235], v[136:139], v[244:247], v[232:235]
    v_mfma_f32_16x16x32_bf16 v[236:239], v[244:247], v[80:83], v[236:239]
    v_mfma_f32_16x16x32_bf16 v[240:243], v[80:83], v[80:83], v[240:243]
    v_mfma_f32_16x16x32_bf16 v[176:179], v[140:143], v[88:91], v[176:179]
    v_mfma_f32_16x16x32_bf16 v[180:183], v[140:143], v[92:95], v[180:183]
    v_mfma_f32_16x16x32_bf16 v[184:187], v[144:147], v[88:91], v[184:187]
    v_mfma_f32_16x16x32_bf16 v[188:191], v[144:147], v[92:95], v[188:191]
    v_mfma_f32_16x16x32_bf16 v[192:195], v[148:151], v[88:91], v[192:195]
    v_mfma_f32_16x16x32_bf16 v[196:199], v[148:151], v[92:95], v[196:199]
    v_mfma_f32_16x16x32_bf16 v[236:239], v[244:247], v[88:91], v[236:239]
    v_mfma_f32_16x16x32_bf16 v[240:243], v[88:91], v[88:91], v[240:243]
    s_waitcnt vmcnt(3)
    s_waitcnt lgkmcnt(0)
    s_barrier
    v_mfma_f32_16x16x32_bf16 v[176:179], v[152:155], v[96:99], v[176:179]
    ds_read_b64_tr_b16 v[128:129], v217 offset:24576
    ds_read_b64_tr_b16 v[130:131], v217 offset:25344
    v_mfma_f32_16x16x32_bf16 v[180:183], v[152:155], v[100:103], v[180:183]
    s_add_u32 s65, s54, s96
    s_add_u32 m0, s61, 81920
    s_nop 0
    buffer_load_dwordx4 v40, s[8:11], s65 offen lds
    ds_read_b64_tr_b16 v[132:133], v218 offset:24576
    ds_read_b64_tr_b16 v[134:135], v218 offset:25344
    v_mfma_f32_16x16x32_bf16 v[224:227], v[152:155], v[244:247], v[224:227]
    ds_read_b64_tr_b16 v[136:137], v219 offset:24576
    ds_read_b64_tr_b16 v[138:139], v219 offset:25344
    v_mfma_f32_16x16x32_bf16 v[184:187], v[156:159], v[96:99], v[184:187]
    ds_read_b64_tr_b16 v[140:141], v220 offset:24576
    ds_read_b64_tr_b16 v[142:143], v220 offset:25344
    v_mfma_f32_16x16x32_bf16 v[188:191], v[156:159], v[100:103], v[188:191]
    s_add_u32 s65, s54, s96
    s_add_u32 m0, s61, 82944
    s_nop 0
    buffer_load_dwordx4 v41, s[8:11], s65 offen lds
    ds_read_b64_tr_b16 v[144:145], v221 offset:24576
    ds_read_b64_tr_b16 v[146:147], v221 offset:25344
    v_mfma_f32_16x16x32_bf16 v[228:231], v[156:159], v[244:247], v[228:231]
    ds_read_b64_tr_b16 v[148:149], v222 offset:24576
    ds_read_b64_tr_b16 v[150:151], v222 offset:25344
    v_mfma_f32_16x16x32_bf16 v[192:195], v[160:163], v[96:99], v[192:195]
    v_add_u32 v45, 0x10000, v45
    v_add_u32 v46, 0x10000, v46
    v_add_u32 v47, 0x10000, v47
    v_add_u32 v216, 0x10000, v216
    ds_read_b128 v[112:115], v45 offset:0
    ds_read_b128 v[116:119], v46 offset:0
    v_mfma_f32_16x16x32_bf16 v[196:199], v[160:163], v[100:103], v[196:199]
    s_add_u32 s65, s54, s96
    s_add_u32 m0, s61, 83968
    s_nop 0
    buffer_load_dwordx4 v42, s[8:11], s65 offen lds
    ds_read_b128 v[120:123], v47 offset:0
    ds_read_b128 v[124:127], v216 offset:0
    v_mfma_f32_16x16x32_bf16 v[232:235], v[160:163], v[244:247], v[232:235]
    v_mfma_f32_16x16x32_bf16 v[236:239], v[244:247], v[96:99], v[236:239]
    v_mfma_f32_16x16x32_bf16 v[240:243], v[96:99], v[96:99], v[240:243]
    v_mfma_f32_16x16x32_bf16 v[176:179], v[164:167], v[104:107], v[176:179]
    v_mfma_f32_16x16x32_bf16 v[180:183], v[164:167], v[108:111], v[180:183]
    v_mfma_f32_16x16x32_bf16 v[184:187], v[168:171], v[104:107], v[184:187]
    v_mfma_f32_16x16x32_bf16 v[188:191], v[168:171], v[108:111], v[188:191]
    v_mfma_f32_16x16x32_bf16 v[192:195], v[172:175], v[104:107], v[192:195]
    v_mfma_f32_16x16x32_bf16 v[196:199], v[172:175], v[108:111], v[196:199]
    v_mfma_f32_16x16x32_bf16 v[236:239], v[244:247], v[104:107], v[236:239]
    v_mfma_f32_16x16x32_bf16 v[240:243], v[104:107], v[104:107], v[240:243]
    s_waitcnt vmcnt(3)
    s_waitcnt lgkmcnt(0)
    s_barrier
    v_mfma_f32_16x16x32_bf16 v[176:179], v[128:131], v[112:115], v[176:179]
    ds_read_b64_tr_b16 v[152:153], v217 offset:49152
    ds_read_b64_tr_b16 v[154:155], v217 offset:49920
    v_mfma_f32_16x16x32_bf16 v[180:183], v[128:131], v[116:119], v[180:183]
    s_add_u32 s65, s54, s97
    s_add_u32 m0, s61, 106496
    s_nop 0
    buffer_load_dwordx4 v40, s[8:11], s65 offen lds
    ds_read_b64_tr_b16 v[156:157], v218 offset:49152
    ds_read_b64_tr_b16 v[158:159], v218 offset:49920
    v_mfma_f32_16x16x32_bf16 v[224:227], v[128:131], v[244:247], v[224:227]
    ds_read_b64_tr_b16 v[160:161], v219 offset:49152
    ds_read_b64_tr_b16 v[162:163], v219 offset:49920
    v_mfma_f32_16x16x32_bf16 v[184:187], v[132:135], v[112:115], v[184:187]
    ds_read_b64_tr_b16 v[164:165], v220 offset:49152
    ds_read_b64_tr_b16 v[166:167], v220 offset:49920
    v_mfma_f32_16x16x32_bf16 v[188:191], v[132:135], v[116:119], v[188:191]
    s_add_u32 s65, s54, s97
    s_add_u32 m0, s61, 107520
    s_nop 0
    buffer_load_dwordx4 v41, s[8:11], s65 offen lds
    ds_read_b64_tr_b16 v[168:169], v221 offset:49152
    ds_read_b64_tr_b16 v[170:171], v221 offset:49920
    v_mfma_f32_16x16x32_bf16 v[228:231], v[132:135], v[244:247], v[228:231]
    ds_read_b64_tr_b16 v[172:173], v222 offset:49152
    ds_read_b64_tr_b16 v[174:175], v222 offset:49920
    v_mfma_f32_16x16x32_bf16 v[192:195], v[136:139], v[112:115], v[192:195]
    v_mfma_f32_16x16x32_bf16 v[196:199], v[136:139], v[116:119], v[196:199]
    s_add_u32 s65, s54, s97
    s_add_u32 m0, s61, 108544
    s_nop 0
    buffer_load_dwordx4 v42, s[8:11], s65 offen lds
    v_mfma_f32_16x16x32_bf16 v[232:235], v[136:139], v[244:247], v[232:235]
    v_mfma_f32_16x16x32_bf16 v[236:239], v[244:247], v[112:115], v[236:239]
    v_mfma_f32_16x16x32_bf16 v[240:243], v[112:115], v[112:115], v[240:243]
    v_mfma_f32_16x16x32_bf16 v[176:179], v[140:143], v[120:123], v[176:179]
    v_mfma_f32_16x16x32_bf16 v[180:183], v[140:143], v[124:127], v[180:183]
    v_mfma_f32_16x16x32_bf16 v[184:187], v[144:147], v[120:123], v[184:187]
    v_mfma_f32_16x16x32_bf16 v[188:191], v[144:147], v[124:127], v[188:191]
    v_mfma_f32_16x16x32_bf16 v[192:195], v[148:151], v[120:123], v[192:195]
    v_mfma_f32_16x16x32_bf16 v[196:199], v[148:151], v[124:127], v[196:199]
    v_mfma_f32_16x16x32_bf16 v[236:239], v[244:247], v[120:123], v[236:239]
    v_mfma_f32_16x16x32_bf16 v[240:243], v[120:123], v[120:123], v[240:243]
    v_lshl_add_u32 v4, v1, 4, s70
    v_lshl_add_u32 v5, v2, 4, s72
    ds_write_b128 v4, v[180:183] offset:0
    s_nop 0
    ds_write_b128 v4, v[188:191] offset:1024
    s_nop 0
    ds_write_b128 v4, v[196:199] offset:2048
    s_mov_b32 exec_lo, 0x00010001
    s_mov_b32 exec_hi, 0x00010001
    ds_write_b128 v5, v[224:227] offset:0
    ds_write_b128 v5, v[228:231] offset:64
    ds_write_b128 v5, v[232:235] offset:128
    s_mov_b64 exec, -1
    v_and_b32 v8, 3, v3
    v_cmp_eq_u32 vcc, 1, v8
    s_nop 1
    v_cndmask_b32 v237, v240, v241, vcc
    v_cmp_eq_u32 vcc, 2, v8
    s_nop 1
    v_cndmask_b32 v237, v237, v242, vcc
    v_cmp_eq_u32 vcc, 3, v8
    s_nop 1
    v_cndmask_b32 v237, v237, v243, vcc
    v_lshl_add_u32 v6, v3, 3, s74
    s_mov_b32 exec_lo, 0x00F0000F
    s_mov_b32 exec_hi, 0xF0000F00
    ds_write_b64 v6, v[236:237]
    s_mov_b64 exec, -1
    v_pk_add_f32 v[200:201], v[176:177], 0
    v_pk_add_f32 v[202:203], v[178:179], 0
    v_pk_add_f32 v[204:205], v[184:185], 0
    v_pk_add_f32 v[206:207], v[186:187], 0
    v_pk_add_f32 v[208:209], v[192:193], 0
    v_pk_add_f32 v[210:211], v[194:195], 0
    v_mov_b32 v238, 0xc0135761
    v_mov_b32 v239, 0xc0135761
    s_waitcnt vmcnt(3)
    s_waitcnt lgkmcnt(0)
    s_barrier
    v_lshl_add_u32 v4, v1, 4, s71
    v_lshl_add_u32 v5, v3, 3, s75
    ds_read_b64 v[20:21], v5
    ds_read_b64 v[22:23], v5 offset:128
    ds_read_b128 v[8:11], v4 offset:0
    ds_read_b128 v[12:15], v4 offset:1024
    ds_read_b128 v[16:19], v4 offset:2048
    v_lshl_add_u32 v6, v2, 4, s73
    ds_read_b128 v[24:27], v6 offset:0
    ds_read_b128 v[28:31], v6 offset:64
    ds_read_b128 v[32:35], v6 offset:128
    ds_read_b128 v[176:179], v6 offset:192
    ds_read_b128 v[180:183], v6 offset:256
    ds_read_b128 v[184:187], v6 offset:320
    ds_read_b128 v[188:191], v6 offset:384
    ds_read_b128 v[192:195], v6 offset:448
    ds_read_b128 v[196:199], v6 offset:512
    ds_read_b128 v[224:227], v6 offset:576
    ds_read_b128 v[228:231], v6 offset:640
    ds_read_b128 v[232:235], v6 offset:704
    s_waitcnt lgkmcnt(15)
    v_pk_add_f32 v[240:241], v[20:21], v[22:23]
    v_mul_f32 v240, 0x3acccccd, v240
    v_mul_f32 v241, 0x3acccccd, v241
    v_fma_f32 v241, -v240, v240, v241
    v_max_f32 v241, 0, v241
    v_cvt_pk_bf16_f32 v241, v241, v240
    v_and_b32 v240, 0xffff0000, v241
    v_lshlrev_b32 v241, 16, v241
    v_add_f32 v241, s55, v241
    v_cvt_pk_bf16_f32 v241, v241, v241
    v_and_b32 v241, 0xffff0000, v241
    v_sqrt_f32 v241, v241
    s_nop 0
    v_cvt_pk_bf16_f32 v241, v241, v241
    v_and_b32 v241, 0xffff0000, v241
    v_rcp_f32 v241, v241
    s_nop 0
    v_mov_b32 v242, v241
    s_waitcnt lgkmcnt(12)
    v_pk_add_f32 v[200:201], v[200:201], v[8:9]
    v_pk_add_f32 v[202:203], v[202:203], v[10:11]
    v_pk_add_f32 v[204:205], v[204:205], v[12:13]
    v_pk_add_f32 v[206:207], v[206:207], v[14:15]
    v_pk_add_f32 v[208:209], v[208:209], v[16:17]
    v_pk_add_f32 v[210:211], v[210:211], v[18:19]
    s_waitcnt lgkmcnt(6)
    v_pk_add_f32 v[24:25], v[24:25], v[176:177]
    v_pk_add_f32 v[26:27], v[26:27], v[178:179]
    v_pk_add_f32 v[28:29], v[28:29], v[180:181]
    v_pk_add_f32 v[30:31], v[30:31], v[182:183]
    v_pk_add_f32 v[32:33], v[32:33], v[184:185]
    v_pk_add_f32 v[34:35], v[34:35], v[186:187]
    s_waitcnt lgkmcnt(0)
    v_pk_add_f32 v[188:189], v[188:189], v[224:225]
    v_pk_add_f32 v[190:191], v[190:191], v[226:227]
    v_pk_add_f32 v[192:193], v[192:193], v[228:229]
    v_pk_add_f32 v[194:195], v[194:195], v[230:231]
    v_pk_add_f32 v[196:197], v[196:197], v[232:233]
    v_pk_add_f32 v[198:199], v[198:199], v[234:235]
    v_pk_add_f32 v[24:25], v[24:25], v[188:189]
    v_pk_add_f32 v[26:27], v[26:27], v[190:191]
    v_pk_add_f32 v[28:29], v[28:29], v[192:193]
    v_pk_add_f32 v[30:31], v[30:31], v[194:195]
    v_pk_add_f32 v[32:33], v[32:33], v[196:197]
    v_pk_add_f32 v[34:35], v[34:35], v[198:199]
    v_pk_fma_f32 v[200:201], v[24:25], v[240:241], v[200:201] op_sel_hi:[1,0,1] neg_lo:[0,1,0] neg_hi:[0,1,0]
    v_pk_fma_f32 v[202:203], v[26:27], v[240:241], v[202:203] op_sel_hi:[1,0,1] neg_lo:[0,1,0] neg_hi:[0,1,0]
    v_pk_fma_f32 v[204:205], v[28:29], v[240:241], v[204:205] op_sel_hi:[1,0,1] neg_lo:[0,1,0] neg_hi:[0,1,0]
    v_pk_fma_f32 v[206:207], v[30:31], v[240:241], v[206:207] op_sel_hi:[1,0,1] neg_lo:[0,1,0] neg_hi:[0,1,0]
    v_pk_fma_f32 v[208:209], v[32:33], v[240:241], v[208:209] op_sel_hi:[1,0,1] neg_lo:[0,1,0] neg_hi:[0,1,0]
    v_pk_fma_f32 v[210:211], v[34:35], v[240:241], v[210:211] op_sel_hi:[1,0,1] neg_lo:[0,1,0] neg_hi:[0,1,0]
    v_pk_mul_f32 v[200:201], v[200:201], v[242:243] op_sel_hi:[1,0]
    v_pk_mul_f32 v[202:203], v[202:203], v[242:243] op_sel_hi:[1,0]
    v_pk_mul_f32 v[204:205], v[204:205], v[242:243] op_sel_hi:[1,0]
    v_pk_mul_f32 v[206:207], v[206:207], v[242:243] op_sel_hi:[1,0]
    v_pk_mul_f32 v[208:209], v[208:209], v[242:243] op_sel_hi:[1,0]
    v_pk_mul_f32 v[210:211], v[210:211], v[242:243] op_sel_hi:[1,0]
    v_pk_mul_f32 v[8:9], v[200:201], v[200:201]
    v_pk_mul_f32 v[10:11], v[202:203], v[202:203]
    v_pk_mul_f32 v[12:13], v[204:205], v[204:205]
    v_pk_mul_f32 v[14:15], v[206:207], v[206:207]
    v_pk_mul_f32 v[16:17], v[208:209], v[208:209]
    v_pk_mul_f32 v[18:19], v[210:211], v[210:211]
    v_pk_fma_f32 v[8:9], v[8:9], s[58:59], v[238:239]
    v_pk_fma_f32 v[10:11], v[10:11], s[58:59], v[238:239]
    v_pk_fma_f32 v[12:13], v[12:13], s[58:59], v[238:239]
    v_pk_fma_f32 v[14:15], v[14:15], s[58:59], v[238:239]
    v_pk_fma_f32 v[16:17], v[16:17], s[58:59], v[238:239]
    v_pk_fma_f32 v[18:19], v[18:19], s[58:59], v[238:239]
    v_pk_mul_f32 v[8:9], v[8:9], v[200:201]
    v_pk_mul_f32 v[10:11], v[10:11], v[202:203]
    v_pk_mul_f32 v[12:13], v[12:13], v[204:205]
    v_pk_mul_f32 v[14:15], v[14:15], v[206:207]
    v_pk_mul_f32 v[16:17], v[16:17], v[208:209]
    v_pk_mul_f32 v[18:19], v[18:19], v[210:211]
    v_exp_f32 v8, v8
    v_exp_f32 v9, v9
    v_exp_f32 v10, v10
    v_exp_f32 v11, v11
    v_exp_f32 v12, v12
    v_exp_f32 v13, v13
    v_exp_f32 v14, v14
    v_exp_f32 v15, v15
    v_exp_f32 v16, v16
    v_exp_f32 v17, v17
    v_exp_f32 v18, v18
    v_exp_f32 v19, v19
    v_pk_add_f32 v[8:9], v[8:9], 1.0 op_sel_hi:[1,0]
    v_pk_add_f32 v[10:11], v[10:11], 1.0 op_sel_hi:[1,0]
    v_pk_add_f32 v[12:13], v[12:13], 1.0 op_sel_hi:[1,0]
    v_pk_add_f32 v[14:15], v[14:15], 1.0 op_sel_hi:[1,0]
    v_pk_add_f32 v[16:17], v[16:17], 1.0 op_sel_hi:[1,0]
    v_pk_add_f32 v[18:19], v[18:19], 1.0 op_sel_hi:[1,0]
    v_rcp_f32 v8, v8
    v_rcp_f32 v9, v9
    v_rcp_f32 v10, v10
    v_rcp_f32 v11, v11
    v_rcp_f32 v12, v12
    v_rcp_f32 v13, v13
    v_rcp_f32 v14, v14
    v_rcp_f32 v15, v15
    v_rcp_f32 v16, v16
    v_rcp_f32 v17, v17
    v_rcp_f32 v18, v18
    v_rcp_f32 v19, v19
    v_pk_mul_f32 v[200:201], v[200:201], v[8:9]
    v_pk_mul_f32 v[202:203], v[202:203], v[10:11]
    v_pk_mul_f32 v[204:205], v[204:205], v[12:13]
    v_pk_mul_f32 v[206:207], v[206:207], v[14:15]
    v_pk_mul_f32 v[208:209], v[208:209], v[16:17]
    v_pk_mul_f32 v[210:211], v[210:211], v[18:19]
    v_pk_add_f32 v[14:15], v[200:201], v[202:203]
    v_pk_mul_f32 v[16:17], v[200:201], v[200:201]
    v_pk_add_f32 v[18:19], v[204:205], v[206:207]
    v_pk_fma_f32 v[16:17], v[202:203], v[202:203], v[16:17]
    v_pk_add_f32 v[20:21], v[208:209], v[210:211]
    v_pk_fma_f32 v[16:17], v[204:205], v[204:205], v[16:17]
    v_pk_add_f32 v[14:15], v[14:15], v[18:19]
    v_pk_fma_f32 v[16:17], v[206:207], v[206:207], v[16:17]
    v_pk_add_f32 v[14:15], v[14:15], v[20:21]
    v_pk_fma_f32 v[16:17], v[208:209], v[208:209], v[16:17]
    v_pk_fma_f32 v[16:17], v[210:211], v[210:211], v[16:17]
    v_add_f32 v8, v14, v15
    v_add_f32 v9, v16, v17
    v_lshl_add_u32 v4, v3, 3, s76
    v_mov_b32 v12, v8
    v_mov_b32 v13, v9
    s_nop 0
    v_permlane16_swap_b32 v8, v12
    v_permlane16_swap_b32 v9, v13
    v_add_f32 v8, v8, v12
    v_add_f32 v9, v9, v13
    v_mov_b32 v12, v8
    v_mov_b32 v13, v9
    s_nop 0
    v_permlane32_swap_b32 v8, v12
    v_permlane32_swap_b32 v9, v13
    v_add_f32 v8, v8, v12
    v_add_f32 v9, v9, v13
    s_mov_b64 exec, 0xffff
    ds_write_b64 v4, v[8:9]
    s_mov_b64 exec, -1
    s_or_b32 s48, s41, s43
    s_cmp_eq_u32 s48, 0
    v_lshlrev_b32 v4, 3, v3
    s_cselect_b64 exec, 0xffff, 0
    buffer_store_dwordx2 v[240:241], v4, s[24:27], s79 offen
    s_mov_b64 exec, -1
    v_mfma_f32_16x16x32_bf16 v[176:179], v[152:155], v[48:51], 0
    ds_read_b64_tr_b16 v[128:129], v217 offset:0
    ds_read_b64_tr_b16 v[130:131], v217 offset:768
    v_mfma_f32_16x16x32_bf16 v[180:183], v[152:155], v[52:55], 0
    s_add_u32 s65, s54, s98
    s_add_u32 m0, s61, 131072
    s_nop 0
    buffer_load_dwordx4 v40, s[8:11], s65 offen lds
    ds_read_b64_tr_b16 v[132:133], v218 offset:0
    ds_read_b64_tr_b16 v[134:135], v218 offset:768
    v_mfma_f32_16x16x32_bf16 v[224:227], v[152:155], v[244:247], 0
    ds_read_b64_tr_b16 v[136:137], v219 offset:0
    ds_read_b64_tr_b16 v[138:139], v219 offset:768
    v_mfma_f32_16x16x32_bf16 v[184:187], v[156:159], v[48:51], 0
    ds_read_b64_tr_b16 v[140:141], v220 offset:0
    ds_read_b64_tr_b16 v[142:143], v220 offset:768
    v_mfma_f32_16x16x32_bf16 v[188:191], v[156:159], v[52:55], 0
    s_add_u32 s65, s54, s98
    s_add_u32 m0, s61, 132096
    s_nop 0
    buffer_load_dwordx4 v41, s[8:11], s65 offen lds
    ds_read_b64_tr_b16 v[144:145], v221 offset:0
    ds_read_b64_tr_b16 v[146:147], v221 offset:768
    v_mfma_f32_16x16x32_bf16 v[228:231], v[156:159], v[244:247], 0
    ds_read_b64_tr_b16 v[148:149], v222 offset:0
    ds_read_b64_tr_b16 v[150:151], v222 offset:768
    v_mfma_f32_16x16x32_bf16 v[192:195], v[160:163], v[48:51], 0
    v_mfma_f32_16x16x32_bf16 v[196:199], v[160:163], v[52:55], 0
    s_add_u32 s65, s54, s98
    s_add_u32 m0, s61, 133120
    s_nop 0
    buffer_load_dwordx4 v42, s[8:11], s65 offen lds
    v_mfma_f32_16x16x32_bf16 v[232:235], v[160:163], v[244:247], 0
    v_mfma_f32_16x16x32_bf16 v[176:179], v[164:167], v[56:59], v[176:179]
    v_mfma_f32_16x16x32_bf16 v[180:183], v[164:167], v[60:63], v[180:183]
    v_mul_u32_u24 v4, 1280, v43
    v_lshl_add_u32 v4, v44, 4, v4
    s_mul_i32 s51, s41, 160
    s_add_u32 s51, s51, s52
    s_mul_i32 s48, s42, 7680
    s_add_u32 s48, s48, s51
    s_sub_i32 s48, s48, 3840
    s_cmp_lt_i32 s48, 0
    s_cselect_b32 s49, 3840, 0
    s_add_u32 s48, s48, s49
    v_subrev_u32 v5, s49, v4
    s_mul_i32 s50, s42, 960
    s_add_u32 m0, s50, 65536
    s_mov_b32 exec_lo, -1
    s_mov_b32 exec_hi, 0xfffffff
    buffer_load_dwordx4 v5, s[12:15], s48 offen lds
    s_mov_b64 exec, -1
    v_mfma_f32_16x16x32_bf16 v[184:187], v[168:171], v[56:59], v[184:187]
    v_mfma_f32_16x16x32_bf16 v[188:191], v[168:171], v[60:63], v[188:191]
    v_mfma_f32_16x16x32_bf16 v[192:195], v[172:175], v[56:59], v[192:195]
    s_cmp_ge_u32 s42, 4
    s_mov_b32 exec_lo, -1
    s_mov_b32 exec_hi, 0xfffffff
    s_cbranch_scc1 k1_kvv_2
    s_mul_i32 s48, s42, 7680
    s_add_u32 s48, s48, s51
    s_add_u32 s48, s48, 57600
    s_mul_i32 s50, s42, 960
    s_add_u32 m0, s50, 73216
    s_nop 0
    buffer_load_dwordx4 v4, s[12:15], s48 offen lds
    s_branch k1_kve_3
k1_kvv_2:
    s_sub_u32 s49, s42, 4
    s_mul_i32 s48, s49, 7680
    s_add_u32 s48, s48, s51
    s_mul_i32 s50, s49, 960
    s_add_u32 m0, s50, 49152
    s_nop 0
    buffer_load_dwordx4 v4, s[16:19], s48 offen lds
k1_kve_3:
    s_mov_b64 exec, -1
    v_mfma_f32_16x16x32_bf16 v[196:199], v[172:175], v[60:63], v[196:199]
    s_add_u32 s49, s42, 4
    s_mul_i32 s48, s49, 7680
    s_add_u32 s48, s48, s51
    s_mul_i32 s50, s49, 960
    s_add_u32 m0, s50, 49152
    s_mov_b32 exec_lo, -1
    s_mov_b32 exec_hi, 0xfffffff
    buffer_load_dwordx4 v4, s[16:19], s48 offen lds
    s_mov_b64 exec, -1
    s_waitcnt vmcnt(7)
    s_waitcnt lgkmcnt(0)
    s_barrier
    s_cmp_lg_u32 s42, 0
    s_cbranch_scc1 k1_pub_4
    v_lshlrev_b32 v4, 3, v1
    v_add_u32 v5, 159744, v4
    ds_read_b64 v[8:9], v5
    ds_read_b64 v[12:13], v5 offset:512
    v_lshlrev_b32 v4, 4, v1
    v_mov_b32 v10, s100
    v_mov_b32 v11, s101
    s_waitcnt lgkmcnt(0)
    v_pk_add_f32 v[8:9], v[8:9], v[12:13]
k1_pub_4:
    s_cmp_eq_u32 s42, 0
    s_cselect_b64 exec, -1, 0
    buffer_store_dwordx4 v[8:11], v4, s[24:27], s77 offen sc1
    s_mov_b64 exec, -1
    v_mfma_f32_16x16x32_bf16 v[176:179], v[128:131], v[64:67], v[176:179]
    ds_read_b64_tr_b16 v[152:153], v217 offset:24576
    ds_read_b64_tr_b16 v[154:155], v217 offset:25344
    v_mfma_f32_16x16x32_bf16 v[180:183], v[128:131], v[68:71], v[180:183]
    s_add_u32 s65, s54, s99
    s_add_u32 m0, s61, 81920
    s_nop 0
    buffer_load_dwordx4 v40, s[8:11], s65 offen lds
    ds_read_b64_tr_b16 v[156:157], v218 offset:24576
    ds_read_b64_tr_b16 v[158:159], v218 offset:25344
    v_mfma_f32_16x16x32_bf16 v[224:227], v[128:131], v[244:247], v[224:227]
    ds_read_b64_tr_b16 v[160:161], v219 offset:24576
    ds_read_b64_tr_b16 v[162:163], v219 offset:25344
    v_mfma_f32_16x16x32_bf16 v[184:187], v[132:135], v[64:67], v[184:187]
    ds_read_b64_tr_b16 v[164:165], v220 offset:24576
    ds_read_b64_tr_b16 v[166:167], v220 offset:25344
    v_mfma_f32_16x16x32_bf16 v[188:191], v[132:135], v[68:71], v[188:191]
    s_add_u32 s65, s54, s99
    s_add_u32 m0, s61, 82944
    s_nop 0
    buffer_load_dwordx4 v41, s[8:11], s65 offen lds
    ds_read_b64_tr_b16 v[168:169], v221 offset:24576
    ds_read_b64_tr_b16 v[170:171], v221 offset:25344
    v_mfma_f32_16x16x32_bf16 v[228:231], v[132:135], v[244:247], v[228:231]
    ds_read_b64_tr_b16 v[172:173], v222 offset:24576
    ds_read_b64_tr_b16 v[174:175], v222 offset:25344
    v_mfma_f32_16x16x32_bf16 v[192:195], v[136:139], v[64:67], v[192:195]
    v_mfma_f32_16x16x32_bf16 v[196:199], v[136:139], v[68:71], v[196:199]
    s_add_u32 s65, s54, s99
    s_add_u32 m0, s61, 83968
    s_nop 0
    buffer_load_dwordx4 v42, s[8:11], s65 offen lds
    v_mfma_f32_16x16x32_bf16 v[232:235], v[136:139], v[244:247], v[232:235]
    v_mfma_f32_16x16x32_bf16 v[176:179], v[140:143], v[72:75], v[176:179]
    v_mfma_f32_16x16x32_bf16 v[180:183], v[140:143], v[76:79], v[180:183]
    v_mfma_f32_16x16x32_bf16 v[184:187], v[144:147], v[72:75], v[184:187]
    v_mfma_f32_16x16x32_bf16 v[188:191], v[144:147], v[76:79], v[188:191]
    v_mfma_f32_16x16x32_bf16 v[192:195], v[148:151], v[72:75], v[192:195]
    v_mfma_f32_16x16x32_bf16 v[196:199], v[148:151], v[76:79], v[196:199]
    s_waitcnt vmcnt(7)
    s_waitcnt lgkmcnt(0)
    s_barrier
    v_mfma_f32_16x16x32_bf16 v[176:179], v[152:155], v[80:83], v[176:179]
    ds_read_b64_tr_b16 v[128:129], v217 offset:49152
    ds_read_b64_tr_b16 v[130:131], v217 offset:49920
    v_mfma_f32_16x16x32_bf16 v[180:183], v[152:155], v[84:87], v[180:183]
    ds_read_b64_tr_b16 v[132:133], v218 offset:49152
    ds_read_b64_tr_b16 v[134:135], v218 offset:49920
    v_mfma_f32_16x16x32_bf16 v[224:227], v[152:155], v[244:247], v[224:227]
    ds_read_b64_tr_b16 v[136:137], v219 offset:49152
    ds_read_b64_tr_b16 v[138:139], v219 offset:49920
    v_mfma_f32_16x16x32_bf16 v[184:187], v[156:159], v[80:83], v[184:187]
    ds_read_b64_tr_b16 v[140:141], v220 offset:49152
    ds_read_b64_tr_b16 v[142:143], v220 offset:49920
    v_mfma_f32_16x16x32_bf16 v[188:191], v[156:159], v[84:87], v[188:191]
    ds_read_b64_tr_b16 v[144:145], v221 offset:49152
    ds_read_b64_tr_b16 v[146:147], v221 offset:49920
    v_mfma_f32_16x16x32_bf16 v[228:231], v[156:159], v[244:247], v[228:231]
    ds_read_b64_tr_b16 v[148:149], v222 offset:49152
    ds_read_b64_tr_b16 v[150:151], v222 offset:49920
    v_mfma_f32_16x16x32_bf16 v[192:195], v[160:163], v[80:83], v[192:195]
    v_mfma_f32_16x16x32_bf16 v[196:199], v[160:163], v[84:87], v[196:199]
    v_mfma_f32_16x16x32_bf16 v[232:235], v[160:163], v[244:247], v[232:235]
    v_mfma_f32_16x16x32_bf16 v[176:179], v[164:167], v[88:91], v[176:179]
    v_mfma_f32_16x16x32_bf16 v[180:183], v[164:167], v[92:95], v[180:183]
    v_mfma_f32_16x16x32_bf16 v[184:187], v[168:171], v[88:91], v[184:187]
    v_mfma_f32_16x16x32_bf16 v[188:191], v[168:171], v[92:95], v[188:191]
    v_mfma_f32_16x16x32_bf16 v[192:195], v[172:175], v[88:91], v[192:195]
    v_mfma_f32_16x16x32_bf16 v[196:199], v[172:175], v[92:95], v[196:199]
    s_waitcnt vmcnt(0)
    s_waitcnt lgkmcnt(0)
    s_barrier
    v_mfma_f32_16x16x32_bf16 v[176:179], v[128:131], v[96:99], v[176:179]
    ds_read_b64_tr_b16 v[152:153], v217 offset:0
    ds_read_b64_tr_b16 v[154:155], v217 offset:768
    v_mfma_f32_16x16x32_bf16 v[180:183], v[128:131], v[100:103], v[180:183]
    ds_read_b64_tr_b16 v[156:157], v218 offset:0
    ds_read_b64_tr_b16 v[158:159], v218 offset:768
    v_mfma_f32_16x16x32_bf16 v[224:227], v[128:131], v[244:247], v[224:227]
    ds_read_b64_tr_b16 v[160:161], v219 offset:0
    ds_read_b64_tr_b16 v[162:163], v219 offset:768
    v_mfma_f32_16x16x32_bf16 v[184:187], v[132:135], v[96:99], v[184:187]
    ds_read_b64_tr_b16 v[164:165], v220 offset:0
    ds_read_b64_tr_b16 v[166:167], v220 offset:768
    v_mfma_f32_16x16x32_bf16 v[188:191], v[132:135], v[100:103], v[188:191]
    ds_read_b64_tr_b16 v[168:169], v221 offset:0
    ds_read_b64_tr_b16 v[170:171], v221 offset:768
    v_mfma_f32_16x16x32_bf16 v[228:231], v[132:135], v[244:247], v[228:231]
    ds_read_b64_tr_b16 v[172:173], v222 offset:0
    ds_read_b64_tr_b16 v[174:175], v222 offset:768
    v_mfma_f32_16x16x32_bf16 v[192:195], v[136:139], v[96:99], v[192:195]
    v_mfma_f32_16x16x32_bf16 v[196:199], v[136:139], v[100:103], v[196:199]
    v_mfma_f32_16x16x32_bf16 v[232:235], v[136:139], v[244:247], v[232:235]
    v_mfma_f32_16x16x32_bf16 v[176:179], v[140:143], v[104:107], v[176:179]
    v_mfma_f32_16x16x32_bf16 v[180:183], v[140:143], v[108:111], v[180:183]
    v_mfma_f32_16x16x32_bf16 v[184:187], v[144:147], v[104:107], v[184:187]
    v_mfma_f32_16x16x32_bf16 v[188:191], v[144:147], v[108:111], v[188:191]
    v_mfma_f32_16x16x32_bf16 v[192:195], v[148:151], v[104:107], v[192:195]
    v_mfma_f32_16x16x32_bf16 v[196:199], v[148:151], v[108:111], v[196:199]
    s_waitcnt lgkmcnt(0)
    s_barrier
    v_lshlrev_b32 v38, 4, v3
    v_lshl_add_u32 v38, v2, 11, v38
    buffer_load_dwordx4 v[28:31], v38, s[24:27], s78 offen sc1
    buffer_load_dwordx4 v[32:35], v38, s[24:27], s78 offen offset:1024 sc1
    v_mfma_f32_16x16x32_bf16 v[176:179], v[152:155], v[112:115], v[176:179]
    v_mfma_f32_16x16x32_bf16 v[180:183], v[152:155], v[116:119], v[180:183]
    v_mfma_f32_16x16x32_bf16 v[224:227], v[152:155], v[244:247], v[224:227]
    v_mfma_f32_16x16x32_bf16 v[184:187], v[156:159], v[112:115], v[184:187]
    v_mfma_f32_16x16x32_bf16 v[188:191], v[156:159], v[116:119], v[188:191]
    v_mfma_f32_16x16x32_bf16 v[228:231], v[156:159], v[244:247], v[228:231]
    v_mfma_f32_16x16x32_bf16 v[192:195], v[160:163], v[112:115], v[192:195]
    v_mfma_f32_16x16x32_bf16 v[196:199], v[160:163], v[116:119], v[196:199]
    v_mfma_f32_16x16x32_bf16 v[232:235], v[160:163], v[244:247], v[232:235]
    v_mfma_f32_16x16x32_bf16 v[176:179], v[164:167], v[120:123], v[176:179]
    v_mfma_f32_16x16x32_bf16 v[180:183], v[164:167], v[124:127], v[180:183]
    v_mfma_f32_16x16x32_bf16 v[184:187], v[168:171], v[120:123], v[184:187]
    v_mfma_f32_16x16x32_bf16 v[188:191], v[168:171], v[124:127], v[188:191]
    v_mfma_f32_16x16x32_bf16 v[192:195], v[172:175], v[120:123], v[192:195]
    v_mfma_f32_16x16x32_bf16 v[196:199], v[172:175], v[124:127], v[196:199]
    v_lshl_add_u32 v4, v1, 4, s70
    v_lshl_add_u32 v5, v2, 4, s72
    s_nop 1
    ds_write_b128 v4, v[180:183] offset:0
    s_nop 0
    ds_write_b128 v4, v[188:191] offset:1024
    s_nop 0
    ds_write_b128 v4, v[196:199] offset:2048
    s_mov_b32 exec_lo, 0x00010001
    s_mov_b32 exec_hi, 0x00010001
    ds_write_b128 v5, v[224:227] offset:1536
    ds_write_b128 v5, v[228:231] offset:1600
    ds_write_b128 v5, v[232:235] offset:1664
    s_mov_b64 exec, -1
    v_pk_add_f32 v[128:129], v[176:177], 0
    v_pk_add_f32 v[130:131], v[178:179], 0
    v_pk_add_f32 v[132:133], v[184:185], 0
    v_pk_add_f32 v[134:135], v[186:187], 0
    v_pk_add_f32 v[136:137], v[192:193], 0
    v_pk_add_f32 v[138:139], v[194:195], 0
    v_add_u32 v4, 65536, v7
    ds_read_b128 v[48:51], v4 offset:0
    ds_read_b128 v[52:55], v4 offset:160
    ds_read_b128 v[56:59], v4 offset:320
    ds_read_b128 v[60:63], v4 offset:480
    ds_read_b128 v[64:67], v4 offset:640
    v_add_u32 v4, 49152, v7
    ds_read_b128 v[68:71], v4
    ds_read_b128 v[72:75], v4 offset:160
    s_waitcnt lgkmcnt(0)
    v_mul_u32_u24 v7, 1152, v44
    v_lshlrev_b32 v106, 2, v43
    v_sub_u32 v7, v7, v106
    s_lshl_b32 s48, s42, 4
    s_add_u32 s48, s48, 106508
    v_add_u32 v7, s48, v7
    v_lshlrev_b32 v44, 6, v44
    v_add_u32 v44, 160768, v44
    ds_read_b128 v[108:111], v44 offset:0
    ds_read_b128 v[112:115], v44 offset:16
    v_lshlrev_b32 v80, 16, v48
    v_and_b32 v81, 0xffff0000, v48
    v_lshlrev_b32 v82, 16, v52
    v_and_b32 v83, 0xffff0000, v52
    v_lshlrev_b32 v84, 16, v56
    v_and_b32 v85, 0xffff0000, v56
    v_lshlrev_b32 v86, 16, v60
    v_and_b32 v87, 0xffff0000, v60
    v_lshlrev_b32 v88, 16, v64
    v_and_b32 v89, 0xffff0000, v64
    s_waitcnt lgkmcnt(0)
    v_lshlrev_b32 v90, 16, v108
    v_lshlrev_b32 v91, 16, v110
    v_and_b32 v92, 0xffff0000, v108
    v_and_b32 v93, 0xffff0000, v110
    v_lshlrev_b32 v94, 16, v109
    v_lshlrev_b32 v95, 16, v111
    v_and_b32 v96, 0xffff0000, v109
    v_and_b32 v97, 0xffff0000, v111
    v_pk_mul_f32 v[98:99], v[86:87], v[90:91]
    v_pk_mul_f32 v[100:101], v[88:89], v[90:91]
    v_pk_fma_f32 v[98:99], v[84:85], v[92:93], v[98:99]
    v_pk_fma_f32 v[100:101], v[86:87], v[92:93], v[100:101]
    v_pk_fma_f32 v[98:99], v[82:83], v[94:95], v[98:99]
    v_pk_fma_f32 v[100:101], v[84:85], v[94:95], v[100:101]
    v_pk_fma_f32 v[98:99], v[80:81], v[96:97], v[98:99]
    v_pk_fma_f32 v[100:101], v[82:83], v[96:97], v[100:101]
    v_lshlrev_b32 v102, 16, v68
    v_and_b32 v103, 0xffff0000, v68
    v_lshlrev_b32 v104, 16, v72
    v_and_b32 v105, 0xffff0000, v72
    v_pk_mul_f32 v[98:99], v[98:99], v[102:103]
    v_pk_mul_f32 v[100:101], v[100:101], v[104:105]
    v_cvt_pk_bf16_f32 v106, v100, v98
    v_cvt_pk_bf16_f32 v107, v101, v99
    s_mov_b32 exec_hi, 0xff
    ds_write_b32 v7, v106 offset:0
    ds_write_b32 v7, v107 offset:144
    s_mov_b32 exec_hi, -1
    v_lshlrev_b32 v80, 16, v49
    v_and_b32 v81, 0xffff0000, v49
    v_lshlrev_b32 v82, 16, v53
    v_and_b32 v83, 0xffff0000, v53
    v_lshlrev_b32 v84, 16, v57
    v_and_b32 v85, 0xffff0000, v57
    v_lshlrev_b32 v86, 16, v61
    v_and_b32 v87, 0xffff0000, v61
    v_lshlrev_b32 v88, 16, v65
    v_and_b32 v89, 0xffff0000, v65
    v_lshlrev_b32 v90, 16, v112
    v_lshlrev_b32 v91, 16, v114
    v_and_b32 v92, 0xffff0000, v112
    v_and_b32 v93, 0xffff0000, v114
    v_lshlrev_b32 v94, 16, v113
    v_lshlrev_b32 v95, 16, v115
    v_and_b32 v96, 0xffff0000, v113
    v_and_b32 v97, 0xffff0000, v115
    v_pk_mul_f32 v[98:99], v[86:87], v[90:91]
    v_pk_mul_f32 v[100:101], v[88:89], v[90:91]
    v_pk_fma_f32 v[98:99], v[84:85], v[92:93], v[98:99]
    v_pk_fma_f32 v[100:101], v[86:87], v[92:93], v[100:101]
    v_pk_fma_f32 v[98:99], v[82:83], v[94:95], v[98:99]
    v_pk_fma_f32 v[100:101], v[84:85], v[94:95], v[100:101]
    v_pk_fma_f32 v[98:99], v[80:81], v[96:97], v[98:99]
    v_pk_fma_f32 v[100:101], v[82:83], v[96:97], v[100:101]
    v_lshlrev_b32 v102, 16, v69
    v_and_b32 v103, 0xffff0000, v69
    v_lshlrev_b32 v104, 16, v73
    v_and_b32 v105, 0xffff0000, v73
    v_pk_mul_f32 v[98:99], v[98:99], v[102:103]
    v_pk_mul_f32 v[100:101], v[100:101], v[104:105]
    v_cvt_pk_bf16_f32 v106, v100, v98
    v_cvt_pk_bf16_f32 v107, v101, v99
    s_mov_b32 exec_hi, 0xff
    ds_write_b32 v7, v106 offset:288
    ds_write_b32 v7, v107 offset:432
    s_mov_b32 exec_hi, -1
    ds_read_b128 v[108:111], v44 offset:32
    ds_read_b128 v[112:115], v44 offset:48
    v_lshlrev_b32 v80, 16, v50
    v_and_b32 v81, 0xffff0000, v50
    v_lshlrev_b32 v82, 16, v54
    v_and_b32 v83, 0xffff0000, v54
    v_lshlrev_b32 v84, 16, v58
    v_and_b32 v85, 0xffff0000, v58
    v_lshlrev_b32 v86, 16, v62
    v_and_b32 v87, 0xffff0000, v62
    v_lshlrev_b32 v88, 16, v66
    v_and_b32 v89, 0xffff0000, v66
    s_waitcnt lgkmcnt(0)
    v_lshlrev_b32 v90, 16, v108
    v_lshlrev_b32 v91, 16, v110
    v_and_b32 v92, 0xffff0000, v108
    v_and_b32 v93, 0xffff0000, v110
    v_lshlrev_b32 v94, 16, v109
    v_lshlrev_b32 v95, 16, v111
    v_and_b32 v96, 0xffff0000, v109
    v_and_b32 v97, 0xffff0000, v111
    v_pk_mul_f32 v[98:99], v[86:87], v[90:91]
    v_pk_mul_f32 v[100:101], v[88:89], v[90:91]
    v_pk_fma_f32 v[98:99], v[84:85], v[92:93], v[98:99]
    v_pk_fma_f32 v[100:101], v[86:87], v[92:93], v[100:101]
    v_pk_fma_f32 v[98:99], v[82:83], v[94:95], v[98:99]
    v_pk_fma_f32 v[100:101], v[84:85], v[94:95], v[100:101]
    v_pk_fma_f32 v[98:99], v[80:81], v[96:97], v[98:99]
    v_pk_fma_f32 v[100:101], v[82:83], v[96:97], v[100:101]
    v_lshlrev_b32 v102, 16, v70
    v_and_b32 v103, 0xffff0000, v70
    v_lshlrev_b32 v104, 16, v74
    v_and_b32 v105, 0xffff0000, v74
    v_pk_mul_f32 v[98:99], v[98:99], v[102:103]
    v_pk_mul_f32 v[100:101], v[100:101], v[104:105]
    v_cvt_pk_bf16_f32 v106, v100, v98
    v_cvt_pk_bf16_f32 v107, v101, v99
    s_mov_b32 exec_hi, 0xff
    ds_write_b32 v7, v106 offset:576
    ds_write_b32 v7, v107 offset:720
    s_mov_b32 exec_hi, -1
    v_lshlrev_b32 v80, 16, v51
    v_and_b32 v81, 0xffff0000, v51
    v_lshlrev_b32 v82, 16, v55
    v_and_b32 v83, 0xffff0000, v55
    v_lshlrev_b32 v84, 16, v59
    v_and_b32 v85, 0xffff0000, v59
    v_lshlrev_b32 v86, 16, v63
    v_and_b32 v87, 0xffff0000, v63
    v_lshlrev_b32 v88, 16, v67
    v_and_b32 v89, 0xffff0000, v67
    v_lshlrev_b32 v90, 16, v112
    v_lshlrev_b32 v91, 16, v114
    v_and_b32 v92, 0xffff0000, v112
    v_and_b32 v93, 0xffff0000, v114
    v_lshlrev_b32 v94, 16, v113
    v_lshlrev_b32 v95, 16, v115
    v_and_b32 v96, 0xffff0000, v113
    v_and_b32 v97, 0xffff0000, v115
    v_pk_mul_f32 v[98:99], v[86:87], v[90:91]
    v_pk_mul_f32 v[100:101], v[88:89], v[90:91]
    v_pk_fma_f32 v[98:99], v[84:85], v[92:93], v[98:99]
    v_pk_fma_f32 v[100:101], v[86:87], v[92:93], v[100:101]
    v_pk_fma_f32 v[98:99], v[82:83], v[94:95], v[98:99]
    v_pk_fma_f32 v[100:101], v[84:85], v[94:95], v[100:101]
    v_pk_fma_f32 v[98:99], v[80:81], v[96:97], v[98:99]
    v_pk_fma_f32 v[100:101], v[82:83], v[96:97], v[100:101]
    v_lshlrev_b32 v102, 16, v71
    v_and_b32 v103, 0xffff0000, v71
    v_lshlrev_b32 v104, 16, v75
    v_and_b32 v105, 0xffff0000, v75
    v_pk_mul_f32 v[98:99], v[98:99], v[102:103]
    v_pk_mul_f32 v[100:101], v[100:101], v[104:105]
    v_cvt_pk_bf16_f32 v106, v100, v98
    v_cvt_pk_bf16_f32 v107, v101, v99
    s_mov_b32 exec_hi, 0xff
    ds_write_b32 v7, v106 offset:864
    ds_write_b32 v7, v107 offset:1008
    s_mov_b32 exec_hi, -1
    s_lshl_b32 s48, s47, 4
    v_add_u32 v43, s48, v3
    v_mul_u32_u24 v43, 200, v43
    v_lshl_add_u32 v43, v2, 3, v43
    s_mul_i32 s48, s43, 96
    s_add_u32 s48, s48, 0
    v_add_u32 v43, s48, v43
    s_waitcnt vmcnt(0)
    s_mov_b32 s65, 0
k1_poll_5:
    s_add_u32 s65, s65, 1
    s_cmp_gt_u32 s65, 100000
    s_cbranch_scc1 k1_polled_6
    v_cmp_ne_u32 vcc, s100, v30
    v_cmp_ne_u32 s[50:51], s101, v31
    s_nop 0
    s_or_b64 vcc, vcc, s[50:51]
    v_cmp_ne_u32 s[50:51], s100, v34
    s_nop 0
    s_or_b64 vcc, vcc, s[50:51]
    v_cmp_ne_u32 s[50:51], s101, v35
    s_nop 0
    s_or_b64 vcc, vcc, s[50:51]
    s_cmp_eq_u64 vcc, 0
    s_cbranch_scc1 k1_polled_6
    s_sleep 4
    buffer_load_dwordx4 v[28:31], v38, s[24:27], s78 offen sc1
    buffer_load_dwordx4 v[32:35], v38, s[24:27], s78 offen offset:1024 sc1
    s_waitcnt vmcnt(0)
    s_branch k1_poll_5
k1_polled_6:
    s_xor_b32 s48, s42, 1
    s_or_b32 s48, s48, s41
    s_cmp_lg_u32 s48, 0
    s_cbranch_scc1 k1_ep_7
    v_mov_b32 v4, 0
    v_mov_b32 v44, 1
    s_mov_b64 exec, 1
    buffer_atomic_add v44, v4, s[28:31], 0 offen sc0
    s_mov_b64 exec, -1
k1_ep_7:
    v_pk_add_f32 v[8:9], v[28:29], v[32:33]
    v_mov_b32 v10, v8
    v_mov_b32 v11, v9
    s_nop 0
    v_permlane16_swap_b32 v8, v10
    v_permlane16_swap_b32 v9, v11
    v_add_f32 v8, v8, v10
    v_add_f32 v9, v9, v11
    v_mov_b32 v10, v8
    v_mov_b32 v11, v9
    s_nop 0
    v_permlane32_swap_b32 v8, v10
    v_permlane32_swap_b32 v9, v11
    v_add_f32 v8, v8, v10
    v_add_f32 v9, v9, v11
    v_mul_f32 v8, 0x3aaaaaab, v8
    v_mul_f32 v9, 0x3aaaaaab, v9
    v_fma_f32 v9, -v8, v8, v9
    v_max_f32 v9, 0, v9
    v_cvt_pk_bf16_f32 v9, v9, v8
    v_and_b32 v8, 0xffff0000, v9
    v_lshlrev_b32 v9, 16, v9
    v_add_f32 v9, s55, v9
    v_cvt_pk_bf16_f32 v9, v9, v9
    v_and_b32 v9, 0xffff0000, v9
    v_sqrt_f32 v9, v9
    s_nop 0
    v_cvt_pk_bf16_f32 v9, v9, v9
    v_and_b32 v9, 0xffff0000, v9
    v_rcp_f32 v9, v9
    s_nop 0
    v_mov_b32 v10, v9
    v_pk_add_f32 v[200:201], v[200:201], v[8:9] op_sel_hi:[1,0] neg_lo:[0,1] neg_hi:[0,1]
    v_pk_add_f32 v[202:203], v[202:203], v[8:9] op_sel_hi:[1,0] neg_lo:[0,1] neg_hi:[0,1]
    v_pk_add_f32 v[204:205], v[204:205], v[8:9] op_sel_hi:[1,0] neg_lo:[0,1] neg_hi:[0,1]
    v_pk_add_f32 v[206:207], v[206:207], v[8:9] op_sel_hi:[1,0] neg_lo:[0,1] neg_hi:[0,1]
    v_pk_add_f32 v[208:209], v[208:209], v[8:9] op_sel_hi:[1,0] neg_lo:[0,1] neg_hi:[0,1]
    v_pk_add_f32 v[210:211], v[210:211], v[8:9] op_sel_hi:[1,0] neg_lo:[0,1] neg_hi:[0,1]
    v_pk_mul_f32 v[200:201], v[200:201], v[10:11] op_sel_hi:[1,0]
    v_pk_mul_f32 v[202:203], v[202:203], v[10:11] op_sel_hi:[1,0]
    v_pk_mul_f32 v[204:205], v[204:205], v[10:11] op_sel_hi:[1,0]
    v_pk_mul_f32 v[206:207], v[206:207], v[10:11] op_sel_hi:[1,0]
    v_pk_mul_f32 v[208:209], v[208:209], v[10:11] op_sel_hi:[1,0]
    v_pk_mul_f32 v[210:211], v[210:211], v[10:11] op_sel_hi:[1,0]
    v_cvt_pk_bf16_f32 v16, v200, v201
    v_cvt_pk_bf16_f32 v17, v202, v203
    ds_write_b64 v43, v[16:17] offset:0
    v_cvt_pk_bf16_f32 v18, v204, v205
    v_cvt_pk_bf16_f32 v19, v206, v207
    ds_write_b64 v43, v[18:19] offset:32
    v_cvt_pk_bf16_f32 v20, v208, v209
    v_cvt_pk_bf16_f32 v21, v210, v211
    ds_write_b64 v43, v[20:21] offset:64
    v_lshrrev_b32 v218, 1, v2
    v_lshrrev_b32 v5, 2, v3
    v_lshl_add_u32 v218, v218, 3, v5
    v_mul_u32_u24 v218, 200, v218
    v_and_b32 v5, 1, v2
    v_lshl_add_u32 v218, v5, 5, v218
    v_and_b32 v5, 3, v3
    v_lshl_add_u32 v218, v5, 3, v218
    v_lshlrev_b32 v219, 4, v1
    s_waitcnt lgkmcnt(0)
    s_barrier
    v_add_u32 v5, s88, v218
    ds_read_b64_tr_b16 v[8:9], v5
    ds_read_b64_tr_b16 v[10:11], v5 offset:800
    s_waitcnt lgkmcnt(0)
    buffer_store_dwordx4 v[8:11], v219, s[24:27], s64 offen sc1
    s_cmp_ge_u32 s42, 4
    s_cbranch_scc1 k1_fr_8
    v_add_u32 v5, s63, v218
    ds_read_b64_tr_b16 v[12:13], v5
    ds_read_b64_tr_b16 v[14:15], v5 offset:800
    s_waitcnt lgkmcnt(0)
    buffer_store_dwordx4 v[12:15], v219, s[24:27], s67 offen sc1
k1_fr_8:
    s_lshl_b32 s48, s42, 3
    v_lshrrev_b32 v4, 3, v1
    v_add_u32 v4, s48, v4
    v_and_b32 v5, 7, v1
    v_lshlrev_b32 v5, 4, v5
    v_mul_u32_u24 v6, 144, v4
    v_add_u32 v6, v6, v5
    v_add_u32 v6, 106496, v6
    ds_read_b128 v[120:123], v6
    v_lshlrev_b32 v4, 12, v4
    v_add_u32 v4, v4, v5
    s_waitcnt lgkmcnt(0)
    buffer_store_dwordx4 v[120:123], v4, s[24:27], s83 offen sc1
    s_lshl_b32 s48, s42, 3
    s_add_u32 s48, s48, 64
    v_lshrrev_b32 v4, 3, v1
    v_add_u32 v4, s48, v4
    v_and_b32 v5, 7, v1
    v_lshlrev_b32 v5, 4, v5
    v_mul_u32_u24 v6, 144, v4
    v_add_u32 v6, v6, v5
    v_add_u32 v6, 106496, v6
    ds_read_b128 v[124:127], v6
    v_lshlrev_b32 v4, 12, v4
    v_add_u32 v4, v4, v5
    s_waitcnt lgkmcnt(0)
    s_cmp_ge_u32 s42, 2
    s_cbranch_scc1 k1_kvskip_9
    buffer_store_dwordx4 v[124:127], v4, s[24:27], s83 offen sc1
k1_kvskip_9:
    v_lshl_add_u32 v4, v1, 4, s71
    ds_read_b128 v[48:51], v4 offset:0
    ds_read_b128 v[52:55], v4 offset:1024
    ds_read_b128 v[56:59], v4 offset:2048
    v_lshl_add_u32 v6, v2, 4, s73
    ds_read_b128 v[64:67], v6 offset:1536
    ds_read_b128 v[68:71], v6 offset:1600
    ds_read_b128 v[72:75], v6 offset:1664
    ds_read_b128 v[76:79], v6 offset:1728
    ds_read_b128 v[80:83], v6 offset:1792
    ds_read_b128 v[84:87], v6 offset:1856
    ds_read_b128 v[88:91], v6 offset:1920
    ds_read_b128 v[92:95], v6 offset:1984
    ds_read_b128 v[96:99], v6 offset:2048
    ds_read_b128 v[100:103], v6 offset:2112
    ds_read_b128 v[104:107], v6 offset:2176
    ds_read_b128 v[108:111], v6 offset:2240
    s_waitcnt lgkmcnt(12)
    v_pk_add_f32 v[128:129], v[128:129], v[48:49]
    v_pk_add_f32 v[130:131], v[130:131], v[50:51]
    v_pk_add_f32 v[132:133], v[132:133], v[52:53]
    v_pk_add_f32 v[134:135], v[134:135], v[54:55]
    v_pk_add_f32 v[136:137], v[136:137], v[56:57]
    v_pk_add_f32 v[138:139], v[138:139], v[58:59]
    s_waitcnt lgkmcnt(6)
    v_pk_add_f32 v[64:65], v[64:65], v[76:77]
    v_pk_add_f32 v[66:67], v[66:67], v[78:79]
    v_pk_add_f32 v[68:69], v[68:69], v[80:81]
    v_pk_add_f32 v[70:71], v[70:71], v[82:83]
    v_pk_add_f32 v[72:73], v[72:73], v[84:85]
    v_pk_add_f32 v[74:75], v[74:75], v[86:87]
    s_waitcnt lgkmcnt(0)
    v_pk_add_f32 v[88:89], v[88:89], v[100:101]
    v_pk_add_f32 v[90:91], v[90:91], v[102:103]
    v_pk_add_f32 v[92:93], v[92:93], v[104:105]
    v_pk_add_f32 v[94:95], v[94:95], v[106:107]
    v_pk_add_f32 v[96:97], v[96:97], v[108:109]
    v_pk_add_f32 v[98:99], v[98:99], v[110:111]
    v_pk_add_f32 v[64:65], v[64:65], v[88:89]
    v_pk_add_f32 v[66:67], v[66:67], v[90:91]
    v_pk_add_f32 v[68:69], v[68:69], v[92:93]
    v_pk_add_f32 v[70:71], v[70:71], v[94:95]
    v_pk_add_f32 v[72:73], v[72:73], v[96:97]
    v_pk_add_f32 v[74:75], v[74:75], v[98:99]
    v_pk_fma_f32 v[128:129], v[64:65], v[240:241], v[128:129] op_sel_hi:[1,0,1] neg_lo:[0,1,0] neg_hi:[0,1,0]
    v_pk_fma_f32 v[130:131], v[66:67], v[240:241], v[130:131] op_sel_hi:[1,0,1] neg_lo:[0,1,0] neg_hi:[0,1,0]
    v_pk_fma_f32 v[132:133], v[68:69], v[240:241], v[132:133] op_sel_hi:[1,0,1] neg_lo:[0,1,0] neg_hi:[0,1,0]
    v_pk_fma_f32 v[134:135], v[70:71], v[240:241], v[134:135] op_sel_hi:[1,0,1] neg_lo:[0,1,0] neg_hi:[0,1,0]
    v_pk_fma_f32 v[136:137], v[72:73], v[240:241], v[136:137] op_sel_hi:[1,0,1] neg_lo:[0,1,0] neg_hi:[0,1,0]
    v_pk_fma_f32 v[138:139], v[74:75], v[240:241], v[138:139] op_sel_hi:[1,0,1] neg_lo:[0,1,0] neg_hi:[0,1,0]
    v_pk_mul_f32 v[128:129], v[128:129], v[242:243] op_sel_hi:[1,0]
    v_pk_mul_f32 v[130:131], v[130:131], v[242:243] op_sel_hi:[1,0]
    v_pk_mul_f32 v[132:133], v[132:133], v[242:243] op_sel_hi:[1,0]
    v_pk_mul_f32 v[134:135], v[134:135], v[242:243] op_sel_hi:[1,0]
    v_pk_mul_f32 v[136:137], v[136:137], v[242:243] op_sel_hi:[1,0]
    v_pk_mul_f32 v[138:139], v[138:139], v[242:243] op_sel_hi:[1,0]
    v_pk_mul_f32 v[48:49], v[128:129], v[128:129]
    v_pk_mul_f32 v[50:51], v[130:131], v[130:131]
    v_pk_mul_f32 v[52:53], v[132:133], v[132:133]
    v_pk_mul_f32 v[54:55], v[134:135], v[134:135]
    v_pk_mul_f32 v[56:57], v[136:137], v[136:137]
    v_pk_mul_f32 v[58:59], v[138:139], v[138:139]
    v_pk_fma_f32 v[48:49], v[48:49], s[58:59], v[238:239]
    v_pk_fma_f32 v[50:51], v[50:51], s[58:59], v[238:239]
    v_pk_fma_f32 v[52:53], v[52:53], s[58:59], v[238:239]
    v_pk_fma_f32 v[54:55], v[54:55], s[58:59], v[238:239]
    v_pk_fma_f32 v[56:57], v[56:57], s[58:59], v[238:239]
    v_pk_fma_f32 v[58:59], v[58:59], s[58:59], v[238:239]
    v_pk_mul_f32 v[48:49], v[48:49], v[128:129]
    v_pk_mul_f32 v[50:51], v[50:51], v[130:131]
    v_pk_mul_f32 v[52:53], v[52:53], v[132:133]
    v_pk_mul_f32 v[54:55], v[54:55], v[134:135]
    v_pk_mul_f32 v[56:57], v[56:57], v[136:137]
    v_pk_mul_f32 v[58:59], v[58:59], v[138:139]
    v_exp_f32 v48, v48
    v_exp_f32 v49, v49
    v_exp_f32 v50, v50
    v_exp_f32 v51, v51
    v_exp_f32 v52, v52
    v_exp_f32 v53, v53
    v_exp_f32 v54, v54
    v_exp_f32 v55, v55
    v_exp_f32 v56, v56
    v_exp_f32 v57, v57
    v_exp_f32 v58, v58
    v_exp_f32 v59, v59
    v_pk_add_f32 v[48:49], v[48:49], 1.0 op_sel_hi:[1,0]
    v_pk_add_f32 v[50:51], v[50:51], 1.0 op_sel_hi:[1,0]
    v_pk_add_f32 v[52:53], v[52:53], 1.0 op_sel_hi:[1,0]
    v_pk_add_f32 v[54:55], v[54:55], 1.0 op_sel_hi:[1,0]
    v_pk_add_f32 v[56:57], v[56:57], 1.0 op_sel_hi:[1,0]
    v_pk_add_f32 v[58:59], v[58:59], 1.0 op_sel_hi:[1,0]
    v_rcp_f32 v48, v48
    v_rcp_f32 v49, v49
    v_rcp_f32 v50, v50
    v_rcp_f32 v51, v51
    v_rcp_f32 v52, v52
    v_rcp_f32 v53, v53
    v_rcp_f32 v54, v54
    v_rcp_f32 v55, v55
    v_rcp_f32 v56, v56
    v_rcp_f32 v57, v57
    v_rcp_f32 v58, v58
    v_rcp_f32 v59, v59
    v_pk_mul_f32 v[128:129], v[128:129], v[48:49]
    v_pk_mul_f32 v[130:131], v[130:131], v[50:51]
    v_pk_mul_f32 v[132:133], v[132:133], v[52:53]
    v_pk_mul_f32 v[134:135], v[134:135], v[54:55]
    v_pk_mul_f32 v[136:137], v[136:137], v[56:57]
    v_pk_mul_f32 v[138:139], v[138:139], v[58:59]
    v_lshrrev_b32 v4, 1, v2
    v_mul_u32_u24 v4, 3072, v4
    v_and_b32 v5, 1, v2
    v_lshlrev_b32 v5, 5, v5
    v_add_u32 v5, v5, v3
    v_lshl_add_u32 v4, v5, 4, v4
    v_cvt_pk_bf16_f32 v48, v128, v129
    v_cvt_pk_bf16_f32 v49, v130, v131
    v_add_u32 v5, s80, v4
    ds_write_b64 v5, v[48:49]
    v_cvt_pk_bf16_f32 v50, v132, v133
    v_cvt_pk_bf16_f32 v51, v134, v135
    v_add_u32 v5, s81, v4
    ds_write_b64 v5, v[50:51]
    v_cvt_pk_bf16_f32 v52, v136, v137
    v_cvt_pk_bf16_f32 v53, v138, v139
    v_add_u32 v5, s82, v4
    ds_write_b64 v5, v[52:53]
    s_xor_b32 s48, s42, 1
    s_or_b32 s48, s48, s41
    s_cmp_lg_u32 s48, 0
    s_cbranch_scc1 k1_ep2_10
    s_waitcnt vmcnt(0)
    v_readfirstlane_b32 s48, v44
    s_nop 0
    s_cmp_lg_u32 s48, 31
    s_cbranch_scc1 k1_ep2_10
    v_mov_b32 v8, s100
    v_mov_b32 v9, s101
    v_mov_b32 v4, 14712832
    s_mov_b64 exec, 1
    buffer_store_dwordx2 v[8:9], v4, s[24:27], 0 offen sc1
    s_mov_b64 exec, -1
k1_ep2_10:
    s_waitcnt vmcnt(0) lgkmcnt(0)
    s_barrier
    s_lshl_b32 s48, s41, 8
    s_lshl_b32 s49, s40, 3
    s_add_u32 s48, s48, s49
    s_add_u32 s48, s48, 14716928
    v_mov_b32 v8, s100
    v_mov_b32 v9, s101
    v_mov_b32 v4, 0
    s_cmp_eq_u32 s42, 0
    s_cselect_b64 exec, 1, 0
    buffer_store_dwordx2 v[8:9], v4, s[24:27], s48 offen sc1
    s_mov_b64 exec, -1
    s_cmp_ge_u32 s42, 4
    s_cbranch_scc1 k12_kernel_conv
    s_load_dwordx2 s[4:5], s[0:1], 64
    s_load_dwordx2 s[8:9], s[0:1], 104
    s_load_dwordx2 s[12:13], s[0:1], 72
    v_lshrrev_b32 v2, 6, v0
    v_and_b32 v1, 63, v0
    v_readfirstlane_b32 s34, v2
    s_mov_b32 s6, 8388608
    s_mov_b32 s7, 0x20000
    s_mov_b32 s10, 15990784
    s_mov_b32 s11, 0x20000
    s_mov_b32 s14, 4096
    s_mov_b32 s15, 0x20000
    s_and_b32 s40, s2, 7
    s_lshr_b32 s41, s2, 3
    s_and_b32 s41, s41, 31
    s_lshr_b32 s32, s40, 1
    s_lshl_b32 s32, s32, 3
    s_and_b32 s42, s41, 7
    s_add_u32 s32, s32, s42
    s_and_b32 s33, s40, 1
    s_lshl_b32 s33, s33, 2
    s_lshr_b32 s42, s41, 3
    s_add_u32 s33, s33, s42
    s_lshl_b32 s44, s33, 7
    s_lshl_b32 s40, s34, 5
    s_add_u32 s44, s44, s40
    s_mul_i32 s44, s44, 3072
    s_add_u32 s44, s44, 0
    s_lshl_b32 s45, s32, 18
    s_lshl_b32 s40, s34, 10
    s_add_u32 s45, s45, s40
    s_lshl_b32 s46, s34, 14
    v_lshlrev_b32 v5, 4, v1
    v_lshrrev_b32 v2, 3, v1
    v_lshlrev_b32 v2, 12, v2
    v_and_b32 v3, 7, v1
    v_lshrrev_b32 v4, 4, v1
    v_xor_b32 v3, v3, v4
    v_lshl_add_u32 v6, v3, 4, v2
    v_xor_b32 v7, 64, v6
    s_mov_b32 s50, 0
    s_waitcnt lgkmcnt(0)
    s_add_u32 s54, s50, 0
    s_and_b32 s54, s54, 7
    s_lshl_b32 s54, s54, 7
    s_add_u32 s54, s54, s45
    s_add_u32 s42, s54, 0
    s_add_u32 m0, s46, 0
    s_nop 0
    buffer_load_dwordx4 v6, s[4:7], s42 offen lds
    s_add_u32 s42, s54, 32768
    s_add_u32 m0, s46, 1024
    s_nop 0
    buffer_load_dwordx4 v7, s[4:7], s42 offen lds
    s_add_u32 s42, s54, 65536
    s_add_u32 m0, s46, 2048
    s_nop 0
    buffer_load_dwordx4 v6, s[4:7], s42 offen lds
    s_add_u32 s42, s54, 98304
    s_add_u32 m0, s46, 3072
    s_nop 0
    buffer_load_dwordx4 v7, s[4:7], s42 offen lds
    s_add_u32 s42, s54, 131072
    s_add_u32 m0, s46, 4096
    s_nop 0
    buffer_load_dwordx4 v6, s[4:7], s42 offen lds
    s_add_u32 s42, s54, 163840
    s_add_u32 m0, s46, 5120
    s_nop 0
    buffer_load_dwordx4 v7, s[4:7], s42 offen lds
    s_add_u32 s42, s54, 196608
    s_add_u32 m0, s46, 6144
    s_nop 0
    buffer_load_dwordx4 v6, s[4:7], s42 offen lds
    s_add_u32 s42, s54, 229376
    s_add_u32 m0, s46, 7168
    s_nop 0
    buffer_load_dwordx4 v7, s[4:7], s42 offen lds
    s_lshl_b32 s43, s33, 8
    s_add_u32 s43, s43, 14716928
    v_mbcnt_lo_u32_b32 v2, -1, 0
    v_mbcnt_hi_u32_b32 v2, -1, v2
    v_and_b32 v2, 31, v2
    v_lshlrev_b32 v2, 3, v2
    s_mov_b32 s67, 0
fpoll_11:
    buffer_load_dwordx2 v[104:105], v2, s[8:11], s43 offen sc1
    s_add_u32 s67, s67, 1
    s_waitcnt vmcnt(0)
    v_cmp_ne_u32 vcc, s100, v104
    v_cmp_ne_u32 s[64:65], s101, v105
    s_nop 0
    s_or_b64 vcc, vcc, s[64:65]
    s_cmp_gt_u32 s67, 100000
    s_cbranch_scc1 fpoll_e_12
    s_cmp_eq_u64 vcc, 0
    s_cbranch_scc1 fpoll_e_12
    s_sleep 2
    s_branch fpoll_11
fpoll_e_12:
    s_add_u32 s52, s50, 0
    s_and_b32 s52, s52, 7
    s_mul_i32 s52, s52, 12288
    s_add_u32 s52, s52, s44
    buffer_load_dwordx4 v[104:107], v5, s[8:11], s52 offen offset:0 sc1
    buffer_load_dwordx4 v[108:111], v5, s[8:11], s52 offen offset:1024 sc1
    buffer_load_dwordx4 v[112:115], v5, s[8:11], s52 offen offset:2048 sc1
    s_add_u32 s41, s52, 3072
    buffer_load_dwordx4 v[116:119], v5, s[8:11], s41 offen offset:0 sc1
    s_add_u32 s41, s52, 3072
    buffer_load_dwordx4 v[120:123], v5, s[8:11], s41 offen offset:1024 sc1
    s_add_u32 s41, s52, 3072
    buffer_load_dwordx4 v[124:127], v5, s[8:11], s41 offen offset:2048 sc1
    s_add_u32 s41, s52, 6144
    buffer_load_dwordx4 v[128:131], v5, s[8:11], s41 offen offset:0 sc1
    s_add_u32 s41, s52, 6144
    buffer_load_dwordx4 v[132:135], v5, s[8:11], s41 offen offset:1024 sc1
    s_add_u32 s41, s52, 6144
    buffer_load_dwordx4 v[136:139], v5, s[8:11], s41 offen offset:2048 sc1
    s_add_u32 s41, s52, 9216
    buffer_load_dwordx4 v[140:143], v5, s[8:11], s41 offen offset:0 sc1
    s_add_u32 s41, s52, 9216
    buffer_load_dwordx4 v[144:147], v5, s[8:11], s41 offen offset:1024 sc1
    s_add_u32 s41, s52, 9216
    buffer_load_dwordx4 v[148:151], v5, s[8:11], s41 offen offset:2048 sc1
    v_and_b32 v2, 31, v1
    v_lshrrev_b32 v3, 1, v2
    v_and_b32 v3, 7, v3
    v_lshrrev_b32 v4, 5, v1
    v_xor_b32 v3, v3, v4
    v_lshl_add_u32 v2, v2, 7, s46
    v_xor_b32 v4, 0, v3
    v_lshl_add_u32 v180, v4, 4, v2
    v_xor_b32 v4, 2, v3
    v_lshl_add_u32 v181, v4, 4, v2
    v_xor_b32 v4, 4, v3
    v_lshl_add_u32 v182, v4, 4, v2
    v_xor_b32 v4, 6, v3
    v_lshl_add_u32 v183, v4, 4, v2
    s_waitcnt vmcnt(12)
    s_setprio 2
    ds_read_b128 v[164:167], v180 offset:0
    ds_read_b128 v[168:171], v180 offset:4096
    s_waitcnt vmcnt(9)
    s_waitcnt lgkmcnt(0)
    v_mfma_f32_32x32x16_bf16 v[8:23], v[104:107], v[164:167], 0
    ds_read_b128 v[172:175], v181 offset:0
    ds_read_b128 v[176:179], v181 offset:4096
    v_mfma_f32_32x32x16_bf16 v[24:39], v[104:107], v[168:171], 0
    s_add_u32 s53, s50, 1
    s_and_b32 s53, s53, 7
    s_mul_i32 s53, s53, 12288
    s_add_u32 s53, s53, s44
    buffer_load_dwordx4 v[152:155], v5, s[8:11], s53 offen offset:0 sc1
    v_mfma_f32_32x32x16_bf16 v[40:55], v[108:111], v[164:167], 0
    buffer_load_dwordx4 v[156:159], v5, s[8:11], s53 offen offset:1024 sc1
    v_mfma_f32_32x32x16_bf16 v[56:71], v[108:111], v[168:171], 0
    buffer_load_dwordx4 v[160:163], v5, s[8:11], s53 offen offset:2048 sc1
    v_mfma_f32_32x32x16_bf16 v[72:87], v[112:115], v[164:167], 0
    s_add_u32 s55, s50, 1
    s_and_b32 s55, s55, 7
    s_lshl_b32 s55, s55, 7
    s_add_u32 s55, s55, s45
    s_add_u32 s42, s55, 0
    s_add_u32 m0, s46, 8192
    s_nop 0
    buffer_load_dwordx4 v6, s[4:7], s42 offen lds
    v_mfma_f32_32x32x16_bf16 v[88:103], v[112:115], v[168:171], 0
    s_add_u32 s42, s55, 32768
    s_add_u32 m0, s46, 9216
    s_nop 0
    buffer_load_dwordx4 v7, s[4:7], s42 offen lds
    s_add_u32 s42, s55, 65536
    s_add_u32 m0, s46, 10240
    s_nop 0
    buffer_load_dwordx4 v6, s[4:7], s42 offen lds
    s_add_u32 s42, s55, 98304
    s_add_u32 m0, s46, 11264
    s_nop 0
    buffer_load_dwordx4 v7, s[4:7], s42 offen lds
    s_waitcnt vmcnt(13)
    s_waitcnt lgkmcnt(0)
    v_mfma_f32_32x32x16_bf16 v[8:23], v[116:119], v[172:175], v[8:23]
    ds_read_b128 v[164:167], v182 offset:0
    ds_read_b128 v[168:171], v182 offset:4096
    v_mfma_f32_32x32x16_bf16 v[24:39], v[116:119], v[176:179], v[24:39]
    s_add_u32 s41, s53, 3072
    buffer_load_dwordx4 v[104:107], v5, s[8:11], s41 offen offset:0 sc1
    v_mfma_f32_32x32x16_bf16 v[40:55], v[120:123], v[172:175], v[40:55]
    s_add_u32 s41, s53, 3072
    buffer_load_dwordx4 v[108:111], v5, s[8:11], s41 offen offset:1024 sc1
    v_mfma_f32_32x32x16_bf16 v[56:71], v[120:123], v[176:179], v[56:71]
    s_add_u32 s41, s53, 3072
    buffer_load_dwordx4 v[112:115], v5, s[8:11], s41 offen offset:2048 sc1
    v_mfma_f32_32x32x16_bf16 v[72:87], v[124:127], v[172:175], v[72:87]
    s_add_u32 s42, s55, 131072
    s_add_u32 m0, s46, 12288
    s_nop 0
    buffer_load_dwordx4 v6, s[4:7], s42 offen lds
    v_mfma_f32_32x32x16_bf16 v[88:103], v[124:127], v[176:179], v[88:103]
    s_add_u32 s42, s55, 163840
    s_add_u32 m0, s46, 13312
    s_nop 0
    buffer_load_dwordx4 v7, s[4:7], s42 offen lds
    s_add_u32 s42, s55, 196608
    s_add_u32 m0, s46, 14336
    s_nop 0
    buffer_load_dwordx4 v6, s[4:7], s42 offen lds
    s_add_u32 s42, s55, 229376
    s_add_u32 m0, s46, 15360
    s_nop 0
    buffer_load_dwordx4 v7, s[4:7], s42 offen lds
    s_waitcnt vmcnt(17)
    s_waitcnt lgkmcnt(0)
    v_mfma_f32_32x32x16_bf16 v[8:23], v[128:131], v[164:167], v[8:23]
    ds_read_b128 v[172:175], v183 offset:0
    ds_read_b128 v[176:179], v183 offset:4096
    v_mfma_f32_32x32x16_bf16 v[24:39], v[128:131], v[168:171], v[24:39]
    s_add_u32 s41, s53, 6144
    buffer_load_dwordx4 v[116:119], v5, s[8:11], s41 offen offset:0 sc1
    v_mfma_f32_32x32x16_bf16 v[40:55], v[132:135], v[164:167], v[40:55]
    s_add_u32 s41, s53, 6144
    buffer_load_dwordx4 v[120:123], v5, s[8:11], s41 offen offset:1024 sc1
    v_mfma_f32_32x32x16_bf16 v[56:71], v[132:135], v[168:171], v[56:71]
    s_add_u32 s41, s53, 6144
    buffer_load_dwordx4 v[124:127], v5, s[8:11], s41 offen offset:2048 sc1
    v_mfma_f32_32x32x16_bf16 v[72:87], v[136:139], v[164:167], v[72:87]
    v_mfma_f32_32x32x16_bf16 v[88:103], v[136:139], v[168:171], v[88:103]
    s_waitcnt vmcnt(17)
    s_waitcnt lgkmcnt(0)
    v_mfma_f32_32x32x16_bf16 v[8:23], v[140:143], v[172:175], v[8:23]
    s_waitcnt vmcnt(3)
    ds_read_b128 v[164:167], v180 offset:8192
    ds_read_b128 v[168:171], v180 offset:12288
    v_mfma_f32_32x32x16_bf16 v[24:39], v[140:143], v[176:179], v[24:39]
    s_add_u32 s41, s53, 9216
    buffer_load_dwordx4 v[128:131], v5, s[8:11], s41 offen offset:0 sc1
    v_mfma_f32_32x32x16_bf16 v[40:55], v[144:147], v[172:175], v[40:55]
    s_add_u32 s41, s53, 9216
    buffer_load_dwordx4 v[132:135], v5, s[8:11], s41 offen offset:1024 sc1
    v_mfma_f32_32x32x16_bf16 v[56:71], v[144:147], v[176:179], v[56:71]
    s_add_u32 s41, s53, 9216
    buffer_load_dwordx4 v[136:139], v5, s[8:11], s41 offen offset:2048 sc1
    v_mfma_f32_32x32x16_bf16 v[72:87], v[148:151], v[172:175], v[72:87]
    s_add_u32 s54, s50, 2
    s_and_b32 s54, s54, 7
    s_lshl_b32 s54, s54, 7
    s_add_u32 s54, s54, s45
    s_add_u32 s42, s54, 0
    s_add_u32 m0, s46, 0
    s_nop 0
    buffer_load_dwordx4 v6, s[4:7], s42 offen lds
    v_mfma_f32_32x32x16_bf16 v[88:103], v[148:151], v[176:179], v[88:103]
    s_add_u32 s42, s54, 32768
    s_add_u32 m0, s46, 1024
    s_nop 0
    buffer_load_dwordx4 v7, s[4:7], s42 offen lds
    s_waitcnt vmcnt(19)
    s_waitcnt lgkmcnt(0)
    v_mfma_f32_32x32x16_bf16 v[8:23], v[152:155], v[164:167], v[8:23]
    ds_read_b128 v[172:175], v181 offset:8192
    ds_read_b128 v[176:179], v181 offset:12288
    v_mfma_f32_32x32x16_bf16 v[24:39], v[152:155], v[168:171], v[24:39]
    s_add_u32 s52, s50, 2
    s_and_b32 s52, s52, 7
    s_mul_i32 s52, s52, 12288
    s_add_u32 s52, s52, s44
    buffer_load_dwordx4 v[140:143], v5, s[8:11], s52 offen offset:0 sc1
    v_mfma_f32_32x32x16_bf16 v[40:55], v[156:159], v[164:167], v[40:55]
    buffer_load_dwordx4 v[144:147], v5, s[8:11], s52 offen offset:1024 sc1
    v_mfma_f32_32x32x16_bf16 v[56:71], v[156:159], v[168:171], v[56:71]
    buffer_load_dwordx4 v[148:151], v5, s[8:11], s52 offen offset:2048 sc1
    v_mfma_f32_32x32x16_bf16 v[72:87], v[160:163], v[164:167], v[72:87]
    s_add_u32 s42, s54, 65536
    s_add_u32 m0, s46, 2048
    s_nop 0
    buffer_load_dwordx4 v6, s[4:7], s42 offen lds
    v_mfma_f32_32x32x16_bf16 v[88:103], v[160:163], v[168:171], v[88:103]
    s_add_u32 s42, s54, 98304
    s_add_u32 m0, s46, 3072
    s_nop 0
    buffer_load_dwordx4 v7, s[4:7], s42 offen lds
    s_add_u32 s42, s54, 131072
    s_add_u32 m0, s46, 4096
    s_nop 0
    buffer_load_dwordx4 v6, s[4:7], s42 offen lds
    s_waitcnt vmcnt(18)
    s_waitcnt lgkmcnt(0)
    v_mfma_f32_32x32x16_bf16 v[8:23], v[104:107], v[172:175], v[8:23]
    ds_read_b128 v[164:167], v182 offset:8192
    ds_read_b128 v[168:171], v182 offset:12288
    v_mfma_f32_32x32x16_bf16 v[24:39], v[104:107], v[176:179], v[24:39]
    s_add_u32 s41, s52, 3072
    buffer_load_dwordx4 v[152:155], v5, s[8:11], s41 offen offset:0 sc1
    v_mfma_f32_32x32x16_bf16 v[40:55], v[108:111], v[172:175], v[40:55]
    s_add_u32 s41, s52, 3072
    buffer_load_dwordx4 v[156:159], v5, s[8:11], s41 offen offset:1024 sc1
    v_mfma_f32_32x32x16_bf16 v[56:71], v[108:111], v[176:179], v[56:71]
    s_add_u32 s41, s52, 3072
    buffer_load_dwordx4 v[160:163], v5, s[8:11], s41 offen offset:2048 sc1
    v_mfma_f32_32x32x16_bf16 v[72:87], v[112:115], v[172:175], v[72:87]
    s_add_u32 s42, s54, 163840
    s_add_u32 m0, s46, 5120
    s_nop 0
    buffer_load_dwordx4 v7, s[4:7], s42 offen lds
    v_mfma_f32_32x32x16_bf16 v[88:103], v[112:115], v[176:179], v[88:103]
    s_add_u32 s42, s54, 196608
    s_add_u32 m0, s46, 6144
    s_nop 0
    buffer_load_dwordx4 v6, s[4:7], s42 offen lds
    s_add_u32 s42, s54, 229376
    s_add_u32 m0, s46, 7168
    s_nop 0
    buffer_load_dwordx4 v7, s[4:7], s42 offen lds
    s_waitcnt vmcnt(17)
    s_waitcnt lgkmcnt(0)
    v_mfma_f32_32x32x16_bf16 v[8:23], v[116:119], v[164:167], v[8:23]
    ds_read_b128 v[172:175], v183 offset:8192
    ds_read_b128 v[176:179], v183 offset:12288
    v_mfma_f32_32x32x16_bf16 v[24:39], v[116:119], v[168:171], v[24:39]
    s_add_u32 s41, s52, 6144
    buffer_load_dwordx4 v[104:107], v5, s[8:11], s41 offen offset:0 sc1
    v_mfma_f32_32x32x16_bf16 v[40:55], v[120:123], v[164:167], v[40:55]
    s_add_u32 s41, s52, 6144
    buffer_load_dwordx4 v[108:111], v5, s[8:11], s41 offen offset:1024 sc1
    v_mfma_f32_32x32x16_bf16 v[56:71], v[120:123], v[168:171], v[56:71]
    s_add_u32 s41, s52, 6144
    buffer_load_dwordx4 v[112:115], v5, s[8:11], s41 offen offset:2048 sc1
    v_mfma_f32_32x32x16_bf16 v[72:87], v[124:127], v[164:167], v[72:87]
    v_mfma_f32_32x32x16_bf16 v[88:103], v[124:127], v[168:171], v[88:103]
    s_waitcnt vmcnt(17)
    s_waitcnt lgkmcnt(0)
    v_mfma_f32_32x32x16_bf16 v[8:23], v[128:131], v[172:175], v[8:23]
    s_waitcnt vmcnt(3)
    ds_read_b128 v[164:167], v180 offset:0
    ds_read_b128 v[168:171], v180 offset:4096
    v_mfma_f32_32x32x16_bf16 v[24:39], v[128:131], v[176:179], v[24:39]
    s_add_u32 s41, s52, 9216
    buffer_load_dwordx4 v[116:119], v5, s[8:11], s41 offen offset:0 sc1
    v_mfma_f32_32x32x16_bf16 v[40:55], v[132:135], v[172:175], v[40:55]
    s_add_u32 s41, s52, 9216
    buffer_load_dwordx4 v[120:123], v5, s[8:11], s41 offen offset:1024 sc1
    v_mfma_f32_32x32x16_bf16 v[56:71], v[132:135], v[176:179], v[56:71]
    s_add_u32 s41, s52, 9216
    buffer_load_dwordx4 v[124:127], v5, s[8:11], s41 offen offset:2048 sc1
    v_mfma_f32_32x32x16_bf16 v[72:87], v[136:139], v[172:175], v[72:87]
    s_add_u32 s55, s50, 3
    s_and_b32 s55, s55, 7
    s_lshl_b32 s55, s55, 7
    s_add_u32 s55, s55, s45
    s_add_u32 s42, s55, 0
    s_add_u32 m0, s46, 8192
    s_nop 0
    buffer_load_dwordx4 v6, s[4:7], s42 offen lds
    v_mfma_f32_32x32x16_bf16 v[88:103], v[136:139], v[176:179], v[88:103]
    s_add_u32 s42, s55, 32768
    s_add_u32 m0, s46, 9216
    s_nop 0
    buffer_load_dwordx4 v7, s[4:7], s42 offen lds
    s_waitcnt vmcnt(17)
    s_waitcnt lgkmcnt(0)
    v_mfma_f32_32x32x16_bf16 v[8:23], v[140:143], v[164:167], v[8:23]
    ds_read_b128 v[172:175], v181 offset:0
    ds_read_b128 v[176:179], v181 offset:4096
    v_mfma_f32_32x32x16_bf16 v[24:39], v[140:143], v[168:171], v[24:39]
    s_add_u32 s53, s50, 3
    s_and_b32 s53, s53, 7
    s_mul_i32 s53, s53, 12288
    s_add_u32 s53, s53, s44
    buffer_load_dwordx4 v[128:131], v5, s[8:11], s53 offen offset:0 sc1
    v_mfma_f32_32x32x16_bf16 v[40:55], v[144:147], v[164:167], v[40:55]
    buffer_load_dwordx4 v[132:135], v5, s[8:11], s53 offen offset:1024 sc1
    v_mfma_f32_32x32x16_bf16 v[56:71], v[144:147], v[168:171], v[56:71]
    buffer_load_dwordx4 v[136:139], v5, s[8:11], s53 offen offset:2048 sc1
    v_mfma_f32_32x32x16_bf16 v[72:87], v[148:151], v[164:167], v[72:87]
    s_add_u32 s42, s55, 65536
    s_add_u32 m0, s46, 10240
    s_nop 0
    buffer_load_dwordx4 v6, s[4:7], s42 offen lds
    v_mfma_f32_32x32x16_bf16 v[88:103], v[148:151], v[168:171], v[88:103]
    s_add_u32 s42, s55, 98304
    s_add_u32 m0, s46, 11264
    s_nop 0
    buffer_load_dwordx4 v7, s[4:7], s42 offen lds
    s_add_u32 s42, s55, 131072
    s_add_u32 m0, s46, 12288
    s_nop 0
    buffer_load_dwordx4 v6, s[4:7], s42 offen lds
    s_waitcnt vmcnt(17)
    s_waitcnt lgkmcnt(0)
    v_mfma_f32_32x32x16_bf16 v[8:23], v[152:155], v[172:175], v[8:23]
    ds_read_b128 v[164:167], v182 offset:0
    ds_read_b128 v[168:171], v182 offset:4096
    v_mfma_f32_32x32x16_bf16 v[24:39], v[152:155], v[176:179], v[24:39]
    s_add_u32 s41, s53, 3072
    buffer_load_dwordx4 v[140:143], v5, s[8:11], s41 offen offset:0 sc1
    v_mfma_f32_32x32x16_bf16 v[40:55], v[156:159], v[172:175], v[40:55]
    s_add_u32 s41, s53, 3072
    buffer_load_dwordx4 v[144:147], v5, s[8:11], s41 offen offset:1024 sc1
    v_mfma_f32_32x32x16_bf16 v[56:71], v[156:159], v[176:179], v[56:71]
    s_add_u32 s41, s53, 3072
    buffer_load_dwordx4 v[148:151], v5, s[8:11], s41 offen offset:2048 sc1
    v_mfma_f32_32x32x16_bf16 v[72:87], v[160:163], v[172:175], v[72:87]
    s_add_u32 s42, s55, 163840
    s_add_u32 m0, s46, 13312
    s_nop 0
    buffer_load_dwordx4 v7, s[4:7], s42 offen lds
    v_mfma_f32_32x32x16_bf16 v[88:103], v[160:163], v[176:179], v[88:103]
    s_add_u32 s42, s55, 196608
    s_add_u32 m0, s46, 14336
    s_nop 0
    buffer_load_dwordx4 v6, s[4:7], s42 offen lds
    s_add_u32 s42, s55, 229376
    s_add_u32 m0, s46, 15360
    s_nop 0
    buffer_load_dwordx4 v7, s[4:7], s42 offen lds
    s_waitcnt vmcnt(17)
    s_waitcnt lgkmcnt(0)
    v_mfma_f32_32x32x16_bf16 v[8:23], v[104:107], v[164:167], v[8:23]
    ds_read_b128 v[172:175], v183 offset:0
    ds_read_b128 v[176:179], v183 offset:4096
    v_mfma_f32_32x32x16_bf16 v[24:39], v[104:107], v[168:171], v[24:39]
    s_add_u32 s41, s53, 6144
    buffer_load_dwordx4 v[152:155], v5, s[8:11], s41 offen offset:0 sc1
    v_mfma_f32_32x32x16_bf16 v[40:55], v[108:111], v[164:167], v[40:55]
    s_add_u32 s41, s53, 6144
    buffer_load_dwordx4 v[156:159], v5, s[8:11], s41 offen offset:1024 sc1
    v_mfma_f32_32x32x16_bf16 v[56:71], v[108:111], v[168:171], v[56:71]
    s_add_u32 s41, s53, 6144
    buffer_load_dwordx4 v[160:163], v5, s[8:11], s41 offen offset:2048 sc1
    v_mfma_f32_32x32x16_bf16 v[72:87], v[112:115], v[164:167], v[72:87]
    v_mfma_f32_32x32x16_bf16 v[88:103], v[112:115], v[168:171], v[88:103]
    s_waitcnt vmcnt(17)
    s_waitcnt lgkmcnt(0)
    v_mfma_f32_32x32x16_bf16 v[8:23], v[116:119], v[172:175], v[8:23]
    s_waitcnt vmcnt(3)
    ds_read_b128 v[164:167], v180 offset:8192
    ds_read_b128 v[168:171], v180 offset:12288
    v_mfma_f32_32x32x16_bf16 v[24:39], v[116:119], v[176:179], v[24:39]
    s_add_u32 s41, s53, 9216
    buffer_load_dwordx4 v[104:107], v5, s[8:11], s41 offen offset:0 sc1
    v_mfma_f32_32x32x16_bf16 v[40:55], v[120:123], v[172:175], v[40:55]
    s_add_u32 s41, s53, 9216
    buffer_load_dwordx4 v[108:111], v5, s[8:11], s41 offen offset:1024 sc1
    v_mfma_f32_32x32x16_bf16 v[56:71], v[120:123], v[176:179], v[56:71]
    s_add_u32 s41, s53, 9216
    buffer_load_dwordx4 v[112:115], v5, s[8:11], s41 offen offset:2048 sc1
    v_mfma_f32_32x32x16_bf16 v[72:87], v[124:127], v[172:175], v[72:87]
    s_add_u32 s54, s50, 4
    s_and_b32 s54, s54, 7
    s_lshl_b32 s54, s54, 7
    s_add_u32 s54, s54, s45
    s_add_u32 s42, s54, 0
    s_add_u32 m0, s46, 0
    s_nop 0
    buffer_load_dwordx4 v6, s[4:7], s42 offen lds
    v_mfma_f32_32x32x16_bf16 v[88:103], v[124:127], v[176:179], v[88:103]
    s_add_u32 s42, s54, 32768
    s_add_u32 m0, s46, 1024
    s_nop 0
    buffer_load_dwordx4 v7, s[4:7], s42 offen lds
    s_waitcnt vmcnt(17)
    s_waitcnt lgkmcnt(0)
    v_mfma_f32_32x32x16_bf16 v[8:23], v[128:131], v[164:167], v[8:23]
    ds_read_b128 v[172:175], v181 offset:8192
    ds_read_b128 v[176:179], v181 offset:12288
    v_mfma_f32_32x32x16_bf16 v[24:39], v[128:131], v[168:171], v[24:39]
    s_add_u32 s52, s50, 4
    s_and_b32 s52, s52, 7
    s_mul_i32 s52, s52, 12288
    s_add_u32 s52, s52, s44
    buffer_load_dwordx4 v[116:119], v5, s[8:11], s52 offen offset:0 sc1
    v_mfma_f32_32x32x16_bf16 v[40:55], v[132:135], v[164:167], v[40:55]
    buffer_load_dwordx4 v[120:123], v5, s[8:11], s52 offen offset:1024 sc1
    v_mfma_f32_32x32x16_bf16 v[56:71], v[132:135], v[168:171], v[56:71]
    buffer_load_dwordx4 v[124:127], v5, s[8:11], s52 offen offset:2048 sc1
    v_mfma_f32_32x32x16_bf16 v[72:87], v[136:139], v[164:167], v[72:87]
    s_add_u32 s42, s54, 65536
    s_add_u32 m0, s46, 2048
    s_nop 0
    buffer_load_dwordx4 v6, s[4:7], s42 offen lds
    v_mfma_f32_32x32x16_bf16 v[88:103], v[136:139], v[168:171], v[88:103]
    s_add_u32 s42, s54, 98304
    s_add_u32 m0, s46, 3072
    s_nop 0
    buffer_load_dwordx4 v7, s[4:7], s42 offen lds
    s_add_u32 s42, s54, 131072
    s_add_u32 m0, s46, 4096
    s_nop 0
    buffer_load_dwordx4 v6, s[4:7], s42 offen lds
    s_waitcnt vmcnt(17)
    s_waitcnt lgkmcnt(0)
    v_mfma_f32_32x32x16_bf16 v[8:23], v[140:143], v[172:175], v[8:23]
    ds_read_b128 v[164:167], v182 offset:8192
    ds_read_b128 v[168:171], v182 offset:12288
    v_mfma_f32_32x32x16_bf16 v[24:39], v[140:143], v[176:179], v[24:39]
    s_add_u32 s41, s52, 3072
    buffer_load_dwordx4 v[128:131], v5, s[8:11], s41 offen offset:0 sc1
    v_mfma_f32_32x32x16_bf16 v[40:55], v[144:147], v[172:175], v[40:55]
    s_add_u32 s41, s52, 3072
    buffer_load_dwordx4 v[132:135], v5, s[8:11], s41 offen offset:1024 sc1
    v_mfma_f32_32x32x16_bf16 v[56:71], v[144:147], v[176:179], v[56:71]
    s_add_u32 s41, s52, 3072
    buffer_load_dwordx4 v[136:139], v5, s[8:11], s41 offen offset:2048 sc1
    v_mfma_f32_32x32x16_bf16 v[72:87], v[148:151], v[172:175], v[72:87]
    s_add_u32 s42, s54, 163840
    s_add_u32 m0, s46, 5120
    s_nop 0
    buffer_load_dwordx4 v7, s[4:7], s42 offen lds
    v_mfma_f32_32x32x16_bf16 v[88:103], v[148:151], v[176:179], v[88:103]
    s_add_u32 s42, s54, 196608
    s_add_u32 m0, s46, 6144
    s_nop 0
    buffer_load_dwordx4 v6, s[4:7], s42 offen lds
    s_add_u32 s42, s54, 229376
    s_add_u32 m0, s46, 7168
    s_nop 0
    buffer_load_dwordx4 v7, s[4:7], s42 offen lds
    s_waitcnt vmcnt(17)
    s_waitcnt lgkmcnt(0)
    v_mfma_f32_32x32x16_bf16 v[8:23], v[152:155], v[164:167], v[8:23]
    ds_read_b128 v[172:175], v183 offset:8192
    ds_read_b128 v[176:179], v183 offset:12288
    v_mfma_f32_32x32x16_bf16 v[24:39], v[152:155], v[168:171], v[24:39]
    s_add_u32 s41, s52, 6144
    buffer_load_dwordx4 v[140:143], v5, s[8:11], s41 offen offset:0 sc1
    v_mfma_f32_32x32x16_bf16 v[40:55], v[156:159], v[164:167], v[40:55]
    s_add_u32 s41, s52, 6144
    buffer_load_dwordx4 v[144:147], v5, s[8:11], s41 offen offset:1024 sc1
    v_mfma_f32_32x32x16_bf16 v[56:71], v[156:159], v[168:171], v[56:71]
    s_add_u32 s41, s52, 6144
    buffer_load_dwordx4 v[148:151], v5, s[8:11], s41 offen offset:2048 sc1
    v_mfma_f32_32x32x16_bf16 v[72:87], v[160:163], v[164:167], v[72:87]
    v_mfma_f32_32x32x16_bf16 v[88:103], v[160:163], v[168:171], v[88:103]
    s_waitcnt vmcnt(17)
    s_waitcnt lgkmcnt(0)
    v_mfma_f32_32x32x16_bf16 v[8:23], v[104:107], v[172:175], v[8:23]
    s_waitcnt vmcnt(3)
    ds_read_b128 v[164:167], v180 offset:0
    ds_read_b128 v[168:171], v180 offset:4096
    v_mfma_f32_32x32x16_bf16 v[24:39], v[104:107], v[176:179], v[24:39]
    s_add_u32 s41, s52, 9216
    buffer_load_dwordx4 v[152:155], v5, s[8:11], s41 offen offset:0 sc1
    v_mfma_f32_32x32x16_bf16 v[40:55], v[108:111], v[172:175], v[40:55]
    s_add_u32 s41, s52, 9216
    buffer_load_dwordx4 v[156:159], v5, s[8:11], s41 offen offset:1024 sc1
    v_mfma_f32_32x32x16_bf16 v[56:71], v[108:111], v[176:179], v[56:71]
    s_add_u32 s41, s52, 9216
    buffer_load_dwordx4 v[160:163], v5, s[8:11], s41 offen offset:2048 sc1
    v_mfma_f32_32x32x16_bf16 v[72:87], v[112:115], v[172:175], v[72:87]
    s_add_u32 s55, s50, 5
    s_and_b32 s55, s55, 7
    s_lshl_b32 s55, s55, 7
    s_add_u32 s55, s55, s45
    s_add_u32 s42, s55, 0
    s_add_u32 m0, s46, 8192
    s_nop 0
    buffer_load_dwordx4 v6, s[4:7], s42 offen lds
    v_mfma_f32_32x32x16_bf16 v[88:103], v[112:115], v[176:179], v[88:103]
    s_add_u32 s42, s55, 32768
    s_add_u32 m0, s46, 9216
    s_nop 0
    buffer_load_dwordx4 v7, s[4:7], s42 offen lds
    s_waitcnt vmcnt(17)
    s_waitcnt lgkmcnt(0)
    v_mfma_f32_32x32x16_bf16 v[8:23], v[116:119], v[164:167], v[8:23]
    ds_read_b128 v[172:175], v181 offset:0
    ds_read_b128 v[176:179], v181 offset:4096
    v_mfma_f32_32x32x16_bf16 v[24:39], v[116:119], v[168:171], v[24:39]
    s_add_u32 s53, s50, 5
    s_and_b32 s53, s53, 7
    s_mul_i32 s53, s53, 12288
    s_add_u32 s53, s53, s44
    buffer_load_dwordx4 v[104:107], v5, s[8:11], s53 offen offset:0 sc1
    v_mfma_f32_32x32x16_bf16 v[40:55], v[120:123], v[164:167], v[40:55]
    buffer_load_dwordx4 v[108:111], v5, s[8:11], s53 offen offset:1024 sc1
    v_mfma_f32_32x32x16_bf16 v[56:71], v[120:123], v[168:171], v[56:71]
    buffer_load_dwordx4 v[112:115], v5, s[8:11], s53 offen offset:2048 sc1
    v_mfma_f32_32x32x16_bf16 v[72:87], v[124:127], v[164:167], v[72:87]
    s_add_u32 s42, s55, 65536
    s_add_u32 m0, s46, 10240
    s_nop 0
    buffer_load_dwordx4 v6, s[4:7], s42 offen lds
    v_mfma_f32_32x32x16_bf16 v[88:103], v[124:127], v[168:171], v[88:103]
    s_add_u32 s42, s55, 98304
    s_add_u32 m0, s46, 11264
    s_nop 0
    buffer_load_dwordx4 v7, s[4:7], s42 offen lds
    s_add_u32 s42, s55, 131072
    s_add_u32 m0, s46, 12288
    s_nop 0
    buffer_load_dwordx4 v6, s[4:7], s42 offen lds
    s_waitcnt vmcnt(17)
    s_waitcnt lgkmcnt(0)
    v_mfma_f32_32x32x16_bf16 v[8:23], v[128:131], v[172:175], v[8:23]
    ds_read_b128 v[164:167], v182 offset:0
    ds_read_b128 v[168:171], v182 offset:4096
    v_mfma_f32_32x32x16_bf16 v[24:39], v[128:131], v[176:179], v[24:39]
    s_add_u32 s41, s53, 3072
    buffer_load_dwordx4 v[116:119], v5, s[8:11], s41 offen offset:0 sc1
    v_mfma_f32_32x32x16_bf16 v[40:55], v[132:135], v[172:175], v[40:55]
    s_add_u32 s41, s53, 3072
    buffer_load_dwordx4 v[120:123], v5, s[8:11], s41 offen offset:1024 sc1
    v_mfma_f32_32x32x16_bf16 v[56:71], v[132:135], v[176:179], v[56:71]
    s_add_u32 s41, s53, 3072
    buffer_load_dwordx4 v[124:127], v5, s[8:11], s41 offen offset:2048 sc1
    v_mfma_f32_32x32x16_bf16 v[72:87], v[136:139], v[172:175], v[72:87]
    s_add_u32 s42, s55, 163840
    s_add_u32 m0, s46, 13312
    s_nop 0
    buffer_load_dwordx4 v7, s[4:7], s42 offen lds
    v_mfma_f32_32x32x16_bf16 v[88:103], v[136:139], v[176:179], v[88:103]
    s_add_u32 s42, s55, 196608
    s_add_u32 m0, s46, 14336
    s_nop 0
    buffer_load_dwordx4 v6, s[4:7], s42 offen lds
    s_add_u32 s42, s55, 229376
    s_add_u32 m0, s46, 15360
    s_nop 0
    buffer_load_dwordx4 v7, s[4:7], s42 offen lds
    s_waitcnt vmcnt(17)
    s_waitcnt lgkmcnt(0)
    v_mfma_f32_32x32x16_bf16 v[8:23], v[140:143], v[164:167], v[8:23]
    ds_read_b128 v[172:175], v183 offset:0
    ds_read_b128 v[176:179], v183 offset:4096
    v_mfma_f32_32x32x16_bf16 v[24:39], v[140:143], v[168:171], v[24:39]
    s_add_u32 s41, s53, 6144
    buffer_load_dwordx4 v[128:131], v5, s[8:11], s41 offen offset:0 sc1
    v_mfma_f32_32x32x16_bf16 v[40:55], v[144:147], v[164:167], v[40:55]
    s_add_u32 s41, s53, 6144
    buffer_load_dwordx4 v[132:135], v5, s[8:11], s41 offen offset:1024 sc1
    v_mfma_f32_32x32x16_bf16 v[56:71], v[144:147], v[168:171], v[56:71]
    s_add_u32 s41, s53, 6144
    buffer_load_dwordx4 v[136:139], v5, s[8:11], s41 offen offset:2048 sc1
    v_mfma_f32_32x32x16_bf16 v[72:87], v[148:151], v[164:167], v[72:87]
    v_mfma_f32_32x32x16_bf16 v[88:103], v[148:151], v[168:171], v[88:103]
    s_waitcnt vmcnt(17)
    s_waitcnt lgkmcnt(0)
    v_mfma_f32_32x32x16_bf16 v[8:23], v[152:155], v[172:175], v[8:23]
    s_waitcnt vmcnt(3)
    ds_read_b128 v[164:167], v180 offset:8192
    ds_read_b128 v[168:171], v180 offset:12288
    v_mfma_f32_32x32x16_bf16 v[24:39], v[152:155], v[176:179], v[24:39]
    s_add_u32 s41, s53, 9216
    buffer_load_dwordx4 v[140:143], v5, s[8:11], s41 offen offset:0 sc1
    v_mfma_f32_32x32x16_bf16 v[40:55], v[156:159], v[172:175], v[40:55]
    s_add_u32 s41, s53, 9216
    buffer_load_dwordx4 v[144:147], v5, s[8:11], s41 offen offset:1024 sc1
    v_mfma_f32_32x32x16_bf16 v[56:71], v[156:159], v[176:179], v[56:71]
    s_add_u32 s41, s53, 9216
    buffer_load_dwordx4 v[148:151], v5, s[8:11], s41 offen offset:2048 sc1
    v_mfma_f32_32x32x16_bf16 v[72:87], v[160:163], v[172:175], v[72:87]
    s_add_u32 s54, s50, 6
    s_and_b32 s54, s54, 7
    s_lshl_b32 s54, s54, 7
    s_add_u32 s54, s54, s45
    s_add_u32 s42, s54, 0
    s_add_u32 m0, s46, 0
    s_nop 0
    buffer_load_dwordx4 v6, s[4:7], s42 offen lds
    v_mfma_f32_32x32x16_bf16 v[88:103], v[160:163], v[176:179], v[88:103]
    s_add_u32 s42, s54, 32768
    s_add_u32 m0, s46, 1024
    s_nop 0
    buffer_load_dwordx4 v7, s[4:7], s42 offen lds
    s_waitcnt vmcnt(17)
    s_waitcnt lgkmcnt(0)
    v_mfma_f32_32x32x16_bf16 v[8:23], v[104:107], v[164:167], v[8:23]
    ds_read_b128 v[172:175], v181 offset:8192
    ds_read_b128 v[176:179], v181 offset:12288
    v_mfma_f32_32x32x16_bf16 v[24:39], v[104:107], v[168:171], v[24:39]
    s_add_u32 s52, s50, 6
    s_and_b32 s52, s52, 7
    s_mul_i32 s52, s52, 12288
    s_add_u32 s52, s52, s44
    buffer_load_dwordx4 v[152:155], v5, s[8:11], s52 offen offset:0 sc1
    v_mfma_f32_32x32x16_bf16 v[40:55], v[108:111], v[164:167], v[40:55]
    buffer_load_dwordx4 v[156:159], v5, s[8:11], s52 offen offset:1024 sc1
    v_mfma_f32_32x32x16_bf16 v[56:71], v[108:111], v[168:171], v[56:71]
    buffer_load_dwordx4 v[160:163], v5, s[8:11], s52 offen offset:2048 sc1
    v_mfma_f32_32x32x16_bf16 v[72:87], v[112:115], v[164:167], v[72:87]
    s_add_u32 s42, s54, 65536
    s_add_u32 m0, s46, 2048
    s_nop 0
    buffer_load_dwordx4 v6, s[4:7], s42 offen lds
    v_mfma_f32_32x32x16_bf16 v[88:103], v[112:115], v[168:171], v[88:103]
    s_add_u32 s42, s54, 98304
    s_add_u32 m0, s46, 3072
    s_nop 0
    buffer_load_dwordx4 v7, s[4:7], s42 offen lds
    s_add_u32 s42, s54, 131072
    s_add_u32 m0, s46, 4096
    s_nop 0
    buffer_load_dwordx4 v6, s[4:7], s42 offen lds
    s_waitcnt vmcnt(17)
    s_waitcnt lgkmcnt(0)
    v_mfma_f32_32x32x16_bf16 v[8:23], v[116:119], v[172:175], v[8:23]
    ds_read_b128 v[164:167], v182 offset:8192
    ds_read_b128 v[168:171], v182 offset:12288
    v_mfma_f32_32x32x16_bf16 v[24:39], v[116:119], v[176:179], v[24:39]
    s_add_u32 s41, s52, 3072
    buffer_load_dwordx4 v[104:107], v5, s[8:11], s41 offen offset:0 sc1
    v_mfma_f32_32x32x16_bf16 v[40:55], v[120:123], v[172:175], v[40:55]
    s_add_u32 s41, s52, 3072
    buffer_load_dwordx4 v[108:111], v5, s[8:11], s41 offen offset:1024 sc1
    v_mfma_f32_32x32x16_bf16 v[56:71], v[120:123], v[176:179], v[56:71]
    s_add_u32 s41, s52, 3072
    buffer_load_dwordx4 v[112:115], v5, s[8:11], s41 offen offset:2048 sc1
    v_mfma_f32_32x32x16_bf16 v[72:87], v[124:127], v[172:175], v[72:87]
    s_add_u32 s42, s54, 163840
    s_add_u32 m0, s46, 5120
    s_nop 0
    buffer_load_dwordx4 v7, s[4:7], s42 offen lds
    v_mfma_f32_32x32x16_bf16 v[88:103], v[124:127], v[176:179], v[88:103]
    s_add_u32 s42, s54, 196608
    s_add_u32 m0, s46, 6144
    s_nop 0
    buffer_load_dwordx4 v6, s[4:7], s42 offen lds
    s_add_u32 s42, s54, 229376
    s_add_u32 m0, s46, 7168
    s_nop 0
    buffer_load_dwordx4 v7, s[4:7], s42 offen lds
    s_waitcnt vmcnt(17)
    s_waitcnt lgkmcnt(0)
    v_mfma_f32_32x32x16_bf16 v[8:23], v[128:131], v[164:167], v[8:23]
    ds_read_b128 v[172:175], v183 offset:8192
    ds_read_b128 v[176:179], v183 offset:12288
    v_mfma_f32_32x32x16_bf16 v[24:39], v[128:131], v[168:171], v[24:39]
    s_add_u32 s41, s52, 6144
    buffer_load_dwordx4 v[116:119], v5, s[8:11], s41 offen offset:0 sc1
    v_mfma_f32_32x32x16_bf16 v[40:55], v[132:135], v[164:167], v[40:55]
    s_add_u32 s41, s52, 6144
    buffer_load_dwordx4 v[120:123], v5, s[8:11], s41 offen offset:1024 sc1
    v_mfma_f32_32x32x16_bf16 v[56:71], v[132:135], v[168:171], v[56:71]
    s_add_u32 s41, s52, 6144
    buffer_load_dwordx4 v[124:127], v5, s[8:11], s41 offen offset:2048 sc1
    v_mfma_f32_32x32x16_bf16 v[72:87], v[136:139], v[164:167], v[72:87]
    v_mfma_f32_32x32x16_bf16 v[88:103], v[136:139], v[168:171], v[88:103]
    s_waitcnt vmcnt(17)
    s_waitcnt lgkmcnt(0)
    v_mfma_f32_32x32x16_bf16 v[8:23], v[140:143], v[172:175], v[8:23]
    s_waitcnt vmcnt(3)
    ds_read_b128 v[164:167], v180 offset:0
    ds_read_b128 v[168:171], v180 offset:4096
    v_mfma_f32_32x32x16_bf16 v[24:39], v[140:143], v[176:179], v[24:39]
    s_add_u32 s41, s52, 9216
    buffer_load_dwordx4 v[128:131], v5, s[8:11], s41 offen offset:0 sc1
    v_mfma_f32_32x32x16_bf16 v[40:55], v[144:147], v[172:175], v[40:55]
    s_add_u32 s41, s52, 9216
    buffer_load_dwordx4 v[132:135], v5, s[8:11], s41 offen offset:1024 sc1
    v_mfma_f32_32x32x16_bf16 v[56:71], v[144:147], v[176:179], v[56:71]
    s_add_u32 s41, s52, 9216
    buffer_load_dwordx4 v[136:139], v5, s[8:11], s41 offen offset:2048 sc1
    v_mfma_f32_32x32x16_bf16 v[72:87], v[148:151], v[172:175], v[72:87]
    s_add_u32 s55, s50, 7
    s_and_b32 s55, s55, 7
    s_lshl_b32 s55, s55, 7
    s_add_u32 s55, s55, s45
    s_add_u32 s42, s55, 0
    s_add_u32 m0, s46, 8192
    s_nop 0
    buffer_load_dwordx4 v6, s[4:7], s42 offen lds
    v_mfma_f32_32x32x16_bf16 v[88:103], v[148:151], v[176:179], v[88:103]
    s_add_u32 s42, s55, 32768
    s_add_u32 m0, s46, 9216
    s_nop 0
    buffer_load_dwordx4 v7, s[4:7], s42 offen lds
    s_waitcnt vmcnt(17)
    s_waitcnt lgkmcnt(0)
    v_mfma_f32_32x32x16_bf16 v[8:23], v[152:155], v[164:167], v[8:23]
    ds_read_b128 v[172:175], v181 offset:0
    ds_read_b128 v[176:179], v181 offset:4096
    v_mfma_f32_32x32x16_bf16 v[24:39], v[152:155], v[168:171], v[24:39]
    s_add_u32 s53, s50, 7
    s_and_b32 s53, s53, 7
    s_mul_i32 s53, s53, 12288
    s_add_u32 s53, s53, s44
    buffer_load_dwordx4 v[140:143], v5, s[8:11], s53 offen offset:0 sc1
    v_mfma_f32_32x32x16_bf16 v[40:55], v[156:159], v[164:167], v[40:55]
    buffer_load_dwordx4 v[144:147], v5, s[8:11], s53 offen offset:1024 sc1
    v_mfma_f32_32x32x16_bf16 v[56:71], v[156:159], v[168:171], v[56:71]
    buffer_load_dwordx4 v[148:151], v5, s[8:11], s53 offen offset:2048 sc1
    v_mfma_f32_32x32x16_bf16 v[72:87], v[160:163], v[164:167], v[72:87]
    s_add_u32 s42, s55, 65536
    s_add_u32 m0, s46, 10240
    s_nop 0
    buffer_load_dwordx4 v6, s[4:7], s42 offen lds
    v_mfma_f32_32x32x16_bf16 v[88:103], v[160:163], v[168:171], v[88:103]
    s_add_u32 s42, s55, 98304
    s_add_u32 m0, s46, 11264
    s_nop 0
    buffer_load_dwordx4 v7, s[4:7], s42 offen lds
    s_add_u32 s42, s55, 131072
    s_add_u32 m0, s46, 12288
    s_nop 0
    buffer_load_dwordx4 v6, s[4:7], s42 offen lds
    s_waitcnt vmcnt(17)
    s_waitcnt lgkmcnt(0)
    v_mfma_f32_32x32x16_bf16 v[8:23], v[104:107], v[172:175], v[8:23]
    ds_read_b128 v[164:167], v182 offset:0
    ds_read_b128 v[168:171], v182 offset:4096
    v_mfma_f32_32x32x16_bf16 v[24:39], v[104:107], v[176:179], v[24:39]
    s_add_u32 s41, s53, 3072
    buffer_load_dwordx4 v[152:155], v5, s[8:11], s41 offen offset:0 sc1
    v_mfma_f32_32x32x16_bf16 v[40:55], v[108:111], v[172:175], v[40:55]
    s_add_u32 s41, s53, 3072
    buffer_load_dwordx4 v[156:159], v5, s[8:11], s41 offen offset:1024 sc1
    v_mfma_f32_32x32x16_bf16 v[56:71], v[108:111], v[176:179], v[56:71]
    s_add_u32 s41, s53, 3072
    buffer_load_dwordx4 v[160:163], v5, s[8:11], s41 offen offset:2048 sc1
    v_mfma_f32_32x32x16_bf16 v[72:87], v[112:115], v[172:175], v[72:87]
    s_add_u32 s42, s55, 163840
    s_add_u32 m0, s46, 13312
    s_nop 0
    buffer_load_dwordx4 v7, s[4:7], s42 offen lds
    v_mfma_f32_32x32x16_bf16 v[88:103], v[112:115], v[176:179], v[88:103]
    s_add_u32 s42, s55, 196608
    s_add_u32 m0, s46, 14336
    s_nop 0
    buffer_load_dwordx4 v6, s[4:7], s42 offen lds
    s_add_u32 s42, s55, 229376
    s_add_u32 m0, s46, 15360
    s_nop 0
    buffer_load_dwordx4 v7, s[4:7], s42 offen lds
    s_waitcnt vmcnt(17)
    s_waitcnt lgkmcnt(0)
    v_mfma_f32_32x32x16_bf16 v[8:23], v[116:119], v[164:167], v[8:23]
    ds_read_b128 v[172:175], v183 offset:0
    ds_read_b128 v[176:179], v183 offset:4096
    v_mfma_f32_32x32x16_bf16 v[24:39], v[116:119], v[168:171], v[24:39]
    s_add_u32 s41, s53, 6144
    buffer_load_dwordx4 v[104:107], v5, s[8:11], s41 offen offset:0 sc1
    v_mfma_f32_32x32x16_bf16 v[40:55], v[120:123], v[164:167], v[40:55]
    s_add_u32 s41, s53, 6144
    buffer_load_dwordx4 v[108:111], v5, s[8:11], s41 offen offset:1024 sc1
    v_mfma_f32_32x32x16_bf16 v[56:71], v[120:123], v[168:171], v[56:71]
    s_add_u32 s41, s53, 6144
    buffer_load_dwordx4 v[112:115], v5, s[8:11], s41 offen offset:2048 sc1
    v_mfma_f32_32x32x16_bf16 v[72:87], v[124:127], v[164:167], v[72:87]
    v_mfma_f32_32x32x16_bf16 v[88:103], v[124:127], v[168:171], v[88:103]
    s_waitcnt vmcnt(17)
    s_waitcnt lgkmcnt(0)
    v_mfma_f32_32x32x16_bf16 v[8:23], v[128:131], v[172:175], v[8:23]
    s_waitcnt vmcnt(3)
    ds_read_b128 v[164:167], v180 offset:8192
    ds_read_b128 v[168:171], v180 offset:12288
    v_mfma_f32_32x32x16_bf16 v[24:39], v[128:131], v[176:179], v[24:39]
    s_add_u32 s41, s53, 9216
    buffer_load_dwordx4 v[116:119], v5, s[8:11], s41 offen offset:0 sc1
    v_mfma_f32_32x32x16_bf16 v[40:55], v[132:135], v[172:175], v[40:55]
    s_add_u32 s41, s53, 9216
    buffer_load_dwordx4 v[120:123], v5, s[8:11], s41 offen offset:1024 sc1
    v_mfma_f32_32x32x16_bf16 v[56:71], v[132:135], v[176:179], v[56:71]
    s_add_u32 s41, s53, 9216
    buffer_load_dwordx4 v[124:127], v5, s[8:11], s41 offen offset:2048 sc1
    v_mfma_f32_32x32x16_bf16 v[72:87], v[136:139], v[172:175], v[72:87]
    v_mfma_f32_32x32x16_bf16 v[88:103], v[136:139], v[176:179], v[88:103]
    s_waitcnt vmcnt(15)
    s_waitcnt lgkmcnt(0)
    v_mfma_f32_32x32x16_bf16 v[8:23], v[140:143], v[164:167], v[8:23]
    ds_read_b128 v[172:175], v181 offset:8192
    ds_read_b128 v[176:179], v181 offset:12288
    v_mfma_f32_32x32x16_bf16 v[24:39], v[140:143], v[168:171], v[24:39]
    v_mfma_f32_32x32x16_bf16 v[40:55], v[144:147], v[164:167], v[40:55]
    v_mfma_f32_32x32x16_bf16 v[56:71], v[144:147], v[168:171], v[56:71]
    v_mfma_f32_32x32x16_bf16 v[72:87], v[148:151], v[164:167], v[72:87]
    v_mfma_f32_32x32x16_bf16 v[88:103], v[148:151], v[168:171], v[88:103]
    s_waitcnt vmcnt(9)
    s_waitcnt lgkmcnt(0)
    v_mfma_f32_32x32x16_bf16 v[8:23], v[152:155], v[172:175], v[8:23]
    ds_read_b128 v[164:167], v182 offset:8192
    ds_read_b128 v[168:171], v182 offset:12288
    v_mfma_f32_32x32x16_bf16 v[24:39], v[152:155], v[176:179], v[24:39]
    v_mfma_f32_32x32x16_bf16 v[40:55], v[156:159], v[172:175], v[40:55]
    v_mfma_f32_32x32x16_bf16 v[56:71], v[156:159], v[176:179], v[56:71]
    v_mfma_f32_32x32x16_bf16 v[72:87], v[160:163], v[172:175], v[72:87]
    v_mfma_f32_32x32x16_bf16 v[88:103], v[160:163], v[176:179], v[88:103]
    s_waitcnt vmcnt(3)
    s_waitcnt lgkmcnt(0)
    v_mfma_f32_32x32x16_bf16 v[8:23], v[104:107], v[164:167], v[8:23]
    ds_read_b128 v[172:175], v183 offset:8192
    ds_read_b128 v[176:179], v183 offset:12288
    v_mfma_f32_32x32x16_bf16 v[24:39], v[104:107], v[168:171], v[24:39]
    s_lshl_b32 s40, s32, 3
    s_add_u32 s40, s40, s33
    s_lshl_b32 s40, s40, 2
    s_add_u32 s40, s40, s34
    s_mul_i32 s40, s40, 3072
    s_add_u32 s40, s40, 3145728
    s_mul_i32 s40, s34, 3072
    s_add_u32 s40, s40, 73728
    v_add_u32 v3, s40, v5
    ds_read_b128 v[184:187], v3 offset:0
    v_mfma_f32_32x32x16_bf16 v[40:55], v[108:111], v[164:167], v[40:55]
    ds_read_b128 v[188:191], v3 offset:1024
    v_mfma_f32_32x32x16_bf16 v[56:71], v[108:111], v[168:171], v[56:71]
    ds_read_b128 v[192:195], v3 offset:2048
    v_mfma_f32_32x32x16_bf16 v[72:87], v[112:115], v[164:167], v[72:87]
    v_and_b32 v2, 31, v1
    v_lshlrev_b32 v2, 1, v2
    s_lshr_b32 s40, s34, 1
    s_lshl_b32 s40, s40, 6
    s_lshl_b32 s43, s32, 7
    s_add_u32 s40, s40, s43
    buffer_load_ushort v196, v2, s[12:15], s40 offen
    v_mfma_f32_32x32x16_bf16 v[88:103], v[112:115], v[168:171], v[88:103]
    s_waitcnt vmcnt(1)
    s_waitcnt lgkmcnt(3)
    v_mfma_f32_32x32x16_bf16 v[8:23], v[116:119], v[172:175], v[8:23]
    v_mfma_f32_32x32x16_bf16 v[24:39], v[116:119], v[176:179], v[24:39]
    v_mfma_f32_32x32x16_bf16 v[40:55], v[120:123], v[172:175], v[40:55]
    v_mfma_f32_32x32x16_bf16 v[56:71], v[120:123], v[176:179], v[56:71]
    v_mfma_f32_32x32x16_bf16 v[72:87], v[124:127], v[172:175], v[72:87]
    v_mfma_f32_32x32x16_bf16 v[88:103], v[124:127], v[176:179], v[88:103]
    s_setprio 0
    v_add_u32 v4, 0x10000, v5
    s_nop 15
    s_waitcnt lgkmcnt(0)
    v_mov_b32 v2, 161792
    v_mov_b32 v3, 1
    s_mov_b64 exec, 1
    ds_add_u32 v2, v3
    s_mov_b64 exec, -1
    s_mov_b32 s67, 0
gsync_18:
    ds_read_b32 v3, v2
    s_add_u32 s67, s67, 1
    s_waitcnt lgkmcnt(0)
    v_readfirstlane_b32 s66, v3
    s_cmp_gt_u32 s67, 1000000
    s_cbranch_scc1 gsync_e_19
    s_cmp_lt_u32 s66, 4
    s_cbranch_scc1 gsync_18
gsync_e_19:
    s_cmp_lg_u32 s34, 0
    s_cbranch_scc1 g_epi_14
    ds_write_b128 v5, v[12:15] offset:30720
    ds_write_b128 v5, v[20:23] offset:31744
    ds_write_b128 v5, v[44:47] offset:32768
    ds_write_b128 v5, v[52:55] offset:33792
    ds_write_b128 v5, v[76:79] offset:34816
    ds_write_b128 v5, v[84:87] offset:35840
    ds_write_b128 v5, v[24:27] offset:43008
    ds_write_b128 v5, v[32:35] offset:44032
    ds_write_b128 v5, v[56:59] offset:45056
    ds_write_b128 v5, v[64:67] offset:46080
    ds_write_b128 v5, v[88:91] offset:47104
    ds_write_b128 v5, v[96:99] offset:48128
    ds_write_b128 v5, v[28:31] offset:55296
    ds_write_b128 v5, v[36:39] offset:56320
    ds_write_b128 v5, v[60:63] offset:57344
    ds_write_b128 v5, v[68:71] offset:58368
    ds_write_b128 v5, v[92:95] offset:59392
    ds_write_b128 v5, v[100:103] offset:60416
    v_pk_add_f32 v[104:105], v[8:9], 0
    v_pk_add_f32 v[106:107], v[10:11], 0
    v_pk_add_f32 v[108:109], v[16:17], 0
    v_pk_add_f32 v[110:111], v[18:19], 0
    v_pk_add_f32 v[112:113], v[40:41], 0
    v_pk_add_f32 v[114:115], v[42:43], 0
    v_pk_add_f32 v[116:117], v[48:49], 0
    v_pk_add_f32 v[118:119], v[50:51], 0
    v_pk_add_f32 v[120:121], v[72:73], 0
    v_pk_add_f32 v[122:123], v[74:75], 0
    v_pk_add_f32 v[124:125], v[80:81], 0
    v_pk_add_f32 v[126:127], v[82:83], 0
    s_branch g_epi_end_13
g_epi_14:
    s_cmp_lg_u32 s34, 1
    s_cbranch_scc1 g_epi_15
    ds_write_b128 v5, v[8:11] offset:0
    ds_write_b128 v5, v[16:19] offset:1024
    ds_write_b128 v5, v[40:43] offset:2048
    ds_write_b128 v5, v[48:51] offset:3072
    ds_write_b128 v5, v[72:75] offset:4096
    ds_write_b128 v5, v[80:83] offset:5120
    ds_write_b128 v5, v[24:27] offset:49152
    ds_write_b128 v5, v[32:35] offset:50176
    ds_write_b128 v5, v[56:59] offset:51200
    ds_write_b128 v5, v[64:67] offset:52224
    ds_write_b128 v5, v[88:91] offset:53248
    ds_write_b128 v5, v[96:99] offset:54272
    ds_write_b128 v5, v[28:31] offset:61440
    ds_write_b128 v5, v[36:39] offset:62464
    ds_write_b128 v5, v[60:63] offset:63488
    ds_write_b128 v5, v[68:71] offset:64512
    ds_write_b128 v4, v[92:95] offset:0
    ds_write_b128 v4, v[100:103] offset:1024
    v_pk_add_f32 v[104:105], v[12:13], 0
    v_pk_add_f32 v[106:107], v[14:15], 0
    v_pk_add_f32 v[108:109], v[20:21], 0
    v_pk_add_f32 v[110:111], v[22:23], 0
    v_pk_add_f32 v[112:113], v[44:45], 0
    v_pk_add_f32 v[114:115], v[46:47], 0
    v_pk_add_f32 v[116:117], v[52:53], 0
    v_pk_add_f32 v[118:119], v[54:55], 0
    v_pk_add_f32 v[120:121], v[76:77], 0
    v_pk_add_f32 v[122:123], v[78:79], 0
    v_pk_add_f32 v[124:125], v[84:85], 0
    v_pk_add_f32 v[126:127], v[86:87], 0
    s_branch g_epi_end_13
g_epi_15:
    s_cmp_lg_u32 s34, 2
    s_cbranch_scc1 g_epi_16
    ds_write_b128 v5, v[8:11] offset:6144
    ds_write_b128 v5, v[16:19] offset:7168
    ds_write_b128 v5, v[40:43] offset:8192
    ds_write_b128 v5, v[48:51] offset:9216
    ds_write_b128 v5, v[72:75] offset:10240
    ds_write_b128 v5, v[80:83] offset:11264
    ds_write_b128 v5, v[12:15] offset:18432
    ds_write_b128 v5, v[20:23] offset:19456
    ds_write_b128 v5, v[44:47] offset:20480
    ds_write_b128 v5, v[52:55] offset:21504
    ds_write_b128 v5, v[76:79] offset:22528
    ds_write_b128 v5, v[84:87] offset:23552
    ds_write_b128 v4, v[28:31] offset:2048
    ds_write_b128 v4, v[36:39] offset:3072
    ds_write_b128 v4, v[60:63] offset:4096
    ds_write_b128 v4, v[68:71] offset:5120
    ds_write_b128 v4, v[92:95] offset:6144
    ds_write_b128 v4, v[100:103] offset:7168
    v_pk_add_f32 v[104:105], v[24:25], 0
    v_pk_add_f32 v[106:107], v[26:27], 0
    v_pk_add_f32 v[108:109], v[32:33], 0
    v_pk_add_f32 v[110:111], v[34:35], 0
    v_pk_add_f32 v[112:113], v[56:57], 0
    v_pk_add_f32 v[114:115], v[58:59], 0
    v_pk_add_f32 v[116:117], v[64:65], 0
    v_pk_add_f32 v[118:119], v[66:67], 0
    v_pk_add_f32 v[120:121], v[88:89], 0
    v_pk_add_f32 v[122:123], v[90:91], 0
    v_pk_add_f32 v[124:125], v[96:97], 0
    v_pk_add_f32 v[126:127], v[98:99], 0
    s_branch g_epi_end_13
g_epi_16:
    ds_write_b128 v5, v[8:11] offset:12288
    ds_write_b128 v5, v[16:19] offset:13312
    ds_write_b128 v5, v[40:43] offset:14336
    ds_write_b128 v5, v[48:51] offset:15360
    ds_write_b128 v5, v[72:75] offset:16384
    ds_write_b128 v5, v[80:83] offset:17408
    ds_write_b128 v5, v[12:15] offset:24576
    ds_write_b128 v5, v[20:23] offset:25600
    ds_write_b128 v5, v[44:47] offset:26624
    ds_write_b128 v5, v[52:55] offset:27648
    ds_write_b128 v5, v[76:79] offset:28672
    ds_write_b128 v5, v[84:87] offset:29696
    ds_write_b128 v5, v[24:27] offset:36864
    ds_write_b128 v5, v[32:35] offset:37888
    ds_write_b128 v5, v[56:59] offset:38912
    ds_write_b128 v5, v[64:67] offset:39936
    ds_write_b128 v5, v[88:91] offset:40960
    ds_write_b128 v5, v[96:99] offset:41984
    v_pk_add_f32 v[104:105], v[28:29], 0
    v_pk_add_f32 v[106:107], v[30:31], 0
    v_pk_add_f32 v[108:109], v[36:37], 0
    v_pk_add_f32 v[110:111], v[38:39], 0
    v_pk_add_f32 v[112:113], v[60:61], 0
    v_pk_add_f32 v[114:115], v[62:63], 0
    v_pk_add_f32 v[116:117], v[68:69], 0
    v_pk_add_f32 v[118:119], v[70:71], 0
    v_pk_add_f32 v[120:121], v[92:93], 0
    v_pk_add_f32 v[122:123], v[94:95], 0
    v_pk_add_f32 v[124:125], v[100:101], 0
    v_pk_add_f32 v[126:127], v[102:103], 0
g_epi_end_13:
    s_waitcnt lgkmcnt(0)
    s_waitcnt lgkmcnt(0)
    v_mov_b32 v2, 161792
    v_mov_b32 v3, 1
    s_mov_b64 exec, 1
    ds_add_u32 v2, v3
    s_mov_b64 exec, -1
    s_mov_b32 s67, 0
gsync_20:
    ds_read_b32 v3, v2
    s_add_u32 s67, s67, 1
    s_waitcnt lgkmcnt(0)
    v_readfirstlane_b32 s66, v3
    s_cmp_gt_u32 s67, 1000000
    s_cbranch_scc1 gsync_e_21
    s_cmp_lt_u32 s66, 8
    s_cbranch_scc1 gsync_20
gsync_e_21:
    s_mul_i32 s40, s34, 18432
    v_add_u32 v2, s40, v5
    ds_read_b128 v[8:11], v2 offset:0
    ds_read_b128 v[12:15], v2 offset:1024
    ds_read_b128 v[16:19], v2 offset:2048
    ds_read_b128 v[20:23], v2 offset:3072
    ds_read_b128 v[24:27], v2 offset:4096
    ds_read_b128 v[28:31], v2 offset:5120
    ds_read_b128 v[32:35], v2 offset:6144
    ds_read_b128 v[36:39], v2 offset:7168
    ds_read_b128 v[40:43], v2 offset:8192
    ds_read_b128 v[44:47], v2 offset:9216
    ds_read_b128 v[48:51], v2 offset:10240
    ds_read_b128 v[52:55], v2 offset:11264
    ds_read_b128 v[56:59], v2 offset:12288
    ds_read_b128 v[60:63], v2 offset:13312
    ds_read_b128 v[64:67], v2 offset:14336
    ds_read_b128 v[68:71], v2 offset:15360
    ds_read_b128 v[72:75], v2 offset:16384
    ds_read_b128 v[76:79], v2 offset:17408
    v_lshrrev_b32 v6, 4, v1
    v_and_b32 v6, 1, v6
    v_mul_u32_u24 v6, 24576, v6
    v_and_b32 v3, 15, v1
    v_lshrrev_b32 v4, 5, v1
    v_lshl_add_u32 v3, v4, 4, v3
    v_lshl_add_u32 v6, v3, 4, v6
    s_mul_i32 s40, s32, 98304
    s_lshr_b32 s41, s34, 1
    s_mul_i32 s41, s41, 49152
    s_add_u32 s40, s40, s41
    s_mul_i32 s41, s33, 3072
    s_add_u32 s40, s40, s41
    s_and_b32 s41, s34, 1
    s_lshl_b32 s41, s41, 9
    s_add_u32 s40, s40, s41
    s_add_u32 s40, s40, 11534336
    s_waitcnt vmcnt(0)
    v_lshlrev_b32 v180, 16, v196
    v_lshlrev_b32 v80, 16, v184
    v_and_b32 v81, 0xffff0000, v184
    v_lshlrev_b32 v82, 16, v185
    v_and_b32 v83, 0xffff0000, v185
    v_lshlrev_b32 v84, 16, v186
    v_and_b32 v85, 0xffff0000, v186
    v_lshlrev_b32 v86, 16, v187
    v_and_b32 v87, 0xffff0000, v187
    v_lshlrev_b32 v88, 16, v188
    v_and_b32 v89, 0xffff0000, v188
    v_lshlrev_b32 v90, 16, v189
    v_and_b32 v91, 0xffff0000, v189
    v_lshlrev_b32 v92, 16, v190
    v_and_b32 v93, 0xffff0000, v190
    v_lshlrev_b32 v94, 16, v191
    v_and_b32 v95, 0xffff0000, v191
    v_lshlrev_b32 v96, 16, v192
    v_and_b32 v97, 0xffff0000, v192
    v_lshlrev_b32 v98, 16, v193
    v_and_b32 v99, 0xffff0000, v193
    v_lshlrev_b32 v100, 16, v194
    v_and_b32 v101, 0xffff0000, v194
    v_lshlrev_b32 v102, 16, v195
    v_and_b32 v103, 0xffff0000, v195
    s_waitcnt lgkmcnt(12)
    v_pk_add_f32 v[104:105], v[104:105], v[8:9]
    v_pk_add_f32 v[106:107], v[106:107], v[10:11]
    v_pk_add_f32 v[108:109], v[108:109], v[12:13]
    v_pk_add_f32 v[110:111], v[110:111], v[14:15]
    v_pk_add_f32 v[112:113], v[112:113], v[16:17]
    v_pk_add_f32 v[114:115], v[114:115], v[18:19]
    v_pk_add_f32 v[116:117], v[116:117], v[20:21]
    v_pk_add_f32 v[118:119], v[118:119], v[22:23]
    v_pk_add_f32 v[120:121], v[120:121], v[24:25]
    v_pk_add_f32 v[122:123], v[122:123], v[26:27]
    v_pk_add_f32 v[124:125], v[124:125], v[28:29]
    v_pk_add_f32 v[126:127], v[126:127], v[30:31]
    s_waitcnt lgkmcnt(6)
    v_pk_add_f32 v[104:105], v[104:105], v[32:33]
    v_pk_add_f32 v[106:107], v[106:107], v[34:35]
    v_pk_add_f32 v[108:109], v[108:109], v[36:37]
    v_pk_add_f32 v[110:111], v[110:111], v[38:39]
    v_pk_add_f32 v[112:113], v[112:113], v[40:41]
    v_pk_add_f32 v[114:115], v[114:115], v[42:43]
    v_pk_add_f32 v[116:117], v[116:117], v[44:45]
    v_pk_add_f32 v[118:119], v[118:119], v[46:47]
    v_pk_add_f32 v[120:121], v[120:121], v[48:49]
    v_pk_add_f32 v[122:123], v[122:123], v[50:51]
    v_pk_add_f32 v[124:125], v[124:125], v[52:53]
    v_pk_add_f32 v[126:127], v[126:127], v[54:55]
    s_waitcnt lgkmcnt(0)
    v_pk_add_f32 v[104:105], v[104:105], v[56:57]
    v_pk_add_f32 v[106:107], v[106:107], v[58:59]
    v_pk_add_f32 v[108:109], v[108:109], v[60:61]
    v_pk_add_f32 v[110:111], v[110:111], v[62:63]
    v_pk_add_f32 v[112:113], v[112:113], v[64:65]
    v_pk_add_f32 v[114:115], v[114:115], v[66:67]
    v_pk_add_f32 v[116:117], v[116:117], v[68:69]
    v_pk_add_f32 v[118:119], v[118:119], v[70:71]
    v_pk_add_f32 v[120:121], v[120:121], v[72:73]
    v_pk_add_f32 v[122:123], v[122:123], v[74:75]
    v_pk_add_f32 v[124:125], v[124:125], v[76:77]
    v_pk_add_f32 v[126:127], v[126:127], v[78:79]
    v_pk_add_f32 v[104:105], v[104:105], v[180:181] op_sel_hi:[1,0]
    v_pk_add_f32 v[106:107], v[106:107], v[180:181] op_sel_hi:[1,0]
    v_pk_add_f32 v[108:109], v[108:109], v[180:181] op_sel_hi:[1,0]
    v_pk_add_f32 v[110:111], v[110:111], v[180:181] op_sel_hi:[1,0]
    v_pk_add_f32 v[112:113], v[112:113], v[180:181] op_sel_hi:[1,0]
    v_pk_add_f32 v[114:115], v[114:115], v[180:181] op_sel_hi:[1,0]
    v_pk_add_f32 v[116:117], v[116:117], v[180:181] op_sel_hi:[1,0]
    v_pk_add_f32 v[118:119], v[118:119], v[180:181] op_sel_hi:[1,0]
    v_pk_add_f32 v[120:121], v[120:121], v[180:181] op_sel_hi:[1,0]
    v_pk_add_f32 v[122:123], v[122:123], v[180:181] op_sel_hi:[1,0]
    v_pk_add_f32 v[124:125], v[124:125], v[180:181] op_sel_hi:[1,0]
    v_pk_add_f32 v[126:127], v[126:127], v[180:181] op_sel_hi:[1,0]
    v_pk_mul_f32 v[104:105], v[104:105], v[80:81]
    v_pk_mul_f32 v[106:107], v[106:107], v[82:83]
    v_pk_mul_f32 v[108:109], v[108:109], v[84:85]
    v_pk_mul_f32 v[110:111], v[110:111], v[86:87]
    v_pk_mul_f32 v[112:113], v[112:113], v[88:89]
    v_pk_mul_f32 v[114:115], v[114:115], v[90:91]
    v_pk_mul_f32 v[116:117], v[116:117], v[92:93]
    v_pk_mul_f32 v[118:119], v[118:119], v[94:95]
    v_pk_mul_f32 v[120:121], v[120:121], v[96:97]
    v_pk_mul_f32 v[122:123], v[122:123], v[98:99]
    v_pk_mul_f32 v[124:125], v[124:125], v[100:101]
    v_pk_mul_f32 v[126:127], v[126:127], v[102:103]
    v_cvt_pk_bf16_f32 v8, v104, v105
    v_cvt_pk_bf16_f32 v9, v106, v107
    v_cvt_pk_bf16_f32 v10, v108, v109
    v_cvt_pk_bf16_f32 v11, v110, v111
    buffer_store_dwordx4 v[8:11], v6, s[8:11], s40 offen offset:0 sc1
    v_cvt_pk_bf16_f32 v12, v112, v113
    v_cvt_pk_bf16_f32 v13, v114, v115
    v_cvt_pk_bf16_f32 v14, v116, v117
    v_cvt_pk_bf16_f32 v15, v118, v119
    buffer_store_dwordx4 v[12:15], v6, s[8:11], s40 offen offset:1024 sc1
    v_cvt_pk_bf16_f32 v16, v120, v121
    v_cvt_pk_bf16_f32 v17, v122, v123
    v_cvt_pk_bf16_f32 v18, v124, v125
    v_cvt_pk_bf16_f32 v19, v126, v127
    buffer_store_dwordx4 v[16:19], v6, s[8:11], s40 offen offset:2048 sc1
    s_endpgm
k12_kernel_conv:
    s_load_dwordx2 s[4:5], s[0:1], 32
    s_load_dwordx2 s[8:9], s[0:1], 104
    s_load_dwordx2 s[12:13], s[0:1], 40
    s_load_dwordx2 s[16:17], s[0:1], 64
    s_load_dwordx2 s[20:21], s[0:1], 80
    v_subrev_u32 v0, 256, v0
    v_lshrrev_b32 v3, 6, v0
    v_and_b32 v1, 63, v0
    v_readfirstlane_b32 s34, v3
    s_mov_b32 s6, 2621440
    s_mov_b32 s7, 0x20000
    s_mov_b32 s10, 15990784
    s_mov_b32 s11, 0x20000
    s_mov_b32 s14, 1280
    s_mov_b32 s15, 0x20000
    s_mov_b32 s18, 8388608
    s_mov_b32 s19, 0x20000
    s_mov_b32 s22, 983040
    s_mov_b32 s23, 0x20000
    s_mov_b32 s32, s2
    v_lshlrev_b32 v2, 4, v0
    v_subrev_u32 v47, 16, v2
    s_mov_b32 s56, s2
    s_add_u32 s57, s2, 256
    s_lshr_b32 s58, s2, 1
    s_add_u32 s58, s58, 512
    s_waitcnt lgkmcnt(0)
    s_lshl_b32 s40, s56, 12
    buffer_load_dwordx4 v[12:15], v2, s[4:7], s40 offen
    buffer_load_dwordx4 v[8:11], v47, s[4:7], s40 offen
    s_lshl_b32 s41, s56, 1
    v_mov_b32 v3, 0
    buffer_load_ushort v44, v3, s[12:15], s41 offen
    s_lshr_b32 s47, s2, 3
    s_lshl_b32 s47, s47, 2
    s_add_u32 s47, s47, s34
    s_mul_i32 s40, s47, 12
    v_add_u32 v3, s40, v1
    v_mul_u32_u24 v4, 43691, v3
    v_lshrrev_b32 v4, 22, v4
    v_mul_u32_u24 v5, 96, v4
    v_sub_u32 v3, v3, v5
    v_mul_u32_u24 v4, 98304, v4
    v_lshl_add_u32 v57, v3, 7, v4
    s_and_b32 s40, s2, 7
    s_lshr_b32 s52, s40, 1
    s_lshl_b32 s52, s52, 21
    s_and_b32 s53, s40, 1
    s_mul_i32 s53, s53, 1572864
    s_add_u32 s53, s53, 0
    s_lshl_b32 s40, s47, 4
    v_add_u32 v3, s40, v1
    v_lshrrev_b32 v4, 2, v3
    v_lshlrev_b32 v4, 12, v4
    v_and_b32 v3, 3, v3
    v_lshl_add_u32 v56, v3, 10, v4
    s_cmp_ge_u32 s2, 192
    s_cbranch_scc1 c_wj_22
    s_mul_i32 s40, s2, 2731
    s_lshr_b32 s40, s40, 16
    s_mul_i32 s41, s40, 24
    s_sub_u32 s41, s2, s41
    s_mul_i32 s41, s41, 40960
    s_mul_i32 s40, s40, 160
    s_add_u32 s54, s40, s41
    v_mov_b32 v3, v0
    v_mul_u32_u24 v4, 6554, v3
    v_lshrrev_b32 v4, 16, v4
    v_mul_u32_u24 v5, 10, v4
    v_sub_u32 v3, v3, v5
    v_lshlrev_b32 v3, 4, v3
    v_mul_u32_u24 v4, 1280, v4
    v_add_u32 v3, v3, v4
    s_lshl_b32 s40, s34, 10
    s_add_u32 m0, s40, 156672
    s_nop 0
    buffer_load_dwordx4 v3, s[20:23], s54 offen lds
    s_cmp_lg_u32 s34, 0
    s_cbranch_scc1 c_wj2_23
    v_add_u32 v3, 256, v1
    v_mul_u32_u24 v4, 6554, v3
    v_lshrrev_b32 v4, 16, v4
    v_mul_u32_u24 v5, 10, v4
    v_sub_u32 v3, v3, v5
    v_lshlrev_b32 v3, 4, v3
    v_mul_u32_u24 v4, 1280, v4
    v_add_u32 v3, v3, v4
    s_mov_b32 m0, 160768
    s_nop 0
    buffer_load_dwordx4 v3, s[20:23], s54 offen lds
c_wj2_23:
c_wj_22:
    s_lshl_b32 s40, s57, 12
    buffer_load_dwordx4 v[20:23], v2, s[4:7], s40 offen
    buffer_load_dwordx4 v[16:19], v47, s[4:7], s40 offen
    s_lshl_b32 s41, s57, 1
    v_mov_b32 v3, 0
    buffer_load_ushort v45, v3, s[12:15], s41 offen
    s_lshl_b32 s40, s58, 12
    buffer_load_dwordx4 v[28:31], v2, s[4:7], s40 offen
    buffer_load_dwordx4 v[24:27], v47, s[4:7], s40 offen
    s_lshl_b32 s41, s58, 1
    v_mov_b32 v3, 0
    buffer_load_ushort v46, v3, s[12:15], s41 offen
    v_mov_b32 v60, 0
    v_mov_b32 v61, 0
    v_mov_b32 v62, 0
    v_mov_b32 v63, 0
    v_mul_u32_u24 v3, 4160, v0
    v_add_u32 v3, 86016, v3
    v_cmp_gt_u32 vcc, 64, v0
    s_nop 0
    s_and_saveexec_b64 s[50:51], vcc
    s_cbranch_execz c_z_24
    v_subrev_u32 v4, -118784, v2
    v_cmp_gt_u32 vcc, 8, v0
    s_nop 1
    v_cndmask_b32 v4, v4, v3, vcc
    v_add_u32 v5, -8, v0
    v_cmp_lt_u32 vcc, 23, v5
    s_nop 0
    s_and_b64 exec, exec, vcc
    ds_write_b128 v4, v[60:63]
c_z_24:
    s_mov_b64 exec, s[50:51]
    v_add_u32 v64, 86032, v2
    v_add_u32 v65, 119808, v2
    v_and_b32 v3, 7, v1
    v_mul_u32_u24 v3, 4160, v3
    v_bfe_u32 v4, v1, 3, 1
    v_lshrrev_b32 v5, 4, v1
    v_sub_u32 v4, v4, v5
    v_add_u32 v4, 3, v4
    v_lshl_add_u32 v66, v4, 4, v3
    v_add_u32 v66, 86016, v66
    v_and_b32 v3, 15, v1
    v_lshl_add_u32 v3, v3, 1, v5
    v_lshlrev_b32 v67, 4, v3
    v_add_u32 v67, 119296, v67
    v_and_b32 v3, 15, v1
    v_lshlrev_b32 v4, 3, v5
    v_sub_u32 v4, v4, v3
    v_add_u32 v4, -9, v4
    v_mov_b32 v72, 0xffff
    v_mov_b32 v73, 0xffff0000
    v_cmp_eq_u32 vcc, 0, v4
    s_nop 1
    v_cndmask_b32 v68, 0, v72, vcc
    v_cmp_eq_u32 vcc, 1, v4
    s_nop 1
    v_cndmask_b32 v68, v68, v73, vcc
    v_cmp_eq_u32 vcc, 2, v4
    s_nop 1
    v_cndmask_b32 v69, 0, v72, vcc
    v_cmp_eq_u32 vcc, 3, v4
    s_nop 1
    v_cndmask_b32 v69, v69, v73, vcc
    v_cmp_eq_u32 vcc, 4, v4
    s_nop 1
    v_cndmask_b32 v70, 0, v72, vcc
    v_cmp_eq_u32 vcc, 5, v4
    s_nop 1
    v_cndmask_b32 v70, v70, v73, vcc
    v_cmp_eq_u32 vcc, 6, v4
    s_nop 1
    v_cndmask_b32 v71, 0, v72, vcc
    v_cmp_eq_u32 vcc, 7, v4
    s_nop 1
    v_cndmask_b32 v71, v71, v73, vcc
    v_and_b32 v3, 15, v1
    v_lshlrev_b32 v3, 6, v3
    v_lshl_add_u32 v3, v5, 4, v3
    s_lshl_b32 s40, s34, 13
    s_add_u32 s40, s40, 123904
    v_add_u32 v74, s40, v3
    v_lshlrev_b32 v75, 5, v0
    v_add_u32 v75, 123904, v75
    s_waitcnt vmcnt(6)
    v_cmp_ne_u32 vcc, 0, v0
    s_nop 1
    v_cndmask_b32 v8, 0, v8, vcc
    v_cndmask_b32 v9, 0, v9, vcc
    v_cndmask_b32 v10, 0, v10, vcc
    v_cndmask_b32 v11, 0, v11, vcc
    v_alignbit_b32 v184, v9, v8, 16
    v_alignbit_b32 v185, v10, v9, 16
    v_alignbit_b32 v186, v11, v10, 16
    v_alignbit_b32 v187, v12, v11, 16
    v_alignbit_b32 v188, v13, v12, 16
    v_alignbit_b32 v189, v14, v13, 16
    v_alignbit_b32 v190, v15, v14, 16
    ds_write_b128 v64, v[184:187] offset:0
    v_mov_b32 v192, v9
    v_mov_b32 v193, v10
    v_mov_b32 v194, v11
    v_mov_b32 v195, v12
    ds_write_b128 v64, v[192:195] offset:4160
    s_nop 1
    v_mov_b32 v192, v185
    v_mov_b32 v193, v186
    v_mov_b32 v194, v187
    v_mov_b32 v195, v188
    ds_write_b128 v64, v[192:195] offset:8320
    s_nop 1
    ds_write_b128 v64, v[10:13] offset:12480
    ds_write_b128 v64, v[186:189] offset:16640
    v_mov_b32 v192, v11
    v_mov_b32 v193, v12
    v_mov_b32 v194, v13
    v_mov_b32 v195, v14
    ds_write_b128 v64, v[192:195] offset:20800
    s_nop 1
    v_mov_b32 v192, v187
    v_mov_b32 v193, v188
    v_mov_b32 v194, v189
    v_mov_b32 v195, v190
    ds_write_b128 v64, v[192:195] offset:24960
    s_nop 1
    ds_write_b128 v64, v[12:15] offset:29120
    v_mbcnt_lo_u32_b32 v3, -1, 0
    v_mbcnt_hi_u32_b32 v3, -1, v3
    v_lshlrev_b32 v3, 4, v3
    s_mov_b32 s66, 14716928
    s_mov_b32 s67, 0
fpoll_25:
    buffer_load_dwordx4 v[48:51], v3, s[8:11], s66 offen sc1
    buffer_load_dwordx4 v[52:55], v3, s[8:11], s66 offen offset:1024 sc1
    s_add_u32 s67, s67, 1
    s_waitcnt vmcnt(0)
    v_cmp_ne_u32 vcc, s100, v48
    v_cmp_ne_u32 s[64:65], s101, v49
    s_nop 0
    s_or_b64 vcc, vcc, s[64:65]
    v_cmp_ne_u32 s[64:65], s100, v50
    s_nop 0
    s_or_b64 vcc, vcc, s[64:65]
    v_cmp_ne_u32 s[64:65], s101, v51
    s_nop 0
    s_or_b64 vcc, vcc, s[64:65]
    v_cmp_ne_u32 s[64:65], s100, v52
    s_nop 0
    s_or_b64 vcc, vcc, s[64:65]
    v_cmp_ne_u32 s[64:65], s101, v53
    s_nop 0
    s_or_b64 vcc, vcc, s[64:65]
    v_cmp_ne_u32 s[64:65], s100, v54
    s_nop 0
    s_or_b64 vcc, vcc, s[64:65]
    v_cmp_ne_u32 s[64:65], s101, v55
    s_nop 0
    s_or_b64 vcc, vcc, s[64:65]
    s_cmp_gt_u32 s67, 100000
    s_cbranch_scc1 fpoll_e_26
    s_cmp_eq_u64 vcc, 0
    s_cbranch_scc1 fpoll_e_26
    s_sleep 2
    s_branch fpoll_25
fpoll_e_26:
    s_lshl_b32 s40, s56, 12
    s_add_u32 s40, s40, 6291456
    buffer_load_dwordx4 v[32:35], v2, s[8:11], s40 offen sc1
    s_lshl_b32 s40, s57, 12
    s_add_u32 s40, s40, 6291456
    buffer_load_dwordx4 v[36:39], v2, s[8:11], s40 offen sc1
    s_lshl_b32 s40, s58, 12
    s_add_u32 s40, s40, 6291456
    buffer_load_dwordx4 v[40:43], v2, s[8:11], s40 offen sc1
    s_waitcnt vmcnt(2)
    ds_write_b128 v65, v[32:35]
    v_lshlrev_b32 v3, 16, v44
    v_or_b32 v3, v3, v44
    v_and_b32 v196, v68, v3
    v_and_b32 v197, v69, v3
    v_and_b32 v198, v70, v3
    v_and_b32 v199, v71, v3
    s_waitcnt lgkmcnt(0)
    v_mov_b32 v3, 161796
    v_mov_b32 v4, 1
    s_mov_b64 exec, 1
    ds_add_u32 v3, v4
    s_mov_b64 exec, -1
    s_mov_b32 s67, 0
gsync_27:
    ds_read_b32 v4, v3
    s_add_u32 s67, s67, 1
    s_waitcnt lgkmcnt(0)
    v_readfirstlane_b32 s66, v4
    s_cmp_gt_u32 s67, 1000000
    s_cbranch_scc1 gsync_e_28
    s_cmp_lt_u32 s66, 4
    s_cbranch_scc1 gsync_27
gsync_e_28:
    s_cmp_lg_u32 s34, 0
    s_cbranch_scc1 c_pw_30
    ds_read_b128 v[108:111], v66 offset:0
    ds_read_b128 v[120:123], v67 offset:480
    ds_read_b128 v[124:127], v67 offset:992
    ds_read_b128 v[128:131], v67 offset:1504
    ds_read_b128 v[132:135], v67 offset:2016
    ds_read_b128 v[136:139], v67 offset:2528
    ds_read_b128 v[140:143], v67 offset:3040
    ds_read_b128 v[144:147], v67 offset:3552
    ds_read_b128 v[148:151], v67 offset:4064
    ds_read_b128 v[112:115], v66 offset:512
    ds_read_b128 v[116:119], v66 offset:1024
    s_waitcnt lgkmcnt(2)
    v_mfma_f32_16x16x32_bf16 v[104:107], v[108:111], v[148:151], 0
    v_mfma_f32_16x16x32_bf16 v[100:103], v[108:111], v[144:147], 0
    v_mfma_f32_16x16x32_bf16 v[96:99], v[108:111], v[140:143], 0
    v_mfma_f32_16x16x32_bf16 v[92:95], v[108:111], v[136:139], 0
    v_mfma_f32_16x16x32_bf16 v[88:91], v[108:111], v[132:135], 0
    v_mfma_f32_16x16x32_bf16 v[84:87], v[108:111], v[128:131], 0
    v_mfma_f32_16x16x32_bf16 v[80:83], v[108:111], v[124:127], 0
    v_mfma_f32_16x16x32_bf16 v[76:79], v[108:111], v[120:123], 0
    v_mfma_f32_16x16x32_bf16 v[76:79], v[196:199], v[120:123], v[76:79]
    v_mfma_f32_16x16x32_bf16 v[80:83], v[196:199], v[124:127], v[80:83]
    v_mfma_f32_16x16x32_bf16 v[84:87], v[196:199], v[128:131], v[84:87]
    v_mfma_f32_16x16x32_bf16 v[88:91], v[196:199], v[132:135], v[88:91]
    v_mfma_f32_16x16x32_bf16 v[92:95], v[196:199], v[136:139], v[92:95]
    v_mfma_f32_16x16x32_bf16 v[96:99], v[196:199], v[140:143], v[96:99]
    v_mfma_f32_16x16x32_bf16 v[100:103], v[196:199], v[144:147], v[100:103]
    v_mfma_f32_16x16x32_bf16 v[104:107], v[196:199], v[148:151], v[104:107]
    ds_read_b128 v[108:111], v66 offset:1536
    s_waitcnt lgkmcnt(2)
    v_mfma_f32_16x16x32_bf16 v[104:107], v[112:115], v[144:147], v[104:107]
    v_mfma_f32_16x16x32_bf16 v[100:103], v[112:115], v[140:143], v[100:103]
    v_mfma_f32_16x16x32_bf16 v[96:99], v[112:115], v[136:139], v[96:99]
    v_mfma_f32_16x16x32_bf16 v[92:95], v[112:115], v[132:135], v[92:95]
    v_mfma_f32_16x16x32_bf16 v[88:91], v[112:115], v[128:131], v[88:91]
    v_mfma_f32_16x16x32_bf16 v[84:87], v[112:115], v[124:127], v[84:87]
    v_mfma_f32_16x16x32_bf16 v[80:83], v[112:115], v[120:123], v[80:83]
    ds_read_b128 v[112:115], v66 offset:2048
    ds_read_b128 v[152:155], v67 offset:416
    ds_read_b128 v[156:159], v67 offset:928
    ds_read_b128 v[160:163], v67 offset:1440
    ds_read_b128 v[164:167], v67 offset:1952
    ds_read_b128 v[168:171], v67 offset:2464
    ds_read_b128 v[172:175], v67 offset:2976
    ds_read_b128 v[176:179], v67 offset:3488
    ds_read_b128 v[180:183], v67 offset:4000
    s_waitcnt lgkmcnt(10)
    v_mfma_f32_16x16x32_bf16 v[104:107], v[116:119], v[140:143], v[104:107]
    v_mfma_f32_16x16x32_bf16 v[100:103], v[116:119], v[136:139], v[100:103]
    v_mfma_f32_16x16x32_bf16 v[96:99], v[116:119], v[132:135], v[96:99]
    v_mfma_f32_16x16x32_bf16 v[92:95], v[116:119], v[128:131], v[92:95]
    v_mfma_f32_16x16x32_bf16 v[88:91], v[116:119], v[124:127], v[88:91]
    v_mfma_f32_16x16x32_bf16 v[84:87], v[116:119], v[120:123], v[84:87]
    ds_read_b128 v[116:119], v66 offset:2560
    s_waitcnt lgkmcnt(10)
    v_mfma_f32_16x16x32_bf16 v[104:107], v[108:111], v[136:139], v[104:107]
    v_mfma_f32_16x16x32_bf16 v[100:103], v[108:111], v[132:135], v[100:103]
    v_mfma_f32_16x16x32_bf16 v[96:99], v[108:111], v[128:131], v[96:99]
    v_mfma_f32_16x16x32_bf16 v[92:95], v[108:111], v[124:127], v[92:95]
    v_mfma_f32_16x16x32_bf16 v[88:91], v[108:111], v[120:123], v[88:91]
    ds_read_b128 v[108:111], v66 offset:3072
    s_waitcnt lgkmcnt(10)
    v_mfma_f32_16x16x32_bf16 v[104:107], v[112:115], v[132:135], v[104:107]
    v_mfma_f32_16x16x32_bf16 v[100:103], v[112:115], v[128:131], v[100:103]
    v_mfma_f32_16x16x32_bf16 v[96:99], v[112:115], v[124:127], v[96:99]
    v_mfma_f32_16x16x32_bf16 v[92:95], v[112:115], v[120:123], v[92:95]
    ds_read_b128 v[112:115], v66 offset:3584
    s_waitcnt lgkmcnt(2)
    v_mfma_f32_16x16x32_bf16 v[104:107], v[116:119], v[128:131], v[104:107]
    v_mfma_f32_16x16x32_bf16 v[100:103], v[116:119], v[124:127], v[100:103]
    v_mfma_f32_16x16x32_bf16 v[96:99], v[116:119], v[120:123], v[96:99]
    ds_read_b128 v[116:119], v66 offset:64
    s_waitcnt lgkmcnt(2)
    v_mfma_f32_16x16x32_bf16 v[104:107], v[108:111], v[124:127], v[104:107]
    v_mfma_f32_16x16x32_bf16 v[100:103], v[108:111], v[120:123], v[100:103]
    ds_read_b128 v[108:111], v66 offset:576
    s_waitcnt lgkmcnt(2)
    v_mfma_f32_16x16x32_bf16 v[104:107], v[112:115], v[120:123], v[104:107]
    ds_read_b128 v[112:115], v66 offset:1088
    s_waitcnt lgkmcnt(2)
    v_mfma_f32_16x16x32_bf16 v[104:107], v[116:119], v[180:183], v[104:107]
    v_mfma_f32_16x16x32_bf16 v[100:103], v[116:119], v[176:179], v[100:103]
    v_mfma_f32_16x16x32_bf16 v[96:99], v[116:119], v[172:175], v[96:99]
    v_mfma_f32_16x16x32_bf16 v[92:95], v[116:119], v[168:171], v[92:95]
    v_mfma_f32_16x16x32_bf16 v[88:91], v[116:119], v[164:167], v[88:91]
    v_mfma_f32_16x16x32_bf16 v[84:87], v[116:119], v[160:163], v[84:87]
    v_mfma_f32_16x16x32_bf16 v[80:83], v[116:119], v[156:159], v[80:83]
    v_mfma_f32_16x16x32_bf16 v[76:79], v[116:119], v[152:155], v[76:79]
    ds_read_b128 v[116:119], v66 offset:1600
    s_waitcnt lgkmcnt(2)
    v_mfma_f32_16x16x32_bf16 v[104:107], v[108:111], v[176:179], v[104:107]
    v_mfma_f32_16x16x32_bf16 v[100:103], v[108:111], v[172:175], v[100:103]
    v_mfma_f32_16x16x32_bf16 v[96:99], v[108:111], v[168:171], v[96:99]
    v_mfma_f32_16x16x32_bf16 v[92:95], v[108:111], v[164:167], v[92:95]
    v_mfma_f32_16x16x32_bf16 v[88:91], v[108:111], v[160:163], v[88:91]
    v_mfma_f32_16x16x32_bf16 v[84:87], v[108:111], v[156:159], v[84:87]
    v_mfma_f32_16x16x32_bf16 v[80:83], v[108:111], v[152:155], v[80:83]
    ds_read_b128 v[108:111], v66 offset:2112
    s_waitcnt lgkmcnt(2)
    v_mfma_f32_16x16x32_bf16 v[104:107], v[112:115], v[172:175], v[104:107]
    v_mfma_f32_16x16x32_bf16 v[100:103], v[112:115], v[168:171], v[100:103]
    v_mfma_f32_16x16x32_bf16 v[96:99], v[112:115], v[164:167], v[96:99]
    v_mfma_f32_16x16x32_bf16 v[92:95], v[112:115], v[160:163], v[92:95]
    v_mfma_f32_16x16x32_bf16 v[88:91], v[112:115], v[156:159], v[88:91]
    v_mfma_f32_16x16x32_bf16 v[84:87], v[112:115], v[152:155], v[84:87]
    ds_read_b128 v[112:115], v66 offset:2624
    s_waitcnt lgkmcnt(2)
    v_mfma_f32_16x16x32_bf16 v[104:107], v[116:119], v[168:171], v[104:107]
    v_mfma_f32_16x16x32_bf16 v[100:103], v[116:119], v[164:167], v[100:103]
    v_mfma_f32_16x16x32_bf16 v[96:99], v[116:119], v[160:163], v[96:99]
    v_mfma_f32_16x16x32_bf16 v[92:95], v[116:119], v[156:159], v[92:95]
    v_mfma_f32_16x16x32_bf16 v[88:91], v[116:119], v[152:155], v[88:91]
    ds_read_b128 v[116:119], v66 offset:3136
    s_waitcnt lgkmcnt(2)
    v_mfma_f32_16x16x32_bf16 v[104:107], v[108:111], v[164:167], v[104:107]
    v_mfma_f32_16x16x32_bf16 v[100:103], v[108:111], v[160:163], v[100:103]
    v_mfma_f32_16x16x32_bf16 v[96:99], v[108:111], v[156:159], v[96:99]
    v_mfma_f32_16x16x32_bf16 v[92:95], v[108:111], v[152:155], v[92:95]
    ds_read_b128 v[108:111], v66 offset:3648
    s_waitcnt lgkmcnt(2)
    v_mfma_f32_16x16x32_bf16 v[104:107], v[112:115], v[160:163], v[104:107]
    v_mfma_f32_16x16x32_bf16 v[100:103], v[112:115], v[156:159], v[100:103]
    v_mfma_f32_16x16x32_bf16 v[96:99], v[112:115], v[152:155], v[96:99]
    s_waitcnt lgkmcnt(1)
    v_mfma_f32_16x16x32_bf16 v[104:107], v[116:119], v[156:159], v[104:107]
    v_mfma_f32_16x16x32_bf16 v[100:103], v[116:119], v[152:155], v[100:103]
    s_waitcnt lgkmcnt(0)
    v_mfma_f32_16x16x32_bf16 v[104:107], v[108:111], v[152:155], v[104:107]
    ds_write_b128 v74, v[76:79] offset:0
    ds_write_b128 v74, v[80:83] offset:1024
    ds_write_b128 v74, v[84:87] offset:2048
    ds_write_b128 v74, v[88:91] offset:3072
    ds_write_b128 v74, v[92:95] offset:4096
    ds_write_b128 v74, v[96:99] offset:5120
    ds_write_b128 v74, v[100:103] offset:6144
    s_nop 0
    ds_write_b128 v74, v[104:107] offset:7168
    s_branch c_pw_end_29
c_pw_30:
    s_cmp_lg_u32 s34, 1
    s_cbranch_scc1 c_pw_31
    ds_read_b128 v[108:111], v66 offset:128
    ds_read_b128 v[120:123], v67 offset:352
    ds_read_b128 v[124:127], v67 offset:864
    ds_read_b128 v[128:131], v67 offset:1376
    ds_read_b128 v[132:135], v67 offset:1888
    ds_read_b128 v[136:139], v67 offset:2400
    ds_read_b128 v[140:143], v67 offset:2912
    ds_read_b128 v[144:147], v67 offset:3424
    ds_read_b128 v[148:151], v67 offset:3936
    ds_read_b128 v[112:115], v66 offset:640
    ds_read_b128 v[116:119], v66 offset:1152
    s_waitcnt lgkmcnt(2)
    v_mfma_f32_16x16x32_bf16 v[104:107], v[108:111], v[148:151], 0
    v_mfma_f32_16x16x32_bf16 v[100:103], v[108:111], v[144:147], 0
    v_mfma_f32_16x16x32_bf16 v[96:99], v[108:111], v[140:143], 0
    v_mfma_f32_16x16x32_bf16 v[92:95], v[108:111], v[136:139], 0
    v_mfma_f32_16x16x32_bf16 v[88:91], v[108:111], v[132:135], 0
    v_mfma_f32_16x16x32_bf16 v[84:87], v[108:111], v[128:131], 0
    v_mfma_f32_16x16x32_bf16 v[80:83], v[108:111], v[124:127], 0
    v_mfma_f32_16x16x32_bf16 v[76:79], v[108:111], v[120:123], 0
    ds_read_b128 v[108:111], v66 offset:1664
    s_waitcnt lgkmcnt(2)
    v_mfma_f32_16x16x32_bf16 v[104:107], v[112:115], v[144:147], v[104:107]
    v_mfma_f32_16x16x32_bf16 v[100:103], v[112:115], v[140:143], v[100:103]
    v_mfma_f32_16x16x32_bf16 v[96:99], v[112:115], v[136:139], v[96:99]
    v_mfma_f32_16x16x32_bf16 v[92:95], v[112:115], v[132:135], v[92:95]
    v_mfma_f32_16x16x32_bf16 v[88:91], v[112:115], v[128:131], v[88:91]
    v_mfma_f32_16x16x32_bf16 v[84:87], v[112:115], v[124:127], v[84:87]
    v_mfma_f32_16x16x32_bf16 v[80:83], v[112:115], v[120:123], v[80:83]
    ds_read_b128 v[112:115], v66 offset:2176
    ds_read_b128 v[152:155], v67 offset:288
    ds_read_b128 v[156:159], v67 offset:800
    ds_read_b128 v[160:163], v67 offset:1312
    ds_read_b128 v[164:167], v67 offset:1824
    ds_read_b128 v[168:171], v67 offset:2336
    ds_read_b128 v[172:175], v67 offset:2848
    ds_read_b128 v[176:179], v67 offset:3360
    ds_read_b128 v[180:183], v67 offset:3872
    s_waitcnt lgkmcnt(10)
    v_mfma_f32_16x16x32_bf16 v[104:107], v[116:119], v[140:143], v[104:107]
    v_mfma_f32_16x16x32_bf16 v[100:103], v[116:119], v[136:139], v[100:103]
    v_mfma_f32_16x16x32_bf16 v[96:99], v[116:119], v[132:135], v[96:99]
    v_mfma_f32_16x16x32_bf16 v[92:95], v[116:119], v[128:131], v[92:95]
    v_mfma_f32_16x16x32_bf16 v[88:91], v[116:119], v[124:127], v[88:91]
    v_mfma_f32_16x16x32_bf16 v[84:87], v[116:119], v[120:123], v[84:87]
    ds_read_b128 v[116:119], v66 offset:2688
    s_waitcnt lgkmcnt(10)
    v_mfma_f32_16x16x32_bf16 v[104:107], v[108:111], v[136:139], v[104:107]
    v_mfma_f32_16x16x32_bf16 v[100:103], v[108:111], v[132:135], v[100:103]
    v_mfma_f32_16x16x32_bf16 v[96:99], v[108:111], v[128:131], v[96:99]
    v_mfma_f32_16x16x32_bf16 v[92:95], v[108:111], v[124:127], v[92:95]
    v_mfma_f32_16x16x32_bf16 v[88:91], v[108:111], v[120:123], v[88:91]
    ds_read_b128 v[108:111], v66 offset:3200
    s_waitcnt lgkmcnt(10)
    v_mfma_f32_16x16x32_bf16 v[104:107], v[112:115], v[132:135], v[104:107]
    v_mfma_f32_16x16x32_bf16 v[100:103], v[112:115], v[128:131], v[100:103]
    v_mfma_f32_16x16x32_bf16 v[96:99], v[112:115], v[124:127], v[96:99]
    v_mfma_f32_16x16x32_bf16 v[92:95], v[112:115], v[120:123], v[92:95]
    ds_read_b128 v[112:115], v66 offset:3712
    s_waitcnt lgkmcnt(2)
    v_mfma_f32_16x16x32_bf16 v[104:107], v[116:119], v[128:131], v[104:107]
    v_mfma_f32_16x16x32_bf16 v[100:103], v[116:119], v[124:127], v[100:103]
    v_mfma_f32_16x16x32_bf16 v[96:99], v[116:119], v[120:123], v[96:99]
    ds_read_b128 v[116:119], v66 offset:192
    s_waitcnt lgkmcnt(2)
    v_mfma_f32_16x16x32_bf16 v[104:107], v[108:111], v[124:127], v[104:107]
    v_mfma_f32_16x16x32_bf16 v[100:103], v[108:111], v[120:123], v[100:103]
    ds_read_b128 v[108:111], v66 offset:704
    s_waitcnt lgkmcnt(2)
    v_mfma_f32_16x16x32_bf16 v[104:107], v[112:115], v[120:123], v[104:107]
    ds_read_b128 v[112:115], v66 offset:1216
    s_waitcnt lgkmcnt(2)
    v_mfma_f32_16x16x32_bf16 v[104:107], v[116:119], v[180:183], v[104:107]
    v_mfma_f32_16x16x32_bf16 v[100:103], v[116:119], v[176:179], v[100:103]
    v_mfma_f32_16x16x32_bf16 v[96:99], v[116:119], v[172:175], v[96:99]
    v_mfma_f32_16x16x32_bf16 v[92:95], v[116:119], v[168:171], v[92:95]
    v_mfma_f32_16x16x32_bf16 v[88:91], v[116:119], v[164:167], v[88:91]
    v_mfma_f32_16x16x32_bf16 v[84:87], v[116:119], v[160:163], v[84:87]
    v_mfma_f32_16x16x32_bf16 v[80:83], v[116:119], v[156:159], v[80:83]
    v_mfma_f32_16x16x32_bf16 v[76:79], v[116:119], v[152:155], v[76:79]
    ds_read_b128 v[116:119], v66 offset:1728
    s_waitcnt lgkmcnt(2)
    v_mfma_f32_16x16x32_bf16 v[104:107], v[108:111], v[176:179], v[104:107]
    v_mfma_f32_16x16x32_bf16 v[100:103], v[108:111], v[172:175], v[100:103]
    v_mfma_f32_16x16x32_bf16 v[96:99], v[108:111], v[168:171], v[96:99]
    v_mfma_f32_16x16x32_bf16 v[92:95], v[108:111], v[164:167], v[92:95]
    v_mfma_f32_16x16x32_bf16 v[88:91], v[108:111], v[160:163], v[88:91]
    v_mfma_f32_16x16x32_bf16 v[84:87], v[108:111], v[156:159], v[84:87]
    v_mfma_f32_16x16x32_bf16 v[80:83], v[108:111], v[152:155], v[80:83]
    ds_read_b128 v[108:111], v66 offset:2240
    s_waitcnt lgkmcnt(2)
    v_mfma_f32_16x16x32_bf16 v[104:107], v[112:115], v[172:175], v[104:107]
    v_mfma_f32_16x16x32_bf16 v[100:103], v[112:115], v[168:171], v[100:103]
    v_mfma_f32_16x16x32_bf16 v[96:99], v[112:115], v[164:167], v[96:99]
    v_mfma_f32_16x16x32_bf16 v[92:95], v[112:115], v[160:163], v[92:95]
    v_mfma_f32_16x16x32_bf16 v[88:91], v[112:115], v[156:159], v[88:91]
    v_mfma_f32_16x16x32_bf16 v[84:87], v[112:115], v[152:155], v[84:87]
    ds_read_b128 v[112:115], v66 offset:2752
    s_waitcnt lgkmcnt(2)
    v_mfma_f32_16x16x32_bf16 v[104:107], v[116:119], v[168:171], v[104:107]
    v_mfma_f32_16x16x32_bf16 v[100:103], v[116:119], v[164:167], v[100:103]
    v_mfma_f32_16x16x32_bf16 v[96:99], v[116:119], v[160:163], v[96:99]
    v_mfma_f32_16x16x32_bf16 v[92:95], v[116:119], v[156:159], v[92:95]
    v_mfma_f32_16x16x32_bf16 v[88:91], v[116:119], v[152:155], v[88:91]
    ds_read_b128 v[116:119], v66 offset:3264
    s_waitcnt lgkmcnt(2)
    v_mfma_f32_16x16x32_bf16 v[104:107], v[108:111], v[164:167], v[104:107]
    v_mfma_f32_16x16x32_bf16 v[100:103], v[108:111], v[160:163], v[100:103]
    v_mfma_f32_16x16x32_bf16 v[96:99], v[108:111], v[156:159], v[96:99]
    v_mfma_f32_16x16x32_bf16 v[92:95], v[108:111], v[152:155], v[92:95]
    ds_read_b128 v[108:111], v66 offset:3776
    s_waitcnt lgkmcnt(2)
    v_mfma_f32_16x16x32_bf16 v[104:107], v[112:115], v[160:163], v[104:107]
    v_mfma_f32_16x16x32_bf16 v[100:103], v[112:115], v[156:159], v[100:103]
    v_mfma_f32_16x16x32_bf16 v[96:99], v[112:115], v[152:155], v[96:99]
    s_waitcnt lgkmcnt(1)
    v_mfma_f32_16x16x32_bf16 v[104:107], v[116:119], v[156:159], v[104:107]
    v_mfma_f32_16x16x32_bf16 v[100:103], v[116:119], v[152:155], v[100:103]
    s_waitcnt lgkmcnt(0)
    v_mfma_f32_16x16x32_bf16 v[104:107], v[108:111], v[152:155], v[104:107]
    ds_write_b128 v74, v[76:79] offset:0
    ds_write_b128 v74, v[80:83] offset:1024
    ds_write_b128 v74, v[84:87] offset:2048
    ds_write_b128 v74, v[88:91] offset:3072
    ds_write_b128 v74, v[92:95] offset:4096
    ds_write_b128 v74, v[96:99] offset:5120
    ds_write_b128 v74, v[100:103] offset:6144
    s_nop 0
    ds_write_b128 v74, v[104:107] offset:7168
    s_branch c_pw_end_29
c_pw_31:
    s_cmp_lg_u32 s34, 2
    s_cbranch_scc1 c_pw_32
    ds_read_b128 v[108:111], v66 offset:256
    ds_read_b128 v[120:123], v67 offset:224
    ds_read_b128 v[124:127], v67 offset:736
    ds_read_b128 v[128:131], v67 offset:1248
    ds_read_b128 v[132:135], v67 offset:1760
    ds_read_b128 v[136:139], v67 offset:2272
    ds_read_b128 v[140:143], v67 offset:2784
    ds_read_b128 v[144:147], v67 offset:3296
    ds_read_b128 v[148:151], v67 offset:3808
    ds_read_b128 v[112:115], v66 offset:768
    ds_read_b128 v[116:119], v66 offset:1280
    s_waitcnt lgkmcnt(2)
    v_mfma_f32_16x16x32_bf16 v[104:107], v[108:111], v[148:151], 0
    v_mfma_f32_16x16x32_bf16 v[100:103], v[108:111], v[144:147], 0
    v_mfma_f32_16x16x32_bf16 v[96:99], v[108:111], v[140:143], 0
    v_mfma_f32_16x16x32_bf16 v[92:95], v[108:111], v[136:139], 0
    v_mfma_f32_16x16x32_bf16 v[88:91], v[108:111], v[132:135], 0
    v_mfma_f32_16x16x32_bf16 v[84:87], v[108:111], v[128:131], 0
    v_mfma_f32_16x16x32_bf16 v[80:83], v[108:111], v[124:127], 0
    v_mfma_f32_16x16x32_bf16 v[76:79], v[108:111], v[120:123], 0
    ds_read_b128 v[108:111], v66 offset:1792
    s_waitcnt lgkmcnt(2)
    v_mfma_f32_16x16x32_bf16 v[104:107], v[112:115], v[144:147], v[104:107]
    v_mfma_f32_16x16x32_bf16 v[100:103], v[112:115], v[140:143], v[100:103]
    v_mfma_f32_16x16x32_bf16 v[96:99], v[112:115], v[136:139], v[96:99]
    v_mfma_f32_16x16x32_bf16 v[92:95], v[112:115], v[132:135], v[92:95]
    v_mfma_f32_16x16x32_bf16 v[88:91], v[112:115], v[128:131], v[88:91]
    v_mfma_f32_16x16x32_bf16 v[84:87], v[112:115], v[124:127], v[84:87]
    v_mfma_f32_16x16x32_bf16 v[80:83], v[112:115], v[120:123], v[80:83]
    ds_read_b128 v[112:115], v66 offset:2304
    ds_read_b128 v[152:155], v67 offset:160
    ds_read_b128 v[156:159], v67 offset:672
    ds_read_b128 v[160:163], v67 offset:1184
    ds_read_b128 v[164:167], v67 offset:1696
    ds_read_b128 v[168:171], v67 offset:2208
    ds_read_b128 v[172:175], v67 offset:2720
    ds_read_b128 v[176:179], v67 offset:3232
    ds_read_b128 v[180:183], v67 offset:3744
    s_waitcnt lgkmcnt(10)
    v_mfma_f32_16x16x32_bf16 v[104:107], v[116:119], v[140:143], v[104:107]
    v_mfma_f32_16x16x32_bf16 v[100:103], v[116:119], v[136:139], v[100:103]
    v_mfma_f32_16x16x32_bf16 v[96:99], v[116:119], v[132:135], v[96:99]
    v_mfma_f32_16x16x32_bf16 v[92:95], v[116:119], v[128:131], v[92:95]
    v_mfma_f32_16x16x32_bf16 v[88:91], v[116:119], v[124:127], v[88:91]
    v_mfma_f32_16x16x32_bf16 v[84:87], v[116:119], v[120:123], v[84:87]
    ds_read_b128 v[116:119], v66 offset:2816
    s_waitcnt lgkmcnt(10)
    v_mfma_f32_16x16x32_bf16 v[104:107], v[108:111], v[136:139], v[104:107]
    v_mfma_f32_16x16x32_bf16 v[100:103], v[108:111], v[132:135], v[100:103]
    v_mfma_f32_16x16x32_bf16 v[96:99], v[108:111], v[128:131], v[96:99]
    v_mfma_f32_16x16x32_bf16 v[92:95], v[108:111], v[124:127], v[92:95]
    v_mfma_f32_16x16x32_bf16 v[88:91], v[108:111], v[120:123], v[88:91]
    ds_read_b128 v[108:111], v66 offset:3328
    s_waitcnt lgkmcnt(10)
    v_mfma_f32_16x16x32_bf16 v[104:107], v[112:115], v[132:135], v[104:107]
    v_mfma_f32_16x16x32_bf16 v[100:103], v[112:115], v[128:131], v[100:103]
    v_mfma_f32_16x16x32_bf16 v[96:99], v[112:115], v[124:127], v[96:99]
    v_mfma_f32_16x16x32_bf16 v[92:95], v[112:115], v[120:123], v[92:95]
    ds_read_b128 v[112:115], v66 offset:3840
    s_waitcnt lgkmcnt(2)
    v_mfma_f32_16x16x32_bf16 v[104:107], v[116:119], v[128:131], v[104:107]
    v_mfma_f32_16x16x32_bf16 v[100:103], v[116:119], v[124:127], v[100:103]
    v_mfma_f32_16x16x32_bf16 v[96:99], v[116:119], v[120:123], v[96:99]
    ds_read_b128 v[116:119], v66 offset:320
    s_waitcnt lgkmcnt(2)
    v_mfma_f32_16x16x32_bf16 v[104:107], v[108:111], v[124:127], v[104:107]
    v_mfma_f32_16x16x32_bf16 v[100:103], v[108:111], v[120:123], v[100:103]
    ds_read_b128 v[108:111], v66 offset:832
    s_waitcnt lgkmcnt(2)
    v_mfma_f32_16x16x32_bf16 v[104:107], v[112:115], v[120:123], v[104:107]
    ds_read_b128 v[112:115], v66 offset:1344
    s_waitcnt lgkmcnt(2)
    v_mfma_f32_16x16x32_bf16 v[104:107], v[116:119], v[180:183], v[104:107]
    v_mfma_f32_16x16x32_bf16 v[100:103], v[116:119], v[176:179], v[100:103]
    v_mfma_f32_16x16x32_bf16 v[96:99], v[116:119], v[172:175], v[96:99]
    v_mfma_f32_16x16x32_bf16 v[92:95], v[116:119], v[168:171], v[92:95]
    v_mfma_f32_16x16x32_bf16 v[88:91], v[116:119], v[164:167], v[88:91]
    v_mfma_f32_16x16x32_bf16 v[84:87], v[116:119], v[160:163], v[84:87]
    v_mfma_f32_16x16x32_bf16 v[80:83], v[116:119], v[156:159], v[80:83]
    v_mfma_f32_16x16x32_bf16 v[76:79], v[116:119], v[152:155], v[76:79]
    ds_read_b128 v[116:119], v66 offset:1856
    s_waitcnt lgkmcnt(2)
    v_mfma_f32_16x16x32_bf16 v[104:107], v[108:111], v[176:179], v[104:107]
    v_mfma_f32_16x16x32_bf16 v[100:103], v[108:111], v[172:175], v[100:103]
    v_mfma_f32_16x16x32_bf16 v[96:99], v[108:111], v[168:171], v[96:99]
    v_mfma_f32_16x16x32_bf16 v[92:95], v[108:111], v[164:167], v[92:95]
    v_mfma_f32_16x16x32_bf16 v[88:91], v[108:111], v[160:163], v[88:91]
    v_mfma_f32_16x16x32_bf16 v[84:87], v[108:111], v[156:159], v[84:87]
    v_mfma_f32_16x16x32_bf16 v[80:83], v[108:111], v[152:155], v[80:83]
    ds_read_b128 v[108:111], v66 offset:2368
    s_waitcnt lgkmcnt(2)
    v_mfma_f32_16x16x32_bf16 v[104:107], v[112:115], v[172:175], v[104:107]
    v_mfma_f32_16x16x32_bf16 v[100:103], v[112:115], v[168:171], v[100:103]
    v_mfma_f32_16x16x32_bf16 v[96:99], v[112:115], v[164:167], v[96:99]
    v_mfma_f32_16x16x32_bf16 v[92:95], v[112:115], v[160:163], v[92:95]
    v_mfma_f32_16x16x32_bf16 v[88:91], v[112:115], v[156:159], v[88:91]
    v_mfma_f32_16x16x32_bf16 v[84:87], v[112:115], v[152:155], v[84:87]
    ds_read_b128 v[112:115], v66 offset:2880
    s_waitcnt lgkmcnt(2)
    v_mfma_f32_16x16x32_bf16 v[104:107], v[116:119], v[168:171], v[104:107]
    v_mfma_f32_16x16x32_bf16 v[100:103], v[116:119], v[164:167], v[100:103]
    v_mfma_f32_16x16x32_bf16 v[96:99], v[116:119], v[160:163], v[96:99]
    v_mfma_f32_16x16x32_bf16 v[92:95], v[116:119], v[156:159], v[92:95]
    v_mfma_f32_16x16x32_bf16 v[88:91], v[116:119], v[152:155], v[88:91]
    ds_read_b128 v[116:119], v66 offset:3392
    s_waitcnt lgkmcnt(2)
    v_mfma_f32_16x16x32_bf16 v[104:107], v[108:111], v[164:167], v[104:107]
    v_mfma_f32_16x16x32_bf16 v[100:103], v[108:111], v[160:163], v[100:103]
    v_mfma_f32_16x16x32_bf16 v[96:99], v[108:111], v[156:159], v[96:99]
    v_mfma_f32_16x16x32_bf16 v[92:95], v[108:111], v[152:155], v[92:95]
    ds_read_b128 v[108:111], v66 offset:3904
    s_waitcnt lgkmcnt(2)
    v_mfma_f32_16x16x32_bf16 v[104:107], v[112:115], v[160:163], v[104:107]
    v_mfma_f32_16x16x32_bf16 v[100:103], v[112:115], v[156:159], v[100:103]
    v_mfma_f32_16x16x32_bf16 v[96:99], v[112:115], v[152:155], v[96:99]
    s_waitcnt lgkmcnt(1)
    v_mfma_f32_16x16x32_bf16 v[104:107], v[116:119], v[156:159], v[104:107]
    v_mfma_f32_16x16x32_bf16 v[100:103], v[116:119], v[152:155], v[100:103]
    s_waitcnt lgkmcnt(0)
    v_mfma_f32_16x16x32_bf16 v[104:107], v[108:111], v[152:155], v[104:107]
    ds_write_b128 v74, v[76:79] offset:0
    ds_write_b128 v74, v[80:83] offset:1024
    ds_write_b128 v74, v[84:87] offset:2048
    ds_write_b128 v74, v[88:91] offset:3072
    ds_write_b128 v74, v[92:95] offset:4096
    ds_write_b128 v74, v[96:99] offset:5120
    ds_write_b128 v74, v[100:103] offset:6144
    s_nop 0
    ds_write_b128 v74, v[104:107] offset:7168
    s_branch c_pw_end_29
c_pw_32:
    ds_read_b128 v[108:111], v66 offset:384
    ds_read_b128 v[120:123], v67 offset:96
    ds_read_b128 v[124:127], v67 offset:608
    ds_read_b128 v[128:131], v67 offset:1120
    ds_read_b128 v[132:135], v67 offset:1632
    ds_read_b128 v[136:139], v67 offset:2144
    ds_read_b128 v[140:143], v67 offset:2656
    ds_read_b128 v[144:147], v67 offset:3168
    ds_read_b128 v[148:151], v67 offset:3680
    ds_read_b128 v[112:115], v66 offset:896
    ds_read_b128 v[116:119], v66 offset:1408
    s_waitcnt lgkmcnt(2)
    v_mfma_f32_16x16x32_bf16 v[104:107], v[108:111], v[148:151], 0
    v_mfma_f32_16x16x32_bf16 v[100:103], v[108:111], v[144:147], 0
    v_mfma_f32_16x16x32_bf16 v[96:99], v[108:111], v[140:143], 0
    v_mfma_f32_16x16x32_bf16 v[92:95], v[108:111], v[136:139], 0
    v_mfma_f32_16x16x32_bf16 v[88:91], v[108:111], v[132:135], 0
    v_mfma_f32_16x16x32_bf16 v[84:87], v[108:111], v[128:131], 0
    v_mfma_f32_16x16x32_bf16 v[80:83], v[108:111], v[124:127], 0
    v_mfma_f32_16x16x32_bf16 v[76:79], v[108:111], v[120:123], 0
    ds_read_b128 v[108:111], v66 offset:1920
    s_waitcnt lgkmcnt(2)
    v_mfma_f32_16x16x32_bf16 v[104:107], v[112:115], v[144:147], v[104:107]
    v_mfma_f32_16x16x32_bf16 v[100:103], v[112:115], v[140:143], v[100:103]
    v_mfma_f32_16x16x32_bf16 v[96:99], v[112:115], v[136:139], v[96:99]
    v_mfma_f32_16x16x32_bf16 v[92:95], v[112:115], v[132:135], v[92:95]
    v_mfma_f32_16x16x32_bf16 v[88:91], v[112:115], v[128:131], v[88:91]
    v_mfma_f32_16x16x32_bf16 v[84:87], v[112:115], v[124:127], v[84:87]
    v_mfma_f32_16x16x32_bf16 v[80:83], v[112:115], v[120:123], v[80:83]
    ds_read_b128 v[112:115], v66 offset:2432
    ds_read_b128 v[152:155], v67 offset:32
    ds_read_b128 v[156:159], v67 offset:544
    ds_read_b128 v[160:163], v67 offset:1056
    ds_read_b128 v[164:167], v67 offset:1568
    ds_read_b128 v[168:171], v67 offset:2080
    ds_read_b128 v[172:175], v67 offset:2592
    ds_read_b128 v[176:179], v67 offset:3104
    ds_read_b128 v[180:183], v67 offset:3616
    s_waitcnt lgkmcnt(10)
    v_mfma_f32_16x16x32_bf16 v[104:107], v[116:119], v[140:143], v[104:107]
    v_mfma_f32_16x16x32_bf16 v[100:103], v[116:119], v[136:139], v[100:103]
    v_mfma_f32_16x16x32_bf16 v[96:99], v[116:119], v[132:135], v[96:99]
    v_mfma_f32_16x16x32_bf16 v[92:95], v[116:119], v[128:131], v[92:95]
    v_mfma_f32_16x16x32_bf16 v[88:91], v[116:119], v[124:127], v[88:91]
    v_mfma_f32_16x16x32_bf16 v[84:87], v[116:119], v[120:123], v[84:87]
    ds_read_b128 v[116:119], v66 offset:2944
    s_waitcnt lgkmcnt(10)
    v_mfma_f32_16x16x32_bf16 v[104:107], v[108:111], v[136:139], v[104:107]
    v_mfma_f32_16x16x32_bf16 v[100:103], v[108:111], v[132:135], v[100:103]
    v_mfma_f32_16x16x32_bf16 v[96:99], v[108:111], v[128:131], v[96:99]
    v_mfma_f32_16x16x32_bf16 v[92:95], v[108:111], v[124:127], v[92:95]
    v_mfma_f32_16x16x32_bf16 v[88:91], v[108:111], v[120:123], v[88:91]
    ds_read_b128 v[108:111], v66 offset:3456
    s_waitcnt lgkmcnt(10)
    v_mfma_f32_16x16x32_bf16 v[104:107], v[112:115], v[132:135], v[104:107]
    v_mfma_f32_16x16x32_bf16 v[100:103], v[112:115], v[128:131], v[100:103]
    v_mfma_f32_16x16x32_bf16 v[96:99], v[112:115], v[124:127], v[96:99]
    v_mfma_f32_16x16x32_bf16 v[92:95], v[112:115], v[120:123], v[92:95]
    ds_read_b128 v[112:115], v66 offset:3968
    s_waitcnt lgkmcnt(2)
    v_mfma_f32_16x16x32_bf16 v[104:107], v[116:119], v[128:131], v[104:107]
    v_mfma_f32_16x16x32_bf16 v[100:103], v[116:119], v[124:127], v[100:103]
    v_mfma_f32_16x16x32_bf16 v[96:99], v[116:119], v[120:123], v[96:99]
    ds_read_b128 v[116:119], v66 offset:448
    s_waitcnt lgkmcnt(2)
    v_mfma_f32_16x16x32_bf16 v[104:107], v[108:111], v[124:127], v[104:107]
    v_mfma_f32_16x16x32_bf16 v[100:103], v[108:111], v[120:123], v[100:103]
    ds_read_b128 v[108:111], v66 offset:960
    s_waitcnt lgkmcnt(2)
    v_mfma_f32_16x16x32_bf16 v[104:107], v[112:115], v[120:123], v[104:107]
    ds_read_b128 v[112:115], v66 offset:1472
    s_waitcnt lgkmcnt(2)
    v_mfma_f32_16x16x32_bf16 v[104:107], v[116:119], v[180:183], v[104:107]
    v_mfma_f32_16x16x32_bf16 v[100:103], v[116:119], v[176:179], v[100:103]
    v_mfma_f32_16x16x32_bf16 v[96:99], v[116:119], v[172:175], v[96:99]
    v_mfma_f32_16x16x32_bf16 v[92:95], v[116:119], v[168:171], v[92:95]
    v_mfma_f32_16x16x32_bf16 v[88:91], v[116:119], v[164:167], v[88:91]
    v_mfma_f32_16x16x32_bf16 v[84:87], v[116:119], v[160:163], v[84:87]
    v_mfma_f32_16x16x32_bf16 v[80:83], v[116:119], v[156:159], v[80:83]
    v_mfma_f32_16x16x32_bf16 v[76:79], v[116:119], v[152:155], v[76:79]
    ds_read_b128 v[116:119], v66 offset:1984
    s_waitcnt lgkmcnt(2)
    v_mfma_f32_16x16x32_bf16 v[104:107], v[108:111], v[176:179], v[104:107]
    v_mfma_f32_16x16x32_bf16 v[100:103], v[108:111], v[172:175], v[100:103]
    v_mfma_f32_16x16x32_bf16 v[96:99], v[108:111], v[168:171], v[96:99]
    v_mfma_f32_16x16x32_bf16 v[92:95], v[108:111], v[164:167], v[92:95]
    v_mfma_f32_16x16x32_bf16 v[88:91], v[108:111], v[160:163], v[88:91]
    v_mfma_f32_16x16x32_bf16 v[84:87], v[108:111], v[156:159], v[84:87]
    v_mfma_f32_16x16x32_bf16 v[80:83], v[108:111], v[152:155], v[80:83]
    ds_read_b128 v[108:111], v66 offset:2496
    s_waitcnt lgkmcnt(2)
    v_mfma_f32_16x16x32_bf16 v[104:107], v[112:115], v[172:175], v[104:107]
    v_mfma_f32_16x16x32_bf16 v[100:103], v[112:115], v[168:171], v[100:103]
    v_mfma_f32_16x16x32_bf16 v[96:99], v[112:115], v[164:167], v[96:99]
    v_mfma_f32_16x16x32_bf16 v[92:95], v[112:115], v[160:163], v[92:95]
    v_mfma_f32_16x16x32_bf16 v[88:91], v[112:115], v[156:159], v[88:91]
    v_mfma_f32_16x16x32_bf16 v[84:87], v[112:115], v[152:155], v[84:87]
    ds_read_b128 v[112:115], v66 offset:3008
    s_waitcnt lgkmcnt(2)
    v_mfma_f32_16x16x32_bf16 v[104:107], v[116:119], v[168:171], v[104:107]
    v_mfma_f32_16x16x32_bf16 v[100:103], v[116:119], v[164:167], v[100:103]
    v_mfma_f32_16x16x32_bf16 v[96:99], v[116:119], v[160:163], v[96:99]
    v_mfma_f32_16x16x32_bf16 v[92:95], v[116:119], v[156:159], v[92:95]
    v_mfma_f32_16x16x32_bf16 v[88:91], v[116:119], v[152:155], v[88:91]
    ds_read_b128 v[116:119], v66 offset:3520
    s_waitcnt lgkmcnt(2)
    v_mfma_f32_16x16x32_bf16 v[104:107], v[108:111], v[164:167], v[104:107]
    v_mfma_f32_16x16x32_bf16 v[100:103], v[108:111], v[160:163], v[100:103]
    v_mfma_f32_16x16x32_bf16 v[96:99], v[108:111], v[156:159], v[96:99]
    v_mfma_f32_16x16x32_bf16 v[92:95], v[108:111], v[152:155], v[92:95]
    ds_read_b128 v[108:111], v66 offset:4032
    s_waitcnt lgkmcnt(2)
    v_mfma_f32_16x16x32_bf16 v[104:107], v[112:115], v[160:163], v[104:107]
    v_mfma_f32_16x16x32_bf16 v[100:103], v[112:115], v[156:159], v[100:103]
    v_mfma_f32_16x16x32_bf16 v[96:99], v[112:115], v[152:155], v[96:99]
    s_waitcnt lgkmcnt(1)
    v_mfma_f32_16x16x32_bf16 v[104:107], v[116:119], v[156:159], v[104:107]
    v_mfma_f32_16x16x32_bf16 v[100:103], v[116:119], v[152:155], v[100:103]
    s_waitcnt lgkmcnt(0)
    v_mfma_f32_16x16x32_bf16 v[104:107], v[108:111], v[152:155], v[104:107]
    ds_write_b128 v74, v[76:79] offset:0
    ds_write_b128 v74, v[80:83] offset:1024
    ds_write_b128 v74, v[84:87] offset:2048
    ds_write_b128 v74, v[88:91] offset:3072
    ds_write_b128 v74, v[92:95] offset:4096
    ds_write_b128 v74, v[96:99] offset:5120
    ds_write_b128 v74, v[100:103] offset:6144
    s_nop 0
    ds_write_b128 v74, v[104:107] offset:7168
c_pw_end_29:
    s_waitcnt lgkmcnt(0)
    v_mov_b32 v3, 161796
    v_mov_b32 v4, 1
    s_mov_b64 exec, 1
    ds_add_u32 v3, v4
    s_mov_b64 exec, -1
    s_mov_b32 s67, 0
gsync_34:
    ds_read_b32 v4, v3
    s_add_u32 s67, s67, 1
    s_waitcnt lgkmcnt(0)
    v_readfirstlane_b32 s66, v4
    s_cmp_gt_u32 s67, 1000000
    s_cbranch_scc1 gsync_e_35
    s_cmp_lt_u32 s66, 8
    s_cbranch_scc1 gsync_34
gsync_e_35:
    ds_read_b128 v[120:123], v75 offset:0
    ds_read_b128 v[124:127], v75 offset:16
    ds_read_b128 v[128:131], v75 offset:8192
    ds_read_b128 v[132:135], v75 offset:8208
    ds_read_b128 v[136:139], v75 offset:16384
    ds_read_b128 v[140:143], v75 offset:16400
    ds_read_b128 v[144:147], v75 offset:24576
    ds_read_b128 v[148:151], v75 offset:24592
    s_lshl_b32 s40, s56, 12
    s_add_u32 s40, s40, 8912896
    s_waitcnt lgkmcnt(0)
    v_pk_add_f32 v[120:121], v[120:121], v[128:129]
    v_pk_add_f32 v[136:137], v[136:137], v[144:145]
    v_pk_add_f32 v[122:123], v[122:123], v[130:131]
    v_pk_add_f32 v[138:139], v[138:139], v[146:147]
    v_pk_add_f32 v[124:125], v[124:125], v[132:133]
    v_pk_add_f32 v[140:141], v[140:141], v[148:149]
    v_pk_add_f32 v[126:127], v[126:127], v[134:135]
    v_pk_add_f32 v[142:143], v[142:143], v[150:151]
    v_pk_add_f32 v[120:121], v[120:121], v[136:137]
    v_pk_add_f32 v[122:123], v[122:123], v[138:139]
    v_pk_add_f32 v[124:125], v[124:125], v[140:141]
    v_pk_add_f32 v[126:127], v[126:127], v[142:143]
    v_cvt_pk_bf16_f32 v192, v120, v121
    v_cvt_pk_bf16_f32 v193, v122, v123
    v_cvt_pk_bf16_f32 v194, v124, v125
    v_cvt_pk_bf16_f32 v195, v126, v127
    buffer_store_dwordx4 v[192:195], v2, s[8:11], s40 offen sc1
    s_nop 1
    s_waitcnt vmcnt(1)
    v_cmp_ne_u32 vcc, 0, v0
    s_nop 1
    v_cndmask_b32 v16, 0, v16, vcc
    v_cndmask_b32 v17, 0, v17, vcc
    v_cndmask_b32 v18, 0, v18, vcc
    v_cndmask_b32 v19, 0, v19, vcc
    v_alignbit_b32 v184, v17, v16, 16
    v_alignbit_b32 v185, v18, v17, 16
    v_alignbit_b32 v186, v19, v18, 16
    v_alignbit_b32 v187, v20, v19, 16
    v_alignbit_b32 v188, v21, v20, 16
    v_alignbit_b32 v189, v22, v21, 16
    v_alignbit_b32 v190, v23, v22, 16
    ds_write_b128 v64, v[184:187] offset:0
    v_mov_b32 v192, v17
    v_mov_b32 v193, v18
    v_mov_b32 v194, v19
    v_mov_b32 v195, v20
    ds_write_b128 v64, v[192:195] offset:4160
    s_nop 1
    v_mov_b32 v192, v185
    v_mov_b32 v193, v186
    v_mov_b32 v194, v187
    v_mov_b32 v195, v188
    ds_write_b128 v64, v[192:195] offset:8320
    s_nop 1
    ds_write_b128 v64, v[18:21] offset:12480
    ds_write_b128 v64, v[186:189] offset:16640
    v_mov_b32 v192, v19
    v_mov_b32 v193, v20
    v_mov_b32 v194, v21
    v_mov_b32 v195, v22
    ds_write_b128 v64, v[192:195] offset:20800
    s_nop 1
    v_mov_b32 v192, v187
    v_mov_b32 v193, v188
    v_mov_b32 v194, v189
    v_mov_b32 v195, v190
    ds_write_b128 v64, v[192:195] offset:24960
    s_nop 1
    ds_write_b128 v64, v[20:23] offset:29120
    ds_write_b128 v65, v[36:39]
    v_lshlrev_b32 v3, 16, v45
    v_or_b32 v3, v3, v45
    v_and_b32 v196, v68, v3
    v_and_b32 v197, v69, v3
    v_and_b32 v198, v70, v3
    v_and_b32 v199, v71, v3
    s_waitcnt lgkmcnt(0)
    v_mov_b32 v3, 161796
    v_mov_b32 v4, 1
    s_mov_b64 exec, 1
    ds_add_u32 v3, v4
    s_mov_b64 exec, -1
    s_mov_b32 s67, 0
gsync_36:
    ds_read_b32 v4, v3
    s_add_u32 s67, s67, 1
    s_waitcnt lgkmcnt(0)
    v_readfirstlane_b32 s66, v4
    s_cmp_gt_u32 s67, 1000000
    s_cbranch_scc1 gsync_e_37
    s_cmp_lt_u32 s66, 12
    s_cbranch_scc1 gsync_36
gsync_e_37:
    s_cmp_ge_u32 s2, 192
    s_cbranch_scc1 c_wj3_38
    v_lshrrev_b32 v3, 4, v1
    v_and_b32 v5, 15, v1
    v_lshrrev_b32 v4, 2, v5
    v_lshl_add_u32 v3, v3, 2, v4
    v_mul_u32_u24 v3, 160, v3
    v_and_b32 v4, 3, v5
    v_lshl_add_u32 v3, v4, 3, v3
    v_lshlrev_b32 v5, 4, v1
    s_lshl_b32 s40, s34, 5
    s_add_u32 s41, s40, 156672
    v_add_u32 v4, s41, v3
    ds_read_b64_tr_b16 v[192:193], v4
    ds_read_b64_tr_b16 v[194:195], v4 offset:2560
    s_mul_i32 s41, s2, 5120
    s_lshl_b32 s40, s40, 5
    s_add_u32 s41, s41, s40
    s_add_u32 s41, s41, 15007744
    s_waitcnt lgkmcnt(0)
    buffer_store_dwordx4 v[192:195], v5, s[8:11], s41 offen sc1
    s_nop 1
    s_cmp_lg_u32 s34, 0
    s_cbranch_scc1 c_wj4_39
    s_mov_b32 s40, 128
    s_add_u32 s41, s40, 156672
    v_add_u32 v4, s41, v3
    ds_read_b64_tr_b16 v[192:193], v4
    ds_read_b64_tr_b16 v[194:195], v4 offset:2560
    s_mul_i32 s41, s2, 5120
    s_lshl_b32 s40, s40, 5
    s_add_u32 s41, s41, s40
    s_add_u32 s41, s41, 15007744
    s_waitcnt lgkmcnt(0)
    buffer_store_dwordx4 v[192:195], v5, s[8:11], s41 offen sc1
    s_nop 1
c_wj4_39:
c_wj3_38:
    s_cmp_lg_u32 s34, 0
    s_cbranch_scc1 c_pw_41
    ds_read_b128 v[108:111], v66 offset:0
    ds_read_b128 v[120:123], v67 offset:480
    ds_read_b128 v[124:127], v67 offset:992
    ds_read_b128 v[128:131], v67 offset:1504
    ds_read_b128 v[132:135], v67 offset:2016
    ds_read_b128 v[136:139], v67 offset:2528
    ds_read_b128 v[140:143], v67 offset:3040
    ds_read_b128 v[144:147], v67 offset:3552
    ds_read_b128 v[148:151], v67 offset:4064
    ds_read_b128 v[112:115], v66 offset:512
    ds_read_b128 v[116:119], v66 offset:1024
    s_waitcnt lgkmcnt(2)
    v_mfma_f32_16x16x32_bf16 v[104:107], v[108:111], v[148:151], 0
    v_mfma_f32_16x16x32_bf16 v[100:103], v[108:111], v[144:147], 0
    v_mfma_f32_16x16x32_bf16 v[96:99], v[108:111], v[140:143], 0
    v_mfma_f32_16x16x32_bf16 v[92:95], v[108:111], v[136:139], 0
    v_mfma_f32_16x16x32_bf16 v[88:91], v[108:111], v[132:135], 0
    v_mfma_f32_16x16x32_bf16 v[84:87], v[108:111], v[128:131], 0
    v_mfma_f32_16x16x32_bf16 v[80:83], v[108:111], v[124:127], 0
    v_mfma_f32_16x16x32_bf16 v[76:79], v[108:111], v[120:123], 0
    v_mfma_f32_16x16x32_bf16 v[76:79], v[196:199], v[120:123], v[76:79]
    v_mfma_f32_16x16x32_bf16 v[80:83], v[196:199], v[124:127], v[80:83]
    v_mfma_f32_16x16x32_bf16 v[84:87], v[196:199], v[128:131], v[84:87]
    v_mfma_f32_16x16x32_bf16 v[88:91], v[196:199], v[132:135], v[88:91]
    v_mfma_f32_16x16x32_bf16 v[92:95], v[196:199], v[136:139], v[92:95]
    v_mfma_f32_16x16x32_bf16 v[96:99], v[196:199], v[140:143], v[96:99]
    v_mfma_f32_16x16x32_bf16 v[100:103], v[196:199], v[144:147], v[100:103]
    v_mfma_f32_16x16x32_bf16 v[104:107], v[196:199], v[148:151], v[104:107]
    ds_read_b128 v[108:111], v66 offset:1536
    s_waitcnt lgkmcnt(2)
    v_mfma_f32_16x16x32_bf16 v[104:107], v[112:115], v[144:147], v[104:107]
    v_mfma_f32_16x16x32_bf16 v[100:103], v[112:115], v[140:143], v[100:103]
    v_mfma_f32_16x16x32_bf16 v[96:99], v[112:115], v[136:139], v[96:99]
    v_mfma_f32_16x16x32_bf16 v[92:95], v[112:115], v[132:135], v[92:95]
    v_mfma_f32_16x16x32_bf16 v[88:91], v[112:115], v[128:131], v[88:91]
    v_mfma_f32_16x16x32_bf16 v[84:87], v[112:115], v[124:127], v[84:87]
    v_mfma_f32_16x16x32_bf16 v[80:83], v[112:115], v[120:123], v[80:83]
    ds_read_b128 v[112:115], v66 offset:2048
    ds_read_b128 v[152:155], v67 offset:416
    ds_read_b128 v[156:159], v67 offset:928
    ds_read_b128 v[160:163], v67 offset:1440
    ds_read_b128 v[164:167], v67 offset:1952
    ds_read_b128 v[168:171], v67 offset:2464
    ds_read_b128 v[172:175], v67 offset:2976
    ds_read_b128 v[176:179], v67 offset:3488
    ds_read_b128 v[180:183], v67 offset:4000
    s_waitcnt lgkmcnt(10)
    v_mfma_f32_16x16x32_bf16 v[104:107], v[116:119], v[140:143], v[104:107]
    v_mfma_f32_16x16x32_bf16 v[100:103], v[116:119], v[136:139], v[100:103]
    v_mfma_f32_16x16x32_bf16 v[96:99], v[116:119], v[132:135], v[96:99]
    v_mfma_f32_16x16x32_bf16 v[92:95], v[116:119], v[128:131], v[92:95]
    v_mfma_f32_16x16x32_bf16 v[88:91], v[116:119], v[124:127], v[88:91]
    v_mfma_f32_16x16x32_bf16 v[84:87], v[116:119], v[120:123], v[84:87]
    ds_read_b128 v[116:119], v66 offset:2560
    s_waitcnt lgkmcnt(10)
    v_mfma_f32_16x16x32_bf16 v[104:107], v[108:111], v[136:139], v[104:107]
    v_mfma_f32_16x16x32_bf16 v[100:103], v[108:111], v[132:135], v[100:103]
    v_mfma_f32_16x16x32_bf16 v[96:99], v[108:111], v[128:131], v[96:99]
    v_mfma_f32_16x16x32_bf16 v[92:95], v[108:111], v[124:127], v[92:95]
    v_mfma_f32_16x16x32_bf16 v[88:91], v[108:111], v[120:123], v[88:91]
    ds_read_b128 v[108:111], v66 offset:3072
    s_waitcnt lgkmcnt(10)
    v_mfma_f32_16x16x32_bf16 v[104:107], v[112:115], v[132:135], v[104:107]
    v_mfma_f32_16x16x32_bf16 v[100:103], v[112:115], v[128:131], v[100:103]
    v_mfma_f32_16x16x32_bf16 v[96:99], v[112:115], v[124:127], v[96:99]
    v_mfma_f32_16x16x32_bf16 v[92:95], v[112:115], v[120:123], v[92:95]
    ds_read_b128 v[112:115], v66 offset:3584
    s_waitcnt lgkmcnt(2)
    v_mfma_f32_16x16x32_bf16 v[104:107], v[116:119], v[128:131], v[104:107]
    v_mfma_f32_16x16x32_bf16 v[100:103], v[116:119], v[124:127], v[100:103]
    v_mfma_f32_16x16x32_bf16 v[96:99], v[116:119], v[120:123], v[96:99]
    ds_read_b128 v[116:119], v66 offset:64
    s_waitcnt lgkmcnt(2)
    v_mfma_f32_16x16x32_bf16 v[104:107], v[108:111], v[124:127], v[104:107]
    v_mfma_f32_16x16x32_bf16 v[100:103], v[108:111], v[120:123], v[100:103]
    ds_read_b128 v[108:111], v66 offset:576
    s_waitcnt lgkmcnt(2)
    v_mfma_f32_16x16x32_bf16 v[104:107], v[112:115], v[120:123], v[104:107]
    ds_read_b128 v[112:115], v66 offset:1088
    s_waitcnt lgkmcnt(2)
    v_mfma_f32_16x16x32_bf16 v[104:107], v[116:119], v[180:183], v[104:107]
    v_mfma_f32_16x16x32_bf16 v[100:103], v[116:119], v[176:179], v[100:103]
    v_mfma_f32_16x16x32_bf16 v[96:99], v[116:119], v[172:175], v[96:99]
    v_mfma_f32_16x16x32_bf16 v[92:95], v[116:119], v[168:171], v[92:95]
    v_mfma_f32_16x16x32_bf16 v[88:91], v[116:119], v[164:167], v[88:91]
    v_mfma_f32_16x16x32_bf16 v[84:87], v[116:119], v[160:163], v[84:87]
    v_mfma_f32_16x16x32_bf16 v[80:83], v[116:119], v[156:159], v[80:83]
    v_mfma_f32_16x16x32_bf16 v[76:79], v[116:119], v[152:155], v[76:79]
    ds_read_b128 v[116:119], v66 offset:1600
    s_waitcnt lgkmcnt(2)
    v_mfma_f32_16x16x32_bf16 v[104:107], v[108:111], v[176:179], v[104:107]
    v_mfma_f32_16x16x32_bf16 v[100:103], v[108:111], v[172:175], v[100:103]
    v_mfma_f32_16x16x32_bf16 v[96:99], v[108:111], v[168:171], v[96:99]
    v_mfma_f32_16x16x32_bf16 v[92:95], v[108:111], v[164:167], v[92:95]
    v_mfma_f32_16x16x32_bf16 v[88:91], v[108:111], v[160:163], v[88:91]
    v_mfma_f32_16x16x32_bf16 v[84:87], v[108:111], v[156:159], v[84:87]
    v_mfma_f32_16x16x32_bf16 v[80:83], v[108:111], v[152:155], v[80:83]
    ds_read_b128 v[108:111], v66 offset:2112
    s_waitcnt lgkmcnt(2)
    v_mfma_f32_16x16x32_bf16 v[104:107], v[112:115], v[172:175], v[104:107]
    v_mfma_f32_16x16x32_bf16 v[100:103], v[112:115], v[168:171], v[100:103]
    v_mfma_f32_16x16x32_bf16 v[96:99], v[112:115], v[164:167], v[96:99]
    v_mfma_f32_16x16x32_bf16 v[92:95], v[112:115], v[160:163], v[92:95]
    v_mfma_f32_16x16x32_bf16 v[88:91], v[112:115], v[156:159], v[88:91]
    v_mfma_f32_16x16x32_bf16 v[84:87], v[112:115], v[152:155], v[84:87]
    ds_read_b128 v[112:115], v66 offset:2624
    s_waitcnt lgkmcnt(2)
    v_mfma_f32_16x16x32_bf16 v[104:107], v[116:119], v[168:171], v[104:107]
    v_mfma_f32_16x16x32_bf16 v[100:103], v[116:119], v[164:167], v[100:103]
    v_mfma_f32_16x16x32_bf16 v[96:99], v[116:119], v[160:163], v[96:99]
    v_mfma_f32_16x16x32_bf16 v[92:95], v[116:119], v[156:159], v[92:95]
    v_mfma_f32_16x16x32_bf16 v[88:91], v[116:119], v[152:155], v[88:91]
    ds_read_b128 v[116:119], v66 offset:3136
    s_waitcnt lgkmcnt(2)
    v_mfma_f32_16x16x32_bf16 v[104:107], v[108:111], v[164:167], v[104:107]
    v_mfma_f32_16x16x32_bf16 v[100:103], v[108:111], v[160:163], v[100:103]
    v_mfma_f32_16x16x32_bf16 v[96:99], v[108:111], v[156:159], v[96:99]
    v_mfma_f32_16x16x32_bf16 v[92:95], v[108:111], v[152:155], v[92:95]
    ds_read_b128 v[108:111], v66 offset:3648
    s_waitcnt lgkmcnt(2)
    v_mfma_f32_16x16x32_bf16 v[104:107], v[112:115], v[160:163], v[104:107]
    v_mfma_f32_16x16x32_bf16 v[100:103], v[112:115], v[156:159], v[100:103]
    v_mfma_f32_16x16x32_bf16 v[96:99], v[112:115], v[152:155], v[96:99]
    s_waitcnt lgkmcnt(1)
    v_mfma_f32_16x16x32_bf16 v[104:107], v[116:119], v[156:159], v[104:107]
    v_mfma_f32_16x16x32_bf16 v[100:103], v[116:119], v[152:155], v[100:103]
    s_waitcnt lgkmcnt(0)
    v_mfma_f32_16x16x32_bf16 v[104:107], v[108:111], v[152:155], v[104:107]
    ds_write_b128 v74, v[76:79] offset:0
    ds_write_b128 v74, v[80:83] offset:1024
    ds_write_b128 v74, v[84:87] offset:2048
    ds_write_b128 v74, v[88:91] offset:3072
    ds_write_b128 v74, v[92:95] offset:4096
    ds_write_b128 v74, v[96:99] offset:5120
    ds_write_b128 v74, v[100:103] offset:6144
    s_nop 0
    ds_write_b128 v74, v[104:107] offset:7168
    s_branch c_pw_end_40
c_pw_41:
    s_cmp_lg_u32 s34, 1
    s_cbranch_scc1 c_pw_42
    ds_read_b128 v[108:111], v66 offset:128
    ds_read_b128 v[120:123], v67 offset:352
    ds_read_b128 v[124:127], v67 offset:864
    ds_read_b128 v[128:131], v67 offset:1376
    ds_read_b128 v[132:135], v67 offset:1888
    ds_read_b128 v[136:139], v67 offset:2400
    ds_read_b128 v[140:143], v67 offset:2912
    ds_read_b128 v[144:147], v67 offset:3424
    ds_read_b128 v[148:151], v67 offset:3936
    ds_read_b128 v[112:115], v66 offset:640
    ds_read_b128 v[116:119], v66 offset:1152
    s_waitcnt lgkmcnt(2)
    v_mfma_f32_16x16x32_bf16 v[104:107], v[108:111], v[148:151], 0
    v_mfma_f32_16x16x32_bf16 v[100:103], v[108:111], v[144:147], 0
    v_mfma_f32_16x16x32_bf16 v[96:99], v[108:111], v[140:143], 0
    v_mfma_f32_16x16x32_bf16 v[92:95], v[108:111], v[136:139], 0
    v_mfma_f32_16x16x32_bf16 v[88:91], v[108:111], v[132:135], 0
    v_mfma_f32_16x16x32_bf16 v[84:87], v[108:111], v[128:131], 0
    v_mfma_f32_16x16x32_bf16 v[80:83], v[108:111], v[124:127], 0
    v_mfma_f32_16x16x32_bf16 v[76:79], v[108:111], v[120:123], 0
    ds_read_b128 v[108:111], v66 offset:1664
    s_waitcnt lgkmcnt(2)
    v_mfma_f32_16x16x32_bf16 v[104:107], v[112:115], v[144:147], v[104:107]
    v_mfma_f32_16x16x32_bf16 v[100:103], v[112:115], v[140:143], v[100:103]
    v_mfma_f32_16x16x32_bf16 v[96:99], v[112:115], v[136:139], v[96:99]
    v_mfma_f32_16x16x32_bf16 v[92:95], v[112:115], v[132:135], v[92:95]
    v_mfma_f32_16x16x32_bf16 v[88:91], v[112:115], v[128:131], v[88:91]
    v_mfma_f32_16x16x32_bf16 v[84:87], v[112:115], v[124:127], v[84:87]
    v_mfma_f32_16x16x32_bf16 v[80:83], v[112:115], v[120:123], v[80:83]
    ds_read_b128 v[112:115], v66 offset:2176
    ds_read_b128 v[152:155], v67 offset:288
    ds_read_b128 v[156:159], v67 offset:800
    ds_read_b128 v[160:163], v67 offset:1312
    ds_read_b128 v[164:167], v67 offset:1824
    ds_read_b128 v[168:171], v67 offset:2336
    ds_read_b128 v[172:175], v67 offset:2848
    ds_read_b128 v[176:179], v67 offset:3360
    ds_read_b128 v[180:183], v67 offset:3872
    s_waitcnt lgkmcnt(10)
    v_mfma_f32_16x16x32_bf16 v[104:107], v[116:119], v[140:143], v[104:107]
    v_mfma_f32_16x16x32_bf16 v[100:103], v[116:119], v[136:139], v[100:103]
    v_mfma_f32_16x16x32_bf16 v[96:99], v[116:119], v[132:135], v[96:99]
    v_mfma_f32_16x16x32_bf16 v[92:95], v[116:119], v[128:131], v[92:95]
    v_mfma_f32_16x16x32_bf16 v[88:91], v[116:119], v[124:127], v[88:91]
    v_mfma_f32_16x16x32_bf16 v[84:87], v[116:119], v[120:123], v[84:87]
    ds_read_b128 v[116:119], v66 offset:2688
    s_waitcnt lgkmcnt(10)
    v_mfma_f32_16x16x32_bf16 v[104:107], v[108:111], v[136:139], v[104:107]
    v_mfma_f32_16x16x32_bf16 v[100:103], v[108:111], v[132:135], v[100:103]
    v_mfma_f32_16x16x32_bf16 v[96:99], v[108:111], v[128:131], v[96:99]
    v_mfma_f32_16x16x32_bf16 v[92:95], v[108:111], v[124:127], v[92:95]
    v_mfma_f32_16x16x32_bf16 v[88:91], v[108:111], v[120:123], v[88:91]
    ds_read_b128 v[108:111], v66 offset:3200
    s_waitcnt lgkmcnt(10)
    v_mfma_f32_16x16x32_bf16 v[104:107], v[112:115], v[132:135], v[104:107]
    v_mfma_f32_16x16x32_bf16 v[100:103], v[112:115], v[128:131], v[100:103]
    v_mfma_f32_16x16x32_bf16 v[96:99], v[112:115], v[124:127], v[96:99]
    v_mfma_f32_16x16x32_bf16 v[92:95], v[112:115], v[120:123], v[92:95]
    ds_read_b128 v[112:115], v66 offset:3712
    s_waitcnt lgkmcnt(2)
    v_mfma_f32_16x16x32_bf16 v[104:107], v[116:119], v[128:131], v[104:107]
    v_mfma_f32_16x16x32_bf16 v[100:103], v[116:119], v[124:127], v[100:103]
    v_mfma_f32_16x16x32_bf16 v[96:99], v[116:119], v[120:123], v[96:99]
    ds_read_b128 v[116:119], v66 offset:192
    s_waitcnt lgkmcnt(2)
    v_mfma_f32_16x16x32_bf16 v[104:107], v[108:111], v[124:127], v[104:107]
    v_mfma_f32_16x16x32_bf16 v[100:103], v[108:111], v[120:123], v[100:103]
    ds_read_b128 v[108:111], v66 offset:704
    s_waitcnt lgkmcnt(2)
    v_mfma_f32_16x16x32_bf16 v[104:107], v[112:115], v[120:123], v[104:107]
    ds_read_b128 v[112:115], v66 offset:1216
    s_waitcnt lgkmcnt(2)
    v_mfma_f32_16x16x32_bf16 v[104:107], v[116:119], v[180:183], v[104:107]
    v_mfma_f32_16x16x32_bf16 v[100:103], v[116:119], v[176:179], v[100:103]
    v_mfma_f32_16x16x32_bf16 v[96:99], v[116:119], v[172:175], v[96:99]
    v_mfma_f32_16x16x32_bf16 v[92:95], v[116:119], v[168:171], v[92:95]
    v_mfma_f32_16x16x32_bf16 v[88:91], v[116:119], v[164:167], v[88:91]
    v_mfma_f32_16x16x32_bf16 v[84:87], v[116:119], v[160:163], v[84:87]
    v_mfma_f32_16x16x32_bf16 v[80:83], v[116:119], v[156:159], v[80:83]
    v_mfma_f32_16x16x32_bf16 v[76:79], v[116:119], v[152:155], v[76:79]
    ds_read_b128 v[116:119], v66 offset:1728
    s_waitcnt lgkmcnt(2)
    v_mfma_f32_16x16x32_bf16 v[104:107], v[108:111], v[176:179], v[104:107]
    v_mfma_f32_16x16x32_bf16 v[100:103], v[108:111], v[172:175], v[100:103]
    v_mfma_f32_16x16x32_bf16 v[96:99], v[108:111], v[168:171], v[96:99]
    v_mfma_f32_16x16x32_bf16 v[92:95], v[108:111], v[164:167], v[92:95]
    v_mfma_f32_16x16x32_bf16 v[88:91], v[108:111], v[160:163], v[88:91]
    v_mfma_f32_16x16x32_bf16 v[84:87], v[108:111], v[156:159], v[84:87]
    v_mfma_f32_16x16x32_bf16 v[80:83], v[108:111], v[152:155], v[80:83]
    ds_read_b128 v[108:111], v66 offset:2240
    s_waitcnt lgkmcnt(2)
    v_mfma_f32_16x16x32_bf16 v[104:107], v[112:115], v[172:175], v[104:107]
    v_mfma_f32_16x16x32_bf16 v[100:103], v[112:115], v[168:171], v[100:103]
    v_mfma_f32_16x16x32_bf16 v[96:99], v[112:115], v[164:167], v[96:99]
    v_mfma_f32_16x16x32_bf16 v[92:95], v[112:115], v[160:163], v[92:95]
    v_mfma_f32_16x16x32_bf16 v[88:91], v[112:115], v[156:159], v[88:91]
    v_mfma_f32_16x16x32_bf16 v[84:87], v[112:115], v[152:155], v[84:87]
    ds_read_b128 v[112:115], v66 offset:2752
    s_waitcnt lgkmcnt(2)
    v_mfma_f32_16x16x32_bf16 v[104:107], v[116:119], v[168:171], v[104:107]
    v_mfma_f32_16x16x32_bf16 v[100:103], v[116:119], v[164:167], v[100:103]
    v_mfma_f32_16x16x32_bf16 v[96:99], v[116:119], v[160:163], v[96:99]
    v_mfma_f32_16x16x32_bf16 v[92:95], v[116:119], v[156:159], v[92:95]
    v_mfma_f32_16x16x32_bf16 v[88:91], v[116:119], v[152:155], v[88:91]
    ds_read_b128 v[116:119], v66 offset:3264
    s_waitcnt lgkmcnt(2)
    v_mfma_f32_16x16x32_bf16 v[104:107], v[108:111], v[164:167], v[104:107]
    v_mfma_f32_16x16x32_bf16 v[100:103], v[108:111], v[160:163], v[100:103]
    v_mfma_f32_16x16x32_bf16 v[96:99], v[108:111], v[156:159], v[96:99]
    v_mfma_f32_16x16x32_bf16 v[92:95], v[108:111], v[152:155], v[92:95]
    ds_read_b128 v[108:111], v66 offset:3776
    s_waitcnt lgkmcnt(2)
    v_mfma_f32_16x16x32_bf16 v[104:107], v[112:115], v[160:163], v[104:107]
    v_mfma_f32_16x16x32_bf16 v[100:103], v[112:115], v[156:159], v[100:103]
    v_mfma_f32_16x16x32_bf16 v[96:99], v[112:115], v[152:155], v[96:99]
    s_waitcnt lgkmcnt(1)
    v_mfma_f32_16x16x32_bf16 v[104:107], v[116:119], v[156:159], v[104:107]
    v_mfma_f32_16x16x32_bf16 v[100:103], v[116:119], v[152:155], v[100:103]
    s_waitcnt lgkmcnt(0)
    v_mfma_f32_16x16x32_bf16 v[104:107], v[108:111], v[152:155], v[104:107]
    ds_write_b128 v74, v[76:79] offset:0
    ds_write_b128 v74, v[80:83] offset:1024
    ds_write_b128 v74, v[84:87] offset:2048
    ds_write_b128 v74, v[88:91] offset:3072
    ds_write_b128 v74, v[92:95] offset:4096
    ds_write_b128 v74, v[96:99] offset:5120
    ds_write_b128 v74, v[100:103] offset:6144
    s_nop 0
    ds_write_b128 v74, v[104:107] offset:7168
    s_branch c_pw_end_40
c_pw_42:
    s_cmp_lg_u32 s34, 2
    s_cbranch_scc1 c_pw_43
    ds_read_b128 v[108:111], v66 offset:256
    ds_read_b128 v[120:123], v67 offset:224
    ds_read_b128 v[124:127], v67 offset:736
    ds_read_b128 v[128:131], v67 offset:1248
    ds_read_b128 v[132:135], v67 offset:1760
    ds_read_b128 v[136:139], v67 offset:2272
    ds_read_b128 v[140:143], v67 offset:2784
    ds_read_b128 v[144:147], v67 offset:3296
    ds_read_b128 v[148:151], v67 offset:3808
    ds_read_b128 v[112:115], v66 offset:768
    ds_read_b128 v[116:119], v66 offset:1280
    s_waitcnt lgkmcnt(2)
    v_mfma_f32_16x16x32_bf16 v[104:107], v[108:111], v[148:151], 0
    v_mfma_f32_16x16x32_bf16 v[100:103], v[108:111], v[144:147], 0
    v_mfma_f32_16x16x32_bf16 v[96:99], v[108:111], v[140:143], 0
    v_mfma_f32_16x16x32_bf16 v[92:95], v[108:111], v[136:139], 0
    v_mfma_f32_16x16x32_bf16 v[88:91], v[108:111], v[132:135], 0
    v_mfma_f32_16x16x32_bf16 v[84:87], v[108:111], v[128:131], 0
    v_mfma_f32_16x16x32_bf16 v[80:83], v[108:111], v[124:127], 0
    v_mfma_f32_16x16x32_bf16 v[76:79], v[108:111], v[120:123], 0
    ds_read_b128 v[108:111], v66 offset:1792
    s_waitcnt lgkmcnt(2)
    v_mfma_f32_16x16x32_bf16 v[104:107], v[112:115], v[144:147], v[104:107]
    v_mfma_f32_16x16x32_bf16 v[100:103], v[112:115], v[140:143], v[100:103]
    v_mfma_f32_16x16x32_bf16 v[96:99], v[112:115], v[136:139], v[96:99]
    v_mfma_f32_16x16x32_bf16 v[92:95], v[112:115], v[132:135], v[92:95]
    v_mfma_f32_16x16x32_bf16 v[88:91], v[112:115], v[128:131], v[88:91]
    v_mfma_f32_16x16x32_bf16 v[84:87], v[112:115], v[124:127], v[84:87]
    v_mfma_f32_16x16x32_bf16 v[80:83], v[112:115], v[120:123], v[80:83]
    ds_read_b128 v[112:115], v66 offset:2304
    ds_read_b128 v[152:155], v67 offset:160
    ds_read_b128 v[156:159], v67 offset:672
    ds_read_b128 v[160:163], v67 offset:1184
    ds_read_b128 v[164:167], v67 offset:1696
    ds_read_b128 v[168:171], v67 offset:2208
    ds_read_b128 v[172:175], v67 offset:2720
    ds_read_b128 v[176:179], v67 offset:3232
    ds_read_b128 v[180:183], v67 offset:3744
    s_waitcnt lgkmcnt(10)
    v_mfma_f32_16x16x32_bf16 v[104:107], v[116:119], v[140:143], v[104:107]
    v_mfma_f32_16x16x32_bf16 v[100:103], v[116:119], v[136:139], v[100:103]
    v_mfma_f32_16x16x32_bf16 v[96:99], v[116:119], v[132:135], v[96:99]
    v_mfma_f32_16x16x32_bf16 v[92:95], v[116:119], v[128:131], v[92:95]
    v_mfma_f32_16x16x32_bf16 v[88:91], v[116:119], v[124:127], v[88:91]
    v_mfma_f32_16x16x32_bf16 v[84:87], v[116:119], v[120:123], v[84:87]
    ds_read_b128 v[116:119], v66 offset:2816
    s_waitcnt lgkmcnt(10)
    v_mfma_f32_16x16x32_bf16 v[104:107], v[108:111], v[136:139], v[104:107]
    v_mfma_f32_16x16x32_bf16 v[100:103], v[108:111], v[132:135], v[100:103]
    v_mfma_f32_16x16x32_bf16 v[96:99], v[108:111], v[128:131], v[96:99]
    v_mfma_f32_16x16x32_bf16 v[92:95], v[108:111], v[124:127], v[92:95]
    v_mfma_f32_16x16x32_bf16 v[88:91], v[108:111], v[120:123], v[88:91]
    ds_read_b128 v[108:111], v66 offset:3328
    s_waitcnt lgkmcnt(10)
    v_mfma_f32_16x16x32_bf16 v[104:107], v[112:115], v[132:135], v[104:107]
    v_mfma_f32_16x16x32_bf16 v[100:103], v[112:115], v[128:131], v[100:103]
    v_mfma_f32_16x16x32_bf16 v[96:99], v[112:115], v[124:127], v[96:99]
    v_mfma_f32_16x16x32_bf16 v[92:95], v[112:115], v[120:123], v[92:95]
    ds_read_b128 v[112:115], v66 offset:3840
    s_waitcnt lgkmcnt(2)
    v_mfma_f32_16x16x32_bf16 v[104:107], v[116:119], v[128:131], v[104:107]
    v_mfma_f32_16x16x32_bf16 v[100:103], v[116:119], v[124:127], v[100:103]
    v_mfma_f32_16x16x32_bf16 v[96:99], v[116:119], v[120:123], v[96:99]
    ds_read_b128 v[116:119], v66 offset:320
    s_waitcnt lgkmcnt(2)
    v_mfma_f32_16x16x32_bf16 v[104:107], v[108:111], v[124:127], v[104:107]
    v_mfma_f32_16x16x32_bf16 v[100:103], v[108:111], v[120:123], v[100:103]
    ds_read_b128 v[108:111], v66 offset:832
    s_waitcnt lgkmcnt(2)
    v_mfma_f32_16x16x32_bf16 v[104:107], v[112:115], v[120:123], v[104:107]
    ds_read_b128 v[112:115], v66 offset:1344
    s_waitcnt lgkmcnt(2)
    v_mfma_f32_16x16x32_bf16 v[104:107], v[116:119], v[180:183], v[104:107]
    v_mfma_f32_16x16x32_bf16 v[100:103], v[116:119], v[176:179], v[100:103]
    v_mfma_f32_16x16x32_bf16 v[96:99], v[116:119], v[172:175], v[96:99]
    v_mfma_f32_16x16x32_bf16 v[92:95], v[116:119], v[168:171], v[92:95]
    v_mfma_f32_16x16x32_bf16 v[88:91], v[116:119], v[164:167], v[88:91]
    v_mfma_f32_16x16x32_bf16 v[84:87], v[116:119], v[160:163], v[84:87]
    v_mfma_f32_16x16x32_bf16 v[80:83], v[116:119], v[156:159], v[80:83]
    v_mfma_f32_16x16x32_bf16 v[76:79], v[116:119], v[152:155], v[76:79]
    ds_read_b128 v[116:119], v66 offset:1856
    s_waitcnt lgkmcnt(2)
    v_mfma_f32_16x16x32_bf16 v[104:107], v[108:111], v[176:179], v[104:107]
    v_mfma_f32_16x16x32_bf16 v[100:103], v[108:111], v[172:175], v[100:103]
    v_mfma_f32_16x16x32_bf16 v[96:99], v[108:111], v[168:171], v[96:99]
    v_mfma_f32_16x16x32_bf16 v[92:95], v[108:111], v[164:167], v[92:95]
    v_mfma_f32_16x16x32_bf16 v[88:91], v[108:111], v[160:163], v[88:91]
    v_mfma_f32_16x16x32_bf16 v[84:87], v[108:111], v[156:159], v[84:87]
    v_mfma_f32_16x16x32_bf16 v[80:83], v[108:111], v[152:155], v[80:83]
    ds_read_b128 v[108:111], v66 offset:2368
    s_waitcnt lgkmcnt(2)
    v_mfma_f32_16x16x32_bf16 v[104:107], v[112:115], v[172:175], v[104:107]
    v_mfma_f32_16x16x32_bf16 v[100:103], v[112:115], v[168:171], v[100:103]
    v_mfma_f32_16x16x32_bf16 v[96:99], v[112:115], v[164:167], v[96:99]
    v_mfma_f32_16x16x32_bf16 v[92:95], v[112:115], v[160:163], v[92:95]
    v_mfma_f32_16x16x32_bf16 v[88:91], v[112:115], v[156:159], v[88:91]
    v_mfma_f32_16x16x32_bf16 v[84:87], v[112:115], v[152:155], v[84:87]
    ds_read_b128 v[112:115], v66 offset:2880
    s_waitcnt lgkmcnt(2)
    v_mfma_f32_16x16x32_bf16 v[104:107], v[116:119], v[168:171], v[104:107]
    v_mfma_f32_16x16x32_bf16 v[100:103], v[116:119], v[164:167], v[100:103]
    v_mfma_f32_16x16x32_bf16 v[96:99], v[116:119], v[160:163], v[96:99]
    v_mfma_f32_16x16x32_bf16 v[92:95], v[116:119], v[156:159], v[92:95]
    v_mfma_f32_16x16x32_bf16 v[88:91], v[116:119], v[152:155], v[88:91]
    ds_read_b128 v[116:119], v66 offset:3392
    s_waitcnt lgkmcnt(2)
    v_mfma_f32_16x16x32_bf16 v[104:107], v[108:111], v[164:167], v[104:107]
    v_mfma_f32_16x16x32_bf16 v[100:103], v[108:111], v[160:163], v[100:103]
    v_mfma_f32_16x16x32_bf16 v[96:99], v[108:111], v[156:159], v[96:99]
    v_mfma_f32_16x16x32_bf16 v[92:95], v[108:111], v[152:155], v[92:95]
    ds_read_b128 v[108:111], v66 offset:3904
    s_waitcnt lgkmcnt(2)
    v_mfma_f32_16x16x32_bf16 v[104:107], v[112:115], v[160:163], v[104:107]
    v_mfma_f32_16x16x32_bf16 v[100:103], v[112:115], v[156:159], v[100:103]
    v_mfma_f32_16x16x32_bf16 v[96:99], v[112:115], v[152:155], v[96:99]
    s_waitcnt lgkmcnt(1)
    v_mfma_f32_16x16x32_bf16 v[104:107], v[116:119], v[156:159], v[104:107]
    v_mfma_f32_16x16x32_bf16 v[100:103], v[116:119], v[152:155], v[100:103]
    s_waitcnt lgkmcnt(0)
    v_mfma_f32_16x16x32_bf16 v[104:107], v[108:111], v[152:155], v[104:107]
    ds_write_b128 v74, v[76:79] offset:0
    ds_write_b128 v74, v[80:83] offset:1024
    ds_write_b128 v74, v[84:87] offset:2048
    ds_write_b128 v74, v[88:91] offset:3072
    ds_write_b128 v74, v[92:95] offset:4096
    ds_write_b128 v74, v[96:99] offset:5120
    ds_write_b128 v74, v[100:103] offset:6144
    s_nop 0
    ds_write_b128 v74, v[104:107] offset:7168
    s_branch c_pw_end_40
c_pw_43:
    ds_read_b128 v[108:111], v66 offset:384
    ds_read_b128 v[120:123], v67 offset:96
    ds_read_b128 v[124:127], v67 offset:608
    ds_read_b128 v[128:131], v67 offset:1120
    ds_read_b128 v[132:135], v67 offset:1632
    ds_read_b128 v[136:139], v67 offset:2144
    ds_read_b128 v[140:143], v67 offset:2656
    ds_read_b128 v[144:147], v67 offset:3168
    ds_read_b128 v[148:151], v67 offset:3680
    ds_read_b128 v[112:115], v66 offset:896
    ds_read_b128 v[116:119], v66 offset:1408
    s_waitcnt lgkmcnt(2)
    v_mfma_f32_16x16x32_bf16 v[104:107], v[108:111], v[148:151], 0
    v_mfma_f32_16x16x32_bf16 v[100:103], v[108:111], v[144:147], 0
    v_mfma_f32_16x16x32_bf16 v[96:99], v[108:111], v[140:143], 0
    v_mfma_f32_16x16x32_bf16 v[92:95], v[108:111], v[136:139], 0
    v_mfma_f32_16x16x32_bf16 v[88:91], v[108:111], v[132:135], 0
    v_mfma_f32_16x16x32_bf16 v[84:87], v[108:111], v[128:131], 0
    v_mfma_f32_16x16x32_bf16 v[80:83], v[108:111], v[124:127], 0
    v_mfma_f32_16x16x32_bf16 v[76:79], v[108:111], v[120:123], 0
    ds_read_b128 v[108:111], v66 offset:1920
    s_waitcnt lgkmcnt(2)
    v_mfma_f32_16x16x32_bf16 v[104:107], v[112:115], v[144:147], v[104:107]
    v_mfma_f32_16x16x32_bf16 v[100:103], v[112:115], v[140:143], v[100:103]
    v_mfma_f32_16x16x32_bf16 v[96:99], v[112:115], v[136:139], v[96:99]
    v_mfma_f32_16x16x32_bf16 v[92:95], v[112:115], v[132:135], v[92:95]
    v_mfma_f32_16x16x32_bf16 v[88:91], v[112:115], v[128:131], v[88:91]
    v_mfma_f32_16x16x32_bf16 v[84:87], v[112:115], v[124:127], v[84:87]
    v_mfma_f32_16x16x32_bf16 v[80:83], v[112:115], v[120:123], v[80:83]
    ds_read_b128 v[112:115], v66 offset:2432
    ds_read_b128 v[152:155], v67 offset:32
    ds_read_b128 v[156:159], v67 offset:544
    ds_read_b128 v[160:163], v67 offset:1056
    ds_read_b128 v[164:167], v67 offset:1568
    ds_read_b128 v[168:171], v67 offset:2080
    ds_read_b128 v[172:175], v67 offset:2592
    ds_read_b128 v[176:179], v67 offset:3104
    ds_read_b128 v[180:183], v67 offset:3616
    s_waitcnt lgkmcnt(10)
    v_mfma_f32_16x16x32_bf16 v[104:107], v[116:119], v[140:143], v[104:107]
    v_mfma_f32_16x16x32_bf16 v[100:103], v[116:119], v[136:139], v[100:103]
    v_mfma_f32_16x16x32_bf16 v[96:99], v[116:119], v[132:135], v[96:99]
    v_mfma_f32_16x16x32_bf16 v[92:95], v[116:119], v[128:131], v[92:95]
    v_mfma_f32_16x16x32_bf16 v[88:91], v[116:119], v[124:127], v[88:91]
    v_mfma_f32_16x16x32_bf16 v[84:87], v[116:119], v[120:123], v[84:87]
    ds_read_b128 v[116:119], v66 offset:2944
    s_waitcnt lgkmcnt(10)
    v_mfma_f32_16x16x32_bf16 v[104:107], v[108:111], v[136:139], v[104:107]
    v_mfma_f32_16x16x32_bf16 v[100:103], v[108:111], v[132:135], v[100:103]
    v_mfma_f32_16x16x32_bf16 v[96:99], v[108:111], v[128:131], v[96:99]
    v_mfma_f32_16x16x32_bf16 v[92:95], v[108:111], v[124:127], v[92:95]
    v_mfma_f32_16x16x32_bf16 v[88:91], v[108:111], v[120:123], v[88:91]
    ds_read_b128 v[108:111], v66 offset:3456
    s_waitcnt lgkmcnt(10)
    v_mfma_f32_16x16x32_bf16 v[104:107], v[112:115], v[132:135], v[104:107]
    v_mfma_f32_16x16x32_bf16 v[100:103], v[112:115], v[128:131], v[100:103]
    v_mfma_f32_16x16x32_bf16 v[96:99], v[112:115], v[124:127], v[96:99]
    v_mfma_f32_16x16x32_bf16 v[92:95], v[112:115], v[120:123], v[92:95]
    ds_read_b128 v[112:115], v66 offset:3968
    s_waitcnt lgkmcnt(2)
    v_mfma_f32_16x16x32_bf16 v[104:107], v[116:119], v[128:131], v[104:107]
    v_mfma_f32_16x16x32_bf16 v[100:103], v[116:119], v[124:127], v[100:103]
    v_mfma_f32_16x16x32_bf16 v[96:99], v[116:119], v[120:123], v[96:99]
    ds_read_b128 v[116:119], v66 offset:448
    s_waitcnt lgkmcnt(2)
    v_mfma_f32_16x16x32_bf16 v[104:107], v[108:111], v[124:127], v[104:107]
    v_mfma_f32_16x16x32_bf16 v[100:103], v[108:111], v[120:123], v[100:103]
    ds_read_b128 v[108:111], v66 offset:960
    s_waitcnt lgkmcnt(2)
    v_mfma_f32_16x16x32_bf16 v[104:107], v[112:115], v[120:123], v[104:107]
    ds_read_b128 v[112:115], v66 offset:1472
    s_waitcnt lgkmcnt(2)
    v_mfma_f32_16x16x32_bf16 v[104:107], v[116:119], v[180:183], v[104:107]
    v_mfma_f32_16x16x32_bf16 v[100:103], v[116:119], v[176:179], v[100:103]
    v_mfma_f32_16x16x32_bf16 v[96:99], v[116:119], v[172:175], v[96:99]
    v_mfma_f32_16x16x32_bf16 v[92:95], v[116:119], v[168:171], v[92:95]
    v_mfma_f32_16x16x32_bf16 v[88:91], v[116:119], v[164:167], v[88:91]
    v_mfma_f32_16x16x32_bf16 v[84:87], v[116:119], v[160:163], v[84:87]
    v_mfma_f32_16x16x32_bf16 v[80:83], v[116:119], v[156:159], v[80:83]
    v_mfma_f32_16x16x32_bf16 v[76:79], v[116:119], v[152:155], v[76:79]
    ds_read_b128 v[116:119], v66 offset:1984
    s_waitcnt lgkmcnt(2)
    v_mfma_f32_16x16x32_bf16 v[104:107], v[108:111], v[176:179], v[104:107]
    v_mfma_f32_16x16x32_bf16 v[100:103], v[108:111], v[172:175], v[100:103]
    v_mfma_f32_16x16x32_bf16 v[96:99], v[108:111], v[168:171], v[96:99]
    v_mfma_f32_16x16x32_bf16 v[92:95], v[108:111], v[164:167], v[92:95]
    v_mfma_f32_16x16x32_bf16 v[88:91], v[108:111], v[160:163], v[88:91]
    v_mfma_f32_16x16x32_bf16 v[84:87], v[108:111], v[156:159], v[84:87]
    v_mfma_f32_16x16x32_bf16 v[80:83], v[108:111], v[152:155], v[80:83]
    ds_read_b128 v[108:111], v66 offset:2496
    s_waitcnt lgkmcnt(2)
    v_mfma_f32_16x16x32_bf16 v[104:107], v[112:115], v[172:175], v[104:107]
    v_mfma_f32_16x16x32_bf16 v[100:103], v[112:115], v[168:171], v[100:103]
    v_mfma_f32_16x16x32_bf16 v[96:99], v[112:115], v[164:167], v[96:99]
    v_mfma_f32_16x16x32_bf16 v[92:95], v[112:115], v[160:163], v[92:95]
    v_mfma_f32_16x16x32_bf16 v[88:91], v[112:115], v[156:159], v[88:91]
    v_mfma_f32_16x16x32_bf16 v[84:87], v[112:115], v[152:155], v[84:87]
    ds_read_b128 v[112:115], v66 offset:3008
    s_waitcnt lgkmcnt(2)
    v_mfma_f32_16x16x32_bf16 v[104:107], v[116:119], v[168:171], v[104:107]
    v_mfma_f32_16x16x32_bf16 v[100:103], v[116:119], v[164:167], v[100:103]
    v_mfma_f32_16x16x32_bf16 v[96:99], v[116:119], v[160:163], v[96:99]
    v_mfma_f32_16x16x32_bf16 v[92:95], v[116:119], v[156:159], v[92:95]
    v_mfma_f32_16x16x32_bf16 v[88:91], v[116:119], v[152:155], v[88:91]
    ds_read_b128 v[116:119], v66 offset:3520
    s_waitcnt lgkmcnt(2)
    v_mfma_f32_16x16x32_bf16 v[104:107], v[108:111], v[164:167], v[104:107]
    v_mfma_f32_16x16x32_bf16 v[100:103], v[108:111], v[160:163], v[100:103]
    v_mfma_f32_16x16x32_bf16 v[96:99], v[108:111], v[156:159], v[96:99]
    v_mfma_f32_16x16x32_bf16 v[92:95], v[108:111], v[152:155], v[92:95]
    ds_read_b128 v[108:111], v66 offset:4032
    s_waitcnt lgkmcnt(2)
    v_mfma_f32_16x16x32_bf16 v[104:107], v[112:115], v[160:163], v[104:107]
    v_mfma_f32_16x16x32_bf16 v[100:103], v[112:115], v[156:159], v[100:103]
    v_mfma_f32_16x16x32_bf16 v[96:99], v[112:115], v[152:155], v[96:99]
    s_waitcnt lgkmcnt(1)
    v_mfma_f32_16x16x32_bf16 v[104:107], v[116:119], v[156:159], v[104:107]
    v_mfma_f32_16x16x32_bf16 v[100:103], v[116:119], v[152:155], v[100:103]
    s_waitcnt lgkmcnt(0)
    v_mfma_f32_16x16x32_bf16 v[104:107], v[108:111], v[152:155], v[104:107]
    ds_write_b128 v74, v[76:79] offset:0
    ds_write_b128 v74, v[80:83] offset:1024
    ds_write_b128 v74, v[84:87] offset:2048
    ds_write_b128 v74, v[88:91] offset:3072
    ds_write_b128 v74, v[92:95] offset:4096
    ds_write_b128 v74, v[96:99] offset:5120
    ds_write_b128 v74, v[100:103] offset:6144
    s_nop 0
    ds_write_b128 v74, v[104:107] offset:7168
c_pw_end_40:
    s_waitcnt lgkmcnt(0)
    v_mov_b32 v3, 161796
    v_mov_b32 v4, 1
    s_mov_b64 exec, 1
    ds_add_u32 v3, v4
    s_mov_b64 exec, -1
    s_mov_b32 s67, 0
gsync_45:
    ds_read_b32 v4, v3
    s_add_u32 s67, s67, 1
    s_waitcnt lgkmcnt(0)
    v_readfirstlane_b32 s66, v4
    s_cmp_gt_u32 s67, 1000000
    s_cbranch_scc1 gsync_e_46
    s_cmp_lt_u32 s66, 16
    s_cbranch_scc1 gsync_45
gsync_e_46:
    ds_read_b128 v[120:123], v75 offset:0
    ds_read_b128 v[124:127], v75 offset:16
    ds_read_b128 v[128:131], v75 offset:8192
    ds_read_b128 v[132:135], v75 offset:8208
    ds_read_b128 v[136:139], v75 offset:16384
    ds_read_b128 v[140:143], v75 offset:16400
    ds_read_b128 v[144:147], v75 offset:24576
    ds_read_b128 v[148:151], v75 offset:24592
    s_lshl_b32 s40, s57, 12
    s_add_u32 s40, s40, 8912896
    s_waitcnt lgkmcnt(0)
    v_pk_add_f32 v[120:121], v[120:121], v[128:129]
    v_pk_add_f32 v[136:137], v[136:137], v[144:145]
    v_pk_add_f32 v[122:123], v[122:123], v[130:131]
    v_pk_add_f32 v[138:139], v[138:139], v[146:147]
    v_pk_add_f32 v[124:125], v[124:125], v[132:133]
    v_pk_add_f32 v[140:141], v[140:141], v[148:149]
    v_pk_add_f32 v[126:127], v[126:127], v[134:135]
    v_pk_add_f32 v[142:143], v[142:143], v[150:151]
    v_pk_add_f32 v[120:121], v[120:121], v[136:137]
    v_pk_add_f32 v[122:123], v[122:123], v[138:139]
    v_pk_add_f32 v[124:125], v[124:125], v[140:141]
    v_pk_add_f32 v[126:127], v[126:127], v[142:143]
    v_cvt_pk_bf16_f32 v192, v120, v121
    v_cvt_pk_bf16_f32 v193, v122, v123
    v_cvt_pk_bf16_f32 v194, v124, v125
    v_cvt_pk_bf16_f32 v195, v126, v127
    buffer_store_dwordx4 v[192:195], v2, s[8:11], s40 offen sc1
    s_nop 1
    s_waitcnt vmcnt(0)
    v_cmp_ne_u32 vcc, 0, v0
    s_nop 1
    v_cndmask_b32 v24, 0, v24, vcc
    v_cndmask_b32 v25, 0, v25, vcc
    v_cndmask_b32 v26, 0, v26, vcc
    v_cndmask_b32 v27, 0, v27, vcc
    v_alignbit_b32 v184, v25, v24, 16
    v_alignbit_b32 v185, v26, v25, 16
    v_alignbit_b32 v186, v27, v26, 16
    v_alignbit_b32 v187, v28, v27, 16
    v_alignbit_b32 v188, v29, v28, 16
    v_alignbit_b32 v189, v30, v29, 16
    v_alignbit_b32 v190, v31, v30, 16
    ds_write_b128 v64, v[184:187] offset:0
    v_mov_b32 v192, v25
    v_mov_b32 v193, v26
    v_mov_b32 v194, v27
    v_mov_b32 v195, v28
    ds_write_b128 v64, v[192:195] offset:4160
    s_nop 1
    v_mov_b32 v192, v185
    v_mov_b32 v193, v186
    v_mov_b32 v194, v187
    v_mov_b32 v195, v188
    ds_write_b128 v64, v[192:195] offset:8320
    s_nop 1
    ds_write_b128 v64, v[26:29] offset:12480
    ds_write_b128 v64, v[186:189] offset:16640
    v_mov_b32 v192, v27
    v_mov_b32 v193, v28
    v_mov_b32 v194, v29
    v_mov_b32 v195, v30
    ds_write_b128 v64, v[192:195] offset:20800
    s_nop 1
    v_mov_b32 v192, v187
    v_mov_b32 v193, v188
    v_mov_b32 v194, v189
    v_mov_b32 v195, v190
    ds_write_b128 v64, v[192:195] offset:24960
    s_nop 1
    ds_write_b128 v64, v[28:31] offset:29120
    ds_write_b128 v65, v[40:43]
    v_lshlrev_b32 v3, 16, v46
    v_or_b32 v3, v3, v46
    v_and_b32 v196, v68, v3
    v_and_b32 v197, v69, v3
    v_and_b32 v198, v70, v3
    v_and_b32 v199, v71, v3
    s_waitcnt lgkmcnt(0)
    v_mov_b32 v3, 161796
    v_mov_b32 v4, 1
    s_mov_b64 exec, 1
    ds_add_u32 v3, v4
    s_mov_b64 exec, -1
    s_mov_b32 s67, 0
gsync_47:
    ds_read_b32 v4, v3
    s_add_u32 s67, s67, 1
    s_waitcnt lgkmcnt(0)
    v_readfirstlane_b32 s66, v4
    s_cmp_gt_u32 s67, 1000000
    s_cbranch_scc1 gsync_e_48
    s_cmp_lt_u32 s66, 20
    s_cbranch_scc1 gsync_47
gsync_e_48:
    s_bitcmp1_b32 s2, 0
    s_cbranch_scc1 c_halfB_49
    s_cmp_lg_u32 s34, 0
    s_cbranch_scc1 c_pw_52
    ds_read_b128 v[108:111], v66 offset:0
    ds_read_b128 v[120:123], v67 offset:480
    ds_read_b128 v[124:127], v67 offset:992
    ds_read_b128 v[128:131], v67 offset:1504
    ds_read_b128 v[132:135], v67 offset:2016
    ds_read_b128 v[136:139], v67 offset:2528
    ds_read_b128 v[140:143], v67 offset:3040
    ds_read_b128 v[144:147], v67 offset:3552
    ds_read_b128 v[148:151], v67 offset:4064
    ds_read_b128 v[112:115], v66 offset:512
    ds_read_b128 v[116:119], v66 offset:1024
    s_waitcnt lgkmcnt(2)
    v_mfma_f32_16x16x32_bf16 v[104:107], v[108:111], v[148:151], 0
    v_mfma_f32_16x16x32_bf16 v[100:103], v[108:111], v[144:147], 0
    v_mfma_f32_16x16x32_bf16 v[84:87], v[108:111], v[128:131], 0
    v_mfma_f32_16x16x32_bf16 v[84:87], v[196:199], v[128:131], v[84:87]
    v_mfma_f32_16x16x32_bf16 v[100:103], v[196:199], v[144:147], v[100:103]
    v_mfma_f32_16x16x32_bf16 v[104:107], v[196:199], v[148:151], v[104:107]
    ds_read_b128 v[108:111], v66 offset:1536
    s_waitcnt lgkmcnt(2)
    v_mfma_f32_16x16x32_bf16 v[104:107], v[112:115], v[144:147], v[104:107]
    v_mfma_f32_16x16x32_bf16 v[100:103], v[112:115], v[140:143], v[100:103]
    v_mfma_f32_16x16x32_bf16 v[84:87], v[112:115], v[124:127], v[84:87]
    ds_read_b128 v[112:115], v66 offset:2048
    ds_read_b128 v[152:155], v67 offset:416
    ds_read_b128 v[156:159], v67 offset:928
    ds_read_b128 v[160:163], v67 offset:1440
    ds_read_b128 v[164:167], v67 offset:1952
    ds_read_b128 v[168:171], v67 offset:2464
    ds_read_b128 v[172:175], v67 offset:2976
    ds_read_b128 v[176:179], v67 offset:3488
    ds_read_b128 v[180:183], v67 offset:4000
    s_waitcnt lgkmcnt(10)
    v_mfma_f32_16x16x32_bf16 v[104:107], v[116:119], v[140:143], v[104:107]
    v_mfma_f32_16x16x32_bf16 v[100:103], v[116:119], v[136:139], v[100:103]
    v_mfma_f32_16x16x32_bf16 v[84:87], v[116:119], v[120:123], v[84:87]
    ds_read_b128 v[116:119], v66 offset:2560
    s_waitcnt lgkmcnt(10)
    v_mfma_f32_16x16x32_bf16 v[104:107], v[108:111], v[136:139], v[104:107]
    v_mfma_f32_16x16x32_bf16 v[100:103], v[108:111], v[132:135], v[100:103]
    ds_read_b128 v[108:111], v66 offset:3072
    s_waitcnt lgkmcnt(10)
    v_mfma_f32_16x16x32_bf16 v[104:107], v[112:115], v[132:135], v[104:107]
    v_mfma_f32_16x16x32_bf16 v[100:103], v[112:115], v[128:131], v[100:103]
    ds_read_b128 v[112:115], v66 offset:3584
    s_waitcnt lgkmcnt(2)
    v_mfma_f32_16x16x32_bf16 v[104:107], v[116:119], v[128:131], v[104:107]
    v_mfma_f32_16x16x32_bf16 v[100:103], v[116:119], v[124:127], v[100:103]
    ds_read_b128 v[116:119], v66 offset:64
    s_waitcnt lgkmcnt(2)
    v_mfma_f32_16x16x32_bf16 v[104:107], v[108:111], v[124:127], v[104:107]
    v_mfma_f32_16x16x32_bf16 v[100:103], v[108:111], v[120:123], v[100:103]
    ds_read_b128 v[108:111], v66 offset:576
    s_waitcnt lgkmcnt(2)
    v_mfma_f32_16x16x32_bf16 v[104:107], v[112:115], v[120:123], v[104:107]
    ds_read_b128 v[112:115], v66 offset:1088
    s_waitcnt lgkmcnt(2)
    v_mfma_f32_16x16x32_bf16 v[104:107], v[116:119], v[180:183], v[104:107]
    v_mfma_f32_16x16x32_bf16 v[100:103], v[116:119], v[176:179], v[100:103]
    v_mfma_f32_16x16x32_bf16 v[84:87], v[116:119], v[160:163], v[84:87]
    ds_read_b128 v[116:119], v66 offset:1600
    s_waitcnt lgkmcnt(2)
    v_mfma_f32_16x16x32_bf16 v[104:107], v[108:111], v[176:179], v[104:107]
    v_mfma_f32_16x16x32_bf16 v[100:103], v[108:111], v[172:175], v[100:103]
    v_mfma_f32_16x16x32_bf16 v[84:87], v[108:111], v[156:159], v[84:87]
    ds_read_b128 v[108:111], v66 offset:2112
    s_waitcnt lgkmcnt(2)
    v_mfma_f32_16x16x32_bf16 v[104:107], v[112:115], v[172:175], v[104:107]
    v_mfma_f32_16x16x32_bf16 v[100:103], v[112:115], v[168:171], v[100:103]
    v_mfma_f32_16x16x32_bf16 v[84:87], v[112:115], v[152:155], v[84:87]
    ds_read_b128 v[112:115], v66 offset:2624
    s_waitcnt lgkmcnt(2)
    v_mfma_f32_16x16x32_bf16 v[104:107], v[116:119], v[168:171], v[104:107]
    v_mfma_f32_16x16x32_bf16 v[100:103], v[116:119], v[164:167], v[100:103]
    ds_read_b128 v[116:119], v66 offset:3136
    s_waitcnt lgkmcnt(2)
    v_mfma_f32_16x16x32_bf16 v[104:107], v[108:111], v[164:167], v[104:107]
    v_mfma_f32_16x16x32_bf16 v[100:103], v[108:111], v[160:163], v[100:103]
    ds_read_b128 v[108:111], v66 offset:3648
    s_waitcnt lgkmcnt(2)
    v_mfma_f32_16x16x32_bf16 v[104:107], v[112:115], v[160:163], v[104:107]
    v_mfma_f32_16x16x32_bf16 v[100:103], v[112:115], v[156:159], v[100:103]
    s_waitcnt lgkmcnt(1)
    v_mfma_f32_16x16x32_bf16 v[104:107], v[116:119], v[156:159], v[104:107]
    v_mfma_f32_16x16x32_bf16 v[100:103], v[116:119], v[152:155], v[100:103]
    s_waitcnt lgkmcnt(0)
    v_mfma_f32_16x16x32_bf16 v[104:107], v[108:111], v[152:155], v[104:107]
    ds_write_b128 v74, v[84:87] offset:2048
    s_nop 4
    ds_write_b128 v74, v[100:103] offset:6144
    s_nop 0
    ds_write_b128 v74, v[104:107] offset:7168
    s_branch c_pw_end_51
c_pw_52:
    s_cmp_lg_u32 s34, 1
    s_cbranch_scc1 c_pw_53
    ds_read_b128 v[108:111], v66 offset:128
    ds_read_b128 v[120:123], v67 offset:352
    ds_read_b128 v[124:127], v67 offset:864
    ds_read_b128 v[128:131], v67 offset:1376
    ds_read_b128 v[132:135], v67 offset:1888
    ds_read_b128 v[136:139], v67 offset:2400
    ds_read_b128 v[140:143], v67 offset:2912
    ds_read_b128 v[144:147], v67 offset:3424
    ds_read_b128 v[148:151], v67 offset:3936
    ds_read_b128 v[112:115], v66 offset:640
    ds_read_b128 v[116:119], v66 offset:1152
    s_waitcnt lgkmcnt(2)
    v_mfma_f32_16x16x32_bf16 v[104:107], v[108:111], v[148:151], 0
    v_mfma_f32_16x16x32_bf16 v[100:103], v[108:111], v[144:147], 0
    v_mfma_f32_16x16x32_bf16 v[84:87], v[108:111], v[128:131], 0
    ds_read_b128 v[108:111], v66 offset:1664
    s_waitcnt lgkmcnt(2)
    v_mfma_f32_16x16x32_bf16 v[104:107], v[112:115], v[144:147], v[104:107]
    v_mfma_f32_16x16x32_bf16 v[100:103], v[112:115], v[140:143], v[100:103]
    v_mfma_f32_16x16x32_bf16 v[84:87], v[112:115], v[124:127], v[84:87]
    ds_read_b128 v[112:115], v66 offset:2176
    ds_read_b128 v[152:155], v67 offset:288
    ds_read_b128 v[156:159], v67 offset:800
    ds_read_b128 v[160:163], v67 offset:1312
    ds_read_b128 v[164:167], v67 offset:1824
    ds_read_b128 v[168:171], v67 offset:2336
    ds_read_b128 v[172:175], v67 offset:2848
    ds_read_b128 v[176:179], v67 offset:3360
    ds_read_b128 v[180:183], v67 offset:3872
    s_waitcnt lgkmcnt(10)
    v_mfma_f32_16x16x32_bf16 v[104:107], v[116:119], v[140:143], v[104:107]
    v_mfma_f32_16x16x32_bf16 v[100:103], v[116:119], v[136:139], v[100:103]
    v_mfma_f32_16x16x32_bf16 v[84:87], v[116:119], v[120:123], v[84:87]
    ds_read_b128 v[116:119], v66 offset:2688
    s_waitcnt lgkmcnt(10)
    v_mfma_f32_16x16x32_bf16 v[104:107], v[108:111], v[136:139], v[104:107]
    v_mfma_f32_16x16x32_bf16 v[100:103], v[108:111], v[132:135], v[100:103]
    ds_read_b128 v[108:111], v66 offset:3200
    s_waitcnt lgkmcnt(10)
    v_mfma_f32_16x16x32_bf16 v[104:107], v[112:115], v[132:135], v[104:107]
    v_mfma_f32_16x16x32_bf16 v[100:103], v[112:115], v[128:131], v[100:103]
    ds_read_b128 v[112:115], v66 offset:3712
    s_waitcnt lgkmcnt(2)
    v_mfma_f32_16x16x32_bf16 v[104:107], v[116:119], v[128:131], v[104:107]
    v_mfma_f32_16x16x32_bf16 v[100:103], v[116:119], v[124:127], v[100:103]
    ds_read_b128 v[116:119], v66 offset:192
    s_waitcnt lgkmcnt(2)
    v_mfma_f32_16x16x32_bf16 v[104:107], v[108:111], v[124:127], v[104:107]
    v_mfma_f32_16x16x32_bf16 v[100:103], v[108:111], v[120:123], v[100:103]
    ds_read_b128 v[108:111], v66 offset:704
    s_waitcnt lgkmcnt(2)
    v_mfma_f32_16x16x32_bf16 v[104:107], v[112:115], v[120:123], v[104:107]
    ds_read_b128 v[112:115], v66 offset:1216
    s_waitcnt lgkmcnt(2)
    v_mfma_f32_16x16x32_bf16 v[104:107], v[116:119], v[180:183], v[104:107]
    v_mfma_f32_16x16x32_bf16 v[100:103], v[116:119], v[176:179], v[100:103]
    v_mfma_f32_16x16x32_bf16 v[84:87], v[116:119], v[160:163], v[84:87]
    ds_read_b128 v[116:119], v66 offset:1728
    s_waitcnt lgkmcnt(2)
    v_mfma_f32_16x16x32_bf16 v[104:107], v[108:111], v[176:179], v[104:107]
    v_mfma_f32_16x16x32_bf16 v[100:103], v[108:111], v[172:175], v[100:103]
    v_mfma_f32_16x16x32_bf16 v[84:87], v[108:111], v[156:159], v[84:87]
    ds_read_b128 v[108:111], v66 offset:2240
    s_waitcnt lgkmcnt(2)
    v_mfma_f32_16x16x32_bf16 v[104:107], v[112:115], v[172:175], v[104:107]
    v_mfma_f32_16x16x32_bf16 v[100:103], v[112:115], v[168:171], v[100:103]
    v_mfma_f32_16x16x32_bf16 v[84:87], v[112:115], v[152:155], v[84:87]
    ds_read_b128 v[112:115], v66 offset:2752
    s_waitcnt lgkmcnt(2)
    v_mfma_f32_16x16x32_bf16 v[104:107], v[116:119], v[168:171], v[104:107]
    v_mfma_f32_16x16x32_bf16 v[100:103], v[116:119], v[164:167], v[100:103]
    ds_read_b128 v[116:119], v66 offset:3264
    s_waitcnt lgkmcnt(2)
    v_mfma_f32_16x16x32_bf16 v[104:107], v[108:111], v[164:167], v[104:107]
    v_mfma_f32_16x16x32_bf16 v[100:103], v[108:111], v[160:163], v[100:103]
    ds_read_b128 v[108:111], v66 offset:3776
    s_waitcnt lgkmcnt(2)
    v_mfma_f32_16x16x32_bf16 v[104:107], v[112:115], v[160:163], v[104:107]
    v_mfma_f32_16x16x32_bf16 v[100:103], v[112:115], v[156:159], v[100:103]
    s_waitcnt lgkmcnt(1)
    v_mfma_f32_16x16x32_bf16 v[104:107], v[116:119], v[156:159], v[104:107]
    v_mfma_f32_16x16x32_bf16 v[100:103], v[116:119], v[152:155], v[100:103]
    s_waitcnt lgkmcnt(0)
    v_mfma_f32_16x16x32_bf16 v[104:107], v[108:111], v[152:155], v[104:107]
    ds_write_b128 v74, v[84:87] offset:2048
    s_nop 4
    ds_write_b128 v74, v[100:103] offset:6144
    s_nop 0
    ds_write_b128 v74, v[104:107] offset:7168
    s_branch c_pw_end_51
c_pw_53:
    s_cmp_lg_u32 s34, 2
    s_cbranch_scc1 c_pw_54
    ds_read_b128 v[108:111], v66 offset:256
    ds_read_b128 v[120:123], v67 offset:224
    ds_read_b128 v[124:127], v67 offset:736
    ds_read_b128 v[128:131], v67 offset:1248
    ds_read_b128 v[132:135], v67 offset:1760
    ds_read_b128 v[136:139], v67 offset:2272
    ds_read_b128 v[140:143], v67 offset:2784
    ds_read_b128 v[144:147], v67 offset:3296
    ds_read_b128 v[148:151], v67 offset:3808
    ds_read_b128 v[112:115], v66 offset:768
    ds_read_b128 v[116:119], v66 offset:1280
    s_waitcnt lgkmcnt(2)
    v_mfma_f32_16x16x32_bf16 v[104:107], v[108:111], v[148:151], 0
    v_mfma_f32_16x16x32_bf16 v[100:103], v[108:111], v[144:147], 0
    v_mfma_f32_16x16x32_bf16 v[84:87], v[108:111], v[128:131], 0
    ds_read_b128 v[108:111], v66 offset:1792
    s_waitcnt lgkmcnt(2)
    v_mfma_f32_16x16x32_bf16 v[104:107], v[112:115], v[144:147], v[104:107]
    v_mfma_f32_16x16x32_bf16 v[100:103], v[112:115], v[140:143], v[100:103]
    v_mfma_f32_16x16x32_bf16 v[84:87], v[112:115], v[124:127], v[84:87]
    ds_read_b128 v[112:115], v66 offset:2304
    ds_read_b128 v[152:155], v67 offset:160
    ds_read_b128 v[156:159], v67 offset:672
    ds_read_b128 v[160:163], v67 offset:1184
    ds_read_b128 v[164:167], v67 offset:1696
    ds_read_b128 v[168:171], v67 offset:2208
    ds_read_b128 v[172:175], v67 offset:2720
    ds_read_b128 v[176:179], v67 offset:3232
    ds_read_b128 v[180:183], v67 offset:3744
    s_waitcnt lgkmcnt(10)
    v_mfma_f32_16x16x32_bf16 v[104:107], v[116:119], v[140:143], v[104:107]
    v_mfma_f32_16x16x32_bf16 v[100:103], v[116:119], v[136:139], v[100:103]
    v_mfma_f32_16x16x32_bf16 v[84:87], v[116:119], v[120:123], v[84:87]
    ds_read_b128 v[116:119], v66 offset:2816
    s_waitcnt lgkmcnt(10)
    v_mfma_f32_16x16x32_bf16 v[104:107], v[108:111], v[136:139], v[104:107]
    v_mfma_f32_16x16x32_bf16 v[100:103], v[108:111], v[132:135], v[100:103]
    ds_read_b128 v[108:111], v66 offset:3328
    s_waitcnt lgkmcnt(10)
    v_mfma_f32_16x16x32_bf16 v[104:107], v[112:115], v[132:135], v[104:107]
    v_mfma_f32_16x16x32_bf16 v[100:103], v[112:115], v[128:131], v[100:103]
    ds_read_b128 v[112:115], v66 offset:3840
    s_waitcnt lgkmcnt(2)
    v_mfma_f32_16x16x32_bf16 v[104:107], v[116:119], v[128:131], v[104:107]
    v_mfma_f32_16x16x32_bf16 v[100:103], v[116:119], v[124:127], v[100:103]
    ds_read_b128 v[116:119], v66 offset:320
    s_waitcnt lgkmcnt(2)
    v_mfma_f32_16x16x32_bf16 v[104:107], v[108:111], v[124:127], v[104:107]
    v_mfma_f32_16x16x32_bf16 v[100:103], v[108:111], v[120:123], v[100:103]
    ds_read_b128 v[108:111], v66 offset:832
    s_waitcnt lgkmcnt(2)
    v_mfma_f32_16x16x32_bf16 v[104:107], v[112:115], v[120:123], v[104:107]
    ds_read_b128 v[112:115], v66 offset:1344
    s_waitcnt lgkmcnt(2)
    v_mfma_f32_16x16x32_bf16 v[104:107], v[116:119], v[180:183], v[104:107]
    v_mfma_f32_16x16x32_bf16 v[100:103], v[116:119], v[176:179], v[100:103]
    v_mfma_f32_16x16x32_bf16 v[84:87], v[116:119], v[160:163], v[84:87]
    ds_read_b128 v[116:119], v66 offset:1856
    s_waitcnt lgkmcnt(2)
    v_mfma_f32_16x16x32_bf16 v[104:107], v[108:111], v[176:179], v[104:107]
    v_mfma_f32_16x16x32_bf16 v[100:103], v[108:111], v[172:175], v[100:103]
    v_mfma_f32_16x16x32_bf16 v[84:87], v[108:111], v[156:159], v[84:87]
    ds_read_b128 v[108:111], v66 offset:2368
    s_waitcnt lgkmcnt(2)
    v_mfma_f32_16x16x32_bf16 v[104:107], v[112:115], v[172:175], v[104:107]
    v_mfma_f32_16x16x32_bf16 v[100:103], v[112:115], v[168:171], v[100:103]
    v_mfma_f32_16x16x32_bf16 v[84:87], v[112:115], v[152:155], v[84:87]
    ds_read_b128 v[112:115], v66 offset:2880
    s_waitcnt lgkmcnt(2)
    v_mfma_f32_16x16x32_bf16 v[104:107], v[116:119], v[168:171], v[104:107]
    v_mfma_f32_16x16x32_bf16 v[100:103], v[116:119], v[164:167], v[100:103]
    ds_read_b128 v[116:119], v66 offset:3392
    s_waitcnt lgkmcnt(2)
    v_mfma_f32_16x16x32_bf16 v[104:107], v[108:111], v[164:167], v[104:107]
    v_mfma_f32_16x16x32_bf16 v[100:103], v[108:111], v[160:163], v[100:103]
    ds_read_b128 v[108:111], v66 offset:3904
    s_waitcnt lgkmcnt(2)
    v_mfma_f32_16x16x32_bf16 v[104:107], v[112:115], v[160:163], v[104:107]
    v_mfma_f32_16x16x32_bf16 v[100:103], v[112:115], v[156:159], v[100:103]
    s_waitcnt lgkmcnt(1)
    v_mfma_f32_16x16x32_bf16 v[104:107], v[116:119], v[156:159], v[104:107]
    v_mfma_f32_16x16x32_bf16 v[100:103], v[116:119], v[152:155], v[100:103]
    s_waitcnt lgkmcnt(0)
    v_mfma_f32_16x16x32_bf16 v[104:107], v[108:111], v[152:155], v[104:107]
    ds_write_b128 v74, v[84:87] offset:2048
    s_nop 4
    ds_write_b128 v74, v[100:103] offset:6144
    s_nop 0
    ds_write_b128 v74, v[104:107] offset:7168
    s_branch c_pw_end_51
c_pw_54:
    ds_read_b128 v[108:111], v66 offset:384
    ds_read_b128 v[120:123], v67 offset:96
    ds_read_b128 v[124:127], v67 offset:608
    ds_read_b128 v[128:131], v67 offset:1120
    ds_read_b128 v[132:135], v67 offset:1632
    ds_read_b128 v[136:139], v67 offset:2144
    ds_read_b128 v[140:143], v67 offset:2656
    ds_read_b128 v[144:147], v67 offset:3168
    ds_read_b128 v[148:151], v67 offset:3680
    ds_read_b128 v[112:115], v66 offset:896
    ds_read_b128 v[116:119], v66 offset:1408
    s_waitcnt lgkmcnt(2)
    v_mfma_f32_16x16x32_bf16 v[104:107], v[108:111], v[148:151], 0
    v_mfma_f32_16x16x32_bf16 v[100:103], v[108:111], v[144:147], 0
    v_mfma_f32_16x16x32_bf16 v[84:87], v[108:111], v[128:131], 0
    ds_read_b128 v[108:111], v66 offset:1920
    s_waitcnt lgkmcnt(2)
    v_mfma_f32_16x16x32_bf16 v[104:107], v[112:115], v[144:147], v[104:107]
    v_mfma_f32_16x16x32_bf16 v[100:103], v[112:115], v[140:143], v[100:103]
    v_mfma_f32_16x16x32_bf16 v[84:87], v[112:115], v[124:127], v[84:87]
    ds_read_b128 v[112:115], v66 offset:2432
    ds_read_b128 v[152:155], v67 offset:32
    ds_read_b128 v[156:159], v67 offset:544
    ds_read_b128 v[160:163], v67 offset:1056
    ds_read_b128 v[164:167], v67 offset:1568
    ds_read_b128 v[168:171], v67 offset:2080
    ds_read_b128 v[172:175], v67 offset:2592
    ds_read_b128 v[176:179], v67 offset:3104
    ds_read_b128 v[180:183], v67 offset:3616
    s_waitcnt lgkmcnt(10)
    v_mfma_f32_16x16x32_bf16 v[104:107], v[116:119], v[140:143], v[104:107]
    v_mfma_f32_16x16x32_bf16 v[100:103], v[116:119], v[136:139], v[100:103]
    v_mfma_f32_16x16x32_bf16 v[84:87], v[116:119], v[120:123], v[84:87]
    ds_read_b128 v[116:119], v66 offset:2944
    s_waitcnt lgkmcnt(10)
    v_mfma_f32_16x16x32_bf16 v[104:107], v[108:111], v[136:139], v[104:107]
    v_mfma_f32_16x16x32_bf16 v[100:103], v[108:111], v[132:135], v[100:103]
    ds_read_b128 v[108:111], v66 offset:3456
    s_waitcnt lgkmcnt(10)
    v_mfma_f32_16x16x32_bf16 v[104:107], v[112:115], v[132:135], v[104:107]
    v_mfma_f32_16x16x32_bf16 v[100:103], v[112:115], v[128:131], v[100:103]
    ds_read_b128 v[112:115], v66 offset:3968
    s_waitcnt lgkmcnt(2)
    v_mfma_f32_16x16x32_bf16 v[104:107], v[116:119], v[128:131], v[104:107]
    v_mfma_f32_16x16x32_bf16 v[100:103], v[116:119], v[124:127], v[100:103]
    ds_read_b128 v[116:119], v66 offset:448
    s_waitcnt lgkmcnt(2)
    v_mfma_f32_16x16x32_bf16 v[104:107], v[108:111], v[124:127], v[104:107]
    v_mfma_f32_16x16x32_bf16 v[100:103], v[108:111], v[120:123], v[100:103]
    ds_read_b128 v[108:111], v66 offset:960
    s_waitcnt lgkmcnt(2)
    v_mfma_f32_16x16x32_bf16 v[104:107], v[112:115], v[120:123], v[104:107]
    ds_read_b128 v[112:115], v66 offset:1472
    s_waitcnt lgkmcnt(2)
    v_mfma_f32_16x16x32_bf16 v[104:107], v[116:119], v[180:183], v[104:107]
    v_mfma_f32_16x16x32_bf16 v[100:103], v[116:119], v[176:179], v[100:103]
    v_mfma_f32_16x16x32_bf16 v[84:87], v[116:119], v[160:163], v[84:87]
    ds_read_b128 v[116:119], v66 offset:1984
    s_waitcnt lgkmcnt(2)
    v_mfma_f32_16x16x32_bf16 v[104:107], v[108:111], v[176:179], v[104:107]
    v_mfma_f32_16x16x32_bf16 v[100:103], v[108:111], v[172:175], v[100:103]
    v_mfma_f32_16x16x32_bf16 v[84:87], v[108:111], v[156:159], v[84:87]
    ds_read_b128 v[108:111], v66 offset:2496
    s_waitcnt lgkmcnt(2)
    v_mfma_f32_16x16x32_bf16 v[104:107], v[112:115], v[172:175], v[104:107]
    v_mfma_f32_16x16x32_bf16 v[100:103], v[112:115], v[168:171], v[100:103]
    v_mfma_f32_16x16x32_bf16 v[84:87], v[112:115], v[152:155], v[84:87]
    ds_read_b128 v[112:115], v66 offset:3008
    s_waitcnt lgkmcnt(2)
    v_mfma_f32_16x16x32_bf16 v[104:107], v[116:119], v[168:171], v[104:107]
    v_mfma_f32_16x16x32_bf16 v[100:103], v[116:119], v[164:167], v[100:103]
    ds_read_b128 v[116:119], v66 offset:3520
    s_waitcnt lgkmcnt(2)
    v_mfma_f32_16x16x32_bf16 v[104:107], v[108:111], v[164:167], v[104:107]
    v_mfma_f32_16x16x32_bf16 v[100:103], v[108:111], v[160:163], v[100:103]
    ds_read_b128 v[108:111], v66 offset:4032
    s_waitcnt lgkmcnt(2)
    v_mfma_f32_16x16x32_bf16 v[104:107], v[112:115], v[160:163], v[104:107]
    v_mfma_f32_16x16x32_bf16 v[100:103], v[112:115], v[156:159], v[100:103]
    s_waitcnt lgkmcnt(1)
    v_mfma_f32_16x16x32_bf16 v[104:107], v[116:119], v[156:159], v[104:107]
    v_mfma_f32_16x16x32_bf16 v[100:103], v[116:119], v[152:155], v[100:103]
    s_waitcnt lgkmcnt(0)
    v_mfma_f32_16x16x32_bf16 v[104:107], v[108:111], v[152:155], v[104:107]
    ds_write_b128 v74, v[84:87] offset:2048
    s_nop 4
    ds_write_b128 v74, v[100:103] offset:6144
    s_nop 0
    ds_write_b128 v74, v[104:107] offset:7168
c_pw_end_51:
    s_waitcnt lgkmcnt(0)
    v_mov_b32 v3, 161796
    v_mov_b32 v4, 1
    s_mov_b64 exec, 1
    ds_add_u32 v3, v4
    s_mov_b64 exec, -1
    s_mov_b32 s67, 0
gsync_56:
    ds_read_b32 v4, v3
    s_add_u32 s67, s67, 1
    s_waitcnt lgkmcnt(0)
    v_readfirstlane_b32 s66, v4
    s_cmp_gt_u32 s67, 1000000
    s_cbranch_scc1 gsync_e_57
    s_cmp_lt_u32 s66, 24
    s_cbranch_scc1 gsync_56
gsync_e_57:
    s_mov_b64 exec, 0
    s_cmp_eq_u32 s34, 0
    s_cselect_b32 exec_lo, 0, exec_lo
    s_cselect_b32 exec_hi, 0, exec_hi
    s_cmp_eq_u32 s34, 1
    s_cselect_b32 exec_lo, -1, exec_lo
    s_cselect_b32 exec_hi, 0, exec_hi
    s_cmp_eq_u32 s34, 2
    s_cselect_b32 exec_lo, 0, exec_lo
    s_cselect_b32 exec_hi, 0, exec_hi
    s_cmp_eq_u32 s34, 3
    s_cselect_b32 exec_lo, -1, exec_lo
    s_cselect_b32 exec_hi, -1, exec_hi
    s_cbranch_execz c_fskip_59
    ds_read_b128 v[120:123], v75 offset:0
    ds_read_b128 v[124:127], v75 offset:16
    ds_read_b128 v[128:131], v75 offset:8192
    ds_read_b128 v[132:135], v75 offset:8208
    ds_read_b128 v[136:139], v75 offset:16384
    ds_read_b128 v[140:143], v75 offset:16400
    ds_read_b128 v[144:147], v75 offset:24576
    ds_read_b128 v[148:151], v75 offset:24592
    s_lshl_b32 s40, s58, 12
    s_add_u32 s40, s40, 8912896
    s_waitcnt lgkmcnt(0)
    v_pk_add_f32 v[120:121], v[120:121], v[128:129]
    v_pk_add_f32 v[136:137], v[136:137], v[144:145]
    v_pk_add_f32 v[122:123], v[122:123], v[130:131]
    v_pk_add_f32 v[138:139], v[138:139], v[146:147]
    v_pk_add_f32 v[124:125], v[124:125], v[132:133]
    v_pk_add_f32 v[140:141], v[140:141], v[148:149]
    v_pk_add_f32 v[126:127], v[126:127], v[134:135]
    v_pk_add_f32 v[142:143], v[142:143], v[150:151]
    v_pk_add_f32 v[120:121], v[120:121], v[136:137]
    v_pk_add_f32 v[122:123], v[122:123], v[138:139]
    v_pk_add_f32 v[124:125], v[124:125], v[140:141]
    v_pk_add_f32 v[126:127], v[126:127], v[142:143]
    v_cvt_pk_bf16_f32 v192, v120, v121
    v_cvt_pk_bf16_f32 v193, v122, v123
    v_cvt_pk_bf16_f32 v194, v124, v125
    v_cvt_pk_bf16_f32 v195, v126, v127
    buffer_store_dwordx4 v[192:195], v2, s[8:11], s40 offen sc1
c_fskip_59:
    s_mov_b64 exec, -1
    s_nop 1
    s_branch c_halfE_50
c_halfB_49:
    s_cmp_lg_u32 s34, 0
    s_cbranch_scc1 c_pw_61
    ds_read_b128 v[108:111], v66 offset:0
    ds_read_b128 v[120:123], v67 offset:480
    ds_read_b128 v[124:127], v67 offset:992
    ds_read_b128 v[128:131], v67 offset:1504
    ds_read_b128 v[132:135], v67 offset:2016
    ds_read_b128 v[136:139], v67 offset:2528
    ds_read_b128 v[140:143], v67 offset:3040
    ds_read_b128 v[112:115], v66 offset:512
    ds_read_b128 v[116:119], v66 offset:1024
    s_waitcnt lgkmcnt(2)
    v_mfma_f32_16x16x32_bf16 v[96:99], v[108:111], v[140:143], 0
    v_mfma_f32_16x16x32_bf16 v[92:95], v[108:111], v[136:139], 0
    v_mfma_f32_16x16x32_bf16 v[88:91], v[108:111], v[132:135], 0
    v_mfma_f32_16x16x32_bf16 v[80:83], v[108:111], v[124:127], 0
    v_mfma_f32_16x16x32_bf16 v[76:79], v[108:111], v[120:123], 0
    v_mfma_f32_16x16x32_bf16 v[76:79], v[196:199], v[120:123], v[76:79]
    v_mfma_f32_16x16x32_bf16 v[80:83], v[196:199], v[124:127], v[80:83]
    v_mfma_f32_16x16x32_bf16 v[88:91], v[196:199], v[132:135], v[88:91]
    v_mfma_f32_16x16x32_bf16 v[92:95], v[196:199], v[136:139], v[92:95]
    v_mfma_f32_16x16x32_bf16 v[96:99], v[196:199], v[140:143], v[96:99]
    ds_read_b128 v[108:111], v66 offset:1536
    s_waitcnt lgkmcnt(2)
    v_mfma_f32_16x16x32_bf16 v[96:99], v[112:115], v[136:139], v[96:99]
    v_mfma_f32_16x16x32_bf16 v[92:95], v[112:115], v[132:135], v[92:95]
    v_mfma_f32_16x16x32_bf16 v[88:91], v[112:115], v[128:131], v[88:91]
    v_mfma_f32_16x16x32_bf16 v[80:83], v[112:115], v[120:123], v[80:83]
    ds_read_b128 v[112:115], v66 offset:2048
    ds_read_b128 v[152:155], v67 offset:416
    ds_read_b128 v[156:159], v67 offset:928
    ds_read_b128 v[160:163], v67 offset:1440
    ds_read_b128 v[164:167], v67 offset:1952
    ds_read_b128 v[168:171], v67 offset:2464
    ds_read_b128 v[172:175], v67 offset:2976
    s_waitcnt lgkmcnt(8)
    v_mfma_f32_16x16x32_bf16 v[96:99], v[116:119], v[132:135], v[96:99]
    v_mfma_f32_16x16x32_bf16 v[92:95], v[116:119], v[128:131], v[92:95]
    v_mfma_f32_16x16x32_bf16 v[88:91], v[116:119], v[124:127], v[88:91]
    ds_read_b128 v[116:119], v66 offset:2560
    s_waitcnt lgkmcnt(8)
    v_mfma_f32_16x16x32_bf16 v[96:99], v[108:111], v[128:131], v[96:99]
    v_mfma_f32_16x16x32_bf16 v[92:95], v[108:111], v[124:127], v[92:95]
    v_mfma_f32_16x16x32_bf16 v[88:91], v[108:111], v[120:123], v[88:91]
    ds_read_b128 v[108:111], v66 offset:64
    s_waitcnt lgkmcnt(8)
    v_mfma_f32_16x16x32_bf16 v[96:99], v[112:115], v[124:127], v[96:99]
    v_mfma_f32_16x16x32_bf16 v[92:95], v[112:115], v[120:123], v[92:95]
    ds_read_b128 v[112:115], v66 offset:576
    s_waitcnt lgkmcnt(2)
    v_mfma_f32_16x16x32_bf16 v[96:99], v[116:119], v[120:123], v[96:99]
    ds_read_b128 v[116:119], v66 offset:1088
    s_waitcnt lgkmcnt(2)
    v_mfma_f32_16x16x32_bf16 v[96:99], v[108:111], v[172:175], v[96:99]
    v_mfma_f32_16x16x32_bf16 v[92:95], v[108:111], v[168:171], v[92:95]
    v_mfma_f32_16x16x32_bf16 v[88:91], v[108:111], v[164:167], v[88:91]
    v_mfma_f32_16x16x32_bf16 v[80:83], v[108:111], v[156:159], v[80:83]
    v_mfma_f32_16x16x32_bf16 v[76:79], v[108:111], v[152:155], v[76:79]
    ds_read_b128 v[108:111], v66 offset:1600
    s_waitcnt lgkmcnt(2)
    v_mfma_f32_16x16x32_bf16 v[96:99], v[112:115], v[168:171], v[96:99]
    v_mfma_f32_16x16x32_bf16 v[92:95], v[112:115], v[164:167], v[92:95]
    v_mfma_f32_16x16x32_bf16 v[88:91], v[112:115], v[160:163], v[88:91]
    v_mfma_f32_16x16x32_bf16 v[80:83], v[112:115], v[152:155], v[80:83]
    ds_read_b128 v[112:115], v66 offset:2112
    s_waitcnt lgkmcnt(2)
    v_mfma_f32_16x16x32_bf16 v[96:99], v[116:119], v[164:167], v[96:99]
    v_mfma_f32_16x16x32_bf16 v[92:95], v[116:119], v[160:163], v[92:95]
    v_mfma_f32_16x16x32_bf16 v[88:91], v[116:119], v[156:159], v[88:91]
    ds_read_b128 v[116:119], v66 offset:2624
    s_waitcnt lgkmcnt(2)
    v_mfma_f32_16x16x32_bf16 v[96:99], v[108:111], v[160:163], v[96:99]
    v_mfma_f32_16x16x32_bf16 v[92:95], v[108:111], v[156:159], v[92:95]
    v_mfma_f32_16x16x32_bf16 v[88:91], v[108:111], v[152:155], v[88:91]
    s_waitcnt lgkmcnt(1)
    v_mfma_f32_16x16x32_bf16 v[96:99], v[112:115], v[156:159], v[96:99]
    v_mfma_f32_16x16x32_bf16 v[92:95], v[112:115], v[152:155], v[92:95]
    s_waitcnt lgkmcnt(0)
    v_mfma_f32_16x16x32_bf16 v[96:99], v[116:119], v[152:155], v[96:99]
    ds_write_b128 v74, v[76:79] offset:0
    ds_write_b128 v74, v[80:83] offset:1024
    s_nop 0
    ds_write_b128 v74, v[88:91] offset:3072
    s_nop 1
    ds_write_b128 v74, v[92:95] offset:4096
    s_nop 0
    ds_write_b128 v74, v[96:99] offset:5120
    s_branch c_pw_end_60
c_pw_61:
    s_cmp_lg_u32 s34, 1
    s_cbranch_scc1 c_pw_62
    ds_read_b128 v[108:111], v66 offset:128
    ds_read_b128 v[120:123], v67 offset:352
    ds_read_b128 v[124:127], v67 offset:864
    ds_read_b128 v[128:131], v67 offset:1376
    ds_read_b128 v[132:135], v67 offset:1888
    ds_read_b128 v[136:139], v67 offset:2400
    ds_read_b128 v[140:143], v67 offset:2912
    ds_read_b128 v[112:115], v66 offset:640
    ds_read_b128 v[116:119], v66 offset:1152
    s_waitcnt lgkmcnt(2)
    v_mfma_f32_16x16x32_bf16 v[96:99], v[108:111], v[140:143], 0
    v_mfma_f32_16x16x32_bf16 v[92:95], v[108:111], v[136:139], 0
    v_mfma_f32_16x16x32_bf16 v[88:91], v[108:111], v[132:135], 0
    v_mfma_f32_16x16x32_bf16 v[80:83], v[108:111], v[124:127], 0
    v_mfma_f32_16x16x32_bf16 v[76:79], v[108:111], v[120:123], 0
    ds_read_b128 v[108:111], v66 offset:1664
    s_waitcnt lgkmcnt(2)
    v_mfma_f32_16x16x32_bf16 v[96:99], v[112:115], v[136:139], v[96:99]
    v_mfma_f32_16x16x32_bf16 v[92:95], v[112:115], v[132:135], v[92:95]
    v_mfma_f32_16x16x32_bf16 v[88:91], v[112:115], v[128:131], v[88:91]
    v_mfma_f32_16x16x32_bf16 v[80:83], v[112:115], v[120:123], v[80:83]
    ds_read_b128 v[112:115], v66 offset:2176
    ds_read_b128 v[152:155], v67 offset:288
    ds_read_b128 v[156:159], v67 offset:800
    ds_read_b128 v[160:163], v67 offset:1312
    ds_read_b128 v[164:167], v67 offset:1824
    ds_read_b128 v[168:171], v67 offset:2336
    ds_read_b128 v[172:175], v67 offset:2848
    s_waitcnt lgkmcnt(8)
    v_mfma_f32_16x16x32_bf16 v[96:99], v[116:119], v[132:135], v[96:99]
    v_mfma_f32_16x16x32_bf16 v[92:95], v[116:119], v[128:131], v[92:95]
    v_mfma_f32_16x16x32_bf16 v[88:91], v[116:119], v[124:127], v[88:91]
    ds_read_b128 v[116:119], v66 offset:2688
    s_waitcnt lgkmcnt(8)
    v_mfma_f32_16x16x32_bf16 v[96:99], v[108:111], v[128:131], v[96:99]
    v_mfma_f32_16x16x32_bf16 v[92:95], v[108:111], v[124:127], v[92:95]
    v_mfma_f32_16x16x32_bf16 v[88:91], v[108:111], v[120:123], v[88:91]
    ds_read_b128 v[108:111], v66 offset:192
    s_waitcnt lgkmcnt(8)
    v_mfma_f32_16x16x32_bf16 v[96:99], v[112:115], v[124:127], v[96:99]
    v_mfma_f32_16x16x32_bf16 v[92:95], v[112:115], v[120:123], v[92:95]
    ds_read_b128 v[112:115], v66 offset:704
    s_waitcnt lgkmcnt(2)
    v_mfma_f32_16x16x32_bf16 v[96:99], v[116:119], v[120:123], v[96:99]
    ds_read_b128 v[116:119], v66 offset:1216
    s_waitcnt lgkmcnt(2)
    v_mfma_f32_16x16x32_bf16 v[96:99], v[108:111], v[172:175], v[96:99]
    v_mfma_f32_16x16x32_bf16 v[92:95], v[108:111], v[168:171], v[92:95]
    v_mfma_f32_16x16x32_bf16 v[88:91], v[108:111], v[164:167], v[88:91]
    v_mfma_f32_16x16x32_bf16 v[80:83], v[108:111], v[156:159], v[80:83]
    v_mfma_f32_16x16x32_bf16 v[76:79], v[108:111], v[152:155], v[76:79]
    ds_read_b128 v[108:111], v66 offset:1728
    s_waitcnt lgkmcnt(2)
    v_mfma_f32_16x16x32_bf16 v[96:99], v[112:115], v[168:171], v[96:99]
    v_mfma_f32_16x16x32_bf16 v[92:95], v[112:115], v[164:167], v[92:95]
    v_mfma_f32_16x16x32_bf16 v[88:91], v[112:115], v[160:163], v[88:91]
    v_mfma_f32_16x16x32_bf16 v[80:83], v[112:115], v[152:155], v[80:83]
    ds_read_b128 v[112:115], v66 offset:2240
    s_waitcnt lgkmcnt(2)
    v_mfma_f32_16x16x32_bf16 v[96:99], v[116:119], v[164:167], v[96:99]
    v_mfma_f32_16x16x32_bf16 v[92:95], v[116:119], v[160:163], v[92:95]
    v_mfma_f32_16x16x32_bf16 v[88:91], v[116:119], v[156:159], v[88:91]
    ds_read_b128 v[116:119], v66 offset:2752
    s_waitcnt lgkmcnt(2)
    v_mfma_f32_16x16x32_bf16 v[96:99], v[108:111], v[160:163], v[96:99]
    v_mfma_f32_16x16x32_bf16 v[92:95], v[108:111], v[156:159], v[92:95]
    v_mfma_f32_16x16x32_bf16 v[88:91], v[108:111], v[152:155], v[88:91]
    s_waitcnt lgkmcnt(1)
    v_mfma_f32_16x16x32_bf16 v[96:99], v[112:115], v[156:159], v[96:99]
    v_mfma_f32_16x16x32_bf16 v[92:95], v[112:115], v[152:155], v[92:95]
    s_waitcnt lgkmcnt(0)
    v_mfma_f32_16x16x32_bf16 v[96:99], v[116:119], v[152:155], v[96:99]
    ds_write_b128 v74, v[76:79] offset:0
    ds_write_b128 v74, v[80:83] offset:1024
    s_nop 0
    ds_write_b128 v74, v[88:91] offset:3072
    s_nop 1
    ds_write_b128 v74, v[92:95] offset:4096
    s_nop 0
    ds_write_b128 v74, v[96:99] offset:5120
    s_branch c_pw_end_60
c_pw_62:
    s_cmp_lg_u32 s34, 2
    s_cbranch_scc1 c_pw_63
    ds_read_b128 v[108:111], v66 offset:256
    ds_read_b128 v[120:123], v67 offset:224
    ds_read_b128 v[124:127], v67 offset:736
    ds_read_b128 v[128:131], v67 offset:1248
    ds_read_b128 v[132:135], v67 offset:1760
    ds_read_b128 v[136:139], v67 offset:2272
    ds_read_b128 v[140:143], v67 offset:2784
    ds_read_b128 v[112:115], v66 offset:768
    ds_read_b128 v[116:119], v66 offset:1280
    s_waitcnt lgkmcnt(2)
    v_mfma_f32_16x16x32_bf16 v[96:99], v[108:111], v[140:143], 0
    v_mfma_f32_16x16x32_bf16 v[92:95], v[108:111], v[136:139], 0
    v_mfma_f32_16x16x32_bf16 v[88:91], v[108:111], v[132:135], 0
    v_mfma_f32_16x16x32_bf16 v[80:83], v[108:111], v[124:127], 0
    v_mfma_f32_16x16x32_bf16 v[76:79], v[108:111], v[120:123], 0
    ds_read_b128 v[108:111], v66 offset:1792
    s_waitcnt lgkmcnt(2)
    v_mfma_f32_16x16x32_bf16 v[96:99], v[112:115], v[136:139], v[96:99]
    v_mfma_f32_16x16x32_bf16 v[92:95], v[112:115], v[132:135], v[92:95]
    v_mfma_f32_16x16x32_bf16 v[88:91], v[112:115], v[128:131], v[88:91]
    v_mfma_f32_16x16x32_bf16 v[80:83], v[112:115], v[120:123], v[80:83]
    ds_read_b128 v[112:115], v66 offset:2304
    ds_read_b128 v[152:155], v67 offset:160
    ds_read_b128 v[156:159], v67 offset:672
    ds_read_b128 v[160:163], v67 offset:1184
    ds_read_b128 v[164:167], v67 offset:1696
    ds_read_b128 v[168:171], v67 offset:2208
    ds_read_b128 v[172:175], v67 offset:2720
    s_waitcnt lgkmcnt(8)
    v_mfma_f32_16x16x32_bf16 v[96:99], v[116:119], v[132:135], v[96:99]
    v_mfma_f32_16x16x32_bf16 v[92:95], v[116:119], v[128:131], v[92:95]
    v_mfma_f32_16x16x32_bf16 v[88:91], v[116:119], v[124:127], v[88:91]
    ds_read_b128 v[116:119], v66 offset:2816
    s_waitcnt lgkmcnt(8)
    v_mfma_f32_16x16x32_bf16 v[96:99], v[108:111], v[128:131], v[96:99]
    v_mfma_f32_16x16x32_bf16 v[92:95], v[108:111], v[124:127], v[92:95]
    v_mfma_f32_16x16x32_bf16 v[88:91], v[108:111], v[120:123], v[88:91]
    ds_read_b128 v[108:111], v66 offset:320
    s_waitcnt lgkmcnt(8)
    v_mfma_f32_16x16x32_bf16 v[96:99], v[112:115], v[124:127], v[96:99]
    v_mfma_f32_16x16x32_bf16 v[92:95], v[112:115], v[120:123], v[92:95]
    ds_read_b128 v[112:115], v66 offset:832
    s_waitcnt lgkmcnt(2)
    v_mfma_f32_16x16x32_bf16 v[96:99], v[116:119], v[120:123], v[96:99]
    ds_read_b128 v[116:119], v66 offset:1344
    s_waitcnt lgkmcnt(2)
    v_mfma_f32_16x16x32_bf16 v[96:99], v[108:111], v[172:175], v[96:99]
    v_mfma_f32_16x16x32_bf16 v[92:95], v[108:111], v[168:171], v[92:95]
    v_mfma_f32_16x16x32_bf16 v[88:91], v[108:111], v[164:167], v[88:91]
    v_mfma_f32_16x16x32_bf16 v[80:83], v[108:111], v[156:159], v[80:83]
    v_mfma_f32_16x16x32_bf16 v[76:79], v[108:111], v[152:155], v[76:79]
    ds_read_b128 v[108:111], v66 offset:1856
    s_waitcnt lgkmcnt(2)
    v_mfma_f32_16x16x32_bf16 v[96:99], v[112:115], v[168:171], v[96:99]
    v_mfma_f32_16x16x32_bf16 v[92:95], v[112:115], v[164:167], v[92:95]
    v_mfma_f32_16x16x32_bf16 v[88:91], v[112:115], v[160:163], v[88:91]
    v_mfma_f32_16x16x32_bf16 v[80:83], v[112:115], v[152:155], v[80:83]
    ds_read_b128 v[112:115], v66 offset:2368
    s_waitcnt lgkmcnt(2)
    v_mfma_f32_16x16x32_bf16 v[96:99], v[116:119], v[164:167], v[96:99]
    v_mfma_f32_16x16x32_bf16 v[92:95], v[116:119], v[160:163], v[92:95]
    v_mfma_f32_16x16x32_bf16 v[88:91], v[116:119], v[156:159], v[88:91]
    ds_read_b128 v[116:119], v66 offset:2880
    s_waitcnt lgkmcnt(2)
    v_mfma_f32_16x16x32_bf16 v[96:99], v[108:111], v[160:163], v[96:99]
    v_mfma_f32_16x16x32_bf16 v[92:95], v[108:111], v[156:159], v[92:95]
    v_mfma_f32_16x16x32_bf16 v[88:91], v[108:111], v[152:155], v[88:91]
    s_waitcnt lgkmcnt(1)
    v_mfma_f32_16x16x32_bf16 v[96:99], v[112:115], v[156:159], v[96:99]
    v_mfma_f32_16x16x32_bf16 v[92:95], v[112:115], v[152:155], v[92:95]
    s_waitcnt lgkmcnt(0)
    v_mfma_f32_16x16x32_bf16 v[96:99], v[116:119], v[152:155], v[96:99]
    ds_write_b128 v74, v[76:79] offset:0
    ds_write_b128 v74, v[80:83] offset:1024
    s_nop 0
    ds_write_b128 v74, v[88:91] offset:3072
    s_nop 1
    ds_write_b128 v74, v[92:95] offset:4096
    s_nop 0
    ds_write_b128 v74, v[96:99] offset:5120
    s_branch c_pw_end_60
c_pw_63:
    ds_read_b128 v[108:111], v66 offset:384
    ds_read_b128 v[120:123], v67 offset:96
    ds_read_b128 v[124:127], v67 offset:608
    ds_read_b128 v[128:131], v67 offset:1120
    ds_read_b128 v[132:135], v67 offset:1632
    ds_read_b128 v[136:139], v67 offset:2144
    ds_read_b128 v[140:143], v67 offset:2656
    ds_read_b128 v[112:115], v66 offset:896
    ds_read_b128 v[116:119], v66 offset:1408
    s_waitcnt lgkmcnt(2)
    v_mfma_f32_16x16x32_bf16 v[96:99], v[108:111], v[140:143], 0
    v_mfma_f32_16x16x32_bf16 v[92:95], v[108:111], v[136:139], 0
    v_mfma_f32_16x16x32_bf16 v[88:91], v[108:111], v[132:135], 0
    v_mfma_f32_16x16x32_bf16 v[80:83], v[108:111], v[124:127], 0
    v_mfma_f32_16x16x32_bf16 v[76:79], v[108:111], v[120:123], 0
    ds_read_b128 v[108:111], v66 offset:1920
    s_waitcnt lgkmcnt(2)
    v_mfma_f32_16x16x32_bf16 v[96:99], v[112:115], v[136:139], v[96:99]
    v_mfma_f32_16x16x32_bf16 v[92:95], v[112:115], v[132:135], v[92:95]
    v_mfma_f32_16x16x32_bf16 v[88:91], v[112:115], v[128:131], v[88:91]
    v_mfma_f32_16x16x32_bf16 v[80:83], v[112:115], v[120:123], v[80:83]
    ds_read_b128 v[112:115], v66 offset:2432
    ds_read_b128 v[152:155], v67 offset:32
    ds_read_b128 v[156:159], v67 offset:544
    ds_read_b128 v[160:163], v67 offset:1056
    ds_read_b128 v[164:167], v67 offset:1568
    ds_read_b128 v[168:171], v67 offset:2080
    ds_read_b128 v[172:175], v67 offset:2592
    s_waitcnt lgkmcnt(8)
    v_mfma_f32_16x16x32_bf16 v[96:99], v[116:119], v[132:135], v[96:99]
    v_mfma_f32_16x16x32_bf16 v[92:95], v[116:119], v[128:131], v[92:95]
    v_mfma_f32_16x16x32_bf16 v[88:91], v[116:119], v[124:127], v[88:91]
    ds_read_b128 v[116:119], v66 offset:2944
    s_waitcnt lgkmcnt(8)
    v_mfma_f32_16x16x32_bf16 v[96:99], v[108:111], v[128:131], v[96:99]
    v_mfma_f32_16x16x32_bf16 v[92:95], v[108:111], v[124:127], v[92:95]
    v_mfma_f32_16x16x32_bf16 v[88:91], v[108:111], v[120:123], v[88:91]
    ds_read_b128 v[108:111], v66 offset:448
    s_waitcnt lgkmcnt(8)
    v_mfma_f32_16x16x32_bf16 v[96:99], v[112:115], v[124:127], v[96:99]
    v_mfma_f32_16x16x32_bf16 v[92:95], v[112:115], v[120:123], v[92:95]
    ds_read_b128 v[112:115], v66 offset:960
    s_waitcnt lgkmcnt(2)
    v_mfma_f32_16x16x32_bf16 v[96:99], v[116:119], v[120:123], v[96:99]
    ds_read_b128 v[116:119], v66 offset:1472
    s_waitcnt lgkmcnt(2)
    v_mfma_f32_16x16x32_bf16 v[96:99], v[108:111], v[172:175], v[96:99]
    v_mfma_f32_16x16x32_bf16 v[92:95], v[108:111], v[168:171], v[92:95]
    v_mfma_f32_16x16x32_bf16 v[88:91], v[108:111], v[164:167], v[88:91]
    v_mfma_f32_16x16x32_bf16 v[80:83], v[108:111], v[156:159], v[80:83]
    v_mfma_f32_16x16x32_bf16 v[76:79], v[108:111], v[152:155], v[76:79]
    ds_read_b128 v[108:111], v66 offset:1984
    s_waitcnt lgkmcnt(2)
    v_mfma_f32_16x16x32_bf16 v[96:99], v[112:115], v[168:171], v[96:99]
    v_mfma_f32_16x16x32_bf16 v[92:95], v[112:115], v[164:167], v[92:95]
    v_mfma_f32_16x16x32_bf16 v[88:91], v[112:115], v[160:163], v[88:91]
    v_mfma_f32_16x16x32_bf16 v[80:83], v[112:115], v[152:155], v[80:83]
    ds_read_b128 v[112:115], v66 offset:2496
    s_waitcnt lgkmcnt(2)
    v_mfma_f32_16x16x32_bf16 v[96:99], v[116:119], v[164:167], v[96:99]
    v_mfma_f32_16x16x32_bf16 v[92:95], v[116:119], v[160:163], v[92:95]
    v_mfma_f32_16x16x32_bf16 v[88:91], v[116:119], v[156:159], v[88:91]
    ds_read_b128 v[116:119], v66 offset:3008
    s_waitcnt lgkmcnt(2)
    v_mfma_f32_16x16x32_bf16 v[96:99], v[108:111], v[160:163], v[96:99]
    v_mfma_f32_16x16x32_bf16 v[92:95], v[108:111], v[156:159], v[92:95]
    v_mfma_f32_16x16x32_bf16 v[88:91], v[108:111], v[152:155], v[88:91]
    s_waitcnt lgkmcnt(1)
    v_mfma_f32_16x16x32_bf16 v[96:99], v[112:115], v[156:159], v[96:99]
    v_mfma_f32_16x16x32_bf16 v[92:95], v[112:115], v[152:155], v[92:95]
    s_waitcnt lgkmcnt(0)
    v_mfma_f32_16x16x32_bf16 v[96:99], v[116:119], v[152:155], v[96:99]
    ds_write_b128 v74, v[76:79] offset:0
    ds_write_b128 v74, v[80:83] offset:1024
    s_nop 0
    ds_write_b128 v74, v[88:91] offset:3072
    s_nop 1
    ds_write_b128 v74, v[92:95] offset:4096
    s_nop 0
    ds_write_b128 v74, v[96:99] offset:5120
c_pw_end_60:
    s_waitcnt lgkmcnt(0)
    v_mov_b32 v3, 161796
    v_mov_b32 v4, 1
    s_mov_b64 exec, 1
    ds_add_u32 v3, v4
    s_mov_b64 exec, -1
    s_mov_b32 s67, 0
gsync_65:
    ds_read_b32 v4, v3
    s_add_u32 s67, s67, 1
    s_waitcnt lgkmcnt(0)
    v_readfirstlane_b32 s66, v4
    s_cmp_gt_u32 s67, 1000000
    s_cbranch_scc1 gsync_e_66
    s_cmp_lt_u32 s66, 24
    s_cbranch_scc1 gsync_65
gsync_e_66:
    s_mov_b64 exec, 0
    s_cmp_eq_u32 s34, 0
    s_cselect_b32 exec_lo, -1, exec_lo
    s_cselect_b32 exec_hi, -1, exec_hi
    s_cmp_eq_u32 s34, 1
    s_cselect_b32 exec_lo, 0, exec_lo
    s_cselect_b32 exec_hi, -1, exec_hi
    s_cmp_eq_u32 s34, 2
    s_cselect_b32 exec_lo, -1, exec_lo
    s_cselect_b32 exec_hi, -1, exec_hi
    s_cmp_eq_u32 s34, 3
    s_cselect_b32 exec_lo, 0, exec_lo
    s_cselect_b32 exec_hi, 0, exec_hi
    s_cbranch_execz c_fskip_68
    ds_read_b128 v[120:123], v75 offset:0
    ds_read_b128 v[124:127], v75 offset:16
    ds_read_b128 v[128:131], v75 offset:8192
    ds_read_b128 v[132:135], v75 offset:8208
    ds_read_b128 v[136:139], v75 offset:16384
    ds_read_b128 v[140:143], v75 offset:16400
    ds_read_b128 v[144:147], v75 offset:24576
    ds_read_b128 v[148:151], v75 offset:24592
    s_lshl_b32 s40, s58, 12
    s_add_u32 s40, s40, 8912896
    s_waitcnt lgkmcnt(0)
    v_pk_add_f32 v[120:121], v[120:121], v[128:129]
    v_pk_add_f32 v[136:137], v[136:137], v[144:145]
    v_pk_add_f32 v[122:123], v[122:123], v[130:131]
    v_pk_add_f32 v[138:139], v[138:139], v[146:147]
    v_pk_add_f32 v[124:125], v[124:125], v[132:133]
    v_pk_add_f32 v[140:141], v[140:141], v[148:149]
    v_pk_add_f32 v[126:127], v[126:127], v[134:135]
    v_pk_add_f32 v[142:143], v[142:143], v[150:151]
    v_pk_add_f32 v[120:121], v[120:121], v[136:137]
    v_pk_add_f32 v[122:123], v[122:123], v[138:139]
    v_pk_add_f32 v[124:125], v[124:125], v[140:141]
    v_pk_add_f32 v[126:127], v[126:127], v[142:143]
    v_cvt_pk_bf16_f32 v192, v120, v121
    v_cvt_pk_bf16_f32 v193, v122, v123
    v_cvt_pk_bf16_f32 v194, v124, v125
    v_cvt_pk_bf16_f32 v195, v126, v127
    buffer_store_dwordx4 v[192:195], v2, s[8:11], s40 offen sc1
c_fskip_68:
    s_mov_b64 exec, -1
    s_nop 1
c_halfE_50:
k12_kernel_end:
    s_endpgm

.globl k3_kernel
.p2align 8
.type k3_kernel,@function
k3_kernel:
    s_cmp_ge_u32 s2, 256
    s_cbranch_scc1 k3_kernel_end
    s_load_dwordx2 s[12:13], s[0:1], 104
    s_load_dwordx2 s[8:9], s[0:1], 0
    s_load_dwordx2 s[16:17], s[0:1], 88
    s_mov_b32 s10, 2621440
    s_mov_b32 s11, 0x20000
    s_mov_b32 s14, 15990784
    s_mov_b32 s15, 0x20000
    s_mov_b32 s18, 2621440
    s_mov_b32 s19, 0x20000
    v_lshrrev_b32 v4, 6, v0
    v_and_b32 v1, 63, v0
    v_readfirstlane_b32 s34, v4
    v_lshlrev_b32 v7, 4, v1
    s_and_b32 s40, s2, 7
    s_lshr_b32 s41, s2, 3
    s_lshr_b32 s32, s40, 1
    s_lshl_b32 s32, s32, 3
    s_and_b32 s42, s41, 7
    s_add_u32 s32, s32, s42
    s_and_b32 s33, s40, 1
    s_lshl_b32 s33, s33, 2
    s_lshr_b32 s42, s41, 3
    s_add_u32 s33, s33, s42
    s_add_u32 s40, s32, s33
    s_mul_i32 s41, s40, 43
    s_lshr_b32 s41, s41, 8
    s_mul_i32 s41, s41, 6
    s_sub_u32 s48, s40, s41
    s_mul_i32 s46, s33, 122880
    s_add_u32 s46, s46, 15007744
    s_mul_i32 s40, s34, 5120
    s_add_u32 s46, s46, s40
    s_mul_i32 s47, s32, 98304
    s_mul_i32 s41, s34, 24576
    s_add_u32 s47, s47, s41
    s_add_u32 s47, s47, 11534336
    s_add_u32 s40, s48, 0
    s_sub_u32 s41, s40, 6
    s_cmp_ge_u32 s40, 6
    s_cselect_b32 s50, s41, s40
    s_add_u32 s40, s48, 1
    s_sub_u32 s41, s40, 6
    s_cmp_ge_u32 s40, 6
    s_cselect_b32 s51, s41, s40
    s_add_u32 s40, s48, 2
    s_sub_u32 s41, s40, 6
    s_cmp_ge_u32 s40, 6
    s_cselect_b32 s52, s41, s40
    s_add_u32 s40, s48, 3
    s_sub_u32 s41, s40, 6
    s_cmp_ge_u32 s40, 6
    s_cselect_b32 s53, s41, s40
    s_add_u32 s40, s48, 4
    s_sub_u32 s41, s40, 6
    s_cmp_ge_u32 s40, 6
    s_cselect_b32 s54, s41, s40
    s_add_u32 s40, s48, 5
    s_sub_u32 s41, s40, 6
    s_cmp_ge_u32 s40, 6
    s_cselect_b32 s55, s41, s40
    s_waitcnt lgkmcnt(0)
    s_mul_i32 s40, s50, 20480
    s_add_u32 s40, s40, s46
    s_add_u32 s40, s40, 0
    s_mul_i32 s41, s34, 5120
    s_add_u32 m0, s41, 0
    s_nop 0
    buffer_load_dwordx4 v7, s[12:15], s40 offen lds
    s_mul_i32 s40, s50, 20480
    s_add_u32 s40, s40, s46
    s_add_u32 s40, s40, 1024
    s_mul_i32 s41, s34, 5120
    s_add_u32 m0, s41, 1024
    s_nop 0
    buffer_load_dwordx4 v7, s[12:15], s40 offen lds
    s_mul_i32 s40, s50, 20480
    s_add_u32 s40, s40, s46
    s_add_u32 s40, s40, 2048
    s_mul_i32 s41, s34, 5120
    s_add_u32 m0, s41, 2048
    s_nop 0
    buffer_load_dwordx4 v7, s[12:15], s40 offen lds
    s_mul_i32 s40, s50, 20480
    s_add_u32 s40, s40, s46
    s_add_u32 s40, s40, 3072
    s_mul_i32 s41, s34, 5120
    s_add_u32 m0, s41, 3072
    s_nop 0
    buffer_load_dwordx4 v7, s[12:15], s40 offen lds
    s_mul_i32 s40, s50, 20480
    s_add_u32 s40, s40, s46
    s_add_u32 s40, s40, 4096
    s_mul_i32 s41, s34, 5120
    s_add_u32 m0, s41, 4096
    s_nop 0
    buffer_load_dwordx4 v7, s[12:15], s40 offen lds
    s_lshl_b32 s42, s50, 12
    s_add_u32 s42, s42, s47
    buffer_load_dwordx4 v[8:11], v7, s[12:15], s42 offen offset:0
    s_lshl_b32 s42, s50, 12
    s_add_u32 s42, s42, s47
    buffer_load_dwordx4 v[12:15], v7, s[12:15], s42 offen offset:1024
    s_lshl_b32 s42, s50, 12
    s_add_u32 s42, s42, s47
    buffer_load_dwordx4 v[16:19], v7, s[12:15], s42 offen offset:2048
    s_lshl_b32 s42, s50, 12
    s_add_u32 s42, s42, s47
    buffer_load_dwordx4 v[20:23], v7, s[12:15], s42 offen offset:3072
    s_barrier
    s_mul_i32 s40, s51, 20480
    s_add_u32 s40, s40, s46
    s_add_u32 s40, s40, 0
    s_mul_i32 s41, s34, 5120
    s_add_u32 m0, s41, 20480
    s_nop 0
    buffer_load_dwordx4 v7, s[12:15], s40 offen lds
    s_mul_i32 s40, s51, 20480
    s_add_u32 s40, s40, s46
    s_add_u32 s40, s40, 1024
    s_mul_i32 s41, s34, 5120
    s_add_u32 m0, s41, 21504
    s_nop 0
    buffer_load_dwordx4 v7, s[12:15], s40 offen lds
    s_mul_i32 s40, s51, 20480
    s_add_u32 s40, s40, s46
    s_add_u32 s40, s40, 2048
    s_mul_i32 s41, s34, 5120
    s_add_u32 m0, s41, 22528
    s_nop 0
    buffer_load_dwordx4 v7, s[12:15], s40 offen lds
    s_mul_i32 s40, s51, 20480
    s_add_u32 s40, s40, s46
    s_add_u32 s40, s40, 3072
    s_mul_i32 s41, s34, 5120
    s_add_u32 m0, s41, 23552
    s_nop 0
    buffer_load_dwordx4 v7, s[12:15], s40 offen lds
    s_mul_i32 s40, s51, 20480
    s_add_u32 s40, s40, s46
    s_add_u32 s40, s40, 4096
    s_mul_i32 s41, s34, 5120
    s_add_u32 m0, s41, 24576
    s_nop 0
    buffer_load_dwordx4 v7, s[12:15], s40 offen lds
    s_lshl_b32 s42, s51, 12
    s_add_u32 s42, s42, s47
    buffer_load_dwordx4 v[24:27], v7, s[12:15], s42 offen offset:0
    s_lshl_b32 s42, s51, 12
    s_add_u32 s42, s42, s47
    buffer_load_dwordx4 v[28:31], v7, s[12:15], s42 offen offset:1024
    s_lshl_b32 s42, s51, 12
    s_add_u32 s42, s42, s47
    buffer_load_dwordx4 v[32:35], v7, s[12:15], s42 offen offset:2048
    s_lshl_b32 s42, s51, 12
    s_add_u32 s42, s42, s47
    buffer_load_dwordx4 v[36:39], v7, s[12:15], s42 offen offset:3072
    s_mul_i32 s44, s33, 160
    s_mul_i32 s45, s32, 81920
    s_add_u32 s45, s45, s44
    v_add_u32 v4, 0, v1
    v_mul_u32_u24 v5, 6554, v4
    v_lshrrev_b32 v5, 16, v5
    v_mul_u32_u24 v6, 10, v5
    v_sub_u32 v4, v4, v6
    v_lshlrev_b32 v4, 4, v4
    v_mul_u32_u24 v5, 1280, v5
    v_add_u32 v104, v4, v5
    v_add_u32 v4, 64, v1
    v_mul_u32_u24 v5, 6554, v4
    v_lshrrev_b32 v5, 16, v5
    v_mul_u32_u24 v6, 10, v5
    v_sub_u32 v4, v4, v6
    v_lshlrev_b32 v4, 4, v4
    v_mul_u32_u24 v5, 1280, v5
    v_add_u32 v105, v4, v5
    v_add_u32 v4, 128, v1
    v_mul_u32_u24 v5, 6554, v4
    v_lshrrev_b32 v5, 16, v5
    v_mul_u32_u24 v6, 10, v5
    v_sub_u32 v4, v4, v6
    v_lshlrev_b32 v4, 4, v4
    v_mul_u32_u24 v5, 1280, v5
    v_add_u32 v106, v4, v5
    v_add_u32 v4, 192, v1
    v_mul_u32_u24 v5, 6554, v4
    v_lshrrev_b32 v5, 16, v5
    v_mul_u32_u24 v6, 10, v5
    v_sub_u32 v4, v4, v6
    v_lshlrev_b32 v4, 4, v4
    v_mul_u32_u24 v5, 1280, v5
    v_add_u32 v107, v4, v5
    v_add_u32 v4, 256, v1
    v_mul_u32_u24 v5, 6554, v4
    v_lshrrev_b32 v5, 16, v5
    v_mul_u32_u24 v6, 10, v5
    v_sub_u32 v4, v4, v6
    v_lshlrev_b32 v4, 4, v4
    v_mul_u32_u24 v5, 1280, v5
    v_add_u32 v108, v4, v5
    v_lshrrev_b32 v2, 4, v1
    v_and_b32 v3, 15, v1
    v_mov_b32 v113, v7
    v_add_u32 v114, 61440, v7
    s_waitcnt vmcnt(13)
    s_barrier
    ds_read_b128 v[136:139], v113 offset:0
    ds_read_b128 v[140:143], v113 offset:1024
    ds_read_b128 v[144:147], v113 offset:2048
    ds_read_b128 v[148:151], v113 offset:3072
    ds_read_b128 v[152:155], v113 offset:4096
    ds_read_b128 v[156:159], v113 offset:5120
    ds_read_b128 v[160:163], v113 offset:6144
    ds_read_b128 v[164:167], v113 offset:7168
    ds_read_b128 v[168:171], v113 offset:8192
    ds_read_b128 v[172:175], v113 offset:9216
    s_waitcnt vmcnt(12)
    s_waitcnt lgkmcnt(9)
    v_mfma_f32_16x16x32_bf16 v[116:119], v[136:139], v[8:11], 0
    s_mul_i32 s40, s52, 20480
    s_add_u32 s40, s40, s46
    s_add_u32 s40, s40, 0
    s_mul_i32 s41, s34, 5120
    s_add_u32 m0, s41, 40960
    s_nop 0
    buffer_load_dwordx4 v7, s[12:15], s40 offen lds
    s_waitcnt lgkmcnt(8)
    v_mfma_f32_16x16x32_bf16 v[120:123], v[140:143], v[8:11], 0
    s_waitcnt lgkmcnt(7)
    v_mfma_f32_16x16x32_bf16 v[124:127], v[144:147], v[8:11], 0
    s_mul_i32 s40, s52, 20480
    s_add_u32 s40, s40, s46
    s_add_u32 s40, s40, 1024
    s_mul_i32 s41, s34, 5120
    s_add_u32 m0, s41, 41984
    s_nop 0
    buffer_load_dwordx4 v7, s[12:15], s40 offen lds
    s_waitcnt lgkmcnt(6)
    v_mfma_f32_16x16x32_bf16 v[128:131], v[148:151], v[8:11], 0
    s_waitcnt lgkmcnt(5)
    v_mfma_f32_16x16x32_bf16 v[132:135], v[152:155], v[8:11], 0
    s_mul_i32 s40, s52, 20480
    s_add_u32 s40, s40, s46
    s_add_u32 s40, s40, 2048
    s_mul_i32 s41, s34, 5120
    s_add_u32 m0, s41, 43008
    s_nop 0
    buffer_load_dwordx4 v7, s[12:15], s40 offen lds
    ds_read_b128 v[136:139], v113 offset:10240
    ds_read_b128 v[140:143], v113 offset:11264
    ds_read_b128 v[144:147], v113 offset:12288
    ds_read_b128 v[148:151], v113 offset:13312
    ds_read_b128 v[152:155], v113 offset:14336
    s_waitcnt vmcnt(14)
    s_waitcnt lgkmcnt(9)
    v_mfma_f32_16x16x32_bf16 v[116:119], v[156:159], v[12:15], v[116:119]
    s_mul_i32 s40, s52, 20480
    s_add_u32 s40, s40, s46
    s_add_u32 s40, s40, 3072
    s_mul_i32 s41, s34, 5120
    s_add_u32 m0, s41, 44032
    s_nop 0
    buffer_load_dwordx4 v7, s[12:15], s40 offen lds
    s_waitcnt lgkmcnt(8)
    v_mfma_f32_16x16x32_bf16 v[120:123], v[160:163], v[12:15], v[120:123]
    s_waitcnt lgkmcnt(7)
    v_mfma_f32_16x16x32_bf16 v[124:127], v[164:167], v[12:15], v[124:127]
    s_mul_i32 s40, s52, 20480
    s_add_u32 s40, s40, s46
    s_add_u32 s40, s40, 4096
    s_mul_i32 s41, s34, 5120
    s_add_u32 m0, s41, 45056
    s_nop 0
    buffer_load_dwordx4 v7, s[12:15], s40 offen lds
    s_waitcnt lgkmcnt(6)
    v_mfma_f32_16x16x32_bf16 v[128:131], v[168:171], v[12:15], v[128:131]
    s_waitcnt lgkmcnt(5)
    v_mfma_f32_16x16x32_bf16 v[132:135], v[172:175], v[12:15], v[132:135]
    s_lshl_b32 s42, s52, 12
    s_add_u32 s42, s42, s47
    buffer_load_dwordx4 v[40:43], v7, s[12:15], s42 offen offset:0
    ds_read_b128 v[156:159], v113 offset:15360
    ds_read_b128 v[160:163], v113 offset:16384
    ds_read_b128 v[164:167], v113 offset:17408
    ds_read_b128 v[168:171], v113 offset:18432
    ds_read_b128 v[172:175], v113 offset:19456
    s_waitcnt vmcnt(16)
    s_waitcnt lgkmcnt(9)
    v_mfma_f32_16x16x32_bf16 v[116:119], v[136:139], v[16:19], v[116:119]
    s_lshl_b32 s42, s52, 12
    s_add_u32 s42, s42, s47
    buffer_load_dwordx4 v[44:47], v7, s[12:15], s42 offen offset:1024
    s_waitcnt lgkmcnt(8)
    v_mfma_f32_16x16x32_bf16 v[120:123], v[140:143], v[16:19], v[120:123]
    s_waitcnt lgkmcnt(7)
    v_mfma_f32_16x16x32_bf16 v[124:127], v[144:147], v[16:19], v[124:127]
    s_lshl_b32 s42, s52, 12
    s_add_u32 s42, s42, s47
    buffer_load_dwordx4 v[48:51], v7, s[12:15], s42 offen offset:2048
    s_waitcnt lgkmcnt(6)
    v_mfma_f32_16x16x32_bf16 v[128:131], v[148:151], v[16:19], v[128:131]
    s_waitcnt lgkmcnt(5)
    v_mfma_f32_16x16x32_bf16 v[132:135], v[152:155], v[16:19], v[132:135]
    s_lshl_b32 s42, s52, 12
    s_add_u32 s42, s42, s47
    buffer_load_dwordx4 v[52:55], v7, s[12:15], s42 offen offset:3072
    s_waitcnt vmcnt(18)
    s_waitcnt lgkmcnt(4)
    v_mfma_f32_16x16x32_bf16 v[116:119], v[156:159], v[20:23], v[116:119]
    s_waitcnt lgkmcnt(3)
    v_mfma_f32_16x16x32_bf16 v[120:123], v[160:163], v[20:23], v[120:123]
    s_waitcnt lgkmcnt(2)
    v_mfma_f32_16x16x32_bf16 v[124:127], v[164:167], v[20:23], v[124:127]
    s_waitcnt lgkmcnt(1)
    v_mfma_f32_16x16x32_bf16 v[128:131], v[168:171], v[20:23], v[128:131]
    s_waitcnt lgkmcnt(0)
    v_mfma_f32_16x16x32_bf16 v[132:135], v[172:175], v[20:23], v[132:135]
    s_waitcnt vmcnt(13)
    s_barrier
    ds_read_b128 v[136:139], v113 offset:20480
    ds_read_b128 v[140:143], v113 offset:21504
    ds_read_b128 v[144:147], v113 offset:22528
    ds_read_b128 v[148:151], v113 offset:23552
    ds_read_b128 v[152:155], v113 offset:24576
    ds_read_b128 v[156:159], v113 offset:25600
    ds_read_b128 v[160:163], v113 offset:26624
    ds_read_b128 v[164:167], v113 offset:27648
    ds_read_b128 v[168:171], v113 offset:28672
    ds_read_b128 v[172:175], v113 offset:29696
    s_waitcnt vmcnt(12)
    s_waitcnt lgkmcnt(9)
    v_mfma_f32_16x16x32_bf16 v[116:119], v[136:139], v[24:27], v[116:119]
    s_mul_i32 s40, s53, 20480
    s_add_u32 s40, s40, s46
    s_add_u32 s40, s40, 0
    s_mul_i32 s41, s34, 5120
    s_add_u32 m0, s41, 61440
    s_nop 0
    buffer_load_dwordx4 v7, s[12:15], s40 offen lds
    s_waitcnt lgkmcnt(8)
    v_mfma_f32_16x16x32_bf16 v[120:123], v[140:143], v[24:27], v[120:123]
    s_waitcnt lgkmcnt(7)
    v_mfma_f32_16x16x32_bf16 v[124:127], v[144:147], v[24:27], v[124:127]
    s_mul_i32 s40, s53, 20480
    s_add_u32 s40, s40, s46
    s_add_u32 s40, s40, 1024
    s_mul_i32 s41, s34, 5120
    s_add_u32 m0, s41, 62464
    s_nop 0
    buffer_load_dwordx4 v7, s[12:15], s40 offen lds
    s_waitcnt lgkmcnt(6)
    v_mfma_f32_16x16x32_bf16 v[128:131], v[148:151], v[24:27], v[128:131]
    s_waitcnt lgkmcnt(5)
    v_mfma_f32_16x16x32_bf16 v[132:135], v[152:155], v[24:27], v[132:135]
    s_mul_i32 s40, s53, 20480
    s_add_u32 s40, s40, s46
    s_add_u32 s40, s40, 2048
    s_mul_i32 s41, s34, 5120
    s_add_u32 m0, s41, 63488
    s_nop 0
    buffer_load_dwordx4 v7, s[12:15], s40 offen lds
    ds_read_b128 v[136:139], v113 offset:30720
    ds_read_b128 v[140:143], v113 offset:31744
    ds_read_b128 v[144:147], v113 offset:32768
    ds_read_b128 v[148:151], v113 offset:33792
    ds_read_b128 v[152:155], v113 offset:34816
    s_waitcnt vmcnt(14)
    s_waitcnt lgkmcnt(9)
    v_mfma_f32_16x16x32_bf16 v[116:119], v[156:159], v[28:31], v[116:119]
    s_mul_i32 s40, s53, 20480
    s_add_u32 s40, s40, s46
    s_add_u32 s40, s40, 3072
    s_mul_i32 s41, s34, 5120
    s_add_u32 m0, s41, 64512
    s_nop 0
    buffer_load_dwordx4 v7, s[12:15], s40 offen lds
    s_waitcnt lgkmcnt(8)
    v_mfma_f32_16x16x32_bf16 v[120:123], v[160:163], v[28:31], v[120:123]
    s_waitcnt lgkmcnt(7)
    v_mfma_f32_16x16x32_bf16 v[124:127], v[164:167], v[28:31], v[124:127]
    s_mul_i32 s40, s53, 20480
    s_add_u32 s40, s40, s46
    s_add_u32 s40, s40, 4096
    s_mul_i32 s41, s34, 5120
    s_add_u32 m0, s41, 65536
    s_nop 0
    buffer_load_dwordx4 v7, s[12:15], s40 offen lds
    s_waitcnt lgkmcnt(6)
    v_mfma_f32_16x16x32_bf16 v[128:131], v[168:171], v[28:31], v[128:131]
    s_waitcnt lgkmcnt(5)
    v_mfma_f32_16x16x32_bf16 v[132:135], v[172:175], v[28:31], v[132:135]
    s_lshl_b32 s42, s53, 12
    s_add_u32 s42, s42, s47
    buffer_load_dwordx4 v[56:59], v7, s[12:15], s42 offen offset:0
    ds_read_b128 v[156:159], v113 offset:35840
    ds_read_b128 v[160:163], v113 offset:36864
    ds_read_b128 v[164:167], v113 offset:37888
    ds_read_b128 v[168:171], v113 offset:38912
    ds_read_b128 v[172:175], v113 offset:39936
    s_waitcnt vmcnt(16)
    s_waitcnt lgkmcnt(9)
    v_mfma_f32_16x16x32_bf16 v[116:119], v[136:139], v[32:35], v[116:119]
    s_lshl_b32 s42, s53, 12
    s_add_u32 s42, s42, s47
    buffer_load_dwordx4 v[60:63], v7, s[12:15], s42 offen offset:1024
    s_waitcnt lgkmcnt(8)
    v_mfma_f32_16x16x32_bf16 v[120:123], v[140:143], v[32:35], v[120:123]
    s_waitcnt lgkmcnt(7)
    v_mfma_f32_16x16x32_bf16 v[124:127], v[144:147], v[32:35], v[124:127]
    s_lshl_b32 s42, s53, 12
    s_add_u32 s42, s42, s47
    buffer_load_dwordx4 v[64:67], v7, s[12:15], s42 offen offset:2048
    s_waitcnt lgkmcnt(6)
    v_mfma_f32_16x16x32_bf16 v[128:131], v[148:151], v[32:35], v[128:131]
    s_waitcnt lgkmcnt(5)
    v_mfma_f32_16x16x32_bf16 v[132:135], v[152:155], v[32:35], v[132:135]
    s_lshl_b32 s42, s53, 12
    s_add_u32 s42, s42, s47
    buffer_load_dwordx4 v[68:71], v7, s[12:15], s42 offen offset:3072
    s_waitcnt vmcnt(18)
    s_waitcnt lgkmcnt(4)
    v_mfma_f32_16x16x32_bf16 v[116:119], v[156:159], v[36:39], v[116:119]
    s_waitcnt lgkmcnt(3)
    v_mfma_f32_16x16x32_bf16 v[120:123], v[160:163], v[36:39], v[120:123]
    s_waitcnt lgkmcnt(2)
    v_mfma_f32_16x16x32_bf16 v[124:127], v[164:167], v[36:39], v[124:127]
    s_waitcnt lgkmcnt(1)
    v_mfma_f32_16x16x32_bf16 v[128:131], v[168:171], v[36:39], v[128:131]
    s_waitcnt lgkmcnt(0)
    v_mfma_f32_16x16x32_bf16 v[132:135], v[172:175], v[36:39], v[132:135]
    s_waitcnt vmcnt(13)
    s_barrier
    ds_read_b128 v[136:139], v113 offset:40960
    ds_read_b128 v[140:143], v113 offset:41984
    ds_read_b128 v[144:147], v113 offset:43008
    ds_read_b128 v[148:151], v113 offset:44032
    ds_read_b128 v[152:155], v113 offset:45056
    ds_read_b128 v[156:159], v113 offset:46080
    ds_read_b128 v[160:163], v113 offset:47104
    ds_read_b128 v[164:167], v113 offset:48128
    ds_read_b128 v[168:171], v113 offset:49152
    ds_read_b128 v[172:175], v113 offset:50176
    s_waitcnt vmcnt(12)
    s_waitcnt lgkmcnt(9)
    v_mfma_f32_16x16x32_bf16 v[116:119], v[136:139], v[40:43], v[116:119]
    s_mul_i32 s40, s54, 20480
    s_add_u32 s40, s40, s46
    s_add_u32 s40, s40, 0
    s_mul_i32 s41, s34, 5120
    s_add_u32 m0, s41, 81920
    s_nop 0
    buffer_load_dwordx4 v7, s[12:15], s40 offen lds
    s_waitcnt lgkmcnt(8)
    v_mfma_f32_16x16x32_bf16 v[120:123], v[140:143], v[40:43], v[120:123]
    s_waitcnt lgkmcnt(7)
    v_mfma_f32_16x16x32_bf16 v[124:127], v[144:147], v[40:43], v[124:127]
    s_mul_i32 s40, s54, 20480
    s_add_u32 s40, s40, s46
    s_add_u32 s40, s40, 1024
    s_mul_i32 s41, s34, 5120
    s_add_u32 m0, s41, 82944
    s_nop 0
    buffer_load_dwordx4 v7, s[12:15], s40 offen lds
    s_waitcnt lgkmcnt(6)
    v_mfma_f32_16x16x32_bf16 v[128:131], v[148:151], v[40:43], v[128:131]
    s_waitcnt lgkmcnt(5)
    v_mfma_f32_16x16x32_bf16 v[132:135], v[152:155], v[40:43], v[132:135]
    s_mul_i32 s40, s54, 20480
    s_add_u32 s40, s40, s46
    s_add_u32 s40, s40, 2048
    s_mul_i32 s41, s34, 5120
    s_add_u32 m0, s41, 83968
    s_nop 0
    buffer_load_dwordx4 v7, s[12:15], s40 offen lds
    ds_read_b128 v[136:139], v113 offset:51200
    ds_read_b128 v[140:143], v113 offset:52224
    ds_read_b128 v[144:147], v113 offset:53248
    ds_read_b128 v[148:151], v113 offset:54272
    ds_read_b128 v[152:155], v113 offset:55296
    s_waitcnt vmcnt(14)
    s_waitcnt lgkmcnt(9)
    v_mfma_f32_16x16x32_bf16 v[116:119], v[156:159], v[44:47], v[116:119]
    s_mul_i32 s40, s54, 20480
    s_add_u32 s40, s40, s46
    s_add_u32 s40, s40, 3072
    s_mul_i32 s41, s34, 5120
    s_add_u32 m0, s41, 84992
    s_nop 0
    buffer_load_dwordx4 v7, s[12:15], s40 offen lds
    s_waitcnt lgkmcnt(8)
    v_mfma_f32_16x16x32_bf16 v[120:123], v[160:163], v[44:47], v[120:123]
    s_waitcnt lgkmcnt(7)
    v_mfma_f32_16x16x32_bf16 v[124:127], v[164:167], v[44:47], v[124:127]
    s_mul_i32 s40, s54, 20480
    s_add_u32 s40, s40, s46
    s_add_u32 s40, s40, 4096
    s_mul_i32 s41, s34, 5120
    s_add_u32 m0, s41, 86016
    s_nop 0
    buffer_load_dwordx4 v7, s[12:15], s40 offen lds
    s_waitcnt lgkmcnt(6)
    v_mfma_f32_16x16x32_bf16 v[128:131], v[168:171], v[44:47], v[128:131]
    s_waitcnt lgkmcnt(5)
    v_mfma_f32_16x16x32_bf16 v[132:135], v[172:175], v[44:47], v[132:135]
    s_lshl_b32 s42, s54, 12
    s_add_u32 s42, s42, s47
    buffer_load_dwordx4 v[72:75], v7, s[12:15], s42 offen offset:0
    ds_read_b128 v[156:159], v113 offset:56320
    ds_read_b128 v[160:163], v113 offset:57344
    ds_read_b128 v[164:167], v113 offset:58368
    ds_read_b128 v[168:171], v113 offset:59392
    ds_read_b128 v[172:175], v113 offset:60416
    s_waitcnt vmcnt(16)
    s_waitcnt lgkmcnt(9)
    v_mfma_f32_16x16x32_bf16 v[116:119], v[136:139], v[48:51], v[116:119]
    s_lshl_b32 s42, s54, 12
    s_add_u32 s42, s42, s47
    buffer_load_dwordx4 v[76:79], v7, s[12:15], s42 offen offset:1024
    s_waitcnt lgkmcnt(8)
    v_mfma_f32_16x16x32_bf16 v[120:123], v[140:143], v[48:51], v[120:123]
    s_waitcnt lgkmcnt(7)
    v_mfma_f32_16x16x32_bf16 v[124:127], v[144:147], v[48:51], v[124:127]
    s_lshl_b32 s42, s54, 12
    s_add_u32 s42, s42, s47
    buffer_load_dwordx4 v[80:83], v7, s[12:15], s42 offen offset:2048
    s_waitcnt lgkmcnt(6)
    v_mfma_f32_16x16x32_bf16 v[128:131], v[148:151], v[48:51], v[128:131]
    s_waitcnt lgkmcnt(5)
    v_mfma_f32_16x16x32_bf16 v[132:135], v[152:155], v[48:51], v[132:135]
    s_lshl_b32 s42, s54, 12
    s_add_u32 s42, s42, s47
    buffer_load_dwordx4 v[84:87], v7, s[12:15], s42 offen offset:3072
    s_waitcnt vmcnt(18)
    s_waitcnt lgkmcnt(4)
    v_mfma_f32_16x16x32_bf16 v[116:119], v[156:159], v[52:55], v[116:119]
    s_waitcnt lgkmcnt(3)
    v_mfma_f32_16x16x32_bf16 v[120:123], v[160:163], v[52:55], v[120:123]
    s_waitcnt lgkmcnt(2)
    v_mfma_f32_16x16x32_bf16 v[124:127], v[164:167], v[52:55], v[124:127]
    s_waitcnt lgkmcnt(1)
    v_mfma_f32_16x16x32_bf16 v[128:131], v[168:171], v[52:55], v[128:131]
    s_waitcnt lgkmcnt(0)
    v_mfma_f32_16x16x32_bf16 v[132:135], v[172:175], v[52:55], v[132:135]
    s_waitcnt vmcnt(13)
    s_barrier
    ds_read_b128 v[136:139], v114 offset:0
    ds_read_b128 v[140:143], v114 offset:1024
    ds_read_b128 v[144:147], v114 offset:2048
    ds_read_b128 v[148:151], v114 offset:3072
    ds_read_b128 v[152:155], v114 offset:4096
    ds_read_b128 v[156:159], v114 offset:5120
    ds_read_b128 v[160:163], v114 offset:6144
    ds_read_b128 v[164:167], v114 offset:7168
    ds_read_b128 v[168:171], v114 offset:8192
    ds_read_b128 v[172:175], v114 offset:9216
    s_waitcnt vmcnt(12)
    s_waitcnt lgkmcnt(9)
    v_mfma_f32_16x16x32_bf16 v[116:119], v[136:139], v[56:59], v[116:119]
    s_mul_i32 s40, s55, 20480
    s_add_u32 s40, s40, s46
    s_add_u32 s40, s40, 0
    s_mul_i32 s41, s34, 5120
    s_add_u32 m0, s41, 102400
    s_nop 0
    buffer_load_dwordx4 v7, s[12:15], s40 offen lds
    s_waitcnt lgkmcnt(8)
    v_mfma_f32_16x16x32_bf16 v[120:123], v[140:143], v[56:59], v[120:123]
    s_waitcnt lgkmcnt(7)
    v_mfma_f32_16x16x32_bf16 v[124:127], v[144:147], v[56:59], v[124:127]
    s_mul_i32 s40, s55, 20480
    s_add_u32 s40, s40, s46
    s_add_u32 s40, s40, 1024
    s_mul_i32 s41, s34, 5120
    s_add_u32 m0, s41, 103424
    s_nop 0
    buffer_load_dwordx4 v7, s[12:15], s40 offen lds
    s_waitcnt lgkmcnt(6)
    v_mfma_f32_16x16x32_bf16 v[128:131], v[148:151], v[56:59], v[128:131]
    s_waitcnt lgkmcnt(5)
    v_mfma_f32_16x16x32_bf16 v[132:135], v[152:155], v[56:59], v[132:135]
    s_mul_i32 s40, s55, 20480
    s_add_u32 s40, s40, s46
    s_add_u32 s40, s40, 2048
    s_mul_i32 s41, s34, 5120
    s_add_u32 m0, s41, 104448
    s_nop 0
    buffer_load_dwordx4 v7, s[12:15], s40 offen lds
    ds_read_b128 v[136:139], v114 offset:10240
    ds_read_b128 v[140:143], v114 offset:11264
    ds_read_b128 v[144:147], v114 offset:12288
    ds_read_b128 v[148:151], v114 offset:13312
    ds_read_b128 v[152:155], v114 offset:14336
    s_waitcnt vmcnt(14)
    s_waitcnt lgkmcnt(9)
    v_mfma_f32_16x16x32_bf16 v[116:119], v[156:159], v[60:63], v[116:119]
    s_mul_i32 s40, s55, 20480
    s_add_u32 s40, s40, s46
    s_add_u32 s40, s40, 3072
    s_mul_i32 s41, s34, 5120
    s_add_u32 m0, s41, 105472
    s_nop 0
    buffer_load_dwordx4 v7, s[12:15], s40 offen lds
    s_waitcnt lgkmcnt(8)
    v_mfma_f32_16x16x32_bf16 v[120:123], v[160:163], v[60:63], v[120:123]
    s_waitcnt lgkmcnt(7)
    v_mfma_f32_16x16x32_bf16 v[124:127], v[164:167], v[60:63], v[124:127]
    s_mul_i32 s40, s55, 20480
    s_add_u32 s40, s40, s46
    s_add_u32 s40, s40, 4096
    s_mul_i32 s41, s34, 5120
    s_add_u32 m0, s41, 106496
    s_nop 0
    buffer_load_dwordx4 v7, s[12:15], s40 offen lds
    s_waitcnt lgkmcnt(6)
    v_mfma_f32_16x16x32_bf16 v[128:131], v[168:171], v[60:63], v[128:131]
    s_waitcnt lgkmcnt(5)
    v_mfma_f32_16x16x32_bf16 v[132:135], v[172:175], v[60:63], v[132:135]
    s_lshl_b32 s42, s55, 12
    s_add_u32 s42, s42, s47
    buffer_load_dwordx4 v[88:91], v7, s[12:15], s42 offen offset:0
    ds_read_b128 v[156:159], v114 offset:15360
    ds_read_b128 v[160:163], v114 offset:16384
    ds_read_b128 v[164:167], v114 offset:17408
    ds_read_b128 v[168:171], v114 offset:18432
    ds_read_b128 v[172:175], v114 offset:19456
    s_waitcnt vmcnt(16)
    s_waitcnt lgkmcnt(9)
    v_mfma_f32_16x16x32_bf16 v[116:119], v[136:139], v[64:67], v[116:119]
    s_lshl_b32 s42, s55, 12
    s_add_u32 s42, s42, s47
    buffer_load_dwordx4 v[92:95], v7, s[12:15], s42 offen offset:1024
    s_waitcnt lgkmcnt(8)
    v_mfma_f32_16x16x32_bf16 v[120:123], v[140:143], v[64:67], v[120:123]
    s_waitcnt lgkmcnt(7)
    v_mfma_f32_16x16x32_bf16 v[124:127], v[144:147], v[64:67], v[124:127]
    s_lshl_b32 s42, s55, 12
    s_add_u32 s42, s42, s47
    buffer_load_dwordx4 v[96:99], v7, s[12:15], s42 offen offset:2048
    s_waitcnt lgkmcnt(6)
    v_mfma_f32_16x16x32_bf16 v[128:131], v[148:151], v[64:67], v[128:131]
    s_waitcnt lgkmcnt(5)
    v_mfma_f32_16x16x32_bf16 v[132:135], v[152:155], v[64:67], v[132:135]
    s_lshl_b32 s42, s55, 12
    s_add_u32 s42, s42, s47
    buffer_load_dwordx4 v[100:103], v7, s[12:15], s42 offen offset:3072
    s_waitcnt vmcnt(18)
    s_waitcnt lgkmcnt(4)
    v_mfma_f32_16x16x32_bf16 v[116:119], v[156:159], v[68:71], v[116:119]
    s_cmp_ge_u32 s34, 2
    s_cbranch_scc1 k3_y_1
    s_mul_i32 s40, s34, 40960
    s_add_u32 s40, s40, s45
    s_mul_i32 s41, s34, 5120
    s_add_u32 m0, s41, 122880
    s_nop 0
    buffer_load_dwordx4 v104, s[8:11], s40 offen lds
    s_add_u32 m0, s41, 123904
    s_nop 0
    buffer_load_dwordx4 v105, s[8:11], s40 offen lds
    s_add_u32 m0, s41, 124928
    s_nop 0
    buffer_load_dwordx4 v106, s[8:11], s40 offen lds
    s_add_u32 m0, s41, 125952
    s_nop 0
    buffer_load_dwordx4 v107, s[8:11], s40 offen lds
    s_add_u32 m0, s41, 126976
    s_nop 0
    buffer_load_dwordx4 v108, s[8:11], s40 offen lds
    s_branch k3_xy_2
k3_y_1:
    v_lshrrev_b32 v4, 3, v1
    v_lshlrev_b32 v4, 12, v4
    v_and_b32 v5, 7, v1
    v_lshl_add_u32 v112, v5, 4, v4
    s_sub_u32 s42, s34, 2
    s_mul_i32 s40, s42, 40
    s_mul_i32 s41, s33, 80
    s_add_u32 s40, s40, s41
    s_lshl_b32 s40, s40, 12
    s_lshl_b32 s41, s32, 7
    s_add_u32 s40, s40, s41
    s_add_u32 s40, s40, 8912896
    s_mul_i32 s41, s42, 5120
    s_add_u32 m0, s41, 133120
    s_nop 0
    buffer_load_dwordx4 v112, s[12:15], s40 offen lds
    s_add_u32 s40, s40, 32768
    s_add_u32 m0, s41, 134144
    s_nop 0
    buffer_load_dwordx4 v112, s[12:15], s40 offen lds
    s_add_u32 s40, s40, 32768
    s_add_u32 m0, s41, 135168
    s_nop 0
    buffer_load_dwordx4 v112, s[12:15], s40 offen lds
    s_add_u32 s40, s40, 32768
    s_add_u32 m0, s41, 136192
    s_nop 0
    buffer_load_dwordx4 v112, s[12:15], s40 offen lds
    s_add_u32 s40, s40, 32768
    s_add_u32 m0, s41, 137216
    s_nop 0
    buffer_load_dwordx4 v112, s[12:15], s40 offen lds
    s_add_u32 s40, s40, 32768
k3_xy_2:
    s_lshl_b32 s40, s32, 9
    s_lshl_b32 s41, s34, 7
    s_add_u32 s40, s40, s41
    s_add_u32 s40, s40, 14680064
    v_lshlrev_b32 v4, 3, v3
    buffer_load_dwordx2 v[110:111], v4, s[12:15], s40 offen
    s_waitcnt lgkmcnt(3)
    v_mfma_f32_16x16x32_bf16 v[120:123], v[160:163], v[68:71], v[120:123]
    s_waitcnt lgkmcnt(2)
    v_mfma_f32_16x16x32_bf16 v[124:127], v[164:167], v[68:71], v[124:127]
    s_waitcnt lgkmcnt(1)
    v_mfma_f32_16x16x32_bf16 v[128:131], v[168:171], v[68:71], v[128:131]
    s_waitcnt lgkmcnt(0)
    v_mfma_f32_16x16x32_bf16 v[132:135], v[172:175], v[68:71], v[132:135]
    s_waitcnt vmcnt(19)
    s_barrier
    ds_read_b128 v[136:139], v114 offset:20480
    ds_read_b128 v[140:143], v114 offset:21504
    ds_read_b128 v[144:147], v114 offset:22528
    ds_read_b128 v[148:151], v114 offset:23552
    ds_read_b128 v[152:155], v114 offset:24576
    ds_read_b128 v[156:159], v114 offset:25600
    ds_read_b128 v[160:163], v114 offset:26624
    ds_read_b128 v[164:167], v114 offset:27648
    ds_read_b128 v[168:171], v114 offset:28672
    ds_read_b128 v[172:175], v114 offset:29696
    s_waitcnt vmcnt(18)
    s_waitcnt lgkmcnt(9)
    v_mfma_f32_16x16x32_bf16 v[116:119], v[136:139], v[72:75], v[116:119]
    s_waitcnt lgkmcnt(8)
    v_mfma_f32_16x16x32_bf16 v[120:123], v[140:143], v[72:75], v[120:123]
    s_waitcnt lgkmcnt(7)
    v_mfma_f32_16x16x32_bf16 v[124:127], v[144:147], v[72:75], v[124:127]
    s_waitcnt lgkmcnt(6)
    v_mfma_f32_16x16x32_bf16 v[128:131], v[148:151], v[72:75], v[128:131]
    s_waitcnt lgkmcnt(5)
    v_mfma_f32_16x16x32_bf16 v[132:135], v[152:155], v[72:75], v[132:135]
    ds_read_b128 v[136:139], v114 offset:30720
    ds_read_b128 v[140:143], v114 offset:31744
    ds_read_b128 v[144:147], v114 offset:32768
    ds_read_b128 v[148:151], v114 offset:33792
    ds_read_b128 v[152:155], v114 offset:34816
    s_waitcnt vmcnt(17)
    s_waitcnt lgkmcnt(9)
    v_mfma_f32_16x16x32_bf16 v[116:119], v[156:159], v[76:79], v[116:119]
    s_waitcnt lgkmcnt(8)
    v_mfma_f32_16x16x32_bf16 v[120:123], v[160:163], v[76:79], v[120:123]
    s_waitcnt lgkmcnt(7)
    v_mfma_f32_16x16x32_bf16 v[124:127], v[164:167], v[76:79], v[124:127]
    s_waitcnt lgkmcnt(6)
    v_mfma_f32_16x16x32_bf16 v[128:131], v[168:171], v[76:79], v[128:131]
    s_waitcnt lgkmcnt(5)
    v_mfma_f32_16x16x32_bf16 v[132:135], v[172:175], v[76:79], v[132:135]
    ds_read_b128 v[156:159], v114 offset:35840
    ds_read_b128 v[160:163], v114 offset:36864
    ds_read_b128 v[164:167], v114 offset:37888
    ds_read_b128 v[168:171], v114 offset:38912
    ds_read_b128 v[172:175], v114 offset:39936
    s_waitcnt vmcnt(16)
    s_waitcnt lgkmcnt(9)
    v_mfma_f32_16x16x32_bf16 v[116:119], v[136:139], v[80:83], v[116:119]
    s_waitcnt lgkmcnt(8)
    v_mfma_f32_16x16x32_bf16 v[120:123], v[140:143], v[80:83], v[120:123]
    s_waitcnt lgkmcnt(7)
    v_mfma_f32_16x16x32_bf16 v[124:127], v[144:147], v[80:83], v[124:127]
    s_waitcnt lgkmcnt(6)
    v_mfma_f32_16x16x32_bf16 v[128:131], v[148:151], v[80:83], v[128:131]
    s_waitcnt lgkmcnt(5)
    v_mfma_f32_16x16x32_bf16 v[132:135], v[152:155], v[80:83], v[132:135]
    s_waitcnt vmcnt(15)
    s_waitcnt lgkmcnt(4)
    v_mfma_f32_16x16x32_bf16 v[116:119], v[156:159], v[84:87], v[116:119]
    s_waitcnt lgkmcnt(3)
    v_mfma_f32_16x16x32_bf16 v[120:123], v[160:163], v[84:87], v[120:123]
    s_waitcnt lgkmcnt(2)
    v_mfma_f32_16x16x32_bf16 v[124:127], v[164:167], v[84:87], v[124:127]
    s_waitcnt lgkmcnt(1)
    v_mfma_f32_16x16x32_bf16 v[128:131], v[168:171], v[84:87], v[128:131]
    s_waitcnt lgkmcnt(0)
    v_mfma_f32_16x16x32_bf16 v[132:135], v[172:175], v[84:87], v[132:135]
    s_waitcnt vmcnt(10)
    s_barrier
    ds_read_b128 v[136:139], v114 offset:40960
    ds_read_b128 v[140:143], v114 offset:41984
    ds_read_b128 v[144:147], v114 offset:43008
    ds_read_b128 v[148:151], v114 offset:44032
    ds_read_b128 v[152:155], v114 offset:45056
    ds_read_b128 v[156:159], v114 offset:46080
    ds_read_b128 v[160:163], v114 offset:47104
    ds_read_b128 v[164:167], v114 offset:48128
    ds_read_b128 v[168:171], v114 offset:49152
    ds_read_b128 v[172:175], v114 offset:50176
    s_waitcnt vmcnt(9)
    s_waitcnt lgkmcnt(9)
    v_mfma_f32_16x16x32_bf16 v[116:119], v[136:139], v[88:91], v[116:119]
    s_waitcnt lgkmcnt(8)
    v_mfma_f32_16x16x32_bf16 v[120:123], v[140:143], v[88:91], v[120:123]
    s_waitcnt lgkmcnt(7)
    v_mfma_f32_16x16x32_bf16 v[124:127], v[144:147], v[88:91], v[124:127]
    s_waitcnt lgkmcnt(6)
    v_mfma_f32_16x16x32_bf16 v[128:131], v[148:151], v[88:91], v[128:131]
    s_waitcnt lgkmcnt(5)
    v_mfma_f32_16x16x32_bf16 v[132:135], v[152:155], v[88:91], v[132:135]
    ds_read_b128 v[136:139], v114 offset:51200
    ds_read_b128 v[140:143], v114 offset:52224
    ds_read_b128 v[144:147], v114 offset:53248
    ds_read_b128 v[148:151], v114 offset:54272
    ds_read_b128 v[152:155], v114 offset:55296
    s_waitcnt vmcnt(8)
    s_waitcnt lgkmcnt(9)
    v_mfma_f32_16x16x32_bf16 v[116:119], v[156:159], v[92:95], v[116:119]
    s_waitcnt lgkmcnt(8)
    v_mfma_f32_16x16x32_bf16 v[120:123], v[160:163], v[92:95], v[120:123]
    s_waitcnt lgkmcnt(7)
    v_mfma_f32_16x16x32_bf16 v[124:127], v[164:167], v[92:95], v[124:127]
    s_waitcnt lgkmcnt(6)
    v_mfma_f32_16x16x32_bf16 v[128:131], v[168:171], v[92:95], v[128:131]
    s_waitcnt lgkmcnt(5)
    v_mfma_f32_16x16x32_bf16 v[132:135], v[172:175], v[92:95], v[132:135]
    ds_read_b128 v[156:159], v114 offset:56320
    ds_read_b128 v[160:163], v114 offset:57344
    ds_read_b128 v[164:167], v114 offset:58368
    ds_read_b128 v[168:171], v114 offset:59392
    ds_read_b128 v[172:175], v114 offset:60416
    s_waitcnt vmcnt(7)
    s_waitcnt lgkmcnt(9)
    v_mfma_f32_16x16x32_bf16 v[116:119], v[136:139], v[96:99], v[116:119]
    s_waitcnt lgkmcnt(8)
    v_mfma_f32_16x16x32_bf16 v[120:123], v[140:143], v[96:99], v[120:123]
    s_waitcnt lgkmcnt(7)
    v_mfma_f32_16x16x32_bf16 v[124:127], v[144:147], v[96:99], v[124:127]
    s_waitcnt lgkmcnt(6)
    v_mfma_f32_16x16x32_bf16 v[128:131], v[148:151], v[96:99], v[128:131]
    s_waitcnt lgkmcnt(5)
    v_mfma_f32_16x16x32_bf16 v[132:135], v[152:155], v[96:99], v[132:135]
    s_waitcnt vmcnt(6)
    s_waitcnt lgkmcnt(4)
    v_mfma_f32_16x16x32_bf16 v[116:119], v[156:159], v[100:103], v[116:119]
    s_waitcnt lgkmcnt(3)
    v_mfma_f32_16x16x32_bf16 v[120:123], v[160:163], v[100:103], v[120:123]
    s_waitcnt lgkmcnt(2)
    v_mfma_f32_16x16x32_bf16 v[124:127], v[164:167], v[100:103], v[124:127]
    s_waitcnt lgkmcnt(1)
    v_mfma_f32_16x16x32_bf16 v[128:131], v[168:171], v[100:103], v[128:131]
    s_waitcnt lgkmcnt(0)
    v_mfma_f32_16x16x32_bf16 v[132:135], v[172:175], v[100:103], v[132:135]
    s_lshl_b32 s40, s34, 4
    v_add_u32 v4, s40, v3
    v_mul_u32_u24 v4, 160, v4
    v_lshl_add_u32 v176, v2, 3, v4
    v_add_u32 v177, 122880, v176
    v_lshrrev_b32 v5, 2, v3
    v_lshl_add_u32 v4, v2, 2, v5
    v_lshlrev_b32 v4, 7, v4
    v_and_b32 v5, 3, v3
    v_lshl_add_u32 v4, v5, 3, v4
    s_lshl_b32 s40, s34, 5
    s_add_u32 s40, s40, 133120
    v_add_u32 v178, s40, v4
    s_mov_b32 s46, 0xbfb8aa3b
    s_mov_b32 s47, 0xbfb8aa3b
    v_pk_mul_f32 v[8:9], v[116:117], s[46:47]
    v_pk_mul_f32 v[10:11], v[118:119], s[46:47]
    v_pk_mul_f32 v[12:13], v[120:121], s[46:47]
    v_pk_mul_f32 v[14:15], v[122:123], s[46:47]
    v_pk_mul_f32 v[16:17], v[124:125], s[46:47]
    v_pk_mul_f32 v[18:19], v[126:127], s[46:47]
    v_pk_mul_f32 v[20:21], v[128:129], s[46:47]
    v_pk_mul_f32 v[22:23], v[130:131], s[46:47]
    v_pk_mul_f32 v[24:25], v[132:133], s[46:47]
    v_pk_mul_f32 v[26:27], v[134:135], s[46:47]
    s_waitcnt vmcnt(0)
    s_barrier
    ds_read_b64 v[136:137], v177 offset:0
    ds_read_b64 v[138:139], v177 offset:32
    ds_read_b64 v[140:141], v177 offset:64
    ds_read_b64 v[142:143], v177 offset:96
    ds_read_b64 v[144:145], v177 offset:128
    ds_read_b64_tr_b16 v[146:147], v178 offset:0
    ds_read_b64_tr_b16 v[148:149], v178 offset:2048
    ds_read_b64_tr_b16 v[150:151], v178 offset:4096
    ds_read_b64_tr_b16 v[152:153], v178 offset:6144
    ds_read_b64_tr_b16 v[154:155], v178 offset:8192
    v_exp_f32 v8, v8
    v_exp_f32 v9, v9
    v_exp_f32 v10, v10
    v_exp_f32 v11, v11
    v_exp_f32 v12, v12
    v_exp_f32 v13, v13
    v_exp_f32 v14, v14
    v_exp_f32 v15, v15
    v_exp_f32 v16, v16
    v_exp_f32 v17, v17
    v_exp_f32 v18, v18
    v_exp_f32 v19, v19
    v_exp_f32 v20, v20
    v_exp_f32 v21, v21
    v_exp_f32 v22, v22
    v_exp_f32 v23, v23
    v_exp_f32 v24, v24
    v_exp_f32 v25, v25
    v_exp_f32 v26, v26
    v_exp_f32 v27, v27
    v_pk_add_f32 v[8:9], v[8:9], 1.0 op_sel_hi:[1,0]
    v_pk_add_f32 v[10:11], v[10:11], 1.0 op_sel_hi:[1,0]
    v_pk_add_f32 v[12:13], v[12:13], 1.0 op_sel_hi:[1,0]
    v_pk_add_f32 v[14:15], v[14:15], 1.0 op_sel_hi:[1,0]
    v_pk_add_f32 v[16:17], v[16:17], 1.0 op_sel_hi:[1,0]
    v_pk_add_f32 v[18:19], v[18:19], 1.0 op_sel_hi:[1,0]
    v_pk_add_f32 v[20:21], v[20:21], 1.0 op_sel_hi:[1,0]
    v_pk_add_f32 v[22:23], v[22:23], 1.0 op_sel_hi:[1,0]
    v_pk_add_f32 v[24:25], v[24:25], 1.0 op_sel_hi:[1,0]
    v_pk_add_f32 v[26:27], v[26:27], 1.0 op_sel_hi:[1,0]
    v_rcp_f32 v8, v8
    v_rcp_f32 v9, v9
    v_rcp_f32 v10, v10
    v_rcp_f32 v11, v11
    v_rcp_f32 v12, v12
    v_rcp_f32 v13, v13
    v_rcp_f32 v14, v14
    v_rcp_f32 v15, v15
    v_rcp_f32 v16, v16
    v_rcp_f32 v17, v17
    v_rcp_f32 v18, v18
    v_rcp_f32 v19, v19
    v_rcp_f32 v20, v20
    v_rcp_f32 v21, v21
    v_rcp_f32 v22, v22
    v_rcp_f32 v23, v23
    v_rcp_f32 v24, v24
    v_rcp_f32 v25, v25
    v_rcp_f32 v26, v26
    v_rcp_f32 v27, v27
    v_pk_mul_f32 v[8:9], v[8:9], v[116:117]
    v_pk_mul_f32 v[10:11], v[10:11], v[118:119]
    v_pk_mul_f32 v[12:13], v[12:13], v[120:121]
    v_pk_mul_f32 v[14:15], v[14:15], v[122:123]
    v_pk_mul_f32 v[16:17], v[16:17], v[124:125]
    v_pk_mul_f32 v[18:19], v[18:19], v[126:127]
    v_pk_mul_f32 v[20:21], v[20:21], v[128:129]
    v_pk_mul_f32 v[22:23], v[22:23], v[130:131]
    v_pk_mul_f32 v[24:25], v[24:25], v[132:133]
    v_pk_mul_f32 v[26:27], v[26:27], v[134:135]
    s_waitcnt lgkmcnt(0)
    v_lshlrev_b32 v28, 16, v136
    v_and_b32 v29, 0xffff0000, v136
    v_lshlrev_b32 v48, 16, v146
    v_and_b32 v49, 0xffff0000, v146
    v_lshlrev_b32 v30, 16, v137
    v_and_b32 v31, 0xffff0000, v137
    v_lshlrev_b32 v50, 16, v147
    v_and_b32 v51, 0xffff0000, v147
    v_lshlrev_b32 v32, 16, v138
    v_and_b32 v33, 0xffff0000, v138
    v_lshlrev_b32 v52, 16, v148
    v_and_b32 v53, 0xffff0000, v148
    v_lshlrev_b32 v34, 16, v139
    v_and_b32 v35, 0xffff0000, v139
    v_lshlrev_b32 v54, 16, v149
    v_and_b32 v55, 0xffff0000, v149
    v_lshlrev_b32 v36, 16, v140
    v_and_b32 v37, 0xffff0000, v140
    v_lshlrev_b32 v56, 16, v150
    v_and_b32 v57, 0xffff0000, v150
    v_lshlrev_b32 v38, 16, v141
    v_and_b32 v39, 0xffff0000, v141
    v_lshlrev_b32 v58, 16, v151
    v_and_b32 v59, 0xffff0000, v151
    v_lshlrev_b32 v40, 16, v142
    v_and_b32 v41, 0xffff0000, v142
    v_lshlrev_b32 v60, 16, v152
    v_and_b32 v61, 0xffff0000, v152
    v_lshlrev_b32 v42, 16, v143
    v_and_b32 v43, 0xffff0000, v143
    v_lshlrev_b32 v62, 16, v153
    v_and_b32 v63, 0xffff0000, v153
    v_lshlrev_b32 v44, 16, v144
    v_and_b32 v45, 0xffff0000, v144
    v_lshlrev_b32 v64, 16, v154
    v_and_b32 v65, 0xffff0000, v154
    v_lshlrev_b32 v46, 16, v145
    v_and_b32 v47, 0xffff0000, v145
    v_lshlrev_b32 v66, 16, v155
    v_and_b32 v67, 0xffff0000, v155
    v_mov_b32 v180, v111
    v_pk_add_f32 v[68:69], v[28:29], v[110:111] op_sel_hi:[1,0] neg_lo:[0,1] neg_hi:[0,1]
    v_pk_add_f32 v[70:71], v[30:31], v[110:111] op_sel_hi:[1,0] neg_lo:[0,1] neg_hi:[0,1]
    v_pk_add_f32 v[72:73], v[32:33], v[110:111] op_sel_hi:[1,0] neg_lo:[0,1] neg_hi:[0,1]
    v_pk_add_f32 v[74:75], v[34:35], v[110:111] op_sel_hi:[1,0] neg_lo:[0,1] neg_hi:[0,1]
    v_pk_add_f32 v[76:77], v[36:37], v[110:111] op_sel_hi:[1,0] neg_lo:[0,1] neg_hi:[0,1]
    v_pk_add_f32 v[78:79], v[38:39], v[110:111] op_sel_hi:[1,0] neg_lo:[0,1] neg_hi:[0,1]
    v_pk_add_f32 v[80:81], v[40:41], v[110:111] op_sel_hi:[1,0] neg_lo:[0,1] neg_hi:[0,1]
    v_pk_add_f32 v[82:83], v[42:43], v[110:111] op_sel_hi:[1,0] neg_lo:[0,1] neg_hi:[0,1]
    v_pk_add_f32 v[84:85], v[44:45], v[110:111] op_sel_hi:[1,0] neg_lo:[0,1] neg_hi:[0,1]
    v_pk_add_f32 v[86:87], v[46:47], v[110:111] op_sel_hi:[1,0] neg_lo:[0,1] neg_hi:[0,1]
    v_pk_mul_f32 v[68:69], v[68:69], v[180:181] op_sel_hi:[1,0]
    v_pk_mul_f32 v[70:71], v[70:71], v[180:181] op_sel_hi:[1,0]
    v_pk_mul_f32 v[72:73], v[72:73], v[180:181] op_sel_hi:[1,0]
    v_pk_mul_f32 v[74:75], v[74:75], v[180:181] op_sel_hi:[1,0]
    v_pk_mul_f32 v[76:77], v[76:77], v[180:181] op_sel_hi:[1,0]
    v_pk_mul_f32 v[78:79], v[78:79], v[180:181] op_sel_hi:[1,0]
    v_pk_mul_f32 v[80:81], v[80:81], v[180:181] op_sel_hi:[1,0]
    v_pk_mul_f32 v[82:83], v[82:83], v[180:181] op_sel_hi:[1,0]
    v_pk_mul_f32 v[84:85], v[84:85], v[180:181] op_sel_hi:[1,0]
    v_pk_mul_f32 v[86:87], v[86:87], v[180:181] op_sel_hi:[1,0]
    v_pk_mul_f32 v[68:69], v[68:69], v[48:49]
    v_pk_mul_f32 v[70:71], v[70:71], v[50:51]
    v_pk_mul_f32 v[72:73], v[72:73], v[52:53]
    v_pk_mul_f32 v[74:75], v[74:75], v[54:55]
    v_pk_mul_f32 v[76:77], v[76:77], v[56:57]
    v_pk_mul_f32 v[78:79], v[78:79], v[58:59]
    v_pk_mul_f32 v[80:81], v[80:81], v[60:61]
    v_pk_mul_f32 v[82:83], v[82:83], v[62:63]
    v_pk_mul_f32 v[84:85], v[84:85], v[64:65]
    v_pk_mul_f32 v[86:87], v[86:87], v[66:67]
    v_pk_fma_f32 v[68:69], v[68:69], v[8:9], v[28:29]
    v_pk_fma_f32 v[70:71], v[70:71], v[10:11], v[30:31]
    v_pk_fma_f32 v[72:73], v[72:73], v[12:13], v[32:33]
    v_pk_fma_f32 v[74:75], v[74:75], v[14:15], v[34:35]
    v_pk_fma_f32 v[76:77], v[76:77], v[16:17], v[36:37]
    v_pk_fma_f32 v[78:79], v[78:79], v[18:19], v[38:39]
    v_pk_fma_f32 v[80:81], v[80:81], v[20:21], v[40:41]
    v_pk_fma_f32 v[82:83], v[82:83], v[22:23], v[42:43]
    v_pk_fma_f32 v[84:85], v[84:85], v[24:25], v[44:45]
    v_pk_fma_f32 v[86:87], v[86:87], v[26:27], v[46:47]
    v_cvt_pk_bf16_f32 v136, v68, v69
    v_cvt_pk_bf16_f32 v137, v70, v71
    v_cvt_pk_bf16_f32 v138, v72, v73
    v_cvt_pk_bf16_f32 v139, v74, v75
    v_cvt_pk_bf16_f32 v140, v76, v77
    v_cvt_pk_bf16_f32 v141, v78, v79
    v_cvt_pk_bf16_f32 v142, v80, v81
    v_cvt_pk_bf16_f32 v143, v82, v83
    v_cvt_pk_bf16_f32 v144, v84, v85
    v_cvt_pk_bf16_f32 v145, v86, v87
    v_add_u32 v182, 143360, v176
    ds_write_b64 v182, v[136:137] offset:0
    ds_write_b64 v182, v[138:139] offset:32
    ds_write_b64 v182, v[140:141] offset:64
    ds_write_b64 v182, v[142:143] offset:96
    ds_write_b64 v182, v[144:145] offset:128
    s_mul_i32 s40, s34, 2560
    s_add_u32 s40, s40, 143360
    v_add_u32 v4, s40, v7
    s_waitcnt lgkmcnt(0)
    ds_read_b128 v[8:11], v4 offset:0
    ds_read_b128 v[12:15], v4 offset:1024
    ds_read_b128 v[16:19], v4 offset:2048
    s_mul_i32 s40, s34, 20480
    s_add_u32 s40, s40, s45
    s_waitcnt lgkmcnt(0)
    buffer_store_dwordx4 v[8:11], v104, s[16:19], s40 offen
    buffer_store_dwordx4 v[12:15], v105, s[16:19], s40 offen
    s_mov_b32 exec_hi, 0
    buffer_store_dwordx4 v[16:19], v106, s[16:19], s40 offen
    s_mov_b64 exec, -1
k3_kernel_end:
    s_endpgm
.section .rodata,"a"
.p2align 6
.amdhsa_kernel k12_kernel
  .amdhsa_next_free_vgpr 248
  .amdhsa_next_free_sgpr 102
  .amdhsa_accum_offset 248
  .amdhsa_group_segment_fixed_size 0
  .amdhsa_kernarg_size 112
  .amdhsa_user_sgpr_count 2
  .amdhsa_user_sgpr_kernarg_segment_ptr 1
  .amdhsa_system_sgpr_workgroup_id_x 1
.end_amdhsa_kernel
.p2align 6
.amdhsa_kernel k3_kernel
  .amdhsa_next_free_vgpr 183
  .amdhsa_next_free_sgpr 102
  .amdhsa_accum_offset 184
  .amdhsa_group_segment_fixed_size 0
  .amdhsa_kernarg_size 112
  .amdhsa_user_sgpr_count 2
  .amdhsa_user_sgpr_kernarg_segment_ptr 1
  .amdhsa_system_sgpr_workgroup_id_x 1
.end_amdhsa_kernel
```

```asm
; @launch grid=(256,1,1) block=(512,1,1) lds=163840
.amdgcn_target "amdgcn-amd-amdhsa--gfx950"
.text
.globl recurrent_scan__ssm_conv_h3__mixer_gmlp__prompt_kernel
.p2align 8
.type recurrent_scan__ssm_conv_h3__mixer_gmlp__prompt_kernel,@function
recurrent_scan__ssm_conv_h3__mixer_gmlp__prompt_kernel:
    s_cmp_ge_u32 s2, 256
    s_cbranch_scc1 recurrent_scan__ssm_conv_h3__mixer_gmlp__prompt_kernel_end
    s_load_dwordx2 s[4:5], s[0:1], 0
    s_load_dwordx2 s[8:9], s[0:1], 56
    s_load_dwordx2 s[12:13], s[0:1], 8
    s_load_dwordx2 s[16:17], s[0:1], 16
    s_load_dwordx2 s[20:21], s[0:1], 24
    s_load_dwordx2 s[24:25], s[0:1], 104
    s_load_dwordx2 s[28:29], s[0:1], 96
    s_load_dwordx2 s[32:33], s[0:1], 64
    s_load_dwordx2 s[36:37], s[0:1], 32
    s_load_dwordx2 s[84:85], s[0:1], 80
    v_lshrrev_b32 v2, 6, v0
    v_and_b32 v1, 63, v0
    v_readfirstlane_b32 s42, v2
    v_lshrrev_b32 v2, 4, v1
    v_and_b32 v3, 15, v1
    s_and_b32 s48, s2, 7
    s_lshr_b32 s49, s2, 3
    s_lshr_b32 s66, s48, 1
    s_and_b32 s67, s48, 1
    s_lshl_b32 s40, s66, 3
    s_and_b32 s48, s49, 7
    s_add_u32 s40, s40, s48
    s_lshl_b32 s41, s67, 2
    s_lshr_b32 s48, s49, 3
    s_add_u32 s41, s41, s48
    s_mul_i32 s52, s40, 81920
    s_mul_i32 s54, s41, 192
    s_add_u32 s53, s54, 1536
    s_lshl_b32 s60, s42, 11
    s_mul_i32 s61, s42, 3072
    s_mov_b32 s6, 2621440
    s_mov_b32 s7, 0x20000
    s_mov_b32 s10, 1966080
    s_mov_b32 s11, 0x20000
    s_lshl_b32 s48, s42, 3
    v_add_u32 v4, s48, v2
    v_and_b32 v5, 15, v4
    v_xor_b32 v5, v5, v3
    v_mul_u32_u24 v4, 1280, v4
    v_lshl_add_u32 v38, v5, 4, v4
    v_add_u32 v4, s48, v2
    v_add_u32 v4, 4, v4
    v_and_b32 v5, 15, v4
    v_xor_b32 v5, v5, v3
    v_mul_u32_u24 v4, 1280, v4
    v_lshl_add_u32 v39, v5, 4, v4
    s_mul_i32 s48, s42, 192
    v_add_u32 v4, s48, v1
    v_mul_u32_u24 v5, 43691, v4
    v_lshrrev_b32 v5, 19, v5
    v_mul_u32_u24 v6, 12, v5
    v_sub_u32 v4, v4, v6
    v_lshrrev_b32 v6, 2, v5
    v_and_b32 v6, 2, v6
    v_xor_b32 v4, v4, v6
    v_mul_u32_u24 v5, 3072, v5
    v_lshl_add_u32 v40, v4, 4, v5
    v_add_u32 v4, s48, v1
    v_add_u32 v4, 64, v4
    v_mul_u32_u24 v5, 43691, v4
    v_lshrrev_b32 v5, 19, v5
    v_mul_u32_u24 v6, 12, v5
    v_sub_u32 v4, v4, v6
    v_lshrrev_b32 v6, 2, v5
    v_and_b32 v6, 2, v6
    v_xor_b32 v4, v4, v6
    v_mul_u32_u24 v5, 3072, v5
    v_lshl_add_u32 v41, v4, 4, v5
    v_add_u32 v4, s48, v1
    v_add_u32 v4, 128, v4
    v_mul_u32_u24 v5, 43691, v4
    v_lshrrev_b32 v5, 19, v5
    v_mul_u32_u24 v6, 12, v5
    v_sub_u32 v4, v4, v6
    v_lshrrev_b32 v6, 2, v5
    v_and_b32 v6, 2, v6
    v_xor_b32 v4, v4, v6
    v_mul_u32_u24 v5, 3072, v5
    v_lshl_add_u32 v42, v4, 4, v5
    s_add_u32 s48, s40, s41
    s_mul_i32 s49, s48, 52
    s_lshr_b32 s49, s49, 8
    s_mul_i32 s49, s49, 5
    s_sub_u32 s51, s48, s49
    s_add_u32 s49, s51, 0
    s_sub_u32 s50, s49, 5
    s_cmp_ge_u32 s49, 5
    s_cselect_b32 s49, s50, s49
    s_lshl_b32 s90, s49, 8
    s_mul_i32 s95, s49, 393216
    s_add_u32 s49, s51, 1
    s_sub_u32 s50, s49, 5
    s_cmp_ge_u32 s49, 5
    s_cselect_b32 s49, s50, s49
    s_lshl_b32 s91, s49, 8
    s_mul_i32 s96, s49, 393216
    s_waitcnt lgkmcnt(0)
    s_add_u32 s65, s52, s90
    s_add_u32 m0, s60, 0
    s_nop 0
    buffer_load_dwordx4 v38, s[4:7], s65 offen lds
    s_add_u32 s65, s52, s90
    s_add_u32 m0, s60, 1024
    s_nop 0
    buffer_load_dwordx4 v39, s[4:7], s65 offen lds
    s_add_u32 s65, s53, s95
    s_add_u32 m0, s61, 81920
    s_nop 0
    buffer_load_dwordx4 v40, s[8:11], s65 offen lds
    s_add_u32 s65, s53, s95
    s_add_u32 m0, s61, 82944
    s_nop 0
    buffer_load_dwordx4 v41, s[8:11], s65 offen lds
    s_add_u32 s65, s53, s95
    s_add_u32 m0, s61, 83968
    s_nop 0
    buffer_load_dwordx4 v42, s[8:11], s65 offen lds
    s_mov_b32 s48, 14712832
    s_load_dwordx2 s[100:101], s[24:25], s48
    s_add_u32 s49, s51, 2
    s_sub_u32 s50, s49, 5
    s_cmp_ge_u32 s49, 5
    s_cselect_b32 s49, s50, s49
    s_lshl_b32 s92, s49, 8
    s_mul_i32 s97, s49, 393216
    s_add_u32 s49, s51, 3
    s_sub_u32 s50, s49, 5
    s_cmp_ge_u32 s49, 5
    s_cselect_b32 s49, s50, s49
    s_lshl_b32 s93, s49, 8
    s_mul_i32 s98, s49, 393216
    s_add_u32 s49, s51, 4
    s_sub_u32 s50, s49, 5
    s_cmp_ge_u32 s49, 5
    s_cselect_b32 s49, s50, s49
    s_lshl_b32 s94, s49, 8
    s_mul_i32 s99, s49, 393216
    s_mov_b32 s14, 2621440
    s_mov_b32 s15, 0x20000
    s_mov_b32 s18, 2621440
    s_mov_b32 s19, 0x20000
    s_mov_b32 s22, 5120
    s_mov_b32 s23, 0x20000
    s_mov_b32 s26, 15990784
    s_mov_b32 s27, 0x20000
    s_mov_b32 s30, 256
    s_mov_b32 s31, 0x20000
    s_mov_b32 s34, 8388608
    s_mov_b32 s35, 0x20000
    s_mov_b32 s38, 2621440
    s_mov_b32 s39, 0x20000
    s_mov_b32 s86, 983040
    s_mov_b32 s87, 0x20000
    v_lshlrev_b32 v36, 7, v1
    v_mov_b32 v4, 161792
    v_mov_b32 v8, 0
    v_mov_b32 v9, 0
    ds_write_b64 v4, v[8:9]
    s_barrier
    s_add_u32 s65, s52, s91
    s_add_u32 m0, s60, 16384
    s_nop 0
    buffer_load_dwordx4 v38, s[4:7], s65 offen lds
    s_add_u32 s65, s52, s91
    s_add_u32 m0, s60, 17408
    s_nop 0
    buffer_load_dwordx4 v39, s[4:7], s65 offen lds
    s_add_u32 s65, s53, s96
    s_add_u32 m0, s61, 106496
    s_nop 0
    buffer_load_dwordx4 v40, s[8:11], s65 offen lds
    s_add_u32 s65, s53, s96
    s_add_u32 m0, s61, 107520
    s_nop 0
    buffer_load_dwordx4 v41, s[8:11], s65 offen lds
    s_add_u32 s65, s53, s96
    s_add_u32 m0, s61, 108544
    s_nop 0
    buffer_load_dwordx4 v42, s[8:11], s65 offen lds
    s_cmp_lg_u32 s42, 7
    s_cbranch_scc1 k1_shk_1
    v_lshlrev_b32 v4, 4, v1
    s_mul_i32 s48, s41, 640
    s_mov_b32 m0, 160768
    s_mov_b32 exec_lo, -1
    s_mov_b32 exec_hi, 0xff
    buffer_load_dwordx4 v4, s[20:23], s48 offen lds
    s_mov_b64 exec, -1
k1_shk_1:
    s_and_b32 s43, s42, 1
    s_lshr_b32 s44, s42, 1
    s_and_b32 s44, s44, 1
    s_lshr_b32 s45, s42, 2
    s_xor_b32 s46, s43, s45
    s_lshl_b32 s47, s44, 1
    s_add_u32 s47, s47, s46
    s_mov_b32 s55, 0x3727c5ac
    s_mov_b32 s56, 0x3f803f80
    s_mov_b32 s58, 0xbdd2d3e8
    s_mov_b32 s59, 0xbdd2d3e8
    s_lshl_b32 s48, s45, 1
    s_add_u32 s63, s48, s44
    s_xor_b32 s64, s63, 1
    v_xor_b32 v4, v2, v3
    v_lshlrev_b32 v6, 8, v3
    s_lshl_b32 s48, s44, 13
    s_lshl_b32 s49, s46, 12
    s_add_u32 s50, s48, s49
    s_xor_b32 s49, s49, 4096
    s_add_u32 s51, s48, s49
    s_lshl_b32 s48, s63, 2
    v_xor_b32 v5, s48, v4
    v_lshl_add_u32 v5, v5, 4, v6
    v_add_u32 v45, s50, v5
    v_add_u32 v46, s51, v5
    s_lshl_b32 s48, s64, 2
    v_xor_b32 v5, s48, v4
    v_lshl_add_u32 v5, v5, 4, v6
    v_add_u32 v47, s50, v5
    v_add_u32 v216, s51, v5
    v_lshrrev_b32 v5, 2, v3
    v_lshl_add_u32 v4, v2, 3, v5
    v_mul_u32_u24 v4, 192, v4
    v_and_b32 v5, 3, v3
    v_lshl_add_u32 v4, v5, 3, v4
    v_and_b32 v5, 1, v2
    s_mul_i32 s51, s43, 3
    s_mul_i32 s49, s63, 6144
    s_add_u32 s49, s49, 81920
    s_mul_i32 s50, s64, 6144
    s_add_u32 s50, s50, 81920
    s_add_u32 s48, s51, 0
    v_xor_b32 v6, s48, v5
    v_lshl_add_u32 v6, v6, 5, v4
    v_add_u32 v217, s49, v6
    v_add_u32 v220, s50, v6
    s_add_u32 s48, s51, 1
    v_xor_b32 v6, s48, v5
    v_lshl_add_u32 v6, v6, 5, v4
    v_add_u32 v218, s49, v6
    v_add_u32 v221, s50, v6
    s_add_u32 s48, s51, 2
    v_xor_b32 v6, s48, v5
    v_lshl_add_u32 v6, v6, 5, v4
    v_add_u32 v219, s49, v6
    v_add_u32 v222, s50, v6
    v_mov_b32 v244, s56
    v_mov_b32 v245, s56
    v_mov_b32 v246, s56
    v_mov_b32 v247, s56
    v_mul_u32_u24 v43, 205, v1
    v_lshrrev_b32 v43, 11, v43
    v_mul_u32_u24 v4, 10, v43
    v_sub_u32 v44, v1, v4
    s_lshl_b32 s48, s42, 3
    v_lshl_add_u32 v4, v43, 1, s48
    v_min_u32 v4, 62, v4
    v_mul_u32_u24 v4, 160, v4
    v_lshl_add_u32 v7, v44, 4, v4
    v_lshlrev_b32 v215, 10, v1
    s_lshl_b32 s89, s2, 3
    s_add_u32 s89, s89, s42
    s_mul_i32 s70, s42, 3072
    s_add_u32 s70, s70, 16384
    s_xor_b32 s48, s42, 4
    s_mul_i32 s71, s48, 3072
    s_add_u32 s71, s71, 16384
    s_lshl_b32 s48, s43, 2
    s_lshl_b32 s49, s44, 1
    s_add_u32 s48, s48, s49
    s_add_u32 s48, s48, s45
    s_mul_i32 s72, s48, 192
    s_add_u32 s72, s72, 155648
    s_mul_i32 s73, s43, 768
    s_add_u32 s73, s73, 155648
    s_lshl_b32 s48, s47, 1
    s_add_u32 s48, s48, s45
    s_lshl_b32 s48, s48, 7
    s_add_u32 s74, s48, 158720
    s_lshl_b32 s48, s47, 8
    s_add_u32 s75, s48, 158720
    s_lshl_b32 s48, s47, 7
    s_lshl_b32 s49, s43, 9
    s_add_u32 s48, s48, s49
    s_add_u32 s76, s48, 159744
    s_lshl_b32 s48, s40, 3
    s_add_u32 s48, s48, s41
    s_lshl_b32 s49, s48, 10
    s_add_u32 s77, s49, 14745600
    s_mov_b32 s48, 0
    s_lshr_b32 s49, s47, 1
    s_mul_i32 s49, s49, 6144
    s_add_u32 s48, s48, s49
    s_and_b32 s49, s47, 1
    s_lshl_b32 s49, s49, 8
    s_add_u32 s48, s48, s49
    s_add_u32 s48, s48, 73728
    s_mul_i32 s49, s43, 3
    s_add_u32 s49, s49, 0
    s_lshr_b32 s50, s49, 1
    s_lshl_b32 s50, s50, 10
    s_and_b32 s49, s49, 1
    s_lshl_b32 s49, s49, 3
    s_add_u32 s80, s48, s49
    s_add_u32 s80, s80, s50
    s_mul_i32 s49, s43, 3
    s_add_u32 s49, s49, 1
    s_lshr_b32 s50, s49, 1
    s_lshl_b32 s50, s50, 10
    s_and_b32 s49, s49, 1
    s_lshl_b32 s49, s49, 3
    s_add_u32 s81, s48, s49
    s_add_u32 s81, s81, s50
    s_mul_i32 s49, s43, 3
    s_add_u32 s49, s49, 2
    s_lshr_b32 s50, s49, 1
    s_lshl_b32 s50, s50, 10
    s_and_b32 s49, s49, 1
    s_lshl_b32 s49, s49, 3
    s_add_u32 s82, s48, s49
    s_add_u32 s82, s82, s50
    s_lshl_b32 s48, s40, 13
    s_lshl_b32 s49, s47, 8
    s_add_u32 s48, s48, s49
    s_add_u32 s78, s48, 14745600
    s_lshl_b32 s48, s40, 9
    s_lshl_b32 s49, s47, 7
    s_add_u32 s48, s48, s49
    s_add_u32 s79, s48, 14680064
    s_mul_i32 s48, s41, 327680
    s_lshl_b32 s49, s40, 7
    s_add_u32 s48, s48, s49
    s_add_u32 s83, s48, 6291456
    s_lshr_b32 s48, s2, 3
    s_lshl_b32 s48, s48, 3
    s_add_u32 s48, s48, s42
    s_lshl_b32 s48, s48, 13
    s_lshl_b32 s49, s66, 21
    s_add_u32 s66, s48, s49
    s_add_u32 s51, s42, 0
    s_mul_i32 s48, s51, 43
    s_lshr_b32 s48, s48, 7
    s_mul_i32 s49, s48, 3
    s_sub_u32 s49, s51, s49
    s_mul_i32 s48, s48, 3200
    s_lshl_b32 s49, s49, 6
    s_add_u32 s48, s48, s49
    s_add_u32 s88, s48, 0
    s_lshl_b32 s48, s41, 7
    s_lshl_b32 s49, s40, 2
    s_add_u32 s48, s48, s49
    s_mul_i32 s48, s48, 3
    s_add_u32 s48, s48, s51
    s_lshl_b32 s48, s48, 10
    s_add_u32 s64, s48, 0
    s_add_u32 s51, s42, 8
    s_mul_i32 s48, s51, 43
    s_lshr_b32 s48, s48, 7
    s_mul_i32 s49, s48, 3
    s_sub_u32 s49, s51, s49
    s_mul_i32 s48, s48, 3200
    s_lshl_b32 s49, s49, 6
    s_add_u32 s48, s48, s49
    s_add_u32 s63, s48, 0
    s_lshl_b32 s48, s41, 7
    s_lshl_b32 s49, s40, 2
    s_add_u32 s48, s48, s49
    s_mul_i32 s48, s48, 3
    s_add_u32 s48, s48, s51
    s_lshl_b32 s48, s48, 10
    s_add_u32 s67, s48, 0
    s_waitcnt vmcnt(5)
    s_waitcnt lgkmcnt(0)
    s_add_u32 s100, s100, 1
    s_addc_u32 s101, s101, 0
    s_barrier
    ds_read_b64_tr_b16 v[128:129], v217 offset:0
    ds_read_b64_tr_b16 v[130:131], v217 offset:768
    ds_read_b64_tr_b16 v[132:133], v218 offset:0
    ds_read_b64_tr_b16 v[134:135], v218 offset:768
    ds_read_b64_tr_b16 v[136:137], v219 offset:0
    ds_read_b64_tr_b16 v[138:139], v219 offset:768
    ds_read_b64_tr_b16 v[140:141], v220 offset:0
    ds_read_b64_tr_b16 v[142:143], v220 offset:768
    ds_read_b64_tr_b16 v[144:145], v221 offset:0
    ds_read_b64_tr_b16 v[146:147], v221 offset:768
    ds_read_b64_tr_b16 v[148:149], v222 offset:0
    ds_read_b64_tr_b16 v[150:151], v222 offset:768
    ds_read_b128 v[48:51], v45 offset:0
    ds_read_b128 v[52:55], v46 offset:0
    ds_read_b128 v[56:59], v47 offset:0
    ds_read_b128 v[60:63], v216 offset:0
    s_add_u32 s65, s52, s92
    s_add_u32 m0, s60, 32768
    s_nop 0
    buffer_load_dwordx4 v38, s[4:7], s65 offen lds
    s_add_u32 s65, s52, s92
    s_add_u32 m0, s60, 33792
    s_nop 0
    buffer_load_dwordx4 v39, s[4:7], s65 offen lds
    s_add_u32 s65, s53, s97
    s_add_u32 m0, s61, 131072
    s_nop 0
    buffer_load_dwordx4 v40, s[8:11], s65 offen lds
    s_add_u32 s65, s53, s97
    s_add_u32 m0, s61, 132096
    s_nop 0
    buffer_load_dwordx4 v41, s[8:11], s65 offen lds
    s_add_u32 s65, s53, s97
    s_add_u32 m0, s61, 133120
    s_nop 0
    buffer_load_dwordx4 v42, s[8:11], s65 offen lds
    s_waitcnt vmcnt(5)
    s_waitcnt lgkmcnt(0)
    s_barrier
    v_mfma_f32_16x16x32_bf16 v[176:179], v[128:131], v[48:51], 0
    ds_read_b64_tr_b16 v[152:153], v217 offset:24576
    ds_read_b64_tr_b16 v[154:155], v217 offset:25344
    v_mfma_f32_16x16x32_bf16 v[180:183], v[128:131], v[52:55], 0
    s_add_u32 s65, s52, s93
    s_add_u32 m0, s60, 49152
    s_nop 0
    buffer_load_dwordx4 v38, s[4:7], s65 offen lds
    ds_read_b64_tr_b16 v[156:157], v218 offset:24576
    ds_read_b64_tr_b16 v[158:159], v218 offset:25344
    v_mfma_f32_16x16x32_bf16 v[224:227], v[128:131], v[244:247], 0
    ds_read_b64_tr_b16 v[160:161], v219 offset:24576
    ds_read_b64_tr_b16 v[162:163], v219 offset:25344
    v_mfma_f32_16x16x32_bf16 v[184:187], v[132:135], v[48:51], 0
    ds_read_b64_tr_b16 v[164:165], v220 offset:24576
    ds_read_b64_tr_b16 v[166:167], v220 offset:25344
    v_mfma_f32_16x16x32_bf16 v[188:191], v[132:135], v[52:55], 0
    s_add_u32 s65, s52, s93
    s_add_u32 m0, s60, 50176
    s_nop 0
    buffer_load_dwordx4 v39, s[4:7], s65 offen lds
    ds_read_b64_tr_b16 v[168:169], v221 offset:24576
    ds_read_b64_tr_b16 v[170:171], v221 offset:25344
    v_mfma_f32_16x16x32_bf16 v[228:231], v[132:135], v[244:247], 0
    ds_read_b64_tr_b16 v[172:173], v222 offset:24576
    ds_read_b64_tr_b16 v[174:175], v222 offset:25344
    v_mfma_f32_16x16x32_bf16 v[192:195], v[136:139], v[48:51], 0
    ds_read_b128 v[64:67], v45 offset:16384
    ds_read_b128 v[68:71], v46 offset:16384
    v_mfma_f32_16x16x32_bf16 v[196:199], v[136:139], v[52:55], 0
    s_add_u32 s65, s53, s98
    s_add_u32 m0, s61, 81920
    s_nop 0
    buffer_load_dwordx4 v40, s[8:11], s65 offen lds
    ds_read_b128 v[72:75], v47 offset:16384
    ds_read_b128 v[76:79], v216 offset:16384
    v_mfma_f32_16x16x32_bf16 v[232:235], v[136:139], v[244:247], 0
    v_mfma_f32_16x16x32_bf16 v[236:239], v[244:247], v[48:51], 0
    v_mfma_f32_16x16x32_bf16 v[240:243], v[48:51], v[48:51], 0
    s_add_u32 s65, s53, s98
    s_add_u32 m0, s61, 82944
    s_nop 0
    buffer_load_dwordx4 v41, s[8:11], s65 offen lds
    v_mfma_f32_16x16x32_bf16 v[176:179], v[140:143], v[56:59], v[176:179]
    v_mfma_f32_16x16x32_bf16 v[180:183], v[140:143], v[60:63], v[180:183]
    v_mfma_f32_16x16x32_bf16 v[184:187], v[144:147], v[56:59], v[184:187]
    s_add_u32 s65, s53, s98
    s_add_u32 m0, s61, 83968
    s_nop 0
    buffer_load_dwordx4 v42, s[8:11], s65 offen lds
    v_mfma_f32_16x16x32_bf16 v[188:191], v[144:147], v[60:63], v[188:191]
    v_mfma_f32_16x16x32_bf16 v[192:195], v[148:151], v[56:59], v[192:195]
    v_mfma_f32_16x16x32_bf16 v[196:199], v[148:151], v[60:63], v[196:199]
    v_mfma_f32_16x16x32_bf16 v[236:239], v[244:247], v[56:59], v[236:239]
    v_mfma_f32_16x16x32_bf16 v[240:243], v[56:59], v[56:59], v[240:243]
    s_waitcnt vmcnt(5)
    s_waitcnt lgkmcnt(0)
    s_barrier
    v_mfma_f32_16x16x32_bf16 v[176:179], v[152:155], v[64:67], v[176:179]
    ds_read_b64_tr_b16 v[128:129], v217 offset:49152
    ds_read_b64_tr_b16 v[130:131], v217 offset:49920
    v_mfma_f32_16x16x32_bf16 v[180:183], v[152:155], v[68:71], v[180:183]
    s_add_u32 s65, s52, s94
    s_add_u32 m0, s60, 65536
    s_nop 0
    buffer_load_dwordx4 v38, s[4:7], s65 offen lds
    ds_read_b64_tr_b16 v[132:133], v218 offset:49152
    ds_read_b64_tr_b16 v[134:135], v218 offset:49920
    v_mfma_f32_16x16x32_bf16 v[224:227], v[152:155], v[244:247], v[224:227]
    ds_read_b64_tr_b16 v[136:137], v219 offset:49152
    ds_read_b64_tr_b16 v[138:139], v219 offset:49920
    v_mfma_f32_16x16x32_bf16 v[184:187], v[156:159], v[64:67], v[184:187]
    ds_read_b64_tr_b16 v[140:141], v220 offset:49152
    ds_read_b64_tr_b16 v[142:143], v220 offset:49920
    v_mfma_f32_16x16x32_bf16 v[188:191], v[156:159], v[68:71], v[188:191]
    s_add_u32 s65, s52, s94
    s_add_u32 m0, s60, 66560
    s_nop 0
    buffer_load_dwordx4 v39, s[4:7], s65 offen lds
    ds_read_b64_tr_b16 v[144:145], v221 offset:49152
    ds_read_b64_tr_b16 v[146:147], v221 offset:49920
    v_mfma_f32_16x16x32_bf16 v[228:231], v[156:159], v[244:247], v[228:231]
    ds_read_b64_tr_b16 v[148:149], v222 offset:49152
    ds_read_b64_tr_b16 v[150:151], v222 offset:49920
    v_mfma_f32_16x16x32_bf16 v[192:195], v[160:163], v[64:67], v[192:195]
    ds_read_b128 v[80:83], v45 offset:32768
    ds_read_b128 v[84:87], v46 offset:32768
    v_mfma_f32_16x16x32_bf16 v[196:199], v[160:163], v[68:71], v[196:199]
    s_add_u32 s65, s53, s99
    s_add_u32 m0, s61, 106496
    s_nop 0
    buffer_load_dwordx4 v40, s[8:11], s65 offen lds
    ds_read_b128 v[88:91], v47 offset:32768
    ds_read_b128 v[92:95], v216 offset:32768
    v_mfma_f32_16x16x32_bf16 v[232:235], v[160:163], v[244:247], v[232:235]
    v_mfma_f32_16x16x32_bf16 v[236:239], v[244:247], v[64:67], v[236:239]
    v_mfma_f32_16x16x32_bf16 v[240:243], v[64:67], v[64:67], v[240:243]
    s_add_u32 s65, s53, s99
    s_add_u32 m0, s61, 107520
    s_nop 0
    buffer_load_dwordx4 v41, s[8:11], s65 offen lds
    v_mfma_f32_16x16x32_bf16 v[176:179], v[164:167], v[72:75], v[176:179]
    v_mfma_f32_16x16x32_bf16 v[180:183], v[164:167], v[76:79], v[180:183]
    v_mfma_f32_16x16x32_bf16 v[184:187], v[168:171], v[72:75], v[184:187]
    s_add_u32 s65, s53, s99
    s_add_u32 m0, s61, 108544
    s_nop 0
    buffer_load_dwordx4 v42, s[8:11], s65 offen lds
    v_mfma_f32_16x16x32_bf16 v[188:191], v[168:171], v[76:79], v[188:191]
    v_mfma_f32_16x16x32_bf16 v[192:195], v[172:175], v[72:75], v[192:195]
    v_mfma_f32_16x16x32_bf16 v[196:199], v[172:175], v[76:79], v[196:199]
    v_mfma_f32_16x16x32_bf16 v[236:239], v[244:247], v[72:75], v[236:239]
    v_mfma_f32_16x16x32_bf16 v[240:243], v[72:75], v[72:75], v[240:243]
    s_waitcnt vmcnt(5)
    s_waitcnt lgkmcnt(0)
    s_barrier
    v_mfma_f32_16x16x32_bf16 v[176:179], v[128:131], v[80:83], v[176:179]
    ds_read_b64_tr_b16 v[152:153], v217 offset:0
    ds_read_b64_tr_b16 v[154:155], v217 offset:768
    v_mfma_f32_16x16x32_bf16 v[180:183], v[128:131], v[84:87], v[180:183]
    s_add_u32 s65, s54, s95
    s_add_u32 m0, s61, 131072
    s_nop 0
    buffer_load_dwordx4 v40, s[8:11], s65 offen lds
    ds_read_b64_tr_b16 v[156:157], v218 offset:0
    ds_read_b64_tr_b16 v[158:159], v218 offset:768
    v_mfma_f32_16x16x32_bf16 v[224:227], v[128:131], v[244:247], v[224:227]
    ds_read_b64_tr_b16 v[160:161], v219 offset:0
    ds_read_b64_tr_b16 v[162:163], v219 offset:768
    v_mfma_f32_16x16x32_bf16 v[184:187], v[132:135], v[80:83], v[184:187]
    ds_read_b64_tr_b16 v[164:165], v220 offset:0
    ds_read_b64_tr_b16 v[166:167], v220 offset:768
    v_mfma_f32_16x16x32_bf16 v[188:191], v[132:135], v[84:87], v[188:191]
    s_add_u32 s65, s54, s95
    s_add_u32 m0, s61, 132096
    s_nop 0
    buffer_load_dwordx4 v41, s[8:11], s65 offen lds
    ds_read_b64_tr_b16 v[168:169], v221 offset:0
    ds_read_b64_tr_b16 v[170:171], v221 offset:768
    v_mfma_f32_16x16x32_bf16 v[228:231], v[132:135], v[244:247], v[228:231]
    ds_read_b64_tr_b16 v[172:173], v222 offset:0
    ds_read_b64_tr_b16 v[174:175], v222 offset:768
    v_mfma_f32_16x16x32_bf16 v[192:195], v[136:139], v[80:83], v[192:195]
    ds_read_b128 v[96:99], v45 offset:49152
    ds_read_b128 v[100:103], v46 offset:49152
    v_mfma_f32_16x16x32_bf16 v[196:199], v[136:139], v[84:87], v[196:199]
    s_add_u32 s65, s54, s95
    s_add_u32 m0, s61, 133120
    s_nop 0
    buffer_load_dwordx4 v42, s[8:11], s65 offen lds
    ds_read_b128 v[104:107], v47 offset:49152
    ds_read_b128 v[108:111], v216 offset:49152
    v_mfma_f32_16x16x32_bf16 v[232:235], v[136:139], v[244:247], v[232:235]
    v_mfma_f32_16x16x32_bf16 v[236:239], v[244:247], v[80:83], v[236:239]
    v_mfma_f32_16x16x32_bf16 v[240:243], v[80:83], v[80:83], v[240:243]
    v_mfma_f32_16x16x32_bf16 v[176:179], v[140:143], v[88:91], v[176:179]
    v_mfma_f32_16x16x32_bf16 v[180:183], v[140:143], v[92:95], v[180:183]
    v_mfma_f32_16x16x32_bf16 v[184:187], v[144:147], v[88:91], v[184:187]
    v_mfma_f32_16x16x32_bf16 v[188:191], v[144:147], v[92:95], v[188:191]
    v_mfma_f32_16x16x32_bf16 v[192:195], v[148:151], v[88:91], v[192:195]
    v_mfma_f32_16x16x32_bf16 v[196:199], v[148:151], v[92:95], v[196:199]
    v_mfma_f32_16x16x32_bf16 v[236:239], v[244:247], v[88:91], v[236:239]
    v_mfma_f32_16x16x32_bf16 v[240:243], v[88:91], v[88:91], v[240:243]
    s_waitcnt vmcnt(3)
    s_waitcnt lgkmcnt(0)
    s_barrier
    v_mfma_f32_16x16x32_bf16 v[176:179], v[152:155], v[96:99], v[176:179]
    ds_read_b64_tr_b16 v[128:129], v217 offset:24576
    ds_read_b64_tr_b16 v[130:131], v217 offset:25344
    v_mfma_f32_16x16x32_bf16 v[180:183], v[152:155], v[100:103], v[180:183]
    s_add_u32 s65, s54, s96
    s_add_u32 m0, s61, 81920
    s_nop 0
    buffer_load_dwordx4 v40, s[8:11], s65 offen lds
    ds_read_b64_tr_b16 v[132:133], v218 offset:24576
    ds_read_b64_tr_b16 v[134:135], v218 offset:25344
    v_mfma_f32_16x16x32_bf16 v[224:227], v[152:155], v[244:247], v[224:227]
    ds_read_b64_tr_b16 v[136:137], v219 offset:24576
    ds_read_b64_tr_b16 v[138:139], v219 offset:25344
    v_mfma_f32_16x16x32_bf16 v[184:187], v[156:159], v[96:99], v[184:187]
    ds_read_b64_tr_b16 v[140:141], v220 offset:24576
    ds_read_b64_tr_b16 v[142:143], v220 offset:25344
    v_mfma_f32_16x16x32_bf16 v[188:191], v[156:159], v[100:103], v[188:191]
    s_add_u32 s65, s54, s96
    s_add_u32 m0, s61, 82944
    s_nop 0
    buffer_load_dwordx4 v41, s[8:11], s65 offen lds
    ds_read_b64_tr_b16 v[144:145], v221 offset:24576
    ds_read_b64_tr_b16 v[146:147], v221 offset:25344
    v_mfma_f32_16x16x32_bf16 v[228:231], v[156:159], v[244:247], v[228:231]
    ds_read_b64_tr_b16 v[148:149], v222 offset:24576
    ds_read_b64_tr_b16 v[150:151], v222 offset:25344
    v_mfma_f32_16x16x32_bf16 v[192:195], v[160:163], v[96:99], v[192:195]
    v_add_u32 v45, 0x10000, v45
    v_add_u32 v46, 0x10000, v46
    v_add_u32 v47, 0x10000, v47
    v_add_u32 v216, 0x10000, v216
    ds_read_b128 v[112:115], v45 offset:0
    ds_read_b128 v[116:119], v46 offset:0
    v_mfma_f32_16x16x32_bf16 v[196:199], v[160:163], v[100:103], v[196:199]
    s_add_u32 s65, s54, s96
    s_add_u32 m0, s61, 83968
    s_nop 0
    buffer_load_dwordx4 v42, s[8:11], s65 offen lds
    ds_read_b128 v[120:123], v47 offset:0
    ds_read_b128 v[124:127], v216 offset:0
    v_mfma_f32_16x16x32_bf16 v[232:235], v[160:163], v[244:247], v[232:235]
    v_mfma_f32_16x16x32_bf16 v[236:239], v[244:247], v[96:99], v[236:239]
    v_mfma_f32_16x16x32_bf16 v[240:243], v[96:99], v[96:99], v[240:243]
    v_mfma_f32_16x16x32_bf16 v[176:179], v[164:167], v[104:107], v[176:179]
    v_mfma_f32_16x16x32_bf16 v[180:183], v[164:167], v[108:111], v[180:183]
    v_mfma_f32_16x16x32_bf16 v[184:187], v[168:171], v[104:107], v[184:187]
    v_mfma_f32_16x16x32_bf16 v[188:191], v[168:171], v[108:111], v[188:191]
    v_mfma_f32_16x16x32_bf16 v[192:195], v[172:175], v[104:107], v[192:195]
    v_mfma_f32_16x16x32_bf16 v[196:199], v[172:175], v[108:111], v[196:199]
    v_mfma_f32_16x16x32_bf16 v[236:239], v[244:247], v[104:107], v[236:239]
    v_mfma_f32_16x16x32_bf16 v[240:243], v[104:107], v[104:107], v[240:243]
    s_waitcnt vmcnt(3)
    s_waitcnt lgkmcnt(0)
    s_barrier
    v_mfma_f32_16x16x32_bf16 v[176:179], v[128:131], v[112:115], v[176:179]
    ds_read_b64_tr_b16 v[152:153], v217 offset:49152
    ds_read_b64_tr_b16 v[154:155], v217 offset:49920
    v_mfma_f32_16x16x32_bf16 v[180:183], v[128:131], v[116:119], v[180:183]
    s_add_u32 s65, s54, s97
    s_add_u32 m0, s61, 106496
    s_nop 0
    buffer_load_dwordx4 v40, s[8:11], s65 offen lds
    ds_read_b64_tr_b16 v[156:157], v218 offset:49152
    ds_read_b64_tr_b16 v[158:159], v218 offset:49920
    v_mfma_f32_16x16x32_bf16 v[224:227], v[128:131], v[244:247], v[224:227]
    ds_read_b64_tr_b16 v[160:161], v219 offset:49152
    ds_read_b64_tr_b16 v[162:163], v219 offset:49920
    v_mfma_f32_16x16x32_bf16 v[184:187], v[132:135], v[112:115], v[184:187]
    ds_read_b64_tr_b16 v[164:165], v220 offset:49152
    ds_read_b64_tr_b16 v[166:167], v220 offset:49920
    v_mfma_f32_16x16x32_bf16 v[188:191], v[132:135], v[116:119], v[188:191]
    s_add_u32 s65, s54, s97
    s_add_u32 m0, s61, 107520
    s_nop 0
    buffer_load_dwordx4 v41, s[8:11], s65 offen lds
    ds_read_b64_tr_b16 v[168:169], v221 offset:49152
    ds_read_b64_tr_b16 v[170:171], v221 offset:49920
    v_mfma_f32_16x16x32_bf16 v[228:231], v[132:135], v[244:247], v[228:231]
    ds_read_b64_tr_b16 v[172:173], v222 offset:49152
    ds_read_b64_tr_b16 v[174:175], v222 offset:49920
    v_mfma_f32_16x16x32_bf16 v[192:195], v[136:139], v[112:115], v[192:195]
    v_mfma_f32_16x16x32_bf16 v[196:199], v[136:139], v[116:119], v[196:199]
    s_add_u32 s65, s54, s97
    s_add_u32 m0, s61, 108544
    s_nop 0
    buffer_load_dwordx4 v42, s[8:11], s65 offen lds
    v_mfma_f32_16x16x32_bf16 v[232:235], v[136:139], v[244:247], v[232:235]
    v_mfma_f32_16x16x32_bf16 v[236:239], v[244:247], v[112:115], v[236:239]
    v_mfma_f32_16x16x32_bf16 v[240:243], v[112:115], v[112:115], v[240:243]
    v_mfma_f32_16x16x32_bf16 v[176:179], v[140:143], v[120:123], v[176:179]
    v_mfma_f32_16x16x32_bf16 v[180:183], v[140:143], v[124:127], v[180:183]
    v_mfma_f32_16x16x32_bf16 v[184:187], v[144:147], v[120:123], v[184:187]
    v_mfma_f32_16x16x32_bf16 v[188:191], v[144:147], v[124:127], v[188:191]
    v_mfma_f32_16x16x32_bf16 v[192:195], v[148:151], v[120:123], v[192:195]
    v_mfma_f32_16x16x32_bf16 v[196:199], v[148:151], v[124:127], v[196:199]
    v_mfma_f32_16x16x32_bf16 v[236:239], v[244:247], v[120:123], v[236:239]
    v_mfma_f32_16x16x32_bf16 v[240:243], v[120:123], v[120:123], v[240:243]
    v_lshl_add_u32 v4, v1, 4, s70
    v_lshl_add_u32 v5, v2, 4, s72
    ds_write_b128 v4, v[180:183] offset:0
    s_nop 0
    ds_write_b128 v4, v[188:191] offset:1024
    s_nop 0
    ds_write_b128 v4, v[196:199] offset:2048
    s_mov_b32 exec_lo, 0x00010001
    s_mov_b32 exec_hi, 0x00010001
    ds_write_b128 v5, v[224:227] offset:0
    ds_write_b128 v5, v[228:231] offset:64
    ds_write_b128 v5, v[232:235] offset:128
    s_mov_b64 exec, -1
    v_and_b32 v8, 3, v3
    v_cmp_eq_u32 vcc, 1, v8
    s_nop 1
    v_cndmask_b32 v237, v240, v241, vcc
    v_cmp_eq_u32 vcc, 2, v8
    s_nop 1
    v_cndmask_b32 v237, v237, v242, vcc
    v_cmp_eq_u32 vcc, 3, v8
    s_nop 1
    v_cndmask_b32 v237, v237, v243, vcc
    v_lshl_add_u32 v6, v3, 3, s74
    s_mov_b32 exec_lo, 0x00F0000F
    s_mov_b32 exec_hi, 0xF0000F00
    ds_write_b64 v6, v[236:237]
    s_mov_b64 exec, -1
    v_pk_add_f32 v[200:201], v[176:177], 0
    v_pk_add_f32 v[202:203], v[178:179], 0
    v_pk_add_f32 v[204:205], v[184:185], 0
    v_pk_add_f32 v[206:207], v[186:187], 0
    v_pk_add_f32 v[208:209], v[192:193], 0
    v_pk_add_f32 v[210:211], v[194:195], 0
    v_mov_b32 v238, 0xc0135761
    v_mov_b32 v239, 0xc0135761
    s_waitcnt vmcnt(3)
    s_waitcnt lgkmcnt(0)
    s_barrier
    v_lshl_add_u32 v4, v1, 4, s71
    v_lshl_add_u32 v5, v3, 3, s75
    ds_read_b64 v[20:21], v5
    ds_read_b64 v[22:23], v5 offset:128
    ds_read_b128 v[8:11], v4 offset:0
    ds_read_b128 v[12:15], v4 offset:1024
    ds_read_b128 v[16:19], v4 offset:2048
    v_lshl_add_u32 v6, v2, 4, s73
    ds_read_b128 v[24:27], v6 offset:0
    ds_read_b128 v[28:31], v6 offset:64
    ds_read_b128 v[32:35], v6 offset:128
    ds_read_b128 v[176:179], v6 offset:192
    ds_read_b128 v[180:183], v6 offset:256
    ds_read_b128 v[184:187], v6 offset:320
    ds_read_b128 v[188:191], v6 offset:384
    ds_read_b128 v[192:195], v6 offset:448
    ds_read_b128 v[196:199], v6 offset:512
    ds_read_b128 v[224:227], v6 offset:576
    ds_read_b128 v[228:231], v6 offset:640
    ds_read_b128 v[232:235], v6 offset:704
    s_waitcnt lgkmcnt(15)
    v_pk_add_f32 v[240:241], v[20:21], v[22:23]
    v_mul_f32 v240, 0x3acccccd, v240
    v_mul_f32 v241, 0x3acccccd, v241
    v_fma_f32 v241, -v240, v240, v241
    v_max_f32 v241, 0, v241
    v_cvt_pk_bf16_f32 v241, v241, v240
    v_and_b32 v240, 0xffff0000, v241
    v_lshlrev_b32 v241, 16, v241
    v_add_f32 v241, s55, v241
    v_cvt_pk_bf16_f32 v241, v241, v241
    v_and_b32 v241, 0xffff0000, v241
    v_sqrt_f32 v241, v241
    s_nop 0
    v_cvt_pk_bf16_f32 v241, v241, v241
    v_and_b32 v241, 0xffff0000, v241
    v_rcp_f32 v241, v241
    s_nop 0
    v_mov_b32 v242, v241
    s_waitcnt lgkmcnt(12)
    v_pk_add_f32 v[200:201], v[200:201], v[8:9]
    v_pk_add_f32 v[202:203], v[202:203], v[10:11]
    v_pk_add_f32 v[204:205], v[204:205], v[12:13]
    v_pk_add_f32 v[206:207], v[206:207], v[14:15]
    v_pk_add_f32 v[208:209], v[208:209], v[16:17]
    v_pk_add_f32 v[210:211], v[210:211], v[18:19]
    s_waitcnt lgkmcnt(6)
    v_pk_add_f32 v[24:25], v[24:25], v[176:177]
    v_pk_add_f32 v[26:27], v[26:27], v[178:179]
    v_pk_add_f32 v[28:29], v[28:29], v[180:181]
    v_pk_add_f32 v[30:31], v[30:31], v[182:183]
    v_pk_add_f32 v[32:33], v[32:33], v[184:185]
    v_pk_add_f32 v[34:35], v[34:35], v[186:187]
    s_waitcnt lgkmcnt(0)
    v_pk_add_f32 v[188:189], v[188:189], v[224:225]
    v_pk_add_f32 v[190:191], v[190:191], v[226:227]
    v_pk_add_f32 v[192:193], v[192:193], v[228:229]
    v_pk_add_f32 v[194:195], v[194:195], v[230:231]
    v_pk_add_f32 v[196:197], v[196:197], v[232:233]
    v_pk_add_f32 v[198:199], v[198:199], v[234:235]
    v_pk_add_f32 v[24:25], v[24:25], v[188:189]
    v_pk_add_f32 v[26:27], v[26:27], v[190:191]
    v_pk_add_f32 v[28:29], v[28:29], v[192:193]
    v_pk_add_f32 v[30:31], v[30:31], v[194:195]
    v_pk_add_f32 v[32:33], v[32:33], v[196:197]
    v_pk_add_f32 v[34:35], v[34:35], v[198:199]
    v_pk_fma_f32 v[200:201], v[24:25], v[240:241], v[200:201] op_sel_hi:[1,0,1] neg_lo:[0,1,0] neg_hi:[0,1,0]
    v_pk_fma_f32 v[202:203], v[26:27], v[240:241], v[202:203] op_sel_hi:[1,0,1] neg_lo:[0,1,0] neg_hi:[0,1,0]
    v_pk_fma_f32 v[204:205], v[28:29], v[240:241], v[204:205] op_sel_hi:[1,0,1] neg_lo:[0,1,0] neg_hi:[0,1,0]
    v_pk_fma_f32 v[206:207], v[30:31], v[240:241], v[206:207] op_sel_hi:[1,0,1] neg_lo:[0,1,0] neg_hi:[0,1,0]
    v_pk_fma_f32 v[208:209], v[32:33], v[240:241], v[208:209] op_sel_hi:[1,0,1] neg_lo:[0,1,0] neg_hi:[0,1,0]
    v_pk_fma_f32 v[210:211], v[34:35], v[240:241], v[210:211] op_sel_hi:[1,0,1] neg_lo:[0,1,0] neg_hi:[0,1,0]
    v_pk_mul_f32 v[200:201], v[200:201], v[242:243] op_sel_hi:[1,0]
    v_pk_mul_f32 v[202:203], v[202:203], v[242:243] op_sel_hi:[1,0]
    v_pk_mul_f32 v[204:205], v[204:205], v[242:243] op_sel_hi:[1,0]
    v_pk_mul_f32 v[206:207], v[206:207], v[242:243] op_sel_hi:[1,0]
    v_pk_mul_f32 v[208:209], v[208:209], v[242:243] op_sel_hi:[1,0]
    v_pk_mul_f32 v[210:211], v[210:211], v[242:243] op_sel_hi:[1,0]
    v_pk_mul_f32 v[8:9], v[200:201], v[200:201]
    v_pk_mul_f32 v[10:11], v[202:203], v[202:203]
    v_pk_mul_f32 v[12:13], v[204:205], v[204:205]
    v_pk_mul_f32 v[14:15], v[206:207], v[206:207]
    v_pk_mul_f32 v[16:17], v[208:209], v[208:209]
    v_pk_mul_f32 v[18:19], v[210:211], v[210:211]
    v_pk_fma_f32 v[8:9], v[8:9], s[58:59], v[238:239]
    v_pk_fma_f32 v[10:11], v[10:11], s[58:59], v[238:239]
    v_pk_fma_f32 v[12:13], v[12:13], s[58:59], v[238:239]
    v_pk_fma_f32 v[14:15], v[14:15], s[58:59], v[238:239]
    v_pk_fma_f32 v[16:17], v[16:17], s[58:59], v[238:239]
    v_pk_fma_f32 v[18:19], v[18:19], s[58:59], v[238:239]
    v_pk_mul_f32 v[8:9], v[8:9], v[200:201]
    v_pk_mul_f32 v[10:11], v[10:11], v[202:203]
    v_pk_mul_f32 v[12:13], v[12:13], v[204:205]
    v_pk_mul_f32 v[14:15], v[14:15], v[206:207]
    v_pk_mul_f32 v[16:17], v[16:17], v[208:209]
    v_pk_mul_f32 v[18:19], v[18:19], v[210:211]
    v_exp_f32 v8, v8
    v_exp_f32 v9, v9
    v_exp_f32 v10, v10
    v_exp_f32 v11, v11
    v_exp_f32 v12, v12
    v_exp_f32 v13, v13
    v_exp_f32 v14, v14
    v_exp_f32 v15, v15
    v_exp_f32 v16, v16
    v_exp_f32 v17, v17
    v_exp_f32 v18, v18
    v_exp_f32 v19, v19
    v_pk_add_f32 v[8:9], v[8:9], 1.0 op_sel_hi:[1,0]
    v_pk_add_f32 v[10:11], v[10:11], 1.0 op_sel_hi:[1,0]
    v_pk_add_f32 v[12:13], v[12:13], 1.0 op_sel_hi:[1,0]
    v_pk_add_f32 v[14:15], v[14:15], 1.0 op_sel_hi:[1,0]
    v_pk_add_f32 v[16:17], v[16:17], 1.0 op_sel_hi:[1,0]
    v_pk_add_f32 v[18:19], v[18:19], 1.0 op_sel_hi:[1,0]
    v_rcp_f32 v8, v8
    v_rcp_f32 v9, v9
    v_rcp_f32 v10, v10
    v_rcp_f32 v11, v11
    v_rcp_f32 v12, v12
    v_rcp_f32 v13, v13
    v_rcp_f32 v14, v14
    v_rcp_f32 v15, v15
    v_rcp_f32 v16, v16
    v_rcp_f32 v17, v17
    v_rcp_f32 v18, v18
    v_rcp_f32 v19, v19
    v_pk_mul_f32 v[200:201], v[200:201], v[8:9]
    v_pk_mul_f32 v[202:203], v[202:203], v[10:11]
    v_pk_mul_f32 v[204:205], v[204:205], v[12:13]
    v_pk_mul_f32 v[206:207], v[206:207], v[14:15]
    v_pk_mul_f32 v[208:209], v[208:209], v[16:17]
    v_pk_mul_f32 v[210:211], v[210:211], v[18:19]
    v_pk_add_f32 v[14:15], v[200:201], v[202:203]
    v_pk_mul_f32 v[16:17], v[200:201], v[200:201]
    v_pk_add_f32 v[18:19], v[204:205], v[206:207]
    v_pk_fma_f32 v[16:17], v[202:203], v[202:203], v[16:17]
    v_pk_add_f32 v[20:21], v[208:209], v[210:211]
    v_pk_fma_f32 v[16:17], v[204:205], v[204:205], v[16:17]
    v_pk_add_f32 v[14:15], v[14:15], v[18:19]
    v_pk_fma_f32 v[16:17], v[206:207], v[206:207], v[16:17]
    v_pk_add_f32 v[14:15], v[14:15], v[20:21]
    v_pk_fma_f32 v[16:17], v[208:209], v[208:209], v[16:17]
    v_pk_fma_f32 v[16:17], v[210:211], v[210:211], v[16:17]
    v_add_f32 v8, v14, v15
    v_add_f32 v9, v16, v17
    v_lshl_add_u32 v4, v3, 3, s76
    v_mov_b32 v12, v8
    v_mov_b32 v13, v9
    s_nop 0
    v_permlane16_swap_b32 v8, v12
    v_permlane16_swap_b32 v9, v13
    v_add_f32 v8, v8, v12
    v_add_f32 v9, v9, v13
    v_mov_b32 v12, v8
    v_mov_b32 v13, v9
    s_nop 0
    v_permlane32_swap_b32 v8, v12
    v_permlane32_swap_b32 v9, v13
    v_add_f32 v8, v8, v12
    v_add_f32 v9, v9, v13
    s_mov_b64 exec, 0xffff
    ds_write_b64 v4, v[8:9]
    s_mov_b64 exec, -1
    s_or_b32 s48, s41, s43
    s_cmp_eq_u32 s48, 0
    v_lshlrev_b32 v4, 3, v3
    s_cselect_b64 exec, 0xffff, 0
    buffer_store_dwordx2 v[240:241], v4, s[24:27], s79 offen sc1
    s_mov_b64 exec, -1
    v_mfma_f32_16x16x32_bf16 v[176:179], v[152:155], v[48:51], 0
    ds_read_b64_tr_b16 v[128:129], v217 offset:0
    ds_read_b64_tr_b16 v[130:131], v217 offset:768
    v_mfma_f32_16x16x32_bf16 v[180:183], v[152:155], v[52:55], 0
    s_add_u32 s65, s54, s98
    s_add_u32 m0, s61, 131072
    s_nop 0
    buffer_load_dwordx4 v40, s[8:11], s65 offen lds
    ds_read_b64_tr_b16 v[132:133], v218 offset:0
    ds_read_b64_tr_b16 v[134:135], v218 offset:768
    v_mfma_f32_16x16x32_bf16 v[224:227], v[152:155], v[244:247], 0
    ds_read_b64_tr_b16 v[136:137], v219 offset:0
    ds_read_b64_tr_b16 v[138:139], v219 offset:768
    v_mfma_f32_16x16x32_bf16 v[184:187], v[156:159], v[48:51], 0
    ds_read_b64_tr_b16 v[140:141], v220 offset:0
    ds_read_b64_tr_b16 v[142:143], v220 offset:768
    v_mfma_f32_16x16x32_bf16 v[188:191], v[156:159], v[52:55], 0
    s_add_u32 s65, s54, s98
    s_add_u32 m0, s61, 132096
    s_nop 0
    buffer_load_dwordx4 v41, s[8:11], s65 offen lds
    ds_read_b64_tr_b16 v[144:145], v221 offset:0
    ds_read_b64_tr_b16 v[146:147], v221 offset:768
    v_mfma_f32_16x16x32_bf16 v[228:231], v[156:159], v[244:247], 0
    ds_read_b64_tr_b16 v[148:149], v222 offset:0
    ds_read_b64_tr_b16 v[150:151], v222 offset:768
    v_mfma_f32_16x16x32_bf16 v[192:195], v[160:163], v[48:51], 0
    v_mfma_f32_16x16x32_bf16 v[196:199], v[160:163], v[52:55], 0
    s_add_u32 s65, s54, s98
    s_add_u32 m0, s61, 133120
    s_nop 0
    buffer_load_dwordx4 v42, s[8:11], s65 offen lds
    v_mfma_f32_16x16x32_bf16 v[232:235], v[160:163], v[244:247], 0
    v_mfma_f32_16x16x32_bf16 v[176:179], v[164:167], v[56:59], v[176:179]
    v_mfma_f32_16x16x32_bf16 v[180:183], v[164:167], v[60:63], v[180:183]
    v_mul_u32_u24 v4, 1280, v43
    v_lshl_add_u32 v4, v44, 4, v4
    s_mul_i32 s51, s41, 160
    s_add_u32 s51, s51, s52
    s_mul_i32 s48, s42, 7680
    s_add_u32 s48, s48, s51
    s_sub_i32 s48, s48, 3840
    s_cmp_lt_i32 s48, 0
    s_cselect_b32 s49, 3840, 0
    s_add_u32 s48, s48, s49
    v_subrev_u32 v5, s49, v4
    s_mul_i32 s50, s42, 960
    s_add_u32 m0, s50, 65536
    s_mov_b32 exec_lo, -1
    s_mov_b32 exec_hi, 0xfffffff
    buffer_load_dwordx4 v5, s[12:15], s48 offen lds
    s_mov_b64 exec, -1
    v_mfma_f32_16x16x32_bf16 v[184:187], v[168:171], v[56:59], v[184:187]
    v_mfma_f32_16x16x32_bf16 v[188:191], v[168:171], v[60:63], v[188:191]
    v_mfma_f32_16x16x32_bf16 v[192:195], v[172:175], v[56:59], v[192:195]
    s_cmp_ge_u32 s42, 4
    s_mov_b32 exec_lo, -1
    s_mov_b32 exec_hi, 0xfffffff
    s_cbranch_scc1 k1_kvv_2
    s_mul_i32 s48, s42, 7680
    s_add_u32 s48, s48, s51
    s_add_u32 s48, s48, 57600
    s_mul_i32 s50, s42, 960
    s_add_u32 m0, s50, 73216
    s_nop 0
    buffer_load_dwordx4 v4, s[12:15], s48 offen lds
    s_branch k1_kve_3
k1_kvv_2:
    s_sub_u32 s49, s42, 4
    s_mul_i32 s48, s49, 7680
    s_add_u32 s48, s48, s51
    s_mul_i32 s50, s49, 960
    s_add_u32 m0, s50, 49152
    s_nop 0
    buffer_load_dwordx4 v4, s[16:19], s48 offen lds
k1_kve_3:
    s_mov_b64 exec, -1
    v_mfma_f32_16x16x32_bf16 v[196:199], v[172:175], v[60:63], v[196:199]
    s_add_u32 s49, s42, 4
    s_mul_i32 s48, s49, 7680
    s_add_u32 s48, s48, s51
    s_mul_i32 s50, s49, 960
    s_add_u32 m0, s50, 49152
    s_mov_b32 exec_lo, -1
    s_mov_b32 exec_hi, 0xfffffff
    buffer_load_dwordx4 v4, s[16:19], s48 offen lds
    s_mov_b64 exec, -1
    s_waitcnt vmcnt(7)
    s_waitcnt lgkmcnt(0)
    s_barrier
    s_cmp_lg_u32 s42, 0
    s_cbranch_scc1 k1_pub_4
    v_lshlrev_b32 v4, 3, v1
    v_add_u32 v5, 159744, v4
    ds_read_b64 v[8:9], v5
    ds_read_b64 v[12:13], v5 offset:512
    v_lshlrev_b32 v4, 4, v1
    v_mov_b32 v10, s100
    v_mov_b32 v11, s101
    s_waitcnt lgkmcnt(0)
    v_pk_add_f32 v[8:9], v[8:9], v[12:13]
k1_pub_4:
    s_cmp_eq_u32 s42, 0
    s_cselect_b64 exec, -1, 0
    buffer_store_dwordx4 v[8:11], v4, s[24:27], s77 offen sc1
    s_mov_b64 exec, -1
    v_mfma_f32_16x16x32_bf16 v[176:179], v[128:131], v[64:67], v[176:179]
    ds_read_b64_tr_b16 v[152:153], v217 offset:24576
    ds_read_b64_tr_b16 v[154:155], v217 offset:25344
    v_mfma_f32_16x16x32_bf16 v[180:183], v[128:131], v[68:71], v[180:183]
    s_add_u32 s65, s54, s99
    s_add_u32 m0, s61, 81920
    s_nop 0
    buffer_load_dwordx4 v40, s[8:11], s65 offen lds
    ds_read_b64_tr_b16 v[156:157], v218 offset:24576
    ds_read_b64_tr_b16 v[158:159], v218 offset:25344
    v_mfma_f32_16x16x32_bf16 v[224:227], v[128:131], v[244:247], v[224:227]
    ds_read_b64_tr_b16 v[160:161], v219 offset:24576
    ds_read_b64_tr_b16 v[162:163], v219 offset:25344
    v_mfma_f32_16x16x32_bf16 v[184:187], v[132:135], v[64:67], v[184:187]
    ds_read_b64_tr_b16 v[164:165], v220 offset:24576
    ds_read_b64_tr_b16 v[166:167], v220 offset:25344
    v_mfma_f32_16x16x32_bf16 v[188:191], v[132:135], v[68:71], v[188:191]
    s_add_u32 s65, s54, s99
    s_add_u32 m0, s61, 82944
    s_nop 0
    buffer_load_dwordx4 v41, s[8:11], s65 offen lds
    ds_read_b64_tr_b16 v[168:169], v221 offset:24576
    ds_read_b64_tr_b16 v[170:171], v221 offset:25344
    v_mfma_f32_16x16x32_bf16 v[228:231], v[132:135], v[244:247], v[228:231]
    ds_read_b64_tr_b16 v[172:173], v222 offset:24576
    ds_read_b64_tr_b16 v[174:175], v222 offset:25344
    v_mfma_f32_16x16x32_bf16 v[192:195], v[136:139], v[64:67], v[192:195]
    v_mfma_f32_16x16x32_bf16 v[196:199], v[136:139], v[68:71], v[196:199]
    s_add_u32 s65, s54, s99
    s_add_u32 m0, s61, 83968
    s_nop 0
    buffer_load_dwordx4 v42, s[8:11], s65 offen lds
    v_mfma_f32_16x16x32_bf16 v[232:235], v[136:139], v[244:247], v[232:235]
    v_mfma_f32_16x16x32_bf16 v[176:179], v[140:143], v[72:75], v[176:179]
    v_mfma_f32_16x16x32_bf16 v[180:183], v[140:143], v[76:79], v[180:183]
    v_mfma_f32_16x16x32_bf16 v[184:187], v[144:147], v[72:75], v[184:187]
    v_mfma_f32_16x16x32_bf16 v[188:191], v[144:147], v[76:79], v[188:191]
    v_mfma_f32_16x16x32_bf16 v[192:195], v[148:151], v[72:75], v[192:195]
    v_mfma_f32_16x16x32_bf16 v[196:199], v[148:151], v[76:79], v[196:199]
    s_waitcnt vmcnt(7)
    s_waitcnt lgkmcnt(0)
    s_barrier
    v_mfma_f32_16x16x32_bf16 v[176:179], v[152:155], v[80:83], v[176:179]
    ds_read_b64_tr_b16 v[128:129], v217 offset:49152
    ds_read_b64_tr_b16 v[130:131], v217 offset:49920
    v_mfma_f32_16x16x32_bf16 v[180:183], v[152:155], v[84:87], v[180:183]
    ds_read_b64_tr_b16 v[132:133], v218 offset:49152
    ds_read_b64_tr_b16 v[134:135], v218 offset:49920
    v_mfma_f32_16x16x32_bf16 v[224:227], v[152:155], v[244:247], v[224:227]
    ds_read_b64_tr_b16 v[136:137], v219 offset:49152
    ds_read_b64_tr_b16 v[138:139], v219 offset:49920
    v_mfma_f32_16x16x32_bf16 v[184:187], v[156:159], v[80:83], v[184:187]
    ds_read_b64_tr_b16 v[140:141], v220 offset:49152
    ds_read_b64_tr_b16 v[142:143], v220 offset:49920
    v_mfma_f32_16x16x32_bf16 v[188:191], v[156:159], v[84:87], v[188:191]
    ds_read_b64_tr_b16 v[144:145], v221 offset:49152
    ds_read_b64_tr_b16 v[146:147], v221 offset:49920
    v_mfma_f32_16x16x32_bf16 v[228:231], v[156:159], v[244:247], v[228:231]
    ds_read_b64_tr_b16 v[148:149], v222 offset:49152
    ds_read_b64_tr_b16 v[150:151], v222 offset:49920
    v_mfma_f32_16x16x32_bf16 v[192:195], v[160:163], v[80:83], v[192:195]
    v_mfma_f32_16x16x32_bf16 v[196:199], v[160:163], v[84:87], v[196:199]
    v_mfma_f32_16x16x32_bf16 v[232:235], v[160:163], v[244:247], v[232:235]
    v_mfma_f32_16x16x32_bf16 v[176:179], v[164:167], v[88:91], v[176:179]
    v_mfma_f32_16x16x32_bf16 v[180:183], v[164:167], v[92:95], v[180:183]
    v_mfma_f32_16x16x32_bf16 v[184:187], v[168:171], v[88:91], v[184:187]
    v_mfma_f32_16x16x32_bf16 v[188:191], v[168:171], v[92:95], v[188:191]
    v_mfma_f32_16x16x32_bf16 v[192:195], v[172:175], v[88:91], v[192:195]
    v_mfma_f32_16x16x32_bf16 v[196:199], v[172:175], v[92:95], v[196:199]
    s_waitcnt vmcnt(0)
    s_waitcnt lgkmcnt(0)
    s_barrier
    v_mfma_f32_16x16x32_bf16 v[176:179], v[128:131], v[96:99], v[176:179]
    ds_read_b64_tr_b16 v[152:153], v217 offset:0
    ds_read_b64_tr_b16 v[154:155], v217 offset:768
    v_mfma_f32_16x16x32_bf16 v[180:183], v[128:131], v[100:103], v[180:183]
    ds_read_b64_tr_b16 v[156:157], v218 offset:0
    ds_read_b64_tr_b16 v[158:159], v218 offset:768
    v_mfma_f32_16x16x32_bf16 v[224:227], v[128:131], v[244:247], v[224:227]
    ds_read_b64_tr_b16 v[160:161], v219 offset:0
    ds_read_b64_tr_b16 v[162:163], v219 offset:768
    v_mfma_f32_16x16x32_bf16 v[184:187], v[132:135], v[96:99], v[184:187]
    ds_read_b64_tr_b16 v[164:165], v220 offset:0
    ds_read_b64_tr_b16 v[166:167], v220 offset:768
    v_mfma_f32_16x16x32_bf16 v[188:191], v[132:135], v[100:103], v[188:191]
    ds_read_b64_tr_b16 v[168:169], v221 offset:0
    ds_read_b64_tr_b16 v[170:171], v221 offset:768
    v_mfma_f32_16x16x32_bf16 v[228:231], v[132:135], v[244:247], v[228:231]
    ds_read_b64_tr_b16 v[172:173], v222 offset:0
    ds_read_b64_tr_b16 v[174:175], v222 offset:768
    v_mfma_f32_16x16x32_bf16 v[192:195], v[136:139], v[96:99], v[192:195]
    v_mfma_f32_16x16x32_bf16 v[196:199], v[136:139], v[100:103], v[196:199]
    v_mfma_f32_16x16x32_bf16 v[232:235], v[136:139], v[244:247], v[232:235]
    v_mfma_f32_16x16x32_bf16 v[176:179], v[140:143], v[104:107], v[176:179]
    v_mfma_f32_16x16x32_bf16 v[180:183], v[140:143], v[108:111], v[180:183]
    v_mfma_f32_16x16x32_bf16 v[184:187], v[144:147], v[104:107], v[184:187]
    v_mfma_f32_16x16x32_bf16 v[188:191], v[144:147], v[108:111], v[188:191]
    v_mfma_f32_16x16x32_bf16 v[192:195], v[148:151], v[104:107], v[192:195]
    v_mfma_f32_16x16x32_bf16 v[196:199], v[148:151], v[108:111], v[196:199]
    s_waitcnt lgkmcnt(0)
    s_barrier
    v_lshlrev_b32 v38, 4, v3
    v_lshl_add_u32 v38, v2, 11, v38
    buffer_load_dwordx4 v[28:31], v38, s[24:27], s78 offen sc1
    buffer_load_dwordx4 v[32:35], v38, s[24:27], s78 offen offset:1024 sc1
    v_mfma_f32_16x16x32_bf16 v[176:179], v[152:155], v[112:115], v[176:179]
    v_mfma_f32_16x16x32_bf16 v[180:183], v[152:155], v[116:119], v[180:183]
    v_mfma_f32_16x16x32_bf16 v[224:227], v[152:155], v[244:247], v[224:227]
    v_mfma_f32_16x16x32_bf16 v[184:187], v[156:159], v[112:115], v[184:187]
    v_mfma_f32_16x16x32_bf16 v[188:191], v[156:159], v[116:119], v[188:191]
    v_mfma_f32_16x16x32_bf16 v[228:231], v[156:159], v[244:247], v[228:231]
    v_mfma_f32_16x16x32_bf16 v[192:195], v[160:163], v[112:115], v[192:195]
    v_mfma_f32_16x16x32_bf16 v[196:199], v[160:163], v[116:119], v[196:199]
    v_mfma_f32_16x16x32_bf16 v[232:235], v[160:163], v[244:247], v[232:235]
    v_mfma_f32_16x16x32_bf16 v[176:179], v[164:167], v[120:123], v[176:179]
    v_mfma_f32_16x16x32_bf16 v[180:183], v[164:167], v[124:127], v[180:183]
    v_mfma_f32_16x16x32_bf16 v[184:187], v[168:171], v[120:123], v[184:187]
    v_mfma_f32_16x16x32_bf16 v[188:191], v[168:171], v[124:127], v[188:191]
    v_mfma_f32_16x16x32_bf16 v[192:195], v[172:175], v[120:123], v[192:195]
    v_mfma_f32_16x16x32_bf16 v[196:199], v[172:175], v[124:127], v[196:199]
    v_lshl_add_u32 v4, v1, 4, s70
    v_lshl_add_u32 v5, v2, 4, s72
    s_nop 1
    ds_write_b128 v4, v[180:183] offset:0
    s_nop 0
    ds_write_b128 v4, v[188:191] offset:1024
    s_nop 0
    ds_write_b128 v4, v[196:199] offset:2048
    s_mov_b32 exec_lo, 0x00010001
    s_mov_b32 exec_hi, 0x00010001
    ds_write_b128 v5, v[224:227] offset:1536
    ds_write_b128 v5, v[228:231] offset:1600
    ds_write_b128 v5, v[232:235] offset:1664
    s_mov_b64 exec, -1
    v_pk_add_f32 v[128:129], v[176:177], 0
    v_pk_add_f32 v[130:131], v[178:179], 0
    v_pk_add_f32 v[132:133], v[184:185], 0
    v_pk_add_f32 v[134:135], v[186:187], 0
    v_pk_add_f32 v[136:137], v[192:193], 0
    v_pk_add_f32 v[138:139], v[194:195], 0
    v_add_u32 v4, 65536, v7
    ds_read_b128 v[48:51], v4 offset:0
    ds_read_b128 v[52:55], v4 offset:160
    ds_read_b128 v[56:59], v4 offset:320
    ds_read_b128 v[60:63], v4 offset:480
    ds_read_b128 v[64:67], v4 offset:640
    v_add_u32 v4, 49152, v7
    ds_read_b128 v[68:71], v4
    ds_read_b128 v[72:75], v4 offset:160
    s_waitcnt lgkmcnt(0)
    v_mul_u32_u24 v7, 1152, v44
    v_lshlrev_b32 v106, 2, v43
    v_sub_u32 v7, v7, v106
    s_lshl_b32 s48, s42, 4
    s_add_u32 s48, s48, 106508
    v_add_u32 v7, s48, v7
    v_lshlrev_b32 v44, 6, v44
    v_add_u32 v44, 160768, v44
    ds_read_b128 v[108:111], v44 offset:0
    ds_read_b128 v[112:115], v44 offset:16
    v_lshlrev_b32 v80, 16, v48
    v_and_b32 v81, 0xffff0000, v48
    v_lshlrev_b32 v82, 16, v52
    v_and_b32 v83, 0xffff0000, v52
    v_lshlrev_b32 v84, 16, v56
    v_and_b32 v85, 0xffff0000, v56
    v_lshlrev_b32 v86, 16, v60
    v_and_b32 v87, 0xffff0000, v60
    v_lshlrev_b32 v88, 16, v64
    v_and_b32 v89, 0xffff0000, v64
    s_waitcnt lgkmcnt(0)
    v_lshlrev_b32 v90, 16, v108
    v_lshlrev_b32 v91, 16, v110
    v_and_b32 v92, 0xffff0000, v108
    v_and_b32 v93, 0xffff0000, v110
    v_lshlrev_b32 v94, 16, v109
    v_lshlrev_b32 v95, 16, v111
    v_and_b32 v96, 0xffff0000, v109
    v_and_b32 v97, 0xffff0000, v111
    v_pk_mul_f32 v[98:99], v[86:87], v[90:91]
    v_pk_mul_f32 v[100:101], v[88:89], v[90:91]
    v_pk_fma_f32 v[98:99], v[84:85], v[92:93], v[98:99]
    v_pk_fma_f32 v[100:101], v[86:87], v[92:93], v[100:101]
    v_pk_fma_f32 v[98:99], v[82:83], v[94:95], v[98:99]
    v_pk_fma_f32 v[100:101], v[84:85], v[94:95], v[100:101]
    v_pk_fma_f32 v[98:99], v[80:81], v[96:97], v[98:99]
    v_pk_fma_f32 v[100:101], v[82:83], v[96:97], v[100:101]
    v_lshlrev_b32 v102, 16, v68
    v_and_b32 v103, 0xffff0000, v68
    v_lshlrev_b32 v104, 16, v72
    v_and_b32 v105, 0xffff0000, v72
    v_pk_mul_f32 v[98:99], v[98:99], v[102:103]
    v_pk_mul_f32 v[100:101], v[100:101], v[104:105]
    v_cvt_pk_bf16_f32 v106, v100, v98
    v_cvt_pk_bf16_f32 v107, v101, v99
    s_mov_b32 exec_hi, 0xff
    ds_write_b32 v7, v106 offset:0
    ds_write_b32 v7, v107 offset:144
    s_mov_b32 exec_hi, -1
    v_lshlrev_b32 v80, 16, v49
    v_and_b32 v81, 0xffff0000, v49
    v_lshlrev_b32 v82, 16, v53
    v_and_b32 v83, 0xffff0000, v53
    v_lshlrev_b32 v84, 16, v57
    v_and_b32 v85, 0xffff0000, v57
    v_lshlrev_b32 v86, 16, v61
    v_and_b32 v87, 0xffff0000, v61
    v_lshlrev_b32 v88, 16, v65
    v_and_b32 v89, 0xffff0000, v65
    v_lshlrev_b32 v90, 16, v112
    v_lshlrev_b32 v91, 16, v114
    v_and_b32 v92, 0xffff0000, v112
    v_and_b32 v93, 0xffff0000, v114
    v_lshlrev_b32 v94, 16, v113
    v_lshlrev_b32 v95, 16, v115
    v_and_b32 v96, 0xffff0000, v113
    v_and_b32 v97, 0xffff0000, v115
    v_pk_mul_f32 v[98:99], v[86:87], v[90:91]
    v_pk_mul_f32 v[100:101], v[88:89], v[90:91]
    v_pk_fma_f32 v[98:99], v[84:85], v[92:93], v[98:99]
    v_pk_fma_f32 v[100:101], v[86:87], v[92:93], v[100:101]
    v_pk_fma_f32 v[98:99], v[82:83], v[94:95], v[98:99]
    v_pk_fma_f32 v[100:101], v[84:85], v[94:95], v[100:101]
    v_pk_fma_f32 v[98:99], v[80:81], v[96:97], v[98:99]
    v_pk_fma_f32 v[100:101], v[82:83], v[96:97], v[100:101]
    v_lshlrev_b32 v102, 16, v69
    v_and_b32 v103, 0xffff0000, v69
    v_lshlrev_b32 v104, 16, v73
    v_and_b32 v105, 0xffff0000, v73
    v_pk_mul_f32 v[98:99], v[98:99], v[102:103]
    v_pk_mul_f32 v[100:101], v[100:101], v[104:105]
    v_cvt_pk_bf16_f32 v106, v100, v98
    v_cvt_pk_bf16_f32 v107, v101, v99
    s_mov_b32 exec_hi, 0xff
    ds_write_b32 v7, v106 offset:288
    ds_write_b32 v7, v107 offset:432
    s_mov_b32 exec_hi, -1
    ds_read_b128 v[108:111], v44 offset:32
    ds_read_b128 v[112:115], v44 offset:48
    v_lshlrev_b32 v80, 16, v50
    v_and_b32 v81, 0xffff0000, v50
    v_lshlrev_b32 v82, 16, v54
    v_and_b32 v83, 0xffff0000, v54
    v_lshlrev_b32 v84, 16, v58
    v_and_b32 v85, 0xffff0000, v58
    v_lshlrev_b32 v86, 16, v62
    v_and_b32 v87, 0xffff0000, v62
    v_lshlrev_b32 v88, 16, v66
    v_and_b32 v89, 0xffff0000, v66
    s_waitcnt lgkmcnt(0)
    v_lshlrev_b32 v90, 16, v108
    v_lshlrev_b32 v91, 16, v110
    v_and_b32 v92, 0xffff0000, v108
    v_and_b32 v93, 0xffff0000, v110
    v_lshlrev_b32 v94, 16, v109
    v_lshlrev_b32 v95, 16, v111
    v_and_b32 v96, 0xffff0000, v109
    v_and_b32 v97, 0xffff0000, v111
    v_pk_mul_f32 v[98:99], v[86:87], v[90:91]
    v_pk_mul_f32 v[100:101], v[88:89], v[90:91]
    v_pk_fma_f32 v[98:99], v[84:85], v[92:93], v[98:99]
    v_pk_fma_f32 v[100:101], v[86:87], v[92:93], v[100:101]
    v_pk_fma_f32 v[98:99], v[82:83], v[94:95], v[98:99]
    v_pk_fma_f32 v[100:101], v[84:85], v[94:95], v[100:101]
    v_pk_fma_f32 v[98:99], v[80:81], v[96:97], v[98:99]
    v_pk_fma_f32 v[100:101], v[82:83], v[96:97], v[100:101]
    v_lshlrev_b32 v102, 16, v70
    v_and_b32 v103, 0xffff0000, v70
    v_lshlrev_b32 v104, 16, v74
    v_and_b32 v105, 0xffff0000, v74
    v_pk_mul_f32 v[98:99], v[98:99], v[102:103]
    v_pk_mul_f32 v[100:101], v[100:101], v[104:105]
    v_cvt_pk_bf16_f32 v106, v100, v98
    v_cvt_pk_bf16_f32 v107, v101, v99
    s_mov_b32 exec_hi, 0xff
    ds_write_b32 v7, v106 offset:576
    ds_write_b32 v7, v107 offset:720
    s_mov_b32 exec_hi, -1
    v_lshlrev_b32 v80, 16, v51
    v_and_b32 v81, 0xffff0000, v51
    v_lshlrev_b32 v82, 16, v55
    v_and_b32 v83, 0xffff0000, v55
    v_lshlrev_b32 v84, 16, v59
    v_and_b32 v85, 0xffff0000, v59
    v_lshlrev_b32 v86, 16, v63
    v_and_b32 v87, 0xffff0000, v63
    v_lshlrev_b32 v88, 16, v67
    v_and_b32 v89, 0xffff0000, v67
    v_lshlrev_b32 v90, 16, v112
    v_lshlrev_b32 v91, 16, v114
    v_and_b32 v92, 0xffff0000, v112
    v_and_b32 v93, 0xffff0000, v114
    v_lshlrev_b32 v94, 16, v113
    v_lshlrev_b32 v95, 16, v115
    v_and_b32 v96, 0xffff0000, v113
    v_and_b32 v97, 0xffff0000, v115
    v_pk_mul_f32 v[98:99], v[86:87], v[90:91]
    v_pk_mul_f32 v[100:101], v[88:89], v[90:91]
    v_pk_fma_f32 v[98:99], v[84:85], v[92:93], v[98:99]
    v_pk_fma_f32 v[100:101], v[86:87], v[92:93], v[100:101]
    v_pk_fma_f32 v[98:99], v[82:83], v[94:95], v[98:99]
    v_pk_fma_f32 v[100:101], v[84:85], v[94:95], v[100:101]
    v_pk_fma_f32 v[98:99], v[80:81], v[96:97], v[98:99]
    v_pk_fma_f32 v[100:101], v[82:83], v[96:97], v[100:101]
    v_lshlrev_b32 v102, 16, v71
    v_and_b32 v103, 0xffff0000, v71
    v_lshlrev_b32 v104, 16, v75
    v_and_b32 v105, 0xffff0000, v75
    v_pk_mul_f32 v[98:99], v[98:99], v[102:103]
    v_pk_mul_f32 v[100:101], v[100:101], v[104:105]
    v_cvt_pk_bf16_f32 v106, v100, v98
    v_cvt_pk_bf16_f32 v107, v101, v99
    s_mov_b32 exec_hi, 0xff
    ds_write_b32 v7, v106 offset:864
    ds_write_b32 v7, v107 offset:1008
    s_mov_b32 exec_hi, -1
    s_lshl_b32 s48, s47, 4
    v_add_u32 v43, s48, v3
    v_mul_u32_u24 v43, 200, v43
    v_lshl_add_u32 v43, v2, 3, v43
    s_mul_i32 s48, s43, 96
    s_add_u32 s48, s48, 0
    v_add_u32 v43, s48, v43
    s_waitcnt vmcnt(0)
    s_mov_b32 s65, 0
k1_poll_5:
    s_add_u32 s65, s65, 1
    s_cmp_gt_u32 s65, 100000
    s_cbranch_scc1 k1_polled_6
    v_cmp_ne_u32 vcc, s100, v30
    v_cmp_ne_u32 s[50:51], s101, v31
    s_nop 0
    s_or_b64 vcc, vcc, s[50:51]
    v_cmp_ne_u32 s[50:51], s100, v34
    s_nop 0
    s_or_b64 vcc, vcc, s[50:51]
    v_cmp_ne_u32 s[50:51], s101, v35
    s_nop 0
    s_or_b64 vcc, vcc, s[50:51]
    s_cmp_eq_u64 vcc, 0
    s_cbranch_scc1 k1_polled_6
    s_sleep 4
    buffer_load_dwordx4 v[28:31], v38, s[24:27], s78 offen sc1
    buffer_load_dwordx4 v[32:35], v38, s[24:27], s78 offen offset:1024 sc1
    s_waitcnt vmcnt(0)
    s_branch k1_poll_5
k1_polled_6:
    s_xor_b32 s48, s42, 1
    s_or_b32 s48, s48, s41
    s_cmp_lg_u32 s48, 0
    s_cbranch_scc1 k1_ep_7
    v_mov_b32 v4, 0
    v_mov_b32 v44, 1
    s_mov_b64 exec, 1
    buffer_atomic_add v44, v4, s[28:31], 0 offen sc0
    s_mov_b64 exec, -1
k1_ep_7:
    v_pk_add_f32 v[8:9], v[28:29], v[32:33]
    v_mov_b32 v10, v8
    v_mov_b32 v11, v9
    s_nop 0
    v_permlane16_swap_b32 v8, v10
    v_permlane16_swap_b32 v9, v11
    v_add_f32 v8, v8, v10
    v_add_f32 v9, v9, v11
    v_mov_b32 v10, v8
    v_mov_b32 v11, v9
    s_nop 0
    v_permlane32_swap_b32 v8, v10
    v_permlane32_swap_b32 v9, v11
    v_add_f32 v8, v8, v10
    v_add_f32 v9, v9, v11
    v_mul_f32 v8, 0x3aaaaaab, v8
    v_mul_f32 v9, 0x3aaaaaab, v9
    v_fma_f32 v9, -v8, v8, v9
    v_max_f32 v9, 0, v9
    v_cvt_pk_bf16_f32 v9, v9, v8
    v_and_b32 v8, 0xffff0000, v9
    v_lshlrev_b32 v9, 16, v9
    v_add_f32 v9, s55, v9
    v_cvt_pk_bf16_f32 v9, v9, v9
    v_and_b32 v9, 0xffff0000, v9
    v_sqrt_f32 v9, v9
    s_nop 0
    v_cvt_pk_bf16_f32 v9, v9, v9
    v_and_b32 v9, 0xffff0000, v9
    v_rcp_f32 v9, v9
    s_nop 0
    v_mov_b32 v10, v9
    v_pk_add_f32 v[200:201], v[200:201], v[8:9] op_sel_hi:[1,0] neg_lo:[0,1] neg_hi:[0,1]
    v_pk_add_f32 v[202:203], v[202:203], v[8:9] op_sel_hi:[1,0] neg_lo:[0,1] neg_hi:[0,1]
    v_pk_add_f32 v[204:205], v[204:205], v[8:9] op_sel_hi:[1,0] neg_lo:[0,1] neg_hi:[0,1]
    v_pk_add_f32 v[206:207], v[206:207], v[8:9] op_sel_hi:[1,0] neg_lo:[0,1] neg_hi:[0,1]
    v_pk_add_f32 v[208:209], v[208:209], v[8:9] op_sel_hi:[1,0] neg_lo:[0,1] neg_hi:[0,1]
    v_pk_add_f32 v[210:211], v[210:211], v[8:9] op_sel_hi:[1,0] neg_lo:[0,1] neg_hi:[0,1]
    v_pk_mul_f32 v[200:201], v[200:201], v[10:11] op_sel_hi:[1,0]
    v_pk_mul_f32 v[202:203], v[202:203], v[10:11] op_sel_hi:[1,0]
    v_pk_mul_f32 v[204:205], v[204:205], v[10:11] op_sel_hi:[1,0]
    v_pk_mul_f32 v[206:207], v[206:207], v[10:11] op_sel_hi:[1,0]
    v_pk_mul_f32 v[208:209], v[208:209], v[10:11] op_sel_hi:[1,0]
    v_pk_mul_f32 v[210:211], v[210:211], v[10:11] op_sel_hi:[1,0]
    v_cvt_pk_bf16_f32 v16, v200, v201
    v_cvt_pk_bf16_f32 v17, v202, v203
    ds_write_b64 v43, v[16:17] offset:0
    v_cvt_pk_bf16_f32 v18, v204, v205
    v_cvt_pk_bf16_f32 v19, v206, v207
    ds_write_b64 v43, v[18:19] offset:32
    v_cvt_pk_bf16_f32 v20, v208, v209
    v_cvt_pk_bf16_f32 v21, v210, v211
    ds_write_b64 v43, v[20:21] offset:64
    v_lshrrev_b32 v218, 1, v2
    v_lshrrev_b32 v5, 2, v3
    v_lshl_add_u32 v218, v218, 3, v5
    v_mul_u32_u24 v218, 200, v218
    v_and_b32 v5, 1, v2
    v_lshl_add_u32 v218, v5, 5, v218
    v_and_b32 v5, 3, v3
    v_lshl_add_u32 v218, v5, 3, v218
    v_lshlrev_b32 v219, 4, v1
    s_waitcnt lgkmcnt(0)
    s_barrier
    v_add_u32 v5, s88, v218
    ds_read_b64_tr_b16 v[8:9], v5
    ds_read_b64_tr_b16 v[10:11], v5 offset:800
    s_waitcnt lgkmcnt(0)
    buffer_store_dwordx4 v[8:11], v219, s[24:27], s64 offen sc1
    s_cmp_ge_u32 s42, 4
    s_cbranch_scc1 k1_fr_8
    v_add_u32 v5, s63, v218
    ds_read_b64_tr_b16 v[12:13], v5
    ds_read_b64_tr_b16 v[14:15], v5 offset:800
    s_waitcnt lgkmcnt(0)
    buffer_store_dwordx4 v[12:15], v219, s[24:27], s67 offen sc1
k1_fr_8:
    s_lshl_b32 s48, s42, 3
    v_lshrrev_b32 v4, 3, v1
    v_add_u32 v4, s48, v4
    v_and_b32 v5, 7, v1
    v_lshlrev_b32 v5, 4, v5
    v_mul_u32_u24 v6, 144, v4
    v_add_u32 v6, v6, v5
    v_add_u32 v6, 106496, v6
    ds_read_b128 v[120:123], v6
    v_lshlrev_b32 v4, 12, v4
    v_add_u32 v4, v4, v5
    s_waitcnt lgkmcnt(0)
    buffer_store_dwordx4 v[120:123], v4, s[24:27], s83 offen sc1
    s_lshl_b32 s48, s42, 3
    s_add_u32 s48, s48, 64
    v_lshrrev_b32 v4, 3, v1
    v_add_u32 v4, s48, v4
    v_and_b32 v5, 7, v1
    v_lshlrev_b32 v5, 4, v5
    v_mul_u32_u24 v6, 144, v4
    v_add_u32 v6, v6, v5
    v_add_u32 v6, 106496, v6
    ds_read_b128 v[124:127], v6
    v_lshlrev_b32 v4, 12, v4
    v_add_u32 v4, v4, v5
    s_waitcnt lgkmcnt(0)
    s_cmp_ge_u32 s42, 2
    s_cbranch_scc1 k1_kvskip_9
    buffer_store_dwordx4 v[124:127], v4, s[24:27], s83 offen sc1
k1_kvskip_9:
    v_lshl_add_u32 v4, v1, 4, s71
    ds_read_b128 v[48:51], v4 offset:0
    ds_read_b128 v[52:55], v4 offset:1024
    ds_read_b128 v[56:59], v4 offset:2048
    v_lshl_add_u32 v6, v2, 4, s73
    ds_read_b128 v[64:67], v6 offset:1536
    ds_read_b128 v[68:71], v6 offset:1600
    ds_read_b128 v[72:75], v6 offset:1664
    ds_read_b128 v[76:79], v6 offset:1728
    ds_read_b128 v[80:83], v6 offset:1792
    ds_read_b128 v[84:87], v6 offset:1856
    ds_read_b128 v[88:91], v6 offset:1920
    ds_read_b128 v[92:95], v6 offset:1984
    ds_read_b128 v[96:99], v6 offset:2048
    ds_read_b128 v[100:103], v6 offset:2112
    ds_read_b128 v[104:107], v6 offset:2176
    ds_read_b128 v[108:111], v6 offset:2240
    s_waitcnt lgkmcnt(12)
    v_pk_add_f32 v[128:129], v[128:129], v[48:49]
    v_pk_add_f32 v[130:131], v[130:131], v[50:51]
    v_pk_add_f32 v[132:133], v[132:133], v[52:53]
    v_pk_add_f32 v[134:135], v[134:135], v[54:55]
    v_pk_add_f32 v[136:137], v[136:137], v[56:57]
    v_pk_add_f32 v[138:139], v[138:139], v[58:59]
    s_waitcnt lgkmcnt(6)
    v_pk_add_f32 v[64:65], v[64:65], v[76:77]
    v_pk_add_f32 v[66:67], v[66:67], v[78:79]
    v_pk_add_f32 v[68:69], v[68:69], v[80:81]
    v_pk_add_f32 v[70:71], v[70:71], v[82:83]
    v_pk_add_f32 v[72:73], v[72:73], v[84:85]
    v_pk_add_f32 v[74:75], v[74:75], v[86:87]
    s_waitcnt lgkmcnt(0)
    v_pk_add_f32 v[88:89], v[88:89], v[100:101]
    v_pk_add_f32 v[90:91], v[90:91], v[102:103]
    v_pk_add_f32 v[92:93], v[92:93], v[104:105]
    v_pk_add_f32 v[94:95], v[94:95], v[106:107]
    v_pk_add_f32 v[96:97], v[96:97], v[108:109]
    v_pk_add_f32 v[98:99], v[98:99], v[110:111]
    v_pk_add_f32 v[64:65], v[64:65], v[88:89]
    v_pk_add_f32 v[66:67], v[66:67], v[90:91]
    v_pk_add_f32 v[68:69], v[68:69], v[92:93]
    v_pk_add_f32 v[70:71], v[70:71], v[94:95]
    v_pk_add_f32 v[72:73], v[72:73], v[96:97]
    v_pk_add_f32 v[74:75], v[74:75], v[98:99]
    v_pk_fma_f32 v[128:129], v[64:65], v[240:241], v[128:129] op_sel_hi:[1,0,1] neg_lo:[0,1,0] neg_hi:[0,1,0]
    v_pk_fma_f32 v[130:131], v[66:67], v[240:241], v[130:131] op_sel_hi:[1,0,1] neg_lo:[0,1,0] neg_hi:[0,1,0]
    v_pk_fma_f32 v[132:133], v[68:69], v[240:241], v[132:133] op_sel_hi:[1,0,1] neg_lo:[0,1,0] neg_hi:[0,1,0]
    v_pk_fma_f32 v[134:135], v[70:71], v[240:241], v[134:135] op_sel_hi:[1,0,1] neg_lo:[0,1,0] neg_hi:[0,1,0]
    v_pk_fma_f32 v[136:137], v[72:73], v[240:241], v[136:137] op_sel_hi:[1,0,1] neg_lo:[0,1,0] neg_hi:[0,1,0]
    v_pk_fma_f32 v[138:139], v[74:75], v[240:241], v[138:139] op_sel_hi:[1,0,1] neg_lo:[0,1,0] neg_hi:[0,1,0]
    v_pk_mul_f32 v[128:129], v[128:129], v[242:243] op_sel_hi:[1,0]
    v_pk_mul_f32 v[130:131], v[130:131], v[242:243] op_sel_hi:[1,0]
    v_pk_mul_f32 v[132:133], v[132:133], v[242:243] op_sel_hi:[1,0]
    v_pk_mul_f32 v[134:135], v[134:135], v[242:243] op_sel_hi:[1,0]
    v_pk_mul_f32 v[136:137], v[136:137], v[242:243] op_sel_hi:[1,0]
    v_pk_mul_f32 v[138:139], v[138:139], v[242:243] op_sel_hi:[1,0]
    v_pk_mul_f32 v[48:49], v[128:129], v[128:129]
    v_pk_mul_f32 v[50:51], v[130:131], v[130:131]
    v_pk_mul_f32 v[52:53], v[132:133], v[132:133]
    v_pk_mul_f32 v[54:55], v[134:135], v[134:135]
    v_pk_mul_f32 v[56:57], v[136:137], v[136:137]
    v_pk_mul_f32 v[58:59], v[138:139], v[138:139]
    v_pk_fma_f32 v[48:49], v[48:49], s[58:59], v[238:239]
    v_pk_fma_f32 v[50:51], v[50:51], s[58:59], v[238:239]
    v_pk_fma_f32 v[52:53], v[52:53], s[58:59], v[238:239]
    v_pk_fma_f32 v[54:55], v[54:55], s[58:59], v[238:239]
    v_pk_fma_f32 v[56:57], v[56:57], s[58:59], v[238:239]
    v_pk_fma_f32 v[58:59], v[58:59], s[58:59], v[238:239]
    v_pk_mul_f32 v[48:49], v[48:49], v[128:129]
    v_pk_mul_f32 v[50:51], v[50:51], v[130:131]
    v_pk_mul_f32 v[52:53], v[52:53], v[132:133]
    v_pk_mul_f32 v[54:55], v[54:55], v[134:135]
    v_pk_mul_f32 v[56:57], v[56:57], v[136:137]
    v_pk_mul_f32 v[58:59], v[58:59], v[138:139]
    v_exp_f32 v48, v48
    v_exp_f32 v49, v49
    v_exp_f32 v50, v50
    v_exp_f32 v51, v51
    v_exp_f32 v52, v52
    v_exp_f32 v53, v53
    v_exp_f32 v54, v54
    v_exp_f32 v55, v55
    v_exp_f32 v56, v56
    v_exp_f32 v57, v57
    v_exp_f32 v58, v58
    v_exp_f32 v59, v59
    v_pk_add_f32 v[48:49], v[48:49], 1.0 op_sel_hi:[1,0]
    v_pk_add_f32 v[50:51], v[50:51], 1.0 op_sel_hi:[1,0]
    v_pk_add_f32 v[52:53], v[52:53], 1.0 op_sel_hi:[1,0]
    v_pk_add_f32 v[54:55], v[54:55], 1.0 op_sel_hi:[1,0]
    v_pk_add_f32 v[56:57], v[56:57], 1.0 op_sel_hi:[1,0]
    v_pk_add_f32 v[58:59], v[58:59], 1.0 op_sel_hi:[1,0]
    v_rcp_f32 v48, v48
    v_rcp_f32 v49, v49
    v_rcp_f32 v50, v50
    v_rcp_f32 v51, v51
    v_rcp_f32 v52, v52
    v_rcp_f32 v53, v53
    v_rcp_f32 v54, v54
    v_rcp_f32 v55, v55
    v_rcp_f32 v56, v56
    v_rcp_f32 v57, v57
    v_rcp_f32 v58, v58
    v_rcp_f32 v59, v59
    v_pk_mul_f32 v[128:129], v[128:129], v[48:49]
    v_pk_mul_f32 v[130:131], v[130:131], v[50:51]
    v_pk_mul_f32 v[132:133], v[132:133], v[52:53]
    v_pk_mul_f32 v[134:135], v[134:135], v[54:55]
    v_pk_mul_f32 v[136:137], v[136:137], v[56:57]
    v_pk_mul_f32 v[138:139], v[138:139], v[58:59]
    v_lshrrev_b32 v4, 1, v2
    v_mul_u32_u24 v4, 3072, v4
    v_and_b32 v5, 1, v2
    v_lshlrev_b32 v5, 5, v5
    v_add_u32 v5, v5, v3
    v_lshl_add_u32 v4, v5, 4, v4
    v_cvt_pk_bf16_f32 v48, v128, v129
    v_cvt_pk_bf16_f32 v49, v130, v131
    v_add_u32 v5, s80, v4
    ds_write_b64 v5, v[48:49]
    v_cvt_pk_bf16_f32 v50, v132, v133
    v_cvt_pk_bf16_f32 v51, v134, v135
    v_add_u32 v5, s81, v4
    ds_write_b64 v5, v[50:51]
    v_cvt_pk_bf16_f32 v52, v136, v137
    v_cvt_pk_bf16_f32 v53, v138, v139
    v_add_u32 v5, s82, v4
    ds_write_b64 v5, v[52:53]
    s_xor_b32 s48, s42, 1
    s_or_b32 s48, s48, s41
    s_cmp_lg_u32 s48, 0
    s_cbranch_scc1 k1_ep2_10
    s_waitcnt vmcnt(0)
    v_readfirstlane_b32 s48, v44
    s_nop 0
    s_cmp_lg_u32 s48, 31
    s_cbranch_scc1 k1_ep2_10
    v_mov_b32 v8, s100
    v_mov_b32 v9, s101
    v_mov_b32 v4, 14712832
    s_mov_b64 exec, 1
    buffer_store_dwordx2 v[8:9], v4, s[24:27], 0 offen sc1
    s_mov_b64 exec, -1
k1_ep2_10:
    s_waitcnt vmcnt(0) lgkmcnt(0)
    s_barrier
    s_lshl_b32 s48, s41, 8
    s_lshl_b32 s49, s40, 3
    s_add_u32 s48, s48, s49
    s_add_u32 s48, s48, 14716928
    v_mov_b32 v8, s100
    v_mov_b32 v9, s101
    v_mov_b32 v4, 0
    s_cmp_eq_u32 s42, 0
    s_cselect_b64 exec, 1, 0
    buffer_store_dwordx2 v[8:9], v4, s[24:27], s48 offen sc1
    s_mov_b64 exec, -1
    s_cmp_ge_u32 s42, 4
    s_cbranch_scc1 recurrent_scan__ssm_conv_h3__mixer_gmlp__prompt_kernel_conv
    s_load_dwordx2 s[4:5], s[0:1], 64
    s_load_dwordx2 s[8:9], s[0:1], 104
    s_load_dwordx2 s[12:13], s[0:1], 72
    v_lshrrev_b32 v2, 6, v0
    v_and_b32 v1, 63, v0
    v_readfirstlane_b32 s34, v2
    s_mov_b32 s6, 8388608
    s_mov_b32 s7, 0x20000
    s_mov_b32 s10, 15990784
    s_mov_b32 s11, 0x20000
    s_mov_b32 s14, 4096
    s_mov_b32 s15, 0x20000
    s_and_b32 s40, s2, 7
    s_lshr_b32 s41, s2, 3
    s_and_b32 s41, s41, 31
    s_lshr_b32 s32, s40, 1
    s_lshl_b32 s32, s32, 3
    s_and_b32 s42, s41, 7
    s_add_u32 s32, s32, s42
    s_and_b32 s33, s40, 1
    s_lshl_b32 s33, s33, 2
    s_lshr_b32 s42, s41, 3
    s_add_u32 s33, s33, s42
    s_lshl_b32 s44, s33, 7
    s_lshl_b32 s40, s34, 5
    s_add_u32 s44, s44, s40
    s_mul_i32 s44, s44, 3072
    s_add_u32 s44, s44, 0
    s_lshl_b32 s45, s32, 18
    s_lshl_b32 s40, s34, 10
    s_add_u32 s45, s45, s40
    s_lshl_b32 s46, s34, 14
    v_lshlrev_b32 v5, 4, v1
    v_lshrrev_b32 v2, 3, v1
    v_lshlrev_b32 v2, 12, v2
    v_and_b32 v3, 7, v1
    v_lshrrev_b32 v4, 4, v1
    v_xor_b32 v3, v3, v4
    v_lshl_add_u32 v6, v3, 4, v2
    v_xor_b32 v7, 64, v6
    s_mov_b32 s50, 0
    s_waitcnt lgkmcnt(0)
    s_add_u32 s54, s50, 0
    s_and_b32 s54, s54, 7
    s_lshl_b32 s54, s54, 7
    s_add_u32 s54, s54, s45
    s_add_u32 s42, s54, 0
    s_add_u32 m0, s46, 0
    s_nop 0
    buffer_load_dwordx4 v6, s[4:7], s42 offen lds
    s_add_u32 s42, s54, 32768
    s_add_u32 m0, s46, 1024
    s_nop 0
    buffer_load_dwordx4 v7, s[4:7], s42 offen lds
    s_add_u32 s42, s54, 65536
    s_add_u32 m0, s46, 2048
    s_nop 0
    buffer_load_dwordx4 v6, s[4:7], s42 offen lds
    s_add_u32 s42, s54, 98304
    s_add_u32 m0, s46, 3072
    s_nop 0
    buffer_load_dwordx4 v7, s[4:7], s42 offen lds
    s_add_u32 s42, s54, 131072
    s_add_u32 m0, s46, 4096
    s_nop 0
    buffer_load_dwordx4 v6, s[4:7], s42 offen lds
    s_add_u32 s42, s54, 163840
    s_add_u32 m0, s46, 5120
    s_nop 0
    buffer_load_dwordx4 v7, s[4:7], s42 offen lds
    s_add_u32 s42, s54, 196608
    s_add_u32 m0, s46, 6144
    s_nop 0
    buffer_load_dwordx4 v6, s[4:7], s42 offen lds
    s_add_u32 s42, s54, 229376
    s_add_u32 m0, s46, 7168
    s_nop 0
    buffer_load_dwordx4 v7, s[4:7], s42 offen lds
    s_lshl_b32 s43, s33, 8
    s_add_u32 s43, s43, 14716928
    v_mbcnt_lo_u32_b32 v2, -1, 0
    v_mbcnt_hi_u32_b32 v2, -1, v2
    v_and_b32 v2, 31, v2
    v_lshlrev_b32 v2, 3, v2
    s_mov_b32 s67, 0
fpoll_11:
    buffer_load_dwordx2 v[104:105], v2, s[8:11], s43 offen sc1
    s_add_u32 s67, s67, 1
    s_waitcnt vmcnt(0)
    v_cmp_ne_u32 vcc, s100, v104
    v_cmp_ne_u32 s[64:65], s101, v105
    s_nop 0
    s_or_b64 vcc, vcc, s[64:65]
    s_cmp_gt_u32 s67, 100000
    s_cbranch_scc1 fpoll_e_12
    s_cmp_eq_u64 vcc, 0
    s_cbranch_scc1 fpoll_e_12
    s_sleep 2
    s_branch fpoll_11
fpoll_e_12:
    s_add_u32 s52, s50, 0
    s_and_b32 s52, s52, 7
    s_mul_i32 s52, s52, 12288
    s_add_u32 s52, s52, s44
    buffer_load_dwordx4 v[104:107], v5, s[8:11], s52 offen offset:0 sc1
    buffer_load_dwordx4 v[108:111], v5, s[8:11], s52 offen offset:1024 sc1
    buffer_load_dwordx4 v[112:115], v5, s[8:11], s52 offen offset:2048 sc1
    s_add_u32 s41, s52, 3072
    buffer_load_dwordx4 v[116:119], v5, s[8:11], s41 offen offset:0 sc1
    s_add_u32 s41, s52, 3072
    buffer_load_dwordx4 v[120:123], v5, s[8:11], s41 offen offset:1024 sc1
    s_add_u32 s41, s52, 3072
    buffer_load_dwordx4 v[124:127], v5, s[8:11], s41 offen offset:2048 sc1
    s_add_u32 s41, s52, 6144
    buffer_load_dwordx4 v[128:131], v5, s[8:11], s41 offen offset:0 sc1
    s_add_u32 s41, s52, 6144
    buffer_load_dwordx4 v[132:135], v5, s[8:11], s41 offen offset:1024 sc1
    s_add_u32 s41, s52, 6144
    buffer_load_dwordx4 v[136:139], v5, s[8:11], s41 offen offset:2048 sc1
    s_add_u32 s41, s52, 9216
    buffer_load_dwordx4 v[140:143], v5, s[8:11], s41 offen offset:0 sc1
    s_add_u32 s41, s52, 9216
    buffer_load_dwordx4 v[144:147], v5, s[8:11], s41 offen offset:1024 sc1
    s_add_u32 s41, s52, 9216
    buffer_load_dwordx4 v[148:151], v5, s[8:11], s41 offen offset:2048 sc1
    v_and_b32 v2, 31, v1
    v_lshrrev_b32 v3, 1, v2
    v_and_b32 v3, 7, v3
    v_lshrrev_b32 v4, 5, v1
    v_xor_b32 v3, v3, v4
    v_lshl_add_u32 v2, v2, 7, s46
    v_xor_b32 v4, 0, v3
    v_lshl_add_u32 v180, v4, 4, v2
    v_xor_b32 v4, 2, v3
    v_lshl_add_u32 v181, v4, 4, v2
    v_xor_b32 v4, 4, v3
    v_lshl_add_u32 v182, v4, 4, v2
    v_xor_b32 v4, 6, v3
    v_lshl_add_u32 v183, v4, 4, v2
    s_waitcnt vmcnt(12)
    s_setprio 2
    ds_read_b128 v[164:167], v180 offset:0
    ds_read_b128 v[168:171], v180 offset:4096
    s_waitcnt vmcnt(9)
    s_waitcnt lgkmcnt(0)
    v_mfma_f32_32x32x16_bf16 v[8:23], v[104:107], v[164:167], 0
    ds_read_b128 v[172:175], v181 offset:0
    ds_read_b128 v[176:179], v181 offset:4096
    v_mfma_f32_32x32x16_bf16 v[24:39], v[104:107], v[168:171], 0
    s_add_u32 s53, s50, 1
    s_and_b32 s53, s53, 7
    s_mul_i32 s53, s53, 12288
    s_add_u32 s53, s53, s44
    buffer_load_dwordx4 v[152:155], v5, s[8:11], s53 offen offset:0 sc1
    v_mfma_f32_32x32x16_bf16 v[40:55], v[108:111], v[164:167], 0
    buffer_load_dwordx4 v[156:159], v5, s[8:11], s53 offen offset:1024 sc1
    v_mfma_f32_32x32x16_bf16 v[56:71], v[108:111], v[168:171], 0
    buffer_load_dwordx4 v[160:163], v5, s[8:11], s53 offen offset:2048 sc1
    v_mfma_f32_32x32x16_bf16 v[72:87], v[112:115], v[164:167], 0
    s_add_u32 s55, s50, 1
    s_and_b32 s55, s55, 7
    s_lshl_b32 s55, s55, 7
    s_add_u32 s55, s55, s45
    s_add_u32 s42, s55, 0
    s_add_u32 m0, s46, 8192
    s_nop 0
    buffer_load_dwordx4 v6, s[4:7], s42 offen lds
    v_mfma_f32_32x32x16_bf16 v[88:103], v[112:115], v[168:171], 0
    s_add_u32 s42, s55, 32768
    s_add_u32 m0, s46, 9216
    s_nop 0
    buffer_load_dwordx4 v7, s[4:7], s42 offen lds
    s_add_u32 s42, s55, 65536
    s_add_u32 m0, s46, 10240
    s_nop 0
    buffer_load_dwordx4 v6, s[4:7], s42 offen lds
    s_add_u32 s42, s55, 98304
    s_add_u32 m0, s46, 11264
    s_nop 0
    buffer_load_dwordx4 v7, s[4:7], s42 offen lds
    s_waitcnt vmcnt(13)
    s_waitcnt lgkmcnt(0)
    v_mfma_f32_32x32x16_bf16 v[8:23], v[116:119], v[172:175], v[8:23]
    ds_read_b128 v[164:167], v182 offset:0
    ds_read_b128 v[168:171], v182 offset:4096
    v_mfma_f32_32x32x16_bf16 v[24:39], v[116:119], v[176:179], v[24:39]
    s_add_u32 s41, s53, 3072
    buffer_load_dwordx4 v[104:107], v5, s[8:11], s41 offen offset:0 sc1
    v_mfma_f32_32x32x16_bf16 v[40:55], v[120:123], v[172:175], v[40:55]
    s_add_u32 s41, s53, 3072
    buffer_load_dwordx4 v[108:111], v5, s[8:11], s41 offen offset:1024 sc1
    v_mfma_f32_32x32x16_bf16 v[56:71], v[120:123], v[176:179], v[56:71]
    s_add_u32 s41, s53, 3072
    buffer_load_dwordx4 v[112:115], v5, s[8:11], s41 offen offset:2048 sc1
    v_mfma_f32_32x32x16_bf16 v[72:87], v[124:127], v[172:175], v[72:87]
    s_add_u32 s42, s55, 131072
    s_add_u32 m0, s46, 12288
    s_nop 0
    buffer_load_dwordx4 v6, s[4:7], s42 offen lds
    v_mfma_f32_32x32x16_bf16 v[88:103], v[124:127], v[176:179], v[88:103]
    s_add_u32 s42, s55, 163840
    s_add_u32 m0, s46, 13312
    s_nop 0
    buffer_load_dwordx4 v7, s[4:7], s42 offen lds
    s_add_u32 s42, s55, 196608
    s_add_u32 m0, s46, 14336
    s_nop 0
    buffer_load_dwordx4 v6, s[4:7], s42 offen lds
    s_add_u32 s42, s55, 229376
    s_add_u32 m0, s46, 15360
    s_nop 0
    buffer_load_dwordx4 v7, s[4:7], s42 offen lds
    s_waitcnt vmcnt(17)
    s_waitcnt lgkmcnt(0)
    v_mfma_f32_32x32x16_bf16 v[8:23], v[128:131], v[164:167], v[8:23]
    ds_read_b128 v[172:175], v183 offset:0
    ds_read_b128 v[176:179], v183 offset:4096
    v_mfma_f32_32x32x16_bf16 v[24:39], v[128:131], v[168:171], v[24:39]
    s_add_u32 s41, s53, 6144
    buffer_load_dwordx4 v[116:119], v5, s[8:11], s41 offen offset:0 sc1
    v_mfma_f32_32x32x16_bf16 v[40:55], v[132:135], v[164:167], v[40:55]
    s_add_u32 s41, s53, 6144
    buffer_load_dwordx4 v[120:123], v5, s[8:11], s41 offen offset:1024 sc1
    v_mfma_f32_32x32x16_bf16 v[56:71], v[132:135], v[168:171], v[56:71]
    s_add_u32 s41, s53, 6144
    buffer_load_dwordx4 v[124:127], v5, s[8:11], s41 offen offset:2048 sc1
    v_mfma_f32_32x32x16_bf16 v[72:87], v[136:139], v[164:167], v[72:87]
    v_mfma_f32_32x32x16_bf16 v[88:103], v[136:139], v[168:171], v[88:103]
    s_waitcnt vmcnt(17)
    s_waitcnt lgkmcnt(0)
    v_mfma_f32_32x32x16_bf16 v[8:23], v[140:143], v[172:175], v[8:23]
    s_waitcnt vmcnt(3)
    ds_read_b128 v[164:167], v180 offset:8192
    ds_read_b128 v[168:171], v180 offset:12288
    v_mfma_f32_32x32x16_bf16 v[24:39], v[140:143], v[176:179], v[24:39]
    s_add_u32 s41, s53, 9216
    buffer_load_dwordx4 v[128:131], v5, s[8:11], s41 offen offset:0 sc1
    v_mfma_f32_32x32x16_bf16 v[40:55], v[144:147], v[172:175], v[40:55]
    s_add_u32 s41, s53, 9216
    buffer_load_dwordx4 v[132:135], v5, s[8:11], s41 offen offset:1024 sc1
    v_mfma_f32_32x32x16_bf16 v[56:71], v[144:147], v[176:179], v[56:71]
    s_add_u32 s41, s53, 9216
    buffer_load_dwordx4 v[136:139], v5, s[8:11], s41 offen offset:2048 sc1
    v_mfma_f32_32x32x16_bf16 v[72:87], v[148:151], v[172:175], v[72:87]
    s_add_u32 s54, s50, 2
    s_and_b32 s54, s54, 7
    s_lshl_b32 s54, s54, 7
    s_add_u32 s54, s54, s45
    s_add_u32 s42, s54, 0
    s_add_u32 m0, s46, 0
    s_nop 0
    buffer_load_dwordx4 v6, s[4:7], s42 offen lds
    v_mfma_f32_32x32x16_bf16 v[88:103], v[148:151], v[176:179], v[88:103]
    s_add_u32 s42, s54, 32768
    s_add_u32 m0, s46, 1024
    s_nop 0
    buffer_load_dwordx4 v7, s[4:7], s42 offen lds
    s_waitcnt vmcnt(19)
    s_waitcnt lgkmcnt(0)
    v_mfma_f32_32x32x16_bf16 v[8:23], v[152:155], v[164:167], v[8:23]
    ds_read_b128 v[172:175], v181 offset:8192
    ds_read_b128 v[176:179], v181 offset:12288
    v_mfma_f32_32x32x16_bf16 v[24:39], v[152:155], v[168:171], v[24:39]
    s_add_u32 s52, s50, 2
    s_and_b32 s52, s52, 7
    s_mul_i32 s52, s52, 12288
    s_add_u32 s52, s52, s44
    buffer_load_dwordx4 v[140:143], v5, s[8:11], s52 offen offset:0 sc1
    v_mfma_f32_32x32x16_bf16 v[40:55], v[156:159], v[164:167], v[40:55]
    buffer_load_dwordx4 v[144:147], v5, s[8:11], s52 offen offset:1024 sc1
    v_mfma_f32_32x32x16_bf16 v[56:71], v[156:159], v[168:171], v[56:71]
    buffer_load_dwordx4 v[148:151], v5, s[8:11], s52 offen offset:2048 sc1
    v_mfma_f32_32x32x16_bf16 v[72:87], v[160:163], v[164:167], v[72:87]
    s_add_u32 s42, s54, 65536
    s_add_u32 m0, s46, 2048
    s_nop 0
    buffer_load_dwordx4 v6, s[4:7], s42 offen lds
    v_mfma_f32_32x32x16_bf16 v[88:103], v[160:163], v[168:171], v[88:103]
    s_add_u32 s42, s54, 98304
    s_add_u32 m0, s46, 3072
    s_nop 0
    buffer_load_dwordx4 v7, s[4:7], s42 offen lds
    s_add_u32 s42, s54, 131072
    s_add_u32 m0, s46, 4096
    s_nop 0
    buffer_load_dwordx4 v6, s[4:7], s42 offen lds
    s_waitcnt vmcnt(18)
    s_waitcnt lgkmcnt(0)
    v_mfma_f32_32x32x16_bf16 v[8:23], v[104:107], v[172:175], v[8:23]
    ds_read_b128 v[164:167], v182 offset:8192
    ds_read_b128 v[168:171], v182 offset:12288
    v_mfma_f32_32x32x16_bf16 v[24:39], v[104:107], v[176:179], v[24:39]
    s_add_u32 s41, s52, 3072
    buffer_load_dwordx4 v[152:155], v5, s[8:11], s41 offen offset:0 sc1
    v_mfma_f32_32x32x16_bf16 v[40:55], v[108:111], v[172:175], v[40:55]
    s_add_u32 s41, s52, 3072
    buffer_load_dwordx4 v[156:159], v5, s[8:11], s41 offen offset:1024 sc1
    v_mfma_f32_32x32x16_bf16 v[56:71], v[108:111], v[176:179], v[56:71]
    s_add_u32 s41, s52, 3072
    buffer_load_dwordx4 v[160:163], v5, s[8:11], s41 offen offset:2048 sc1
    v_mfma_f32_32x32x16_bf16 v[72:87], v[112:115], v[172:175], v[72:87]
    s_add_u32 s42, s54, 163840
    s_add_u32 m0, s46, 5120
    s_nop 0
    buffer_load_dwordx4 v7, s[4:7], s42 offen lds
    v_mfma_f32_32x32x16_bf16 v[88:103], v[112:115], v[176:179], v[88:103]
    s_add_u32 s42, s54, 196608
    s_add_u32 m0, s46, 6144
    s_nop 0
    buffer_load_dwordx4 v6, s[4:7], s42 offen lds
    s_add_u32 s42, s54, 229376
    s_add_u32 m0, s46, 7168
    s_nop 0
    buffer_load_dwordx4 v7, s[4:7], s42 offen lds
    s_waitcnt vmcnt(17)
    s_waitcnt lgkmcnt(0)
    v_mfma_f32_32x32x16_bf16 v[8:23], v[116:119], v[164:167], v[8:23]
    ds_read_b128 v[172:175], v183 offset:8192
    ds_read_b128 v[176:179], v183 offset:12288
    v_mfma_f32_32x32x16_bf16 v[24:39], v[116:119], v[168:171], v[24:39]
    s_add_u32 s41, s52, 6144
    buffer_load_dwordx4 v[104:107], v5, s[8:11], s41 offen offset:0 sc1
    v_mfma_f32_32x32x16_bf16 v[40:55], v[120:123], v[164:167], v[40:55]
    s_add_u32 s41, s52, 6144
    buffer_load_dwordx4 v[108:111], v5, s[8:11], s41 offen offset:1024 sc1
    v_mfma_f32_32x32x16_bf16 v[56:71], v[120:123], v[168:171], v[56:71]
    s_add_u32 s41, s52, 6144
    buffer_load_dwordx4 v[112:115], v5, s[8:11], s41 offen offset:2048 sc1
    v_mfma_f32_32x32x16_bf16 v[72:87], v[124:127], v[164:167], v[72:87]
    v_mfma_f32_32x32x16_bf16 v[88:103], v[124:127], v[168:171], v[88:103]
    s_waitcnt vmcnt(17)
    s_waitcnt lgkmcnt(0)
    v_mfma_f32_32x32x16_bf16 v[8:23], v[128:131], v[172:175], v[8:23]
    s_waitcnt vmcnt(3)
    ds_read_b128 v[164:167], v180 offset:0
    ds_read_b128 v[168:171], v180 offset:4096
    v_mfma_f32_32x32x16_bf16 v[24:39], v[128:131], v[176:179], v[24:39]
    s_add_u32 s41, s52, 9216
    buffer_load_dwordx4 v[116:119], v5, s[8:11], s41 offen offset:0 sc1
    v_mfma_f32_32x32x16_bf16 v[40:55], v[132:135], v[172:175], v[40:55]
    s_add_u32 s41, s52, 9216
    buffer_load_dwordx4 v[120:123], v5, s[8:11], s41 offen offset:1024 sc1
    v_mfma_f32_32x32x16_bf16 v[56:71], v[132:135], v[176:179], v[56:71]
    s_add_u32 s41, s52, 9216
    buffer_load_dwordx4 v[124:127], v5, s[8:11], s41 offen offset:2048 sc1
    v_mfma_f32_32x32x16_bf16 v[72:87], v[136:139], v[172:175], v[72:87]
    s_add_u32 s55, s50, 3
    s_and_b32 s55, s55, 7
    s_lshl_b32 s55, s55, 7
    s_add_u32 s55, s55, s45
    s_add_u32 s42, s55, 0
    s_add_u32 m0, s46, 8192
    s_nop 0
    buffer_load_dwordx4 v6, s[4:7], s42 offen lds
    v_mfma_f32_32x32x16_bf16 v[88:103], v[136:139], v[176:179], v[88:103]
    s_add_u32 s42, s55, 32768
    s_add_u32 m0, s46, 9216
    s_nop 0
    buffer_load_dwordx4 v7, s[4:7], s42 offen lds
    s_waitcnt vmcnt(17)
    s_waitcnt lgkmcnt(0)
    v_mfma_f32_32x32x16_bf16 v[8:23], v[140:143], v[164:167], v[8:23]
    ds_read_b128 v[172:175], v181 offset:0
    ds_read_b128 v[176:179], v181 offset:4096
    v_mfma_f32_32x32x16_bf16 v[24:39], v[140:143], v[168:171], v[24:39]
    s_add_u32 s53, s50, 3
    s_and_b32 s53, s53, 7
    s_mul_i32 s53, s53, 12288
    s_add_u32 s53, s53, s44
    buffer_load_dwordx4 v[128:131], v5, s[8:11], s53 offen offset:0 sc1
    v_mfma_f32_32x32x16_bf16 v[40:55], v[144:147], v[164:167], v[40:55]
    buffer_load_dwordx4 v[132:135], v5, s[8:11], s53 offen offset:1024 sc1
    v_mfma_f32_32x32x16_bf16 v[56:71], v[144:147], v[168:171], v[56:71]
    buffer_load_dwordx4 v[136:139], v5, s[8:11], s53 offen offset:2048 sc1
    v_mfma_f32_32x32x16_bf16 v[72:87], v[148:151], v[164:167], v[72:87]
    s_add_u32 s42, s55, 65536
    s_add_u32 m0, s46, 10240
    s_nop 0
    buffer_load_dwordx4 v6, s[4:7], s42 offen lds
    v_mfma_f32_32x32x16_bf16 v[88:103], v[148:151], v[168:171], v[88:103]
    s_add_u32 s42, s55, 98304
    s_add_u32 m0, s46, 11264
    s_nop 0
    buffer_load_dwordx4 v7, s[4:7], s42 offen lds
    s_add_u32 s42, s55, 131072
    s_add_u32 m0, s46, 12288
    s_nop 0
    buffer_load_dwordx4 v6, s[4:7], s42 offen lds
    s_waitcnt vmcnt(17)
    s_waitcnt lgkmcnt(0)
    v_mfma_f32_32x32x16_bf16 v[8:23], v[152:155], v[172:175], v[8:23]
    ds_read_b128 v[164:167], v182 offset:0
    ds_read_b128 v[168:171], v182 offset:4096
    v_mfma_f32_32x32x16_bf16 v[24:39], v[152:155], v[176:179], v[24:39]
    s_add_u32 s41, s53, 3072
    buffer_load_dwordx4 v[140:143], v5, s[8:11], s41 offen offset:0 sc1
    v_mfma_f32_32x32x16_bf16 v[40:55], v[156:159], v[172:175], v[40:55]
    s_add_u32 s41, s53, 3072
    buffer_load_dwordx4 v[144:147], v5, s[8:11], s41 offen offset:1024 sc1
    v_mfma_f32_32x32x16_bf16 v[56:71], v[156:159], v[176:179], v[56:71]
    s_add_u32 s41, s53, 3072
    buffer_load_dwordx4 v[148:151], v5, s[8:11], s41 offen offset:2048 sc1
    v_mfma_f32_32x32x16_bf16 v[72:87], v[160:163], v[172:175], v[72:87]
    s_add_u32 s42, s55, 163840
    s_add_u32 m0, s46, 13312
    s_nop 0
    buffer_load_dwordx4 v7, s[4:7], s42 offen lds
    v_mfma_f32_32x32x16_bf16 v[88:103], v[160:163], v[176:179], v[88:103]
    s_add_u32 s42, s55, 196608
    s_add_u32 m0, s46, 14336
    s_nop 0
    buffer_load_dwordx4 v6, s[4:7], s42 offen lds
    s_add_u32 s42, s55, 229376
    s_add_u32 m0, s46, 15360
    s_nop 0
    buffer_load_dwordx4 v7, s[4:7], s42 offen lds
    s_waitcnt vmcnt(17)
    s_waitcnt lgkmcnt(0)
    v_mfma_f32_32x32x16_bf16 v[8:23], v[104:107], v[164:167], v[8:23]
    ds_read_b128 v[172:175], v183 offset:0
    ds_read_b128 v[176:179], v183 offset:4096
    v_mfma_f32_32x32x16_bf16 v[24:39], v[104:107], v[168:171], v[24:39]
    s_add_u32 s41, s53, 6144
    buffer_load_dwordx4 v[152:155], v5, s[8:11], s41 offen offset:0 sc1
    v_mfma_f32_32x32x16_bf16 v[40:55], v[108:111], v[164:167], v[40:55]
    s_add_u32 s41, s53, 6144
    buffer_load_dwordx4 v[156:159], v5, s[8:11], s41 offen offset:1024 sc1
    v_mfma_f32_32x32x16_bf16 v[56:71], v[108:111], v[168:171], v[56:71]
    s_add_u32 s41, s53, 6144
    buffer_load_dwordx4 v[160:163], v5, s[8:11], s41 offen offset:2048 sc1
    v_mfma_f32_32x32x16_bf16 v[72:87], v[112:115], v[164:167], v[72:87]
    v_mfma_f32_32x32x16_bf16 v[88:103], v[112:115], v[168:171], v[88:103]
    s_waitcnt vmcnt(17)
    s_waitcnt lgkmcnt(0)
    v_mfma_f32_32x32x16_bf16 v[8:23], v[116:119], v[172:175], v[8:23]
    s_waitcnt vmcnt(3)
    ds_read_b128 v[164:167], v180 offset:8192
    ds_read_b128 v[168:171], v180 offset:12288
    v_mfma_f32_32x32x16_bf16 v[24:39], v[116:119], v[176:179], v[24:39]
    s_add_u32 s41, s53, 9216
    buffer_load_dwordx4 v[104:107], v5, s[8:11], s41 offen offset:0 sc1
    v_mfma_f32_32x32x16_bf16 v[40:55], v[120:123], v[172:175], v[40:55]
    s_add_u32 s41, s53, 9216
    buffer_load_dwordx4 v[108:111], v5, s[8:11], s41 offen offset:1024 sc1
    v_mfma_f32_32x32x16_bf16 v[56:71], v[120:123], v[176:179], v[56:71]
    s_add_u32 s41, s53, 9216
    buffer_load_dwordx4 v[112:115], v5, s[8:11], s41 offen offset:2048 sc1
    v_mfma_f32_32x32x16_bf16 v[72:87], v[124:127], v[172:175], v[72:87]
    s_add_u32 s54, s50, 4
    s_and_b32 s54, s54, 7
    s_lshl_b32 s54, s54, 7
    s_add_u32 s54, s54, s45
    s_add_u32 s42, s54, 0
    s_add_u32 m0, s46, 0
    s_nop 0
    buffer_load_dwordx4 v6, s[4:7], s42 offen lds
    v_mfma_f32_32x32x16_bf16 v[88:103], v[124:127], v[176:179], v[88:103]
    s_add_u32 s42, s54, 32768
    s_add_u32 m0, s46, 1024
    s_nop 0
    buffer_load_dwordx4 v7, s[4:7], s42 offen lds
    s_waitcnt vmcnt(17)
    s_waitcnt lgkmcnt(0)
    v_mfma_f32_32x32x16_bf16 v[8:23], v[128:131], v[164:167], v[8:23]
    ds_read_b128 v[172:175], v181 offset:8192
    ds_read_b128 v[176:179], v181 offset:12288
    v_mfma_f32_32x32x16_bf16 v[24:39], v[128:131], v[168:171], v[24:39]
    s_add_u32 s52, s50, 4
    s_and_b32 s52, s52, 7
    s_mul_i32 s52, s52, 12288
    s_add_u32 s52, s52, s44
    buffer_load_dwordx4 v[116:119], v5, s[8:11], s52 offen offset:0 sc1
    v_mfma_f32_32x32x16_bf16 v[40:55], v[132:135], v[164:167], v[40:55]
    buffer_load_dwordx4 v[120:123], v5, s[8:11], s52 offen offset:1024 sc1
    v_mfma_f32_32x32x16_bf16 v[56:71], v[132:135], v[168:171], v[56:71]
    buffer_load_dwordx4 v[124:127], v5, s[8:11], s52 offen offset:2048 sc1
    v_mfma_f32_32x32x16_bf16 v[72:87], v[136:139], v[164:167], v[72:87]
    s_add_u32 s42, s54, 65536
    s_add_u32 m0, s46, 2048
    s_nop 0
    buffer_load_dwordx4 v6, s[4:7], s42 offen lds
    v_mfma_f32_32x32x16_bf16 v[88:103], v[136:139], v[168:171], v[88:103]
    s_add_u32 s42, s54, 98304
    s_add_u32 m0, s46, 3072
    s_nop 0
    buffer_load_dwordx4 v7, s[4:7], s42 offen lds
    s_add_u32 s42, s54, 131072
    s_add_u32 m0, s46, 4096
    s_nop 0
    buffer_load_dwordx4 v6, s[4:7], s42 offen lds
    s_waitcnt vmcnt(17)
    s_waitcnt lgkmcnt(0)
    v_mfma_f32_32x32x16_bf16 v[8:23], v[140:143], v[172:175], v[8:23]
    ds_read_b128 v[164:167], v182 offset:8192
    ds_read_b128 v[168:171], v182 offset:12288
    v_mfma_f32_32x32x16_bf16 v[24:39], v[140:143], v[176:179], v[24:39]
    s_add_u32 s41, s52, 3072
    buffer_load_dwordx4 v[128:131], v5, s[8:11], s41 offen offset:0 sc1
    v_mfma_f32_32x32x16_bf16 v[40:55], v[144:147], v[172:175], v[40:55]
    s_add_u32 s41, s52, 3072
    buffer_load_dwordx4 v[132:135], v5, s[8:11], s41 offen offset:1024 sc1
    v_mfma_f32_32x32x16_bf16 v[56:71], v[144:147], v[176:179], v[56:71]
    s_add_u32 s41, s52, 3072
    buffer_load_dwordx4 v[136:139], v5, s[8:11], s41 offen offset:2048 sc1
    v_mfma_f32_32x32x16_bf16 v[72:87], v[148:151], v[172:175], v[72:87]
    s_add_u32 s42, s54, 163840
    s_add_u32 m0, s46, 5120
    s_nop 0
    buffer_load_dwordx4 v7, s[4:7], s42 offen lds
    v_mfma_f32_32x32x16_bf16 v[88:103], v[148:151], v[176:179], v[88:103]
    s_add_u32 s42, s54, 196608
    s_add_u32 m0, s46, 6144
    s_nop 0
    buffer_load_dwordx4 v6, s[4:7], s42 offen lds
    s_add_u32 s42, s54, 229376
    s_add_u32 m0, s46, 7168
    s_nop 0
    buffer_load_dwordx4 v7, s[4:7], s42 offen lds
    s_waitcnt vmcnt(17)
    s_waitcnt lgkmcnt(0)
    v_mfma_f32_32x32x16_bf16 v[8:23], v[152:155], v[164:167], v[8:23]
    ds_read_b128 v[172:175], v183 offset:8192
    ds_read_b128 v[176:179], v183 offset:12288
    v_mfma_f32_32x32x16_bf16 v[24:39], v[152:155], v[168:171], v[24:39]
    s_add_u32 s41, s52, 6144
    buffer_load_dwordx4 v[140:143], v5, s[8:11], s41 offen offset:0 sc1
    v_mfma_f32_32x32x16_bf16 v[40:55], v[156:159], v[164:167], v[40:55]
    s_add_u32 s41, s52, 6144
    buffer_load_dwordx4 v[144:147], v5, s[8:11], s41 offen offset:1024 sc1
    v_mfma_f32_32x32x16_bf16 v[56:71], v[156:159], v[168:171], v[56:71]
    s_add_u32 s41, s52, 6144
    buffer_load_dwordx4 v[148:151], v5, s[8:11], s41 offen offset:2048 sc1
    v_mfma_f32_32x32x16_bf16 v[72:87], v[160:163], v[164:167], v[72:87]
    v_mfma_f32_32x32x16_bf16 v[88:103], v[160:163], v[168:171], v[88:103]
    s_waitcnt vmcnt(17)
    s_waitcnt lgkmcnt(0)
    v_mfma_f32_32x32x16_bf16 v[8:23], v[104:107], v[172:175], v[8:23]
    s_waitcnt vmcnt(3)
    ds_read_b128 v[164:167], v180 offset:0
    ds_read_b128 v[168:171], v180 offset:4096
    v_mfma_f32_32x32x16_bf16 v[24:39], v[104:107], v[176:179], v[24:39]
    s_add_u32 s41, s52, 9216
    buffer_load_dwordx4 v[152:155], v5, s[8:11], s41 offen offset:0 sc1
    v_mfma_f32_32x32x16_bf16 v[40:55], v[108:111], v[172:175], v[40:55]
    s_add_u32 s41, s52, 9216
    buffer_load_dwordx4 v[156:159], v5, s[8:11], s41 offen offset:1024 sc1
    v_mfma_f32_32x32x16_bf16 v[56:71], v[108:111], v[176:179], v[56:71]
    s_add_u32 s41, s52, 9216
    buffer_load_dwordx4 v[160:163], v5, s[8:11], s41 offen offset:2048 sc1
    v_mfma_f32_32x32x16_bf16 v[72:87], v[112:115], v[172:175], v[72:87]
    s_add_u32 s55, s50, 5
    s_and_b32 s55, s55, 7
    s_lshl_b32 s55, s55, 7
    s_add_u32 s55, s55, s45
    s_add_u32 s42, s55, 0
    s_add_u32 m0, s46, 8192
    s_nop 0
    buffer_load_dwordx4 v6, s[4:7], s42 offen lds
    v_mfma_f32_32x32x16_bf16 v[88:103], v[112:115], v[176:179], v[88:103]
    s_add_u32 s42, s55, 32768
    s_add_u32 m0, s46, 9216
    s_nop 0
    buffer_load_dwordx4 v7, s[4:7], s42 offen lds
    s_waitcnt vmcnt(17)
    s_waitcnt lgkmcnt(0)
    v_mfma_f32_32x32x16_bf16 v[8:23], v[116:119], v[164:167], v[8:23]
    ds_read_b128 v[172:175], v181 offset:0
    ds_read_b128 v[176:179], v181 offset:4096
    v_mfma_f32_32x32x16_bf16 v[24:39], v[116:119], v[168:171], v[24:39]
    s_add_u32 s53, s50, 5
    s_and_b32 s53, s53, 7
    s_mul_i32 s53, s53, 12288
    s_add_u32 s53, s53, s44
    buffer_load_dwordx4 v[104:107], v5, s[8:11], s53 offen offset:0 sc1
    v_mfma_f32_32x32x16_bf16 v[40:55], v[120:123], v[164:167], v[40:55]
    buffer_load_dwordx4 v[108:111], v5, s[8:11], s53 offen offset:1024 sc1
    v_mfma_f32_32x32x16_bf16 v[56:71], v[120:123], v[168:171], v[56:71]
    buffer_load_dwordx4 v[112:115], v5, s[8:11], s53 offen offset:2048 sc1
    v_mfma_f32_32x32x16_bf16 v[72:87], v[124:127], v[164:167], v[72:87]
    s_add_u32 s42, s55, 65536
    s_add_u32 m0, s46, 10240
    s_nop 0
    buffer_load_dwordx4 v6, s[4:7], s42 offen lds
    v_mfma_f32_32x32x16_bf16 v[88:103], v[124:127], v[168:171], v[88:103]
    s_add_u32 s42, s55, 98304
    s_add_u32 m0, s46, 11264
    s_nop 0
    buffer_load_dwordx4 v7, s[4:7], s42 offen lds
    s_add_u32 s42, s55, 131072
    s_add_u32 m0, s46, 12288
    s_nop 0
    buffer_load_dwordx4 v6, s[4:7], s42 offen lds
    s_waitcnt vmcnt(17)
    s_waitcnt lgkmcnt(0)
    v_mfma_f32_32x32x16_bf16 v[8:23], v[128:131], v[172:175], v[8:23]
    ds_read_b128 v[164:167], v182 offset:0
    ds_read_b128 v[168:171], v182 offset:4096
    v_mfma_f32_32x32x16_bf16 v[24:39], v[128:131], v[176:179], v[24:39]
    s_add_u32 s41, s53, 3072
    buffer_load_dwordx4 v[116:119], v5, s[8:11], s41 offen offset:0 sc1
    v_mfma_f32_32x32x16_bf16 v[40:55], v[132:135], v[172:175], v[40:55]
    s_add_u32 s41, s53, 3072
    buffer_load_dwordx4 v[120:123], v5, s[8:11], s41 offen offset:1024 sc1
    v_mfma_f32_32x32x16_bf16 v[56:71], v[132:135], v[176:179], v[56:71]
    s_add_u32 s41, s53, 3072
    buffer_load_dwordx4 v[124:127], v5, s[8:11], s41 offen offset:2048 sc1
    v_mfma_f32_32x32x16_bf16 v[72:87], v[136:139], v[172:175], v[72:87]
    s_add_u32 s42, s55, 163840
    s_add_u32 m0, s46, 13312
    s_nop 0
    buffer_load_dwordx4 v7, s[4:7], s42 offen lds
    v_mfma_f32_32x32x16_bf16 v[88:103], v[136:139], v[176:179], v[88:103]
    s_add_u32 s42, s55, 196608
    s_add_u32 m0, s46, 14336
    s_nop 0
    buffer_load_dwordx4 v6, s[4:7], s42 offen lds
    s_add_u32 s42, s55, 229376
    s_add_u32 m0, s46, 15360
    s_nop 0
    buffer_load_dwordx4 v7, s[4:7], s42 offen lds
    s_waitcnt vmcnt(17)
    s_waitcnt lgkmcnt(0)
    v_mfma_f32_32x32x16_bf16 v[8:23], v[140:143], v[164:167], v[8:23]
    ds_read_b128 v[172:175], v183 offset:0
    ds_read_b128 v[176:179], v183 offset:4096
    v_mfma_f32_32x32x16_bf16 v[24:39], v[140:143], v[168:171], v[24:39]
    s_add_u32 s41, s53, 6144
    buffer_load_dwordx4 v[128:131], v5, s[8:11], s41 offen offset:0 sc1
    v_mfma_f32_32x32x16_bf16 v[40:55], v[144:147], v[164:167], v[40:55]
    s_add_u32 s41, s53, 6144
    buffer_load_dwordx4 v[132:135], v5, s[8:11], s41 offen offset:1024 sc1
    v_mfma_f32_32x32x16_bf16 v[56:71], v[144:147], v[168:171], v[56:71]
    s_add_u32 s41, s53, 6144
    buffer_load_dwordx4 v[136:139], v5, s[8:11], s41 offen offset:2048 sc1
    v_mfma_f32_32x32x16_bf16 v[72:87], v[148:151], v[164:167], v[72:87]
    v_mfma_f32_32x32x16_bf16 v[88:103], v[148:151], v[168:171], v[88:103]
    s_waitcnt vmcnt(17)
    s_waitcnt lgkmcnt(0)
    v_mfma_f32_32x32x16_bf16 v[8:23], v[152:155], v[172:175], v[8:23]
    s_waitcnt vmcnt(3)
    ds_read_b128 v[164:167], v180 offset:8192
    ds_read_b128 v[168:171], v180 offset:12288
    v_mfma_f32_32x32x16_bf16 v[24:39], v[152:155], v[176:179], v[24:39]
    s_add_u32 s41, s53, 9216
    buffer_load_dwordx4 v[140:143], v5, s[8:11], s41 offen offset:0 sc1
    v_mfma_f32_32x32x16_bf16 v[40:55], v[156:159], v[172:175], v[40:55]
    s_add_u32 s41, s53, 9216
    buffer_load_dwordx4 v[144:147], v5, s[8:11], s41 offen offset:1024 sc1
    v_mfma_f32_32x32x16_bf16 v[56:71], v[156:159], v[176:179], v[56:71]
    s_add_u32 s41, s53, 9216
    buffer_load_dwordx4 v[148:151], v5, s[8:11], s41 offen offset:2048 sc1
    v_mfma_f32_32x32x16_bf16 v[72:87], v[160:163], v[172:175], v[72:87]
    s_add_u32 s54, s50, 6
    s_and_b32 s54, s54, 7
    s_lshl_b32 s54, s54, 7
    s_add_u32 s54, s54, s45
    s_add_u32 s42, s54, 0
    s_add_u32 m0, s46, 0
    s_nop 0
    buffer_load_dwordx4 v6, s[4:7], s42 offen lds
    v_mfma_f32_32x32x16_bf16 v[88:103], v[160:163], v[176:179], v[88:103]
    s_add_u32 s42, s54, 32768
    s_add_u32 m0, s46, 1024
    s_nop 0
    buffer_load_dwordx4 v7, s[4:7], s42 offen lds
    s_waitcnt vmcnt(17)
    s_waitcnt lgkmcnt(0)
    v_mfma_f32_32x32x16_bf16 v[8:23], v[104:107], v[164:167], v[8:23]
    ds_read_b128 v[172:175], v181 offset:8192
    ds_read_b128 v[176:179], v181 offset:12288
    v_mfma_f32_32x32x16_bf16 v[24:39], v[104:107], v[168:171], v[24:39]
    s_add_u32 s52, s50, 6
    s_and_b32 s52, s52, 7
    s_mul_i32 s52, s52, 12288
    s_add_u32 s52, s52, s44
    buffer_load_dwordx4 v[152:155], v5, s[8:11], s52 offen offset:0 sc1
    v_mfma_f32_32x32x16_bf16 v[40:55], v[108:111], v[164:167], v[40:55]
    buffer_load_dwordx4 v[156:159], v5, s[8:11], s52 offen offset:1024 sc1
    v_mfma_f32_32x32x16_bf16 v[56:71], v[108:111], v[168:171], v[56:71]
    buffer_load_dwordx4 v[160:163], v5, s[8:11], s52 offen offset:2048 sc1
    v_mfma_f32_32x32x16_bf16 v[72:87], v[112:115], v[164:167], v[72:87]
    s_add_u32 s42, s54, 65536
    s_add_u32 m0, s46, 2048
    s_nop 0
    buffer_load_dwordx4 v6, s[4:7], s42 offen lds
    v_mfma_f32_32x32x16_bf16 v[88:103], v[112:115], v[168:171], v[88:103]
    s_add_u32 s42, s54, 98304
    s_add_u32 m0, s46, 3072
    s_nop 0
    buffer_load_dwordx4 v7, s[4:7], s42 offen lds
    s_add_u32 s42, s54, 131072
    s_add_u32 m0, s46, 4096
    s_nop 0
    buffer_load_dwordx4 v6, s[4:7], s42 offen lds
    s_waitcnt vmcnt(17)
    s_waitcnt lgkmcnt(0)
    v_mfma_f32_32x32x16_bf16 v[8:23], v[116:119], v[172:175], v[8:23]
    ds_read_b128 v[164:167], v182 offset:8192
    ds_read_b128 v[168:171], v182 offset:12288
    v_mfma_f32_32x32x16_bf16 v[24:39], v[116:119], v[176:179], v[24:39]
    s_add_u32 s41, s52, 3072
    buffer_load_dwordx4 v[104:107], v5, s[8:11], s41 offen offset:0 sc1
    v_mfma_f32_32x32x16_bf16 v[40:55], v[120:123], v[172:175], v[40:55]
    s_add_u32 s41, s52, 3072
    buffer_load_dwordx4 v[108:111], v5, s[8:11], s41 offen offset:1024 sc1
    v_mfma_f32_32x32x16_bf16 v[56:71], v[120:123], v[176:179], v[56:71]
    s_add_u32 s41, s52, 3072
    buffer_load_dwordx4 v[112:115], v5, s[8:11], s41 offen offset:2048 sc1
    v_mfma_f32_32x32x16_bf16 v[72:87], v[124:127], v[172:175], v[72:87]
    s_add_u32 s42, s54, 163840
    s_add_u32 m0, s46, 5120
    s_nop 0
    buffer_load_dwordx4 v7, s[4:7], s42 offen lds
    v_mfma_f32_32x32x16_bf16 v[88:103], v[124:127], v[176:179], v[88:103]
    s_add_u32 s42, s54, 196608
    s_add_u32 m0, s46, 6144
    s_nop 0
    buffer_load_dwordx4 v6, s[4:7], s42 offen lds
    s_add_u32 s42, s54, 229376
    s_add_u32 m0, s46, 7168
    s_nop 0
    buffer_load_dwordx4 v7, s[4:7], s42 offen lds
    s_waitcnt vmcnt(17)
    s_waitcnt lgkmcnt(0)
    v_mfma_f32_32x32x16_bf16 v[8:23], v[128:131], v[164:167], v[8:23]
    ds_read_b128 v[172:175], v183 offset:8192
    ds_read_b128 v[176:179], v183 offset:12288
    v_mfma_f32_32x32x16_bf16 v[24:39], v[128:131], v[168:171], v[24:39]
    s_add_u32 s41, s52, 6144
    buffer_load_dwordx4 v[116:119], v5, s[8:11], s41 offen offset:0 sc1
    v_mfma_f32_32x32x16_bf16 v[40:55], v[132:135], v[164:167], v[40:55]
    s_add_u32 s41, s52, 6144
    buffer_load_dwordx4 v[120:123], v5, s[8:11], s41 offen offset:1024 sc1
    v_mfma_f32_32x32x16_bf16 v[56:71], v[132:135], v[168:171], v[56:71]
    s_add_u32 s41, s52, 6144
    buffer_load_dwordx4 v[124:127], v5, s[8:11], s41 offen offset:2048 sc1
    v_mfma_f32_32x32x16_bf16 v[72:87], v[136:139], v[164:167], v[72:87]
    v_mfma_f32_32x32x16_bf16 v[88:103], v[136:139], v[168:171], v[88:103]
    s_waitcnt vmcnt(17)
    s_waitcnt lgkmcnt(0)
    v_mfma_f32_32x32x16_bf16 v[8:23], v[140:143], v[172:175], v[8:23]
    s_waitcnt vmcnt(3)
    ds_read_b128 v[164:167], v180 offset:0
    ds_read_b128 v[168:171], v180 offset:4096
    v_mfma_f32_32x32x16_bf16 v[24:39], v[140:143], v[176:179], v[24:39]
    s_add_u32 s41, s52, 9216
    buffer_load_dwordx4 v[128:131], v5, s[8:11], s41 offen offset:0 sc1
    v_mfma_f32_32x32x16_bf16 v[40:55], v[144:147], v[172:175], v[40:55]
    s_add_u32 s41, s52, 9216
    buffer_load_dwordx4 v[132:135], v5, s[8:11], s41 offen offset:1024 sc1
    v_mfma_f32_32x32x16_bf16 v[56:71], v[144:147], v[176:179], v[56:71]
    s_add_u32 s41, s52, 9216
    buffer_load_dwordx4 v[136:139], v5, s[8:11], s41 offen offset:2048 sc1
    v_mfma_f32_32x32x16_bf16 v[72:87], v[148:151], v[172:175], v[72:87]
    s_add_u32 s55, s50, 7
    s_and_b32 s55, s55, 7
    s_lshl_b32 s55, s55, 7
    s_add_u32 s55, s55, s45
    s_add_u32 s42, s55, 0
    s_add_u32 m0, s46, 8192
    s_nop 0
    buffer_load_dwordx4 v6, s[4:7], s42 offen lds
    v_mfma_f32_32x32x16_bf16 v[88:103], v[148:151], v[176:179], v[88:103]
    s_add_u32 s42, s55, 32768
    s_add_u32 m0, s46, 9216
    s_nop 0
    buffer_load_dwordx4 v7, s[4:7], s42 offen lds
    s_waitcnt vmcnt(17)
    s_waitcnt lgkmcnt(0)
    v_mfma_f32_32x32x16_bf16 v[8:23], v[152:155], v[164:167], v[8:23]
    ds_read_b128 v[172:175], v181 offset:0
    ds_read_b128 v[176:179], v181 offset:4096
    v_mfma_f32_32x32x16_bf16 v[24:39], v[152:155], v[168:171], v[24:39]
    s_add_u32 s53, s50, 7
    s_and_b32 s53, s53, 7
    s_mul_i32 s53, s53, 12288
    s_add_u32 s53, s53, s44
    buffer_load_dwordx4 v[140:143], v5, s[8:11], s53 offen offset:0 sc1
    v_mfma_f32_32x32x16_bf16 v[40:55], v[156:159], v[164:167], v[40:55]
    buffer_load_dwordx4 v[144:147], v5, s[8:11], s53 offen offset:1024 sc1
    v_mfma_f32_32x32x16_bf16 v[56:71], v[156:159], v[168:171], v[56:71]
    buffer_load_dwordx4 v[148:151], v5, s[8:11], s53 offen offset:2048 sc1
    v_mfma_f32_32x32x16_bf16 v[72:87], v[160:163], v[164:167], v[72:87]
    s_add_u32 s42, s55, 65536
    s_add_u32 m0, s46, 10240
    s_nop 0
    buffer_load_dwordx4 v6, s[4:7], s42 offen lds
    v_mfma_f32_32x32x16_bf16 v[88:103], v[160:163], v[168:171], v[88:103]
    s_add_u32 s42, s55, 98304
    s_add_u32 m0, s46, 11264
    s_nop 0
    buffer_load_dwordx4 v7, s[4:7], s42 offen lds
    s_add_u32 s42, s55, 131072
    s_add_u32 m0, s46, 12288
    s_nop 0
    buffer_load_dwordx4 v6, s[4:7], s42 offen lds
    s_waitcnt vmcnt(17)
    s_waitcnt lgkmcnt(0)
    v_mfma_f32_32x32x16_bf16 v[8:23], v[104:107], v[172:175], v[8:23]
    ds_read_b128 v[164:167], v182 offset:0
    ds_read_b128 v[168:171], v182 offset:4096
    v_mfma_f32_32x32x16_bf16 v[24:39], v[104:107], v[176:179], v[24:39]
    s_add_u32 s41, s53, 3072
    buffer_load_dwordx4 v[152:155], v5, s[8:11], s41 offen offset:0 sc1
    v_mfma_f32_32x32x16_bf16 v[40:55], v[108:111], v[172:175], v[40:55]
    s_add_u32 s41, s53, 3072
    buffer_load_dwordx4 v[156:159], v5, s[8:11], s41 offen offset:1024 sc1
    v_mfma_f32_32x32x16_bf16 v[56:71], v[108:111], v[176:179], v[56:71]
    s_add_u32 s41, s53, 3072
    buffer_load_dwordx4 v[160:163], v5, s[8:11], s41 offen offset:2048 sc1
    v_mfma_f32_32x32x16_bf16 v[72:87], v[112:115], v[172:175], v[72:87]
    s_add_u32 s42, s55, 163840
    s_add_u32 m0, s46, 13312
    s_nop 0
    buffer_load_dwordx4 v7, s[4:7], s42 offen lds
    v_mfma_f32_32x32x16_bf16 v[88:103], v[112:115], v[176:179], v[88:103]
    s_add_u32 s42, s55, 196608
    s_add_u32 m0, s46, 14336
    s_nop 0
    buffer_load_dwordx4 v6, s[4:7], s42 offen lds
    s_add_u32 s42, s55, 229376
    s_add_u32 m0, s46, 15360
    s_nop 0
    buffer_load_dwordx4 v7, s[4:7], s42 offen lds
    s_waitcnt vmcnt(17)
    s_waitcnt lgkmcnt(0)
    v_mfma_f32_32x32x16_bf16 v[8:23], v[116:119], v[164:167], v[8:23]
    ds_read_b128 v[172:175], v183 offset:0
    ds_read_b128 v[176:179], v183 offset:4096
    v_mfma_f32_32x32x16_bf16 v[24:39], v[116:119], v[168:171], v[24:39]
    s_add_u32 s41, s53, 6144
    buffer_load_dwordx4 v[104:107], v5, s[8:11], s41 offen offset:0 sc1
    v_mfma_f32_32x32x16_bf16 v[40:55], v[120:123], v[164:167], v[40:55]
    s_add_u32 s41, s53, 6144
    buffer_load_dwordx4 v[108:111], v5, s[8:11], s41 offen offset:1024 sc1
    v_mfma_f32_32x32x16_bf16 v[56:71], v[120:123], v[168:171], v[56:71]
    s_add_u32 s41, s53, 6144
    buffer_load_dwordx4 v[112:115], v5, s[8:11], s41 offen offset:2048 sc1
    v_mfma_f32_32x32x16_bf16 v[72:87], v[124:127], v[164:167], v[72:87]
    v_mfma_f32_32x32x16_bf16 v[88:103], v[124:127], v[168:171], v[88:103]
    s_waitcnt vmcnt(17)
    s_waitcnt lgkmcnt(0)
    v_mfma_f32_32x32x16_bf16 v[8:23], v[128:131], v[172:175], v[8:23]
    s_waitcnt vmcnt(3)
    ds_read_b128 v[164:167], v180 offset:8192
    ds_read_b128 v[168:171], v180 offset:12288
    v_mfma_f32_32x32x16_bf16 v[24:39], v[128:131], v[176:179], v[24:39]
    s_add_u32 s41, s53, 9216
    buffer_load_dwordx4 v[116:119], v5, s[8:11], s41 offen offset:0 sc1
    v_mfma_f32_32x32x16_bf16 v[40:55], v[132:135], v[172:175], v[40:55]
    s_add_u32 s41, s53, 9216
    buffer_load_dwordx4 v[120:123], v5, s[8:11], s41 offen offset:1024 sc1
    v_mfma_f32_32x32x16_bf16 v[56:71], v[132:135], v[176:179], v[56:71]
    s_add_u32 s41, s53, 9216
    buffer_load_dwordx4 v[124:127], v5, s[8:11], s41 offen offset:2048 sc1
    v_mfma_f32_32x32x16_bf16 v[72:87], v[136:139], v[172:175], v[72:87]
    v_mfma_f32_32x32x16_bf16 v[88:103], v[136:139], v[176:179], v[88:103]
    s_waitcnt vmcnt(15)
    s_waitcnt lgkmcnt(0)
    v_mfma_f32_32x32x16_bf16 v[8:23], v[140:143], v[164:167], v[8:23]
    ds_read_b128 v[172:175], v181 offset:8192
    ds_read_b128 v[176:179], v181 offset:12288
    v_mfma_f32_32x32x16_bf16 v[24:39], v[140:143], v[168:171], v[24:39]
    v_mfma_f32_32x32x16_bf16 v[40:55], v[144:147], v[164:167], v[40:55]
    v_mfma_f32_32x32x16_bf16 v[56:71], v[144:147], v[168:171], v[56:71]
    v_mfma_f32_32x32x16_bf16 v[72:87], v[148:151], v[164:167], v[72:87]
    v_mfma_f32_32x32x16_bf16 v[88:103], v[148:151], v[168:171], v[88:103]
    s_waitcnt vmcnt(9)
    s_waitcnt lgkmcnt(0)
    v_mfma_f32_32x32x16_bf16 v[8:23], v[152:155], v[172:175], v[8:23]
    ds_read_b128 v[164:167], v182 offset:8192
    ds_read_b128 v[168:171], v182 offset:12288
    v_mfma_f32_32x32x16_bf16 v[24:39], v[152:155], v[176:179], v[24:39]
    v_mfma_f32_32x32x16_bf16 v[40:55], v[156:159], v[172:175], v[40:55]
    v_mfma_f32_32x32x16_bf16 v[56:71], v[156:159], v[176:179], v[56:71]
    v_mfma_f32_32x32x16_bf16 v[72:87], v[160:163], v[172:175], v[72:87]
    v_mfma_f32_32x32x16_bf16 v[88:103], v[160:163], v[176:179], v[88:103]
    s_waitcnt vmcnt(3)
    s_waitcnt lgkmcnt(0)
    v_mfma_f32_32x32x16_bf16 v[8:23], v[104:107], v[164:167], v[8:23]
    ds_read_b128 v[172:175], v183 offset:8192
    ds_read_b128 v[176:179], v183 offset:12288
    v_mfma_f32_32x32x16_bf16 v[24:39], v[104:107], v[168:171], v[24:39]
    s_lshl_b32 s40, s32, 3
    s_add_u32 s40, s40, s33
    s_lshl_b32 s40, s40, 2
    s_add_u32 s40, s40, s34
    s_mul_i32 s40, s40, 3072
    s_add_u32 s40, s40, 3145728
    s_mul_i32 s40, s34, 3072
    s_add_u32 s40, s40, 73728
    v_add_u32 v3, s40, v5
    ds_read_b128 v[184:187], v3 offset:0
    v_mfma_f32_32x32x16_bf16 v[40:55], v[108:111], v[164:167], v[40:55]
    ds_read_b128 v[188:191], v3 offset:1024
    v_mfma_f32_32x32x16_bf16 v[56:71], v[108:111], v[168:171], v[56:71]
    ds_read_b128 v[192:195], v3 offset:2048
    v_mfma_f32_32x32x16_bf16 v[72:87], v[112:115], v[164:167], v[72:87]
    v_and_b32 v2, 31, v1
    v_lshlrev_b32 v2, 1, v2
    s_lshr_b32 s40, s34, 1
    s_lshl_b32 s40, s40, 6
    s_lshl_b32 s43, s32, 7
    s_add_u32 s40, s40, s43
    buffer_load_ushort v196, v2, s[12:15], s40 offen
    v_mfma_f32_32x32x16_bf16 v[88:103], v[112:115], v[168:171], v[88:103]
    s_waitcnt vmcnt(1)
    s_waitcnt lgkmcnt(3)
    v_mfma_f32_32x32x16_bf16 v[8:23], v[116:119], v[172:175], v[8:23]
    v_mfma_f32_32x32x16_bf16 v[24:39], v[116:119], v[176:179], v[24:39]
    v_mfma_f32_32x32x16_bf16 v[40:55], v[120:123], v[172:175], v[40:55]
    v_mfma_f32_32x32x16_bf16 v[56:71], v[120:123], v[176:179], v[56:71]
    v_mfma_f32_32x32x16_bf16 v[72:87], v[124:127], v[172:175], v[72:87]
    v_mfma_f32_32x32x16_bf16 v[88:103], v[124:127], v[176:179], v[88:103]
    s_setprio 0
    v_add_u32 v4, 0x10000, v5
    s_nop 15
    s_waitcnt lgkmcnt(0)
    v_mov_b32 v2, 161792
    v_mov_b32 v3, 1
    s_mov_b64 exec, 1
    ds_add_u32 v2, v3
    s_mov_b64 exec, -1
    s_mov_b32 s67, 0
gsync_18:
    ds_read_b32 v3, v2
    s_add_u32 s67, s67, 1
    s_waitcnt lgkmcnt(0)
    v_readfirstlane_b32 s66, v3
    s_cmp_gt_u32 s67, 1000000
    s_cbranch_scc1 gsync_e_19
    s_cmp_lt_u32 s66, 4
    s_cbranch_scc1 gsync_18
gsync_e_19:
    s_cmp_lg_u32 s34, 0
    s_cbranch_scc1 g_epi_14
    ds_write_b128 v5, v[12:15] offset:30720
    ds_write_b128 v5, v[20:23] offset:31744
    ds_write_b128 v5, v[44:47] offset:32768
    ds_write_b128 v5, v[52:55] offset:33792
    ds_write_b128 v5, v[76:79] offset:34816
    ds_write_b128 v5, v[84:87] offset:35840
    ds_write_b128 v5, v[24:27] offset:43008
    ds_write_b128 v5, v[32:35] offset:44032
    ds_write_b128 v5, v[56:59] offset:45056
    ds_write_b128 v5, v[64:67] offset:46080
    ds_write_b128 v5, v[88:91] offset:47104
    ds_write_b128 v5, v[96:99] offset:48128
    ds_write_b128 v5, v[28:31] offset:55296
    ds_write_b128 v5, v[36:39] offset:56320
    ds_write_b128 v5, v[60:63] offset:57344
    ds_write_b128 v5, v[68:71] offset:58368
    ds_write_b128 v5, v[92:95] offset:59392
    ds_write_b128 v5, v[100:103] offset:60416
    v_pk_add_f32 v[104:105], v[8:9], 0
    v_pk_add_f32 v[106:107], v[10:11], 0
    v_pk_add_f32 v[108:109], v[16:17], 0
    v_pk_add_f32 v[110:111], v[18:19], 0
    v_pk_add_f32 v[112:113], v[40:41], 0
    v_pk_add_f32 v[114:115], v[42:43], 0
    v_pk_add_f32 v[116:117], v[48:49], 0
    v_pk_add_f32 v[118:119], v[50:51], 0
    v_pk_add_f32 v[120:121], v[72:73], 0
    v_pk_add_f32 v[122:123], v[74:75], 0
    v_pk_add_f32 v[124:125], v[80:81], 0
    v_pk_add_f32 v[126:127], v[82:83], 0
    s_branch g_epi_end_13
g_epi_14:
    s_cmp_lg_u32 s34, 1
    s_cbranch_scc1 g_epi_15
    ds_write_b128 v5, v[8:11] offset:0
    ds_write_b128 v5, v[16:19] offset:1024
    ds_write_b128 v5, v[40:43] offset:2048
    ds_write_b128 v5, v[48:51] offset:3072
    ds_write_b128 v5, v[72:75] offset:4096
    ds_write_b128 v5, v[80:83] offset:5120
    ds_write_b128 v5, v[24:27] offset:49152
    ds_write_b128 v5, v[32:35] offset:50176
    ds_write_b128 v5, v[56:59] offset:51200
    ds_write_b128 v5, v[64:67] offset:52224
    ds_write_b128 v5, v[88:91] offset:53248
    ds_write_b128 v5, v[96:99] offset:54272
    ds_write_b128 v5, v[28:31] offset:61440
    ds_write_b128 v5, v[36:39] offset:62464
    ds_write_b128 v5, v[60:63] offset:63488
    ds_write_b128 v5, v[68:71] offset:64512
    ds_write_b128 v4, v[92:95] offset:0
    ds_write_b128 v4, v[100:103] offset:1024
    v_pk_add_f32 v[104:105], v[12:13], 0
    v_pk_add_f32 v[106:107], v[14:15], 0
    v_pk_add_f32 v[108:109], v[20:21], 0
    v_pk_add_f32 v[110:111], v[22:23], 0
    v_pk_add_f32 v[112:113], v[44:45], 0
    v_pk_add_f32 v[114:115], v[46:47], 0
    v_pk_add_f32 v[116:117], v[52:53], 0
    v_pk_add_f32 v[118:119], v[54:55], 0
    v_pk_add_f32 v[120:121], v[76:77], 0
    v_pk_add_f32 v[122:123], v[78:79], 0
    v_pk_add_f32 v[124:125], v[84:85], 0
    v_pk_add_f32 v[126:127], v[86:87], 0
    s_branch g_epi_end_13
g_epi_15:
    s_cmp_lg_u32 s34, 2
    s_cbranch_scc1 g_epi_16
    ds_write_b128 v5, v[8:11] offset:6144
    ds_write_b128 v5, v[16:19] offset:7168
    ds_write_b128 v5, v[40:43] offset:8192
    ds_write_b128 v5, v[48:51] offset:9216
    ds_write_b128 v5, v[72:75] offset:10240
    ds_write_b128 v5, v[80:83] offset:11264
    ds_write_b128 v5, v[12:15] offset:18432
    ds_write_b128 v5, v[20:23] offset:19456
    ds_write_b128 v5, v[44:47] offset:20480
    ds_write_b128 v5, v[52:55] offset:21504
    ds_write_b128 v5, v[76:79] offset:22528
    ds_write_b128 v5, v[84:87] offset:23552
    ds_write_b128 v4, v[28:31] offset:2048
    ds_write_b128 v4, v[36:39] offset:3072
    ds_write_b128 v4, v[60:63] offset:4096
    ds_write_b128 v4, v[68:71] offset:5120
    ds_write_b128 v4, v[92:95] offset:6144
    ds_write_b128 v4, v[100:103] offset:7168
    v_pk_add_f32 v[104:105], v[24:25], 0
    v_pk_add_f32 v[106:107], v[26:27], 0
    v_pk_add_f32 v[108:109], v[32:33], 0
    v_pk_add_f32 v[110:111], v[34:35], 0
    v_pk_add_f32 v[112:113], v[56:57], 0
    v_pk_add_f32 v[114:115], v[58:59], 0
    v_pk_add_f32 v[116:117], v[64:65], 0
    v_pk_add_f32 v[118:119], v[66:67], 0
    v_pk_add_f32 v[120:121], v[88:89], 0
    v_pk_add_f32 v[122:123], v[90:91], 0
    v_pk_add_f32 v[124:125], v[96:97], 0
    v_pk_add_f32 v[126:127], v[98:99], 0
    s_branch g_epi_end_13
g_epi_16:
    ds_write_b128 v5, v[8:11] offset:12288
    ds_write_b128 v5, v[16:19] offset:13312
    ds_write_b128 v5, v[40:43] offset:14336
    ds_write_b128 v5, v[48:51] offset:15360
    ds_write_b128 v5, v[72:75] offset:16384
    ds_write_b128 v5, v[80:83] offset:17408
    ds_write_b128 v5, v[12:15] offset:24576
    ds_write_b128 v5, v[20:23] offset:25600
    ds_write_b128 v5, v[44:47] offset:26624
    ds_write_b128 v5, v[52:55] offset:27648
    ds_write_b128 v5, v[76:79] offset:28672
    ds_write_b128 v5, v[84:87] offset:29696
    ds_write_b128 v5, v[24:27] offset:36864
    ds_write_b128 v5, v[32:35] offset:37888
    ds_write_b128 v5, v[56:59] offset:38912
    ds_write_b128 v5, v[64:67] offset:39936
    ds_write_b128 v5, v[88:91] offset:40960
    ds_write_b128 v5, v[96:99] offset:41984
    v_pk_add_f32 v[104:105], v[28:29], 0
    v_pk_add_f32 v[106:107], v[30:31], 0
    v_pk_add_f32 v[108:109], v[36:37], 0
    v_pk_add_f32 v[110:111], v[38:39], 0
    v_pk_add_f32 v[112:113], v[60:61], 0
    v_pk_add_f32 v[114:115], v[62:63], 0
    v_pk_add_f32 v[116:117], v[68:69], 0
    v_pk_add_f32 v[118:119], v[70:71], 0
    v_pk_add_f32 v[120:121], v[92:93], 0
    v_pk_add_f32 v[122:123], v[94:95], 0
    v_pk_add_f32 v[124:125], v[100:101], 0
    v_pk_add_f32 v[126:127], v[102:103], 0
g_epi_end_13:
    s_waitcnt lgkmcnt(0)
    s_waitcnt lgkmcnt(0)
    v_mov_b32 v2, 161792
    v_mov_b32 v3, 1
    s_mov_b64 exec, 1
    ds_add_u32 v2, v3
    s_mov_b64 exec, -1
    s_mov_b32 s67, 0
gsync_20:
    ds_read_b32 v3, v2
    s_add_u32 s67, s67, 1
    s_waitcnt lgkmcnt(0)
    v_readfirstlane_b32 s66, v3
    s_cmp_gt_u32 s67, 1000000
    s_cbranch_scc1 gsync_e_21
    s_cmp_lt_u32 s66, 8
    s_cbranch_scc1 gsync_20
gsync_e_21:
    s_mul_i32 s40, s34, 18432
    v_add_u32 v2, s40, v5
    ds_read_b128 v[8:11], v2 offset:0
    ds_read_b128 v[12:15], v2 offset:1024
    ds_read_b128 v[16:19], v2 offset:2048
    ds_read_b128 v[20:23], v2 offset:3072
    ds_read_b128 v[24:27], v2 offset:4096
    ds_read_b128 v[28:31], v2 offset:5120
    ds_read_b128 v[32:35], v2 offset:6144
    ds_read_b128 v[36:39], v2 offset:7168
    ds_read_b128 v[40:43], v2 offset:8192
    ds_read_b128 v[44:47], v2 offset:9216
    ds_read_b128 v[48:51], v2 offset:10240
    ds_read_b128 v[52:55], v2 offset:11264
    ds_read_b128 v[56:59], v2 offset:12288
    ds_read_b128 v[60:63], v2 offset:13312
    ds_read_b128 v[64:67], v2 offset:14336
    ds_read_b128 v[68:71], v2 offset:15360
    ds_read_b128 v[72:75], v2 offset:16384
    ds_read_b128 v[76:79], v2 offset:17408
    v_lshrrev_b32 v6, 4, v1
    v_and_b32 v6, 1, v6
    v_mul_u32_u24 v6, 24576, v6
    v_and_b32 v3, 15, v1
    v_lshrrev_b32 v4, 5, v1
    v_lshl_add_u32 v3, v4, 4, v3
    v_lshl_add_u32 v6, v3, 4, v6
    s_mul_i32 s40, s32, 98304
    s_lshr_b32 s41, s34, 1
    s_mul_i32 s41, s41, 49152
    s_add_u32 s40, s40, s41
    s_mul_i32 s41, s33, 3072
    s_add_u32 s40, s40, s41
    s_and_b32 s41, s34, 1
    s_lshl_b32 s41, s41, 9
    s_add_u32 s40, s40, s41
    s_add_u32 s40, s40, 11534336
    s_waitcnt vmcnt(0)
    v_lshlrev_b32 v180, 16, v196
    v_lshlrev_b32 v80, 16, v184
    v_and_b32 v81, 0xffff0000, v184
    v_lshlrev_b32 v82, 16, v185
    v_and_b32 v83, 0xffff0000, v185
    v_lshlrev_b32 v84, 16, v186
    v_and_b32 v85, 0xffff0000, v186
    v_lshlrev_b32 v86, 16, v187
    v_and_b32 v87, 0xffff0000, v187
    v_lshlrev_b32 v88, 16, v188
    v_and_b32 v89, 0xffff0000, v188
    v_lshlrev_b32 v90, 16, v189
    v_and_b32 v91, 0xffff0000, v189
    v_lshlrev_b32 v92, 16, v190
    v_and_b32 v93, 0xffff0000, v190
    v_lshlrev_b32 v94, 16, v191
    v_and_b32 v95, 0xffff0000, v191
    v_lshlrev_b32 v96, 16, v192
    v_and_b32 v97, 0xffff0000, v192
    v_lshlrev_b32 v98, 16, v193
    v_and_b32 v99, 0xffff0000, v193
    v_lshlrev_b32 v100, 16, v194
    v_and_b32 v101, 0xffff0000, v194
    v_lshlrev_b32 v102, 16, v195
    v_and_b32 v103, 0xffff0000, v195
    s_waitcnt lgkmcnt(12)
    v_pk_add_f32 v[104:105], v[104:105], v[8:9]
    v_pk_add_f32 v[106:107], v[106:107], v[10:11]
    v_pk_add_f32 v[108:109], v[108:109], v[12:13]
    v_pk_add_f32 v[110:111], v[110:111], v[14:15]
    v_pk_add_f32 v[112:113], v[112:113], v[16:17]
    v_pk_add_f32 v[114:115], v[114:115], v[18:19]
    v_pk_add_f32 v[116:117], v[116:117], v[20:21]
    v_pk_add_f32 v[118:119], v[118:119], v[22:23]
    v_pk_add_f32 v[120:121], v[120:121], v[24:25]
    v_pk_add_f32 v[122:123], v[122:123], v[26:27]
    v_pk_add_f32 v[124:125], v[124:125], v[28:29]
    v_pk_add_f32 v[126:127], v[126:127], v[30:31]
    s_waitcnt lgkmcnt(6)
    v_pk_add_f32 v[104:105], v[104:105], v[32:33]
    v_pk_add_f32 v[106:107], v[106:107], v[34:35]
    v_pk_add_f32 v[108:109], v[108:109], v[36:37]
    v_pk_add_f32 v[110:111], v[110:111], v[38:39]
    v_pk_add_f32 v[112:113], v[112:113], v[40:41]
    v_pk_add_f32 v[114:115], v[114:115], v[42:43]
    v_pk_add_f32 v[116:117], v[116:117], v[44:45]
    v_pk_add_f32 v[118:119], v[118:119], v[46:47]
    v_pk_add_f32 v[120:121], v[120:121], v[48:49]
    v_pk_add_f32 v[122:123], v[122:123], v[50:51]
    v_pk_add_f32 v[124:125], v[124:125], v[52:53]
    v_pk_add_f32 v[126:127], v[126:127], v[54:55]
    s_waitcnt lgkmcnt(0)
    v_pk_add_f32 v[104:105], v[104:105], v[56:57]
    v_pk_add_f32 v[106:107], v[106:107], v[58:59]
    v_pk_add_f32 v[108:109], v[108:109], v[60:61]
    v_pk_add_f32 v[110:111], v[110:111], v[62:63]
    v_pk_add_f32 v[112:113], v[112:113], v[64:65]
    v_pk_add_f32 v[114:115], v[114:115], v[66:67]
    v_pk_add_f32 v[116:117], v[116:117], v[68:69]
    v_pk_add_f32 v[118:119], v[118:119], v[70:71]
    v_pk_add_f32 v[120:121], v[120:121], v[72:73]
    v_pk_add_f32 v[122:123], v[122:123], v[74:75]
    v_pk_add_f32 v[124:125], v[124:125], v[76:77]
    v_pk_add_f32 v[126:127], v[126:127], v[78:79]
    v_pk_add_f32 v[104:105], v[104:105], v[180:181] op_sel_hi:[1,0]
    v_pk_add_f32 v[106:107], v[106:107], v[180:181] op_sel_hi:[1,0]
    v_pk_add_f32 v[108:109], v[108:109], v[180:181] op_sel_hi:[1,0]
    v_pk_add_f32 v[110:111], v[110:111], v[180:181] op_sel_hi:[1,0]
    v_pk_add_f32 v[112:113], v[112:113], v[180:181] op_sel_hi:[1,0]
    v_pk_add_f32 v[114:115], v[114:115], v[180:181] op_sel_hi:[1,0]
    v_pk_add_f32 v[116:117], v[116:117], v[180:181] op_sel_hi:[1,0]
    v_pk_add_f32 v[118:119], v[118:119], v[180:181] op_sel_hi:[1,0]
    v_pk_add_f32 v[120:121], v[120:121], v[180:181] op_sel_hi:[1,0]
    v_pk_add_f32 v[122:123], v[122:123], v[180:181] op_sel_hi:[1,0]
    v_pk_add_f32 v[124:125], v[124:125], v[180:181] op_sel_hi:[1,0]
    v_pk_add_f32 v[126:127], v[126:127], v[180:181] op_sel_hi:[1,0]
    v_pk_mul_f32 v[104:105], v[104:105], v[80:81]
    v_pk_mul_f32 v[106:107], v[106:107], v[82:83]
    v_pk_mul_f32 v[108:109], v[108:109], v[84:85]
    v_pk_mul_f32 v[110:111], v[110:111], v[86:87]
    v_pk_mul_f32 v[112:113], v[112:113], v[88:89]
    v_pk_mul_f32 v[114:115], v[114:115], v[90:91]
    v_pk_mul_f32 v[116:117], v[116:117], v[92:93]
    v_pk_mul_f32 v[118:119], v[118:119], v[94:95]
    v_pk_mul_f32 v[120:121], v[120:121], v[96:97]
    v_pk_mul_f32 v[122:123], v[122:123], v[98:99]
    v_pk_mul_f32 v[124:125], v[124:125], v[100:101]
    v_pk_mul_f32 v[126:127], v[126:127], v[102:103]
    v_cvt_pk_bf16_f32 v8, v104, v105
    v_cvt_pk_bf16_f32 v9, v106, v107
    v_cvt_pk_bf16_f32 v10, v108, v109
    v_cvt_pk_bf16_f32 v11, v110, v111
    buffer_store_dwordx4 v[8:11], v6, s[8:11], s40 offen offset:0 sc1
    v_cvt_pk_bf16_f32 v12, v112, v113
    v_cvt_pk_bf16_f32 v13, v114, v115
    v_cvt_pk_bf16_f32 v14, v116, v117
    v_cvt_pk_bf16_f32 v15, v118, v119
    buffer_store_dwordx4 v[12:15], v6, s[8:11], s40 offen offset:1024 sc1
    v_cvt_pk_bf16_f32 v16, v120, v121
    v_cvt_pk_bf16_f32 v17, v122, v123
    v_cvt_pk_bf16_f32 v18, v124, v125
    v_cvt_pk_bf16_f32 v19, v126, v127
    buffer_store_dwordx4 v[16:19], v6, s[8:11], s40 offen offset:2048 sc1
    s_waitcnt vmcnt(0) lgkmcnt(0)
    s_barrier
    s_lshl_b32 s40, s2, 3
    s_add_u32 s40, s40, 14721024
    v_mov_b32 v2, s100
    v_mov_b32 v3, s101
    v_mov_b32 v1, 0
    s_cmp_eq_u32 s34, 0
    s_cselect_b64 exec, 1, 0
    buffer_store_dwordx2 v[2:3], v1, s[8:11], s40 offen sc1
    s_mov_b64 exec, -1
    s_load_dwordx2 s[12:13], s[0:1], 104
    s_load_dwordx2 s[8:9], s[0:1], 0
    s_load_dwordx2 s[16:17], s[0:1], 88
    s_mov_b32 s10, 2621440
    s_mov_b32 s11, 0x20000
    s_mov_b32 s14, 15990784
    s_mov_b32 s15, 0x20000
    s_mov_b32 s18, 2621440
    s_mov_b32 s19, 0x20000
    v_lshrrev_b32 v4, 6, v0
    v_and_b32 v1, 63, v0
    v_readfirstlane_b32 s34, v4
    v_lshlrev_b32 v7, 4, v1
    s_and_b32 s40, s2, 7
    s_lshr_b32 s41, s2, 3
    s_lshr_b32 s32, s40, 1
    s_lshl_b32 s32, s32, 3
    s_and_b32 s42, s41, 7
    s_add_u32 s32, s32, s42
    s_and_b32 s33, s40, 1
    s_lshl_b32 s33, s33, 2
    s_lshr_b32 s42, s41, 3
    s_add_u32 s33, s33, s42
    s_add_u32 s40, s32, s33
    s_mul_i32 s41, s40, 43
    s_lshr_b32 s41, s41, 8
    s_mul_i32 s41, s41, 6
    s_sub_u32 s48, s40, s41
    s_mul_i32 s46, s33, 122880
    s_add_u32 s46, s46, 15007744
    s_mul_i32 s40, s34, 5120
    s_add_u32 s46, s46, s40
    s_mul_i32 s47, s32, 98304
    s_mul_i32 s41, s34, 24576
    s_add_u32 s47, s47, s41
    s_add_u32 s47, s47, 11534336
    s_add_u32 s40, s48, 0
    s_sub_u32 s41, s40, 6
    s_cmp_ge_u32 s40, 6
    s_cselect_b32 s50, s41, s40
    s_add_u32 s40, s48, 1
    s_sub_u32 s41, s40, 6
    s_cmp_ge_u32 s40, 6
    s_cselect_b32 s51, s41, s40
    s_add_u32 s40, s48, 2
    s_sub_u32 s41, s40, 6
    s_cmp_ge_u32 s40, 6
    s_cselect_b32 s52, s41, s40
    s_add_u32 s40, s48, 3
    s_sub_u32 s41, s40, 6
    s_cmp_ge_u32 s40, 6
    s_cselect_b32 s53, s41, s40
    s_add_u32 s40, s48, 4
    s_sub_u32 s41, s40, 6
    s_cmp_ge_u32 s40, 6
    s_cselect_b32 s54, s41, s40
    s_add_u32 s40, s48, 5
    s_sub_u32 s41, s40, 6
    s_cmp_ge_u32 s40, 6
    s_cselect_b32 s55, s41, s40
    s_waitcnt lgkmcnt(0)
    s_mul_i32 s40, s33, 192
    s_add_u32 s40, s40, 14725120
    v_mbcnt_lo_u32_b32 v4, -1, 0
    v_mbcnt_hi_u32_b32 v4, -1, v4
    v_min_u32 v4, 23, v4
    v_lshlrev_b32 v4, 3, v4
    s_mov_b32 s67, 0
fpoll_22:
    buffer_load_dwordx2 v[8:9], v4, s[12:15], s40 offen sc1
    s_add_u32 s67, s67, 1
    s_waitcnt vmcnt(0)
    v_cmp_ne_u32 vcc, s100, v8
    v_cmp_ne_u32 s[64:65], s101, v9
    s_nop 0
    s_or_b64 vcc, vcc, s[64:65]
    s_cmp_gt_u32 s67, 100000
    s_cbranch_scc1 fpoll_e_23
    s_cmp_eq_u64 vcc, 0
    s_cbranch_scc1 fpoll_e_23
    s_sleep 2
    s_branch fpoll_22
fpoll_e_23:
    s_mul_i32 s40, s50, 20480
    s_add_u32 s40, s40, s46
    s_add_u32 s40, s40, 0
    s_mul_i32 s41, s34, 5120
    s_add_u32 m0, s41, 0
    s_nop 0
    buffer_load_dwordx4 v7, s[12:15], s40 offen sc1 lds
    s_mul_i32 s40, s50, 20480
    s_add_u32 s40, s40, s46
    s_add_u32 s40, s40, 1024
    s_mul_i32 s41, s34, 5120
    s_add_u32 m0, s41, 1024
    s_nop 0
    buffer_load_dwordx4 v7, s[12:15], s40 offen sc1 lds
    s_mul_i32 s40, s50, 20480
    s_add_u32 s40, s40, s46
    s_add_u32 s40, s40, 2048
    s_mul_i32 s41, s34, 5120
    s_add_u32 m0, s41, 2048
    s_nop 0
    buffer_load_dwordx4 v7, s[12:15], s40 offen sc1 lds
    s_mul_i32 s40, s50, 20480
    s_add_u32 s40, s40, s46
    s_add_u32 s40, s40, 3072
    s_mul_i32 s41, s34, 5120
    s_add_u32 m0, s41, 3072
    s_nop 0
    buffer_load_dwordx4 v7, s[12:15], s40 offen sc1 lds
    s_mul_i32 s40, s50, 20480
    s_add_u32 s40, s40, s46
    s_add_u32 s40, s40, 4096
    s_mul_i32 s41, s34, 5120
    s_add_u32 m0, s41, 4096
    s_nop 0
    buffer_load_dwordx4 v7, s[12:15], s40 offen sc1 lds
    s_mul_i32 s40, s51, 20480
    s_add_u32 s40, s40, s46
    s_add_u32 s40, s40, 0
    s_mul_i32 s41, s34, 5120
    s_add_u32 m0, s41, 20480
    s_nop 0
    buffer_load_dwordx4 v7, s[12:15], s40 offen sc1 lds
    s_mul_i32 s40, s51, 20480
    s_add_u32 s40, s40, s46
    s_add_u32 s40, s40, 1024
    s_mul_i32 s41, s34, 5120
    s_add_u32 m0, s41, 21504
    s_nop 0
    buffer_load_dwordx4 v7, s[12:15], s40 offen sc1 lds
    s_mul_i32 s40, s51, 20480
    s_add_u32 s40, s40, s46
    s_add_u32 s40, s40, 2048
    s_mul_i32 s41, s34, 5120
    s_add_u32 m0, s41, 22528
    s_nop 0
    buffer_load_dwordx4 v7, s[12:15], s40 offen sc1 lds
    s_mul_i32 s40, s51, 20480
    s_add_u32 s40, s40, s46
    s_add_u32 s40, s40, 3072
    s_mul_i32 s41, s34, 5120
    s_add_u32 m0, s41, 23552
    s_nop 0
    buffer_load_dwordx4 v7, s[12:15], s40 offen sc1 lds
    s_mul_i32 s40, s51, 20480
    s_add_u32 s40, s40, s46
    s_add_u32 s40, s40, 4096
    s_mul_i32 s41, s34, 5120
    s_add_u32 m0, s41, 24576
    s_nop 0
    buffer_load_dwordx4 v7, s[12:15], s40 offen sc1 lds
    s_mul_i32 s40, s52, 20480
    s_add_u32 s40, s40, s46
    s_add_u32 s40, s40, 0
    s_mul_i32 s41, s34, 5120
    s_add_u32 m0, s41, 40960
    s_nop 0
    buffer_load_dwordx4 v7, s[12:15], s40 offen sc1 lds
    s_mul_i32 s40, s52, 20480
    s_add_u32 s40, s40, s46
    s_add_u32 s40, s40, 1024
    s_mul_i32 s41, s34, 5120
    s_add_u32 m0, s41, 41984
    s_nop 0
    buffer_load_dwordx4 v7, s[12:15], s40 offen sc1 lds
    s_mul_i32 s40, s52, 20480
    s_add_u32 s40, s40, s46
    s_add_u32 s40, s40, 2048
    s_mul_i32 s41, s34, 5120
    s_add_u32 m0, s41, 43008
    s_nop 0
    buffer_load_dwordx4 v7, s[12:15], s40 offen sc1 lds
    s_mul_i32 s40, s52, 20480
    s_add_u32 s40, s40, s46
    s_add_u32 s40, s40, 3072
    s_mul_i32 s41, s34, 5120
    s_add_u32 m0, s41, 44032
    s_nop 0
    buffer_load_dwordx4 v7, s[12:15], s40 offen sc1 lds
    s_mul_i32 s40, s52, 20480
    s_add_u32 s40, s40, s46
    s_add_u32 s40, s40, 4096
    s_mul_i32 s41, s34, 5120
    s_add_u32 m0, s41, 45056
    s_nop 0
    buffer_load_dwordx4 v7, s[12:15], s40 offen sc1 lds
    s_mul_i32 s40, s53, 20480
    s_add_u32 s40, s40, s46
    s_add_u32 s40, s40, 0
    s_mul_i32 s41, s34, 5120
    s_add_u32 m0, s41, 61440
    s_nop 0
    buffer_load_dwordx4 v7, s[12:15], s40 offen sc1 lds
    s_mul_i32 s40, s53, 20480
    s_add_u32 s40, s40, s46
    s_add_u32 s40, s40, 1024
    s_mul_i32 s41, s34, 5120
    s_add_u32 m0, s41, 62464
    s_nop 0
    buffer_load_dwordx4 v7, s[12:15], s40 offen sc1 lds
    s_mul_i32 s40, s53, 20480
    s_add_u32 s40, s40, s46
    s_add_u32 s40, s40, 2048
    s_mul_i32 s41, s34, 5120
    s_add_u32 m0, s41, 63488
    s_nop 0
    buffer_load_dwordx4 v7, s[12:15], s40 offen sc1 lds
    s_mul_i32 s40, s53, 20480
    s_add_u32 s40, s40, s46
    s_add_u32 s40, s40, 3072
    s_mul_i32 s41, s34, 5120
    s_add_u32 m0, s41, 64512
    s_nop 0
    buffer_load_dwordx4 v7, s[12:15], s40 offen sc1 lds
    s_mul_i32 s40, s53, 20480
    s_add_u32 s40, s40, s46
    s_add_u32 s40, s40, 4096
    s_mul_i32 s41, s34, 5120
    s_add_u32 m0, s41, 65536
    s_nop 0
    buffer_load_dwordx4 v7, s[12:15], s40 offen sc1 lds
    s_mul_i32 s40, s54, 20480
    s_add_u32 s40, s40, s46
    s_add_u32 s40, s40, 0
    s_mul_i32 s41, s34, 5120
    s_add_u32 m0, s41, 81920
    s_nop 0
    buffer_load_dwordx4 v7, s[12:15], s40 offen sc1 lds
    s_mul_i32 s40, s54, 20480
    s_add_u32 s40, s40, s46
    s_add_u32 s40, s40, 1024
    s_mul_i32 s41, s34, 5120
    s_add_u32 m0, s41, 82944
    s_nop 0
    buffer_load_dwordx4 v7, s[12:15], s40 offen sc1 lds
    s_mul_i32 s40, s54, 20480
    s_add_u32 s40, s40, s46
    s_add_u32 s40, s40, 2048
    s_mul_i32 s41, s34, 5120
    s_add_u32 m0, s41, 83968
    s_nop 0
    buffer_load_dwordx4 v7, s[12:15], s40 offen sc1 lds
    s_mul_i32 s40, s54, 20480
    s_add_u32 s40, s40, s46
    s_add_u32 s40, s40, 3072
    s_mul_i32 s41, s34, 5120
    s_add_u32 m0, s41, 84992
    s_nop 0
    buffer_load_dwordx4 v7, s[12:15], s40 offen sc1 lds
    s_mul_i32 s40, s54, 20480
    s_add_u32 s40, s40, s46
    s_add_u32 s40, s40, 4096
    s_mul_i32 s41, s34, 5120
    s_add_u32 m0, s41, 86016
    s_nop 0
    buffer_load_dwordx4 v7, s[12:15], s40 offen sc1 lds
    s_mul_i32 s40, s55, 20480
    s_add_u32 s40, s40, s46
    s_add_u32 s40, s40, 0
    s_mul_i32 s41, s34, 5120
    s_add_u32 m0, s41, 102400
    s_nop 0
    buffer_load_dwordx4 v7, s[12:15], s40 offen sc1 lds
    s_mul_i32 s40, s55, 20480
    s_add_u32 s40, s40, s46
    s_add_u32 s40, s40, 1024
    s_mul_i32 s41, s34, 5120
    s_add_u32 m0, s41, 103424
    s_nop 0
    buffer_load_dwordx4 v7, s[12:15], s40 offen sc1 lds
    s_mul_i32 s40, s55, 20480
    s_add_u32 s40, s40, s46
    s_add_u32 s40, s40, 2048
    s_mul_i32 s41, s34, 5120
    s_add_u32 m0, s41, 104448
    s_nop 0
    buffer_load_dwordx4 v7, s[12:15], s40 offen sc1 lds
    s_mul_i32 s40, s55, 20480
    s_add_u32 s40, s40, s46
    s_add_u32 s40, s40, 3072
    s_mul_i32 s41, s34, 5120
    s_add_u32 m0, s41, 105472
    s_nop 0
    buffer_load_dwordx4 v7, s[12:15], s40 offen sc1 lds
    s_mul_i32 s40, s55, 20480
    s_add_u32 s40, s40, s46
    s_add_u32 s40, s40, 4096
    s_mul_i32 s41, s34, 5120
    s_add_u32 m0, s41, 106496
    s_nop 0
    buffer_load_dwordx4 v7, s[12:15], s40 offen sc1 lds
    v_mbcnt_lo_u32_b32 v4, -1, 0
    v_mbcnt_hi_u32_b32 v4, -1, v4
    v_lshlrev_b32 v4, 4, v4
    s_mov_b32 s66, 14721024
    s_mov_b32 s67, 0
fpoll_24:
    buffer_load_dwordx4 v[8:11], v4, s[12:15], s66 offen sc1
    buffer_load_dwordx4 v[12:15], v4, s[12:15], s66 offen offset:1024 sc1
    s_add_u32 s67, s67, 1
    s_waitcnt vmcnt(0)
    v_cmp_ne_u32 vcc, s100, v8
    v_cmp_ne_u32 s[64:65], s101, v9
    s_nop 0
    s_or_b64 vcc, vcc, s[64:65]
    v_cmp_ne_u32 s[64:65], s100, v10
    s_nop 0
    s_or_b64 vcc, vcc, s[64:65]
    v_cmp_ne_u32 s[64:65], s101, v11
    s_nop 0
    s_or_b64 vcc, vcc, s[64:65]
    v_cmp_ne_u32 s[64:65], s100, v12
    s_nop 0
    s_or_b64 vcc, vcc, s[64:65]
    v_cmp_ne_u32 s[64:65], s101, v13
    s_nop 0
    s_or_b64 vcc, vcc, s[64:65]
    v_cmp_ne_u32 s[64:65], s100, v14
    s_nop 0
    s_or_b64 vcc, vcc, s[64:65]
    v_cmp_ne_u32 s[64:65], s101, v15
    s_nop 0
    s_or_b64 vcc, vcc, s[64:65]
    s_cmp_gt_u32 s67, 100000
    s_cbranch_scc1 fpoll_e_25
    s_cmp_eq_u64 vcc, 0
    s_cbranch_scc1 fpoll_e_25
    s_sleep 2
    s_branch fpoll_24
fpoll_e_25:
    s_lshl_b32 s42, s50, 12
    s_add_u32 s42, s42, s47
    buffer_load_dwordx4 v[8:11], v7, s[12:15], s42 offen offset:0 sc1
    s_lshl_b32 s42, s50, 12
    s_add_u32 s42, s42, s47
    buffer_load_dwordx4 v[12:15], v7, s[12:15], s42 offen offset:1024 sc1
    s_lshl_b32 s42, s50, 12
    s_add_u32 s42, s42, s47
    buffer_load_dwordx4 v[16:19], v7, s[12:15], s42 offen offset:2048 sc1
    s_lshl_b32 s42, s50, 12
    s_add_u32 s42, s42, s47
    buffer_load_dwordx4 v[20:23], v7, s[12:15], s42 offen offset:3072 sc1
    s_lshl_b32 s42, s51, 12
    s_add_u32 s42, s42, s47
    buffer_load_dwordx4 v[24:27], v7, s[12:15], s42 offen offset:0 sc1
    s_lshl_b32 s42, s51, 12
    s_add_u32 s42, s42, s47
    buffer_load_dwordx4 v[28:31], v7, s[12:15], s42 offen offset:1024 sc1
    s_lshl_b32 s42, s51, 12
    s_add_u32 s42, s42, s47
    buffer_load_dwordx4 v[32:35], v7, s[12:15], s42 offen offset:2048 sc1
    s_lshl_b32 s42, s51, 12
    s_add_u32 s42, s42, s47
    buffer_load_dwordx4 v[36:39], v7, s[12:15], s42 offen offset:3072 sc1
    s_mul_i32 s44, s33, 160
    s_mul_i32 s45, s32, 81920
    s_add_u32 s45, s45, s44
    v_add_u32 v4, 0, v1
    v_mul_u32_u24 v5, 6554, v4
    v_lshrrev_b32 v5, 16, v5
    v_mul_u32_u24 v6, 10, v5
    v_sub_u32 v4, v4, v6
    v_lshlrev_b32 v4, 4, v4
    v_mul_u32_u24 v5, 1280, v5
    v_add_u32 v104, v4, v5
    v_add_u32 v4, 64, v1
    v_mul_u32_u24 v5, 6554, v4
    v_lshrrev_b32 v5, 16, v5
    v_mul_u32_u24 v6, 10, v5
    v_sub_u32 v4, v4, v6
    v_lshlrev_b32 v4, 4, v4
    v_mul_u32_u24 v5, 1280, v5
    v_add_u32 v105, v4, v5
    v_add_u32 v4, 128, v1
    v_mul_u32_u24 v5, 6554, v4
    v_lshrrev_b32 v5, 16, v5
    v_mul_u32_u24 v6, 10, v5
    v_sub_u32 v4, v4, v6
    v_lshlrev_b32 v4, 4, v4
    v_mul_u32_u24 v5, 1280, v5
    v_add_u32 v106, v4, v5
    v_add_u32 v4, 192, v1
    v_mul_u32_u24 v5, 6554, v4
    v_lshrrev_b32 v5, 16, v5
    v_mul_u32_u24 v6, 10, v5
    v_sub_u32 v4, v4, v6
    v_lshlrev_b32 v4, 4, v4
    v_mul_u32_u24 v5, 1280, v5
    v_add_u32 v107, v4, v5
    v_add_u32 v4, 256, v1
    v_mul_u32_u24 v5, 6554, v4
    v_lshrrev_b32 v5, 16, v5
    v_mul_u32_u24 v6, 10, v5
    v_sub_u32 v4, v4, v6
    v_lshlrev_b32 v4, 4, v4
    v_mul_u32_u24 v5, 1280, v5
    v_add_u32 v108, v4, v5
    v_lshrrev_b32 v2, 4, v1
    v_and_b32 v3, 15, v1
    v_mov_b32 v113, v7
    v_add_u32 v114, 61440, v7
    s_waitcnt vmcnt(33)
    s_barrier
    ds_read_b128 v[136:139], v113 offset:0
    ds_read_b128 v[140:143], v113 offset:1024
    ds_read_b128 v[144:147], v113 offset:2048
    ds_read_b128 v[148:151], v113 offset:3072
    ds_read_b128 v[152:155], v113 offset:4096
    ds_read_b128 v[156:159], v113 offset:5120
    ds_read_b128 v[160:163], v113 offset:6144
    ds_read_b128 v[164:167], v113 offset:7168
    ds_read_b128 v[168:171], v113 offset:8192
    ds_read_b128 v[172:175], v113 offset:9216
    s_waitcnt vmcnt(7)
    s_waitcnt lgkmcnt(9)
    v_mfma_f32_16x16x32_bf16 v[116:119], v[136:139], v[8:11], 0
    s_lshl_b32 s42, s52, 12
    s_add_u32 s42, s42, s47
    buffer_load_dwordx4 v[40:43], v7, s[12:15], s42 offen offset:0 sc1
    s_waitcnt lgkmcnt(8)
    v_mfma_f32_16x16x32_bf16 v[120:123], v[140:143], v[8:11], 0
    s_waitcnt lgkmcnt(7)
    v_mfma_f32_16x16x32_bf16 v[124:127], v[144:147], v[8:11], 0
    s_lshl_b32 s42, s52, 12
    s_add_u32 s42, s42, s47
    buffer_load_dwordx4 v[44:47], v7, s[12:15], s42 offen offset:1024 sc1
    s_waitcnt lgkmcnt(6)
    v_mfma_f32_16x16x32_bf16 v[128:131], v[148:151], v[8:11], 0
    s_waitcnt lgkmcnt(5)
    v_mfma_f32_16x16x32_bf16 v[132:135], v[152:155], v[8:11], 0
    s_lshl_b32 s42, s52, 12
    s_add_u32 s42, s42, s47
    buffer_load_dwordx4 v[48:51], v7, s[12:15], s42 offen offset:2048 sc1
    ds_read_b128 v[136:139], v113 offset:10240
    ds_read_b128 v[140:143], v113 offset:11264
    ds_read_b128 v[144:147], v113 offset:12288
    ds_read_b128 v[148:151], v113 offset:13312
    ds_read_b128 v[152:155], v113 offset:14336
    s_waitcnt vmcnt(9)
    s_waitcnt lgkmcnt(9)
    v_mfma_f32_16x16x32_bf16 v[116:119], v[156:159], v[12:15], v[116:119]
    s_lshl_b32 s42, s52, 12
    s_add_u32 s42, s42, s47
    buffer_load_dwordx4 v[52:55], v7, s[12:15], s42 offen offset:3072 sc1
    s_waitcnt lgkmcnt(8)
    v_mfma_f32_16x16x32_bf16 v[120:123], v[160:163], v[12:15], v[120:123]
    s_waitcnt lgkmcnt(7)
    v_mfma_f32_16x16x32_bf16 v[124:127], v[164:167], v[12:15], v[124:127]
    s_waitcnt lgkmcnt(6)
    v_mfma_f32_16x16x32_bf16 v[128:131], v[168:171], v[12:15], v[128:131]
    s_waitcnt lgkmcnt(5)
    v_mfma_f32_16x16x32_bf16 v[132:135], v[172:175], v[12:15], v[132:135]
    ds_read_b128 v[156:159], v113 offset:15360
    ds_read_b128 v[160:163], v113 offset:16384
    ds_read_b128 v[164:167], v113 offset:17408
    ds_read_b128 v[168:171], v113 offset:18432
    ds_read_b128 v[172:175], v113 offset:19456
    s_waitcnt vmcnt(9)
    s_waitcnt lgkmcnt(9)
    v_mfma_f32_16x16x32_bf16 v[116:119], v[136:139], v[16:19], v[116:119]
    s_waitcnt lgkmcnt(8)
    v_mfma_f32_16x16x32_bf16 v[120:123], v[140:143], v[16:19], v[120:123]
    s_waitcnt lgkmcnt(7)
    v_mfma_f32_16x16x32_bf16 v[124:127], v[144:147], v[16:19], v[124:127]
    s_waitcnt lgkmcnt(6)
    v_mfma_f32_16x16x32_bf16 v[128:131], v[148:151], v[16:19], v[128:131]
    s_waitcnt lgkmcnt(5)
    v_mfma_f32_16x16x32_bf16 v[132:135], v[152:155], v[16:19], v[132:135]
    s_waitcnt vmcnt(8)
    s_waitcnt lgkmcnt(4)
    v_mfma_f32_16x16x32_bf16 v[116:119], v[156:159], v[20:23], v[116:119]
    s_waitcnt lgkmcnt(3)
    v_mfma_f32_16x16x32_bf16 v[120:123], v[160:163], v[20:23], v[120:123]
    s_waitcnt lgkmcnt(2)
    v_mfma_f32_16x16x32_bf16 v[124:127], v[164:167], v[20:23], v[124:127]
    s_waitcnt lgkmcnt(1)
    v_mfma_f32_16x16x32_bf16 v[128:131], v[168:171], v[20:23], v[128:131]
    s_waitcnt lgkmcnt(0)
    v_mfma_f32_16x16x32_bf16 v[132:135], v[172:175], v[20:23], v[132:135]
    s_waitcnt vmcnt(32)
    s_barrier
    ds_read_b128 v[136:139], v113 offset:20480
    ds_read_b128 v[140:143], v113 offset:21504
    ds_read_b128 v[144:147], v113 offset:22528
    ds_read_b128 v[148:151], v113 offset:23552
    ds_read_b128 v[152:155], v113 offset:24576
    ds_read_b128 v[156:159], v113 offset:25600
    ds_read_b128 v[160:163], v113 offset:26624
    ds_read_b128 v[164:167], v113 offset:27648
    ds_read_b128 v[168:171], v113 offset:28672
    ds_read_b128 v[172:175], v113 offset:29696
    s_waitcnt vmcnt(7)
    s_waitcnt lgkmcnt(9)
    v_mfma_f32_16x16x32_bf16 v[116:119], v[136:139], v[24:27], v[116:119]
    s_lshl_b32 s42, s53, 12
    s_add_u32 s42, s42, s47
    buffer_load_dwordx4 v[56:59], v7, s[12:15], s42 offen offset:0 sc1
    s_waitcnt lgkmcnt(8)
    v_mfma_f32_16x16x32_bf16 v[120:123], v[140:143], v[24:27], v[120:123]
    s_waitcnt lgkmcnt(7)
    v_mfma_f32_16x16x32_bf16 v[124:127], v[144:147], v[24:27], v[124:127]
    s_lshl_b32 s42, s53, 12
    s_add_u32 s42, s42, s47
    buffer_load_dwordx4 v[60:63], v7, s[12:15], s42 offen offset:1024 sc1
    s_waitcnt lgkmcnt(6)
    v_mfma_f32_16x16x32_bf16 v[128:131], v[148:151], v[24:27], v[128:131]
    s_waitcnt lgkmcnt(5)
    v_mfma_f32_16x16x32_bf16 v[132:135], v[152:155], v[24:27], v[132:135]
    s_lshl_b32 s42, s53, 12
    s_add_u32 s42, s42, s47
    buffer_load_dwordx4 v[64:67], v7, s[12:15], s42 offen offset:2048 sc1
    ds_read_b128 v[136:139], v113 offset:30720
    ds_read_b128 v[140:143], v113 offset:31744
    ds_read_b128 v[144:147], v113 offset:32768
    ds_read_b128 v[148:151], v113 offset:33792
    ds_read_b128 v[152:155], v113 offset:34816
    s_waitcnt vmcnt(9)
    s_waitcnt lgkmcnt(9)
    v_mfma_f32_16x16x32_bf16 v[116:119], v[156:159], v[28:31], v[116:119]
    s_lshl_b32 s42, s53, 12
    s_add_u32 s42, s42, s47
    buffer_load_dwordx4 v[68:71], v7, s[12:15], s42 offen offset:3072 sc1
    s_waitcnt lgkmcnt(8)
    v_mfma_f32_16x16x32_bf16 v[120:123], v[160:163], v[28:31], v[120:123]
    s_waitcnt lgkmcnt(7)
    v_mfma_f32_16x16x32_bf16 v[124:127], v[164:167], v[28:31], v[124:127]
    s_waitcnt lgkmcnt(6)
    v_mfma_f32_16x16x32_bf16 v[128:131], v[168:171], v[28:31], v[128:131]
    s_waitcnt lgkmcnt(5)
    v_mfma_f32_16x16x32_bf16 v[132:135], v[172:175], v[28:31], v[132:135]
    ds_read_b128 v[156:159], v113 offset:35840
    ds_read_b128 v[160:163], v113 offset:36864
    ds_read_b128 v[164:167], v113 offset:37888
    ds_read_b128 v[168:171], v113 offset:38912
    ds_read_b128 v[172:175], v113 offset:39936
    s_waitcnt vmcnt(9)
    s_waitcnt lgkmcnt(9)
    v_mfma_f32_16x16x32_bf16 v[116:119], v[136:139], v[32:35], v[116:119]
    s_waitcnt lgkmcnt(8)
    v_mfma_f32_16x16x32_bf16 v[120:123], v[140:143], v[32:35], v[120:123]
    s_waitcnt lgkmcnt(7)
    v_mfma_f32_16x16x32_bf16 v[124:127], v[144:147], v[32:35], v[124:127]
    s_waitcnt lgkmcnt(6)
    v_mfma_f32_16x16x32_bf16 v[128:131], v[148:151], v[32:35], v[128:131]
    s_waitcnt lgkmcnt(5)
    v_mfma_f32_16x16x32_bf16 v[132:135], v[152:155], v[32:35], v[132:135]
    s_waitcnt vmcnt(8)
    s_waitcnt lgkmcnt(4)
    v_mfma_f32_16x16x32_bf16 v[116:119], v[156:159], v[36:39], v[116:119]
    s_waitcnt lgkmcnt(3)
    v_mfma_f32_16x16x32_bf16 v[120:123], v[160:163], v[36:39], v[120:123]
    s_waitcnt lgkmcnt(2)
    v_mfma_f32_16x16x32_bf16 v[124:127], v[164:167], v[36:39], v[124:127]
    s_waitcnt lgkmcnt(1)
    v_mfma_f32_16x16x32_bf16 v[128:131], v[168:171], v[36:39], v[128:131]
    s_waitcnt lgkmcnt(0)
    v_mfma_f32_16x16x32_bf16 v[132:135], v[172:175], v[36:39], v[132:135]
    s_waitcnt vmcnt(31)
    s_barrier
    ds_read_b128 v[136:139], v113 offset:40960
    ds_read_b128 v[140:143], v113 offset:41984
    ds_read_b128 v[144:147], v113 offset:43008
    ds_read_b128 v[148:151], v113 offset:44032
    ds_read_b128 v[152:155], v113 offset:45056
    ds_read_b128 v[156:159], v113 offset:46080
    ds_read_b128 v[160:163], v113 offset:47104
    ds_read_b128 v[164:167], v113 offset:48128
    ds_read_b128 v[168:171], v113 offset:49152
    ds_read_b128 v[172:175], v113 offset:50176
    s_waitcnt vmcnt(7)
    s_waitcnt lgkmcnt(9)
    v_mfma_f32_16x16x32_bf16 v[116:119], v[136:139], v[40:43], v[116:119]
    s_lshl_b32 s42, s54, 12
    s_add_u32 s42, s42, s47
    buffer_load_dwordx4 v[72:75], v7, s[12:15], s42 offen offset:0 sc1
    s_waitcnt lgkmcnt(8)
    v_mfma_f32_16x16x32_bf16 v[120:123], v[140:143], v[40:43], v[120:123]
    s_waitcnt lgkmcnt(7)
    v_mfma_f32_16x16x32_bf16 v[124:127], v[144:147], v[40:43], v[124:127]
    s_lshl_b32 s42, s54, 12
    s_add_u32 s42, s42, s47
    buffer_load_dwordx4 v[76:79], v7, s[12:15], s42 offen offset:1024 sc1
    s_waitcnt lgkmcnt(6)
    v_mfma_f32_16x16x32_bf16 v[128:131], v[148:151], v[40:43], v[128:131]
    s_waitcnt lgkmcnt(5)
    v_mfma_f32_16x16x32_bf16 v[132:135], v[152:155], v[40:43], v[132:135]
    s_lshl_b32 s42, s54, 12
    s_add_u32 s42, s42, s47
    buffer_load_dwordx4 v[80:83], v7, s[12:15], s42 offen offset:2048 sc1
    ds_read_b128 v[136:139], v113 offset:51200
    ds_read_b128 v[140:143], v113 offset:52224
    ds_read_b128 v[144:147], v113 offset:53248
    ds_read_b128 v[148:151], v113 offset:54272
    ds_read_b128 v[152:155], v113 offset:55296
    s_waitcnt vmcnt(9)
    s_waitcnt lgkmcnt(9)
    v_mfma_f32_16x16x32_bf16 v[116:119], v[156:159], v[44:47], v[116:119]
    s_lshl_b32 s42, s54, 12
    s_add_u32 s42, s42, s47
    buffer_load_dwordx4 v[84:87], v7, s[12:15], s42 offen offset:3072 sc1
    s_waitcnt lgkmcnt(8)
    v_mfma_f32_16x16x32_bf16 v[120:123], v[160:163], v[44:47], v[120:123]
    s_waitcnt lgkmcnt(7)
    v_mfma_f32_16x16x32_bf16 v[124:127], v[164:167], v[44:47], v[124:127]
    s_waitcnt lgkmcnt(6)
    v_mfma_f32_16x16x32_bf16 v[128:131], v[168:171], v[44:47], v[128:131]
    s_waitcnt lgkmcnt(5)
    v_mfma_f32_16x16x32_bf16 v[132:135], v[172:175], v[44:47], v[132:135]
    ds_read_b128 v[156:159], v113 offset:56320
    ds_read_b128 v[160:163], v113 offset:57344
    ds_read_b128 v[164:167], v113 offset:58368
    ds_read_b128 v[168:171], v113 offset:59392
    ds_read_b128 v[172:175], v113 offset:60416
    s_waitcnt vmcnt(9)
    s_waitcnt lgkmcnt(9)
    v_mfma_f32_16x16x32_bf16 v[116:119], v[136:139], v[48:51], v[116:119]
    s_waitcnt lgkmcnt(8)
    v_mfma_f32_16x16x32_bf16 v[120:123], v[140:143], v[48:51], v[120:123]
    s_waitcnt lgkmcnt(7)
    v_mfma_f32_16x16x32_bf16 v[124:127], v[144:147], v[48:51], v[124:127]
    s_waitcnt lgkmcnt(6)
    v_mfma_f32_16x16x32_bf16 v[128:131], v[148:151], v[48:51], v[128:131]
    s_waitcnt lgkmcnt(5)
    v_mfma_f32_16x16x32_bf16 v[132:135], v[152:155], v[48:51], v[132:135]
    s_waitcnt vmcnt(8)
    s_waitcnt lgkmcnt(4)
    v_mfma_f32_16x16x32_bf16 v[116:119], v[156:159], v[52:55], v[116:119]
    s_waitcnt lgkmcnt(3)
    v_mfma_f32_16x16x32_bf16 v[120:123], v[160:163], v[52:55], v[120:123]
    s_waitcnt lgkmcnt(2)
    v_mfma_f32_16x16x32_bf16 v[124:127], v[164:167], v[52:55], v[124:127]
    s_waitcnt lgkmcnt(1)
    v_mfma_f32_16x16x32_bf16 v[128:131], v[168:171], v[52:55], v[128:131]
    s_waitcnt lgkmcnt(0)
    v_mfma_f32_16x16x32_bf16 v[132:135], v[172:175], v[52:55], v[132:135]
    s_waitcnt vmcnt(30)
    s_barrier
    ds_read_b128 v[136:139], v114 offset:0
    ds_read_b128 v[140:143], v114 offset:1024
    ds_read_b128 v[144:147], v114 offset:2048
    ds_read_b128 v[148:151], v114 offset:3072
    ds_read_b128 v[152:155], v114 offset:4096
    ds_read_b128 v[156:159], v114 offset:5120
    ds_read_b128 v[160:163], v114 offset:6144
    ds_read_b128 v[164:167], v114 offset:7168
    ds_read_b128 v[168:171], v114 offset:8192
    ds_read_b128 v[172:175], v114 offset:9216
    s_waitcnt vmcnt(7)
    s_waitcnt lgkmcnt(9)
    v_mfma_f32_16x16x32_bf16 v[116:119], v[136:139], v[56:59], v[116:119]
    s_lshl_b32 s42, s55, 12
    s_add_u32 s42, s42, s47
    buffer_load_dwordx4 v[88:91], v7, s[12:15], s42 offen offset:0 sc1
    s_waitcnt lgkmcnt(8)
    v_mfma_f32_16x16x32_bf16 v[120:123], v[140:143], v[56:59], v[120:123]
    s_waitcnt lgkmcnt(7)
    v_mfma_f32_16x16x32_bf16 v[124:127], v[144:147], v[56:59], v[124:127]
    s_lshl_b32 s42, s55, 12
    s_add_u32 s42, s42, s47
    buffer_load_dwordx4 v[92:95], v7, s[12:15], s42 offen offset:1024 sc1
    s_waitcnt lgkmcnt(6)
    v_mfma_f32_16x16x32_bf16 v[128:131], v[148:151], v[56:59], v[128:131]
    s_waitcnt lgkmcnt(5)
    v_mfma_f32_16x16x32_bf16 v[132:135], v[152:155], v[56:59], v[132:135]
    s_lshl_b32 s42, s55, 12
    s_add_u32 s42, s42, s47
    buffer_load_dwordx4 v[96:99], v7, s[12:15], s42 offen offset:2048 sc1
    ds_read_b128 v[136:139], v114 offset:10240
    ds_read_b128 v[140:143], v114 offset:11264
    ds_read_b128 v[144:147], v114 offset:12288
    ds_read_b128 v[148:151], v114 offset:13312
    ds_read_b128 v[152:155], v114 offset:14336
    s_waitcnt vmcnt(9)
    s_waitcnt lgkmcnt(9)
    v_mfma_f32_16x16x32_bf16 v[116:119], v[156:159], v[60:63], v[116:119]
    s_lshl_b32 s42, s55, 12
    s_add_u32 s42, s42, s47
    buffer_load_dwordx4 v[100:103], v7, s[12:15], s42 offen offset:3072 sc1
    s_waitcnt lgkmcnt(8)
    v_mfma_f32_16x16x32_bf16 v[120:123], v[160:163], v[60:63], v[120:123]
    s_waitcnt lgkmcnt(7)
    v_mfma_f32_16x16x32_bf16 v[124:127], v[164:167], v[60:63], v[124:127]
    s_cmp_ge_u32 s34, 2
    s_cbranch_scc1 k3_y_26
    s_mul_i32 s40, s34, 40960
    s_add_u32 s40, s40, s45
    s_mul_i32 s41, s34, 5120
    s_add_u32 m0, s41, 122880
    s_nop 0
    buffer_load_dwordx4 v104, s[8:11], s40 offen lds
    s_add_u32 m0, s41, 123904
    s_nop 0
    buffer_load_dwordx4 v105, s[8:11], s40 offen lds
    s_add_u32 m0, s41, 124928
    s_nop 0
    buffer_load_dwordx4 v106, s[8:11], s40 offen lds
    s_add_u32 m0, s41, 125952
    s_nop 0
    buffer_load_dwordx4 v107, s[8:11], s40 offen lds
    s_add_u32 m0, s41, 126976
    s_nop 0
    buffer_load_dwordx4 v108, s[8:11], s40 offen lds
    s_branch k3_xy_27
k3_y_26:
    v_lshrrev_b32 v4, 3, v1
    v_lshlrev_b32 v4, 12, v4
    v_and_b32 v5, 7, v1
    v_lshl_add_u32 v112, v5, 4, v4
    s_sub_u32 s42, s34, 2
    s_mul_i32 s40, s42, 40
    s_mul_i32 s41, s33, 80
    s_add_u32 s40, s40, s41
    s_lshl_b32 s40, s40, 12
    s_lshl_b32 s41, s32, 7
    s_add_u32 s40, s40, s41
    s_add_u32 s40, s40, 8912896
    s_mul_i32 s41, s42, 5120
    s_add_u32 m0, s41, 133120
    s_nop 0
    buffer_load_dwordx4 v112, s[12:15], s40 offen sc1 lds
    s_add_u32 s40, s40, 32768
    s_add_u32 m0, s41, 134144
    s_nop 0
    buffer_load_dwordx4 v112, s[12:15], s40 offen sc1 lds
    s_add_u32 s40, s40, 32768
    s_add_u32 m0, s41, 135168
    s_nop 0
    buffer_load_dwordx4 v112, s[12:15], s40 offen sc1 lds
    s_add_u32 s40, s40, 32768
    s_add_u32 m0, s41, 136192
    s_nop 0
    buffer_load_dwordx4 v112, s[12:15], s40 offen sc1 lds
    s_add_u32 s40, s40, 32768
    s_add_u32 m0, s41, 137216
    s_nop 0
    buffer_load_dwordx4 v112, s[12:15], s40 offen sc1 lds
    s_add_u32 s40, s40, 32768
k3_xy_27:
    s_lshl_b32 s40, s32, 9
    s_lshl_b32 s41, s34, 7
    s_add_u32 s40, s40, s41
    s_add_u32 s40, s40, 14680064
    v_lshlrev_b32 v4, 3, v3
    buffer_load_dwordx2 v[110:111], v4, s[12:15], s40 offen sc1
    s_waitcnt lgkmcnt(6)
    v_mfma_f32_16x16x32_bf16 v[128:131], v[168:171], v[60:63], v[128:131]
    s_waitcnt lgkmcnt(5)
    v_mfma_f32_16x16x32_bf16 v[132:135], v[172:175], v[60:63], v[132:135]
    ds_read_b128 v[156:159], v114 offset:15360
    ds_read_b128 v[160:163], v114 offset:16384
    ds_read_b128 v[164:167], v114 offset:17408
    ds_read_b128 v[168:171], v114 offset:18432
    ds_read_b128 v[172:175], v114 offset:19456
    s_waitcnt vmcnt(15)
    s_waitcnt lgkmcnt(9)
    v_mfma_f32_16x16x32_bf16 v[116:119], v[136:139], v[64:67], v[116:119]
    s_waitcnt lgkmcnt(8)
    v_mfma_f32_16x16x32_bf16 v[120:123], v[140:143], v[64:67], v[120:123]
    s_waitcnt lgkmcnt(7)
    v_mfma_f32_16x16x32_bf16 v[124:127], v[144:147], v[64:67], v[124:127]
    s_waitcnt lgkmcnt(6)
    v_mfma_f32_16x16x32_bf16 v[128:131], v[148:151], v[64:67], v[128:131]
    s_waitcnt lgkmcnt(5)
    v_mfma_f32_16x16x32_bf16 v[132:135], v[152:155], v[64:67], v[132:135]
    s_waitcnt vmcnt(14)
    s_waitcnt lgkmcnt(4)
    v_mfma_f32_16x16x32_bf16 v[116:119], v[156:159], v[68:71], v[116:119]
    s_waitcnt lgkmcnt(3)
    v_mfma_f32_16x16x32_bf16 v[120:123], v[160:163], v[68:71], v[120:123]
    s_waitcnt lgkmcnt(2)
    v_mfma_f32_16x16x32_bf16 v[124:127], v[164:167], v[68:71], v[124:127]
    s_waitcnt lgkmcnt(1)
    v_mfma_f32_16x16x32_bf16 v[128:131], v[168:171], v[68:71], v[128:131]
    s_waitcnt lgkmcnt(0)
    v_mfma_f32_16x16x32_bf16 v[132:135], v[172:175], v[68:71], v[132:135]
    s_waitcnt vmcnt(35)
    s_barrier
    ds_read_b128 v[136:139], v114 offset:20480
    ds_read_b128 v[140:143], v114 offset:21504
    ds_read_b128 v[144:147], v114 offset:22528
    ds_read_b128 v[148:151], v114 offset:23552
    ds_read_b128 v[152:155], v114 offset:24576
    ds_read_b128 v[156:159], v114 offset:25600
    ds_read_b128 v[160:163], v114 offset:26624
    ds_read_b128 v[164:167], v114 offset:27648
    ds_read_b128 v[168:171], v114 offset:28672
    ds_read_b128 v[172:175], v114 offset:29696
    s_waitcnt vmcnt(13)
    s_waitcnt lgkmcnt(9)
    v_mfma_f32_16x16x32_bf16 v[116:119], v[136:139], v[72:75], v[116:119]
    s_waitcnt lgkmcnt(8)
    v_mfma_f32_16x16x32_bf16 v[120:123], v[140:143], v[72:75], v[120:123]
    s_waitcnt lgkmcnt(7)
    v_mfma_f32_16x16x32_bf16 v[124:127], v[144:147], v[72:75], v[124:127]
    s_waitcnt lgkmcnt(6)
    v_mfma_f32_16x16x32_bf16 v[128:131], v[148:151], v[72:75], v[128:131]
    s_waitcnt lgkmcnt(5)
    v_mfma_f32_16x16x32_bf16 v[132:135], v[152:155], v[72:75], v[132:135]
    ds_read_b128 v[136:139], v114 offset:30720
    ds_read_b128 v[140:143], v114 offset:31744
    ds_read_b128 v[144:147], v114 offset:32768
    ds_read_b128 v[148:151], v114 offset:33792
    ds_read_b128 v[152:155], v114 offset:34816
    s_waitcnt vmcnt(12)
    s_waitcnt lgkmcnt(9)
    v_mfma_f32_16x16x32_bf16 v[116:119], v[156:159], v[76:79], v[116:119]
    s_waitcnt lgkmcnt(8)
    v_mfma_f32_16x16x32_bf16 v[120:123], v[160:163], v[76:79], v[120:123]
    s_waitcnt lgkmcnt(7)
    v_mfma_f32_16x16x32_bf16 v[124:127], v[164:167], v[76:79], v[124:127]
    s_waitcnt lgkmcnt(6)
    v_mfma_f32_16x16x32_bf16 v[128:131], v[168:171], v[76:79], v[128:131]
    s_waitcnt lgkmcnt(5)
    v_mfma_f32_16x16x32_bf16 v[132:135], v[172:175], v[76:79], v[132:135]
    ds_read_b128 v[156:159], v114 offset:35840
    ds_read_b128 v[160:163], v114 offset:36864
    ds_read_b128 v[164:167], v114 offset:37888
    ds_read_b128 v[168:171], v114 offset:38912
    ds_read_b128 v[172:175], v114 offset:39936
    s_waitcnt vmcnt(11)
    s_waitcnt lgkmcnt(9)
    v_mfma_f32_16x16x32_bf16 v[116:119], v[136:139], v[80:83], v[116:119]
    s_waitcnt lgkmcnt(8)
    v_mfma_f32_16x16x32_bf16 v[120:123], v[140:143], v[80:83], v[120:123]
    s_waitcnt lgkmcnt(7)
    v_mfma_f32_16x16x32_bf16 v[124:127], v[144:147], v[80:83], v[124:127]
    s_waitcnt lgkmcnt(6)
    v_mfma_f32_16x16x32_bf16 v[128:131], v[148:151], v[80:83], v[128:131]
    s_waitcnt lgkmcnt(5)
    v_mfma_f32_16x16x32_bf16 v[132:135], v[152:155], v[80:83], v[132:135]
    s_waitcnt vmcnt(10)
    s_waitcnt lgkmcnt(4)
    v_mfma_f32_16x16x32_bf16 v[116:119], v[156:159], v[84:87], v[116:119]
    s_waitcnt lgkmcnt(3)
    v_mfma_f32_16x16x32_bf16 v[120:123], v[160:163], v[84:87], v[120:123]
    s_waitcnt lgkmcnt(2)
    v_mfma_f32_16x16x32_bf16 v[124:127], v[164:167], v[84:87], v[124:127]
    s_waitcnt lgkmcnt(1)
    v_mfma_f32_16x16x32_bf16 v[128:131], v[168:171], v[84:87], v[128:131]
    s_waitcnt lgkmcnt(0)
    v_mfma_f32_16x16x32_bf16 v[132:135], v[172:175], v[84:87], v[132:135]
    s_waitcnt vmcnt(30)
    s_barrier
    ds_read_b128 v[136:139], v114 offset:40960
    ds_read_b128 v[140:143], v114 offset:41984
    ds_read_b128 v[144:147], v114 offset:43008
    ds_read_b128 v[148:151], v114 offset:44032
    ds_read_b128 v[152:155], v114 offset:45056
    ds_read_b128 v[156:159], v114 offset:46080
    ds_read_b128 v[160:163], v114 offset:47104
    ds_read_b128 v[164:167], v114 offset:48128
    ds_read_b128 v[168:171], v114 offset:49152
    ds_read_b128 v[172:175], v114 offset:50176
    s_waitcnt vmcnt(9)
    s_waitcnt lgkmcnt(9)
    v_mfma_f32_16x16x32_bf16 v[116:119], v[136:139], v[88:91], v[116:119]
    s_waitcnt lgkmcnt(8)
    v_mfma_f32_16x16x32_bf16 v[120:123], v[140:143], v[88:91], v[120:123]
    s_waitcnt lgkmcnt(7)
    v_mfma_f32_16x16x32_bf16 v[124:127], v[144:147], v[88:91], v[124:127]
    s_waitcnt lgkmcnt(6)
    v_mfma_f32_16x16x32_bf16 v[128:131], v[148:151], v[88:91], v[128:131]
    s_waitcnt lgkmcnt(5)
    v_mfma_f32_16x16x32_bf16 v[132:135], v[152:155], v[88:91], v[132:135]
    ds_read_b128 v[136:139], v114 offset:51200
    ds_read_b128 v[140:143], v114 offset:52224
    ds_read_b128 v[144:147], v114 offset:53248
    ds_read_b128 v[148:151], v114 offset:54272
    ds_read_b128 v[152:155], v114 offset:55296
    s_waitcnt vmcnt(8)
    s_waitcnt lgkmcnt(9)
    v_mfma_f32_16x16x32_bf16 v[116:119], v[156:159], v[92:95], v[116:119]
    s_waitcnt lgkmcnt(8)
    v_mfma_f32_16x16x32_bf16 v[120:123], v[160:163], v[92:95], v[120:123]
    s_waitcnt lgkmcnt(7)
    v_mfma_f32_16x16x32_bf16 v[124:127], v[164:167], v[92:95], v[124:127]
    s_waitcnt lgkmcnt(6)
    v_mfma_f32_16x16x32_bf16 v[128:131], v[168:171], v[92:95], v[128:131]
    s_waitcnt lgkmcnt(5)
    v_mfma_f32_16x16x32_bf16 v[132:135], v[172:175], v[92:95], v[132:135]
    ds_read_b128 v[156:159], v114 offset:56320
    ds_read_b128 v[160:163], v114 offset:57344
    ds_read_b128 v[164:167], v114 offset:58368
    ds_read_b128 v[168:171], v114 offset:59392
    ds_read_b128 v[172:175], v114 offset:60416
    s_waitcnt vmcnt(7)
    s_waitcnt lgkmcnt(9)
    v_mfma_f32_16x16x32_bf16 v[116:119], v[136:139], v[96:99], v[116:119]
    s_waitcnt lgkmcnt(8)
    v_mfma_f32_16x16x32_bf16 v[120:123], v[140:143], v[96:99], v[120:123]
    s_waitcnt lgkmcnt(7)
    v_mfma_f32_16x16x32_bf16 v[124:127], v[144:147], v[96:99], v[124:127]
    s_waitcnt lgkmcnt(6)
    v_mfma_f32_16x16x32_bf16 v[128:131], v[148:151], v[96:99], v[128:131]
    s_waitcnt lgkmcnt(5)
    v_mfma_f32_16x16x32_bf16 v[132:135], v[152:155], v[96:99], v[132:135]
    s_waitcnt vmcnt(6)
    s_waitcnt lgkmcnt(4)
    v_mfma_f32_16x16x32_bf16 v[116:119], v[156:159], v[100:103], v[116:119]
    s_waitcnt lgkmcnt(3)
    v_mfma_f32_16x16x32_bf16 v[120:123], v[160:163], v[100:103], v[120:123]
    s_waitcnt lgkmcnt(2)
    v_mfma_f32_16x16x32_bf16 v[124:127], v[164:167], v[100:103], v[124:127]
    s_waitcnt lgkmcnt(1)
    v_mfma_f32_16x16x32_bf16 v[128:131], v[168:171], v[100:103], v[128:131]
    s_waitcnt lgkmcnt(0)
    v_mfma_f32_16x16x32_bf16 v[132:135], v[172:175], v[100:103], v[132:135]
    s_lshl_b32 s40, s34, 4
    v_add_u32 v4, s40, v3
    v_mul_u32_u24 v4, 160, v4
    v_lshl_add_u32 v176, v2, 3, v4
    v_add_u32 v177, 122880, v176
    v_lshrrev_b32 v5, 2, v3
    v_lshl_add_u32 v4, v2, 2, v5
    v_lshlrev_b32 v4, 7, v4
    v_and_b32 v5, 3, v3
    v_lshl_add_u32 v4, v5, 3, v4
    s_lshl_b32 s40, s34, 5
    s_add_u32 s40, s40, 133120
    v_add_u32 v178, s40, v4
    s_mov_b32 s46, 0xbfb8aa3b
    s_mov_b32 s47, 0xbfb8aa3b
    v_pk_mul_f32 v[8:9], v[116:117], s[46:47]
    v_pk_mul_f32 v[10:11], v[118:119], s[46:47]
    v_pk_mul_f32 v[12:13], v[120:121], s[46:47]
    v_pk_mul_f32 v[14:15], v[122:123], s[46:47]
    v_pk_mul_f32 v[16:17], v[124:125], s[46:47]
    v_pk_mul_f32 v[18:19], v[126:127], s[46:47]
    v_pk_mul_f32 v[20:21], v[128:129], s[46:47]
    v_pk_mul_f32 v[22:23], v[130:131], s[46:47]
    v_pk_mul_f32 v[24:25], v[132:133], s[46:47]
    v_pk_mul_f32 v[26:27], v[134:135], s[46:47]
    s_waitcnt vmcnt(0)
    s_barrier
    ds_read_b64 v[136:137], v177 offset:0
    ds_read_b64 v[138:139], v177 offset:32
    ds_read_b64 v[140:141], v177 offset:64
    ds_read_b64 v[142:143], v177 offset:96
    ds_read_b64 v[144:145], v177 offset:128
    ds_read_b64_tr_b16 v[146:147], v178 offset:0
    ds_read_b64_tr_b16 v[148:149], v178 offset:2048
    ds_read_b64_tr_b16 v[150:151], v178 offset:4096
    ds_read_b64_tr_b16 v[152:153], v178 offset:6144
    ds_read_b64_tr_b16 v[154:155], v178 offset:8192
    v_exp_f32 v8, v8
    v_exp_f32 v9, v9
    v_exp_f32 v10, v10
    v_exp_f32 v11, v11
    v_exp_f32 v12, v12
    v_exp_f32 v13, v13
    v_exp_f32 v14, v14
    v_exp_f32 v15, v15
    v_exp_f32 v16, v16
    v_exp_f32 v17, v17
    v_exp_f32 v18, v18
    v_exp_f32 v19, v19
    v_exp_f32 v20, v20
    v_exp_f32 v21, v21
    v_exp_f32 v22, v22
    v_exp_f32 v23, v23
    v_exp_f32 v24, v24
    v_exp_f32 v25, v25
    v_exp_f32 v26, v26
    v_exp_f32 v27, v27
    v_pk_add_f32 v[8:9], v[8:9], 1.0 op_sel_hi:[1,0]
    v_pk_add_f32 v[10:11], v[10:11], 1.0 op_sel_hi:[1,0]
    v_pk_add_f32 v[12:13], v[12:13], 1.0 op_sel_hi:[1,0]
    v_pk_add_f32 v[14:15], v[14:15], 1.0 op_sel_hi:[1,0]
    v_pk_add_f32 v[16:17], v[16:17], 1.0 op_sel_hi:[1,0]
    v_pk_add_f32 v[18:19], v[18:19], 1.0 op_sel_hi:[1,0]
    v_pk_add_f32 v[20:21], v[20:21], 1.0 op_sel_hi:[1,0]
    v_pk_add_f32 v[22:23], v[22:23], 1.0 op_sel_hi:[1,0]
    v_pk_add_f32 v[24:25], v[24:25], 1.0 op_sel_hi:[1,0]
    v_pk_add_f32 v[26:27], v[26:27], 1.0 op_sel_hi:[1,0]
    v_rcp_f32 v8, v8
    v_rcp_f32 v9, v9
    v_rcp_f32 v10, v10
    v_rcp_f32 v11, v11
    v_rcp_f32 v12, v12
    v_rcp_f32 v13, v13
    v_rcp_f32 v14, v14
    v_rcp_f32 v15, v15
    v_rcp_f32 v16, v16
    v_rcp_f32 v17, v17
    v_rcp_f32 v18, v18
    v_rcp_f32 v19, v19
    v_rcp_f32 v20, v20
    v_rcp_f32 v21, v21
    v_rcp_f32 v22, v22
    v_rcp_f32 v23, v23
    v_rcp_f32 v24, v24
    v_rcp_f32 v25, v25
    v_rcp_f32 v26, v26
    v_rcp_f32 v27, v27
    v_pk_mul_f32 v[8:9], v[8:9], v[116:117]
    v_pk_mul_f32 v[10:11], v[10:11], v[118:119]
    v_pk_mul_f32 v[12:13], v[12:13], v[120:121]
    v_pk_mul_f32 v[14:15], v[14:15], v[122:123]
    v_pk_mul_f32 v[16:17], v[16:17], v[124:125]
    v_pk_mul_f32 v[18:19], v[18:19], v[126:127]
    v_pk_mul_f32 v[20:21], v[20:21], v[128:129]
    v_pk_mul_f32 v[22:23], v[22:23], v[130:131]
    v_pk_mul_f32 v[24:25], v[24:25], v[132:133]
    v_pk_mul_f32 v[26:27], v[26:27], v[134:135]
    s_waitcnt lgkmcnt(0)
    v_lshlrev_b32 v28, 16, v136
    v_and_b32 v29, 0xffff0000, v136
    v_lshlrev_b32 v48, 16, v146
    v_and_b32 v49, 0xffff0000, v146
    v_lshlrev_b32 v30, 16, v137
    v_and_b32 v31, 0xffff0000, v137
    v_lshlrev_b32 v50, 16, v147
    v_and_b32 v51, 0xffff0000, v147
    v_lshlrev_b32 v32, 16, v138
    v_and_b32 v33, 0xffff0000, v138
    v_lshlrev_b32 v52, 16, v148
    v_and_b32 v53, 0xffff0000, v148
    v_lshlrev_b32 v34, 16, v139
    v_and_b32 v35, 0xffff0000, v139
    v_lshlrev_b32 v54, 16, v149
    v_and_b32 v55, 0xffff0000, v149
    v_lshlrev_b32 v36, 16, v140
    v_and_b32 v37, 0xffff0000, v140
    v_lshlrev_b32 v56, 16, v150
    v_and_b32 v57, 0xffff0000, v150
    v_lshlrev_b32 v38, 16, v141
    v_and_b32 v39, 0xffff0000, v141
    v_lshlrev_b32 v58, 16, v151
    v_and_b32 v59, 0xffff0000, v151
    v_lshlrev_b32 v40, 16, v142
    v_and_b32 v41, 0xffff0000, v142
    v_lshlrev_b32 v60, 16, v152
    v_and_b32 v61, 0xffff0000, v152
    v_lshlrev_b32 v42, 16, v143
    v_and_b32 v43, 0xffff0000, v143
    v_lshlrev_b32 v62, 16, v153
    v_and_b32 v63, 0xffff0000, v153
    v_lshlrev_b32 v44, 16, v144
    v_and_b32 v45, 0xffff0000, v144
    v_lshlrev_b32 v64, 16, v154
    v_and_b32 v65, 0xffff0000, v154
    v_lshlrev_b32 v46, 16, v145
    v_and_b32 v47, 0xffff0000, v145
    v_lshlrev_b32 v66, 16, v155
    v_and_b32 v67, 0xffff0000, v155
    v_mov_b32 v180, v111
    v_pk_add_f32 v[68:69], v[28:29], v[110:111] op_sel_hi:[1,0] neg_lo:[0,1] neg_hi:[0,1]
    v_pk_add_f32 v[70:71], v[30:31], v[110:111] op_sel_hi:[1,0] neg_lo:[0,1] neg_hi:[0,1]
    v_pk_add_f32 v[72:73], v[32:33], v[110:111] op_sel_hi:[1,0] neg_lo:[0,1] neg_hi:[0,1]
    v_pk_add_f32 v[74:75], v[34:35], v[110:111] op_sel_hi:[1,0] neg_lo:[0,1] neg_hi:[0,1]
    v_pk_add_f32 v[76:77], v[36:37], v[110:111] op_sel_hi:[1,0] neg_lo:[0,1] neg_hi:[0,1]
    v_pk_add_f32 v[78:79], v[38:39], v[110:111] op_sel_hi:[1,0] neg_lo:[0,1] neg_hi:[0,1]
    v_pk_add_f32 v[80:81], v[40:41], v[110:111] op_sel_hi:[1,0] neg_lo:[0,1] neg_hi:[0,1]
    v_pk_add_f32 v[82:83], v[42:43], v[110:111] op_sel_hi:[1,0] neg_lo:[0,1] neg_hi:[0,1]
    v_pk_add_f32 v[84:85], v[44:45], v[110:111] op_sel_hi:[1,0] neg_lo:[0,1] neg_hi:[0,1]
    v_pk_add_f32 v[86:87], v[46:47], v[110:111] op_sel_hi:[1,0] neg_lo:[0,1] neg_hi:[0,1]
    v_pk_mul_f32 v[68:69], v[68:69], v[180:181] op_sel_hi:[1,0]
    v_pk_mul_f32 v[70:71], v[70:71], v[180:181] op_sel_hi:[1,0]
    v_pk_mul_f32 v[72:73], v[72:73], v[180:181] op_sel_hi:[1,0]
    v_pk_mul_f32 v[74:75], v[74:75], v[180:181] op_sel_hi:[1,0]
    v_pk_mul_f32 v[76:77], v[76:77], v[180:181] op_sel_hi:[1,0]
    v_pk_mul_f32 v[78:79], v[78:79], v[180:181] op_sel_hi:[1,0]
    v_pk_mul_f32 v[80:81], v[80:81], v[180:181] op_sel_hi:[1,0]
    v_pk_mul_f32 v[82:83], v[82:83], v[180:181] op_sel_hi:[1,0]
    v_pk_mul_f32 v[84:85], v[84:85], v[180:181] op_sel_hi:[1,0]
    v_pk_mul_f32 v[86:87], v[86:87], v[180:181] op_sel_hi:[1,0]
    v_pk_mul_f32 v[68:69], v[68:69], v[48:49]
    v_pk_mul_f32 v[70:71], v[70:71], v[50:51]
    v_pk_mul_f32 v[72:73], v[72:73], v[52:53]
    v_pk_mul_f32 v[74:75], v[74:75], v[54:55]
    v_pk_mul_f32 v[76:77], v[76:77], v[56:57]
    v_pk_mul_f32 v[78:79], v[78:79], v[58:59]
    v_pk_mul_f32 v[80:81], v[80:81], v[60:61]
    v_pk_mul_f32 v[82:83], v[82:83], v[62:63]
    v_pk_mul_f32 v[84:85], v[84:85], v[64:65]
    v_pk_mul_f32 v[86:87], v[86:87], v[66:67]
    v_pk_fma_f32 v[68:69], v[68:69], v[8:9], v[28:29]
    v_pk_fma_f32 v[70:71], v[70:71], v[10:11], v[30:31]
    v_pk_fma_f32 v[72:73], v[72:73], v[12:13], v[32:33]
    v_pk_fma_f32 v[74:75], v[74:75], v[14:15], v[34:35]
    v_pk_fma_f32 v[76:77], v[76:77], v[16:17], v[36:37]
    v_pk_fma_f32 v[78:79], v[78:79], v[18:19], v[38:39]
    v_pk_fma_f32 v[80:81], v[80:81], v[20:21], v[40:41]
    v_pk_fma_f32 v[82:83], v[82:83], v[22:23], v[42:43]
    v_pk_fma_f32 v[84:85], v[84:85], v[24:25], v[44:45]
    v_pk_fma_f32 v[86:87], v[86:87], v[26:27], v[46:47]
    v_cvt_pk_bf16_f32 v136, v68, v69
    v_cvt_pk_bf16_f32 v137, v70, v71
    v_cvt_pk_bf16_f32 v138, v72, v73
    v_cvt_pk_bf16_f32 v139, v74, v75
    v_cvt_pk_bf16_f32 v140, v76, v77
    v_cvt_pk_bf16_f32 v141, v78, v79
    v_cvt_pk_bf16_f32 v142, v80, v81
    v_cvt_pk_bf16_f32 v143, v82, v83
    v_cvt_pk_bf16_f32 v144, v84, v85
    v_cvt_pk_bf16_f32 v145, v86, v87
    v_add_u32 v182, 143360, v176
    ds_write_b64 v182, v[136:137] offset:0
    ds_write_b64 v182, v[138:139] offset:32
    ds_write_b64 v182, v[140:141] offset:64
    ds_write_b64 v182, v[142:143] offset:96
    ds_write_b64 v182, v[144:145] offset:128
    s_mul_i32 s40, s34, 2560
    s_add_u32 s40, s40, 143360
    v_add_u32 v4, s40, v7
    s_waitcnt lgkmcnt(0)
    ds_read_b128 v[8:11], v4 offset:0
    ds_read_b128 v[12:15], v4 offset:1024
    ds_read_b128 v[16:19], v4 offset:2048
    s_mul_i32 s40, s34, 20480
    s_add_u32 s40, s40, s45
    s_waitcnt lgkmcnt(0)
    buffer_store_dwordx4 v[8:11], v104, s[16:19], s40 offen
    buffer_store_dwordx4 v[12:15], v105, s[16:19], s40 offen
    s_mov_b32 exec_hi, 0
    buffer_store_dwordx4 v[16:19], v106, s[16:19], s40 offen
    s_mov_b64 exec, -1
    s_endpgm
recurrent_scan__ssm_conv_h3__mixer_gmlp__prompt_kernel_conv:
    s_load_dwordx2 s[4:5], s[0:1], 32
    s_load_dwordx2 s[8:9], s[0:1], 104
    s_load_dwordx2 s[12:13], s[0:1], 40
    s_load_dwordx2 s[16:17], s[0:1], 64
    s_load_dwordx2 s[20:21], s[0:1], 80
    v_subrev_u32 v0, 256, v0
    v_lshrrev_b32 v3, 6, v0
    v_and_b32 v1, 63, v0
    v_readfirstlane_b32 s34, v3
    s_mov_b32 s6, 2621440
    s_mov_b32 s7, 0x20000
    s_mov_b32 s10, 15990784
    s_mov_b32 s11, 0x20000
    s_mov_b32 s14, 1280
    s_mov_b32 s15, 0x20000
    s_mov_b32 s18, 8388608
    s_mov_b32 s19, 0x20000
    s_mov_b32 s22, 983040
    s_mov_b32 s23, 0x20000
    s_mov_b32 s32, s2
    v_lshlrev_b32 v2, 4, v0
    v_subrev_u32 v47, 16, v2
    s_mov_b32 s56, s2
    s_add_u32 s57, s2, 256
    s_lshr_b32 s58, s2, 1
    s_add_u32 s58, s58, 512
    s_waitcnt lgkmcnt(0)
    s_lshl_b32 s40, s56, 12
    buffer_load_dwordx4 v[12:15], v2, s[4:7], s40 offen
    buffer_load_dwordx4 v[8:11], v47, s[4:7], s40 offen
    s_lshl_b32 s41, s56, 1
    v_mov_b32 v3, 0
    buffer_load_ushort v44, v3, s[12:15], s41 offen
    s_lshr_b32 s47, s2, 3
    s_lshl_b32 s47, s47, 2
    s_add_u32 s47, s47, s34
    s_mul_i32 s40, s47, 12
    v_add_u32 v3, s40, v1
    v_mul_u32_u24 v4, 43691, v3
    v_lshrrev_b32 v4, 22, v4
    v_mul_u32_u24 v5, 96, v4
    v_sub_u32 v3, v3, v5
    v_mul_u32_u24 v4, 98304, v4
    v_lshl_add_u32 v57, v3, 7, v4
    s_and_b32 s40, s2, 7
    s_lshr_b32 s52, s40, 1
    s_lshl_b32 s52, s52, 21
    s_and_b32 s53, s40, 1
    s_mul_i32 s53, s53, 1572864
    s_add_u32 s53, s53, 0
    s_lshl_b32 s40, s47, 4
    v_add_u32 v3, s40, v1
    v_lshrrev_b32 v4, 2, v3
    v_lshlrev_b32 v4, 12, v4
    v_and_b32 v3, 3, v3
    v_lshl_add_u32 v56, v3, 10, v4
    s_cmp_ge_u32 s2, 192
    s_cbranch_scc1 c_wj_28
    s_mul_i32 s40, s2, 2731
    s_lshr_b32 s40, s40, 16
    s_mul_i32 s41, s40, 24
    s_sub_u32 s41, s2, s41
    s_mul_i32 s41, s41, 40960
    s_mul_i32 s40, s40, 160
    s_add_u32 s54, s40, s41
    v_mov_b32 v3, v0
    v_mul_u32_u24 v4, 6554, v3
    v_lshrrev_b32 v4, 16, v4
    v_mul_u32_u24 v5, 10, v4
    v_sub_u32 v3, v3, v5
    v_lshlrev_b32 v3, 4, v3
    v_mul_u32_u24 v4, 1280, v4
    v_add_u32 v3, v3, v4
    s_lshl_b32 s40, s34, 10
    s_add_u32 m0, s40, 156672
    s_nop 0
    buffer_load_dwordx4 v3, s[20:23], s54 offen lds
    s_cmp_lg_u32 s34, 0
    s_cbranch_scc1 c_wj2_29
    v_add_u32 v3, 256, v1
    v_mul_u32_u24 v4, 6554, v3
    v_lshrrev_b32 v4, 16, v4
    v_mul_u32_u24 v5, 10, v4
    v_sub_u32 v3, v3, v5
    v_lshlrev_b32 v3, 4, v3
    v_mul_u32_u24 v4, 1280, v4
    v_add_u32 v3, v3, v4
    s_mov_b32 m0, 160768
    s_nop 0
    buffer_load_dwordx4 v3, s[20:23], s54 offen lds
c_wj2_29:
c_wj_28:
    s_lshl_b32 s40, s57, 12
    buffer_load_dwordx4 v[20:23], v2, s[4:7], s40 offen
    buffer_load_dwordx4 v[16:19], v47, s[4:7], s40 offen
    s_lshl_b32 s41, s57, 1
    v_mov_b32 v3, 0
    buffer_load_ushort v45, v3, s[12:15], s41 offen
    s_lshl_b32 s40, s58, 12
    buffer_load_dwordx4 v[28:31], v2, s[4:7], s40 offen
    buffer_load_dwordx4 v[24:27], v47, s[4:7], s40 offen
    s_lshl_b32 s41, s58, 1
    v_mov_b32 v3, 0
    buffer_load_ushort v46, v3, s[12:15], s41 offen
    v_mov_b32 v60, 0
    v_mov_b32 v61, 0
    v_mov_b32 v62, 0
    v_mov_b32 v63, 0
    v_mul_u32_u24 v3, 4160, v0
    v_add_u32 v3, 86016, v3
    v_cmp_gt_u32 vcc, 64, v0
    s_nop 0
    s_and_saveexec_b64 s[50:51], vcc
    s_cbranch_execz c_z_30
    v_subrev_u32 v4, -118784, v2
    v_cmp_gt_u32 vcc, 8, v0
    s_nop 1
    v_cndmask_b32 v4, v4, v3, vcc
    v_add_u32 v5, -8, v0
    v_cmp_lt_u32 vcc, 23, v5
    s_nop 0
    s_and_b64 exec, exec, vcc
    ds_write_b128 v4, v[60:63]
c_z_30:
    s_mov_b64 exec, s[50:51]
    v_add_u32 v64, 86032, v2
    v_add_u32 v65, 119808, v2
    v_and_b32 v3, 7, v1
    v_mul_u32_u24 v3, 4160, v3
    v_bfe_u32 v4, v1, 3, 1
    v_lshrrev_b32 v5, 4, v1
    v_sub_u32 v4, v4, v5
    v_add_u32 v4, 3, v4
    v_lshl_add_u32 v66, v4, 4, v3
    v_add_u32 v66, 86016, v66
    v_and_b32 v3, 15, v1
    v_lshl_add_u32 v3, v3, 1, v5
    v_lshlrev_b32 v67, 4, v3
    v_add_u32 v67, 119296, v67
    v_and_b32 v3, 15, v1
    v_lshlrev_b32 v4, 3, v5
    v_sub_u32 v4, v4, v3
    v_add_u32 v4, -9, v4
    v_mov_b32 v72, 0xffff
    v_mov_b32 v73, 0xffff0000
    v_cmp_eq_u32 vcc, 0, v4
    s_nop 1
    v_cndmask_b32 v68, 0, v72, vcc
    v_cmp_eq_u32 vcc, 1, v4
    s_nop 1
    v_cndmask_b32 v68, v68, v73, vcc
    v_cmp_eq_u32 vcc, 2, v4
    s_nop 1
    v_cndmask_b32 v69, 0, v72, vcc
    v_cmp_eq_u32 vcc, 3, v4
    s_nop 1
    v_cndmask_b32 v69, v69, v73, vcc
    v_cmp_eq_u32 vcc, 4, v4
    s_nop 1
    v_cndmask_b32 v70, 0, v72, vcc
    v_cmp_eq_u32 vcc, 5, v4
    s_nop 1
    v_cndmask_b32 v70, v70, v73, vcc
    v_cmp_eq_u32 vcc, 6, v4
    s_nop 1
    v_cndmask_b32 v71, 0, v72, vcc
    v_cmp_eq_u32 vcc, 7, v4
    s_nop 1
    v_cndmask_b32 v71, v71, v73, vcc
    v_and_b32 v3, 15, v1
    v_lshlrev_b32 v3, 6, v3
    v_lshl_add_u32 v3, v5, 4, v3
    s_lshl_b32 s40, s34, 13
    s_add_u32 s40, s40, 123904
    v_add_u32 v74, s40, v3
    v_lshlrev_b32 v75, 5, v0
    v_add_u32 v75, 123904, v75
    s_waitcnt vmcnt(6)
    v_cmp_ne_u32 vcc, 0, v0
    s_nop 1
    v_cndmask_b32 v8, 0, v8, vcc
    v_cndmask_b32 v9, 0, v9, vcc
    v_cndmask_b32 v10, 0, v10, vcc
    v_cndmask_b32 v11, 0, v11, vcc
    v_alignbit_b32 v184, v9, v8, 16
    v_alignbit_b32 v185, v10, v9, 16
    v_alignbit_b32 v186, v11, v10, 16
    v_alignbit_b32 v187, v12, v11, 16
    v_alignbit_b32 v188, v13, v12, 16
    v_alignbit_b32 v189, v14, v13, 16
    v_alignbit_b32 v190, v15, v14, 16
    ds_write_b128 v64, v[184:187] offset:0
    v_mov_b32 v192, v9
    v_mov_b32 v193, v10
    v_mov_b32 v194, v11
    v_mov_b32 v195, v12
    ds_write_b128 v64, v[192:195] offset:4160
    s_nop 1
    v_mov_b32 v192, v185
    v_mov_b32 v193, v186
    v_mov_b32 v194, v187
    v_mov_b32 v195, v188
    ds_write_b128 v64, v[192:195] offset:8320
    s_nop 1
    ds_write_b128 v64, v[10:13] offset:12480
    ds_write_b128 v64, v[186:189] offset:16640
    v_mov_b32 v192, v11
    v_mov_b32 v193, v12
    v_mov_b32 v194, v13
    v_mov_b32 v195, v14
    ds_write_b128 v64, v[192:195] offset:20800
    s_nop 1
    v_mov_b32 v192, v187
    v_mov_b32 v193, v188
    v_mov_b32 v194, v189
    v_mov_b32 v195, v190
    ds_write_b128 v64, v[192:195] offset:24960
    s_nop 1
    ds_write_b128 v64, v[12:15] offset:29120
    v_mbcnt_lo_u32_b32 v3, -1, 0
    v_mbcnt_hi_u32_b32 v3, -1, v3
    v_lshlrev_b32 v3, 4, v3
    s_mov_b32 s66, 14716928
    s_mov_b32 s67, 0
fpoll_31:
    buffer_load_dwordx4 v[48:51], v3, s[8:11], s66 offen sc1
    buffer_load_dwordx4 v[52:55], v3, s[8:11], s66 offen offset:1024 sc1
    s_add_u32 s67, s67, 1
    s_waitcnt vmcnt(0)
    v_cmp_ne_u32 vcc, s100, v48
    v_cmp_ne_u32 s[64:65], s101, v49
    s_nop 0
    s_or_b64 vcc, vcc, s[64:65]
    v_cmp_ne_u32 s[64:65], s100, v50
    s_nop 0
    s_or_b64 vcc, vcc, s[64:65]
    v_cmp_ne_u32 s[64:65], s101, v51
    s_nop 0
    s_or_b64 vcc, vcc, s[64:65]
    v_cmp_ne_u32 s[64:65], s100, v52
    s_nop 0
    s_or_b64 vcc, vcc, s[64:65]
    v_cmp_ne_u32 s[64:65], s101, v53
    s_nop 0
    s_or_b64 vcc, vcc, s[64:65]
    v_cmp_ne_u32 s[64:65], s100, v54
    s_nop 0
    s_or_b64 vcc, vcc, s[64:65]
    v_cmp_ne_u32 s[64:65], s101, v55
    s_nop 0
    s_or_b64 vcc, vcc, s[64:65]
    s_cmp_gt_u32 s67, 100000
    s_cbranch_scc1 fpoll_e_32
    s_cmp_eq_u64 vcc, 0
    s_cbranch_scc1 fpoll_e_32
    s_sleep 2
    s_branch fpoll_31
fpoll_e_32:
    s_lshl_b32 s40, s56, 12
    s_add_u32 s40, s40, 6291456
    buffer_load_dwordx4 v[32:35], v2, s[8:11], s40 offen sc1
    s_lshl_b32 s40, s57, 12
    s_add_u32 s40, s40, 6291456
    buffer_load_dwordx4 v[36:39], v2, s[8:11], s40 offen sc1
    s_lshl_b32 s40, s58, 12
    s_add_u32 s40, s40, 6291456
    buffer_load_dwordx4 v[40:43], v2, s[8:11], s40 offen sc1
    s_waitcnt vmcnt(2)
    ds_write_b128 v65, v[32:35]
    v_lshlrev_b32 v3, 16, v44
    v_or_b32 v3, v3, v44
    v_and_b32 v196, v68, v3
    v_and_b32 v197, v69, v3
    v_and_b32 v198, v70, v3
    v_and_b32 v199, v71, v3
    s_waitcnt lgkmcnt(0)
    v_mov_b32 v3, 161796
    v_mov_b32 v4, 1
    s_mov_b64 exec, 1
    ds_add_u32 v3, v4
    s_mov_b64 exec, -1
    s_mov_b32 s67, 0
gsync_33:
    ds_read_b32 v4, v3
    s_add_u32 s67, s67, 1
    s_waitcnt lgkmcnt(0)
    v_readfirstlane_b32 s66, v4
    s_cmp_gt_u32 s67, 1000000
    s_cbranch_scc1 gsync_e_34
    s_cmp_lt_u32 s66, 4
    s_cbranch_scc1 gsync_33
gsync_e_34:
    s_cmp_lg_u32 s34, 0
    s_cbranch_scc1 c_pw_36
    ds_read_b128 v[108:111], v66 offset:0
    ds_read_b128 v[120:123], v67 offset:480
    ds_read_b128 v[124:127], v67 offset:992
    ds_read_b128 v[128:131], v67 offset:1504
    ds_read_b128 v[132:135], v67 offset:2016
    ds_read_b128 v[136:139], v67 offset:2528
    ds_read_b128 v[140:143], v67 offset:3040
    ds_read_b128 v[144:147], v67 offset:3552
    ds_read_b128 v[148:151], v67 offset:4064
    ds_read_b128 v[112:115], v66 offset:512
    ds_read_b128 v[116:119], v66 offset:1024
    s_waitcnt lgkmcnt(2)
    v_mfma_f32_16x16x32_bf16 v[104:107], v[108:111], v[148:151], 0
    v_mfma_f32_16x16x32_bf16 v[100:103], v[108:111], v[144:147], 0
    v_mfma_f32_16x16x32_bf16 v[96:99], v[108:111], v[140:143], 0
    v_mfma_f32_16x16x32_bf16 v[92:95], v[108:111], v[136:139], 0
    v_mfma_f32_16x16x32_bf16 v[88:91], v[108:111], v[132:135], 0
    v_mfma_f32_16x16x32_bf16 v[84:87], v[108:111], v[128:131], 0
    v_mfma_f32_16x16x32_bf16 v[80:83], v[108:111], v[124:127], 0
    v_mfma_f32_16x16x32_bf16 v[76:79], v[108:111], v[120:123], 0
    v_mfma_f32_16x16x32_bf16 v[76:79], v[196:199], v[120:123], v[76:79]
    v_mfma_f32_16x16x32_bf16 v[80:83], v[196:199], v[124:127], v[80:83]
    v_mfma_f32_16x16x32_bf16 v[84:87], v[196:199], v[128:131], v[84:87]
    v_mfma_f32_16x16x32_bf16 v[88:91], v[196:199], v[132:135], v[88:91]
    v_mfma_f32_16x16x32_bf16 v[92:95], v[196:199], v[136:139], v[92:95]
    v_mfma_f32_16x16x32_bf16 v[96:99], v[196:199], v[140:143], v[96:99]
    v_mfma_f32_16x16x32_bf16 v[100:103], v[196:199], v[144:147], v[100:103]
    v_mfma_f32_16x16x32_bf16 v[104:107], v[196:199], v[148:151], v[104:107]
    ds_read_b128 v[108:111], v66 offset:1536
    s_waitcnt lgkmcnt(2)
    v_mfma_f32_16x16x32_bf16 v[104:107], v[112:115], v[144:147], v[104:107]
    v_mfma_f32_16x16x32_bf16 v[100:103], v[112:115], v[140:143], v[100:103]
    v_mfma_f32_16x16x32_bf16 v[96:99], v[112:115], v[136:139], v[96:99]
    v_mfma_f32_16x16x32_bf16 v[92:95], v[112:115], v[132:135], v[92:95]
    v_mfma_f32_16x16x32_bf16 v[88:91], v[112:115], v[128:131], v[88:91]
    v_mfma_f32_16x16x32_bf16 v[84:87], v[112:115], v[124:127], v[84:87]
    v_mfma_f32_16x16x32_bf16 v[80:83], v[112:115], v[120:123], v[80:83]
    ds_read_b128 v[112:115], v66 offset:2048
    ds_read_b128 v[152:155], v67 offset:416
    ds_read_b128 v[156:159], v67 offset:928
    ds_read_b128 v[160:163], v67 offset:1440
    ds_read_b128 v[164:167], v67 offset:1952
    ds_read_b128 v[168:171], v67 offset:2464
    ds_read_b128 v[172:175], v67 offset:2976
    ds_read_b128 v[176:179], v67 offset:3488
    ds_read_b128 v[180:183], v67 offset:4000
    s_waitcnt lgkmcnt(10)
    v_mfma_f32_16x16x32_bf16 v[104:107], v[116:119], v[140:143], v[104:107]
    v_mfma_f32_16x16x32_bf16 v[100:103], v[116:119], v[136:139], v[100:103]
    v_mfma_f32_16x16x32_bf16 v[96:99], v[116:119], v[132:135], v[96:99]
    v_mfma_f32_16x16x32_bf16 v[92:95], v[116:119], v[128:131], v[92:95]
    v_mfma_f32_16x16x32_bf16 v[88:91], v[116:119], v[124:127], v[88:91]
    v_mfma_f32_16x16x32_bf16 v[84:87], v[116:119], v[120:123], v[84:87]
    ds_read_b128 v[116:119], v66 offset:2560
    s_waitcnt lgkmcnt(10)
    v_mfma_f32_16x16x32_bf16 v[104:107], v[108:111], v[136:139], v[104:107]
    v_mfma_f32_16x16x32_bf16 v[100:103], v[108:111], v[132:135], v[100:103]
    v_mfma_f32_16x16x32_bf16 v[96:99], v[108:111], v[128:131], v[96:99]
    v_mfma_f32_16x16x32_bf16 v[92:95], v[108:111], v[124:127], v[92:95]
    v_mfma_f32_16x16x32_bf16 v[88:91], v[108:111], v[120:123], v[88:91]
    ds_read_b128 v[108:111], v66 offset:3072
    s_waitcnt lgkmcnt(10)
    v_mfma_f32_16x16x32_bf16 v[104:107], v[112:115], v[132:135], v[104:107]
    v_mfma_f32_16x16x32_bf16 v[100:103], v[112:115], v[128:131], v[100:103]
    v_mfma_f32_16x16x32_bf16 v[96:99], v[112:115], v[124:127], v[96:99]
    v_mfma_f32_16x16x32_bf16 v[92:95], v[112:115], v[120:123], v[92:95]
    ds_read_b128 v[112:115], v66 offset:3584
    s_waitcnt lgkmcnt(2)
    v_mfma_f32_16x16x32_bf16 v[104:107], v[116:119], v[128:131], v[104:107]
    v_mfma_f32_16x16x32_bf16 v[100:103], v[116:119], v[124:127], v[100:103]
    v_mfma_f32_16x16x32_bf16 v[96:99], v[116:119], v[120:123], v[96:99]
    ds_read_b128 v[116:119], v66 offset:64
    s_waitcnt lgkmcnt(2)
    v_mfma_f32_16x16x32_bf16 v[104:107], v[108:111], v[124:127], v[104:107]
    v_mfma_f32_16x16x32_bf16 v[100:103], v[108:111], v[120:123], v[100:103]
    ds_read_b128 v[108:111], v66 offset:576
    s_waitcnt lgkmcnt(2)
    v_mfma_f32_16x16x32_bf16 v[104:107], v[112:115], v[120:123], v[104:107]
    ds_read_b128 v[112:115], v66 offset:1088
    s_waitcnt lgkmcnt(2)
    v_mfma_f32_16x16x32_bf16 v[104:107], v[116:119], v[180:183], v[104:107]
    v_mfma_f32_16x16x32_bf16 v[100:103], v[116:119], v[176:179], v[100:103]
    v_mfma_f32_16x16x32_bf16 v[96:99], v[116:119], v[172:175], v[96:99]
    v_mfma_f32_16x16x32_bf16 v[92:95], v[116:119], v[168:171], v[92:95]
    v_mfma_f32_16x16x32_bf16 v[88:91], v[116:119], v[164:167], v[88:91]
    v_mfma_f32_16x16x32_bf16 v[84:87], v[116:119], v[160:163], v[84:87]
    v_mfma_f32_16x16x32_bf16 v[80:83], v[116:119], v[156:159], v[80:83]
    v_mfma_f32_16x16x32_bf16 v[76:79], v[116:119], v[152:155], v[76:79]
    ds_read_b128 v[116:119], v66 offset:1600
    s_waitcnt lgkmcnt(2)
    v_mfma_f32_16x16x32_bf16 v[104:107], v[108:111], v[176:179], v[104:107]
    v_mfma_f32_16x16x32_bf16 v[100:103], v[108:111], v[172:175], v[100:103]
    v_mfma_f32_16x16x32_bf16 v[96:99], v[108:111], v[168:171], v[96:99]
    v_mfma_f32_16x16x32_bf16 v[92:95], v[108:111], v[164:167], v[92:95]
    v_mfma_f32_16x16x32_bf16 v[88:91], v[108:111], v[160:163], v[88:91]
    v_mfma_f32_16x16x32_bf16 v[84:87], v[108:111], v[156:159], v[84:87]
    v_mfma_f32_16x16x32_bf16 v[80:83], v[108:111], v[152:155], v[80:83]
    ds_read_b128 v[108:111], v66 offset:2112
    s_waitcnt lgkmcnt(2)
    v_mfma_f32_16x16x32_bf16 v[104:107], v[112:115], v[172:175], v[104:107]
    v_mfma_f32_16x16x32_bf16 v[100:103], v[112:115], v[168:171], v[100:103]
    v_mfma_f32_16x16x32_bf16 v[96:99], v[112:115], v[164:167], v[96:99]
    v_mfma_f32_16x16x32_bf16 v[92:95], v[112:115], v[160:163], v[92:95]
    v_mfma_f32_16x16x32_bf16 v[88:91], v[112:115], v[156:159], v[88:91]
    v_mfma_f32_16x16x32_bf16 v[84:87], v[112:115], v[152:155], v[84:87]
    ds_read_b128 v[112:115], v66 offset:2624
    s_waitcnt lgkmcnt(2)
    v_mfma_f32_16x16x32_bf16 v[104:107], v[116:119], v[168:171], v[104:107]
    v_mfma_f32_16x16x32_bf16 v[100:103], v[116:119], v[164:167], v[100:103]
    v_mfma_f32_16x16x32_bf16 v[96:99], v[116:119], v[160:163], v[96:99]
    v_mfma_f32_16x16x32_bf16 v[92:95], v[116:119], v[156:159], v[92:95]
    v_mfma_f32_16x16x32_bf16 v[88:91], v[116:119], v[152:155], v[88:91]
    ds_read_b128 v[116:119], v66 offset:3136
    s_waitcnt lgkmcnt(2)
    v_mfma_f32_16x16x32_bf16 v[104:107], v[108:111], v[164:167], v[104:107]
    v_mfma_f32_16x16x32_bf16 v[100:103], v[108:111], v[160:163], v[100:103]
    v_mfma_f32_16x16x32_bf16 v[96:99], v[108:111], v[156:159], v[96:99]
    v_mfma_f32_16x16x32_bf16 v[92:95], v[108:111], v[152:155], v[92:95]
    ds_read_b128 v[108:111], v66 offset:3648
    s_waitcnt lgkmcnt(2)
    v_mfma_f32_16x16x32_bf16 v[104:107], v[112:115], v[160:163], v[104:107]
    v_mfma_f32_16x16x32_bf16 v[100:103], v[112:115], v[156:159], v[100:103]
    v_mfma_f32_16x16x32_bf16 v[96:99], v[112:115], v[152:155], v[96:99]
    s_waitcnt lgkmcnt(1)
    v_mfma_f32_16x16x32_bf16 v[104:107], v[116:119], v[156:159], v[104:107]
    v_mfma_f32_16x16x32_bf16 v[100:103], v[116:119], v[152:155], v[100:103]
    s_waitcnt lgkmcnt(0)
    v_mfma_f32_16x16x32_bf16 v[104:107], v[108:111], v[152:155], v[104:107]
    ds_write_b128 v74, v[76:79] offset:0
    ds_write_b128 v74, v[80:83] offset:1024
    ds_write_b128 v74, v[84:87] offset:2048
    ds_write_b128 v74, v[88:91] offset:3072
    ds_write_b128 v74, v[92:95] offset:4096
    ds_write_b128 v74, v[96:99] offset:5120
    ds_write_b128 v74, v[100:103] offset:6144
    s_nop 0
    ds_write_b128 v74, v[104:107] offset:7168
    s_branch c_pw_end_35
c_pw_36:
    s_cmp_lg_u32 s34, 1
    s_cbranch_scc1 c_pw_37
    ds_read_b128 v[108:111], v66 offset:128
    ds_read_b128 v[120:123], v67 offset:352
    ds_read_b128 v[124:127], v67 offset:864
    ds_read_b128 v[128:131], v67 offset:1376
    ds_read_b128 v[132:135], v67 offset:1888
    ds_read_b128 v[136:139], v67 offset:2400
    ds_read_b128 v[140:143], v67 offset:2912
    ds_read_b128 v[144:147], v67 offset:3424
    ds_read_b128 v[148:151], v67 offset:3936
    ds_read_b128 v[112:115], v66 offset:640
    ds_read_b128 v[116:119], v66 offset:1152
    s_waitcnt lgkmcnt(2)
    v_mfma_f32_16x16x32_bf16 v[104:107], v[108:111], v[148:151], 0
    v_mfma_f32_16x16x32_bf16 v[100:103], v[108:111], v[144:147], 0
    v_mfma_f32_16x16x32_bf16 v[96:99], v[108:111], v[140:143], 0
    v_mfma_f32_16x16x32_bf16 v[92:95], v[108:111], v[136:139], 0
    v_mfma_f32_16x16x32_bf16 v[88:91], v[108:111], v[132:135], 0
    v_mfma_f32_16x16x32_bf16 v[84:87], v[108:111], v[128:131], 0
    v_mfma_f32_16x16x32_bf16 v[80:83], v[108:111], v[124:127], 0
    v_mfma_f32_16x16x32_bf16 v[76:79], v[108:111], v[120:123], 0
    ds_read_b128 v[108:111], v66 offset:1664
    s_waitcnt lgkmcnt(2)
    v_mfma_f32_16x16x32_bf16 v[104:107], v[112:115], v[144:147], v[104:107]
    v_mfma_f32_16x16x32_bf16 v[100:103], v[112:115], v[140:143], v[100:103]
    v_mfma_f32_16x16x32_bf16 v[96:99], v[112:115], v[136:139], v[96:99]
    v_mfma_f32_16x16x32_bf16 v[92:95], v[112:115], v[132:135], v[92:95]
    v_mfma_f32_16x16x32_bf16 v[88:91], v[112:115], v[128:131], v[88:91]
    v_mfma_f32_16x16x32_bf16 v[84:87], v[112:115], v[124:127], v[84:87]
    v_mfma_f32_16x16x32_bf16 v[80:83], v[112:115], v[120:123], v[80:83]
    ds_read_b128 v[112:115], v66 offset:2176
    ds_read_b128 v[152:155], v67 offset:288
    ds_read_b128 v[156:159], v67 offset:800
    ds_read_b128 v[160:163], v67 offset:1312
    ds_read_b128 v[164:167], v67 offset:1824
    ds_read_b128 v[168:171], v67 offset:2336
    ds_read_b128 v[172:175], v67 offset:2848
    ds_read_b128 v[176:179], v67 offset:3360
    ds_read_b128 v[180:183], v67 offset:3872
    s_waitcnt lgkmcnt(10)
    v_mfma_f32_16x16x32_bf16 v[104:107], v[116:119], v[140:143], v[104:107]
    v_mfma_f32_16x16x32_bf16 v[100:103], v[116:119], v[136:139], v[100:103]
    v_mfma_f32_16x16x32_bf16 v[96:99], v[116:119], v[132:135], v[96:99]
    v_mfma_f32_16x16x32_bf16 v[92:95], v[116:119], v[128:131], v[92:95]
    v_mfma_f32_16x16x32_bf16 v[88:91], v[116:119], v[124:127], v[88:91]
    v_mfma_f32_16x16x32_bf16 v[84:87], v[116:119], v[120:123], v[84:87]
    ds_read_b128 v[116:119], v66 offset:2688
    s_waitcnt lgkmcnt(10)
    v_mfma_f32_16x16x32_bf16 v[104:107], v[108:111], v[136:139], v[104:107]
    v_mfma_f32_16x16x32_bf16 v[100:103], v[108:111], v[132:135], v[100:103]
    v_mfma_f32_16x16x32_bf16 v[96:99], v[108:111], v[128:131], v[96:99]
    v_mfma_f32_16x16x32_bf16 v[92:95], v[108:111], v[124:127], v[92:95]
    v_mfma_f32_16x16x32_bf16 v[88:91], v[108:111], v[120:123], v[88:91]
    ds_read_b128 v[108:111], v66 offset:3200
    s_waitcnt lgkmcnt(10)
    v_mfma_f32_16x16x32_bf16 v[104:107], v[112:115], v[132:135], v[104:107]
    v_mfma_f32_16x16x32_bf16 v[100:103], v[112:115], v[128:131], v[100:103]
    v_mfma_f32_16x16x32_bf16 v[96:99], v[112:115], v[124:127], v[96:99]
    v_mfma_f32_16x16x32_bf16 v[92:95], v[112:115], v[120:123], v[92:95]
    ds_read_b128 v[112:115], v66 offset:3712
    s_waitcnt lgkmcnt(2)
    v_mfma_f32_16x16x32_bf16 v[104:107], v[116:119], v[128:131], v[104:107]
    v_mfma_f32_16x16x32_bf16 v[100:103], v[116:119], v[124:127], v[100:103]
    v_mfma_f32_16x16x32_bf16 v[96:99], v[116:119], v[120:123], v[96:99]
    ds_read_b128 v[116:119], v66 offset:192
    s_waitcnt lgkmcnt(2)
    v_mfma_f32_16x16x32_bf16 v[104:107], v[108:111], v[124:127], v[104:107]
    v_mfma_f32_16x16x32_bf16 v[100:103], v[108:111], v[120:123], v[100:103]
    ds_read_b128 v[108:111], v66 offset:704
    s_waitcnt lgkmcnt(2)
    v_mfma_f32_16x16x32_bf16 v[104:107], v[112:115], v[120:123], v[104:107]
    ds_read_b128 v[112:115], v66 offset:1216
    s_waitcnt lgkmcnt(2)
    v_mfma_f32_16x16x32_bf16 v[104:107], v[116:119], v[180:183], v[104:107]
    v_mfma_f32_16x16x32_bf16 v[100:103], v[116:119], v[176:179], v[100:103]
    v_mfma_f32_16x16x32_bf16 v[96:99], v[116:119], v[172:175], v[96:99]
    v_mfma_f32_16x16x32_bf16 v[92:95], v[116:119], v[168:171], v[92:95]
    v_mfma_f32_16x16x32_bf16 v[88:91], v[116:119], v[164:167], v[88:91]
    v_mfma_f32_16x16x32_bf16 v[84:87], v[116:119], v[160:163], v[84:87]
    v_mfma_f32_16x16x32_bf16 v[80:83], v[116:119], v[156:159], v[80:83]
    v_mfma_f32_16x16x32_bf16 v[76:79], v[116:119], v[152:155], v[76:79]
    ds_read_b128 v[116:119], v66 offset:1728
    s_waitcnt lgkmcnt(2)
    v_mfma_f32_16x16x32_bf16 v[104:107], v[108:111], v[176:179], v[104:107]
    v_mfma_f32_16x16x32_bf16 v[100:103], v[108:111], v[172:175], v[100:103]
    v_mfma_f32_16x16x32_bf16 v[96:99], v[108:111], v[168:171], v[96:99]
    v_mfma_f32_16x16x32_bf16 v[92:95], v[108:111], v[164:167], v[92:95]
    v_mfma_f32_16x16x32_bf16 v[88:91], v[108:111], v[160:163], v[88:91]
    v_mfma_f32_16x16x32_bf16 v[84:87], v[108:111], v[156:159], v[84:87]
    v_mfma_f32_16x16x32_bf16 v[80:83], v[108:111], v[152:155], v[80:83]
    ds_read_b128 v[108:111], v66 offset:2240
    s_waitcnt lgkmcnt(2)
    v_mfma_f32_16x16x32_bf16 v[104:107], v[112:115], v[172:175], v[104:107]
    v_mfma_f32_16x16x32_bf16 v[100:103], v[112:115], v[168:171], v[100:103]
    v_mfma_f32_16x16x32_bf16 v[96:99], v[112:115], v[164:167], v[96:99]
    v_mfma_f32_16x16x32_bf16 v[92:95], v[112:115], v[160:163], v[92:95]
    v_mfma_f32_16x16x32_bf16 v[88:91], v[112:115], v[156:159], v[88:91]
    v_mfma_f32_16x16x32_bf16 v[84:87], v[112:115], v[152:155], v[84:87]
    ds_read_b128 v[112:115], v66 offset:2752
    s_waitcnt lgkmcnt(2)
    v_mfma_f32_16x16x32_bf16 v[104:107], v[116:119], v[168:171], v[104:107]
    v_mfma_f32_16x16x32_bf16 v[100:103], v[116:119], v[164:167], v[100:103]
    v_mfma_f32_16x16x32_bf16 v[96:99], v[116:119], v[160:163], v[96:99]
    v_mfma_f32_16x16x32_bf16 v[92:95], v[116:119], v[156:159], v[92:95]
    v_mfma_f32_16x16x32_bf16 v[88:91], v[116:119], v[152:155], v[88:91]
    ds_read_b128 v[116:119], v66 offset:3264
    s_waitcnt lgkmcnt(2)
    v_mfma_f32_16x16x32_bf16 v[104:107], v[108:111], v[164:167], v[104:107]
    v_mfma_f32_16x16x32_bf16 v[100:103], v[108:111], v[160:163], v[100:103]
    v_mfma_f32_16x16x32_bf16 v[96:99], v[108:111], v[156:159], v[96:99]
    v_mfma_f32_16x16x32_bf16 v[92:95], v[108:111], v[152:155], v[92:95]
    ds_read_b128 v[108:111], v66 offset:3776
    s_waitcnt lgkmcnt(2)
    v_mfma_f32_16x16x32_bf16 v[104:107], v[112:115], v[160:163], v[104:107]
    v_mfma_f32_16x16x32_bf16 v[100:103], v[112:115], v[156:159], v[100:103]
    v_mfma_f32_16x16x32_bf16 v[96:99], v[112:115], v[152:155], v[96:99]
    s_waitcnt lgkmcnt(1)
    v_mfma_f32_16x16x32_bf16 v[104:107], v[116:119], v[156:159], v[104:107]
    v_mfma_f32_16x16x32_bf16 v[100:103], v[116:119], v[152:155], v[100:103]
    s_waitcnt lgkmcnt(0)
    v_mfma_f32_16x16x32_bf16 v[104:107], v[108:111], v[152:155], v[104:107]
    ds_write_b128 v74, v[76:79] offset:0
    ds_write_b128 v74, v[80:83] offset:1024
    ds_write_b128 v74, v[84:87] offset:2048
    ds_write_b128 v74, v[88:91] offset:3072
    ds_write_b128 v74, v[92:95] offset:4096
    ds_write_b128 v74, v[96:99] offset:5120
    ds_write_b128 v74, v[100:103] offset:6144
    s_nop 0
    ds_write_b128 v74, v[104:107] offset:7168
    s_branch c_pw_end_35
c_pw_37:
    s_cmp_lg_u32 s34, 2
    s_cbranch_scc1 c_pw_38
    ds_read_b128 v[108:111], v66 offset:256
    ds_read_b128 v[120:123], v67 offset:224
    ds_read_b128 v[124:127], v67 offset:736
    ds_read_b128 v[128:131], v67 offset:1248
    ds_read_b128 v[132:135], v67 offset:1760
    ds_read_b128 v[136:139], v67 offset:2272
    ds_read_b128 v[140:143], v67 offset:2784
    ds_read_b128 v[144:147], v67 offset:3296
    ds_read_b128 v[148:151], v67 offset:3808
    ds_read_b128 v[112:115], v66 offset:768
    ds_read_b128 v[116:119], v66 offset:1280
    s_waitcnt lgkmcnt(2)
    v_mfma_f32_16x16x32_bf16 v[104:107], v[108:111], v[148:151], 0
    v_mfma_f32_16x16x32_bf16 v[100:103], v[108:111], v[144:147], 0
    v_mfma_f32_16x16x32_bf16 v[96:99], v[108:111], v[140:143], 0
    v_mfma_f32_16x16x32_bf16 v[92:95], v[108:111], v[136:139], 0
    v_mfma_f32_16x16x32_bf16 v[88:91], v[108:111], v[132:135], 0
    v_mfma_f32_16x16x32_bf16 v[84:87], v[108:111], v[128:131], 0
    v_mfma_f32_16x16x32_bf16 v[80:83], v[108:111], v[124:127], 0
    v_mfma_f32_16x16x32_bf16 v[76:79], v[108:111], v[120:123], 0
    ds_read_b128 v[108:111], v66 offset:1792
    s_waitcnt lgkmcnt(2)
    v_mfma_f32_16x16x32_bf16 v[104:107], v[112:115], v[144:147], v[104:107]
    v_mfma_f32_16x16x32_bf16 v[100:103], v[112:115], v[140:143], v[100:103]
    v_mfma_f32_16x16x32_bf16 v[96:99], v[112:115], v[136:139], v[96:99]
    v_mfma_f32_16x16x32_bf16 v[92:95], v[112:115], v[132:135], v[92:95]
    v_mfma_f32_16x16x32_bf16 v[88:91], v[112:115], v[128:131], v[88:91]
    v_mfma_f32_16x16x32_bf16 v[84:87], v[112:115], v[124:127], v[84:87]
    v_mfma_f32_16x16x32_bf16 v[80:83], v[112:115], v[120:123], v[80:83]
    ds_read_b128 v[112:115], v66 offset:2304
    ds_read_b128 v[152:155], v67 offset:160
    ds_read_b128 v[156:159], v67 offset:672
    ds_read_b128 v[160:163], v67 offset:1184
    ds_read_b128 v[164:167], v67 offset:1696
    ds_read_b128 v[168:171], v67 offset:2208
    ds_read_b128 v[172:175], v67 offset:2720
    ds_read_b128 v[176:179], v67 offset:3232
    ds_read_b128 v[180:183], v67 offset:3744
    s_waitcnt lgkmcnt(10)
    v_mfma_f32_16x16x32_bf16 v[104:107], v[116:119], v[140:143], v[104:107]
    v_mfma_f32_16x16x32_bf16 v[100:103], v[116:119], v[136:139], v[100:103]
    v_mfma_f32_16x16x32_bf16 v[96:99], v[116:119], v[132:135], v[96:99]
    v_mfma_f32_16x16x32_bf16 v[92:95], v[116:119], v[128:131], v[92:95]
    v_mfma_f32_16x16x32_bf16 v[88:91], v[116:119], v[124:127], v[88:91]
    v_mfma_f32_16x16x32_bf16 v[84:87], v[116:119], v[120:123], v[84:87]
    ds_read_b128 v[116:119], v66 offset:2816
    s_waitcnt lgkmcnt(10)
    v_mfma_f32_16x16x32_bf16 v[104:107], v[108:111], v[136:139], v[104:107]
    v_mfma_f32_16x16x32_bf16 v[100:103], v[108:111], v[132:135], v[100:103]
    v_mfma_f32_16x16x32_bf16 v[96:99], v[108:111], v[128:131], v[96:99]
    v_mfma_f32_16x16x32_bf16 v[92:95], v[108:111], v[124:127], v[92:95]
    v_mfma_f32_16x16x32_bf16 v[88:91], v[108:111], v[120:123], v[88:91]
    ds_read_b128 v[108:111], v66 offset:3328
    s_waitcnt lgkmcnt(10)
    v_mfma_f32_16x16x32_bf16 v[104:107], v[112:115], v[132:135], v[104:107]
    v_mfma_f32_16x16x32_bf16 v[100:103], v[112:115], v[128:131], v[100:103]
    v_mfma_f32_16x16x32_bf16 v[96:99], v[112:115], v[124:127], v[96:99]
    v_mfma_f32_16x16x32_bf16 v[92:95], v[112:115], v[120:123], v[92:95]
    ds_read_b128 v[112:115], v66 offset:3840
    s_waitcnt lgkmcnt(2)
    v_mfma_f32_16x16x32_bf16 v[104:107], v[116:119], v[128:131], v[104:107]
    v_mfma_f32_16x16x32_bf16 v[100:103], v[116:119], v[124:127], v[100:103]
    v_mfma_f32_16x16x32_bf16 v[96:99], v[116:119], v[120:123], v[96:99]
    ds_read_b128 v[116:119], v66 offset:320
    s_waitcnt lgkmcnt(2)
    v_mfma_f32_16x16x32_bf16 v[104:107], v[108:111], v[124:127], v[104:107]
    v_mfma_f32_16x16x32_bf16 v[100:103], v[108:111], v[120:123], v[100:103]
    ds_read_b128 v[108:111], v66 offset:832
    s_waitcnt lgkmcnt(2)
    v_mfma_f32_16x16x32_bf16 v[104:107], v[112:115], v[120:123], v[104:107]
    ds_read_b128 v[112:115], v66 offset:1344
    s_waitcnt lgkmcnt(2)
    v_mfma_f32_16x16x32_bf16 v[104:107], v[116:119], v[180:183], v[104:107]
    v_mfma_f32_16x16x32_bf16 v[100:103], v[116:119], v[176:179], v[100:103]
    v_mfma_f32_16x16x32_bf16 v[96:99], v[116:119], v[172:175], v[96:99]
    v_mfma_f32_16x16x32_bf16 v[92:95], v[116:119], v[168:171], v[92:95]
    v_mfma_f32_16x16x32_bf16 v[88:91], v[116:119], v[164:167], v[88:91]
    v_mfma_f32_16x16x32_bf16 v[84:87], v[116:119], v[160:163], v[84:87]
    v_mfma_f32_16x16x32_bf16 v[80:83], v[116:119], v[156:159], v[80:83]
    v_mfma_f32_16x16x32_bf16 v[76:79], v[116:119], v[152:155], v[76:79]
    ds_read_b128 v[116:119], v66 offset:1856
    s_waitcnt lgkmcnt(2)
    v_mfma_f32_16x16x32_bf16 v[104:107], v[108:111], v[176:179], v[104:107]
    v_mfma_f32_16x16x32_bf16 v[100:103], v[108:111], v[172:175], v[100:103]
    v_mfma_f32_16x16x32_bf16 v[96:99], v[108:111], v[168:171], v[96:99]
    v_mfma_f32_16x16x32_bf16 v[92:95], v[108:111], v[164:167], v[92:95]
    v_mfma_f32_16x16x32_bf16 v[88:91], v[108:111], v[160:163], v[88:91]
    v_mfma_f32_16x16x32_bf16 v[84:87], v[108:111], v[156:159], v[84:87]
    v_mfma_f32_16x16x32_bf16 v[80:83], v[108:111], v[152:155], v[80:83]
    ds_read_b128 v[108:111], v66 offset:2368
    s_waitcnt lgkmcnt(2)
    v_mfma_f32_16x16x32_bf16 v[104:107], v[112:115], v[172:175], v[104:107]
    v_mfma_f32_16x16x32_bf16 v[100:103], v[112:115], v[168:171], v[100:103]
    v_mfma_f32_16x16x32_bf16 v[96:99], v[112:115], v[164:167], v[96:99]
    v_mfma_f32_16x16x32_bf16 v[92:95], v[112:115], v[160:163], v[92:95]
    v_mfma_f32_16x16x32_bf16 v[88:91], v[112:115], v[156:159], v[88:91]
    v_mfma_f32_16x16x32_bf16 v[84:87], v[112:115], v[152:155], v[84:87]
    ds_read_b128 v[112:115], v66 offset:2880
    s_waitcnt lgkmcnt(2)
    v_mfma_f32_16x16x32_bf16 v[104:107], v[116:119], v[168:171], v[104:107]
    v_mfma_f32_16x16x32_bf16 v[100:103], v[116:119], v[164:167], v[100:103]
    v_mfma_f32_16x16x32_bf16 v[96:99], v[116:119], v[160:163], v[96:99]
    v_mfma_f32_16x16x32_bf16 v[92:95], v[116:119], v[156:159], v[92:95]
    v_mfma_f32_16x16x32_bf16 v[88:91], v[116:119], v[152:155], v[88:91]
    ds_read_b128 v[116:119], v66 offset:3392
    s_waitcnt lgkmcnt(2)
    v_mfma_f32_16x16x32_bf16 v[104:107], v[108:111], v[164:167], v[104:107]
    v_mfma_f32_16x16x32_bf16 v[100:103], v[108:111], v[160:163], v[100:103]
    v_mfma_f32_16x16x32_bf16 v[96:99], v[108:111], v[156:159], v[96:99]
    v_mfma_f32_16x16x32_bf16 v[92:95], v[108:111], v[152:155], v[92:95]
    ds_read_b128 v[108:111], v66 offset:3904
    s_waitcnt lgkmcnt(2)
    v_mfma_f32_16x16x32_bf16 v[104:107], v[112:115], v[160:163], v[104:107]
    v_mfma_f32_16x16x32_bf16 v[100:103], v[112:115], v[156:159], v[100:103]
    v_mfma_f32_16x16x32_bf16 v[96:99], v[112:115], v[152:155], v[96:99]
    s_waitcnt lgkmcnt(1)
    v_mfma_f32_16x16x32_bf16 v[104:107], v[116:119], v[156:159], v[104:107]
    v_mfma_f32_16x16x32_bf16 v[100:103], v[116:119], v[152:155], v[100:103]
    s_waitcnt lgkmcnt(0)
    v_mfma_f32_16x16x32_bf16 v[104:107], v[108:111], v[152:155], v[104:107]
    ds_write_b128 v74, v[76:79] offset:0
    ds_write_b128 v74, v[80:83] offset:1024
    ds_write_b128 v74, v[84:87] offset:2048
    ds_write_b128 v74, v[88:91] offset:3072
    ds_write_b128 v74, v[92:95] offset:4096
    ds_write_b128 v74, v[96:99] offset:5120
    ds_write_b128 v74, v[100:103] offset:6144
    s_nop 0
    ds_write_b128 v74, v[104:107] offset:7168
    s_branch c_pw_end_35
c_pw_38:
    ds_read_b128 v[108:111], v66 offset:384
    ds_read_b128 v[120:123], v67 offset:96
    ds_read_b128 v[124:127], v67 offset:608
    ds_read_b128 v[128:131], v67 offset:1120
    ds_read_b128 v[132:135], v67 offset:1632
    ds_read_b128 v[136:139], v67 offset:2144
    ds_read_b128 v[140:143], v67 offset:2656
    ds_read_b128 v[144:147], v67 offset:3168
    ds_read_b128 v[148:151], v67 offset:3680
    ds_read_b128 v[112:115], v66 offset:896
    ds_read_b128 v[116:119], v66 offset:1408
    s_waitcnt lgkmcnt(2)
    v_mfma_f32_16x16x32_bf16 v[104:107], v[108:111], v[148:151], 0
    v_mfma_f32_16x16x32_bf16 v[100:103], v[108:111], v[144:147], 0
    v_mfma_f32_16x16x32_bf16 v[96:99], v[108:111], v[140:143], 0
    v_mfma_f32_16x16x32_bf16 v[92:95], v[108:111], v[136:139], 0
    v_mfma_f32_16x16x32_bf16 v[88:91], v[108:111], v[132:135], 0
    v_mfma_f32_16x16x32_bf16 v[84:87], v[108:111], v[128:131], 0
    v_mfma_f32_16x16x32_bf16 v[80:83], v[108:111], v[124:127], 0
    v_mfma_f32_16x16x32_bf16 v[76:79], v[108:111], v[120:123], 0
    ds_read_b128 v[108:111], v66 offset:1920
    s_waitcnt lgkmcnt(2)
    v_mfma_f32_16x16x32_bf16 v[104:107], v[112:115], v[144:147], v[104:107]
    v_mfma_f32_16x16x32_bf16 v[100:103], v[112:115], v[140:143], v[100:103]
    v_mfma_f32_16x16x32_bf16 v[96:99], v[112:115], v[136:139], v[96:99]
    v_mfma_f32_16x16x32_bf16 v[92:95], v[112:115], v[132:135], v[92:95]
    v_mfma_f32_16x16x32_bf16 v[88:91], v[112:115], v[128:131], v[88:91]
    v_mfma_f32_16x16x32_bf16 v[84:87], v[112:115], v[124:127], v[84:87]
    v_mfma_f32_16x16x32_bf16 v[80:83], v[112:115], v[120:123], v[80:83]
    ds_read_b128 v[112:115], v66 offset:2432
    ds_read_b128 v[152:155], v67 offset:32
    ds_read_b128 v[156:159], v67 offset:544
    ds_read_b128 v[160:163], v67 offset:1056
    ds_read_b128 v[164:167], v67 offset:1568
    ds_read_b128 v[168:171], v67 offset:2080
    ds_read_b128 v[172:175], v67 offset:2592
    ds_read_b128 v[176:179], v67 offset:3104
    ds_read_b128 v[180:183], v67 offset:3616
    s_waitcnt lgkmcnt(10)
    v_mfma_f32_16x16x32_bf16 v[104:107], v[116:119], v[140:143], v[104:107]
    v_mfma_f32_16x16x32_bf16 v[100:103], v[116:119], v[136:139], v[100:103]
    v_mfma_f32_16x16x32_bf16 v[96:99], v[116:119], v[132:135], v[96:99]
    v_mfma_f32_16x16x32_bf16 v[92:95], v[116:119], v[128:131], v[92:95]
    v_mfma_f32_16x16x32_bf16 v[88:91], v[116:119], v[124:127], v[88:91]
    v_mfma_f32_16x16x32_bf16 v[84:87], v[116:119], v[120:123], v[84:87]
    ds_read_b128 v[116:119], v66 offset:2944
    s_waitcnt lgkmcnt(10)
    v_mfma_f32_16x16x32_bf16 v[104:107], v[108:111], v[136:139], v[104:107]
    v_mfma_f32_16x16x32_bf16 v[100:103], v[108:111], v[132:135], v[100:103]
    v_mfma_f32_16x16x32_bf16 v[96:99], v[108:111], v[128:131], v[96:99]
    v_mfma_f32_16x16x32_bf16 v[92:95], v[108:111], v[124:127], v[92:95]
    v_mfma_f32_16x16x32_bf16 v[88:91], v[108:111], v[120:123], v[88:91]
    ds_read_b128 v[108:111], v66 offset:3456
    s_waitcnt lgkmcnt(10)
    v_mfma_f32_16x16x32_bf16 v[104:107], v[112:115], v[132:135], v[104:107]
    v_mfma_f32_16x16x32_bf16 v[100:103], v[112:115], v[128:131], v[100:103]
    v_mfma_f32_16x16x32_bf16 v[96:99], v[112:115], v[124:127], v[96:99]
    v_mfma_f32_16x16x32_bf16 v[92:95], v[112:115], v[120:123], v[92:95]
    ds_read_b128 v[112:115], v66 offset:3968
    s_waitcnt lgkmcnt(2)
    v_mfma_f32_16x16x32_bf16 v[104:107], v[116:119], v[128:131], v[104:107]
    v_mfma_f32_16x16x32_bf16 v[100:103], v[116:119], v[124:127], v[100:103]
    v_mfma_f32_16x16x32_bf16 v[96:99], v[116:119], v[120:123], v[96:99]
    ds_read_b128 v[116:119], v66 offset:448
    s_waitcnt lgkmcnt(2)
    v_mfma_f32_16x16x32_bf16 v[104:107], v[108:111], v[124:127], v[104:107]
    v_mfma_f32_16x16x32_bf16 v[100:103], v[108:111], v[120:123], v[100:103]
    ds_read_b128 v[108:111], v66 offset:960
    s_waitcnt lgkmcnt(2)
    v_mfma_f32_16x16x32_bf16 v[104:107], v[112:115], v[120:123], v[104:107]
    ds_read_b128 v[112:115], v66 offset:1472
    s_waitcnt lgkmcnt(2)
    v_mfma_f32_16x16x32_bf16 v[104:107], v[116:119], v[180:183], v[104:107]
    v_mfma_f32_16x16x32_bf16 v[100:103], v[116:119], v[176:179], v[100:103]
    v_mfma_f32_16x16x32_bf16 v[96:99], v[116:119], v[172:175], v[96:99]
    v_mfma_f32_16x16x32_bf16 v[92:95], v[116:119], v[168:171], v[92:95]
    v_mfma_f32_16x16x32_bf16 v[88:91], v[116:119], v[164:167], v[88:91]
    v_mfma_f32_16x16x32_bf16 v[84:87], v[116:119], v[160:163], v[84:87]
    v_mfma_f32_16x16x32_bf16 v[80:83], v[116:119], v[156:159], v[80:83]
    v_mfma_f32_16x16x32_bf16 v[76:79], v[116:119], v[152:155], v[76:79]
    ds_read_b128 v[116:119], v66 offset:1984
    s_waitcnt lgkmcnt(2)
    v_mfma_f32_16x16x32_bf16 v[104:107], v[108:111], v[176:179], v[104:107]
    v_mfma_f32_16x16x32_bf16 v[100:103], v[108:111], v[172:175], v[100:103]
    v_mfma_f32_16x16x32_bf16 v[96:99], v[108:111], v[168:171], v[96:99]
    v_mfma_f32_16x16x32_bf16 v[92:95], v[108:111], v[164:167], v[92:95]
    v_mfma_f32_16x16x32_bf16 v[88:91], v[108:111], v[160:163], v[88:91]
    v_mfma_f32_16x16x32_bf16 v[84:87], v[108:111], v[156:159], v[84:87]
    v_mfma_f32_16x16x32_bf16 v[80:83], v[108:111], v[152:155], v[80:83]
    ds_read_b128 v[108:111], v66 offset:2496
    s_waitcnt lgkmcnt(2)
    v_mfma_f32_16x16x32_bf16 v[104:107], v[112:115], v[172:175], v[104:107]
    v_mfma_f32_16x16x32_bf16 v[100:103], v[112:115], v[168:171], v[100:103]
    v_mfma_f32_16x16x32_bf16 v[96:99], v[112:115], v[164:167], v[96:99]
    v_mfma_f32_16x16x32_bf16 v[92:95], v[112:115], v[160:163], v[92:95]
    v_mfma_f32_16x16x32_bf16 v[88:91], v[112:115], v[156:159], v[88:91]
    v_mfma_f32_16x16x32_bf16 v[84:87], v[112:115], v[152:155], v[84:87]
    ds_read_b128 v[112:115], v66 offset:3008
    s_waitcnt lgkmcnt(2)
    v_mfma_f32_16x16x32_bf16 v[104:107], v[116:119], v[168:171], v[104:107]
    v_mfma_f32_16x16x32_bf16 v[100:103], v[116:119], v[164:167], v[100:103]
    v_mfma_f32_16x16x32_bf16 v[96:99], v[116:119], v[160:163], v[96:99]
    v_mfma_f32_16x16x32_bf16 v[92:95], v[116:119], v[156:159], v[92:95]
    v_mfma_f32_16x16x32_bf16 v[88:91], v[116:119], v[152:155], v[88:91]
    ds_read_b128 v[116:119], v66 offset:3520
    s_waitcnt lgkmcnt(2)
    v_mfma_f32_16x16x32_bf16 v[104:107], v[108:111], v[164:167], v[104:107]
    v_mfma_f32_16x16x32_bf16 v[100:103], v[108:111], v[160:163], v[100:103]
    v_mfma_f32_16x16x32_bf16 v[96:99], v[108:111], v[156:159], v[96:99]
    v_mfma_f32_16x16x32_bf16 v[92:95], v[108:111], v[152:155], v[92:95]
    ds_read_b128 v[108:111], v66 offset:4032
    s_waitcnt lgkmcnt(2)
    v_mfma_f32_16x16x32_bf16 v[104:107], v[112:115], v[160:163], v[104:107]
    v_mfma_f32_16x16x32_bf16 v[100:103], v[112:115], v[156:159], v[100:103]
    v_mfma_f32_16x16x32_bf16 v[96:99], v[112:115], v[152:155], v[96:99]
    s_waitcnt lgkmcnt(1)
    v_mfma_f32_16x16x32_bf16 v[104:107], v[116:119], v[156:159], v[104:107]
    v_mfma_f32_16x16x32_bf16 v[100:103], v[116:119], v[152:155], v[100:103]
    s_waitcnt lgkmcnt(0)
    v_mfma_f32_16x16x32_bf16 v[104:107], v[108:111], v[152:155], v[104:107]
    ds_write_b128 v74, v[76:79] offset:0
    ds_write_b128 v74, v[80:83] offset:1024
    ds_write_b128 v74, v[84:87] offset:2048
    ds_write_b128 v74, v[88:91] offset:3072
    ds_write_b128 v74, v[92:95] offset:4096
    ds_write_b128 v74, v[96:99] offset:5120
    ds_write_b128 v74, v[100:103] offset:6144
    s_nop 0
    ds_write_b128 v74, v[104:107] offset:7168
c_pw_end_35:
    s_waitcnt lgkmcnt(0)
    v_mov_b32 v3, 161796
    v_mov_b32 v4, 1
    s_mov_b64 exec, 1
    ds_add_u32 v3, v4
    s_mov_b64 exec, -1
    s_mov_b32 s67, 0
gsync_40:
    ds_read_b32 v4, v3
    s_add_u32 s67, s67, 1
    s_waitcnt lgkmcnt(0)
    v_readfirstlane_b32 s66, v4
    s_cmp_gt_u32 s67, 1000000
    s_cbranch_scc1 gsync_e_41
    s_cmp_lt_u32 s66, 8
    s_cbranch_scc1 gsync_40
gsync_e_41:
    ds_read_b128 v[120:123], v75 offset:0
    ds_read_b128 v[124:127], v75 offset:16
    ds_read_b128 v[128:131], v75 offset:8192
    ds_read_b128 v[132:135], v75 offset:8208
    ds_read_b128 v[136:139], v75 offset:16384
    ds_read_b128 v[140:143], v75 offset:16400
    ds_read_b128 v[144:147], v75 offset:24576
    ds_read_b128 v[148:151], v75 offset:24592
    s_lshl_b32 s40, s56, 12
    s_add_u32 s40, s40, 8912896
    s_waitcnt lgkmcnt(0)
    v_pk_add_f32 v[120:121], v[120:121], v[128:129]
    v_pk_add_f32 v[136:137], v[136:137], v[144:145]
    v_pk_add_f32 v[122:123], v[122:123], v[130:131]
    v_pk_add_f32 v[138:139], v[138:139], v[146:147]
    v_pk_add_f32 v[124:125], v[124:125], v[132:133]
    v_pk_add_f32 v[140:141], v[140:141], v[148:149]
    v_pk_add_f32 v[126:127], v[126:127], v[134:135]
    v_pk_add_f32 v[142:143], v[142:143], v[150:151]
    v_pk_add_f32 v[120:121], v[120:121], v[136:137]
    v_pk_add_f32 v[122:123], v[122:123], v[138:139]
    v_pk_add_f32 v[124:125], v[124:125], v[140:141]
    v_pk_add_f32 v[126:127], v[126:127], v[142:143]
    v_cvt_pk_bf16_f32 v192, v120, v121
    v_cvt_pk_bf16_f32 v193, v122, v123
    v_cvt_pk_bf16_f32 v194, v124, v125
    v_cvt_pk_bf16_f32 v195, v126, v127
    buffer_store_dwordx4 v[192:195], v2, s[8:11], s40 offen sc1
    s_nop 1
    s_waitcnt vmcnt(1)
    v_cmp_ne_u32 vcc, 0, v0
    s_nop 1
    v_cndmask_b32 v16, 0, v16, vcc
    v_cndmask_b32 v17, 0, v17, vcc
    v_cndmask_b32 v18, 0, v18, vcc
    v_cndmask_b32 v19, 0, v19, vcc
    v_alignbit_b32 v184, v17, v16, 16
    v_alignbit_b32 v185, v18, v17, 16
    v_alignbit_b32 v186, v19, v18, 16
    v_alignbit_b32 v187, v20, v19, 16
    v_alignbit_b32 v188, v21, v20, 16
    v_alignbit_b32 v189, v22, v21, 16
    v_alignbit_b32 v190, v23, v22, 16
    ds_write_b128 v64, v[184:187] offset:0
    v_mov_b32 v192, v17
    v_mov_b32 v193, v18
    v_mov_b32 v194, v19
    v_mov_b32 v195, v20
    ds_write_b128 v64, v[192:195] offset:4160
    s_nop 1
    v_mov_b32 v192, v185
    v_mov_b32 v193, v186
    v_mov_b32 v194, v187
    v_mov_b32 v195, v188
    ds_write_b128 v64, v[192:195] offset:8320
    s_nop 1
    ds_write_b128 v64, v[18:21] offset:12480
    ds_write_b128 v64, v[186:189] offset:16640
    v_mov_b32 v192, v19
    v_mov_b32 v193, v20
    v_mov_b32 v194, v21
    v_mov_b32 v195, v22
    ds_write_b128 v64, v[192:195] offset:20800
    s_nop 1
    v_mov_b32 v192, v187
    v_mov_b32 v193, v188
    v_mov_b32 v194, v189
    v_mov_b32 v195, v190
    ds_write_b128 v64, v[192:195] offset:24960
    s_nop 1
    ds_write_b128 v64, v[20:23] offset:29120
    ds_write_b128 v65, v[36:39]
    v_lshlrev_b32 v3, 16, v45
    v_or_b32 v3, v3, v45
    v_and_b32 v196, v68, v3
    v_and_b32 v197, v69, v3
    v_and_b32 v198, v70, v3
    v_and_b32 v199, v71, v3
    s_waitcnt lgkmcnt(0)
    v_mov_b32 v3, 161796
    v_mov_b32 v4, 1
    s_mov_b64 exec, 1
    ds_add_u32 v3, v4
    s_mov_b64 exec, -1
    s_mov_b32 s67, 0
gsync_42:
    ds_read_b32 v4, v3
    s_add_u32 s67, s67, 1
    s_waitcnt lgkmcnt(0)
    v_readfirstlane_b32 s66, v4
    s_cmp_gt_u32 s67, 1000000
    s_cbranch_scc1 gsync_e_43
    s_cmp_lt_u32 s66, 12
    s_cbranch_scc1 gsync_42
gsync_e_43:
    s_cmp_ge_u32 s2, 192
    s_cbranch_scc1 c_wj3_44
    v_lshrrev_b32 v3, 4, v1
    v_and_b32 v5, 15, v1
    v_lshrrev_b32 v4, 2, v5
    v_lshl_add_u32 v3, v3, 2, v4
    v_mul_u32_u24 v3, 160, v3
    v_and_b32 v4, 3, v5
    v_lshl_add_u32 v3, v4, 3, v3
    v_lshlrev_b32 v5, 4, v1
    s_lshl_b32 s40, s34, 5
    s_add_u32 s41, s40, 156672
    v_add_u32 v4, s41, v3
    ds_read_b64_tr_b16 v[192:193], v4
    ds_read_b64_tr_b16 v[194:195], v4 offset:2560
    s_mul_i32 s41, s2, 5120
    s_lshl_b32 s40, s40, 5
    s_add_u32 s41, s41, s40
    s_add_u32 s41, s41, 15007744
    s_waitcnt lgkmcnt(0)
    buffer_store_dwordx4 v[192:195], v5, s[8:11], s41 offen sc1
    s_nop 1
    s_cmp_lg_u32 s34, 0
    s_cbranch_scc1 c_wj4_45
    s_mov_b32 s40, 128
    s_add_u32 s41, s40, 156672
    v_add_u32 v4, s41, v3
    ds_read_b64_tr_b16 v[192:193], v4
    ds_read_b64_tr_b16 v[194:195], v4 offset:2560
    s_mul_i32 s41, s2, 5120
    s_lshl_b32 s40, s40, 5
    s_add_u32 s41, s41, s40
    s_add_u32 s41, s41, 15007744
    s_waitcnt lgkmcnt(0)
    buffer_store_dwordx4 v[192:195], v5, s[8:11], s41 offen sc1
    s_nop 1
c_wj4_45:
c_wj3_44:
    s_cmp_lg_u32 s34, 0
    s_cbranch_scc1 c_pw_47
    ds_read_b128 v[108:111], v66 offset:0
    ds_read_b128 v[120:123], v67 offset:480
    ds_read_b128 v[124:127], v67 offset:992
    ds_read_b128 v[128:131], v67 offset:1504
    ds_read_b128 v[132:135], v67 offset:2016
    ds_read_b128 v[136:139], v67 offset:2528
    ds_read_b128 v[140:143], v67 offset:3040
    ds_read_b128 v[144:147], v67 offset:3552
    ds_read_b128 v[148:151], v67 offset:4064
    ds_read_b128 v[112:115], v66 offset:512
    ds_read_b128 v[116:119], v66 offset:1024
    s_waitcnt lgkmcnt(2)
    v_mfma_f32_16x16x32_bf16 v[104:107], v[108:111], v[148:151], 0
    v_mfma_f32_16x16x32_bf16 v[100:103], v[108:111], v[144:147], 0
    v_mfma_f32_16x16x32_bf16 v[96:99], v[108:111], v[140:143], 0
    v_mfma_f32_16x16x32_bf16 v[92:95], v[108:111], v[136:139], 0
    v_mfma_f32_16x16x32_bf16 v[88:91], v[108:111], v[132:135], 0
    v_mfma_f32_16x16x32_bf16 v[84:87], v[108:111], v[128:131], 0
    v_mfma_f32_16x16x32_bf16 v[80:83], v[108:111], v[124:127], 0
    v_mfma_f32_16x16x32_bf16 v[76:79], v[108:111], v[120:123], 0
    v_mfma_f32_16x16x32_bf16 v[76:79], v[196:199], v[120:123], v[76:79]
    v_mfma_f32_16x16x32_bf16 v[80:83], v[196:199], v[124:127], v[80:83]
    v_mfma_f32_16x16x32_bf16 v[84:87], v[196:199], v[128:131], v[84:87]
    v_mfma_f32_16x16x32_bf16 v[88:91], v[196:199], v[132:135], v[88:91]
    v_mfma_f32_16x16x32_bf16 v[92:95], v[196:199], v[136:139], v[92:95]
    v_mfma_f32_16x16x32_bf16 v[96:99], v[196:199], v[140:143], v[96:99]
    v_mfma_f32_16x16x32_bf16 v[100:103], v[196:199], v[144:147], v[100:103]
    v_mfma_f32_16x16x32_bf16 v[104:107], v[196:199], v[148:151], v[104:107]
    ds_read_b128 v[108:111], v66 offset:1536
    s_waitcnt lgkmcnt(2)
    v_mfma_f32_16x16x32_bf16 v[104:107], v[112:115], v[144:147], v[104:107]
    v_mfma_f32_16x16x32_bf16 v[100:103], v[112:115], v[140:143], v[100:103]
    v_mfma_f32_16x16x32_bf16 v[96:99], v[112:115], v[136:139], v[96:99]
    v_mfma_f32_16x16x32_bf16 v[92:95], v[112:115], v[132:135], v[92:95]
    v_mfma_f32_16x16x32_bf16 v[88:91], v[112:115], v[128:131], v[88:91]
    v_mfma_f32_16x16x32_bf16 v[84:87], v[112:115], v[124:127], v[84:87]
    v_mfma_f32_16x16x32_bf16 v[80:83], v[112:115], v[120:123], v[80:83]
    ds_read_b128 v[112:115], v66 offset:2048
    ds_read_b128 v[152:155], v67 offset:416
    ds_read_b128 v[156:159], v67 offset:928
    ds_read_b128 v[160:163], v67 offset:1440
    ds_read_b128 v[164:167], v67 offset:1952
    ds_read_b128 v[168:171], v67 offset:2464
    ds_read_b128 v[172:175], v67 offset:2976
    ds_read_b128 v[176:179], v67 offset:3488
    ds_read_b128 v[180:183], v67 offset:4000
    s_waitcnt lgkmcnt(10)
    v_mfma_f32_16x16x32_bf16 v[104:107], v[116:119], v[140:143], v[104:107]
    v_mfma_f32_16x16x32_bf16 v[100:103], v[116:119], v[136:139], v[100:103]
    v_mfma_f32_16x16x32_bf16 v[96:99], v[116:119], v[132:135], v[96:99]
    v_mfma_f32_16x16x32_bf16 v[92:95], v[116:119], v[128:131], v[92:95]
    v_mfma_f32_16x16x32_bf16 v[88:91], v[116:119], v[124:127], v[88:91]
    v_mfma_f32_16x16x32_bf16 v[84:87], v[116:119], v[120:123], v[84:87]
    ds_read_b128 v[116:119], v66 offset:2560
    s_waitcnt lgkmcnt(10)
    v_mfma_f32_16x16x32_bf16 v[104:107], v[108:111], v[136:139], v[104:107]
    v_mfma_f32_16x16x32_bf16 v[100:103], v[108:111], v[132:135], v[100:103]
    v_mfma_f32_16x16x32_bf16 v[96:99], v[108:111], v[128:131], v[96:99]
    v_mfma_f32_16x16x32_bf16 v[92:95], v[108:111], v[124:127], v[92:95]
    v_mfma_f32_16x16x32_bf16 v[88:91], v[108:111], v[120:123], v[88:91]
    ds_read_b128 v[108:111], v66 offset:3072
    s_waitcnt lgkmcnt(10)
    v_mfma_f32_16x16x32_bf16 v[104:107], v[112:115], v[132:135], v[104:107]
    v_mfma_f32_16x16x32_bf16 v[100:103], v[112:115], v[128:131], v[100:103]
    v_mfma_f32_16x16x32_bf16 v[96:99], v[112:115], v[124:127], v[96:99]
    v_mfma_f32_16x16x32_bf16 v[92:95], v[112:115], v[120:123], v[92:95]
    ds_read_b128 v[112:115], v66 offset:3584
    s_waitcnt lgkmcnt(2)
    v_mfma_f32_16x16x32_bf16 v[104:107], v[116:119], v[128:131], v[104:107]
    v_mfma_f32_16x16x32_bf16 v[100:103], v[116:119], v[124:127], v[100:103]
    v_mfma_f32_16x16x32_bf16 v[96:99], v[116:119], v[120:123], v[96:99]
    ds_read_b128 v[116:119], v66 offset:64
    s_waitcnt lgkmcnt(2)
    v_mfma_f32_16x16x32_bf16 v[104:107], v[108:111], v[124:127], v[104:107]
    v_mfma_f32_16x16x32_bf16 v[100:103], v[108:111], v[120:123], v[100:103]
    ds_read_b128 v[108:111], v66 offset:576
    s_waitcnt lgkmcnt(2)
    v_mfma_f32_16x16x32_bf16 v[104:107], v[112:115], v[120:123], v[104:107]
    ds_read_b128 v[112:115], v66 offset:1088
    s_waitcnt lgkmcnt(2)
    v_mfma_f32_16x16x32_bf16 v[104:107], v[116:119], v[180:183], v[104:107]
    v_mfma_f32_16x16x32_bf16 v[100:103], v[116:119], v[176:179], v[100:103]
    v_mfma_f32_16x16x32_bf16 v[96:99], v[116:119], v[172:175], v[96:99]
    v_mfma_f32_16x16x32_bf16 v[92:95], v[116:119], v[168:171], v[92:95]
    v_mfma_f32_16x16x32_bf16 v[88:91], v[116:119], v[164:167], v[88:91]
    v_mfma_f32_16x16x32_bf16 v[84:87], v[116:119], v[160:163], v[84:87]
    v_mfma_f32_16x16x32_bf16 v[80:83], v[116:119], v[156:159], v[80:83]
    v_mfma_f32_16x16x32_bf16 v[76:79], v[116:119], v[152:155], v[76:79]
    ds_read_b128 v[116:119], v66 offset:1600
    s_waitcnt lgkmcnt(2)
    v_mfma_f32_16x16x32_bf16 v[104:107], v[108:111], v[176:179], v[104:107]
    v_mfma_f32_16x16x32_bf16 v[100:103], v[108:111], v[172:175], v[100:103]
    v_mfma_f32_16x16x32_bf16 v[96:99], v[108:111], v[168:171], v[96:99]
    v_mfma_f32_16x16x32_bf16 v[92:95], v[108:111], v[164:167], v[92:95]
    v_mfma_f32_16x16x32_bf16 v[88:91], v[108:111], v[160:163], v[88:91]
    v_mfma_f32_16x16x32_bf16 v[84:87], v[108:111], v[156:159], v[84:87]
    v_mfma_f32_16x16x32_bf16 v[80:83], v[108:111], v[152:155], v[80:83]
    ds_read_b128 v[108:111], v66 offset:2112
    s_waitcnt lgkmcnt(2)
    v_mfma_f32_16x16x32_bf16 v[104:107], v[112:115], v[172:175], v[104:107]
    v_mfma_f32_16x16x32_bf16 v[100:103], v[112:115], v[168:171], v[100:103]
    v_mfma_f32_16x16x32_bf16 v[96:99], v[112:115], v[164:167], v[96:99]
    v_mfma_f32_16x16x32_bf16 v[92:95], v[112:115], v[160:163], v[92:95]
    v_mfma_f32_16x16x32_bf16 v[88:91], v[112:115], v[156:159], v[88:91]
    v_mfma_f32_16x16x32_bf16 v[84:87], v[112:115], v[152:155], v[84:87]
    ds_read_b128 v[112:115], v66 offset:2624
    s_waitcnt lgkmcnt(2)
    v_mfma_f32_16x16x32_bf16 v[104:107], v[116:119], v[168:171], v[104:107]
    v_mfma_f32_16x16x32_bf16 v[100:103], v[116:119], v[164:167], v[100:103]
    v_mfma_f32_16x16x32_bf16 v[96:99], v[116:119], v[160:163], v[96:99]
    v_mfma_f32_16x16x32_bf16 v[92:95], v[116:119], v[156:159], v[92:95]
    v_mfma_f32_16x16x32_bf16 v[88:91], v[116:119], v[152:155], v[88:91]
    ds_read_b128 v[116:119], v66 offset:3136
    s_waitcnt lgkmcnt(2)
    v_mfma_f32_16x16x32_bf16 v[104:107], v[108:111], v[164:167], v[104:107]
    v_mfma_f32_16x16x32_bf16 v[100:103], v[108:111], v[160:163], v[100:103]
    v_mfma_f32_16x16x32_bf16 v[96:99], v[108:111], v[156:159], v[96:99]
    v_mfma_f32_16x16x32_bf16 v[92:95], v[108:111], v[152:155], v[92:95]
    ds_read_b128 v[108:111], v66 offset:3648
    s_waitcnt lgkmcnt(2)
    v_mfma_f32_16x16x32_bf16 v[104:107], v[112:115], v[160:163], v[104:107]
    v_mfma_f32_16x16x32_bf16 v[100:103], v[112:115], v[156:159], v[100:103]
    v_mfma_f32_16x16x32_bf16 v[96:99], v[112:115], v[152:155], v[96:99]
    s_waitcnt lgkmcnt(1)
    v_mfma_f32_16x16x32_bf16 v[104:107], v[116:119], v[156:159], v[104:107]
    v_mfma_f32_16x16x32_bf16 v[100:103], v[116:119], v[152:155], v[100:103]
    s_waitcnt lgkmcnt(0)
    v_mfma_f32_16x16x32_bf16 v[104:107], v[108:111], v[152:155], v[104:107]
    ds_write_b128 v74, v[76:79] offset:0
    ds_write_b128 v74, v[80:83] offset:1024
    ds_write_b128 v74, v[84:87] offset:2048
    ds_write_b128 v74, v[88:91] offset:3072
    ds_write_b128 v74, v[92:95] offset:4096
    ds_write_b128 v74, v[96:99] offset:5120
    ds_write_b128 v74, v[100:103] offset:6144
    s_nop 0
    ds_write_b128 v74, v[104:107] offset:7168
    s_branch c_pw_end_46
c_pw_47:
    s_cmp_lg_u32 s34, 1
    s_cbranch_scc1 c_pw_48
    ds_read_b128 v[108:111], v66 offset:128
    ds_read_b128 v[120:123], v67 offset:352
    ds_read_b128 v[124:127], v67 offset:864
    ds_read_b128 v[128:131], v67 offset:1376
    ds_read_b128 v[132:135], v67 offset:1888
    ds_read_b128 v[136:139], v67 offset:2400
    ds_read_b128 v[140:143], v67 offset:2912
    ds_read_b128 v[144:147], v67 offset:3424
    ds_read_b128 v[148:151], v67 offset:3936
    ds_read_b128 v[112:115], v66 offset:640
    ds_read_b128 v[116:119], v66 offset:1152
    s_waitcnt lgkmcnt(2)
    v_mfma_f32_16x16x32_bf16 v[104:107], v[108:111], v[148:151], 0
    v_mfma_f32_16x16x32_bf16 v[100:103], v[108:111], v[144:147], 0
    v_mfma_f32_16x16x32_bf16 v[96:99], v[108:111], v[140:143], 0
    v_mfma_f32_16x16x32_bf16 v[92:95], v[108:111], v[136:139], 0
    v_mfma_f32_16x16x32_bf16 v[88:91], v[108:111], v[132:135], 0
    v_mfma_f32_16x16x32_bf16 v[84:87], v[108:111], v[128:131], 0
    v_mfma_f32_16x16x32_bf16 v[80:83], v[108:111], v[124:127], 0
    v_mfma_f32_16x16x32_bf16 v[76:79], v[108:111], v[120:123], 0
    ds_read_b128 v[108:111], v66 offset:1664
    s_waitcnt lgkmcnt(2)
    v_mfma_f32_16x16x32_bf16 v[104:107], v[112:115], v[144:147], v[104:107]
    v_mfma_f32_16x16x32_bf16 v[100:103], v[112:115], v[140:143], v[100:103]
    v_mfma_f32_16x16x32_bf16 v[96:99], v[112:115], v[136:139], v[96:99]
    v_mfma_f32_16x16x32_bf16 v[92:95], v[112:115], v[132:135], v[92:95]
    v_mfma_f32_16x16x32_bf16 v[88:91], v[112:115], v[128:131], v[88:91]
    v_mfma_f32_16x16x32_bf16 v[84:87], v[112:115], v[124:127], v[84:87]
    v_mfma_f32_16x16x32_bf16 v[80:83], v[112:115], v[120:123], v[80:83]
    ds_read_b128 v[112:115], v66 offset:2176
    ds_read_b128 v[152:155], v67 offset:288
    ds_read_b128 v[156:159], v67 offset:800
    ds_read_b128 v[160:163], v67 offset:1312
    ds_read_b128 v[164:167], v67 offset:1824
    ds_read_b128 v[168:171], v67 offset:2336
    ds_read_b128 v[172:175], v67 offset:2848
    ds_read_b128 v[176:179], v67 offset:3360
    ds_read_b128 v[180:183], v67 offset:3872
    s_waitcnt lgkmcnt(10)
    v_mfma_f32_16x16x32_bf16 v[104:107], v[116:119], v[140:143], v[104:107]
    v_mfma_f32_16x16x32_bf16 v[100:103], v[116:119], v[136:139], v[100:103]
    v_mfma_f32_16x16x32_bf16 v[96:99], v[116:119], v[132:135], v[96:99]
    v_mfma_f32_16x16x32_bf16 v[92:95], v[116:119], v[128:131], v[92:95]
    v_mfma_f32_16x16x32_bf16 v[88:91], v[116:119], v[124:127], v[88:91]
    v_mfma_f32_16x16x32_bf16 v[84:87], v[116:119], v[120:123], v[84:87]
    ds_read_b128 v[116:119], v66 offset:2688
    s_waitcnt lgkmcnt(10)
    v_mfma_f32_16x16x32_bf16 v[104:107], v[108:111], v[136:139], v[104:107]
    v_mfma_f32_16x16x32_bf16 v[100:103], v[108:111], v[132:135], v[100:103]
    v_mfma_f32_16x16x32_bf16 v[96:99], v[108:111], v[128:131], v[96:99]
    v_mfma_f32_16x16x32_bf16 v[92:95], v[108:111], v[124:127], v[92:95]
    v_mfma_f32_16x16x32_bf16 v[88:91], v[108:111], v[120:123], v[88:91]
    ds_read_b128 v[108:111], v66 offset:3200
    s_waitcnt lgkmcnt(10)
    v_mfma_f32_16x16x32_bf16 v[104:107], v[112:115], v[132:135], v[104:107]
    v_mfma_f32_16x16x32_bf16 v[100:103], v[112:115], v[128:131], v[100:103]
    v_mfma_f32_16x16x32_bf16 v[96:99], v[112:115], v[124:127], v[96:99]
    v_mfma_f32_16x16x32_bf16 v[92:95], v[112:115], v[120:123], v[92:95]
    ds_read_b128 v[112:115], v66 offset:3712
    s_waitcnt lgkmcnt(2)
    v_mfma_f32_16x16x32_bf16 v[104:107], v[116:119], v[128:131], v[104:107]
    v_mfma_f32_16x16x32_bf16 v[100:103], v[116:119], v[124:127], v[100:103]
    v_mfma_f32_16x16x32_bf16 v[96:99], v[116:119], v[120:123], v[96:99]
    ds_read_b128 v[116:119], v66 offset:192
    s_waitcnt lgkmcnt(2)
    v_mfma_f32_16x16x32_bf16 v[104:107], v[108:111], v[124:127], v[104:107]
    v_mfma_f32_16x16x32_bf16 v[100:103], v[108:111], v[120:123], v[100:103]
    ds_read_b128 v[108:111], v66 offset:704
    s_waitcnt lgkmcnt(2)
    v_mfma_f32_16x16x32_bf16 v[104:107], v[112:115], v[120:123], v[104:107]
    ds_read_b128 v[112:115], v66 offset:1216
    s_waitcnt lgkmcnt(2)
    v_mfma_f32_16x16x32_bf16 v[104:107], v[116:119], v[180:183], v[104:107]
    v_mfma_f32_16x16x32_bf16 v[100:103], v[116:119], v[176:179], v[100:103]
    v_mfma_f32_16x16x32_bf16 v[96:99], v[116:119], v[172:175], v[96:99]
    v_mfma_f32_16x16x32_bf16 v[92:95], v[116:119], v[168:171], v[92:95]
    v_mfma_f32_16x16x32_bf16 v[88:91], v[116:119], v[164:167], v[88:91]
    v_mfma_f32_16x16x32_bf16 v[84:87], v[116:119], v[160:163], v[84:87]
    v_mfma_f32_16x16x32_bf16 v[80:83], v[116:119], v[156:159], v[80:83]
    v_mfma_f32_16x16x32_bf16 v[76:79], v[116:119], v[152:155], v[76:79]
    ds_read_b128 v[116:119], v66 offset:1728
    s_waitcnt lgkmcnt(2)
    v_mfma_f32_16x16x32_bf16 v[104:107], v[108:111], v[176:179], v[104:107]
    v_mfma_f32_16x16x32_bf16 v[100:103], v[108:111], v[172:175], v[100:103]
    v_mfma_f32_16x16x32_bf16 v[96:99], v[108:111], v[168:171], v[96:99]
    v_mfma_f32_16x16x32_bf16 v[92:95], v[108:111], v[164:167], v[92:95]
    v_mfma_f32_16x16x32_bf16 v[88:91], v[108:111], v[160:163], v[88:91]
    v_mfma_f32_16x16x32_bf16 v[84:87], v[108:111], v[156:159], v[84:87]
    v_mfma_f32_16x16x32_bf16 v[80:83], v[108:111], v[152:155], v[80:83]
    ds_read_b128 v[108:111], v66 offset:2240
    s_waitcnt lgkmcnt(2)
    v_mfma_f32_16x16x32_bf16 v[104:107], v[112:115], v[172:175], v[104:107]
    v_mfma_f32_16x16x32_bf16 v[100:103], v[112:115], v[168:171], v[100:103]
    v_mfma_f32_16x16x32_bf16 v[96:99], v[112:115], v[164:167], v[96:99]
    v_mfma_f32_16x16x32_bf16 v[92:95], v[112:115], v[160:163], v[92:95]
    v_mfma_f32_16x16x32_bf16 v[88:91], v[112:115], v[156:159], v[88:91]
    v_mfma_f32_16x16x32_bf16 v[84:87], v[112:115], v[152:155], v[84:87]
    ds_read_b128 v[112:115], v66 offset:2752
    s_waitcnt lgkmcnt(2)
    v_mfma_f32_16x16x32_bf16 v[104:107], v[116:119], v[168:171], v[104:107]
    v_mfma_f32_16x16x32_bf16 v[100:103], v[116:119], v[164:167], v[100:103]
    v_mfma_f32_16x16x32_bf16 v[96:99], v[116:119], v[160:163], v[96:99]
    v_mfma_f32_16x16x32_bf16 v[92:95], v[116:119], v[156:159], v[92:95]
    v_mfma_f32_16x16x32_bf16 v[88:91], v[116:119], v[152:155], v[88:91]
    ds_read_b128 v[116:119], v66 offset:3264
    s_waitcnt lgkmcnt(2)
    v_mfma_f32_16x16x32_bf16 v[104:107], v[108:111], v[164:167], v[104:107]
    v_mfma_f32_16x16x32_bf16 v[100:103], v[108:111], v[160:163], v[100:103]
    v_mfma_f32_16x16x32_bf16 v[96:99], v[108:111], v[156:159], v[96:99]
    v_mfma_f32_16x16x32_bf16 v[92:95], v[108:111], v[152:155], v[92:95]
    ds_read_b128 v[108:111], v66 offset:3776
    s_waitcnt lgkmcnt(2)
    v_mfma_f32_16x16x32_bf16 v[104:107], v[112:115], v[160:163], v[104:107]
    v_mfma_f32_16x16x32_bf16 v[100:103], v[112:115], v[156:159], v[100:103]
    v_mfma_f32_16x16x32_bf16 v[96:99], v[112:115], v[152:155], v[96:99]
    s_waitcnt lgkmcnt(1)
    v_mfma_f32_16x16x32_bf16 v[104:107], v[116:119], v[156:159], v[104:107]
    v_mfma_f32_16x16x32_bf16 v[100:103], v[116:119], v[152:155], v[100:103]
    s_waitcnt lgkmcnt(0)
    v_mfma_f32_16x16x32_bf16 v[104:107], v[108:111], v[152:155], v[104:107]
    ds_write_b128 v74, v[76:79] offset:0
    ds_write_b128 v74, v[80:83] offset:1024
    ds_write_b128 v74, v[84:87] offset:2048
    ds_write_b128 v74, v[88:91] offset:3072
    ds_write_b128 v74, v[92:95] offset:4096
    ds_write_b128 v74, v[96:99] offset:5120
    ds_write_b128 v74, v[100:103] offset:6144
    s_nop 0
    ds_write_b128 v74, v[104:107] offset:7168
    s_branch c_pw_end_46
c_pw_48:
    s_cmp_lg_u32 s34, 2
    s_cbranch_scc1 c_pw_49
    ds_read_b128 v[108:111], v66 offset:256
    ds_read_b128 v[120:123], v67 offset:224
    ds_read_b128 v[124:127], v67 offset:736
    ds_read_b128 v[128:131], v67 offset:1248
    ds_read_b128 v[132:135], v67 offset:1760
    ds_read_b128 v[136:139], v67 offset:2272
    ds_read_b128 v[140:143], v67 offset:2784
    ds_read_b128 v[144:147], v67 offset:3296
    ds_read_b128 v[148:151], v67 offset:3808
    ds_read_b128 v[112:115], v66 offset:768
    ds_read_b128 v[116:119], v66 offset:1280
    s_waitcnt lgkmcnt(2)
    v_mfma_f32_16x16x32_bf16 v[104:107], v[108:111], v[148:151], 0
    v_mfma_f32_16x16x32_bf16 v[100:103], v[108:111], v[144:147], 0
    v_mfma_f32_16x16x32_bf16 v[96:99], v[108:111], v[140:143], 0
    v_mfma_f32_16x16x32_bf16 v[92:95], v[108:111], v[136:139], 0
    v_mfma_f32_16x16x32_bf16 v[88:91], v[108:111], v[132:135], 0
    v_mfma_f32_16x16x32_bf16 v[84:87], v[108:111], v[128:131], 0
    v_mfma_f32_16x16x32_bf16 v[80:83], v[108:111], v[124:127], 0
    v_mfma_f32_16x16x32_bf16 v[76:79], v[108:111], v[120:123], 0
    ds_read_b128 v[108:111], v66 offset:1792
    s_waitcnt lgkmcnt(2)
    v_mfma_f32_16x16x32_bf16 v[104:107], v[112:115], v[144:147], v[104:107]
    v_mfma_f32_16x16x32_bf16 v[100:103], v[112:115], v[140:143], v[100:103]
    v_mfma_f32_16x16x32_bf16 v[96:99], v[112:115], v[136:139], v[96:99]
    v_mfma_f32_16x16x32_bf16 v[92:95], v[112:115], v[132:135], v[92:95]
    v_mfma_f32_16x16x32_bf16 v[88:91], v[112:115], v[128:131], v[88:91]
    v_mfma_f32_16x16x32_bf16 v[84:87], v[112:115], v[124:127], v[84:87]
    v_mfma_f32_16x16x32_bf16 v[80:83], v[112:115], v[120:123], v[80:83]
    ds_read_b128 v[112:115], v66 offset:2304
    ds_read_b128 v[152:155], v67 offset:160
    ds_read_b128 v[156:159], v67 offset:672
    ds_read_b128 v[160:163], v67 offset:1184
    ds_read_b128 v[164:167], v67 offset:1696
    ds_read_b128 v[168:171], v67 offset:2208
    ds_read_b128 v[172:175], v67 offset:2720
    ds_read_b128 v[176:179], v67 offset:3232
    ds_read_b128 v[180:183], v67 offset:3744
    s_waitcnt lgkmcnt(10)
    v_mfma_f32_16x16x32_bf16 v[104:107], v[116:119], v[140:143], v[104:107]
    v_mfma_f32_16x16x32_bf16 v[100:103], v[116:119], v[136:139], v[100:103]
    v_mfma_f32_16x16x32_bf16 v[96:99], v[116:119], v[132:135], v[96:99]
    v_mfma_f32_16x16x32_bf16 v[92:95], v[116:119], v[128:131], v[92:95]
    v_mfma_f32_16x16x32_bf16 v[88:91], v[116:119], v[124:127], v[88:91]
    v_mfma_f32_16x16x32_bf16 v[84:87], v[116:119], v[120:123], v[84:87]
    ds_read_b128 v[116:119], v66 offset:2816
    s_waitcnt lgkmcnt(10)
    v_mfma_f32_16x16x32_bf16 v[104:107], v[108:111], v[136:139], v[104:107]
    v_mfma_f32_16x16x32_bf16 v[100:103], v[108:111], v[132:135], v[100:103]
    v_mfma_f32_16x16x32_bf16 v[96:99], v[108:111], v[128:131], v[96:99]
    v_mfma_f32_16x16x32_bf16 v[92:95], v[108:111], v[124:127], v[92:95]
    v_mfma_f32_16x16x32_bf16 v[88:91], v[108:111], v[120:123], v[88:91]
    ds_read_b128 v[108:111], v66 offset:3328
    s_waitcnt lgkmcnt(10)
    v_mfma_f32_16x16x32_bf16 v[104:107], v[112:115], v[132:135], v[104:107]
    v_mfma_f32_16x16x32_bf16 v[100:103], v[112:115], v[128:131], v[100:103]
    v_mfma_f32_16x16x32_bf16 v[96:99], v[112:115], v[124:127], v[96:99]
    v_mfma_f32_16x16x32_bf16 v[92:95], v[112:115], v[120:123], v[92:95]
    ds_read_b128 v[112:115], v66 offset:3840
    s_waitcnt lgkmcnt(2)
    v_mfma_f32_16x16x32_bf16 v[104:107], v[116:119], v[128:131], v[104:107]
    v_mfma_f32_16x16x32_bf16 v[100:103], v[116:119], v[124:127], v[100:103]
    v_mfma_f32_16x16x32_bf16 v[96:99], v[116:119], v[120:123], v[96:99]
    ds_read_b128 v[116:119], v66 offset:320
    s_waitcnt lgkmcnt(2)
    v_mfma_f32_16x16x32_bf16 v[104:107], v[108:111], v[124:127], v[104:107]
    v_mfma_f32_16x16x32_bf16 v[100:103], v[108:111], v[120:123], v[100:103]
    ds_read_b128 v[108:111], v66 offset:832
    s_waitcnt lgkmcnt(2)
    v_mfma_f32_16x16x32_bf16 v[104:107], v[112:115], v[120:123], v[104:107]
    ds_read_b128 v[112:115], v66 offset:1344
    s_waitcnt lgkmcnt(2)
    v_mfma_f32_16x16x32_bf16 v[104:107], v[116:119], v[180:183], v[104:107]
    v_mfma_f32_16x16x32_bf16 v[100:103], v[116:119], v[176:179], v[100:103]
    v_mfma_f32_16x16x32_bf16 v[96:99], v[116:119], v[172:175], v[96:99]
    v_mfma_f32_16x16x32_bf16 v[92:95], v[116:119], v[168:171], v[92:95]
    v_mfma_f32_16x16x32_bf16 v[88:91], v[116:119], v[164:167], v[88:91]
    v_mfma_f32_16x16x32_bf16 v[84:87], v[116:119], v[160:163], v[84:87]
    v_mfma_f32_16x16x32_bf16 v[80:83], v[116:119], v[156:159], v[80:83]
    v_mfma_f32_16x16x32_bf16 v[76:79], v[116:119], v[152:155], v[76:79]
    ds_read_b128 v[116:119], v66 offset:1856
    s_waitcnt lgkmcnt(2)
    v_mfma_f32_16x16x32_bf16 v[104:107], v[108:111], v[176:179], v[104:107]
    v_mfma_f32_16x16x32_bf16 v[100:103], v[108:111], v[172:175], v[100:103]
    v_mfma_f32_16x16x32_bf16 v[96:99], v[108:111], v[168:171], v[96:99]
    v_mfma_f32_16x16x32_bf16 v[92:95], v[108:111], v[164:167], v[92:95]
    v_mfma_f32_16x16x32_bf16 v[88:91], v[108:111], v[160:163], v[88:91]
    v_mfma_f32_16x16x32_bf16 v[84:87], v[108:111], v[156:159], v[84:87]
    v_mfma_f32_16x16x32_bf16 v[80:83], v[108:111], v[152:155], v[80:83]
    ds_read_b128 v[108:111], v66 offset:2368
    s_waitcnt lgkmcnt(2)
    v_mfma_f32_16x16x32_bf16 v[104:107], v[112:115], v[172:175], v[104:107]
    v_mfma_f32_16x16x32_bf16 v[100:103], v[112:115], v[168:171], v[100:103]
    v_mfma_f32_16x16x32_bf16 v[96:99], v[112:115], v[164:167], v[96:99]
    v_mfma_f32_16x16x32_bf16 v[92:95], v[112:115], v[160:163], v[92:95]
    v_mfma_f32_16x16x32_bf16 v[88:91], v[112:115], v[156:159], v[88:91]
    v_mfma_f32_16x16x32_bf16 v[84:87], v[112:115], v[152:155], v[84:87]
    ds_read_b128 v[112:115], v66 offset:2880
    s_waitcnt lgkmcnt(2)
    v_mfma_f32_16x16x32_bf16 v[104:107], v[116:119], v[168:171], v[104:107]
    v_mfma_f32_16x16x32_bf16 v[100:103], v[116:119], v[164:167], v[100:103]
    v_mfma_f32_16x16x32_bf16 v[96:99], v[116:119], v[160:163], v[96:99]
    v_mfma_f32_16x16x32_bf16 v[92:95], v[116:119], v[156:159], v[92:95]
    v_mfma_f32_16x16x32_bf16 v[88:91], v[116:119], v[152:155], v[88:91]
    ds_read_b128 v[116:119], v66 offset:3392
    s_waitcnt lgkmcnt(2)
    v_mfma_f32_16x16x32_bf16 v[104:107], v[108:111], v[164:167], v[104:107]
    v_mfma_f32_16x16x32_bf16 v[100:103], v[108:111], v[160:163], v[100:103]
    v_mfma_f32_16x16x32_bf16 v[96:99], v[108:111], v[156:159], v[96:99]
    v_mfma_f32_16x16x32_bf16 v[92:95], v[108:111], v[152:155], v[92:95]
    ds_read_b128 v[108:111], v66 offset:3904
    s_waitcnt lgkmcnt(2)
    v_mfma_f32_16x16x32_bf16 v[104:107], v[112:115], v[160:163], v[104:107]
    v_mfma_f32_16x16x32_bf16 v[100:103], v[112:115], v[156:159], v[100:103]
    v_mfma_f32_16x16x32_bf16 v[96:99], v[112:115], v[152:155], v[96:99]
    s_waitcnt lgkmcnt(1)
    v_mfma_f32_16x16x32_bf16 v[104:107], v[116:119], v[156:159], v[104:107]
    v_mfma_f32_16x16x32_bf16 v[100:103], v[116:119], v[152:155], v[100:103]
    s_waitcnt lgkmcnt(0)
    v_mfma_f32_16x16x32_bf16 v[104:107], v[108:111], v[152:155], v[104:107]
    ds_write_b128 v74, v[76:79] offset:0
    ds_write_b128 v74, v[80:83] offset:1024
    ds_write_b128 v74, v[84:87] offset:2048
    ds_write_b128 v74, v[88:91] offset:3072
    ds_write_b128 v74, v[92:95] offset:4096
    ds_write_b128 v74, v[96:99] offset:5120
    ds_write_b128 v74, v[100:103] offset:6144
    s_nop 0
    ds_write_b128 v74, v[104:107] offset:7168
    s_branch c_pw_end_46
c_pw_49:
    ds_read_b128 v[108:111], v66 offset:384
    ds_read_b128 v[120:123], v67 offset:96
    ds_read_b128 v[124:127], v67 offset:608
    ds_read_b128 v[128:131], v67 offset:1120
    ds_read_b128 v[132:135], v67 offset:1632
    ds_read_b128 v[136:139], v67 offset:2144
    ds_read_b128 v[140:143], v67 offset:2656
    ds_read_b128 v[144:147], v67 offset:3168
    ds_read_b128 v[148:151], v67 offset:3680
    ds_read_b128 v[112:115], v66 offset:896
    ds_read_b128 v[116:119], v66 offset:1408
    s_waitcnt lgkmcnt(2)
    v_mfma_f32_16x16x32_bf16 v[104:107], v[108:111], v[148:151], 0
    v_mfma_f32_16x16x32_bf16 v[100:103], v[108:111], v[144:147], 0
    v_mfma_f32_16x16x32_bf16 v[96:99], v[108:111], v[140:143], 0
    v_mfma_f32_16x16x32_bf16 v[92:95], v[108:111], v[136:139], 0
    v_mfma_f32_16x16x32_bf16 v[88:91], v[108:111], v[132:135], 0
    v_mfma_f32_16x16x32_bf16 v[84:87], v[108:111], v[128:131], 0
    v_mfma_f32_16x16x32_bf16 v[80:83], v[108:111], v[124:127], 0
    v_mfma_f32_16x16x32_bf16 v[76:79], v[108:111], v[120:123], 0
    ds_read_b128 v[108:111], v66 offset:1920
    s_waitcnt lgkmcnt(2)
    v_mfma_f32_16x16x32_bf16 v[104:107], v[112:115], v[144:147], v[104:107]
    v_mfma_f32_16x16x32_bf16 v[100:103], v[112:115], v[140:143], v[100:103]
    v_mfma_f32_16x16x32_bf16 v[96:99], v[112:115], v[136:139], v[96:99]
    v_mfma_f32_16x16x32_bf16 v[92:95], v[112:115], v[132:135], v[92:95]
    v_mfma_f32_16x16x32_bf16 v[88:91], v[112:115], v[128:131], v[88:91]
    v_mfma_f32_16x16x32_bf16 v[84:87], v[112:115], v[124:127], v[84:87]
    v_mfma_f32_16x16x32_bf16 v[80:83], v[112:115], v[120:123], v[80:83]
    ds_read_b128 v[112:115], v66 offset:2432
    ds_read_b128 v[152:155], v67 offset:32
    ds_read_b128 v[156:159], v67 offset:544
    ds_read_b128 v[160:163], v67 offset:1056
    ds_read_b128 v[164:167], v67 offset:1568
    ds_read_b128 v[168:171], v67 offset:2080
    ds_read_b128 v[172:175], v67 offset:2592
    ds_read_b128 v[176:179], v67 offset:3104
    ds_read_b128 v[180:183], v67 offset:3616
    s_waitcnt lgkmcnt(10)
    v_mfma_f32_16x16x32_bf16 v[104:107], v[116:119], v[140:143], v[104:107]
    v_mfma_f32_16x16x32_bf16 v[100:103], v[116:119], v[136:139], v[100:103]
    v_mfma_f32_16x16x32_bf16 v[96:99], v[116:119], v[132:135], v[96:99]
    v_mfma_f32_16x16x32_bf16 v[92:95], v[116:119], v[128:131], v[92:95]
    v_mfma_f32_16x16x32_bf16 v[88:91], v[116:119], v[124:127], v[88:91]
    v_mfma_f32_16x16x32_bf16 v[84:87], v[116:119], v[120:123], v[84:87]
    ds_read_b128 v[116:119], v66 offset:2944
    s_waitcnt lgkmcnt(10)
    v_mfma_f32_16x16x32_bf16 v[104:107], v[108:111], v[136:139], v[104:107]
    v_mfma_f32_16x16x32_bf16 v[100:103], v[108:111], v[132:135], v[100:103]
    v_mfma_f32_16x16x32_bf16 v[96:99], v[108:111], v[128:131], v[96:99]
    v_mfma_f32_16x16x32_bf16 v[92:95], v[108:111], v[124:127], v[92:95]
    v_mfma_f32_16x16x32_bf16 v[88:91], v[108:111], v[120:123], v[88:91]
    ds_read_b128 v[108:111], v66 offset:3456
    s_waitcnt lgkmcnt(10)
    v_mfma_f32_16x16x32_bf16 v[104:107], v[112:115], v[132:135], v[104:107]
    v_mfma_f32_16x16x32_bf16 v[100:103], v[112:115], v[128:131], v[100:103]
    v_mfma_f32_16x16x32_bf16 v[96:99], v[112:115], v[124:127], v[96:99]
    v_mfma_f32_16x16x32_bf16 v[92:95], v[112:115], v[120:123], v[92:95]
    ds_read_b128 v[112:115], v66 offset:3968
    s_waitcnt lgkmcnt(2)
    v_mfma_f32_16x16x32_bf16 v[104:107], v[116:119], v[128:131], v[104:107]
    v_mfma_f32_16x16x32_bf16 v[100:103], v[116:119], v[124:127], v[100:103]
    v_mfma_f32_16x16x32_bf16 v[96:99], v[116:119], v[120:123], v[96:99]
    ds_read_b128 v[116:119], v66 offset:448
    s_waitcnt lgkmcnt(2)
    v_mfma_f32_16x16x32_bf16 v[104:107], v[108:111], v[124:127], v[104:107]
    v_mfma_f32_16x16x32_bf16 v[100:103], v[108:111], v[120:123], v[100:103]
    ds_read_b128 v[108:111], v66 offset:960
    s_waitcnt lgkmcnt(2)
    v_mfma_f32_16x16x32_bf16 v[104:107], v[112:115], v[120:123], v[104:107]
    ds_read_b128 v[112:115], v66 offset:1472
    s_waitcnt lgkmcnt(2)
    v_mfma_f32_16x16x32_bf16 v[104:107], v[116:119], v[180:183], v[104:107]
    v_mfma_f32_16x16x32_bf16 v[100:103], v[116:119], v[176:179], v[100:103]
    v_mfma_f32_16x16x32_bf16 v[96:99], v[116:119], v[172:175], v[96:99]
    v_mfma_f32_16x16x32_bf16 v[92:95], v[116:119], v[168:171], v[92:95]
    v_mfma_f32_16x16x32_bf16 v[88:91], v[116:119], v[164:167], v[88:91]
    v_mfma_f32_16x16x32_bf16 v[84:87], v[116:119], v[160:163], v[84:87]
    v_mfma_f32_16x16x32_bf16 v[80:83], v[116:119], v[156:159], v[80:83]
    v_mfma_f32_16x16x32_bf16 v[76:79], v[116:119], v[152:155], v[76:79]
    ds_read_b128 v[116:119], v66 offset:1984
    s_waitcnt lgkmcnt(2)
    v_mfma_f32_16x16x32_bf16 v[104:107], v[108:111], v[176:179], v[104:107]
    v_mfma_f32_16x16x32_bf16 v[100:103], v[108:111], v[172:175], v[100:103]
    v_mfma_f32_16x16x32_bf16 v[96:99], v[108:111], v[168:171], v[96:99]
    v_mfma_f32_16x16x32_bf16 v[92:95], v[108:111], v[164:167], v[92:95]
    v_mfma_f32_16x16x32_bf16 v[88:91], v[108:111], v[160:163], v[88:91]
    v_mfma_f32_16x16x32_bf16 v[84:87], v[108:111], v[156:159], v[84:87]
    v_mfma_f32_16x16x32_bf16 v[80:83], v[108:111], v[152:155], v[80:83]
    ds_read_b128 v[108:111], v66 offset:2496
    s_waitcnt lgkmcnt(2)
    v_mfma_f32_16x16x32_bf16 v[104:107], v[112:115], v[172:175], v[104:107]
    v_mfma_f32_16x16x32_bf16 v[100:103], v[112:115], v[168:171], v[100:103]
    v_mfma_f32_16x16x32_bf16 v[96:99], v[112:115], v[164:167], v[96:99]
    v_mfma_f32_16x16x32_bf16 v[92:95], v[112:115], v[160:163], v[92:95]
    v_mfma_f32_16x16x32_bf16 v[88:91], v[112:115], v[156:159], v[88:91]
    v_mfma_f32_16x16x32_bf16 v[84:87], v[112:115], v[152:155], v[84:87]
    ds_read_b128 v[112:115], v66 offset:3008
    s_waitcnt lgkmcnt(2)
    v_mfma_f32_16x16x32_bf16 v[104:107], v[116:119], v[168:171], v[104:107]
    v_mfma_f32_16x16x32_bf16 v[100:103], v[116:119], v[164:167], v[100:103]
    v_mfma_f32_16x16x32_bf16 v[96:99], v[116:119], v[160:163], v[96:99]
    v_mfma_f32_16x16x32_bf16 v[92:95], v[116:119], v[156:159], v[92:95]
    v_mfma_f32_16x16x32_bf16 v[88:91], v[116:119], v[152:155], v[88:91]
    ds_read_b128 v[116:119], v66 offset:3520
    s_waitcnt lgkmcnt(2)
    v_mfma_f32_16x16x32_bf16 v[104:107], v[108:111], v[164:167], v[104:107]
    v_mfma_f32_16x16x32_bf16 v[100:103], v[108:111], v[160:163], v[100:103]
    v_mfma_f32_16x16x32_bf16 v[96:99], v[108:111], v[156:159], v[96:99]
    v_mfma_f32_16x16x32_bf16 v[92:95], v[108:111], v[152:155], v[92:95]
    ds_read_b128 v[108:111], v66 offset:4032
    s_waitcnt lgkmcnt(2)
    v_mfma_f32_16x16x32_bf16 v[104:107], v[112:115], v[160:163], v[104:107]
    v_mfma_f32_16x16x32_bf16 v[100:103], v[112:115], v[156:159], v[100:103]
    v_mfma_f32_16x16x32_bf16 v[96:99], v[112:115], v[152:155], v[96:99]
    s_waitcnt lgkmcnt(1)
    v_mfma_f32_16x16x32_bf16 v[104:107], v[116:119], v[156:159], v[104:107]
    v_mfma_f32_16x16x32_bf16 v[100:103], v[116:119], v[152:155], v[100:103]
    s_waitcnt lgkmcnt(0)
    v_mfma_f32_16x16x32_bf16 v[104:107], v[108:111], v[152:155], v[104:107]
    ds_write_b128 v74, v[76:79] offset:0
    ds_write_b128 v74, v[80:83] offset:1024
    ds_write_b128 v74, v[84:87] offset:2048
    ds_write_b128 v74, v[88:91] offset:3072
    ds_write_b128 v74, v[92:95] offset:4096
    ds_write_b128 v74, v[96:99] offset:5120
    ds_write_b128 v74, v[100:103] offset:6144
    s_nop 0
    ds_write_b128 v74, v[104:107] offset:7168
c_pw_end_46:
    s_waitcnt vmcnt(0)
    s_waitcnt lgkmcnt(0)
    v_mov_b32 v3, 161796
    v_mov_b32 v4, 1
    s_mov_b64 exec, 1
    ds_add_u32 v3, v4
    s_mov_b64 exec, -1
    s_mov_b32 s67, 0
gsync_51:
    ds_read_b32 v4, v3
    s_add_u32 s67, s67, 1
    s_waitcnt lgkmcnt(0)
    v_readfirstlane_b32 s66, v4
    s_cmp_gt_u32 s67, 1000000
    s_cbranch_scc1 gsync_e_52
    s_cmp_lt_u32 s66, 16
    s_cbranch_scc1 gsync_51
gsync_e_52:
    s_lshl_b32 s40, s2, 3
    s_add_u32 s40, s40, 14725120
    v_mov_b32 v48, s100
    v_mov_b32 v49, s101
    v_mov_b32 v3, 0
    s_cmp_eq_u32 s34, 0
    s_cselect_b64 exec, 1, 0
    s_cmp_lt_u32 s2, 192
    s_cselect_b64 exec, exec, 0
    buffer_store_dwordx2 v[48:49], v3, s[8:11], s40 offen sc1
    s_mov_b64 exec, -1
    ds_read_b128 v[120:123], v75 offset:0
    ds_read_b128 v[124:127], v75 offset:16
    ds_read_b128 v[128:131], v75 offset:8192
    ds_read_b128 v[132:135], v75 offset:8208
    ds_read_b128 v[136:139], v75 offset:16384
    ds_read_b128 v[140:143], v75 offset:16400
    ds_read_b128 v[144:147], v75 offset:24576
    ds_read_b128 v[148:151], v75 offset:24592
    s_lshl_b32 s40, s57, 12
    s_add_u32 s40, s40, 8912896
    s_waitcnt lgkmcnt(0)
    v_pk_add_f32 v[120:121], v[120:121], v[128:129]
    v_pk_add_f32 v[136:137], v[136:137], v[144:145]
    v_pk_add_f32 v[122:123], v[122:123], v[130:131]
    v_pk_add_f32 v[138:139], v[138:139], v[146:147]
    v_pk_add_f32 v[124:125], v[124:125], v[132:133]
    v_pk_add_f32 v[140:141], v[140:141], v[148:149]
    v_pk_add_f32 v[126:127], v[126:127], v[134:135]
    v_pk_add_f32 v[142:143], v[142:143], v[150:151]
    v_pk_add_f32 v[120:121], v[120:121], v[136:137]
    v_pk_add_f32 v[122:123], v[122:123], v[138:139]
    v_pk_add_f32 v[124:125], v[124:125], v[140:141]
    v_pk_add_f32 v[126:127], v[126:127], v[142:143]
    v_cvt_pk_bf16_f32 v192, v120, v121
    v_cvt_pk_bf16_f32 v193, v122, v123
    v_cvt_pk_bf16_f32 v194, v124, v125
    v_cvt_pk_bf16_f32 v195, v126, v127
    buffer_store_dwordx4 v[192:195], v2, s[8:11], s40 offen sc1
    s_nop 1
    s_waitcnt vmcnt(0)
    v_cmp_ne_u32 vcc, 0, v0
    s_nop 1
    v_cndmask_b32 v24, 0, v24, vcc
    v_cndmask_b32 v25, 0, v25, vcc
    v_cndmask_b32 v26, 0, v26, vcc
    v_cndmask_b32 v27, 0, v27, vcc
    v_alignbit_b32 v184, v25, v24, 16
    v_alignbit_b32 v185, v26, v25, 16
    v_alignbit_b32 v186, v27, v26, 16
    v_alignbit_b32 v187, v28, v27, 16
    v_alignbit_b32 v188, v29, v28, 16
    v_alignbit_b32 v189, v30, v29, 16
    v_alignbit_b32 v190, v31, v30, 16
    ds_write_b128 v64, v[184:187] offset:0
    v_mov_b32 v192, v25
    v_mov_b32 v193, v26
    v_mov_b32 v194, v27
    v_mov_b32 v195, v28
    ds_write_b128 v64, v[192:195] offset:4160
    s_nop 1
    v_mov_b32 v192, v185
    v_mov_b32 v193, v186
    v_mov_b32 v194, v187
    v_mov_b32 v195, v188
    ds_write_b128 v64, v[192:195] offset:8320
    s_nop 1
    ds_write_b128 v64, v[26:29] offset:12480
    ds_write_b128 v64, v[186:189] offset:16640
    v_mov_b32 v192, v27
    v_mov_b32 v193, v28
    v_mov_b32 v194, v29
    v_mov_b32 v195, v30
    ds_write_b128 v64, v[192:195] offset:20800
    s_nop 1
    v_mov_b32 v192, v187
    v_mov_b32 v193, v188
    v_mov_b32 v194, v189
    v_mov_b32 v195, v190
    ds_write_b128 v64, v[192:195] offset:24960
    s_nop 1
    ds_write_b128 v64, v[28:31] offset:29120
    ds_write_b128 v65, v[40:43]
    v_lshlrev_b32 v3, 16, v46
    v_or_b32 v3, v3, v46
    v_and_b32 v196, v68, v3
    v_and_b32 v197, v69, v3
    v_and_b32 v198, v70, v3
    v_and_b32 v199, v71, v3
    s_waitcnt lgkmcnt(0)
    v_mov_b32 v3, 161796
    v_mov_b32 v4, 1
    s_mov_b64 exec, 1
    ds_add_u32 v3, v4
    s_mov_b64 exec, -1
    s_mov_b32 s67, 0
gsync_53:
    ds_read_b32 v4, v3
    s_add_u32 s67, s67, 1
    s_waitcnt lgkmcnt(0)
    v_readfirstlane_b32 s66, v4
    s_cmp_gt_u32 s67, 1000000
    s_cbranch_scc1 gsync_e_54
    s_cmp_lt_u32 s66, 20
    s_cbranch_scc1 gsync_53
gsync_e_54:
    s_bitcmp1_b32 s2, 0
    s_cbranch_scc1 c_halfB_55
    s_cmp_lg_u32 s34, 0
    s_cbranch_scc1 c_pw_58
    ds_read_b128 v[108:111], v66 offset:0
    ds_read_b128 v[120:123], v67 offset:480
    ds_read_b128 v[124:127], v67 offset:992
    ds_read_b128 v[128:131], v67 offset:1504
    ds_read_b128 v[132:135], v67 offset:2016
    ds_read_b128 v[136:139], v67 offset:2528
    ds_read_b128 v[140:143], v67 offset:3040
    ds_read_b128 v[144:147], v67 offset:3552
    ds_read_b128 v[148:151], v67 offset:4064
    ds_read_b128 v[112:115], v66 offset:512
    ds_read_b128 v[116:119], v66 offset:1024
    s_waitcnt lgkmcnt(2)
    v_mfma_f32_16x16x32_bf16 v[104:107], v[108:111], v[148:151], 0
    v_mfma_f32_16x16x32_bf16 v[100:103], v[108:111], v[144:147], 0
    v_mfma_f32_16x16x32_bf16 v[84:87], v[108:111], v[128:131], 0
    v_mfma_f32_16x16x32_bf16 v[84:87], v[196:199], v[128:131], v[84:87]
    v_mfma_f32_16x16x32_bf16 v[100:103], v[196:199], v[144:147], v[100:103]
    v_mfma_f32_16x16x32_bf16 v[104:107], v[196:199], v[148:151], v[104:107]
    ds_read_b128 v[108:111], v66 offset:1536
    s_waitcnt lgkmcnt(2)
    v_mfma_f32_16x16x32_bf16 v[104:107], v[112:115], v[144:147], v[104:107]
    v_mfma_f32_16x16x32_bf16 v[100:103], v[112:115], v[140:143], v[100:103]
    v_mfma_f32_16x16x32_bf16 v[84:87], v[112:115], v[124:127], v[84:87]
    ds_read_b128 v[112:115], v66 offset:2048
    ds_read_b128 v[152:155], v67 offset:416
    ds_read_b128 v[156:159], v67 offset:928
    ds_read_b128 v[160:163], v67 offset:1440
    ds_read_b128 v[164:167], v67 offset:1952
    ds_read_b128 v[168:171], v67 offset:2464
    ds_read_b128 v[172:175], v67 offset:2976
    ds_read_b128 v[176:179], v67 offset:3488
    ds_read_b128 v[180:183], v67 offset:4000
    s_waitcnt lgkmcnt(10)
    v_mfma_f32_16x16x32_bf16 v[104:107], v[116:119], v[140:143], v[104:107]
    v_mfma_f32_16x16x32_bf16 v[100:103], v[116:119], v[136:139], v[100:103]
    v_mfma_f32_16x16x32_bf16 v[84:87], v[116:119], v[120:123], v[84:87]
    ds_read_b128 v[116:119], v66 offset:2560
    s_waitcnt lgkmcnt(10)
    v_mfma_f32_16x16x32_bf16 v[104:107], v[108:111], v[136:139], v[104:107]
    v_mfma_f32_16x16x32_bf16 v[100:103], v[108:111], v[132:135], v[100:103]
    ds_read_b128 v[108:111], v66 offset:3072
    s_waitcnt lgkmcnt(10)
    v_mfma_f32_16x16x32_bf16 v[104:107], v[112:115], v[132:135], v[104:107]
    v_mfma_f32_16x16x32_bf16 v[100:103], v[112:115], v[128:131], v[100:103]
    ds_read_b128 v[112:115], v66 offset:3584
    s_waitcnt lgkmcnt(2)
    v_mfma_f32_16x16x32_bf16 v[104:107], v[116:119], v[128:131], v[104:107]
    v_mfma_f32_16x16x32_bf16 v[100:103], v[116:119], v[124:127], v[100:103]
    ds_read_b128 v[116:119], v66 offset:64
    s_waitcnt lgkmcnt(2)
    v_mfma_f32_16x16x32_bf16 v[104:107], v[108:111], v[124:127], v[104:107]
    v_mfma_f32_16x16x32_bf16 v[100:103], v[108:111], v[120:123], v[100:103]
    ds_read_b128 v[108:111], v66 offset:576
    s_waitcnt lgkmcnt(2)
    v_mfma_f32_16x16x32_bf16 v[104:107], v[112:115], v[120:123], v[104:107]
    ds_read_b128 v[112:115], v66 offset:1088
    s_waitcnt lgkmcnt(2)
    v_mfma_f32_16x16x32_bf16 v[104:107], v[116:119], v[180:183], v[104:107]
    v_mfma_f32_16x16x32_bf16 v[100:103], v[116:119], v[176:179], v[100:103]
    v_mfma_f32_16x16x32_bf16 v[84:87], v[116:119], v[160:163], v[84:87]
    ds_read_b128 v[116:119], v66 offset:1600
    s_waitcnt lgkmcnt(2)
    v_mfma_f32_16x16x32_bf16 v[104:107], v[108:111], v[176:179], v[104:107]
    v_mfma_f32_16x16x32_bf16 v[100:103], v[108:111], v[172:175], v[100:103]
    v_mfma_f32_16x16x32_bf16 v[84:87], v[108:111], v[156:159], v[84:87]
    ds_read_b128 v[108:111], v66 offset:2112
    s_waitcnt lgkmcnt(2)
    v_mfma_f32_16x16x32_bf16 v[104:107], v[112:115], v[172:175], v[104:107]
    v_mfma_f32_16x16x32_bf16 v[100:103], v[112:115], v[168:171], v[100:103]
    v_mfma_f32_16x16x32_bf16 v[84:87], v[112:115], v[152:155], v[84:87]
    ds_read_b128 v[112:115], v66 offset:2624
    s_waitcnt lgkmcnt(2)
    v_mfma_f32_16x16x32_bf16 v[104:107], v[116:119], v[168:171], v[104:107]
    v_mfma_f32_16x16x32_bf16 v[100:103], v[116:119], v[164:167], v[100:103]
    ds_read_b128 v[116:119], v66 offset:3136
    s_waitcnt lgkmcnt(2)
    v_mfma_f32_16x16x32_bf16 v[104:107], v[108:111], v[164:167], v[104:107]
    v_mfma_f32_16x16x32_bf16 v[100:103], v[108:111], v[160:163], v[100:103]
    ds_read_b128 v[108:111], v66 offset:3648
    s_waitcnt lgkmcnt(2)
    v_mfma_f32_16x16x32_bf16 v[104:107], v[112:115], v[160:163], v[104:107]
    v_mfma_f32_16x16x32_bf16 v[100:103], v[112:115], v[156:159], v[100:103]
    s_waitcnt lgkmcnt(1)
    v_mfma_f32_16x16x32_bf16 v[104:107], v[116:119], v[156:159], v[104:107]
    v_mfma_f32_16x16x32_bf16 v[100:103], v[116:119], v[152:155], v[100:103]
    s_waitcnt lgkmcnt(0)
    v_mfma_f32_16x16x32_bf16 v[104:107], v[108:111], v[152:155], v[104:107]
    ds_write_b128 v74, v[84:87] offset:2048
    s_nop 4
    ds_write_b128 v74, v[100:103] offset:6144
    s_nop 0
    ds_write_b128 v74, v[104:107] offset:7168
    s_branch c_pw_end_57
c_pw_58:
    s_cmp_lg_u32 s34, 1
    s_cbranch_scc1 c_pw_59
    ds_read_b128 v[108:111], v66 offset:128
    ds_read_b128 v[120:123], v67 offset:352
    ds_read_b128 v[124:127], v67 offset:864
    ds_read_b128 v[128:131], v67 offset:1376
    ds_read_b128 v[132:135], v67 offset:1888
    ds_read_b128 v[136:139], v67 offset:2400
    ds_read_b128 v[140:143], v67 offset:2912
    ds_read_b128 v[144:147], v67 offset:3424
    ds_read_b128 v[148:151], v67 offset:3936
    ds_read_b128 v[112:115], v66 offset:640
    ds_read_b128 v[116:119], v66 offset:1152
    s_waitcnt lgkmcnt(2)
    v_mfma_f32_16x16x32_bf16 v[104:107], v[108:111], v[148:151], 0
    v_mfma_f32_16x16x32_bf16 v[100:103], v[108:111], v[144:147], 0
    v_mfma_f32_16x16x32_bf16 v[84:87], v[108:111], v[128:131], 0
    ds_read_b128 v[108:111], v66 offset:1664
    s_waitcnt lgkmcnt(2)
    v_mfma_f32_16x16x32_bf16 v[104:107], v[112:115], v[144:147], v[104:107]
    v_mfma_f32_16x16x32_bf16 v[100:103], v[112:115], v[140:143], v[100:103]
    v_mfma_f32_16x16x32_bf16 v[84:87], v[112:115], v[124:127], v[84:87]
    ds_read_b128 v[112:115], v66 offset:2176
    ds_read_b128 v[152:155], v67 offset:288
    ds_read_b128 v[156:159], v67 offset:800
    ds_read_b128 v[160:163], v67 offset:1312
    ds_read_b128 v[164:167], v67 offset:1824
    ds_read_b128 v[168:171], v67 offset:2336
    ds_read_b128 v[172:175], v67 offset:2848
    ds_read_b128 v[176:179], v67 offset:3360
    ds_read_b128 v[180:183], v67 offset:3872
    s_waitcnt lgkmcnt(10)
    v_mfma_f32_16x16x32_bf16 v[104:107], v[116:119], v[140:143], v[104:107]
    v_mfma_f32_16x16x32_bf16 v[100:103], v[116:119], v[136:139], v[100:103]
    v_mfma_f32_16x16x32_bf16 v[84:87], v[116:119], v[120:123], v[84:87]
    ds_read_b128 v[116:119], v66 offset:2688
    s_waitcnt lgkmcnt(10)
    v_mfma_f32_16x16x32_bf16 v[104:107], v[108:111], v[136:139], v[104:107]
    v_mfma_f32_16x16x32_bf16 v[100:103], v[108:111], v[132:135], v[100:103]
    ds_read_b128 v[108:111], v66 offset:3200
    s_waitcnt lgkmcnt(10)
    v_mfma_f32_16x16x32_bf16 v[104:107], v[112:115], v[132:135], v[104:107]
    v_mfma_f32_16x16x32_bf16 v[100:103], v[112:115], v[128:131], v[100:103]
    ds_read_b128 v[112:115], v66 offset:3712
    s_waitcnt lgkmcnt(2)
    v_mfma_f32_16x16x32_bf16 v[104:107], v[116:119], v[128:131], v[104:107]
    v_mfma_f32_16x16x32_bf16 v[100:103], v[116:119], v[124:127], v[100:103]
    ds_read_b128 v[116:119], v66 offset:192
    s_waitcnt lgkmcnt(2)
    v_mfma_f32_16x16x32_bf16 v[104:107], v[108:111], v[124:127], v[104:107]
    v_mfma_f32_16x16x32_bf16 v[100:103], v[108:111], v[120:123], v[100:103]
    ds_read_b128 v[108:111], v66 offset:704
    s_waitcnt lgkmcnt(2)
    v_mfma_f32_16x16x32_bf16 v[104:107], v[112:115], v[120:123], v[104:107]
    ds_read_b128 v[112:115], v66 offset:1216
    s_waitcnt lgkmcnt(2)
    v_mfma_f32_16x16x32_bf16 v[104:107], v[116:119], v[180:183], v[104:107]
    v_mfma_f32_16x16x32_bf16 v[100:103], v[116:119], v[176:179], v[100:103]
    v_mfma_f32_16x16x32_bf16 v[84:87], v[116:119], v[160:163], v[84:87]
    ds_read_b128 v[116:119], v66 offset:1728
    s_waitcnt lgkmcnt(2)
    v_mfma_f32_16x16x32_bf16 v[104:107], v[108:111], v[176:179], v[104:107]
    v_mfma_f32_16x16x32_bf16 v[100:103], v[108:111], v[172:175], v[100:103]
    v_mfma_f32_16x16x32_bf16 v[84:87], v[108:111], v[156:159], v[84:87]
    ds_read_b128 v[108:111], v66 offset:2240
    s_waitcnt lgkmcnt(2)
    v_mfma_f32_16x16x32_bf16 v[104:107], v[112:115], v[172:175], v[104:107]
    v_mfma_f32_16x16x32_bf16 v[100:103], v[112:115], v[168:171], v[100:103]
    v_mfma_f32_16x16x32_bf16 v[84:87], v[112:115], v[152:155], v[84:87]
    ds_read_b128 v[112:115], v66 offset:2752
    s_waitcnt lgkmcnt(2)
    v_mfma_f32_16x16x32_bf16 v[104:107], v[116:119], v[168:171], v[104:107]
    v_mfma_f32_16x16x32_bf16 v[100:103], v[116:119], v[164:167], v[100:103]
    ds_read_b128 v[116:119], v66 offset:3264
    s_waitcnt lgkmcnt(2)
    v_mfma_f32_16x16x32_bf16 v[104:107], v[108:111], v[164:167], v[104:107]
    v_mfma_f32_16x16x32_bf16 v[100:103], v[108:111], v[160:163], v[100:103]
    ds_read_b128 v[108:111], v66 offset:3776
    s_waitcnt lgkmcnt(2)
    v_mfma_f32_16x16x32_bf16 v[104:107], v[112:115], v[160:163], v[104:107]
    v_mfma_f32_16x16x32_bf16 v[100:103], v[112:115], v[156:159], v[100:103]
    s_waitcnt lgkmcnt(1)
    v_mfma_f32_16x16x32_bf16 v[104:107], v[116:119], v[156:159], v[104:107]
    v_mfma_f32_16x16x32_bf16 v[100:103], v[116:119], v[152:155], v[100:103]
    s_waitcnt lgkmcnt(0)
    v_mfma_f32_16x16x32_bf16 v[104:107], v[108:111], v[152:155], v[104:107]
    ds_write_b128 v74, v[84:87] offset:2048
    s_nop 4
    ds_write_b128 v74, v[100:103] offset:6144
    s_nop 0
    ds_write_b128 v74, v[104:107] offset:7168
    s_branch c_pw_end_57
c_pw_59:
    s_cmp_lg_u32 s34, 2
    s_cbranch_scc1 c_pw_60
    ds_read_b128 v[108:111], v66 offset:256
    ds_read_b128 v[120:123], v67 offset:224
    ds_read_b128 v[124:127], v67 offset:736
    ds_read_b128 v[128:131], v67 offset:1248
    ds_read_b128 v[132:135], v67 offset:1760
    ds_read_b128 v[136:139], v67 offset:2272
    ds_read_b128 v[140:143], v67 offset:2784
    ds_read_b128 v[144:147], v67 offset:3296
    ds_read_b128 v[148:151], v67 offset:3808
    ds_read_b128 v[112:115], v66 offset:768
    ds_read_b128 v[116:119], v66 offset:1280
    s_waitcnt lgkmcnt(2)
    v_mfma_f32_16x16x32_bf16 v[104:107], v[108:111], v[148:151], 0
    v_mfma_f32_16x16x32_bf16 v[100:103], v[108:111], v[144:147], 0
    v_mfma_f32_16x16x32_bf16 v[84:87], v[108:111], v[128:131], 0
    ds_read_b128 v[108:111], v66 offset:1792
    s_waitcnt lgkmcnt(2)
    v_mfma_f32_16x16x32_bf16 v[104:107], v[112:115], v[144:147], v[104:107]
    v_mfma_f32_16x16x32_bf16 v[100:103], v[112:115], v[140:143], v[100:103]
    v_mfma_f32_16x16x32_bf16 v[84:87], v[112:115], v[124:127], v[84:87]
    ds_read_b128 v[112:115], v66 offset:2304
    ds_read_b128 v[152:155], v67 offset:160
    ds_read_b128 v[156:159], v67 offset:672
    ds_read_b128 v[160:163], v67 offset:1184
    ds_read_b128 v[164:167], v67 offset:1696
    ds_read_b128 v[168:171], v67 offset:2208
    ds_read_b128 v[172:175], v67 offset:2720
    ds_read_b128 v[176:179], v67 offset:3232
    ds_read_b128 v[180:183], v67 offset:3744
    s_waitcnt lgkmcnt(10)
    v_mfma_f32_16x16x32_bf16 v[104:107], v[116:119], v[140:143], v[104:107]
    v_mfma_f32_16x16x32_bf16 v[100:103], v[116:119], v[136:139], v[100:103]
    v_mfma_f32_16x16x32_bf16 v[84:87], v[116:119], v[120:123], v[84:87]
    ds_read_b128 v[116:119], v66 offset:2816
    s_waitcnt lgkmcnt(10)
    v_mfma_f32_16x16x32_bf16 v[104:107], v[108:111], v[136:139], v[104:107]
    v_mfma_f32_16x16x32_bf16 v[100:103], v[108:111], v[132:135], v[100:103]
    ds_read_b128 v[108:111], v66 offset:3328
    s_waitcnt lgkmcnt(10)
    v_mfma_f32_16x16x32_bf16 v[104:107], v[112:115], v[132:135], v[104:107]
    v_mfma_f32_16x16x32_bf16 v[100:103], v[112:115], v[128:131], v[100:103]
    ds_read_b128 v[112:115], v66 offset:3840
    s_waitcnt lgkmcnt(2)
    v_mfma_f32_16x16x32_bf16 v[104:107], v[116:119], v[128:131], v[104:107]
    v_mfma_f32_16x16x32_bf16 v[100:103], v[116:119], v[124:127], v[100:103]
    ds_read_b128 v[116:119], v66 offset:320
    s_waitcnt lgkmcnt(2)
    v_mfma_f32_16x16x32_bf16 v[104:107], v[108:111], v[124:127], v[104:107]
    v_mfma_f32_16x16x32_bf16 v[100:103], v[108:111], v[120:123], v[100:103]
    ds_read_b128 v[108:111], v66 offset:832
    s_waitcnt lgkmcnt(2)
    v_mfma_f32_16x16x32_bf16 v[104:107], v[112:115], v[120:123], v[104:107]
    ds_read_b128 v[112:115], v66 offset:1344
    s_waitcnt lgkmcnt(2)
    v_mfma_f32_16x16x32_bf16 v[104:107], v[116:119], v[180:183], v[104:107]
    v_mfma_f32_16x16x32_bf16 v[100:103], v[116:119], v[176:179], v[100:103]
    v_mfma_f32_16x16x32_bf16 v[84:87], v[116:119], v[160:163], v[84:87]
    ds_read_b128 v[116:119], v66 offset:1856
    s_waitcnt lgkmcnt(2)
    v_mfma_f32_16x16x32_bf16 v[104:107], v[108:111], v[176:179], v[104:107]
    v_mfma_f32_16x16x32_bf16 v[100:103], v[108:111], v[172:175], v[100:103]
    v_mfma_f32_16x16x32_bf16 v[84:87], v[108:111], v[156:159], v[84:87]
    ds_read_b128 v[108:111], v66 offset:2368
    s_waitcnt lgkmcnt(2)
    v_mfma_f32_16x16x32_bf16 v[104:107], v[112:115], v[172:175], v[104:107]
    v_mfma_f32_16x16x32_bf16 v[100:103], v[112:115], v[168:171], v[100:103]
    v_mfma_f32_16x16x32_bf16 v[84:87], v[112:115], v[152:155], v[84:87]
    ds_read_b128 v[112:115], v66 offset:2880
    s_waitcnt lgkmcnt(2)
    v_mfma_f32_16x16x32_bf16 v[104:107], v[116:119], v[168:171], v[104:107]
    v_mfma_f32_16x16x32_bf16 v[100:103], v[116:119], v[164:167], v[100:103]
    ds_read_b128 v[116:119], v66 offset:3392
    s_waitcnt lgkmcnt(2)
    v_mfma_f32_16x16x32_bf16 v[104:107], v[108:111], v[164:167], v[104:107]
    v_mfma_f32_16x16x32_bf16 v[100:103], v[108:111], v[160:163], v[100:103]
    ds_read_b128 v[108:111], v66 offset:3904
    s_waitcnt lgkmcnt(2)
    v_mfma_f32_16x16x32_bf16 v[104:107], v[112:115], v[160:163], v[104:107]
    v_mfma_f32_16x16x32_bf16 v[100:103], v[112:115], v[156:159], v[100:103]
    s_waitcnt lgkmcnt(1)
    v_mfma_f32_16x16x32_bf16 v[104:107], v[116:119], v[156:159], v[104:107]
    v_mfma_f32_16x16x32_bf16 v[100:103], v[116:119], v[152:155], v[100:103]
    s_waitcnt lgkmcnt(0)
    v_mfma_f32_16x16x32_bf16 v[104:107], v[108:111], v[152:155], v[104:107]
    ds_write_b128 v74, v[84:87] offset:2048
    s_nop 4
    ds_write_b128 v74, v[100:103] offset:6144
    s_nop 0
    ds_write_b128 v74, v[104:107] offset:7168
    s_branch c_pw_end_57
c_pw_60:
    ds_read_b128 v[108:111], v66 offset:384
    ds_read_b128 v[120:123], v67 offset:96
    ds_read_b128 v[124:127], v67 offset:608
    ds_read_b128 v[128:131], v67 offset:1120
    ds_read_b128 v[132:135], v67 offset:1632
    ds_read_b128 v[136:139], v67 offset:2144
    ds_read_b128 v[140:143], v67 offset:2656
    ds_read_b128 v[144:147], v67 offset:3168
    ds_read_b128 v[148:151], v67 offset:3680
    ds_read_b128 v[112:115], v66 offset:896
    ds_read_b128 v[116:119], v66 offset:1408
    s_waitcnt lgkmcnt(2)
    v_mfma_f32_16x16x32_bf16 v[104:107], v[108:111], v[148:151], 0
    v_mfma_f32_16x16x32_bf16 v[100:103], v[108:111], v[144:147], 0
    v_mfma_f32_16x16x32_bf16 v[84:87], v[108:111], v[128:131], 0
    ds_read_b128 v[108:111], v66 offset:1920
    s_waitcnt lgkmcnt(2)
    v_mfma_f32_16x16x32_bf16 v[104:107], v[112:115], v[144:147], v[104:107]
    v_mfma_f32_16x16x32_bf16 v[100:103], v[112:115], v[140:143], v[100:103]
    v_mfma_f32_16x16x32_bf16 v[84:87], v[112:115], v[124:127], v[84:87]
    ds_read_b128 v[112:115], v66 offset:2432
    ds_read_b128 v[152:155], v67 offset:32
    ds_read_b128 v[156:159], v67 offset:544
    ds_read_b128 v[160:163], v67 offset:1056
    ds_read_b128 v[164:167], v67 offset:1568
    ds_read_b128 v[168:171], v67 offset:2080
    ds_read_b128 v[172:175], v67 offset:2592
    ds_read_b128 v[176:179], v67 offset:3104
    ds_read_b128 v[180:183], v67 offset:3616
    s_waitcnt lgkmcnt(10)
    v_mfma_f32_16x16x32_bf16 v[104:107], v[116:119], v[140:143], v[104:107]
    v_mfma_f32_16x16x32_bf16 v[100:103], v[116:119], v[136:139], v[100:103]
    v_mfma_f32_16x16x32_bf16 v[84:87], v[116:119], v[120:123], v[84:87]
    ds_read_b128 v[116:119], v66 offset:2944
    s_waitcnt lgkmcnt(10)
    v_mfma_f32_16x16x32_bf16 v[104:107], v[108:111], v[136:139], v[104:107]
    v_mfma_f32_16x16x32_bf16 v[100:103], v[108:111], v[132:135], v[100:103]
    ds_read_b128 v[108:111], v66 offset:3456
    s_waitcnt lgkmcnt(10)
    v_mfma_f32_16x16x32_bf16 v[104:107], v[112:115], v[132:135], v[104:107]
    v_mfma_f32_16x16x32_bf16 v[100:103], v[112:115], v[128:131], v[100:103]
    ds_read_b128 v[112:115], v66 offset:3968
    s_waitcnt lgkmcnt(2)
    v_mfma_f32_16x16x32_bf16 v[104:107], v[116:119], v[128:131], v[104:107]
    v_mfma_f32_16x16x32_bf16 v[100:103], v[116:119], v[124:127], v[100:103]
    ds_read_b128 v[116:119], v66 offset:448
    s_waitcnt lgkmcnt(2)
    v_mfma_f32_16x16x32_bf16 v[104:107], v[108:111], v[124:127], v[104:107]
    v_mfma_f32_16x16x32_bf16 v[100:103], v[108:111], v[120:123], v[100:103]
    ds_read_b128 v[108:111], v66 offset:960
    s_waitcnt lgkmcnt(2)
    v_mfma_f32_16x16x32_bf16 v[104:107], v[112:115], v[120:123], v[104:107]
    ds_read_b128 v[112:115], v66 offset:1472
    s_waitcnt lgkmcnt(2)
    v_mfma_f32_16x16x32_bf16 v[104:107], v[116:119], v[180:183], v[104:107]
    v_mfma_f32_16x16x32_bf16 v[100:103], v[116:119], v[176:179], v[100:103]
    v_mfma_f32_16x16x32_bf16 v[84:87], v[116:119], v[160:163], v[84:87]
    ds_read_b128 v[116:119], v66 offset:1984
    s_waitcnt lgkmcnt(2)
    v_mfma_f32_16x16x32_bf16 v[104:107], v[108:111], v[176:179], v[104:107]
    v_mfma_f32_16x16x32_bf16 v[100:103], v[108:111], v[172:175], v[100:103]
    v_mfma_f32_16x16x32_bf16 v[84:87], v[108:111], v[156:159], v[84:87]
    ds_read_b128 v[108:111], v66 offset:2496
    s_waitcnt lgkmcnt(2)
    v_mfma_f32_16x16x32_bf16 v[104:107], v[112:115], v[172:175], v[104:107]
    v_mfma_f32_16x16x32_bf16 v[100:103], v[112:115], v[168:171], v[100:103]
    v_mfma_f32_16x16x32_bf16 v[84:87], v[112:115], v[152:155], v[84:87]
    ds_read_b128 v[112:115], v66 offset:3008
    s_waitcnt lgkmcnt(2)
    v_mfma_f32_16x16x32_bf16 v[104:107], v[116:119], v[168:171], v[104:107]
    v_mfma_f32_16x16x32_bf16 v[100:103], v[116:119], v[164:167], v[100:103]
    ds_read_b128 v[116:119], v66 offset:3520
    s_waitcnt lgkmcnt(2)
    v_mfma_f32_16x16x32_bf16 v[104:107], v[108:111], v[164:167], v[104:107]
    v_mfma_f32_16x16x32_bf16 v[100:103], v[108:111], v[160:163], v[100:103]
    ds_read_b128 v[108:111], v66 offset:4032
    s_waitcnt lgkmcnt(2)
    v_mfma_f32_16x16x32_bf16 v[104:107], v[112:115], v[160:163], v[104:107]
    v_mfma_f32_16x16x32_bf16 v[100:103], v[112:115], v[156:159], v[100:103]
    s_waitcnt lgkmcnt(1)
    v_mfma_f32_16x16x32_bf16 v[104:107], v[116:119], v[156:159], v[104:107]
    v_mfma_f32_16x16x32_bf16 v[100:103], v[116:119], v[152:155], v[100:103]
    s_waitcnt lgkmcnt(0)
    v_mfma_f32_16x16x32_bf16 v[104:107], v[108:111], v[152:155], v[104:107]
    ds_write_b128 v74, v[84:87] offset:2048
    s_nop 4
    ds_write_b128 v74, v[100:103] offset:6144
    s_nop 0
    ds_write_b128 v74, v[104:107] offset:7168
c_pw_end_57:
    s_waitcnt lgkmcnt(0)
    v_mov_b32 v3, 161796
    v_mov_b32 v4, 1
    s_mov_b64 exec, 1
    ds_add_u32 v3, v4
    s_mov_b64 exec, -1
    s_mov_b32 s67, 0
gsync_62:
    ds_read_b32 v4, v3
    s_add_u32 s67, s67, 1
    s_waitcnt lgkmcnt(0)
    v_readfirstlane_b32 s66, v4
    s_cmp_gt_u32 s67, 1000000
    s_cbranch_scc1 gsync_e_63
    s_cmp_lt_u32 s66, 24
    s_cbranch_scc1 gsync_62
gsync_e_63:
    s_mov_b64 exec, 0
    s_cmp_eq_u32 s34, 0
    s_cselect_b32 exec_lo, 0, exec_lo
    s_cselect_b32 exec_hi, 0, exec_hi
    s_cmp_eq_u32 s34, 1
    s_cselect_b32 exec_lo, -1, exec_lo
    s_cselect_b32 exec_hi, 0, exec_hi
    s_cmp_eq_u32 s34, 2
    s_cselect_b32 exec_lo, 0, exec_lo
    s_cselect_b32 exec_hi, 0, exec_hi
    s_cmp_eq_u32 s34, 3
    s_cselect_b32 exec_lo, -1, exec_lo
    s_cselect_b32 exec_hi, -1, exec_hi
    s_cbranch_execz c_fskip_65
    ds_read_b128 v[120:123], v75 offset:0
    ds_read_b128 v[124:127], v75 offset:16
    ds_read_b128 v[128:131], v75 offset:8192
    ds_read_b128 v[132:135], v75 offset:8208
    ds_read_b128 v[136:139], v75 offset:16384
    ds_read_b128 v[140:143], v75 offset:16400
    ds_read_b128 v[144:147], v75 offset:24576
    ds_read_b128 v[148:151], v75 offset:24592
    s_lshl_b32 s40, s58, 12
    s_add_u32 s40, s40, 8912896
    s_waitcnt lgkmcnt(0)
    v_pk_add_f32 v[120:121], v[120:121], v[128:129]
    v_pk_add_f32 v[136:137], v[136:137], v[144:145]
    v_pk_add_f32 v[122:123], v[122:123], v[130:131]
    v_pk_add_f32 v[138:139], v[138:139], v[146:147]
    v_pk_add_f32 v[124:125], v[124:125], v[132:133]
    v_pk_add_f32 v[140:141], v[140:141], v[148:149]
    v_pk_add_f32 v[126:127], v[126:127], v[134:135]
    v_pk_add_f32 v[142:143], v[142:143], v[150:151]
    v_pk_add_f32 v[120:121], v[120:121], v[136:137]
    v_pk_add_f32 v[122:123], v[122:123], v[138:139]
    v_pk_add_f32 v[124:125], v[124:125], v[140:141]
    v_pk_add_f32 v[126:127], v[126:127], v[142:143]
    v_cvt_pk_bf16_f32 v192, v120, v121
    v_cvt_pk_bf16_f32 v193, v122, v123
    v_cvt_pk_bf16_f32 v194, v124, v125
    v_cvt_pk_bf16_f32 v195, v126, v127
    buffer_store_dwordx4 v[192:195], v2, s[8:11], s40 offen sc1
c_fskip_65:
    s_mov_b64 exec, -1
    s_nop 1
    s_branch c_halfE_56
c_halfB_55:
    s_cmp_lg_u32 s34, 0
    s_cbranch_scc1 c_pw_67
    ds_read_b128 v[108:111], v66 offset:0
    ds_read_b128 v[120:123], v67 offset:480
    ds_read_b128 v[124:127], v67 offset:992
    ds_read_b128 v[128:131], v67 offset:1504
    ds_read_b128 v[132:135], v67 offset:2016
    ds_read_b128 v[136:139], v67 offset:2528
    ds_read_b128 v[140:143], v67 offset:3040
    ds_read_b128 v[112:115], v66 offset:512
    ds_read_b128 v[116:119], v66 offset:1024
    s_waitcnt lgkmcnt(2)
    v_mfma_f32_16x16x32_bf16 v[96:99], v[108:111], v[140:143], 0
    v_mfma_f32_16x16x32_bf16 v[92:95], v[108:111], v[136:139], 0
    v_mfma_f32_16x16x32_bf16 v[88:91], v[108:111], v[132:135], 0
    v_mfma_f32_16x16x32_bf16 v[80:83], v[108:111], v[124:127], 0
    v_mfma_f32_16x16x32_bf16 v[76:79], v[108:111], v[120:123], 0
    v_mfma_f32_16x16x32_bf16 v[76:79], v[196:199], v[120:123], v[76:79]
    v_mfma_f32_16x16x32_bf16 v[80:83], v[196:199], v[124:127], v[80:83]
    v_mfma_f32_16x16x32_bf16 v[88:91], v[196:199], v[132:135], v[88:91]
    v_mfma_f32_16x16x32_bf16 v[92:95], v[196:199], v[136:139], v[92:95]
    v_mfma_f32_16x16x32_bf16 v[96:99], v[196:199], v[140:143], v[96:99]
    ds_read_b128 v[108:111], v66 offset:1536
    s_waitcnt lgkmcnt(2)
    v_mfma_f32_16x16x32_bf16 v[96:99], v[112:115], v[136:139], v[96:99]
    v_mfma_f32_16x16x32_bf16 v[92:95], v[112:115], v[132:135], v[92:95]
    v_mfma_f32_16x16x32_bf16 v[88:91], v[112:115], v[128:131], v[88:91]
    v_mfma_f32_16x16x32_bf16 v[80:83], v[112:115], v[120:123], v[80:83]
    ds_read_b128 v[112:115], v66 offset:2048
    ds_read_b128 v[152:155], v67 offset:416
    ds_read_b128 v[156:159], v67 offset:928
    ds_read_b128 v[160:163], v67 offset:1440
    ds_read_b128 v[164:167], v67 offset:1952
    ds_read_b128 v[168:171], v67 offset:2464
    ds_read_b128 v[172:175], v67 offset:2976
    s_waitcnt lgkmcnt(8)
    v_mfma_f32_16x16x32_bf16 v[96:99], v[116:119], v[132:135], v[96:99]
    v_mfma_f32_16x16x32_bf16 v[92:95], v[116:119], v[128:131], v[92:95]
    v_mfma_f32_16x16x32_bf16 v[88:91], v[116:119], v[124:127], v[88:91]
    ds_read_b128 v[116:119], v66 offset:2560
    s_waitcnt lgkmcnt(8)
    v_mfma_f32_16x16x32_bf16 v[96:99], v[108:111], v[128:131], v[96:99]
    v_mfma_f32_16x16x32_bf16 v[92:95], v[108:111], v[124:127], v[92:95]
    v_mfma_f32_16x16x32_bf16 v[88:91], v[108:111], v[120:123], v[88:91]
    ds_read_b128 v[108:111], v66 offset:64
    s_waitcnt lgkmcnt(8)
    v_mfma_f32_16x16x32_bf16 v[96:99], v[112:115], v[124:127], v[96:99]
    v_mfma_f32_16x16x32_bf16 v[92:95], v[112:115], v[120:123], v[92:95]
    ds_read_b128 v[112:115], v66 offset:576
    s_waitcnt lgkmcnt(2)
    v_mfma_f32_16x16x32_bf16 v[96:99], v[116:119], v[120:123], v[96:99]
    ds_read_b128 v[116:119], v66 offset:1088
    s_waitcnt lgkmcnt(2)
    v_mfma_f32_16x16x32_bf16 v[96:99], v[108:111], v[172:175], v[96:99]
    v_mfma_f32_16x16x32_bf16 v[92:95], v[108:111], v[168:171], v[92:95]
    v_mfma_f32_16x16x32_bf16 v[88:91], v[108:111], v[164:167], v[88:91]
    v_mfma_f32_16x16x32_bf16 v[80:83], v[108:111], v[156:159], v[80:83]
    v_mfma_f32_16x16x32_bf16 v[76:79], v[108:111], v[152:155], v[76:79]
    ds_read_b128 v[108:111], v66 offset:1600
    s_waitcnt lgkmcnt(2)
    v_mfma_f32_16x16x32_bf16 v[96:99], v[112:115], v[168:171], v[96:99]
    v_mfma_f32_16x16x32_bf16 v[92:95], v[112:115], v[164:167], v[92:95]
    v_mfma_f32_16x16x32_bf16 v[88:91], v[112:115], v[160:163], v[88:91]
    v_mfma_f32_16x16x32_bf16 v[80:83], v[112:115], v[152:155], v[80:83]
    ds_read_b128 v[112:115], v66 offset:2112
    s_waitcnt lgkmcnt(2)
    v_mfma_f32_16x16x32_bf16 v[96:99], v[116:119], v[164:167], v[96:99]
    v_mfma_f32_16x16x32_bf16 v[92:95], v[116:119], v[160:163], v[92:95]
    v_mfma_f32_16x16x32_bf16 v[88:91], v[116:119], v[156:159], v[88:91]
    ds_read_b128 v[116:119], v66 offset:2624
    s_waitcnt lgkmcnt(2)
    v_mfma_f32_16x16x32_bf16 v[96:99], v[108:111], v[160:163], v[96:99]
    v_mfma_f32_16x16x32_bf16 v[92:95], v[108:111], v[156:159], v[92:95]
    v_mfma_f32_16x16x32_bf16 v[88:91], v[108:111], v[152:155], v[88:91]
    s_waitcnt lgkmcnt(1)
    v_mfma_f32_16x16x32_bf16 v[96:99], v[112:115], v[156:159], v[96:99]
    v_mfma_f32_16x16x32_bf16 v[92:95], v[112:115], v[152:155], v[92:95]
    s_waitcnt lgkmcnt(0)
    v_mfma_f32_16x16x32_bf16 v[96:99], v[116:119], v[152:155], v[96:99]
    ds_write_b128 v74, v[76:79] offset:0
    ds_write_b128 v74, v[80:83] offset:1024
    s_nop 0
    ds_write_b128 v74, v[88:91] offset:3072
    s_nop 1
    ds_write_b128 v74, v[92:95] offset:4096
    s_nop 0
    ds_write_b128 v74, v[96:99] offset:5120
    s_branch c_pw_end_66
c_pw_67:
    s_cmp_lg_u32 s34, 1
    s_cbranch_scc1 c_pw_68
    ds_read_b128 v[108:111], v66 offset:128
    ds_read_b128 v[120:123], v67 offset:352
    ds_read_b128 v[124:127], v67 offset:864
    ds_read_b128 v[128:131], v67 offset:1376
    ds_read_b128 v[132:135], v67 offset:1888
    ds_read_b128 v[136:139], v67 offset:2400
    ds_read_b128 v[140:143], v67 offset:2912
    ds_read_b128 v[112:115], v66 offset:640
    ds_read_b128 v[116:119], v66 offset:1152
    s_waitcnt lgkmcnt(2)
    v_mfma_f32_16x16x32_bf16 v[96:99], v[108:111], v[140:143], 0
    v_mfma_f32_16x16x32_bf16 v[92:95], v[108:111], v[136:139], 0
    v_mfma_f32_16x16x32_bf16 v[88:91], v[108:111], v[132:135], 0
    v_mfma_f32_16x16x32_bf16 v[80:83], v[108:111], v[124:127], 0
    v_mfma_f32_16x16x32_bf16 v[76:79], v[108:111], v[120:123], 0
    ds_read_b128 v[108:111], v66 offset:1664
    s_waitcnt lgkmcnt(2)
    v_mfma_f32_16x16x32_bf16 v[96:99], v[112:115], v[136:139], v[96:99]
    v_mfma_f32_16x16x32_bf16 v[92:95], v[112:115], v[132:135], v[92:95]
    v_mfma_f32_16x16x32_bf16 v[88:91], v[112:115], v[128:131], v[88:91]
    v_mfma_f32_16x16x32_bf16 v[80:83], v[112:115], v[120:123], v[80:83]
    ds_read_b128 v[112:115], v66 offset:2176
    ds_read_b128 v[152:155], v67 offset:288
    ds_read_b128 v[156:159], v67 offset:800
    ds_read_b128 v[160:163], v67 offset:1312
    ds_read_b128 v[164:167], v67 offset:1824
    ds_read_b128 v[168:171], v67 offset:2336
    ds_read_b128 v[172:175], v67 offset:2848
    s_waitcnt lgkmcnt(8)
    v_mfma_f32_16x16x32_bf16 v[96:99], v[116:119], v[132:135], v[96:99]
    v_mfma_f32_16x16x32_bf16 v[92:95], v[116:119], v[128:131], v[92:95]
    v_mfma_f32_16x16x32_bf16 v[88:91], v[116:119], v[124:127], v[88:91]
    ds_read_b128 v[116:119], v66 offset:2688
    s_waitcnt lgkmcnt(8)
    v_mfma_f32_16x16x32_bf16 v[96:99], v[108:111], v[128:131], v[96:99]
    v_mfma_f32_16x16x32_bf16 v[92:95], v[108:111], v[124:127], v[92:95]
    v_mfma_f32_16x16x32_bf16 v[88:91], v[108:111], v[120:123], v[88:91]
    ds_read_b128 v[108:111], v66 offset:192
    s_waitcnt lgkmcnt(8)
    v_mfma_f32_16x16x32_bf16 v[96:99], v[112:115], v[124:127], v[96:99]
    v_mfma_f32_16x16x32_bf16 v[92:95], v[112:115], v[120:123], v[92:95]
    ds_read_b128 v[112:115], v66 offset:704
    s_waitcnt lgkmcnt(2)
    v_mfma_f32_16x16x32_bf16 v[96:99], v[116:119], v[120:123], v[96:99]
    ds_read_b128 v[116:119], v66 offset:1216
    s_waitcnt lgkmcnt(2)
    v_mfma_f32_16x16x32_bf16 v[96:99], v[108:111], v[172:175], v[96:99]
    v_mfma_f32_16x16x32_bf16 v[92:95], v[108:111], v[168:171], v[92:95]
    v_mfma_f32_16x16x32_bf16 v[88:91], v[108:111], v[164:167], v[88:91]
    v_mfma_f32_16x16x32_bf16 v[80:83], v[108:111], v[156:159], v[80:83]
    v_mfma_f32_16x16x32_bf16 v[76:79], v[108:111], v[152:155], v[76:79]
    ds_read_b128 v[108:111], v66 offset:1728
    s_waitcnt lgkmcnt(2)
    v_mfma_f32_16x16x32_bf16 v[96:99], v[112:115], v[168:171], v[96:99]
    v_mfma_f32_16x16x32_bf16 v[92:95], v[112:115], v[164:167], v[92:95]
    v_mfma_f32_16x16x32_bf16 v[88:91], v[112:115], v[160:163], v[88:91]
    v_mfma_f32_16x16x32_bf16 v[80:83], v[112:115], v[152:155], v[80:83]
    ds_read_b128 v[112:115], v66 offset:2240
    s_waitcnt lgkmcnt(2)
    v_mfma_f32_16x16x32_bf16 v[96:99], v[116:119], v[164:167], v[96:99]
    v_mfma_f32_16x16x32_bf16 v[92:95], v[116:119], v[160:163], v[92:95]
    v_mfma_f32_16x16x32_bf16 v[88:91], v[116:119], v[156:159], v[88:91]
    ds_read_b128 v[116:119], v66 offset:2752
    s_waitcnt lgkmcnt(2)
    v_mfma_f32_16x16x32_bf16 v[96:99], v[108:111], v[160:163], v[96:99]
    v_mfma_f32_16x16x32_bf16 v[92:95], v[108:111], v[156:159], v[92:95]
    v_mfma_f32_16x16x32_bf16 v[88:91], v[108:111], v[152:155], v[88:91]
    s_waitcnt lgkmcnt(1)
    v_mfma_f32_16x16x32_bf16 v[96:99], v[112:115], v[156:159], v[96:99]
    v_mfma_f32_16x16x32_bf16 v[92:95], v[112:115], v[152:155], v[92:95]
    s_waitcnt lgkmcnt(0)
    v_mfma_f32_16x16x32_bf16 v[96:99], v[116:119], v[152:155], v[96:99]
    ds_write_b128 v74, v[76:79] offset:0
    ds_write_b128 v74, v[80:83] offset:1024
    s_nop 0
    ds_write_b128 v74, v[88:91] offset:3072
    s_nop 1
    ds_write_b128 v74, v[92:95] offset:4096
    s_nop 0
    ds_write_b128 v74, v[96:99] offset:5120
    s_branch c_pw_end_66
c_pw_68:
    s_cmp_lg_u32 s34, 2
    s_cbranch_scc1 c_pw_69
    ds_read_b128 v[108:111], v66 offset:256
    ds_read_b128 v[120:123], v67 offset:224
    ds_read_b128 v[124:127], v67 offset:736
    ds_read_b128 v[128:131], v67 offset:1248
    ds_read_b128 v[132:135], v67 offset:1760
    ds_read_b128 v[136:139], v67 offset:2272
    ds_read_b128 v[140:143], v67 offset:2784
    ds_read_b128 v[112:115], v66 offset:768
    ds_read_b128 v[116:119], v66 offset:1280
    s_waitcnt lgkmcnt(2)
    v_mfma_f32_16x16x32_bf16 v[96:99], v[108:111], v[140:143], 0
    v_mfma_f32_16x16x32_bf16 v[92:95], v[108:111], v[136:139], 0
    v_mfma_f32_16x16x32_bf16 v[88:91], v[108:111], v[132:135], 0
    v_mfma_f32_16x16x32_bf16 v[80:83], v[108:111], v[124:127], 0
    v_mfma_f32_16x16x32_bf16 v[76:79], v[108:111], v[120:123], 0
    ds_read_b128 v[108:111], v66 offset:1792
    s_waitcnt lgkmcnt(2)
    v_mfma_f32_16x16x32_bf16 v[96:99], v[112:115], v[136:139], v[96:99]
    v_mfma_f32_16x16x32_bf16 v[92:95], v[112:115], v[132:135], v[92:95]
    v_mfma_f32_16x16x32_bf16 v[88:91], v[112:115], v[128:131], v[88:91]
    v_mfma_f32_16x16x32_bf16 v[80:83], v[112:115], v[120:123], v[80:83]
    ds_read_b128 v[112:115], v66 offset:2304
    ds_read_b128 v[152:155], v67 offset:160
    ds_read_b128 v[156:159], v67 offset:672
    ds_read_b128 v[160:163], v67 offset:1184
    ds_read_b128 v[164:167], v67 offset:1696
    ds_read_b128 v[168:171], v67 offset:2208
    ds_read_b128 v[172:175], v67 offset:2720
    s_waitcnt lgkmcnt(8)
    v_mfma_f32_16x16x32_bf16 v[96:99], v[116:119], v[132:135], v[96:99]
    v_mfma_f32_16x16x32_bf16 v[92:95], v[116:119], v[128:131], v[92:95]
    v_mfma_f32_16x16x32_bf16 v[88:91], v[116:119], v[124:127], v[88:91]
    ds_read_b128 v[116:119], v66 offset:2816
    s_waitcnt lgkmcnt(8)
    v_mfma_f32_16x16x32_bf16 v[96:99], v[108:111], v[128:131], v[96:99]
    v_mfma_f32_16x16x32_bf16 v[92:95], v[108:111], v[124:127], v[92:95]
    v_mfma_f32_16x16x32_bf16 v[88:91], v[108:111], v[120:123], v[88:91]
    ds_read_b128 v[108:111], v66 offset:320
    s_waitcnt lgkmcnt(8)
    v_mfma_f32_16x16x32_bf16 v[96:99], v[112:115], v[124:127], v[96:99]
    v_mfma_f32_16x16x32_bf16 v[92:95], v[112:115], v[120:123], v[92:95]
    ds_read_b128 v[112:115], v66 offset:832
    s_waitcnt lgkmcnt(2)
    v_mfma_f32_16x16x32_bf16 v[96:99], v[116:119], v[120:123], v[96:99]
    ds_read_b128 v[116:119], v66 offset:1344
    s_waitcnt lgkmcnt(2)
    v_mfma_f32_16x16x32_bf16 v[96:99], v[108:111], v[172:175], v[96:99]
    v_mfma_f32_16x16x32_bf16 v[92:95], v[108:111], v[168:171], v[92:95]
    v_mfma_f32_16x16x32_bf16 v[88:91], v[108:111], v[164:167], v[88:91]
    v_mfma_f32_16x16x32_bf16 v[80:83], v[108:111], v[156:159], v[80:83]
    v_mfma_f32_16x16x32_bf16 v[76:79], v[108:111], v[152:155], v[76:79]
    ds_read_b128 v[108:111], v66 offset:1856
    s_waitcnt lgkmcnt(2)
    v_mfma_f32_16x16x32_bf16 v[96:99], v[112:115], v[168:171], v[96:99]
    v_mfma_f32_16x16x32_bf16 v[92:95], v[112:115], v[164:167], v[92:95]
    v_mfma_f32_16x16x32_bf16 v[88:91], v[112:115], v[160:163], v[88:91]
    v_mfma_f32_16x16x32_bf16 v[80:83], v[112:115], v[152:155], v[80:83]
    ds_read_b128 v[112:115], v66 offset:2368
    s_waitcnt lgkmcnt(2)
    v_mfma_f32_16x16x32_bf16 v[96:99], v[116:119], v[164:167], v[96:99]
    v_mfma_f32_16x16x32_bf16 v[92:95], v[116:119], v[160:163], v[92:95]
    v_mfma_f32_16x16x32_bf16 v[88:91], v[116:119], v[156:159], v[88:91]
    ds_read_b128 v[116:119], v66 offset:2880
    s_waitcnt lgkmcnt(2)
    v_mfma_f32_16x16x32_bf16 v[96:99], v[108:111], v[160:163], v[96:99]
    v_mfma_f32_16x16x32_bf16 v[92:95], v[108:111], v[156:159], v[92:95]
    v_mfma_f32_16x16x32_bf16 v[88:91], v[108:111], v[152:155], v[88:91]
    s_waitcnt lgkmcnt(1)
    v_mfma_f32_16x16x32_bf16 v[96:99], v[112:115], v[156:159], v[96:99]
    v_mfma_f32_16x16x32_bf16 v[92:95], v[112:115], v[152:155], v[92:95]
    s_waitcnt lgkmcnt(0)
    v_mfma_f32_16x16x32_bf16 v[96:99], v[116:119], v[152:155], v[96:99]
    ds_write_b128 v74, v[76:79] offset:0
    ds_write_b128 v74, v[80:83] offset:1024
    s_nop 0
    ds_write_b128 v74, v[88:91] offset:3072
    s_nop 1
    ds_write_b128 v74, v[92:95] offset:4096
    s_nop 0
    ds_write_b128 v74, v[96:99] offset:5120
    s_branch c_pw_end_66
c_pw_69:
    ds_read_b128 v[108:111], v66 offset:384
    ds_read_b128 v[120:123], v67 offset:96
    ds_read_b128 v[124:127], v67 offset:608
    ds_read_b128 v[128:131], v67 offset:1120
    ds_read_b128 v[132:135], v67 offset:1632
    ds_read_b128 v[136:139], v67 offset:2144
    ds_read_b128 v[140:143], v67 offset:2656
    ds_read_b128 v[112:115], v66 offset:896
    ds_read_b128 v[116:119], v66 offset:1408
    s_waitcnt lgkmcnt(2)
    v_mfma_f32_16x16x32_bf16 v[96:99], v[108:111], v[140:143], 0
    v_mfma_f32_16x16x32_bf16 v[92:95], v[108:111], v[136:139], 0
    v_mfma_f32_16x16x32_bf16 v[88:91], v[108:111], v[132:135], 0
    v_mfma_f32_16x16x32_bf16 v[80:83], v[108:111], v[124:127], 0
    v_mfma_f32_16x16x32_bf16 v[76:79], v[108:111], v[120:123], 0
    ds_read_b128 v[108:111], v66 offset:1920
    s_waitcnt lgkmcnt(2)
    v_mfma_f32_16x16x32_bf16 v[96:99], v[112:115], v[136:139], v[96:99]
    v_mfma_f32_16x16x32_bf16 v[92:95], v[112:115], v[132:135], v[92:95]
    v_mfma_f32_16x16x32_bf16 v[88:91], v[112:115], v[128:131], v[88:91]
    v_mfma_f32_16x16x32_bf16 v[80:83], v[112:115], v[120:123], v[80:83]
    ds_read_b128 v[112:115], v66 offset:2432
    ds_read_b128 v[152:155], v67 offset:32
    ds_read_b128 v[156:159], v67 offset:544
    ds_read_b128 v[160:163], v67 offset:1056
    ds_read_b128 v[164:167], v67 offset:1568
    ds_read_b128 v[168:171], v67 offset:2080
    ds_read_b128 v[172:175], v67 offset:2592
    s_waitcnt lgkmcnt(8)
    v_mfma_f32_16x16x32_bf16 v[96:99], v[116:119], v[132:135], v[96:99]
    v_mfma_f32_16x16x32_bf16 v[92:95], v[116:119], v[128:131], v[92:95]
    v_mfma_f32_16x16x32_bf16 v[88:91], v[116:119], v[124:127], v[88:91]
    ds_read_b128 v[116:119], v66 offset:2944
    s_waitcnt lgkmcnt(8)
    v_mfma_f32_16x16x32_bf16 v[96:99], v[108:111], v[128:131], v[96:99]
    v_mfma_f32_16x16x32_bf16 v[92:95], v[108:111], v[124:127], v[92:95]
    v_mfma_f32_16x16x32_bf16 v[88:91], v[108:111], v[120:123], v[88:91]
    ds_read_b128 v[108:111], v66 offset:448
    s_waitcnt lgkmcnt(8)
    v_mfma_f32_16x16x32_bf16 v[96:99], v[112:115], v[124:127], v[96:99]
    v_mfma_f32_16x16x32_bf16 v[92:95], v[112:115], v[120:123], v[92:95]
    ds_read_b128 v[112:115], v66 offset:960
    s_waitcnt lgkmcnt(2)
    v_mfma_f32_16x16x32_bf16 v[96:99], v[116:119], v[120:123], v[96:99]
    ds_read_b128 v[116:119], v66 offset:1472
    s_waitcnt lgkmcnt(2)
    v_mfma_f32_16x16x32_bf16 v[96:99], v[108:111], v[172:175], v[96:99]
    v_mfma_f32_16x16x32_bf16 v[92:95], v[108:111], v[168:171], v[92:95]
    v_mfma_f32_16x16x32_bf16 v[88:91], v[108:111], v[164:167], v[88:91]
    v_mfma_f32_16x16x32_bf16 v[80:83], v[108:111], v[156:159], v[80:83]
    v_mfma_f32_16x16x32_bf16 v[76:79], v[108:111], v[152:155], v[76:79]
    ds_read_b128 v[108:111], v66 offset:1984
    s_waitcnt lgkmcnt(2)
    v_mfma_f32_16x16x32_bf16 v[96:99], v[112:115], v[168:171], v[96:99]
    v_mfma_f32_16x16x32_bf16 v[92:95], v[112:115], v[164:167], v[92:95]
    v_mfma_f32_16x16x32_bf16 v[88:91], v[112:115], v[160:163], v[88:91]
    v_mfma_f32_16x16x32_bf16 v[80:83], v[112:115], v[152:155], v[80:83]
    ds_read_b128 v[112:115], v66 offset:2496
    s_waitcnt lgkmcnt(2)
    v_mfma_f32_16x16x32_bf16 v[96:99], v[116:119], v[164:167], v[96:99]
    v_mfma_f32_16x16x32_bf16 v[92:95], v[116:119], v[160:163], v[92:95]
    v_mfma_f32_16x16x32_bf16 v[88:91], v[116:119], v[156:159], v[88:91]
    ds_read_b128 v[116:119], v66 offset:3008
    s_waitcnt lgkmcnt(2)
    v_mfma_f32_16x16x32_bf16 v[96:99], v[108:111], v[160:163], v[96:99]
    v_mfma_f32_16x16x32_bf16 v[92:95], v[108:111], v[156:159], v[92:95]
    v_mfma_f32_16x16x32_bf16 v[88:91], v[108:111], v[152:155], v[88:91]
    s_waitcnt lgkmcnt(1)
    v_mfma_f32_16x16x32_bf16 v[96:99], v[112:115], v[156:159], v[96:99]
    v_mfma_f32_16x16x32_bf16 v[92:95], v[112:115], v[152:155], v[92:95]
    s_waitcnt lgkmcnt(0)
    v_mfma_f32_16x16x32_bf16 v[96:99], v[116:119], v[152:155], v[96:99]
    ds_write_b128 v74, v[76:79] offset:0
    ds_write_b128 v74, v[80:83] offset:1024
    s_nop 0
    ds_write_b128 v74, v[88:91] offset:3072
    s_nop 1
    ds_write_b128 v74, v[92:95] offset:4096
    s_nop 0
    ds_write_b128 v74, v[96:99] offset:5120
c_pw_end_66:
    s_waitcnt lgkmcnt(0)
    v_mov_b32 v3, 161796
    v_mov_b32 v4, 1
    s_mov_b64 exec, 1
    ds_add_u32 v3, v4
    s_mov_b64 exec, -1
    s_mov_b32 s67, 0
gsync_71:
    ds_read_b32 v4, v3
    s_add_u32 s67, s67, 1
    s_waitcnt lgkmcnt(0)
    v_readfirstlane_b32 s66, v4
    s_cmp_gt_u32 s67, 1000000
    s_cbranch_scc1 gsync_e_72
    s_cmp_lt_u32 s66, 24
    s_cbranch_scc1 gsync_71
gsync_e_72:
    s_mov_b64 exec, 0
    s_cmp_eq_u32 s34, 0
    s_cselect_b32 exec_lo, -1, exec_lo
    s_cselect_b32 exec_hi, -1, exec_hi
    s_cmp_eq_u32 s34, 1
    s_cselect_b32 exec_lo, 0, exec_lo
    s_cselect_b32 exec_hi, -1, exec_hi
    s_cmp_eq_u32 s34, 2
    s_cselect_b32 exec_lo, -1, exec_lo
    s_cselect_b32 exec_hi, -1, exec_hi
    s_cmp_eq_u32 s34, 3
    s_cselect_b32 exec_lo, 0, exec_lo
    s_cselect_b32 exec_hi, 0, exec_hi
    s_cbranch_execz c_fskip_74
    ds_read_b128 v[120:123], v75 offset:0
    ds_read_b128 v[124:127], v75 offset:16
    ds_read_b128 v[128:131], v75 offset:8192
    ds_read_b128 v[132:135], v75 offset:8208
    ds_read_b128 v[136:139], v75 offset:16384
    ds_read_b128 v[140:143], v75 offset:16400
    ds_read_b128 v[144:147], v75 offset:24576
    ds_read_b128 v[148:151], v75 offset:24592
    s_lshl_b32 s40, s58, 12
    s_add_u32 s40, s40, 8912896
    s_waitcnt lgkmcnt(0)
    v_pk_add_f32 v[120:121], v[120:121], v[128:129]
    v_pk_add_f32 v[136:137], v[136:137], v[144:145]
    v_pk_add_f32 v[122:123], v[122:123], v[130:131]
    v_pk_add_f32 v[138:139], v[138:139], v[146:147]
    v_pk_add_f32 v[124:125], v[124:125], v[132:133]
    v_pk_add_f32 v[140:141], v[140:141], v[148:149]
    v_pk_add_f32 v[126:127], v[126:127], v[134:135]
    v_pk_add_f32 v[142:143], v[142:143], v[150:151]
    v_pk_add_f32 v[120:121], v[120:121], v[136:137]
    v_pk_add_f32 v[122:123], v[122:123], v[138:139]
    v_pk_add_f32 v[124:125], v[124:125], v[140:141]
    v_pk_add_f32 v[126:127], v[126:127], v[142:143]
    v_cvt_pk_bf16_f32 v192, v120, v121
    v_cvt_pk_bf16_f32 v193, v122, v123
    v_cvt_pk_bf16_f32 v194, v124, v125
    v_cvt_pk_bf16_f32 v195, v126, v127
    buffer_store_dwordx4 v[192:195], v2, s[8:11], s40 offen sc1
c_fskip_74:
    s_mov_b64 exec, -1
    s_nop 1
c_halfE_56:
    s_waitcnt vmcnt(0) lgkmcnt(0)
    s_barrier
recurrent_scan__ssm_conv_h3__mixer_gmlp__prompt_kernel_end:
    s_endpgm
.section .rodata,"a"
.p2align 6
.amdhsa_kernel recurrent_scan__ssm_conv_h3__mixer_gmlp__prompt_kernel
  .amdhsa_next_free_vgpr 248
  .amdhsa_next_free_sgpr 102
  .amdhsa_accum_offset 248
  .amdhsa_group_segment_fixed_size 0
  .amdhsa_kernarg_size 112
  .amdhsa_user_sgpr_count 2
  .amdhsa_user_sgpr_kernarg_segment_ptr 1
  .amdhsa_system_sgpr_workgroup_id_x 1
.end_amdhsa_kernel
```

```asm
; @launch grid=(256,1,1) block=(512,1,1) lds=163840
.amdgcn_target "amdgcn-amd-amdhsa--gfx950"
.text
.globl recurrent_scan__ssm_conv_h3__mixer_gmlp__prompt_kernel
.p2align 8
.type recurrent_scan__ssm_conv_h3__mixer_gmlp__prompt_kernel,@function
recurrent_scan__ssm_conv_h3__mixer_gmlp__prompt_kernel:
    s_cmp_ge_u32 s2, 256
    s_cbranch_scc1 recurrent_scan__ssm_conv_h3__mixer_gmlp__prompt_kernel_end
    s_load_dwordx2 s[4:5], s[0:1], 0
    s_load_dwordx2 s[8:9], s[0:1], 56
    s_load_dwordx2 s[12:13], s[0:1], 8
    s_load_dwordx2 s[16:17], s[0:1], 16
    s_load_dwordx2 s[20:21], s[0:1], 24
    s_load_dwordx2 s[24:25], s[0:1], 104
    s_load_dwordx2 s[28:29], s[0:1], 96
    s_load_dwordx2 s[32:33], s[0:1], 64
    s_load_dwordx2 s[36:37], s[0:1], 32
    s_load_dwordx2 s[84:85], s[0:1], 80
    v_lshrrev_b32 v2, 6, v0
    v_and_b32 v1, 63, v0
    v_readfirstlane_b32 s42, v2
    v_lshrrev_b32 v2, 4, v1
    v_and_b32 v3, 15, v1
    s_and_b32 s48, s2, 7
    s_lshr_b32 s49, s2, 3
    s_lshr_b32 s66, s48, 1
    s_and_b32 s67, s48, 1
    s_lshl_b32 s40, s66, 3
    s_and_b32 s48, s49, 7
    s_add_u32 s40, s40, s48
    s_lshl_b32 s41, s67, 2
    s_lshr_b32 s48, s49, 3
    s_add_u32 s41, s41, s48
    s_mul_i32 s52, s40, 81920
    s_mul_i32 s54, s41, 192
    s_add_u32 s53, s54, 1536
    s_lshl_b32 s60, s42, 11
    s_mul_i32 s61, s42, 3072
    s_mov_b32 s6, 2621440
    s_mov_b32 s7, 0x20000
    s_mov_b32 s10, 1966080
    s_mov_b32 s11, 0x20000
    s_lshl_b32 s48, s42, 3
    v_add_u32 v4, s48, v2
    v_and_b32 v5, 15, v4
    v_xor_b32 v5, v5, v3
    v_mul_u32_u24 v4, 1280, v4
    v_lshl_add_u32 v38, v5, 4, v4
    v_add_u32 v4, s48, v2
    v_add_u32 v4, 4, v4
    v_and_b32 v5, 15, v4
    v_xor_b32 v5, v5, v3
    v_mul_u32_u24 v4, 1280, v4
    v_lshl_add_u32 v39, v5, 4, v4
    s_mul_i32 s48, s42, 192
    v_add_u32 v4, s48, v1
    v_mul_u32_u24 v5, 43691, v4
    v_lshrrev_b32 v5, 19, v5
    v_mul_u32_u24 v6, 12, v5
    v_sub_u32 v4, v4, v6
    v_lshrrev_b32 v6, 2, v5
    v_and_b32 v6, 2, v6
    v_xor_b32 v4, v4, v6
    v_mul_u32_u24 v5, 3072, v5
    v_lshl_add_u32 v40, v4, 4, v5
    v_add_u32 v4, s48, v1
    v_add_u32 v4, 64, v4
    v_mul_u32_u24 v5, 43691, v4
    v_lshrrev_b32 v5, 19, v5
    v_mul_u32_u24 v6, 12, v5
    v_sub_u32 v4, v4, v6
    v_lshrrev_b32 v6, 2, v5
    v_and_b32 v6, 2, v6
    v_xor_b32 v4, v4, v6
    v_mul_u32_u24 v5, 3072, v5
    v_lshl_add_u32 v41, v4, 4, v5
    v_add_u32 v4, s48, v1
    v_add_u32 v4, 128, v4
    v_mul_u32_u24 v5, 43691, v4
    v_lshrrev_b32 v5, 19, v5
    v_mul_u32_u24 v6, 12, v5
    v_sub_u32 v4, v4, v6
    v_lshrrev_b32 v6, 2, v5
    v_and_b32 v6, 2, v6
    v_xor_b32 v4, v4, v6
    v_mul_u32_u24 v5, 3072, v5
    v_lshl_add_u32 v42, v4, 4, v5
    s_add_u32 s48, s40, s41
    s_mul_i32 s49, s48, 52
    s_lshr_b32 s49, s49, 8
    s_mul_i32 s49, s49, 5
    s_sub_u32 s51, s48, s49
    s_add_u32 s49, s51, 0
    s_sub_u32 s50, s49, 5
    s_cmp_ge_u32 s49, 5
    s_cselect_b32 s49, s50, s49
    s_lshl_b32 s90, s49, 8
    s_mul_i32 s95, s49, 393216
    s_add_u32 s49, s51, 1
    s_sub_u32 s50, s49, 5
    s_cmp_ge_u32 s49, 5
    s_cselect_b32 s49, s50, s49
    s_lshl_b32 s91, s49, 8
    s_mul_i32 s96, s49, 393216
    s_waitcnt lgkmcnt(0)
    s_add_u32 s65, s52, s90
    s_add_u32 m0, s60, 0
    s_nop 0
    buffer_load_dwordx4 v38, s[4:7], s65 offen lds
    s_add_u32 s65, s52, s90
    s_add_u32 m0, s60, 1024
    s_nop 0
    buffer_load_dwordx4 v39, s[4:7], s65 offen lds
    s_add_u32 s65, s53, s95
    s_add_u32 m0, s61, 81920
    s_nop 0
    buffer_load_dwordx4 v40, s[8:11], s65 offen lds
    s_add_u32 s65, s53, s95
    s_add_u32 m0, s61, 82944
    s_nop 0
    buffer_load_dwordx4 v41, s[8:11], s65 offen lds
    s_add_u32 s65, s53, s95
    s_add_u32 m0, s61, 83968
    s_nop 0
    buffer_load_dwordx4 v42, s[8:11], s65 offen lds
    s_mov_b32 s48, 14712832
    s_load_dwordx2 s[100:101], s[24:25], s48
    s_add_u32 s49, s51, 2
    s_sub_u32 s50, s49, 5
    s_cmp_ge_u32 s49, 5
    s_cselect_b32 s49, s50, s49
    s_lshl_b32 s92, s49, 8
    s_mul_i32 s97, s49, 393216
    s_add_u32 s49, s51, 3
    s_sub_u32 s50, s49, 5
    s_cmp_ge_u32 s49, 5
    s_cselect_b32 s49, s50, s49
    s_lshl_b32 s93, s49, 8
    s_mul_i32 s98, s49, 393216
    s_add_u32 s49, s51, 4
    s_sub_u32 s50, s49, 5
    s_cmp_ge_u32 s49, 5
    s_cselect_b32 s49, s50, s49
    s_lshl_b32 s94, s49, 8
    s_mul_i32 s99, s49, 393216
    s_mov_b32 s14, 2621440
    s_mov_b32 s15, 0x20000
    s_mov_b32 s18, 2621440
    s_mov_b32 s19, 0x20000
    s_mov_b32 s22, 5120
    s_mov_b32 s23, 0x20000
    s_mov_b32 s26, 15990784
    s_mov_b32 s27, 0x20000
    s_mov_b32 s30, 256
    s_mov_b32 s31, 0x20000
    s_mov_b32 s34, 8388608
    s_mov_b32 s35, 0x20000
    s_mov_b32 s38, 2621440
    s_mov_b32 s39, 0x20000
    s_mov_b32 s86, 983040
    s_mov_b32 s87, 0x20000
    v_lshlrev_b32 v36, 7, v1
    v_mov_b32 v4, 161792
    v_mov_b32 v8, 0
    v_mov_b32 v9, 0
    ds_write_b64 v4, v[8:9]
    s_barrier
    s_add_u32 s65, s52, s91
    s_add_u32 m0, s60, 16384
    s_nop 0
    buffer_load_dwordx4 v38, s[4:7], s65 offen lds
    s_add_u32 s65, s52, s91
    s_add_u32 m0, s60, 17408
    s_nop 0
    buffer_load_dwordx4 v39, s[4:7], s65 offen lds
    s_add_u32 s65, s53, s96
    s_add_u32 m0, s61, 106496
    s_nop 0
    buffer_load_dwordx4 v40, s[8:11], s65 offen lds
    s_add_u32 s65, s53, s96
    s_add_u32 m0, s61, 107520
    s_nop 0
    buffer_load_dwordx4 v41, s[8:11], s65 offen lds
    s_add_u32 s65, s53, s96
    s_add_u32 m0, s61, 108544
    s_nop 0
    buffer_load_dwordx4 v42, s[8:11], s65 offen lds
    s_cmp_lg_u32 s42, 7
    s_cbranch_scc1 k1_shk_1
    v_lshlrev_b32 v4, 4, v1
    s_mul_i32 s48, s41, 640
    s_mov_b32 m0, 160768
    s_mov_b32 exec_lo, -1
    s_mov_b32 exec_hi, 0xff
    buffer_load_dwordx4 v4, s[20:23], s48 offen lds
    s_mov_b64 exec, -1
k1_shk_1:
    s_and_b32 s43, s42, 1
    s_lshr_b32 s44, s42, 1
    s_and_b32 s44, s44, 1
    s_lshr_b32 s45, s42, 2
    s_xor_b32 s46, s43, s45
    s_lshl_b32 s47, s44, 1
    s_add_u32 s47, s47, s46
    s_mov_b32 s55, 0x3727c5ac
    s_mov_b32 s56, 0x3f803f80
    s_mov_b32 s58, 0xbdd2d3e8
    s_mov_b32 s59, 0xbdd2d3e8
    s_lshl_b32 s48, s45, 1
    s_add_u32 s63, s48, s44
    s_xor_b32 s64, s63, 1
    v_xor_b32 v4, v2, v3
    v_lshlrev_b32 v6, 8, v3
    s_lshl_b32 s48, s44, 13
    s_lshl_b32 s49, s46, 12
    s_add_u32 s50, s48, s49
    s_xor_b32 s49, s49, 4096
    s_add_u32 s51, s48, s49
    s_lshl_b32 s48, s63, 2
    v_xor_b32 v5, s48, v4
    v_lshl_add_u32 v5, v5, 4, v6
    v_add_u32 v45, s50, v5
    v_add_u32 v46, s51, v5
    s_lshl_b32 s48, s64, 2
    v_xor_b32 v5, s48, v4
    v_lshl_add_u32 v5, v5, 4, v6
    v_add_u32 v47, s50, v5
    v_add_u32 v216, s51, v5
    v_lshrrev_b32 v5, 2, v3
    v_lshl_add_u32 v4, v2, 3, v5
    v_mul_u32_u24 v4, 192, v4
    v_and_b32 v5, 3, v3
    v_lshl_add_u32 v4, v5, 3, v4
    v_and_b32 v5, 1, v2
    s_mul_i32 s51, s43, 3
    s_mul_i32 s49, s63, 6144
    s_add_u32 s49, s49, 81920
    s_mul_i32 s50, s64, 6144
    s_add_u32 s50, s50, 81920
    s_add_u32 s48, s51, 0
    v_xor_b32 v6, s48, v5
    v_lshl_add_u32 v6, v6, 5, v4
    v_add_u32 v217, s49, v6
    v_add_u32 v220, s50, v6
    s_add_u32 s48, s51, 1
    v_xor_b32 v6, s48, v5
    v_lshl_add_u32 v6, v6, 5, v4
    v_add_u32 v218, s49, v6
    v_add_u32 v221, s50, v6
    s_add_u32 s48, s51, 2
    v_xor_b32 v6, s48, v5
    v_lshl_add_u32 v6, v6, 5, v4
    v_add_u32 v219, s49, v6
    v_add_u32 v222, s50, v6
    v_mov_b32 v244, s56
    v_mov_b32 v245, s56
    v_mov_b32 v246, s56
    v_mov_b32 v247, s56
    v_mul_u32_u24 v43, 205, v1
    v_lshrrev_b32 v43, 11, v43
    v_mul_u32_u24 v4, 10, v43
    v_sub_u32 v44, v1, v4
    s_lshl_b32 s48, s42, 3
    v_lshl_add_u32 v4, v43, 1, s48
    v_min_u32 v4, 62, v4
    v_mul_u32_u24 v4, 160, v4
    v_lshl_add_u32 v7, v44, 4, v4
    v_lshlrev_b32 v215, 10, v1
    s_lshl_b32 s89, s2, 3
    s_add_u32 s89, s89, s42
    s_mul_i32 s70, s42, 3072
    s_add_u32 s70, s70, 16384
    s_xor_b32 s48, s42, 4
    s_mul_i32 s71, s48, 3072
    s_add_u32 s71, s71, 16384
    s_lshl_b32 s48, s43, 2
    s_lshl_b32 s49, s44, 1
    s_add_u32 s48, s48, s49
    s_add_u32 s48, s48, s45
    s_mul_i32 s72, s48, 192
    s_add_u32 s72, s72, 155648
    s_mul_i32 s73, s43, 768
    s_add_u32 s73, s73, 155648
    s_lshl_b32 s48, s47, 1
    s_add_u32 s48, s48, s45
    s_lshl_b32 s48, s48, 7
    s_add_u32 s74, s48, 158720
    s_lshl_b32 s48, s47, 8
    s_add_u32 s75, s48, 158720
    s_lshl_b32 s48, s47, 7
    s_lshl_b32 s49, s43, 9
    s_add_u32 s48, s48, s49
    s_add_u32 s76, s48, 159744
    s_lshl_b32 s48, s40, 3
    s_add_u32 s48, s48, s41
    s_lshl_b32 s49, s48, 10
    s_add_u32 s77, s49, 14745600
    s_mov_b32 s48, 0
    s_lshr_b32 s49, s47, 1
    s_mul_i32 s49, s49, 6144
    s_add_u32 s48, s48, s49
    s_and_b32 s49, s47, 1
    s_lshl_b32 s49, s49, 8
    s_add_u32 s48, s48, s49
    s_add_u32 s48, s48, 73728
    s_mul_i32 s49, s43, 3
    s_add_u32 s49, s49, 0
    s_lshr_b32 s50, s49, 1
    s_lshl_b32 s50, s50, 10
    s_and_b32 s49, s49, 1
    s_lshl_b32 s49, s49, 3
    s_add_u32 s80, s48, s49
    s_add_u32 s80, s80, s50
    s_mul_i32 s49, s43, 3
    s_add_u32 s49, s49, 1
    s_lshr_b32 s50, s49, 1
    s_lshl_b32 s50, s50, 10
    s_and_b32 s49, s49, 1
    s_lshl_b32 s49, s49, 3
    s_add_u32 s81, s48, s49
    s_add_u32 s81, s81, s50
    s_mul_i32 s49, s43, 3
    s_add_u32 s49, s49, 2
    s_lshr_b32 s50, s49, 1
    s_lshl_b32 s50, s50, 10
    s_and_b32 s49, s49, 1
    s_lshl_b32 s49, s49, 3
    s_add_u32 s82, s48, s49
    s_add_u32 s82, s82, s50
    s_lshl_b32 s48, s40, 13
    s_lshl_b32 s49, s47, 8
    s_add_u32 s48, s48, s49
    s_add_u32 s78, s48, 14745600
    s_lshl_b32 s48, s40, 9
    s_lshl_b32 s49, s47, 7
    s_add_u32 s48, s48, s49
    s_add_u32 s79, s48, 14680064
    s_mul_i32 s48, s41, 327680
    s_lshl_b32 s49, s40, 7
    s_add_u32 s48, s48, s49
    s_add_u32 s83, s48, 6291456
    s_lshr_b32 s48, s2, 3
    s_lshl_b32 s48, s48, 3
    s_add_u32 s48, s48, s42
    s_lshl_b32 s48, s48, 13
    s_lshl_b32 s49, s66, 21
    s_add_u32 s66, s48, s49
    s_add_u32 s51, s42, 0
    s_mul_i32 s48, s51, 43
    s_lshr_b32 s48, s48, 7
    s_mul_i32 s49, s48, 3
    s_sub_u32 s49, s51, s49
    s_mul_i32 s48, s48, 3200
    s_lshl_b32 s49, s49, 6
    s_add_u32 s48, s48, s49
    s_add_u32 s88, s48, 0
    s_lshl_b32 s48, s41, 7
    s_lshl_b32 s49, s40, 2
    s_add_u32 s48, s48, s49
    s_mul_i32 s48, s48, 3
    s_add_u32 s48, s48, s51
    s_lshl_b32 s48, s48, 10
    s_add_u32 s64, s48, 0
    s_add_u32 s51, s42, 8
    s_mul_i32 s48, s51, 43
    s_lshr_b32 s48, s48, 7
    s_mul_i32 s49, s48, 3
    s_sub_u32 s49, s51, s49
    s_mul_i32 s48, s48, 3200
    s_lshl_b32 s49, s49, 6
    s_add_u32 s48, s48, s49
    s_add_u32 s63, s48, 0
    s_lshl_b32 s48, s41, 7
    s_lshl_b32 s49, s40, 2
    s_add_u32 s48, s48, s49
    s_mul_i32 s48, s48, 3
    s_add_u32 s48, s48, s51
    s_lshl_b32 s48, s48, 10
    s_add_u32 s67, s48, 0
    s_waitcnt vmcnt(5)
    s_waitcnt lgkmcnt(0)
    s_add_u32 s100, s100, 1
    s_addc_u32 s101, s101, 0
    s_barrier
    ds_read_b64_tr_b16 v[128:129], v217 offset:0
    ds_read_b64_tr_b16 v[130:131], v217 offset:768
    ds_read_b64_tr_b16 v[132:133], v218 offset:0
    ds_read_b64_tr_b16 v[134:135], v218 offset:768
    ds_read_b64_tr_b16 v[136:137], v219 offset:0
    ds_read_b64_tr_b16 v[138:139], v219 offset:768
    ds_read_b64_tr_b16 v[140:141], v220 offset:0
    ds_read_b64_tr_b16 v[142:143], v220 offset:768
    ds_read_b64_tr_b16 v[144:145], v221 offset:0
    ds_read_b64_tr_b16 v[146:147], v221 offset:768
    ds_read_b64_tr_b16 v[148:149], v222 offset:0
    ds_read_b64_tr_b16 v[150:151], v222 offset:768
    ds_read_b128 v[48:51], v45 offset:0
    ds_read_b128 v[52:55], v46 offset:0
    ds_read_b128 v[56:59], v47 offset:0
    ds_read_b128 v[60:63], v216 offset:0
    s_add_u32 s65, s52, s92
    s_add_u32 m0, s60, 32768
    s_nop 0
    buffer_load_dwordx4 v38, s[4:7], s65 offen lds
    s_add_u32 s65, s52, s92
    s_add_u32 m0, s60, 33792
    s_nop 0
    buffer_load_dwordx4 v39, s[4:7], s65 offen lds
    s_add_u32 s65, s53, s97
    s_add_u32 m0, s61, 131072
    s_nop 0
    buffer_load_dwordx4 v40, s[8:11], s65 offen lds
    s_add_u32 s65, s53, s97
    s_add_u32 m0, s61, 132096
    s_nop 0
    buffer_load_dwordx4 v41, s[8:11], s65 offen lds
    s_add_u32 s65, s53, s97
    s_add_u32 m0, s61, 133120
    s_nop 0
    buffer_load_dwordx4 v42, s[8:11], s65 offen lds
    s_waitcnt vmcnt(5)
    s_waitcnt lgkmcnt(0)
    s_barrier
    v_mfma_f32_16x16x32_bf16 v[176:179], v[128:131], v[48:51], 0
    ds_read_b64_tr_b16 v[152:153], v217 offset:24576
    ds_read_b64_tr_b16 v[154:155], v217 offset:25344
    v_mfma_f32_16x16x32_bf16 v[180:183], v[128:131], v[52:55], 0
    s_add_u32 s65, s52, s93
    s_add_u32 m0, s60, 49152
    s_nop 0
    buffer_load_dwordx4 v38, s[4:7], s65 offen lds
    ds_read_b64_tr_b16 v[156:157], v218 offset:24576
    ds_read_b64_tr_b16 v[158:159], v218 offset:25344
    v_mfma_f32_16x16x32_bf16 v[224:227], v[128:131], v[244:247], 0
    ds_read_b64_tr_b16 v[160:161], v219 offset:24576
    ds_read_b64_tr_b16 v[162:163], v219 offset:25344
    v_mfma_f32_16x16x32_bf16 v[184:187], v[132:135], v[48:51], 0
    ds_read_b64_tr_b16 v[164:165], v220 offset:24576
    ds_read_b64_tr_b16 v[166:167], v220 offset:25344
    v_mfma_f32_16x16x32_bf16 v[188:191], v[132:135], v[52:55], 0
    s_add_u32 s65, s52, s93
    s_add_u32 m0, s60, 50176
    s_nop 0
    buffer_load_dwordx4 v39, s[4:7], s65 offen lds
    ds_read_b64_tr_b16 v[168:169], v221 offset:24576
    ds_read_b64_tr_b16 v[170:171], v221 offset:25344
    v_mfma_f32_16x16x32_bf16 v[228:231], v[132:135], v[244:247], 0
    ds_read_b64_tr_b16 v[172:173], v222 offset:24576
    ds_read_b64_tr_b16 v[174:175], v222 offset:25344
    v_mfma_f32_16x16x32_bf16 v[192:195], v[136:139], v[48:51], 0
    ds_read_b128 v[64:67], v45 offset:16384
    ds_read_b128 v[68:71], v46 offset:16384
    v_mfma_f32_16x16x32_bf16 v[196:199], v[136:139], v[52:55], 0
    s_add_u32 s65, s53, s98
    s_add_u32 m0, s61, 81920
    s_nop 0
    buffer_load_dwordx4 v40, s[8:11], s65 offen lds
    ds_read_b128 v[72:75], v47 offset:16384
    ds_read_b128 v[76:79], v216 offset:16384
    v_mfma_f32_16x16x32_bf16 v[232:235], v[136:139], v[244:247], 0
    v_mfma_f32_16x16x32_bf16 v[236:239], v[244:247], v[48:51], 0
    v_mfma_f32_16x16x32_bf16 v[240:243], v[48:51], v[48:51], 0
    s_add_u32 s65, s53, s98
    s_add_u32 m0, s61, 82944
    s_nop 0
    buffer_load_dwordx4 v41, s[8:11], s65 offen lds
    v_mfma_f32_16x16x32_bf16 v[176:179], v[140:143], v[56:59], v[176:179]
    v_mfma_f32_16x16x32_bf16 v[180:183], v[140:143], v[60:63], v[180:183]
    v_mfma_f32_16x16x32_bf16 v[184:187], v[144:147], v[56:59], v[184:187]
    s_add_u32 s65, s53, s98
    s_add_u32 m0, s61, 83968
    s_nop 0
    buffer_load_dwordx4 v42, s[8:11], s65 offen lds
    v_mfma_f32_16x16x32_bf16 v[188:191], v[144:147], v[60:63], v[188:191]
    v_mfma_f32_16x16x32_bf16 v[192:195], v[148:151], v[56:59], v[192:195]
    v_mfma_f32_16x16x32_bf16 v[196:199], v[148:151], v[60:63], v[196:199]
    v_mfma_f32_16x16x32_bf16 v[236:239], v[244:247], v[56:59], v[236:239]
    v_mfma_f32_16x16x32_bf16 v[240:243], v[56:59], v[56:59], v[240:243]
    s_waitcnt vmcnt(5)
    s_waitcnt lgkmcnt(0)
    s_barrier
    v_mfma_f32_16x16x32_bf16 v[176:179], v[152:155], v[64:67], v[176:179]
    ds_read_b64_tr_b16 v[128:129], v217 offset:49152
    ds_read_b64_tr_b16 v[130:131], v217 offset:49920
    v_mfma_f32_16x16x32_bf16 v[180:183], v[152:155], v[68:71], v[180:183]
    s_add_u32 s65, s52, s94
    s_add_u32 m0, s60, 65536
    s_nop 0
    buffer_load_dwordx4 v38, s[4:7], s65 offen lds
    ds_read_b64_tr_b16 v[132:133], v218 offset:49152
    ds_read_b64_tr_b16 v[134:135], v218 offset:49920
    v_mfma_f32_16x16x32_bf16 v[224:227], v[152:155], v[244:247], v[224:227]
    ds_read_b64_tr_b16 v[136:137], v219 offset:49152
    ds_read_b64_tr_b16 v[138:139], v219 offset:49920
    v_mfma_f32_16x16x32_bf16 v[184:187], v[156:159], v[64:67], v[184:187]
    ds_read_b64_tr_b16 v[140:141], v220 offset:49152
    ds_read_b64_tr_b16 v[142:143], v220 offset:49920
    v_mfma_f32_16x16x32_bf16 v[188:191], v[156:159], v[68:71], v[188:191]
    s_add_u32 s65, s52, s94
    s_add_u32 m0, s60, 66560
    s_nop 0
    buffer_load_dwordx4 v39, s[4:7], s65 offen lds
    ds_read_b64_tr_b16 v[144:145], v221 offset:49152
    ds_read_b64_tr_b16 v[146:147], v221 offset:49920
    v_mfma_f32_16x16x32_bf16 v[228:231], v[156:159], v[244:247], v[228:231]
    ds_read_b64_tr_b16 v[148:149], v222 offset:49152
    ds_read_b64_tr_b16 v[150:151], v222 offset:49920
    v_mfma_f32_16x16x32_bf16 v[192:195], v[160:163], v[64:67], v[192:195]
    ds_read_b128 v[80:83], v45 offset:32768
    ds_read_b128 v[84:87], v46 offset:32768
    v_mfma_f32_16x16x32_bf16 v[196:199], v[160:163], v[68:71], v[196:199]
    s_add_u32 s65, s53, s99
    s_add_u32 m0, s61, 106496
    s_nop 0
    buffer_load_dwordx4 v40, s[8:11], s65 offen lds
    ds_read_b128 v[88:91], v47 offset:32768
    ds_read_b128 v[92:95], v216 offset:32768
    v_mfma_f32_16x16x32_bf16 v[232:235], v[160:163], v[244:247], v[232:235]
    v_mfma_f32_16x16x32_bf16 v[236:239], v[244:247], v[64:67], v[236:239]
    v_mfma_f32_16x16x32_bf16 v[240:243], v[64:67], v[64:67], v[240:243]
    s_add_u32 s65, s53, s99
    s_add_u32 m0, s61, 107520
    s_nop 0
    buffer_load_dwordx4 v41, s[8:11], s65 offen lds
    v_mfma_f32_16x16x32_bf16 v[176:179], v[164:167], v[72:75], v[176:179]
    v_mfma_f32_16x16x32_bf16 v[180:183], v[164:167], v[76:79], v[180:183]
    v_mfma_f32_16x16x32_bf16 v[184:187], v[168:171], v[72:75], v[184:187]
    s_add_u32 s65, s53, s99
    s_add_u32 m0, s61, 108544
    s_nop 0
    buffer_load_dwordx4 v42, s[8:11], s65 offen lds
    v_mfma_f32_16x16x32_bf16 v[188:191], v[168:171], v[76:79], v[188:191]
    v_mfma_f32_16x16x32_bf16 v[192:195], v[172:175], v[72:75], v[192:195]
    v_mfma_f32_16x16x32_bf16 v[196:199], v[172:175], v[76:79], v[196:199]
    v_mfma_f32_16x16x32_bf16 v[236:239], v[244:247], v[72:75], v[236:239]
    v_mfma_f32_16x16x32_bf16 v[240:243], v[72:75], v[72:75], v[240:243]
    s_waitcnt vmcnt(5)
    s_waitcnt lgkmcnt(0)
    s_barrier
    v_mfma_f32_16x16x32_bf16 v[176:179], v[128:131], v[80:83], v[176:179]
    ds_read_b64_tr_b16 v[152:153], v217 offset:0
    ds_read_b64_tr_b16 v[154:155], v217 offset:768
    v_mfma_f32_16x16x32_bf16 v[180:183], v[128:131], v[84:87], v[180:183]
    s_add_u32 s65, s54, s95
    s_add_u32 m0, s61, 131072
    s_nop 0
    buffer_load_dwordx4 v40, s[8:11], s65 offen lds
    ds_read_b64_tr_b16 v[156:157], v218 offset:0
    ds_read_b64_tr_b16 v[158:159], v218 offset:768
    v_mfma_f32_16x16x32_bf16 v[224:227], v[128:131], v[244:247], v[224:227]
    ds_read_b64_tr_b16 v[160:161], v219 offset:0
    ds_read_b64_tr_b16 v[162:163], v219 offset:768
    v_mfma_f32_16x16x32_bf16 v[184:187], v[132:135], v[80:83], v[184:187]
    ds_read_b64_tr_b16 v[164:165], v220 offset:0
    ds_read_b64_tr_b16 v[166:167], v220 offset:768
    v_mfma_f32_16x16x32_bf16 v[188:191], v[132:135], v[84:87], v[188:191]
    s_add_u32 s65, s54, s95
    s_add_u32 m0, s61, 132096
    s_nop 0
    buffer_load_dwordx4 v41, s[8:11], s65 offen lds
    ds_read_b64_tr_b16 v[168:169], v221 offset:0
    ds_read_b64_tr_b16 v[170:171], v221 offset:768
    v_mfma_f32_16x16x32_bf16 v[228:231], v[132:135], v[244:247], v[228:231]
    ds_read_b64_tr_b16 v[172:173], v222 offset:0
    ds_read_b64_tr_b16 v[174:175], v222 offset:768
    v_mfma_f32_16x16x32_bf16 v[192:195], v[136:139], v[80:83], v[192:195]
    ds_read_b128 v[96:99], v45 offset:49152
    ds_read_b128 v[100:103], v46 offset:49152
    v_mfma_f32_16x16x32_bf16 v[196:199], v[136:139], v[84:87], v[196:199]
    s_add_u32 s65, s54, s95
    s_add_u32 m0, s61, 133120
    s_nop 0
    buffer_load_dwordx4 v42, s[8:11], s65 offen lds
    ds_read_b128 v[104:107], v47 offset:49152
    ds_read_b128 v[108:111], v216 offset:49152
    v_mfma_f32_16x16x32_bf16 v[232:235], v[136:139], v[244:247], v[232:235]
    v_mfma_f32_16x16x32_bf16 v[236:239], v[244:247], v[80:83], v[236:239]
    v_mfma_f32_16x16x32_bf16 v[240:243], v[80:83], v[80:83], v[240:243]
    s_mul_i32 s48, s89, 1280
    s_add_u32 s48, s48, 0
    s_mov_b64 exec, 0x1f
    buffer_load_dword v37, v36, s[36:39], s48 offen
    s_mov_b64 exec, -1
    v_mfma_f32_16x16x32_bf16 v[176:179], v[140:143], v[88:91], v[176:179]
    v_mfma_f32_16x16x32_bf16 v[180:183], v[140:143], v[92:95], v[180:183]
    v_mfma_f32_16x16x32_bf16 v[184:187], v[144:147], v[88:91], v[184:187]
    v_mfma_f32_16x16x32_bf16 v[188:191], v[144:147], v[92:95], v[188:191]
    v_mfma_f32_16x16x32_bf16 v[192:195], v[148:151], v[88:91], v[192:195]
    v_mfma_f32_16x16x32_bf16 v[196:199], v[148:151], v[92:95], v[196:199]
    v_mfma_f32_16x16x32_bf16 v[236:239], v[244:247], v[88:91], v[236:239]
    v_mfma_f32_16x16x32_bf16 v[240:243], v[88:91], v[88:91], v[240:243]
    s_waitcnt vmcnt(4)
    s_waitcnt lgkmcnt(0)
    s_barrier
    v_mfma_f32_16x16x32_bf16 v[176:179], v[152:155], v[96:99], v[176:179]
    ds_read_b64_tr_b16 v[128:129], v217 offset:24576
    ds_read_b64_tr_b16 v[130:131], v217 offset:25344
    v_mfma_f32_16x16x32_bf16 v[180:183], v[152:155], v[100:103], v[180:183]
    s_add_u32 s65, s54, s96
    s_add_u32 m0, s61, 81920
    s_nop 0
    buffer_load_dwordx4 v40, s[8:11], s65 offen lds
    ds_read_b64_tr_b16 v[132:133], v218 offset:24576
    ds_read_b64_tr_b16 v[134:135], v218 offset:25344
    v_mfma_f32_16x16x32_bf16 v[224:227], v[152:155], v[244:247], v[224:227]
    ds_read_b64_tr_b16 v[136:137], v219 offset:24576
    ds_read_b64_tr_b16 v[138:139], v219 offset:25344
    v_mfma_f32_16x16x32_bf16 v[184:187], v[156:159], v[96:99], v[184:187]
    ds_read_b64_tr_b16 v[140:141], v220 offset:24576
    ds_read_b64_tr_b16 v[142:143], v220 offset:25344
    v_mfma_f32_16x16x32_bf16 v[188:191], v[156:159], v[100:103], v[188:191]
    s_add_u32 s65, s54, s96
    s_add_u32 m0, s61, 82944
    s_nop 0
    buffer_load_dwordx4 v41, s[8:11], s65 offen lds
    ds_read_b64_tr_b16 v[144:145], v221 offset:24576
    ds_read_b64_tr_b16 v[146:147], v221 offset:25344
    v_mfma_f32_16x16x32_bf16 v[228:231], v[156:159], v[244:247], v[228:231]
    ds_read_b64_tr_b16 v[148:149], v222 offset:24576
    ds_read_b64_tr_b16 v[150:151], v222 offset:25344
    v_mfma_f32_16x16x32_bf16 v[192:195], v[160:163], v[96:99], v[192:195]
    v_add_u32 v45, 0x10000, v45
    v_add_u32 v46, 0x10000, v46
    v_add_u32 v47, 0x10000, v47
    v_add_u32 v216, 0x10000, v216
    ds_read_b128 v[112:115], v45 offset:0
    ds_read_b128 v[116:119], v46 offset:0
    v_mfma_f32_16x16x32_bf16 v[196:199], v[160:163], v[100:103], v[196:199]
    s_add_u32 s65, s54, s96
    s_add_u32 m0, s61, 83968
    s_nop 0
    buffer_load_dwordx4 v42, s[8:11], s65 offen lds
    ds_read_b128 v[120:123], v47 offset:0
    ds_read_b128 v[124:127], v216 offset:0
    v_mfma_f32_16x16x32_bf16 v[232:235], v[160:163], v[244:247], v[232:235]
    v_mfma_f32_16x16x32_bf16 v[236:239], v[244:247], v[96:99], v[236:239]
    v_mfma_f32_16x16x32_bf16 v[240:243], v[96:99], v[96:99], v[240:243]
    v_mfma_f32_16x16x32_bf16 v[176:179], v[164:167], v[104:107], v[176:179]
    v_mfma_f32_16x16x32_bf16 v[180:183], v[164:167], v[108:111], v[180:183]
    v_mfma_f32_16x16x32_bf16 v[184:187], v[168:171], v[104:107], v[184:187]
    v_mfma_f32_16x16x32_bf16 v[188:191], v[168:171], v[108:111], v[188:191]
    v_mfma_f32_16x16x32_bf16 v[192:195], v[172:175], v[104:107], v[192:195]
    v_mfma_f32_16x16x32_bf16 v[196:199], v[172:175], v[108:111], v[196:199]
    v_mfma_f32_16x16x32_bf16 v[236:239], v[244:247], v[104:107], v[236:239]
    v_mfma_f32_16x16x32_bf16 v[240:243], v[104:107], v[104:107], v[240:243]
    s_waitcnt vmcnt(4)
    s_waitcnt lgkmcnt(0)
    s_barrier
    v_mfma_f32_16x16x32_bf16 v[176:179], v[128:131], v[112:115], v[176:179]
    ds_read_b64_tr_b16 v[152:153], v217 offset:49152
    ds_read_b64_tr_b16 v[154:155], v217 offset:49920
    v_mfma_f32_16x16x32_bf16 v[180:183], v[128:131], v[116:119], v[180:183]
    s_add_u32 s65, s54, s97
    s_add_u32 m0, s61, 106496
    s_nop 0
    buffer_load_dwordx4 v40, s[8:11], s65 offen lds
    ds_read_b64_tr_b16 v[156:157], v218 offset:49152
    ds_read_b64_tr_b16 v[158:159], v218 offset:49920
    v_mfma_f32_16x16x32_bf16 v[224:227], v[128:131], v[244:247], v[224:227]
    ds_read_b64_tr_b16 v[160:161], v219 offset:49152
    ds_read_b64_tr_b16 v[162:163], v219 offset:49920
    v_mfma_f32_16x16x32_bf16 v[184:187], v[132:135], v[112:115], v[184:187]
    ds_read_b64_tr_b16 v[164:165], v220 offset:49152
    ds_read_b64_tr_b16 v[166:167], v220 offset:49920
    v_mfma_f32_16x16x32_bf16 v[188:191], v[132:135], v[116:119], v[188:191]
    s_add_u32 s65, s54, s97
    s_add_u32 m0, s61, 107520
    s_nop 0
    buffer_load_dwordx4 v41, s[8:11], s65 offen lds
    ds_read_b64_tr_b16 v[168:169], v221 offset:49152
    ds_read_b64_tr_b16 v[170:171], v221 offset:49920
    v_mfma_f32_16x16x32_bf16 v[228:231], v[132:135], v[244:247], v[228:231]
    ds_read_b64_tr_b16 v[172:173], v222 offset:49152
    ds_read_b64_tr_b16 v[174:175], v222 offset:49920
    v_mfma_f32_16x16x32_bf16 v[192:195], v[136:139], v[112:115], v[192:195]
    v_mfma_f32_16x16x32_bf16 v[196:199], v[136:139], v[116:119], v[196:199]
    s_add_u32 s65, s54, s97
    s_add_u32 m0, s61, 108544
    s_nop 0
    buffer_load_dwordx4 v42, s[8:11], s65 offen lds
    v_mfma_f32_16x16x32_bf16 v[232:235], v[136:139], v[244:247], v[232:235]
    v_mfma_f32_16x16x32_bf16 v[236:239], v[244:247], v[112:115], v[236:239]
    v_mfma_f32_16x16x32_bf16 v[240:243], v[112:115], v[112:115], v[240:243]
    v_mfma_f32_16x16x32_bf16 v[176:179], v[140:143], v[120:123], v[176:179]
    v_mfma_f32_16x16x32_bf16 v[180:183], v[140:143], v[124:127], v[180:183]
    v_mfma_f32_16x16x32_bf16 v[184:187], v[144:147], v[120:123], v[184:187]
    v_mfma_f32_16x16x32_bf16 v[188:191], v[144:147], v[124:127], v[188:191]
    v_mfma_f32_16x16x32_bf16 v[192:195], v[148:151], v[120:123], v[192:195]
    v_mfma_f32_16x16x32_bf16 v[196:199], v[148:151], v[124:127], v[196:199]
    v_mfma_f32_16x16x32_bf16 v[236:239], v[244:247], v[120:123], v[236:239]
    v_mfma_f32_16x16x32_bf16 v[240:243], v[120:123], v[120:123], v[240:243]
    v_lshl_add_u32 v4, v1, 4, s70
    v_lshl_add_u32 v5, v2, 4, s72
    ds_write_b128 v4, v[180:183] offset:0
    s_nop 0
    ds_write_b128 v4, v[188:191] offset:1024
    s_nop 0
    ds_write_b128 v4, v[196:199] offset:2048
    s_mov_b32 exec_lo, 0x00010001
    s_mov_b32 exec_hi, 0x00010001
    ds_write_b128 v5, v[224:227] offset:0
    ds_write_b128 v5, v[228:231] offset:64
    ds_write_b128 v5, v[232:235] offset:128
    s_mov_b64 exec, -1
    v_and_b32 v8, 3, v3
    v_cmp_eq_u32 vcc, 1, v8
    s_nop 1
    v_cndmask_b32 v237, v240, v241, vcc
    v_cmp_eq_u32 vcc, 2, v8
    s_nop 1
    v_cndmask_b32 v237, v237, v242, vcc
    v_cmp_eq_u32 vcc, 3, v8
    s_nop 1
    v_cndmask_b32 v237, v237, v243, vcc
    v_lshl_add_u32 v6, v3, 3, s74
    s_mov_b32 exec_lo, 0x00F0000F
    s_mov_b32 exec_hi, 0xF0000F00
    ds_write_b64 v6, v[236:237]
    s_mov_b64 exec, -1
    v_pk_add_f32 v[200:201], v[176:177], 0
    v_pk_add_f32 v[202:203], v[178:179], 0
    v_pk_add_f32 v[204:205], v[184:185], 0
    v_pk_add_f32 v[206:207], v[186:187], 0
    v_pk_add_f32 v[208:209], v[192:193], 0
    v_pk_add_f32 v[210:211], v[194:195], 0
    v_mov_b32 v238, 0xc0135761
    v_mov_b32 v239, 0xc0135761
    s_waitcnt vmcnt(3)
    s_waitcnt lgkmcnt(0)
    s_barrier
    v_lshl_add_u32 v4, v1, 4, s71
    v_lshl_add_u32 v5, v3, 3, s75
    ds_read_b64 v[20:21], v5
    ds_read_b64 v[22:23], v5 offset:128
    ds_read_b128 v[8:11], v4 offset:0
    ds_read_b128 v[12:15], v4 offset:1024
    ds_read_b128 v[16:19], v4 offset:2048
    v_lshl_add_u32 v6, v2, 4, s73
    ds_read_b128 v[24:27], v6 offset:0
    ds_read_b128 v[28:31], v6 offset:64
    ds_read_b128 v[32:35], v6 offset:128
    ds_read_b128 v[176:179], v6 offset:192
    ds_read_b128 v[180:183], v6 offset:256
    ds_read_b128 v[184:187], v6 offset:320
    ds_read_b128 v[188:191], v6 offset:384
    ds_read_b128 v[192:195], v6 offset:448
    ds_read_b128 v[196:199], v6 offset:512
    ds_read_b128 v[224:227], v6 offset:576
    ds_read_b128 v[228:231], v6 offset:640
    ds_read_b128 v[232:235], v6 offset:704
    s_waitcnt lgkmcnt(15)
    v_pk_add_f32 v[240:241], v[20:21], v[22:23]
    v_mul_f32 v240, 0x3acccccd, v240
    v_mul_f32 v241, 0x3acccccd, v241
    v_fma_f32 v241, -v240, v240, v241
    v_max_f32 v241, 0, v241
    v_cvt_pk_bf16_f32 v241, v241, v240
    v_and_b32 v240, 0xffff0000, v241
    v_lshlrev_b32 v241, 16, v241
    v_add_f32 v241, s55, v241
    v_cvt_pk_bf16_f32 v241, v241, v241
    v_and_b32 v241, 0xffff0000, v241
    v_sqrt_f32 v241, v241
    s_nop 0
    v_cvt_pk_bf16_f32 v241, v241, v241
    v_and_b32 v241, 0xffff0000, v241
    v_rcp_f32 v241, v241
    s_nop 0
    v_mov_b32 v242, v241
    s_waitcnt lgkmcnt(12)
    v_pk_add_f32 v[200:201], v[200:201], v[8:9]
    v_pk_add_f32 v[202:203], v[202:203], v[10:11]
    v_pk_add_f32 v[204:205], v[204:205], v[12:13]
    v_pk_add_f32 v[206:207], v[206:207], v[14:15]
    v_pk_add_f32 v[208:209], v[208:209], v[16:17]
    v_pk_add_f32 v[210:211], v[210:211], v[18:19]
    s_waitcnt lgkmcnt(6)
    v_pk_add_f32 v[24:25], v[24:25], v[176:177]
    v_pk_add_f32 v[26:27], v[26:27], v[178:179]
    v_pk_add_f32 v[28:29], v[28:29], v[180:181]
    v_pk_add_f32 v[30:31], v[30:31], v[182:183]
    v_pk_add_f32 v[32:33], v[32:33], v[184:185]
    v_pk_add_f32 v[34:35], v[34:35], v[186:187]
    s_waitcnt lgkmcnt(0)
    v_pk_add_f32 v[188:189], v[188:189], v[224:225]
    v_pk_add_f32 v[190:191], v[190:191], v[226:227]
    v_pk_add_f32 v[192:193], v[192:193], v[228:229]
    v_pk_add_f32 v[194:195], v[194:195], v[230:231]
    v_pk_add_f32 v[196:197], v[196:197], v[232:233]
    v_pk_add_f32 v[198:199], v[198:199], v[234:235]
    v_pk_add_f32 v[24:25], v[24:25], v[188:189]
    v_pk_add_f32 v[26:27], v[26:27], v[190:191]
    v_pk_add_f32 v[28:29], v[28:29], v[192:193]
    v_pk_add_f32 v[30:31], v[30:31], v[194:195]
    v_pk_add_f32 v[32:33], v[32:33], v[196:197]
    v_pk_add_f32 v[34:35], v[34:35], v[198:199]
    v_pk_fma_f32 v[200:201], v[24:25], v[240:241], v[200:201] op_sel_hi:[1,0,1] neg_lo:[0,1,0] neg_hi:[0,1,0]
    v_pk_fma_f32 v[202:203], v[26:27], v[240:241], v[202:203] op_sel_hi:[1,0,1] neg_lo:[0,1,0] neg_hi:[0,1,0]
    v_pk_fma_f32 v[204:205], v[28:29], v[240:241], v[204:205] op_sel_hi:[1,0,1] neg_lo:[0,1,0] neg_hi:[0,1,0]
    v_pk_fma_f32 v[206:207], v[30:31], v[240:241], v[206:207] op_sel_hi:[1,0,1] neg_lo:[0,1,0] neg_hi:[0,1,0]
    v_pk_fma_f32 v[208:209], v[32:33], v[240:241], v[208:209] op_sel_hi:[1,0,1] neg_lo:[0,1,0] neg_hi:[0,1,0]
    v_pk_fma_f32 v[210:211], v[34:35], v[240:241], v[210:211] op_sel_hi:[1,0,1] neg_lo:[0,1,0] neg_hi:[0,1,0]
    v_pk_mul_f32 v[200:201], v[200:201], v[242:243] op_sel_hi:[1,0]
    v_pk_mul_f32 v[202:203], v[202:203], v[242:243] op_sel_hi:[1,0]
    v_pk_mul_f32 v[204:205], v[204:205], v[242:243] op_sel_hi:[1,0]
    v_pk_mul_f32 v[206:207], v[206:207], v[242:243] op_sel_hi:[1,0]
    v_pk_mul_f32 v[208:209], v[208:209], v[242:243] op_sel_hi:[1,0]
    v_pk_mul_f32 v[210:211], v[210:211], v[242:243] op_sel_hi:[1,0]
    v_pk_mul_f32 v[8:9], v[200:201], v[200:201]
    v_pk_mul_f32 v[10:11], v[202:203], v[202:203]
    v_pk_mul_f32 v[12:13], v[204:205], v[204:205]
    v_pk_mul_f32 v[14:15], v[206:207], v[206:207]
    v_pk_mul_f32 v[16:17], v[208:209], v[208:209]
    v_pk_mul_f32 v[18:19], v[210:211], v[210:211]
    v_pk_fma_f32 v[8:9], v[8:9], s[58:59], v[238:239]
    v_pk_fma_f32 v[10:11], v[10:11], s[58:59], v[238:239]
    v_pk_fma_f32 v[12:13], v[12:13], s[58:59], v[238:239]
    v_pk_fma_f32 v[14:15], v[14:15], s[58:59], v[238:239]
    v_pk_fma_f32 v[16:17], v[16:17], s[58:59], v[238:239]
    v_pk_fma_f32 v[18:19], v[18:19], s[58:59], v[238:239]
    v_pk_mul_f32 v[8:9], v[8:9], v[200:201]
    v_pk_mul_f32 v[10:11], v[10:11], v[202:203]
    v_pk_mul_f32 v[12:13], v[12:13], v[204:205]
    v_pk_mul_f32 v[14:15], v[14:15], v[206:207]
    v_pk_mul_f32 v[16:17], v[16:17], v[208:209]
    v_pk_mul_f32 v[18:19], v[18:19], v[210:211]
    v_exp_f32 v8, v8
    v_exp_f32 v9, v9
    v_exp_f32 v10, v10
    v_exp_f32 v11, v11
    v_exp_f32 v12, v12
    v_exp_f32 v13, v13
    v_exp_f32 v14, v14
    v_exp_f32 v15, v15
    v_exp_f32 v16, v16
    v_exp_f32 v17, v17
    v_exp_f32 v18, v18
    v_exp_f32 v19, v19
    v_pk_add_f32 v[8:9], v[8:9], 1.0 op_sel_hi:[1,0]
    v_pk_add_f32 v[10:11], v[10:11], 1.0 op_sel_hi:[1,0]
    v_pk_add_f32 v[12:13], v[12:13], 1.0 op_sel_hi:[1,0]
    v_pk_add_f32 v[14:15], v[14:15], 1.0 op_sel_hi:[1,0]
    v_pk_add_f32 v[16:17], v[16:17], 1.0 op_sel_hi:[1,0]
    v_pk_add_f32 v[18:19], v[18:19], 1.0 op_sel_hi:[1,0]
    v_rcp_f32 v8, v8
    v_rcp_f32 v9, v9
    v_rcp_f32 v10, v10
    v_rcp_f32 v11, v11
    v_rcp_f32 v12, v12
    v_rcp_f32 v13, v13
    v_rcp_f32 v14, v14
    v_rcp_f32 v15, v15
    v_rcp_f32 v16, v16
    v_rcp_f32 v17, v17
    v_rcp_f32 v18, v18
    v_rcp_f32 v19, v19
    v_pk_mul_f32 v[200:201], v[200:201], v[8:9]
    v_pk_mul_f32 v[202:203], v[202:203], v[10:11]
    v_pk_mul_f32 v[204:205], v[204:205], v[12:13]
    v_pk_mul_f32 v[206:207], v[206:207], v[14:15]
    v_pk_mul_f32 v[208:209], v[208:209], v[16:17]
    v_pk_mul_f32 v[210:211], v[210:211], v[18:19]
    v_pk_add_f32 v[14:15], v[200:201], v[202:203]
    v_pk_mul_f32 v[16:17], v[200:201], v[200:201]
    v_pk_add_f32 v[18:19], v[204:205], v[206:207]
    v_pk_fma_f32 v[16:17], v[202:203], v[202:203], v[16:17]
    v_pk_add_f32 v[20:21], v[208:209], v[210:211]
    v_pk_fma_f32 v[16:17], v[204:205], v[204:205], v[16:17]
    v_pk_add_f32 v[14:15], v[14:15], v[18:19]
    v_pk_fma_f32 v[16:17], v[206:207], v[206:207], v[16:17]
    v_pk_add_f32 v[14:15], v[14:15], v[20:21]
    v_pk_fma_f32 v[16:17], v[208:209], v[208:209], v[16:17]
    v_pk_fma_f32 v[16:17], v[210:211], v[210:211], v[16:17]
    v_add_f32 v8, v14, v15
    v_add_f32 v9, v16, v17
    v_lshl_add_u32 v4, v3, 3, s76
    v_mov_b32 v12, v8
    v_mov_b32 v13, v9
    s_nop 0
    v_permlane16_swap_b32 v8, v12
    v_permlane16_swap_b32 v9, v13
    v_add_f32 v8, v8, v12
    v_add_f32 v9, v9, v13
    v_mov_b32 v12, v8
    v_mov_b32 v13, v9
    s_nop 0
    v_permlane32_swap_b32 v8, v12
    v_permlane32_swap_b32 v9, v13
    v_add_f32 v8, v8, v12
    v_add_f32 v9, v9, v13
    s_mov_b64 exec, 0xffff
    ds_write_b64 v4, v[8:9]
    s_mov_b64 exec, -1
    s_or_b32 s48, s41, s43
    s_cmp_eq_u32 s48, 0
    v_lshlrev_b32 v4, 3, v3
    s_cselect_b64 exec, 0xffff, 0
    buffer_store_dwordx2 v[240:241], v4, s[24:27], s79 offen sc1
    s_mov_b64 exec, -1
    v_mfma_f32_16x16x32_bf16 v[176:179], v[152:155], v[48:51], 0
    ds_read_b64_tr_b16 v[128:129], v217 offset:0
    ds_read_b64_tr_b16 v[130:131], v217 offset:768
    v_mfma_f32_16x16x32_bf16 v[180:183], v[152:155], v[52:55], 0
    s_add_u32 s65, s54, s98
    s_add_u32 m0, s61, 131072
    s_nop 0
    buffer_load_dwordx4 v40, s[8:11], s65 offen lds
    ds_read_b64_tr_b16 v[132:133], v218 offset:0
    ds_read_b64_tr_b16 v[134:135], v218 offset:768
    v_mfma_f32_16x16x32_bf16 v[224:227], v[152:155], v[244:247], 0
    ds_read_b64_tr_b16 v[136:137], v219 offset:0
    ds_read_b64_tr_b16 v[138:139], v219 offset:768
    v_mfma_f32_16x16x32_bf16 v[184:187], v[156:159], v[48:51], 0
    ds_read_b64_tr_b16 v[140:141], v220 offset:0
    ds_read_b64_tr_b16 v[142:143], v220 offset:768
    v_mfma_f32_16x16x32_bf16 v[188:191], v[156:159], v[52:55], 0
    s_add_u32 s65, s54, s98
    s_add_u32 m0, s61, 132096
    s_nop 0
    buffer_load_dwordx4 v41, s[8:11], s65 offen lds
    ds_read_b64_tr_b16 v[144:145], v221 offset:0
    ds_read_b64_tr_b16 v[146:147], v221 offset:768
    v_mfma_f32_16x16x32_bf16 v[228:231], v[156:159], v[244:247], 0
    ds_read_b64_tr_b16 v[148:149], v222 offset:0
    ds_read_b64_tr_b16 v[150:151], v222 offset:768
    v_mfma_f32_16x16x32_bf16 v[192:195], v[160:163], v[48:51], 0
    v_mfma_f32_16x16x32_bf16 v[196:199], v[160:163], v[52:55], 0
    s_add_u32 s65, s54, s98
    s_add_u32 m0, s61, 133120
    s_nop 0
    buffer_load_dwordx4 v42, s[8:11], s65 offen lds
    v_mfma_f32_16x16x32_bf16 v[232:235], v[160:163], v[244:247], 0
    v_mfma_f32_16x16x32_bf16 v[176:179], v[164:167], v[56:59], v[176:179]
    v_mfma_f32_16x16x32_bf16 v[180:183], v[164:167], v[60:63], v[180:183]
    v_mul_u32_u24 v4, 1280, v43
    v_lshl_add_u32 v4, v44, 4, v4
    s_mul_i32 s51, s41, 160
    s_add_u32 s51, s51, s52
    s_mul_i32 s48, s42, 7680
    s_add_u32 s48, s48, s51
    s_sub_i32 s48, s48, 3840
    s_cmp_lt_i32 s48, 0
    s_cselect_b32 s49, 3840, 0
    s_add_u32 s48, s48, s49
    v_subrev_u32 v5, s49, v4
    s_mul_i32 s50, s42, 960
    s_add_u32 m0, s50, 65536
    s_mov_b32 exec_lo, -1
    s_mov_b32 exec_hi, 0xfffffff
    buffer_load_dwordx4 v5, s[12:15], s48 offen lds
    s_mov_b64 exec, -1
    v_mfma_f32_16x16x32_bf16 v[184:187], v[168:171], v[56:59], v[184:187]
    v_mfma_f32_16x16x32_bf16 v[188:191], v[168:171], v[60:63], v[188:191]
    v_mfma_f32_16x16x32_bf16 v[192:195], v[172:175], v[56:59], v[192:195]
    s_cmp_ge_u32 s42, 4
    s_mov_b32 exec_lo, -1
    s_mov_b32 exec_hi, 0xfffffff
    s_cbranch_scc1 k1_kvv_2
    s_mul_i32 s48, s42, 7680
    s_add_u32 s48, s48, s51
    s_add_u32 s48, s48, 57600
    s_mul_i32 s50, s42, 960
    s_add_u32 m0, s50, 73216
    s_nop 0
    buffer_load_dwordx4 v4, s[12:15], s48 offen lds
    s_branch k1_kve_3
k1_kvv_2:
    s_sub_u32 s49, s42, 4
    s_mul_i32 s48, s49, 7680
    s_add_u32 s48, s48, s51
    s_mul_i32 s50, s49, 960
    s_add_u32 m0, s50, 49152
    s_nop 0
    buffer_load_dwordx4 v4, s[16:19], s48 offen lds
k1_kve_3:
    s_mov_b64 exec, -1
    v_mfma_f32_16x16x32_bf16 v[196:199], v[172:175], v[60:63], v[196:199]
    s_add_u32 s49, s42, 4
    s_mul_i32 s48, s49, 7680
    s_add_u32 s48, s48, s51
    s_mul_i32 s50, s49, 960
    s_add_u32 m0, s50, 49152
    s_mov_b32 exec_lo, -1
    s_mov_b32 exec_hi, 0xfffffff
    buffer_load_dwordx4 v4, s[16:19], s48 offen lds
    s_mov_b64 exec, -1
    s_mul_i32 s48, s89, 1280
    s_add_u32 s48, s48, 640
    s_mov_b64 exec, 0x1f
    buffer_load_dword v37, v36, s[36:39], s48 offen
    s_mov_b64 exec, -1
    s_waitcnt vmcnt(8)
    s_waitcnt lgkmcnt(0)
    s_barrier
    s_cmp_lg_u32 s42, 0
    s_cbranch_scc1 k1_pub_4
    v_lshlrev_b32 v4, 3, v1
    v_add_u32 v5, 159744, v4
    ds_read_b64 v[8:9], v5
    ds_read_b64 v[12:13], v5 offset:512
    v_lshlrev_b32 v4, 4, v1
    v_mov_b32 v10, s100
    v_mov_b32 v11, s101
    s_waitcnt lgkmcnt(0)
    v_pk_add_f32 v[8:9], v[8:9], v[12:13]
k1_pub_4:
    s_cmp_eq_u32 s42, 0
    s_cselect_b64 exec, -1, 0
    buffer_store_dwordx4 v[8:11], v4, s[24:27], s77 offen sc1
    s_mov_b64 exec, -1
    v_mfma_f32_16x16x32_bf16 v[176:179], v[128:131], v[64:67], v[176:179]
    ds_read_b64_tr_b16 v[152:153], v217 offset:24576
    ds_read_b64_tr_b16 v[154:155], v217 offset:25344
    v_mfma_f32_16x16x32_bf16 v[180:183], v[128:131], v[68:71], v[180:183]
    s_add_u32 s65, s54, s99
    s_add_u32 m0, s61, 81920
    s_nop 0
    buffer_load_dwordx4 v40, s[8:11], s65 offen lds
    ds_read_b64_tr_b16 v[156:157], v218 offset:24576
    ds_read_b64_tr_b16 v[158:159], v218 offset:25344
    v_mfma_f32_16x16x32_bf16 v[224:227], v[128:131], v[244:247], v[224:227]
    ds_read_b64_tr_b16 v[160:161], v219 offset:24576
    ds_read_b64_tr_b16 v[162:163], v219 offset:25344
    v_mfma_f32_16x16x32_bf16 v[184:187], v[132:135], v[64:67], v[184:187]
    ds_read_b64_tr_b16 v[164:165], v220 offset:24576
    ds_read_b64_tr_b16 v[166:167], v220 offset:25344
    v_mfma_f32_16x16x32_bf16 v[188:191], v[132:135], v[68:71], v[188:191]
    s_add_u32 s65, s54, s99
    s_add_u32 m0, s61, 82944
    s_nop 0
    buffer_load_dwordx4 v41, s[8:11], s65 offen lds
    ds_read_b64_tr_b16 v[168:169], v221 offset:24576
    ds_read_b64_tr_b16 v[170:171], v221 offset:25344
    v_mfma_f32_16x16x32_bf16 v[228:231], v[132:135], v[244:247], v[228:231]
    ds_read_b64_tr_b16 v[172:173], v222 offset:24576
    ds_read_b64_tr_b16 v[174:175], v222 offset:25344
    v_mfma_f32_16x16x32_bf16 v[192:195], v[136:139], v[64:67], v[192:195]
    v_mfma_f32_16x16x32_bf16 v[196:199], v[136:139], v[68:71], v[196:199]
    s_add_u32 s65, s54, s99
    s_add_u32 m0, s61, 83968
    s_nop 0
    buffer_load_dwordx4 v42, s[8:11], s65 offen lds
    v_mfma_f32_16x16x32_bf16 v[232:235], v[136:139], v[244:247], v[232:235]
    v_mfma_f32_16x16x32_bf16 v[176:179], v[140:143], v[72:75], v[176:179]
    v_mfma_f32_16x16x32_bf16 v[180:183], v[140:143], v[76:79], v[180:183]
    v_mfma_f32_16x16x32_bf16 v[184:187], v[144:147], v[72:75], v[184:187]
    v_mfma_f32_16x16x32_bf16 v[188:191], v[144:147], v[76:79], v[188:191]
    v_mfma_f32_16x16x32_bf16 v[192:195], v[148:151], v[72:75], v[192:195]
    v_mfma_f32_16x16x32_bf16 v[196:199], v[148:151], v[76:79], v[196:199]
    s_waitcnt vmcnt(8)
    s_waitcnt lgkmcnt(0)
    s_barrier
    v_mfma_f32_16x16x32_bf16 v[176:179], v[152:155], v[80:83], v[176:179]
    ds_read_b64_tr_b16 v[128:129], v217 offset:49152
    ds_read_b64_tr_b16 v[130:131], v217 offset:49920
    v_mfma_f32_16x16x32_bf16 v[180:183], v[152:155], v[84:87], v[180:183]
    s_add_u32 s48, s66, 0
    s_mov_b64 exec, 0xff
    buffer_load_dword v37, v215, s[32:35], s48 offen
    s_mov_b64 exec, -1
    ds_read_b64_tr_b16 v[132:133], v218 offset:49152
    ds_read_b64_tr_b16 v[134:135], v218 offset:49920
    v_mfma_f32_16x16x32_bf16 v[224:227], v[152:155], v[244:247], v[224:227]
    ds_read_b64_tr_b16 v[136:137], v219 offset:49152
    ds_read_b64_tr_b16 v[138:139], v219 offset:49920
    v_mfma_f32_16x16x32_bf16 v[184:187], v[156:159], v[80:83], v[184:187]
    ds_read_b64_tr_b16 v[140:141], v220 offset:49152
    ds_read_b64_tr_b16 v[142:143], v220 offset:49920
    v_mfma_f32_16x16x32_bf16 v[188:191], v[156:159], v[84:87], v[188:191]
    s_add_u32 s48, s66, 128
    s_mov_b64 exec, 0xff
    buffer_load_dword v37, v215, s[32:35], s48 offen
    s_mov_b64 exec, -1
    ds_read_b64_tr_b16 v[144:145], v221 offset:49152
    ds_read_b64_tr_b16 v[146:147], v221 offset:49920
    v_mfma_f32_16x16x32_bf16 v[228:231], v[156:159], v[244:247], v[228:231]
    ds_read_b64_tr_b16 v[148:149], v222 offset:49152
    ds_read_b64_tr_b16 v[150:151], v222 offset:49920
    v_mfma_f32_16x16x32_bf16 v[192:195], v[160:163], v[80:83], v[192:195]
    v_mfma_f32_16x16x32_bf16 v[196:199], v[160:163], v[84:87], v[196:199]
    s_add_u32 s48, s66, 256
    s_mov_b64 exec, 0xff
    buffer_load_dword v37, v215, s[32:35], s48 offen
    s_mov_b64 exec, -1
    v_mfma_f32_16x16x32_bf16 v[232:235], v[160:163], v[244:247], v[232:235]
    v_mfma_f32_16x16x32_bf16 v[176:179], v[164:167], v[88:91], v[176:179]
    v_mfma_f32_16x16x32_bf16 v[180:183], v[164:167], v[92:95], v[180:183]
    s_add_u32 s48, s66, 384
    s_mov_b64 exec, 0xff
    buffer_load_dword v37, v215, s[32:35], s48 offen
    s_mov_b64 exec, -1
    v_mfma_f32_16x16x32_bf16 v[184:187], v[168:171], v[88:91], v[184:187]
    v_mfma_f32_16x16x32_bf16 v[188:191], v[168:171], v[92:95], v[188:191]
    v_mfma_f32_16x16x32_bf16 v[192:195], v[172:175], v[88:91], v[192:195]
    s_mul_i32 s48, s89, 512
    s_add_u32 s48, s48, 0
    s_mov_b64 exec, 0xf
    buffer_load_dword v37, v36, s[84:87], s48 offen
    s_mov_b64 exec, -1
    v_mfma_f32_16x16x32_bf16 v[196:199], v[172:175], v[92:95], v[196:199]
    s_waitcnt vmcnt(5)
    s_waitcnt lgkmcnt(0)
    s_barrier
    v_lshlrev_b32 v38, 4, v3
    v_lshl_add_u32 v38, v2, 11, v38
    buffer_load_dwordx4 v[28:31], v38, s[24:27], s78 offen sc1
    buffer_load_dwordx4 v[32:35], v38, s[24:27], s78 offen offset:1024 sc1
    v_mfma_f32_16x16x32_bf16 v[176:179], v[128:131], v[96:99], v[176:179]
    ds_read_b64_tr_b16 v[152:153], v217 offset:0
    ds_read_b64_tr_b16 v[154:155], v217 offset:768
    v_mfma_f32_16x16x32_bf16 v[180:183], v[128:131], v[100:103], v[180:183]
    s_add_u32 s48, s66, 512
    s_mov_b64 exec, 0xff
    buffer_load_dword v37, v215, s[32:35], s48 offen
    s_mov_b64 exec, -1
    ds_read_b64_tr_b16 v[156:157], v218 offset:0
    ds_read_b64_tr_b16 v[158:159], v218 offset:768
    v_mfma_f32_16x16x32_bf16 v[224:227], v[128:131], v[244:247], v[224:227]
    ds_read_b64_tr_b16 v[160:161], v219 offset:0
    ds_read_b64_tr_b16 v[162:163], v219 offset:768
    v_mfma_f32_16x16x32_bf16 v[184:187], v[132:135], v[96:99], v[184:187]
    ds_read_b64_tr_b16 v[164:165], v220 offset:0
    ds_read_b64_tr_b16 v[166:167], v220 offset:768
    v_mfma_f32_16x16x32_bf16 v[188:191], v[132:135], v[100:103], v[188:191]
    s_add_u32 s48, s66, 640
    s_mov_b64 exec, 0xff
    buffer_load_dword v37, v215, s[32:35], s48 offen
    s_mov_b64 exec, -1
    ds_read_b64_tr_b16 v[168:169], v221 offset:0
    ds_read_b64_tr_b16 v[170:171], v221 offset:768
    v_mfma_f32_16x16x32_bf16 v[228:231], v[132:135], v[244:247], v[228:231]
    ds_read_b64_tr_b16 v[172:173], v222 offset:0
    ds_read_b64_tr_b16 v[174:175], v222 offset:768
    v_mfma_f32_16x16x32_bf16 v[192:195], v[136:139], v[96:99], v[192:195]
    v_mfma_f32_16x16x32_bf16 v[196:199], v[136:139], v[100:103], v[196:199]
    s_add_u32 s48, s66, 768
    s_mov_b64 exec, 0xff
    buffer_load_dword v37, v215, s[32:35], s48 offen
    s_mov_b64 exec, -1
    v_mfma_f32_16x16x32_bf16 v[232:235], v[136:139], v[244:247], v[232:235]
    v_mfma_f32_16x16x32_bf16 v[176:179], v[140:143], v[104:107], v[176:179]
    v_mfma_f32_16x16x32_bf16 v[180:183], v[140:143], v[108:111], v[180:183]
    s_add_u32 s48, s66, 896
    s_mov_b64 exec, 0xff
    buffer_load_dword v37, v215, s[32:35], s48 offen
    s_mov_b64 exec, -1
    v_mfma_f32_16x16x32_bf16 v[184:187], v[144:147], v[104:107], v[184:187]
    v_mfma_f32_16x16x32_bf16 v[188:191], v[144:147], v[108:111], v[188:191]
    v_mfma_f32_16x16x32_bf16 v[192:195], v[148:151], v[104:107], v[192:195]
    v_mfma_f32_16x16x32_bf16 v[196:199], v[148:151], v[108:111], v[196:199]
    v_add_u32 v4, 65536, v7
    ds_read_b128 v[48:51], v4 offset:0
    ds_read_b128 v[52:55], v4 offset:160
    ds_read_b128 v[56:59], v4 offset:320
    ds_read_b128 v[60:63], v4 offset:480
    ds_read_b128 v[64:67], v4 offset:640
    v_add_u32 v4, 49152, v7
    ds_read_b128 v[68:71], v4
    ds_read_b128 v[72:75], v4 offset:160
    s_waitcnt lgkmcnt(0)
    v_mul_u32_u24 v7, 1152, v44
    v_lshlrev_b32 v102, 2, v43
    v_sub_u32 v7, v7, v102
    s_lshl_b32 s48, s42, 4
    s_add_u32 s48, s48, 106508
    v_add_u32 v7, s48, v7
    v_lshlrev_b32 v44, 6, v44
    v_add_u32 v44, 160768, v44
    ds_read_b128 v[104:107], v44 offset:0
    ds_read_b128 v[108:111], v44 offset:16
    v_lshlrev_b32 v76, 16, v48
    v_and_b32 v77, 0xffff0000, v48
    v_lshlrev_b32 v78, 16, v52
    v_and_b32 v79, 0xffff0000, v52
    v_lshlrev_b32 v80, 16, v56
    v_and_b32 v81, 0xffff0000, v56
    v_lshlrev_b32 v82, 16, v60
    v_and_b32 v83, 0xffff0000, v60
    v_lshlrev_b32 v84, 16, v64
    v_and_b32 v85, 0xffff0000, v64
    s_waitcnt lgkmcnt(0)
    v_lshlrev_b32 v86, 16, v104
    v_lshlrev_b32 v87, 16, v106
    v_and_b32 v88, 0xffff0000, v104
    v_and_b32 v89, 0xffff0000, v106
    v_lshlrev_b32 v90, 16, v105
    v_lshlrev_b32 v91, 16, v107
    v_and_b32 v92, 0xffff0000, v105
    v_and_b32 v93, 0xffff0000, v107
    v_pk_mul_f32 v[94:95], v[82:83], v[86:87]
    v_pk_mul_f32 v[96:97], v[84:85], v[86:87]
    v_pk_fma_f32 v[94:95], v[80:81], v[88:89], v[94:95]
    v_pk_fma_f32 v[96:97], v[82:83], v[88:89], v[96:97]
    v_pk_fma_f32 v[94:95], v[78:79], v[90:91], v[94:95]
    v_pk_fma_f32 v[96:97], v[80:81], v[90:91], v[96:97]
    v_pk_fma_f32 v[94:95], v[76:77], v[92:93], v[94:95]
    v_pk_fma_f32 v[96:97], v[78:79], v[92:93], v[96:97]
    v_lshlrev_b32 v98, 16, v68
    v_and_b32 v99, 0xffff0000, v68
    v_lshlrev_b32 v100, 16, v72
    v_and_b32 v101, 0xffff0000, v72
    v_pk_mul_f32 v[94:95], v[94:95], v[98:99]
    v_pk_mul_f32 v[96:97], v[96:97], v[100:101]
    v_cvt_pk_bf16_f32 v102, v96, v94
    v_cvt_pk_bf16_f32 v103, v97, v95
    s_mov_b32 exec_hi, 0xff
    ds_write_b32 v7, v102 offset:0
    ds_write_b32 v7, v103 offset:144
    s_mov_b32 exec_hi, -1
    v_lshlrev_b32 v76, 16, v49
    v_and_b32 v77, 0xffff0000, v49
    v_lshlrev_b32 v78, 16, v53
    v_and_b32 v79, 0xffff0000, v53
    v_lshlrev_b32 v80, 16, v57
    v_and_b32 v81, 0xffff0000, v57
    v_lshlrev_b32 v82, 16, v61
    v_and_b32 v83, 0xffff0000, v61
    v_lshlrev_b32 v84, 16, v65
    v_and_b32 v85, 0xffff0000, v65
    v_lshlrev_b32 v86, 16, v108
    v_lshlrev_b32 v87, 16, v110
    v_and_b32 v88, 0xffff0000, v108
    v_and_b32 v89, 0xffff0000, v110
    v_lshlrev_b32 v90, 16, v109
    v_lshlrev_b32 v91, 16, v111
    v_and_b32 v92, 0xffff0000, v109
    v_and_b32 v93, 0xffff0000, v111
    v_pk_mul_f32 v[94:95], v[82:83], v[86:87]
    v_pk_mul_f32 v[96:97], v[84:85], v[86:87]
    v_pk_fma_f32 v[94:95], v[80:81], v[88:89], v[94:95]
    v_pk_fma_f32 v[96:97], v[82:83], v[88:89], v[96:97]
    v_pk_fma_f32 v[94:95], v[78:79], v[90:91], v[94:95]
    v_pk_fma_f32 v[96:97], v[80:81], v[90:91], v[96:97]
    v_pk_fma_f32 v[94:95], v[76:77], v[92:93], v[94:95]
    v_pk_fma_f32 v[96:97], v[78:79], v[92:93], v[96:97]
    v_lshlrev_b32 v98, 16, v69
    v_and_b32 v99, 0xffff0000, v69
    v_lshlrev_b32 v100, 16, v73
    v_and_b32 v101, 0xffff0000, v73
    v_pk_mul_f32 v[94:95], v[94:95], v[98:99]
    v_pk_mul_f32 v[96:97], v[96:97], v[100:101]
    v_cvt_pk_bf16_f32 v102, v96, v94
    v_cvt_pk_bf16_f32 v103, v97, v95
    s_mov_b32 exec_hi, 0xff
    ds_write_b32 v7, v102 offset:288
    ds_write_b32 v7, v103 offset:432
    s_mov_b32 exec_hi, -1
    ds_read_b128 v[104:107], v44 offset:32
    ds_read_b128 v[108:111], v44 offset:48
    v_lshlrev_b32 v76, 16, v50
    v_and_b32 v77, 0xffff0000, v50
    v_lshlrev_b32 v78, 16, v54
    v_and_b32 v79, 0xffff0000, v54
    v_lshlrev_b32 v80, 16, v58
    v_and_b32 v81, 0xffff0000, v58
    v_lshlrev_b32 v82, 16, v62
    v_and_b32 v83, 0xffff0000, v62
    v_lshlrev_b32 v84, 16, v66
    v_and_b32 v85, 0xffff0000, v66
    s_waitcnt lgkmcnt(0)
    v_lshlrev_b32 v86, 16, v104
    v_lshlrev_b32 v87, 16, v106
    v_and_b32 v88, 0xffff0000, v104
    v_and_b32 v89, 0xffff0000, v106
    v_lshlrev_b32 v90, 16, v105
    v_lshlrev_b32 v91, 16, v107
    v_and_b32 v92, 0xffff0000, v105
    v_and_b32 v93, 0xffff0000, v107
    v_pk_mul_f32 v[94:95], v[82:83], v[86:87]
    v_pk_mul_f32 v[96:97], v[84:85], v[86:87]
    v_pk_fma_f32 v[94:95], v[80:81], v[88:89], v[94:95]
    v_pk_fma_f32 v[96:97], v[82:83], v[88:89], v[96:97]
    v_pk_fma_f32 v[94:95], v[78:79], v[90:91], v[94:95]
    v_pk_fma_f32 v[96:97], v[80:81], v[90:91], v[96:97]
    v_pk_fma_f32 v[94:95], v[76:77], v[92:93], v[94:95]
    v_pk_fma_f32 v[96:97], v[78:79], v[92:93], v[96:97]
    v_lshlrev_b32 v98, 16, v70
    v_and_b32 v99, 0xffff0000, v70
    v_lshlrev_b32 v100, 16, v74
    v_and_b32 v101, 0xffff0000, v74
    v_pk_mul_f32 v[94:95], v[94:95], v[98:99]
    v_pk_mul_f32 v[96:97], v[96:97], v[100:101]
    v_cvt_pk_bf16_f32 v102, v96, v94
    v_cvt_pk_bf16_f32 v103, v97, v95
    s_mov_b32 exec_hi, 0xff
    ds_write_b32 v7, v102 offset:576
    ds_write_b32 v7, v103 offset:720
    s_mov_b32 exec_hi, -1
    v_lshlrev_b32 v76, 16, v51
    v_and_b32 v77, 0xffff0000, v51
    v_lshlrev_b32 v78, 16, v55
    v_and_b32 v79, 0xffff0000, v55
    v_lshlrev_b32 v80, 16, v59
    v_and_b32 v81, 0xffff0000, v59
    v_lshlrev_b32 v82, 16, v63
    v_and_b32 v83, 0xffff0000, v63
    v_lshlrev_b32 v84, 16, v67
    v_and_b32 v85, 0xffff0000, v67
    v_lshlrev_b32 v86, 16, v108
    v_lshlrev_b32 v87, 16, v110
    v_and_b32 v88, 0xffff0000, v108
    v_and_b32 v89, 0xffff0000, v110
    v_lshlrev_b32 v90, 16, v109
    v_lshlrev_b32 v91, 16, v111
    v_and_b32 v92, 0xffff0000, v109
    v_and_b32 v93, 0xffff0000, v111
    v_pk_mul_f32 v[94:95], v[82:83], v[86:87]
    v_pk_mul_f32 v[96:97], v[84:85], v[86:87]
    v_pk_fma_f32 v[94:95], v[80:81], v[88:89], v[94:95]
    v_pk_fma_f32 v[96:97], v[82:83], v[88:89], v[96:97]
    v_pk_fma_f32 v[94:95], v[78:79], v[90:91], v[94:95]
    v_pk_fma_f32 v[96:97], v[80:81], v[90:91], v[96:97]
    v_pk_fma_f32 v[94:95], v[76:77], v[92:93], v[94:95]
    v_pk_fma_f32 v[96:97], v[78:79], v[92:93], v[96:97]
    v_lshlrev_b32 v98, 16, v71
    v_and_b32 v99, 0xffff0000, v71
    v_lshlrev_b32 v100, 16, v75
    v_and_b32 v101, 0xffff0000, v75
    v_pk_mul_f32 v[94:95], v[94:95], v[98:99]
    v_pk_mul_f32 v[96:97], v[96:97], v[100:101]
    v_cvt_pk_bf16_f32 v102, v96, v94
    v_cvt_pk_bf16_f32 v103, v97, v95
    s_mov_b32 exec_hi, 0xff
    ds_write_b32 v7, v102 offset:864
    ds_write_b32 v7, v103 offset:1008
    s_mov_b32 exec_hi, -1
    s_lshl_b32 s48, s47, 4
    v_add_u32 v43, s48, v3
    v_mul_u32_u24 v43, 200, v43
    v_lshl_add_u32 v43, v2, 3, v43
    s_mul_i32 s48, s43, 96
    s_add_u32 s48, s48, 0
    v_add_u32 v43, s48, v43
    s_waitcnt vmcnt(4)
    s_mov_b32 s65, 0
k1_poll_5:
    s_add_u32 s65, s65, 1
    s_cmp_gt_u32 s65, 100000
    s_cbranch_scc1 k1_polled_6
    v_cmp_ne_u32 vcc, s100, v30
    v_cmp_ne_u32 s[50:51], s101, v31
    s_nop 0
    s_or_b64 vcc, vcc, s[50:51]
    v_cmp_ne_u32 s[50:51], s100, v34
    s_nop 0
    s_or_b64 vcc, vcc, s[50:51]
    v_cmp_ne_u32 s[50:51], s101, v35
    s_nop 0
    s_or_b64 vcc, vcc, s[50:51]
    s_cmp_eq_u64 vcc, 0
    s_cbranch_scc1 k1_polled_6
    s_sleep 4
    buffer_load_dwordx4 v[28:31], v38, s[24:27], s78 offen sc1
    buffer_load_dwordx4 v[32:35], v38, s[24:27], s78 offen offset:1024 sc1
    s_waitcnt vmcnt(0)
    s_branch k1_poll_5
k1_polled_6:
    s_xor_b32 s48, s42, 1
    s_or_b32 s48, s48, s41
    s_cmp_lg_u32 s48, 0
    s_cbranch_scc1 k1_ep_7
    v_mov_b32 v4, 0
    v_mov_b32 v44, 1
    s_mov_b64 exec, 1
    buffer_atomic_add v44, v4, s[28:31], 0 offen sc0
    s_mov_b64 exec, -1
k1_ep_7:
    v_pk_add_f32 v[8:9], v[28:29], v[32:33]
    v_mov_b32 v10, v8
    v_mov_b32 v11, v9
    s_nop 0
    v_permlane16_swap_b32 v8, v10
    v_permlane16_swap_b32 v9, v11
    v_add_f32 v8, v8, v10
    v_add_f32 v9, v9, v11
    v_mov_b32 v10, v8
    v_mov_b32 v11, v9
    s_nop 0
    v_permlane32_swap_b32 v8, v10
    v_permlane32_swap_b32 v9, v11
    v_add_f32 v8, v8, v10
    v_add_f32 v9, v9, v11
    v_mul_f32 v8, 0x3aaaaaab, v8
    v_mul_f32 v9, 0x3aaaaaab, v9
    v_fma_f32 v9, -v8, v8, v9
    v_max_f32 v9, 0, v9
    v_cvt_pk_bf16_f32 v9, v9, v8
    v_and_b32 v8, 0xffff0000, v9
    v_lshlrev_b32 v9, 16, v9
    v_add_f32 v9, s55, v9
    v_cvt_pk_bf16_f32 v9, v9, v9
    v_and_b32 v9, 0xffff0000, v9
    v_sqrt_f32 v9, v9
    s_nop 0
    v_cvt_pk_bf16_f32 v9, v9, v9
    v_and_b32 v9, 0xffff0000, v9
    v_rcp_f32 v9, v9
    s_nop 0
    v_mov_b32 v10, v9
    v_pk_add_f32 v[200:201], v[200:201], v[8:9] op_sel_hi:[1,0] neg_lo:[0,1] neg_hi:[0,1]
    v_pk_add_f32 v[202:203], v[202:203], v[8:9] op_sel_hi:[1,0] neg_lo:[0,1] neg_hi:[0,1]
    v_pk_add_f32 v[204:205], v[204:205], v[8:9] op_sel_hi:[1,0] neg_lo:[0,1] neg_hi:[0,1]
    v_pk_add_f32 v[206:207], v[206:207], v[8:9] op_sel_hi:[1,0] neg_lo:[0,1] neg_hi:[0,1]
    v_pk_add_f32 v[208:209], v[208:209], v[8:9] op_sel_hi:[1,0] neg_lo:[0,1] neg_hi:[0,1]
    v_pk_add_f32 v[210:211], v[210:211], v[8:9] op_sel_hi:[1,0] neg_lo:[0,1] neg_hi:[0,1]
    v_pk_mul_f32 v[200:201], v[200:201], v[10:11] op_sel_hi:[1,0]
    v_pk_mul_f32 v[202:203], v[202:203], v[10:11] op_sel_hi:[1,0]
    v_pk_mul_f32 v[204:205], v[204:205], v[10:11] op_sel_hi:[1,0]
    v_pk_mul_f32 v[206:207], v[206:207], v[10:11] op_sel_hi:[1,0]
    v_pk_mul_f32 v[208:209], v[208:209], v[10:11] op_sel_hi:[1,0]
    v_pk_mul_f32 v[210:211], v[210:211], v[10:11] op_sel_hi:[1,0]
    v_cvt_pk_bf16_f32 v16, v200, v201
    v_cvt_pk_bf16_f32 v17, v202, v203
    ds_write_b64 v43, v[16:17] offset:0
    v_cvt_pk_bf16_f32 v18, v204, v205
    v_cvt_pk_bf16_f32 v19, v206, v207
    ds_write_b64 v43, v[18:19] offset:32
    v_cvt_pk_bf16_f32 v20, v208, v209
    v_cvt_pk_bf16_f32 v21, v210, v211
    ds_write_b64 v43, v[20:21] offset:64
    v_lshrrev_b32 v212, 1, v2
    v_lshrrev_b32 v5, 2, v3
    v_lshl_add_u32 v212, v212, 3, v5
    v_mul_u32_u24 v212, 200, v212
    v_and_b32 v5, 1, v2
    v_lshl_add_u32 v212, v5, 5, v212
    v_and_b32 v5, 3, v3
    v_lshl_add_u32 v212, v5, 3, v212
    v_lshlrev_b32 v213, 4, v1
    s_waitcnt lgkmcnt(0)
    s_barrier
    v_add_u32 v5, s88, v212
    ds_read_b64_tr_b16 v[8:9], v5
    ds_read_b64_tr_b16 v[10:11], v5 offset:800
    s_waitcnt lgkmcnt(0)
    buffer_store_dwordx4 v[8:11], v213, s[24:27], s64 offen sc1
    s_cmp_ge_u32 s42, 4
    s_cbranch_scc1 k1_fr_8
    v_add_u32 v5, s63, v212
    ds_read_b64_tr_b16 v[12:13], v5
    ds_read_b64_tr_b16 v[14:15], v5 offset:800
    s_waitcnt lgkmcnt(0)
    buffer_store_dwordx4 v[12:15], v213, s[24:27], s67 offen sc1
k1_fr_8:
    s_lshl_b32 s48, s42, 3
    v_lshrrev_b32 v4, 3, v1
    v_add_u32 v4, s48, v4
    v_and_b32 v5, 7, v1
    v_lshlrev_b32 v5, 4, v5
    v_mul_u32_u24 v6, 144, v4
    v_add_u32 v6, v6, v5
    v_add_u32 v6, 106496, v6
    ds_read_b128 v[16:19], v6
    v_lshlrev_b32 v4, 12, v4
    v_add_u32 v4, v4, v5
    s_waitcnt lgkmcnt(0)
    buffer_store_dwordx4 v[16:19], v4, s[24:27], s83 offen sc1
    s_lshl_b32 s48, s42, 3
    s_add_u32 s48, s48, 64
    v_lshrrev_b32 v4, 3, v1
    v_add_u32 v4, s48, v4
    v_and_b32 v5, 7, v1
    v_lshlrev_b32 v5, 4, v5
    v_mul_u32_u24 v6, 144, v4
    v_add_u32 v6, v6, v5
    v_add_u32 v6, 106496, v6
    ds_read_b128 v[20:23], v6
    v_lshlrev_b32 v4, 12, v4
    v_add_u32 v4, v4, v5
    s_waitcnt lgkmcnt(0)
    s_cmp_ge_u32 s42, 2
    s_cbranch_scc1 k1_kvskip_9
    buffer_store_dwordx4 v[20:23], v4, s[24:27], s83 offen sc1
k1_kvskip_9:
    v_mfma_f32_16x16x32_bf16 v[176:179], v[152:155], v[112:115], v[176:179]
    v_mfma_f32_16x16x32_bf16 v[180:183], v[152:155], v[116:119], v[180:183]
    v_mfma_f32_16x16x32_bf16 v[224:227], v[152:155], v[244:247], v[224:227]
    v_mfma_f32_16x16x32_bf16 v[184:187], v[156:159], v[112:115], v[184:187]
    v_mfma_f32_16x16x32_bf16 v[188:191], v[156:159], v[116:119], v[188:191]
    v_mfma_f32_16x16x32_bf16 v[228:231], v[156:159], v[244:247], v[228:231]
    v_mfma_f32_16x16x32_bf16 v[192:195], v[160:163], v[112:115], v[192:195]
    v_mfma_f32_16x16x32_bf16 v[196:199], v[160:163], v[116:119], v[196:199]
    v_mfma_f32_16x16x32_bf16 v[232:235], v[160:163], v[244:247], v[232:235]
    v_mfma_f32_16x16x32_bf16 v[176:179], v[164:167], v[120:123], v[176:179]
    v_mfma_f32_16x16x32_bf16 v[180:183], v[164:167], v[124:127], v[180:183]
    v_mfma_f32_16x16x32_bf16 v[184:187], v[168:171], v[120:123], v[184:187]
    v_mfma_f32_16x16x32_bf16 v[188:191], v[168:171], v[124:127], v[188:191]
    v_mfma_f32_16x16x32_bf16 v[192:195], v[172:175], v[120:123], v[192:195]
    v_mfma_f32_16x16x32_bf16 v[196:199], v[172:175], v[124:127], v[196:199]
    v_lshl_add_u32 v4, v1, 4, s70
    v_lshl_add_u32 v5, v2, 4, s72
    s_nop 1
    ds_write_b128 v4, v[180:183] offset:0
    s_nop 0
    ds_write_b128 v4, v[188:191] offset:1024
    s_nop 0
    ds_write_b128 v4, v[196:199] offset:2048
    s_mov_b32 exec_lo, 0x00010001
    s_mov_b32 exec_hi, 0x00010001
    ds_write_b128 v5, v[224:227] offset:1536
    ds_write_b128 v5, v[228:231] offset:1600
    ds_write_b128 v5, v[232:235] offset:1664
    s_mov_b64 exec, -1
    v_pk_add_f32 v[128:129], v[176:177], 0
    v_pk_add_f32 v[130:131], v[178:179], 0
    v_pk_add_f32 v[132:133], v[184:185], 0
    v_pk_add_f32 v[134:135], v[186:187], 0
    v_pk_add_f32 v[136:137], v[192:193], 0
    v_pk_add_f32 v[138:139], v[194:195], 0
    s_waitcnt vmcnt(0) lgkmcnt(0)
    s_barrier
    s_lshl_b32 s48, s41, 8
    s_lshl_b32 s49, s40, 3
    s_add_u32 s48, s48, s49
    s_add_u32 s48, s48, 14716928
    v_mov_b32 v8, s100
    v_mov_b32 v9, s101
    v_mov_b32 v4, 0
    s_cmp_eq_u32 s42, 0
    s_cselect_b64 exec, 1, 0
    buffer_store_dwordx2 v[8:9], v4, s[24:27], s48 offen sc1
    s_mov_b64 exec, -1
    v_lshl_add_u32 v4, v1, 4, s71
    ds_read_b128 v[48:51], v4 offset:0
    ds_read_b128 v[52:55], v4 offset:1024
    ds_read_b128 v[56:59], v4 offset:2048
    v_lshl_add_u32 v6, v2, 4, s73
    ds_read_b128 v[64:67], v6 offset:1536
    ds_read_b128 v[68:71], v6 offset:1600
    ds_read_b128 v[72:75], v6 offset:1664
    ds_read_b128 v[76:79], v6 offset:1728
    ds_read_b128 v[80:83], v6 offset:1792
    ds_read_b128 v[84:87], v6 offset:1856
    ds_read_b128 v[88:91], v6 offset:1920
    ds_read_b128 v[92:95], v6 offset:1984
    ds_read_b128 v[96:99], v6 offset:2048
    ds_read_b128 v[100:103], v6 offset:2112
    ds_read_b128 v[104:107], v6 offset:2176
    ds_read_b128 v[108:111], v6 offset:2240
    s_waitcnt lgkmcnt(12)
    v_pk_add_f32 v[128:129], v[128:129], v[48:49]
    v_pk_add_f32 v[130:131], v[130:131], v[50:51]
    v_pk_add_f32 v[132:133], v[132:133], v[52:53]
    v_pk_add_f32 v[134:135], v[134:135], v[54:55]
    v_pk_add_f32 v[136:137], v[136:137], v[56:57]
    v_pk_add_f32 v[138:139], v[138:139], v[58:59]
    s_waitcnt lgkmcnt(6)
    v_pk_add_f32 v[64:65], v[64:65], v[76:77]
    v_pk_add_f32 v[66:67], v[66:67], v[78:79]
    v_pk_add_f32 v[68:69], v[68:69], v[80:81]
    v_pk_add_f32 v[70:71], v[70:71], v[82:83]
    v_pk_add_f32 v[72:73], v[72:73], v[84:85]
    v_pk_add_f32 v[74:75], v[74:75], v[86:87]
    s_waitcnt lgkmcnt(0)
    v_pk_add_f32 v[88:89], v[88:89], v[100:101]
    v_pk_add_f32 v[90:91], v[90:91], v[102:103]
    v_pk_add_f32 v[92:93], v[92:93], v[104:105]
    v_pk_add_f32 v[94:95], v[94:95], v[106:107]
    v_pk_add_f32 v[96:97], v[96:97], v[108:109]
    v_pk_add_f32 v[98:99], v[98:99], v[110:111]
    v_pk_add_f32 v[64:65], v[64:65], v[88:89]
    v_pk_add_f32 v[66:67], v[66:67], v[90:91]
    v_pk_add_f32 v[68:69], v[68:69], v[92:93]
    v_pk_add_f32 v[70:71], v[70:71], v[94:95]
    v_pk_add_f32 v[72:73], v[72:73], v[96:97]
    v_pk_add_f32 v[74:75], v[74:75], v[98:99]
    v_pk_fma_f32 v[128:129], v[64:65], v[240:241], v[128:129] op_sel_hi:[1,0,1] neg_lo:[0,1,0] neg_hi:[0,1,0]
    v_pk_fma_f32 v[130:131], v[66:67], v[240:241], v[130:131] op_sel_hi:[1,0,1] neg_lo:[0,1,0] neg_hi:[0,1,0]
    v_pk_fma_f32 v[132:133], v[68:69], v[240:241], v[132:133] op_sel_hi:[1,0,1] neg_lo:[0,1,0] neg_hi:[0,1,0]
    v_pk_fma_f32 v[134:135], v[70:71], v[240:241], v[134:135] op_sel_hi:[1,0,1] neg_lo:[0,1,0] neg_hi:[0,1,0]
    v_pk_fma_f32 v[136:137], v[72:73], v[240:241], v[136:137] op_sel_hi:[1,0,1] neg_lo:[0,1,0] neg_hi:[0,1,0]
    v_pk_fma_f32 v[138:139], v[74:75], v[240:241], v[138:139] op_sel_hi:[1,0,1] neg_lo:[0,1,0] neg_hi:[0,1,0]
    v_pk_mul_f32 v[128:129], v[128:129], v[242:243] op_sel_hi:[1,0]
    v_pk_mul_f32 v[130:131], v[130:131], v[242:243] op_sel_hi:[1,0]
    v_pk_mul_f32 v[132:133], v[132:133], v[242:243] op_sel_hi:[1,0]
    v_pk_mul_f32 v[134:135], v[134:135], v[242:243] op_sel_hi:[1,0]
    v_pk_mul_f32 v[136:137], v[136:137], v[242:243] op_sel_hi:[1,0]
    v_pk_mul_f32 v[138:139], v[138:139], v[242:243] op_sel_hi:[1,0]
    v_pk_mul_f32 v[48:49], v[128:129], v[128:129]
    v_pk_mul_f32 v[50:51], v[130:131], v[130:131]
    v_pk_mul_f32 v[52:53], v[132:133], v[132:133]
    v_pk_mul_f32 v[54:55], v[134:135], v[134:135]
    v_pk_mul_f32 v[56:57], v[136:137], v[136:137]
    v_pk_mul_f32 v[58:59], v[138:139], v[138:139]
    v_pk_fma_f32 v[48:49], v[48:49], s[58:59], v[238:239]
    v_pk_fma_f32 v[50:51], v[50:51], s[58:59], v[238:239]
    v_pk_fma_f32 v[52:53], v[52:53], s[58:59], v[238:239]
    v_pk_fma_f32 v[54:55], v[54:55], s[58:59], v[238:239]
    v_pk_fma_f32 v[56:57], v[56:57], s[58:59], v[238:239]
    v_pk_fma_f32 v[58:59], v[58:59], s[58:59], v[238:239]
    v_pk_mul_f32 v[48:49], v[48:49], v[128:129]
    v_pk_mul_f32 v[50:51], v[50:51], v[130:131]
    v_pk_mul_f32 v[52:53], v[52:53], v[132:133]
    v_pk_mul_f32 v[54:55], v[54:55], v[134:135]
    v_pk_mul_f32 v[56:57], v[56:57], v[136:137]
    v_pk_mul_f32 v[58:59], v[58:59], v[138:139]
    v_exp_f32 v48, v48
    v_exp_f32 v49, v49
    v_exp_f32 v50, v50
    v_exp_f32 v51, v51
    v_exp_f32 v52, v52
    v_exp_f32 v53, v53
    v_exp_f32 v54, v54
    v_exp_f32 v55, v55
    v_exp_f32 v56, v56
    v_exp_f32 v57, v57
    v_exp_f32 v58, v58
    v_exp_f32 v59, v59
    v_pk_add_f32 v[48:49], v[48:49], 1.0 op_sel_hi:[1,0]
    v_pk_add_f32 v[50:51], v[50:51], 1.0 op_sel_hi:[1,0]
    v_pk_add_f32 v[52:53], v[52:53], 1.0 op_sel_hi:[1,0]
    v_pk_add_f32 v[54:55], v[54:55], 1.0 op_sel_hi:[1,0]
    v_pk_add_f32 v[56:57], v[56:57], 1.0 op_sel_hi:[1,0]
    v_pk_add_f32 v[58:59], v[58:59], 1.0 op_sel_hi:[1,0]
    v_rcp_f32 v48, v48
    v_rcp_f32 v49, v49
    v_rcp_f32 v50, v50
    v_rcp_f32 v51, v51
    v_rcp_f32 v52, v52
    v_rcp_f32 v53, v53
    v_rcp_f32 v54, v54
    v_rcp_f32 v55, v55
    v_rcp_f32 v56, v56
    v_rcp_f32 v57, v57
    v_rcp_f32 v58, v58
    v_rcp_f32 v59, v59
    v_pk_mul_f32 v[128:129], v[128:129], v[48:49]
    v_pk_mul_f32 v[130:131], v[130:131], v[50:51]
    v_pk_mul_f32 v[132:133], v[132:133], v[52:53]
    v_pk_mul_f32 v[134:135], v[134:135], v[54:55]
    v_pk_mul_f32 v[136:137], v[136:137], v[56:57]
    v_pk_mul_f32 v[138:139], v[138:139], v[58:59]
    v_lshrrev_b32 v4, 1, v2
    v_mul_u32_u24 v4, 3072, v4
    v_and_b32 v5, 1, v2
    v_lshlrev_b32 v5, 5, v5
    v_add_u32 v5, v5, v3
    v_lshl_add_u32 v4, v5, 4, v4
    v_cvt_pk_bf16_f32 v48, v128, v129
    v_cvt_pk_bf16_f32 v49, v130, v131
    v_add_u32 v5, s80, v4
    ds_write_b64 v5, v[48:49]
    v_cvt_pk_bf16_f32 v50, v132, v133
    v_cvt_pk_bf16_f32 v51, v134, v135
    v_add_u32 v5, s81, v4
    ds_write_b64 v5, v[50:51]
    v_cvt_pk_bf16_f32 v52, v136, v137
    v_cvt_pk_bf16_f32 v53, v138, v139
    v_add_u32 v5, s82, v4
    ds_write_b64 v5, v[52:53]
    s_xor_b32 s48, s42, 1
    s_or_b32 s48, s48, s41
    s_cmp_lg_u32 s48, 0
    s_cbranch_scc1 k1_ep2_10
    s_waitcnt vmcnt(0)
    v_readfirstlane_b32 s48, v44
    s_nop 0
    s_cmp_lg_u32 s48, 31
    s_cbranch_scc1 k1_ep2_10
    v_mov_b32 v8, s100
    v_mov_b32 v9, s101
    v_mov_b32 v4, 14712832
    s_mov_b64 exec, 1
    buffer_store_dwordx2 v[8:9], v4, s[24:27], 0 offen sc1
    s_mov_b64 exec, -1
k1_ep2_10:
    s_waitcnt lgkmcnt(0)
    s_barrier
    s_cmp_ge_u32 s42, 4
    s_cbranch_scc1 recurrent_scan__ssm_conv_h3__mixer_gmlp__prompt_kernel_conv
    s_load_dwordx2 s[4:5], s[0:1], 64
    s_load_dwordx2 s[8:9], s[0:1], 104
    s_load_dwordx2 s[12:13], s[0:1], 72
    v_lshrrev_b32 v2, 6, v0
    v_and_b32 v1, 63, v0
    v_readfirstlane_b32 s34, v2
    s_mov_b32 s6, 8388608
    s_mov_b32 s7, 0x20000
    s_mov_b32 s10, 15990784
    s_mov_b32 s11, 0x20000
    s_mov_b32 s14, 4096
    s_mov_b32 s15, 0x20000
    s_and_b32 s40, s2, 7
    s_lshr_b32 s41, s2, 3
    s_and_b32 s41, s41, 31
    s_lshr_b32 s32, s40, 1
    s_lshl_b32 s32, s32, 3
    s_and_b32 s42, s41, 7
    s_add_u32 s32, s32, s42
    s_and_b32 s33, s40, 1
    s_lshl_b32 s33, s33, 2
    s_lshr_b32 s42, s41, 3
    s_add_u32 s33, s33, s42
    s_lshl_b32 s44, s33, 7
    s_lshl_b32 s40, s34, 5
    s_add_u32 s44, s44, s40
    s_mul_i32 s44, s44, 3072
    s_add_u32 s44, s44, 0
    s_lshl_b32 s45, s32, 18
    s_lshl_b32 s40, s34, 10
    s_add_u32 s45, s45, s40
    s_lshl_b32 s46, s34, 14
    v_lshlrev_b32 v5, 4, v1
    v_lshrrev_b32 v2, 3, v1
    v_lshlrev_b32 v2, 12, v2
    v_and_b32 v3, 7, v1
    v_lshrrev_b32 v4, 4, v1
    v_xor_b32 v3, v3, v4
    v_lshl_add_u32 v6, v3, 4, v2
    v_xor_b32 v7, 64, v6
    s_mov_b32 s50, 0
    s_waitcnt lgkmcnt(0)
    s_add_u32 s54, s50, 0
    s_and_b32 s54, s54, 7
    s_lshl_b32 s54, s54, 7
    s_add_u32 s54, s54, s45
    s_add_u32 s42, s54, 0
    s_add_u32 m0, s46, 0
    s_nop 0
    buffer_load_dwordx4 v6, s[4:7], s42 offen lds
    s_add_u32 s42, s54, 32768
    s_add_u32 m0, s46, 1024
    s_nop 0
    buffer_load_dwordx4 v7, s[4:7], s42 offen lds
    s_add_u32 s42, s54, 65536
    s_add_u32 m0, s46, 2048
    s_nop 0
    buffer_load_dwordx4 v6, s[4:7], s42 offen lds
    s_add_u32 s42, s54, 98304
    s_add_u32 m0, s46, 3072
    s_nop 0
    buffer_load_dwordx4 v7, s[4:7], s42 offen lds
    s_add_u32 s42, s54, 131072
    s_add_u32 m0, s46, 4096
    s_nop 0
    buffer_load_dwordx4 v6, s[4:7], s42 offen lds
    s_add_u32 s42, s54, 163840
    s_add_u32 m0, s46, 5120
    s_nop 0
    buffer_load_dwordx4 v7, s[4:7], s42 offen lds
    s_add_u32 s42, s54, 196608
    s_add_u32 m0, s46, 6144
    s_nop 0
    buffer_load_dwordx4 v6, s[4:7], s42 offen lds
    s_add_u32 s42, s54, 229376
    s_add_u32 m0, s46, 7168
    s_nop 0
    buffer_load_dwordx4 v7, s[4:7], s42 offen lds
    s_lshl_b32 s43, s33, 8
    s_add_u32 s43, s43, 14716928
    v_mbcnt_lo_u32_b32 v2, -1, 0
    v_mbcnt_hi_u32_b32 v2, -1, v2
    v_and_b32 v2, 31, v2
    v_lshlrev_b32 v2, 3, v2
    s_mov_b32 s67, 0
fpoll_11:
    buffer_load_dwordx2 v[104:105], v2, s[8:11], s43 offen sc1
    s_add_u32 s67, s67, 1
    s_waitcnt vmcnt(0)
    v_cmp_ne_u32 vcc, s100, v104
    v_cmp_ne_u32 s[64:65], s101, v105
    s_nop 0
    s_or_b64 vcc, vcc, s[64:65]
    s_cmp_gt_u32 s67, 100000
    s_cbranch_scc1 fpoll_e_12
    s_cmp_eq_u64 vcc, 0
    s_cbranch_scc1 fpoll_e_12
    s_sleep 2
    s_branch fpoll_11
fpoll_e_12:
    s_add_u32 s52, s50, 0
    s_and_b32 s52, s52, 7
    s_mul_i32 s52, s52, 12288
    s_add_u32 s52, s52, s44
    buffer_load_dwordx4 v[104:107], v5, s[8:11], s52 offen offset:0 sc1
    buffer_load_dwordx4 v[108:111], v5, s[8:11], s52 offen offset:1024 sc1
    buffer_load_dwordx4 v[112:115], v5, s[8:11], s52 offen offset:2048 sc1
    s_add_u32 s41, s52, 3072
    buffer_load_dwordx4 v[116:119], v5, s[8:11], s41 offen offset:0 sc1
    s_add_u32 s41, s52, 3072
    buffer_load_dwordx4 v[120:123], v5, s[8:11], s41 offen offset:1024 sc1
    s_add_u32 s41, s52, 3072
    buffer_load_dwordx4 v[124:127], v5, s[8:11], s41 offen offset:2048 sc1
    s_add_u32 s41, s52, 6144
    buffer_load_dwordx4 v[128:131], v5, s[8:11], s41 offen offset:0 sc1
    s_add_u32 s41, s52, 6144
    buffer_load_dwordx4 v[132:135], v5, s[8:11], s41 offen offset:1024 sc1
    s_add_u32 s41, s52, 6144
    buffer_load_dwordx4 v[136:139], v5, s[8:11], s41 offen offset:2048 sc1
    s_add_u32 s41, s52, 9216
    buffer_load_dwordx4 v[140:143], v5, s[8:11], s41 offen offset:0 sc1
    s_add_u32 s41, s52, 9216
    buffer_load_dwordx4 v[144:147], v5, s[8:11], s41 offen offset:1024 sc1
    s_add_u32 s41, s52, 9216
    buffer_load_dwordx4 v[148:151], v5, s[8:11], s41 offen offset:2048 sc1
    v_and_b32 v2, 31, v1
    v_lshrrev_b32 v3, 1, v2
    v_and_b32 v3, 7, v3
    v_lshrrev_b32 v4, 5, v1
    v_xor_b32 v3, v3, v4
    v_lshl_add_u32 v2, v2, 7, s46
    v_xor_b32 v4, 0, v3
    v_lshl_add_u32 v180, v4, 4, v2
    v_xor_b32 v4, 2, v3
    v_lshl_add_u32 v181, v4, 4, v2
    v_xor_b32 v4, 4, v3
    v_lshl_add_u32 v182, v4, 4, v2
    v_xor_b32 v4, 6, v3
    v_lshl_add_u32 v183, v4, 4, v2
    s_waitcnt vmcnt(12)
    s_setprio 2
    ds_read_b128 v[164:167], v180 offset:0
    ds_read_b128 v[168:171], v180 offset:4096
    s_waitcnt vmcnt(9)
    s_waitcnt lgkmcnt(0)
    v_mfma_f32_32x32x16_bf16 v[8:23], v[104:107], v[164:167], 0
    ds_read_b128 v[172:175], v181 offset:0
    ds_read_b128 v[176:179], v181 offset:4096
    v_mfma_f32_32x32x16_bf16 v[24:39], v[104:107], v[168:171], 0
    s_add_u32 s53, s50, 1
    s_and_b32 s53, s53, 7
    s_mul_i32 s53, s53, 12288
    s_add_u32 s53, s53, s44
    buffer_load_dwordx4 v[152:155], v5, s[8:11], s53 offen offset:0 sc1
    v_mfma_f32_32x32x16_bf16 v[40:55], v[108:111], v[164:167], 0
    buffer_load_dwordx4 v[156:159], v5, s[8:11], s53 offen offset:1024 sc1
    v_mfma_f32_32x32x16_bf16 v[56:71], v[108:111], v[168:171], 0
    buffer_load_dwordx4 v[160:163], v5, s[8:11], s53 offen offset:2048 sc1
    v_mfma_f32_32x32x16_bf16 v[72:87], v[112:115], v[164:167], 0
    s_add_u32 s55, s50, 1
    s_and_b32 s55, s55, 7
    s_lshl_b32 s55, s55, 7
    s_add_u32 s55, s55, s45
    s_add_u32 s42, s55, 0
    s_add_u32 m0, s46, 8192
    s_nop 0
    buffer_load_dwordx4 v6, s[4:7], s42 offen lds
    v_mfma_f32_32x32x16_bf16 v[88:103], v[112:115], v[168:171], 0
    s_add_u32 s42, s55, 32768
    s_add_u32 m0, s46, 9216
    s_nop 0
    buffer_load_dwordx4 v7, s[4:7], s42 offen lds
    s_add_u32 s42, s55, 65536
    s_add_u32 m0, s46, 10240
    s_nop 0
    buffer_load_dwordx4 v6, s[4:7], s42 offen lds
    s_add_u32 s42, s55, 98304
    s_add_u32 m0, s46, 11264
    s_nop 0
    buffer_load_dwordx4 v7, s[4:7], s42 offen lds
    s_waitcnt vmcnt(13)
    s_waitcnt lgkmcnt(0)
    v_mfma_f32_32x32x16_bf16 v[8:23], v[116:119], v[172:175], v[8:23]
    ds_read_b128 v[164:167], v182 offset:0
    ds_read_b128 v[168:171], v182 offset:4096
    v_mfma_f32_32x32x16_bf16 v[24:39], v[116:119], v[176:179], v[24:39]
    s_add_u32 s41, s53, 3072
    buffer_load_dwordx4 v[104:107], v5, s[8:11], s41 offen offset:0 sc1
    v_mfma_f32_32x32x16_bf16 v[40:55], v[120:123], v[172:175], v[40:55]
    s_add_u32 s41, s53, 3072
    buffer_load_dwordx4 v[108:111], v5, s[8:11], s41 offen offset:1024 sc1
    v_mfma_f32_32x32x16_bf16 v[56:71], v[120:123], v[176:179], v[56:71]
    s_add_u32 s41, s53, 3072
    buffer_load_dwordx4 v[112:115], v5, s[8:11], s41 offen offset:2048 sc1
    v_mfma_f32_32x32x16_bf16 v[72:87], v[124:127], v[172:175], v[72:87]
    s_add_u32 s42, s55, 131072
    s_add_u32 m0, s46, 12288
    s_nop 0
    buffer_load_dwordx4 v6, s[4:7], s42 offen lds
    v_mfma_f32_32x32x16_bf16 v[88:103], v[124:127], v[176:179], v[88:103]
    s_add_u32 s42, s55, 163840
    s_add_u32 m0, s46, 13312
    s_nop 0
    buffer_load_dwordx4 v7, s[4:7], s42 offen lds
    s_add_u32 s42, s55, 196608
    s_add_u32 m0, s46, 14336
    s_nop 0
    buffer_load_dwordx4 v6, s[4:7], s42 offen lds
    s_add_u32 s42, s55, 229376
    s_add_u32 m0, s46, 15360
    s_nop 0
    buffer_load_dwordx4 v7, s[4:7], s42 offen lds
    s_waitcnt vmcnt(17)
    s_waitcnt lgkmcnt(0)
    v_mfma_f32_32x32x16_bf16 v[8:23], v[128:131], v[164:167], v[8:23]
    ds_read_b128 v[172:175], v183 offset:0
    ds_read_b128 v[176:179], v183 offset:4096
    v_mfma_f32_32x32x16_bf16 v[24:39], v[128:131], v[168:171], v[24:39]
    s_add_u32 s41, s53, 6144
    buffer_load_dwordx4 v[116:119], v5, s[8:11], s41 offen offset:0 sc1
    v_mfma_f32_32x32x16_bf16 v[40:55], v[132:135], v[164:167], v[40:55]
    s_add_u32 s41, s53, 6144
    buffer_load_dwordx4 v[120:123], v5, s[8:11], s41 offen offset:1024 sc1
    v_mfma_f32_32x32x16_bf16 v[56:71], v[132:135], v[168:171], v[56:71]
    s_add_u32 s41, s53, 6144
    buffer_load_dwordx4 v[124:127], v5, s[8:11], s41 offen offset:2048 sc1
    v_mfma_f32_32x32x16_bf16 v[72:87], v[136:139], v[164:167], v[72:87]
    v_mfma_f32_32x32x16_bf16 v[88:103], v[136:139], v[168:171], v[88:103]
    s_waitcnt vmcnt(17)
    s_waitcnt lgkmcnt(0)
    v_mfma_f32_32x32x16_bf16 v[8:23], v[140:143], v[172:175], v[8:23]
    s_waitcnt vmcnt(3)
    ds_read_b128 v[164:167], v180 offset:8192
    ds_read_b128 v[168:171], v180 offset:12288
    v_mfma_f32_32x32x16_bf16 v[24:39], v[140:143], v[176:179], v[24:39]
    s_add_u32 s41, s53, 9216
    buffer_load_dwordx4 v[128:131], v5, s[8:11], s41 offen offset:0 sc1
    v_mfma_f32_32x32x16_bf16 v[40:55], v[144:147], v[172:175], v[40:55]
    s_add_u32 s41, s53, 9216
    buffer_load_dwordx4 v[132:135], v5, s[8:11], s41 offen offset:1024 sc1
    v_mfma_f32_32x32x16_bf16 v[56:71], v[144:147], v[176:179], v[56:71]
    s_add_u32 s41, s53, 9216
    buffer_load_dwordx4 v[136:139], v5, s[8:11], s41 offen offset:2048 sc1
    v_mfma_f32_32x32x16_bf16 v[72:87], v[148:151], v[172:175], v[72:87]
    s_add_u32 s54, s50, 2
    s_and_b32 s54, s54, 7
    s_lshl_b32 s54, s54, 7
    s_add_u32 s54, s54, s45
    s_add_u32 s42, s54, 0
    s_add_u32 m0, s46, 0
    s_nop 0
    buffer_load_dwordx4 v6, s[4:7], s42 offen lds
    v_mfma_f32_32x32x16_bf16 v[88:103], v[148:151], v[176:179], v[88:103]
    s_add_u32 s42, s54, 32768
    s_add_u32 m0, s46, 1024
    s_nop 0
    buffer_load_dwordx4 v7, s[4:7], s42 offen lds
    s_waitcnt vmcnt(19)
    s_waitcnt lgkmcnt(0)
    v_mfma_f32_32x32x16_bf16 v[8:23], v[152:155], v[164:167], v[8:23]
    ds_read_b128 v[172:175], v181 offset:8192
    ds_read_b128 v[176:179], v181 offset:12288
    v_mfma_f32_32x32x16_bf16 v[24:39], v[152:155], v[168:171], v[24:39]
    s_add_u32 s52, s50, 2
    s_and_b32 s52, s52, 7
    s_mul_i32 s52, s52, 12288
    s_add_u32 s52, s52, s44
    buffer_load_dwordx4 v[140:143], v5, s[8:11], s52 offen offset:0 sc1
    v_mfma_f32_32x32x16_bf16 v[40:55], v[156:159], v[164:167], v[40:55]
    buffer_load_dwordx4 v[144:147], v5, s[8:11], s52 offen offset:1024 sc1
    v_mfma_f32_32x32x16_bf16 v[56:71], v[156:159], v[168:171], v[56:71]
    buffer_load_dwordx4 v[148:151], v5, s[8:11], s52 offen offset:2048 sc1
    v_mfma_f32_32x32x16_bf16 v[72:87], v[160:163], v[164:167], v[72:87]
    s_add_u32 s42, s54, 65536
    s_add_u32 m0, s46, 2048
    s_nop 0
    buffer_load_dwordx4 v6, s[4:7], s42 offen lds
    v_mfma_f32_32x32x16_bf16 v[88:103], v[160:163], v[168:171], v[88:103]
    s_add_u32 s42, s54, 98304
    s_add_u32 m0, s46, 3072
    s_nop 0
    buffer_load_dwordx4 v7, s[4:7], s42 offen lds
    s_add_u32 s42, s54, 131072
    s_add_u32 m0, s46, 4096
    s_nop 0
    buffer_load_dwordx4 v6, s[4:7], s42 offen lds
    s_waitcnt vmcnt(18)
    s_waitcnt lgkmcnt(0)
    v_mfma_f32_32x32x16_bf16 v[8:23], v[104:107], v[172:175], v[8:23]
    ds_read_b128 v[164:167], v182 offset:8192
    ds_read_b128 v[168:171], v182 offset:12288
    v_mfma_f32_32x32x16_bf16 v[24:39], v[104:107], v[176:179], v[24:39]
    s_add_u32 s41, s52, 3072
    buffer_load_dwordx4 v[152:155], v5, s[8:11], s41 offen offset:0 sc1
    v_mfma_f32_32x32x16_bf16 v[40:55], v[108:111], v[172:175], v[40:55]
    s_add_u32 s41, s52, 3072
    buffer_load_dwordx4 v[156:159], v5, s[8:11], s41 offen offset:1024 sc1
    v_mfma_f32_32x32x16_bf16 v[56:71], v[108:111], v[176:179], v[56:71]
    s_add_u32 s41, s52, 3072
    buffer_load_dwordx4 v[160:163], v5, s[8:11], s41 offen offset:2048 sc1
    v_mfma_f32_32x32x16_bf16 v[72:87], v[112:115], v[172:175], v[72:87]
    s_add_u32 s42, s54, 163840
    s_add_u32 m0, s46, 5120
    s_nop 0
    buffer_load_dwordx4 v7, s[4:7], s42 offen lds
    v_mfma_f32_32x32x16_bf16 v[88:103], v[112:115], v[176:179], v[88:103]
    s_add_u32 s42, s54, 196608
    s_add_u32 m0, s46, 6144
    s_nop 0
    buffer_load_dwordx4 v6, s[4:7], s42 offen lds
    s_add_u32 s42, s54, 229376
    s_add_u32 m0, s46, 7168
    s_nop 0
    buffer_load_dwordx4 v7, s[4:7], s42 offen lds
    s_waitcnt vmcnt(17)
    s_waitcnt lgkmcnt(0)
    v_mfma_f32_32x32x16_bf16 v[8:23], v[116:119], v[164:167], v[8:23]
    ds_read_b128 v[172:175], v183 offset:8192
    ds_read_b128 v[176:179], v183 offset:12288
    v_mfma_f32_32x32x16_bf16 v[24:39], v[116:119], v[168:171], v[24:39]
    s_add_u32 s41, s52, 6144
    buffer_load_dwordx4 v[104:107], v5, s[8:11], s41 offen offset:0 sc1
    v_mfma_f32_32x32x16_bf16 v[40:55], v[120:123], v[164:167], v[40:55]
    s_add_u32 s41, s52, 6144
    buffer_load_dwordx4 v[108:111], v5, s[8:11], s41 offen offset:1024 sc1
    v_mfma_f32_32x32x16_bf16 v[56:71], v[120:123], v[168:171], v[56:71]
    s_add_u32 s41, s52, 6144
    buffer_load_dwordx4 v[112:115], v5, s[8:11], s41 offen offset:2048 sc1
    v_mfma_f32_32x32x16_bf16 v[72:87], v[124:127], v[164:167], v[72:87]
    v_mfma_f32_32x32x16_bf16 v[88:103], v[124:127], v[168:171], v[88:103]
    s_waitcnt vmcnt(17)
    s_waitcnt lgkmcnt(0)
    v_mfma_f32_32x32x16_bf16 v[8:23], v[128:131], v[172:175], v[8:23]
    s_waitcnt vmcnt(3)
    ds_read_b128 v[164:167], v180 offset:0
    ds_read_b128 v[168:171], v180 offset:4096
    v_mfma_f32_32x32x16_bf16 v[24:39], v[128:131], v[176:179], v[24:39]
    s_add_u32 s41, s52, 9216
    buffer_load_dwordx4 v[116:119], v5, s[8:11], s41 offen offset:0 sc1
    v_mfma_f32_32x32x16_bf16 v[40:55], v[132:135], v[172:175], v[40:55]
    s_add_u32 s41, s52, 9216
    buffer_load_dwordx4 v[120:123], v5, s[8:11], s41 offen offset:1024 sc1
    v_mfma_f32_32x32x16_bf16 v[56:71], v[132:135], v[176:179], v[56:71]
    s_add_u32 s41, s52, 9216
    buffer_load_dwordx4 v[124:127], v5, s[8:11], s41 offen offset:2048 sc1
    v_mfma_f32_32x32x16_bf16 v[72:87], v[136:139], v[172:175], v[72:87]
    s_add_u32 s55, s50, 3
    s_and_b32 s55, s55, 7
    s_lshl_b32 s55, s55, 7
    s_add_u32 s55, s55, s45
    s_add_u32 s42, s55, 0
    s_add_u32 m0, s46, 8192
    s_nop 0
    buffer_load_dwordx4 v6, s[4:7], s42 offen lds
    v_mfma_f32_32x32x16_bf16 v[88:103], v[136:139], v[176:179], v[88:103]
    s_add_u32 s42, s55, 32768
    s_add_u32 m0, s46, 9216
    s_nop 0
    buffer_load_dwordx4 v7, s[4:7], s42 offen lds
    s_waitcnt vmcnt(17)
    s_waitcnt lgkmcnt(0)
    v_mfma_f32_32x32x16_bf16 v[8:23], v[140:143], v[164:167], v[8:23]
    ds_read_b128 v[172:175], v181 offset:0
    ds_read_b128 v[176:179], v181 offset:4096
    v_mfma_f32_32x32x16_bf16 v[24:39], v[140:143], v[168:171], v[24:39]
    s_add_u32 s53, s50, 3
    s_and_b32 s53, s53, 7
    s_mul_i32 s53, s53, 12288
    s_add_u32 s53, s53, s44
    buffer_load_dwordx4 v[128:131], v5, s[8:11], s53 offen offset:0 sc1
    v_mfma_f32_32x32x16_bf16 v[40:55], v[144:147], v[164:167], v[40:55]
    buffer_load_dwordx4 v[132:135], v5, s[8:11], s53 offen offset:1024 sc1
    v_mfma_f32_32x32x16_bf16 v[56:71], v[144:147], v[168:171], v[56:71]
    buffer_load_dwordx4 v[136:139], v5, s[8:11], s53 offen offset:2048 sc1
    v_mfma_f32_32x32x16_bf16 v[72:87], v[148:151], v[164:167], v[72:87]
    s_add_u32 s42, s55, 65536
    s_add_u32 m0, s46, 10240
    s_nop 0
    buffer_load_dwordx4 v6, s[4:7], s42 offen lds
    v_mfma_f32_32x32x16_bf16 v[88:103], v[148:151], v[168:171], v[88:103]
    s_add_u32 s42, s55, 98304
    s_add_u32 m0, s46, 11264
    s_nop 0
    buffer_load_dwordx4 v7, s[4:7], s42 offen lds
    s_add_u32 s42, s55, 131072
    s_add_u32 m0, s46, 12288
    s_nop 0
    buffer_load_dwordx4 v6, s[4:7], s42 offen lds
    s_waitcnt vmcnt(17)
    s_waitcnt lgkmcnt(0)
    v_mfma_f32_32x32x16_bf16 v[8:23], v[152:155], v[172:175], v[8:23]
    ds_read_b128 v[164:167], v182 offset:0
    ds_read_b128 v[168:171], v182 offset:4096
    v_mfma_f32_32x32x16_bf16 v[24:39], v[152:155], v[176:179], v[24:39]
    s_add_u32 s41, s53, 3072
    buffer_load_dwordx4 v[140:143], v5, s[8:11], s41 offen offset:0 sc1
    v_mfma_f32_32x32x16_bf16 v[40:55], v[156:159], v[172:175], v[40:55]
    s_add_u32 s41, s53, 3072
    buffer_load_dwordx4 v[144:147], v5, s[8:11], s41 offen offset:1024 sc1
    v_mfma_f32_32x32x16_bf16 v[56:71], v[156:159], v[176:179], v[56:71]
    s_add_u32 s41, s53, 3072
    buffer_load_dwordx4 v[148:151], v5, s[8:11], s41 offen offset:2048 sc1
    v_mfma_f32_32x32x16_bf16 v[72:87], v[160:163], v[172:175], v[72:87]
    s_add_u32 s42, s55, 163840
    s_add_u32 m0, s46, 13312
    s_nop 0
    buffer_load_dwordx4 v7, s[4:7], s42 offen lds
    v_mfma_f32_32x32x16_bf16 v[88:103], v[160:163], v[176:179], v[88:103]
    s_add_u32 s42, s55, 196608
    s_add_u32 m0, s46, 14336
    s_nop 0
    buffer_load_dwordx4 v6, s[4:7], s42 offen lds
    s_add_u32 s42, s55, 229376
    s_add_u32 m0, s46, 15360
    s_nop 0
    buffer_load_dwordx4 v7, s[4:7], s42 offen lds
    s_waitcnt vmcnt(17)
    s_waitcnt lgkmcnt(0)
    v_mfma_f32_32x32x16_bf16 v[8:23], v[104:107], v[164:167], v[8:23]
    ds_read_b128 v[172:175], v183 offset:0
    ds_read_b128 v[176:179], v183 offset:4096
    v_mfma_f32_32x32x16_bf16 v[24:39], v[104:107], v[168:171], v[24:39]
    s_add_u32 s41, s53, 6144
    buffer_load_dwordx4 v[152:155], v5, s[8:11], s41 offen offset:0 sc1
    v_mfma_f32_32x32x16_bf16 v[40:55], v[108:111], v[164:167], v[40:55]
    s_add_u32 s41, s53, 6144
    buffer_load_dwordx4 v[156:159], v5, s[8:11], s41 offen offset:1024 sc1
    v_mfma_f32_32x32x16_bf16 v[56:71], v[108:111], v[168:171], v[56:71]
    s_add_u32 s41, s53, 6144
    buffer_load_dwordx4 v[160:163], v5, s[8:11], s41 offen offset:2048 sc1
    v_mfma_f32_32x32x16_bf16 v[72:87], v[112:115], v[164:167], v[72:87]
    v_mfma_f32_32x32x16_bf16 v[88:103], v[112:115], v[168:171], v[88:103]
    s_waitcnt vmcnt(17)
    s_waitcnt lgkmcnt(0)
    v_mfma_f32_32x32x16_bf16 v[8:23], v[116:119], v[172:175], v[8:23]
    s_waitcnt vmcnt(3)
    ds_read_b128 v[164:167], v180 offset:8192
    ds_read_b128 v[168:171], v180 offset:12288
    v_mfma_f32_32x32x16_bf16 v[24:39], v[116:119], v[176:179], v[24:39]
    s_add_u32 s41, s53, 9216
    buffer_load_dwordx4 v[104:107], v5, s[8:11], s41 offen offset:0 sc1
    v_mfma_f32_32x32x16_bf16 v[40:55], v[120:123], v[172:175], v[40:55]
    s_add_u32 s41, s53, 9216
    buffer_load_dwordx4 v[108:111], v5, s[8:11], s41 offen offset:1024 sc1
    v_mfma_f32_32x32x16_bf16 v[56:71], v[120:123], v[176:179], v[56:71]
    s_add_u32 s41, s53, 9216
    buffer_load_dwordx4 v[112:115], v5, s[8:11], s41 offen offset:2048 sc1
    v_mfma_f32_32x32x16_bf16 v[72:87], v[124:127], v[172:175], v[72:87]
    s_add_u32 s54, s50, 4
    s_and_b32 s54, s54, 7
    s_lshl_b32 s54, s54, 7
    s_add_u32 s54, s54, s45
    s_add_u32 s42, s54, 0
    s_add_u32 m0, s46, 0
    s_nop 0
    buffer_load_dwordx4 v6, s[4:7], s42 offen lds
    v_mfma_f32_32x32x16_bf16 v[88:103], v[124:127], v[176:179], v[88:103]
    s_add_u32 s42, s54, 32768
    s_add_u32 m0, s46, 1024
    s_nop 0
    buffer_load_dwordx4 v7, s[4:7], s42 offen lds
    s_setprio 0
    s_waitcnt vmcnt(17)
    s_waitcnt lgkmcnt(0)
    v_mfma_f32_32x32x16_bf16 v[8:23], v[128:131], v[164:167], v[8:23]
    ds_read_b128 v[172:175], v181 offset:8192
    ds_read_b128 v[176:179], v181 offset:12288
    v_mfma_f32_32x32x16_bf16 v[24:39], v[128:131], v[168:171], v[24:39]
    s_add_u32 s52, s50, 4
    s_and_b32 s52, s52, 7
    s_mul_i32 s52, s52, 12288
    s_add_u32 s52, s52, s44
    buffer_load_dwordx4 v[116:119], v5, s[8:11], s52 offen offset:0 sc1
    v_mfma_f32_32x32x16_bf16 v[40:55], v[132:135], v[164:167], v[40:55]
    buffer_load_dwordx4 v[120:123], v5, s[8:11], s52 offen offset:1024 sc1
    v_mfma_f32_32x32x16_bf16 v[56:71], v[132:135], v[168:171], v[56:71]
    buffer_load_dwordx4 v[124:127], v5, s[8:11], s52 offen offset:2048 sc1
    v_mfma_f32_32x32x16_bf16 v[72:87], v[136:139], v[164:167], v[72:87]
    s_add_u32 s42, s54, 65536
    s_add_u32 m0, s46, 2048
    s_nop 0
    buffer_load_dwordx4 v6, s[4:7], s42 offen lds
    v_mfma_f32_32x32x16_bf16 v[88:103], v[136:139], v[168:171], v[88:103]
    s_add_u32 s42, s54, 98304
    s_add_u32 m0, s46, 3072
    s_nop 0
    buffer_load_dwordx4 v7, s[4:7], s42 offen lds
    s_add_u32 s42, s54, 131072
    s_add_u32 m0, s46, 4096
    s_nop 0
    buffer_load_dwordx4 v6, s[4:7], s42 offen lds
    s_waitcnt vmcnt(17)
    s_waitcnt lgkmcnt(0)
    v_mfma_f32_32x32x16_bf16 v[8:23], v[140:143], v[172:175], v[8:23]
    ds_read_b128 v[164:167], v182 offset:8192
    ds_read_b128 v[168:171], v182 offset:12288
    v_mfma_f32_32x32x16_bf16 v[24:39], v[140:143], v[176:179], v[24:39]
    s_add_u32 s41, s52, 3072
    buffer_load_dwordx4 v[128:131], v5, s[8:11], s41 offen offset:0 sc1
    v_mfma_f32_32x32x16_bf16 v[40:55], v[144:147], v[172:175], v[40:55]
    s_add_u32 s41, s52, 3072
    buffer_load_dwordx4 v[132:135], v5, s[8:11], s41 offen offset:1024 sc1
    v_mfma_f32_32x32x16_bf16 v[56:71], v[144:147], v[176:179], v[56:71]
    s_add_u32 s41, s52, 3072
    buffer_load_dwordx4 v[136:139], v5, s[8:11], s41 offen offset:2048 sc1
    v_mfma_f32_32x32x16_bf16 v[72:87], v[148:151], v[172:175], v[72:87]
    s_add_u32 s42, s54, 163840
    s_add_u32 m0, s46, 5120
    s_nop 0
    buffer_load_dwordx4 v7, s[4:7], s42 offen lds
    v_mfma_f32_32x32x16_bf16 v[88:103], v[148:151], v[176:179], v[88:103]
    s_add_u32 s42, s54, 196608
    s_add_u32 m0, s46, 6144
    s_nop 0
    buffer_load_dwordx4 v6, s[4:7], s42 offen lds
    s_add_u32 s42, s54, 229376
    s_add_u32 m0, s46, 7168
    s_nop 0
    buffer_load_dwordx4 v7, s[4:7], s42 offen lds
    s_waitcnt vmcnt(17)
    s_waitcnt lgkmcnt(0)
    v_mfma_f32_32x32x16_bf16 v[8:23], v[152:155], v[164:167], v[8:23]
    ds_read_b128 v[172:175], v183 offset:8192
    ds_read_b128 v[176:179], v183 offset:12288
    v_mfma_f32_32x32x16_bf16 v[24:39], v[152:155], v[168:171], v[24:39]
    s_add_u32 s41, s52, 6144
    buffer_load_dwordx4 v[140:143], v5, s[8:11], s41 offen offset:0 sc1
    v_mfma_f32_32x32x16_bf16 v[40:55], v[156:159], v[164:167], v[40:55]
    s_add_u32 s41, s52, 6144
    buffer_load_dwordx4 v[144:147], v5, s[8:11], s41 offen offset:1024 sc1
    v_mfma_f32_32x32x16_bf16 v[56:71], v[156:159], v[168:171], v[56:71]
    s_add_u32 s41, s52, 6144
    buffer_load_dwordx4 v[148:151], v5, s[8:11], s41 offen offset:2048 sc1
    v_mfma_f32_32x32x16_bf16 v[72:87], v[160:163], v[164:167], v[72:87]
    v_mfma_f32_32x32x16_bf16 v[88:103], v[160:163], v[168:171], v[88:103]
    s_waitcnt vmcnt(17)
    s_waitcnt lgkmcnt(0)
    v_mfma_f32_32x32x16_bf16 v[8:23], v[104:107], v[172:175], v[8:23]
    s_waitcnt vmcnt(3)
    ds_read_b128 v[164:167], v180 offset:0
    ds_read_b128 v[168:171], v180 offset:4096
    v_mfma_f32_32x32x16_bf16 v[24:39], v[104:107], v[176:179], v[24:39]
    s_add_u32 s41, s52, 9216
    buffer_load_dwordx4 v[152:155], v5, s[8:11], s41 offen offset:0 sc1
    v_mfma_f32_32x32x16_bf16 v[40:55], v[108:111], v[172:175], v[40:55]
    s_add_u32 s41, s52, 9216
    buffer_load_dwordx4 v[156:159], v5, s[8:11], s41 offen offset:1024 sc1
    v_mfma_f32_32x32x16_bf16 v[56:71], v[108:111], v[176:179], v[56:71]
    s_add_u32 s41, s52, 9216
    buffer_load_dwordx4 v[160:163], v5, s[8:11], s41 offen offset:2048 sc1
    v_mfma_f32_32x32x16_bf16 v[72:87], v[112:115], v[172:175], v[72:87]
    s_add_u32 s55, s50, 5
    s_and_b32 s55, s55, 7
    s_lshl_b32 s55, s55, 7
    s_add_u32 s55, s55, s45
    s_add_u32 s42, s55, 0
    s_add_u32 m0, s46, 8192
    s_nop 0
    buffer_load_dwordx4 v6, s[4:7], s42 offen lds
    v_mfma_f32_32x32x16_bf16 v[88:103], v[112:115], v[176:179], v[88:103]
    s_add_u32 s42, s55, 32768
    s_add_u32 m0, s46, 9216
    s_nop 0
    buffer_load_dwordx4 v7, s[4:7], s42 offen lds
    s_waitcnt vmcnt(17)
    s_waitcnt lgkmcnt(0)
    v_mfma_f32_32x32x16_bf16 v[8:23], v[116:119], v[164:167], v[8:23]
    ds_read_b128 v[172:175], v181 offset:0
    ds_read_b128 v[176:179], v181 offset:4096
    v_mfma_f32_32x32x16_bf16 v[24:39], v[116:119], v[168:171], v[24:39]
    s_add_u32 s53, s50, 5
    s_and_b32 s53, s53, 7
    s_mul_i32 s53, s53, 12288
    s_add_u32 s53, s53, s44
    buffer_load_dwordx4 v[104:107], v5, s[8:11], s53 offen offset:0 sc1
    v_mfma_f32_32x32x16_bf16 v[40:55], v[120:123], v[164:167], v[40:55]
    buffer_load_dwordx4 v[108:111], v5, s[8:11], s53 offen offset:1024 sc1
    v_mfma_f32_32x32x16_bf16 v[56:71], v[120:123], v[168:171], v[56:71]
    buffer_load_dwordx4 v[112:115], v5, s[8:11], s53 offen offset:2048 sc1
    v_mfma_f32_32x32x16_bf16 v[72:87], v[124:127], v[164:167], v[72:87]
    s_add_u32 s42, s55, 65536
    s_add_u32 m0, s46, 10240
    s_nop 0
    buffer_load_dwordx4 v6, s[4:7], s42 offen lds
    v_mfma_f32_32x32x16_bf16 v[88:103], v[124:127], v[168:171], v[88:103]
    s_add_u32 s42, s55, 98304
    s_add_u32 m0, s46, 11264
    s_nop 0
    buffer_load_dwordx4 v7, s[4:7], s42 offen lds
    s_add_u32 s42, s55, 131072
    s_add_u32 m0, s46, 12288
    s_nop 0
    buffer_load_dwordx4 v6, s[4:7], s42 offen lds
    s_waitcnt vmcnt(17)
    s_waitcnt lgkmcnt(0)
    v_mfma_f32_32x32x16_bf16 v[8:23], v[128:131], v[172:175], v[8:23]
    ds_read_b128 v[164:167], v182 offset:0
    ds_read_b128 v[168:171], v182 offset:4096
    v_mfma_f32_32x32x16_bf16 v[24:39], v[128:131], v[176:179], v[24:39]
    s_add_u32 s41, s53, 3072
    buffer_load_dwordx4 v[116:119], v5, s[8:11], s41 offen offset:0 sc1
    v_mfma_f32_32x32x16_bf16 v[40:55], v[132:135], v[172:175], v[40:55]
    s_add_u32 s41, s53, 3072
    buffer_load_dwordx4 v[120:123], v5, s[8:11], s41 offen offset:1024 sc1
    v_mfma_f32_32x32x16_bf16 v[56:71], v[132:135], v[176:179], v[56:71]
    s_add_u32 s41, s53, 3072
    buffer_load_dwordx4 v[124:127], v5, s[8:11], s41 offen offset:2048 sc1
    v_mfma_f32_32x32x16_bf16 v[72:87], v[136:139], v[172:175], v[72:87]
    s_add_u32 s42, s55, 163840
    s_add_u32 m0, s46, 13312
    s_nop 0
    buffer_load_dwordx4 v7, s[4:7], s42 offen lds
    v_mfma_f32_32x32x16_bf16 v[88:103], v[136:139], v[176:179], v[88:103]
    s_add_u32 s42, s55, 196608
    s_add_u32 m0, s46, 14336
    s_nop 0
    buffer_load_dwordx4 v6, s[4:7], s42 offen lds
    s_add_u32 s42, s55, 229376
    s_add_u32 m0, s46, 15360
    s_nop 0
    buffer_load_dwordx4 v7, s[4:7], s42 offen lds
    s_waitcnt vmcnt(17)
    s_waitcnt lgkmcnt(0)
    v_mfma_f32_32x32x16_bf16 v[8:23], v[140:143], v[164:167], v[8:23]
    ds_read_b128 v[172:175], v183 offset:0
    ds_read_b128 v[176:179], v183 offset:4096
    v_mfma_f32_32x32x16_bf16 v[24:39], v[140:143], v[168:171], v[24:39]
    s_add_u32 s41, s53, 6144
    buffer_load_dwordx4 v[128:131], v5, s[8:11], s41 offen offset:0 sc1
    v_mfma_f32_32x32x16_bf16 v[40:55], v[144:147], v[164:167], v[40:55]
    s_add_u32 s41, s53, 6144
    buffer_load_dwordx4 v[132:135], v5, s[8:11], s41 offen offset:1024 sc1
    v_mfma_f32_32x32x16_bf16 v[56:71], v[144:147], v[168:171], v[56:71]
    s_add_u32 s41, s53, 6144
    buffer_load_dwordx4 v[136:139], v5, s[8:11], s41 offen offset:2048 sc1
    v_mfma_f32_32x32x16_bf16 v[72:87], v[148:151], v[164:167], v[72:87]
    v_mfma_f32_32x32x16_bf16 v[88:103], v[148:151], v[168:171], v[88:103]
    s_waitcnt vmcnt(17)
    s_waitcnt lgkmcnt(0)
    v_mfma_f32_32x32x16_bf16 v[8:23], v[152:155], v[172:175], v[8:23]
    s_waitcnt vmcnt(3)
    ds_read_b128 v[164:167], v180 offset:8192
    ds_read_b128 v[168:171], v180 offset:12288
    v_mfma_f32_32x32x16_bf16 v[24:39], v[152:155], v[176:179], v[24:39]
    s_add_u32 s41, s53, 9216
    buffer_load_dwordx4 v[140:143], v5, s[8:11], s41 offen offset:0 sc1
    v_mfma_f32_32x32x16_bf16 v[40:55], v[156:159], v[172:175], v[40:55]
    s_add_u32 s41, s53, 9216
    buffer_load_dwordx4 v[144:147], v5, s[8:11], s41 offen offset:1024 sc1
    v_mfma_f32_32x32x16_bf16 v[56:71], v[156:159], v[176:179], v[56:71]
    s_add_u32 s41, s53, 9216
    buffer_load_dwordx4 v[148:151], v5, s[8:11], s41 offen offset:2048 sc1
    v_mfma_f32_32x32x16_bf16 v[72:87], v[160:163], v[172:175], v[72:87]
    s_add_u32 s54, s50, 6
    s_and_b32 s54, s54, 7
    s_lshl_b32 s54, s54, 7
    s_add_u32 s54, s54, s45
    s_add_u32 s42, s54, 0
    s_add_u32 m0, s46, 0
    s_nop 0
    buffer_load_dwordx4 v6, s[4:7], s42 offen lds
    v_mfma_f32_32x32x16_bf16 v[88:103], v[160:163], v[176:179], v[88:103]
    s_add_u32 s42, s54, 32768
    s_add_u32 m0, s46, 1024
    s_nop 0
    buffer_load_dwordx4 v7, s[4:7], s42 offen lds
    s_waitcnt vmcnt(17)
    s_waitcnt lgkmcnt(0)
    v_mfma_f32_32x32x16_bf16 v[8:23], v[104:107], v[164:167], v[8:23]
    ds_read_b128 v[172:175], v181 offset:8192
    ds_read_b128 v[176:179], v181 offset:12288
    v_mfma_f32_32x32x16_bf16 v[24:39], v[104:107], v[168:171], v[24:39]
    s_add_u32 s52, s50, 6
    s_and_b32 s52, s52, 7
    s_mul_i32 s52, s52, 12288
    s_add_u32 s52, s52, s44
    buffer_load_dwordx4 v[152:155], v5, s[8:11], s52 offen offset:0 sc1
    v_mfma_f32_32x32x16_bf16 v[40:55], v[108:111], v[164:167], v[40:55]
    buffer_load_dwordx4 v[156:159], v5, s[8:11], s52 offen offset:1024 sc1
    v_mfma_f32_32x32x16_bf16 v[56:71], v[108:111], v[168:171], v[56:71]
    buffer_load_dwordx4 v[160:163], v5, s[8:11], s52 offen offset:2048 sc1
    v_mfma_f32_32x32x16_bf16 v[72:87], v[112:115], v[164:167], v[72:87]
    s_add_u32 s42, s54, 65536
    s_add_u32 m0, s46, 2048
    s_nop 0
    buffer_load_dwordx4 v6, s[4:7], s42 offen lds
    v_mfma_f32_32x32x16_bf16 v[88:103], v[112:115], v[168:171], v[88:103]
    s_add_u32 s42, s54, 98304
    s_add_u32 m0, s46, 3072
    s_nop 0
    buffer_load_dwordx4 v7, s[4:7], s42 offen lds
    s_add_u32 s42, s54, 131072
    s_add_u32 m0, s46, 4096
    s_nop 0
    buffer_load_dwordx4 v6, s[4:7], s42 offen lds
    s_waitcnt vmcnt(17)
    s_waitcnt lgkmcnt(0)
    v_mfma_f32_32x32x16_bf16 v[8:23], v[116:119], v[172:175], v[8:23]
    ds_read_b128 v[164:167], v182 offset:8192
    ds_read_b128 v[168:171], v182 offset:12288
    v_mfma_f32_32x32x16_bf16 v[24:39], v[116:119], v[176:179], v[24:39]
    s_add_u32 s41, s52, 3072
    buffer_load_dwordx4 v[104:107], v5, s[8:11], s41 offen offset:0 sc1
    v_mfma_f32_32x32x16_bf16 v[40:55], v[120:123], v[172:175], v[40:55]
    s_add_u32 s41, s52, 3072
    buffer_load_dwordx4 v[108:111], v5, s[8:11], s41 offen offset:1024 sc1
    v_mfma_f32_32x32x16_bf16 v[56:71], v[120:123], v[176:179], v[56:71]
    s_add_u32 s41, s52, 3072
    buffer_load_dwordx4 v[112:115], v5, s[8:11], s41 offen offset:2048 sc1
    v_mfma_f32_32x32x16_bf16 v[72:87], v[124:127], v[172:175], v[72:87]
    s_add_u32 s42, s54, 163840
    s_add_u32 m0, s46, 5120
    s_nop 0
    buffer_load_dwordx4 v7, s[4:7], s42 offen lds
    v_mfma_f32_32x32x16_bf16 v[88:103], v[124:127], v[176:179], v[88:103]
    s_add_u32 s42, s54, 196608
    s_add_u32 m0, s46, 6144
    s_nop 0
    buffer_load_dwordx4 v6, s[4:7], s42 offen lds
    s_add_u32 s42, s54, 229376
    s_add_u32 m0, s46, 7168
    s_nop 0
    buffer_load_dwordx4 v7, s[4:7], s42 offen lds
    s_waitcnt vmcnt(17)
    s_waitcnt lgkmcnt(0)
    v_mfma_f32_32x32x16_bf16 v[8:23], v[128:131], v[164:167], v[8:23]
    ds_read_b128 v[172:175], v183 offset:8192
    ds_read_b128 v[176:179], v183 offset:12288
    v_mfma_f32_32x32x16_bf16 v[24:39], v[128:131], v[168:171], v[24:39]
    s_add_u32 s41, s52, 6144
    buffer_load_dwordx4 v[116:119], v5, s[8:11], s41 offen offset:0 sc1
    v_mfma_f32_32x32x16_bf16 v[40:55], v[132:135], v[164:167], v[40:55]
    s_add_u32 s41, s52, 6144
    buffer_load_dwordx4 v[120:123], v5, s[8:11], s41 offen offset:1024 sc1
    v_mfma_f32_32x32x16_bf16 v[56:71], v[132:135], v[168:171], v[56:71]
    s_add_u32 s41, s52, 6144
    buffer_load_dwordx4 v[124:127], v5, s[8:11], s41 offen offset:2048 sc1
    v_mfma_f32_32x32x16_bf16 v[72:87], v[136:139], v[164:167], v[72:87]
    v_mfma_f32_32x32x16_bf16 v[88:103], v[136:139], v[168:171], v[88:103]
    s_waitcnt vmcnt(17)
    s_waitcnt lgkmcnt(0)
    v_mfma_f32_32x32x16_bf16 v[8:23], v[140:143], v[172:175], v[8:23]
    s_waitcnt vmcnt(3)
    ds_read_b128 v[164:167], v180 offset:0
    ds_read_b128 v[168:171], v180 offset:4096
    v_mfma_f32_32x32x16_bf16 v[24:39], v[140:143], v[176:179], v[24:39]
    s_add_u32 s41, s52, 9216
    buffer_load_dwordx4 v[128:131], v5, s[8:11], s41 offen offset:0 sc1
    v_mfma_f32_32x32x16_bf16 v[40:55], v[144:147], v[172:175], v[40:55]
    s_add_u32 s41, s52, 9216
    buffer_load_dwordx4 v[132:135], v5, s[8:11], s41 offen offset:1024 sc1
    v_mfma_f32_32x32x16_bf16 v[56:71], v[144:147], v[176:179], v[56:71]
    s_add_u32 s41, s52, 9216
    buffer_load_dwordx4 v[136:139], v5, s[8:11], s41 offen offset:2048 sc1
    v_mfma_f32_32x32x16_bf16 v[72:87], v[148:151], v[172:175], v[72:87]
    s_add_u32 s55, s50, 7
    s_and_b32 s55, s55, 7
    s_lshl_b32 s55, s55, 7
    s_add_u32 s55, s55, s45
    s_add_u32 s42, s55, 0
    s_add_u32 m0, s46, 8192
    s_nop 0
    buffer_load_dwordx4 v6, s[4:7], s42 offen lds
    v_mfma_f32_32x32x16_bf16 v[88:103], v[148:151], v[176:179], v[88:103]
    s_add_u32 s42, s55, 32768
    s_add_u32 m0, s46, 9216
    s_nop 0
    buffer_load_dwordx4 v7, s[4:7], s42 offen lds
    s_waitcnt vmcnt(17)
    s_waitcnt lgkmcnt(0)
    v_mfma_f32_32x32x16_bf16 v[8:23], v[152:155], v[164:167], v[8:23]
    ds_read_b128 v[172:175], v181 offset:0
    ds_read_b128 v[176:179], v181 offset:4096
    v_mfma_f32_32x32x16_bf16 v[24:39], v[152:155], v[168:171], v[24:39]
    s_add_u32 s53, s50, 7
    s_and_b32 s53, s53, 7
    s_mul_i32 s53, s53, 12288
    s_add_u32 s53, s53, s44
    buffer_load_dwordx4 v[140:143], v5, s[8:11], s53 offen offset:0 sc1
    v_mfma_f32_32x32x16_bf16 v[40:55], v[156:159], v[164:167], v[40:55]
    buffer_load_dwordx4 v[144:147], v5, s[8:11], s53 offen offset:1024 sc1
    v_mfma_f32_32x32x16_bf16 v[56:71], v[156:159], v[168:171], v[56:71]
    buffer_load_dwordx4 v[148:151], v5, s[8:11], s53 offen offset:2048 sc1
    v_mfma_f32_32x32x16_bf16 v[72:87], v[160:163], v[164:167], v[72:87]
    s_add_u32 s42, s55, 65536
    s_add_u32 m0, s46, 10240
    s_nop 0
    buffer_load_dwordx4 v6, s[4:7], s42 offen lds
    v_mfma_f32_32x32x16_bf16 v[88:103], v[160:163], v[168:171], v[88:103]
    s_add_u32 s42, s55, 98304
    s_add_u32 m0, s46, 11264
    s_nop 0
    buffer_load_dwordx4 v7, s[4:7], s42 offen lds
    s_add_u32 s42, s55, 131072
    s_add_u32 m0, s46, 12288
    s_nop 0
    buffer_load_dwordx4 v6, s[4:7], s42 offen lds
    s_waitcnt vmcnt(17)
    s_waitcnt lgkmcnt(0)
    v_mfma_f32_32x32x16_bf16 v[8:23], v[104:107], v[172:175], v[8:23]
    ds_read_b128 v[164:167], v182 offset:0
    ds_read_b128 v[168:171], v182 offset:4096
    v_mfma_f32_32x32x16_bf16 v[24:39], v[104:107], v[176:179], v[24:39]
    s_add_u32 s41, s53, 3072
    buffer_load_dwordx4 v[152:155], v5, s[8:11], s41 offen offset:0 sc1
    v_mfma_f32_32x32x16_bf16 v[40:55], v[108:111], v[172:175], v[40:55]
    s_add_u32 s41, s53, 3072
    buffer_load_dwordx4 v[156:159], v5, s[8:11], s41 offen offset:1024 sc1
    v_mfma_f32_32x32x16_bf16 v[56:71], v[108:111], v[176:179], v[56:71]
    s_add_u32 s41, s53, 3072
    buffer_load_dwordx4 v[160:163], v5, s[8:11], s41 offen offset:2048 sc1
    v_mfma_f32_32x32x16_bf16 v[72:87], v[112:115], v[172:175], v[72:87]
    s_add_u32 s42, s55, 163840
    s_add_u32 m0, s46, 13312
    s_nop 0
    buffer_load_dwordx4 v7, s[4:7], s42 offen lds
    v_mfma_f32_32x32x16_bf16 v[88:103], v[112:115], v[176:179], v[88:103]
    s_add_u32 s42, s55, 196608
    s_add_u32 m0, s46, 14336
    s_nop 0
    buffer_load_dwordx4 v6, s[4:7], s42 offen lds
    s_add_u32 s42, s55, 229376
    s_add_u32 m0, s46, 15360
    s_nop 0
    buffer_load_dwordx4 v7, s[4:7], s42 offen lds
    s_waitcnt vmcnt(17)
    s_waitcnt lgkmcnt(0)
    v_mfma_f32_32x32x16_bf16 v[8:23], v[116:119], v[164:167], v[8:23]
    ds_read_b128 v[172:175], v183 offset:0
    ds_read_b128 v[176:179], v183 offset:4096
    v_mfma_f32_32x32x16_bf16 v[24:39], v[116:119], v[168:171], v[24:39]
    s_add_u32 s41, s53, 6144
    buffer_load_dwordx4 v[104:107], v5, s[8:11], s41 offen offset:0 sc1
    v_mfma_f32_32x32x16_bf16 v[40:55], v[120:123], v[164:167], v[40:55]
    s_add_u32 s41, s53, 6144
    buffer_load_dwordx4 v[108:111], v5, s[8:11], s41 offen offset:1024 sc1
    v_mfma_f32_32x32x16_bf16 v[56:71], v[120:123], v[168:171], v[56:71]
    s_add_u32 s41, s53, 6144
    buffer_load_dwordx4 v[112:115], v5, s[8:11], s41 offen offset:2048 sc1
    v_mfma_f32_32x32x16_bf16 v[72:87], v[124:127], v[164:167], v[72:87]
    v_mfma_f32_32x32x16_bf16 v[88:103], v[124:127], v[168:171], v[88:103]
    s_waitcnt vmcnt(17)
    s_waitcnt lgkmcnt(0)
    v_mfma_f32_32x32x16_bf16 v[8:23], v[128:131], v[172:175], v[8:23]
    s_waitcnt vmcnt(3)
    ds_read_b128 v[164:167], v180 offset:8192
    ds_read_b128 v[168:171], v180 offset:12288
    v_mfma_f32_32x32x16_bf16 v[24:39], v[128:131], v[176:179], v[24:39]
    s_add_u32 s41, s53, 9216
    buffer_load_dwordx4 v[116:119], v5, s[8:11], s41 offen offset:0 sc1
    v_mfma_f32_32x32x16_bf16 v[40:55], v[132:135], v[172:175], v[40:55]
    s_add_u32 s41, s53, 9216
    buffer_load_dwordx4 v[120:123], v5, s[8:11], s41 offen offset:1024 sc1
    v_mfma_f32_32x32x16_bf16 v[56:71], v[132:135], v[176:179], v[56:71]
    s_add_u32 s41, s53, 9216
    buffer_load_dwordx4 v[124:127], v5, s[8:11], s41 offen offset:2048 sc1
    v_mfma_f32_32x32x16_bf16 v[72:87], v[136:139], v[172:175], v[72:87]
    v_mfma_f32_32x32x16_bf16 v[88:103], v[136:139], v[176:179], v[88:103]
    s_waitcnt vmcnt(15)
    s_waitcnt lgkmcnt(0)
    v_mfma_f32_32x32x16_bf16 v[8:23], v[140:143], v[164:167], v[8:23]
    ds_read_b128 v[172:175], v181 offset:8192
    ds_read_b128 v[176:179], v181 offset:12288
    v_mfma_f32_32x32x16_bf16 v[24:39], v[140:143], v[168:171], v[24:39]
    v_mfma_f32_32x32x16_bf16 v[40:55], v[144:147], v[164:167], v[40:55]
    v_mfma_f32_32x32x16_bf16 v[56:71], v[144:147], v[168:171], v[56:71]
    v_mfma_f32_32x32x16_bf16 v[72:87], v[148:151], v[164:167], v[72:87]
    v_mfma_f32_32x32x16_bf16 v[88:103], v[148:151], v[168:171], v[88:103]
    s_waitcnt vmcnt(9)
    s_waitcnt lgkmcnt(0)
    v_mfma_f32_32x32x16_bf16 v[8:23], v[152:155], v[172:175], v[8:23]
    ds_read_b128 v[164:167], v182 offset:8192
    ds_read_b128 v[168:171], v182 offset:12288
    v_mfma_f32_32x32x16_bf16 v[24:39], v[152:155], v[176:179], v[24:39]
    v_mfma_f32_32x32x16_bf16 v[40:55], v[156:159], v[172:175], v[40:55]
    v_mfma_f32_32x32x16_bf16 v[56:71], v[156:159], v[176:179], v[56:71]
    v_mfma_f32_32x32x16_bf16 v[72:87], v[160:163], v[172:175], v[72:87]
    v_mfma_f32_32x32x16_bf16 v[88:103], v[160:163], v[176:179], v[88:103]
    s_waitcnt vmcnt(3)
    s_waitcnt lgkmcnt(0)
    v_mfma_f32_32x32x16_bf16 v[8:23], v[104:107], v[164:167], v[8:23]
    ds_read_b128 v[172:175], v183 offset:8192
    ds_read_b128 v[176:179], v183 offset:12288
    v_mfma_f32_32x32x16_bf16 v[24:39], v[104:107], v[168:171], v[24:39]
    s_lshl_b32 s40, s32, 3
    s_add_u32 s40, s40, s33
    s_lshl_b32 s40, s40, 2
    s_add_u32 s40, s40, s34
    s_mul_i32 s40, s40, 3072
    s_add_u32 s40, s40, 3145728
    s_mul_i32 s40, s34, 3072
    s_add_u32 s40, s40, 73728
    v_add_u32 v3, s40, v5
    ds_read_b128 v[184:187], v3 offset:0
    v_mfma_f32_32x32x16_bf16 v[40:55], v[108:111], v[164:167], v[40:55]
    ds_read_b128 v[188:191], v3 offset:1024
    v_mfma_f32_32x32x16_bf16 v[56:71], v[108:111], v[168:171], v[56:71]
    ds_read_b128 v[192:195], v3 offset:2048
    v_mfma_f32_32x32x16_bf16 v[72:87], v[112:115], v[164:167], v[72:87]
    v_and_b32 v2, 31, v1
    v_lshlrev_b32 v2, 1, v2
    s_lshr_b32 s40, s34, 1
    s_lshl_b32 s40, s40, 6
    s_lshl_b32 s43, s32, 7
    s_add_u32 s40, s40, s43
    buffer_load_ushort v196, v2, s[12:15], s40 offen
    v_mfma_f32_32x32x16_bf16 v[88:103], v[112:115], v[168:171], v[88:103]
    s_waitcnt vmcnt(1)
    s_waitcnt lgkmcnt(3)
    v_mfma_f32_32x32x16_bf16 v[8:23], v[116:119], v[172:175], v[8:23]
    v_mfma_f32_32x32x16_bf16 v[24:39], v[116:119], v[176:179], v[24:39]
    v_mfma_f32_32x32x16_bf16 v[40:55], v[120:123], v[172:175], v[40:55]
    v_mfma_f32_32x32x16_bf16 v[56:71], v[120:123], v[176:179], v[56:71]
    v_mfma_f32_32x32x16_bf16 v[72:87], v[124:127], v[172:175], v[72:87]
    v_mfma_f32_32x32x16_bf16 v[88:103], v[124:127], v[176:179], v[88:103]
    s_setprio 0
    v_add_u32 v4, 0x10000, v5
    s_nop 15
    s_waitcnt lgkmcnt(0)
    v_mov_b32 v2, 161792
    v_mov_b32 v3, 1
    s_mov_b64 exec, 1
    ds_add_u32 v2, v3
    s_mov_b64 exec, -1
    s_mov_b32 s67, 0
gsync_18:
    ds_read_b32 v3, v2
    s_add_u32 s67, s67, 1
    s_waitcnt lgkmcnt(0)
    v_readfirstlane_b32 s66, v3
    s_cmp_gt_u32 s67, 1000000
    s_cbranch_scc1 gsync_e_19
    s_cmp_lt_u32 s66, 4
    s_cbranch_scc1 gsync_18
gsync_e_19:
    s_cmp_lg_u32 s34, 0
    s_cbranch_scc1 g_epi_14
    ds_write_b128 v5, v[12:15] offset:30720
    ds_write_b128 v5, v[20:23] offset:31744
    ds_write_b128 v5, v[44:47] offset:32768
    ds_write_b128 v5, v[52:55] offset:33792
    ds_write_b128 v5, v[76:79] offset:34816
    ds_write_b128 v5, v[84:87] offset:35840
    ds_write_b128 v5, v[24:27] offset:43008
    ds_write_b128 v5, v[32:35] offset:44032
    ds_write_b128 v5, v[56:59] offset:45056
    ds_write_b128 v5, v[64:67] offset:46080
    ds_write_b128 v5, v[88:91] offset:47104
    ds_write_b128 v5, v[96:99] offset:48128
    ds_write_b128 v5, v[28:31] offset:55296
    ds_write_b128 v5, v[36:39] offset:56320
    ds_write_b128 v5, v[60:63] offset:57344
    ds_write_b128 v5, v[68:71] offset:58368
    ds_write_b128 v5, v[92:95] offset:59392
    ds_write_b128 v5, v[100:103] offset:60416
    v_pk_add_f32 v[104:105], v[8:9], 0
    v_pk_add_f32 v[106:107], v[10:11], 0
    v_pk_add_f32 v[108:109], v[16:17], 0
    v_pk_add_f32 v[110:111], v[18:19], 0
    v_pk_add_f32 v[112:113], v[40:41], 0
    v_pk_add_f32 v[114:115], v[42:43], 0
    v_pk_add_f32 v[116:117], v[48:49], 0
    v_pk_add_f32 v[118:119], v[50:51], 0
    v_pk_add_f32 v[120:121], v[72:73], 0
    v_pk_add_f32 v[122:123], v[74:75], 0
    v_pk_add_f32 v[124:125], v[80:81], 0
    v_pk_add_f32 v[126:127], v[82:83], 0
    s_branch g_epi_end_13
g_epi_14:
    s_cmp_lg_u32 s34, 1
    s_cbranch_scc1 g_epi_15
    ds_write_b128 v5, v[8:11] offset:0
    ds_write_b128 v5, v[16:19] offset:1024
    ds_write_b128 v5, v[40:43] offset:2048
    ds_write_b128 v5, v[48:51] offset:3072
    ds_write_b128 v5, v[72:75] offset:4096
    ds_write_b128 v5, v[80:83] offset:5120
    ds_write_b128 v5, v[24:27] offset:49152
    ds_write_b128 v5, v[32:35] offset:50176
    ds_write_b128 v5, v[56:59] offset:51200
    ds_write_b128 v5, v[64:67] offset:52224
    ds_write_b128 v5, v[88:91] offset:53248
    ds_write_b128 v5, v[96:99] offset:54272
    ds_write_b128 v5, v[28:31] offset:61440
    ds_write_b128 v5, v[36:39] offset:62464
    ds_write_b128 v5, v[60:63] offset:63488
    ds_write_b128 v5, v[68:71] offset:64512
    ds_write_b128 v4, v[92:95] offset:0
    ds_write_b128 v4, v[100:103] offset:1024
    v_pk_add_f32 v[104:105], v[12:13], 0
    v_pk_add_f32 v[106:107], v[14:15], 0
    v_pk_add_f32 v[108:109], v[20:21], 0
    v_pk_add_f32 v[110:111], v[22:23], 0
    v_pk_add_f32 v[112:113], v[44:45], 0
    v_pk_add_f32 v[114:115], v[46:47], 0
    v_pk_add_f32 v[116:117], v[52:53], 0
    v_pk_add_f32 v[118:119], v[54:55], 0
    v_pk_add_f32 v[120:121], v[76:77], 0
    v_pk_add_f32 v[122:123], v[78:79], 0
    v_pk_add_f32 v[124:125], v[84:85], 0
    v_pk_add_f32 v[126:127], v[86:87], 0
    s_branch g_epi_end_13
g_epi_15:
    s_cmp_lg_u32 s34, 2
    s_cbranch_scc1 g_epi_16
    ds_write_b128 v5, v[8:11] offset:6144
    ds_write_b128 v5, v[16:19] offset:7168
    ds_write_b128 v5, v[40:43] offset:8192
    ds_write_b128 v5, v[48:51] offset:9216
    ds_write_b128 v5, v[72:75] offset:10240
    ds_write_b128 v5, v[80:83] offset:11264
    ds_write_b128 v5, v[12:15] offset:18432
    ds_write_b128 v5, v[20:23] offset:19456
    ds_write_b128 v5, v[44:47] offset:20480
    ds_write_b128 v5, v[52:55] offset:21504
    ds_write_b128 v5, v[76:79] offset:22528
    ds_write_b128 v5, v[84:87] offset:23552
    ds_write_b128 v4, v[28:31] offset:2048
    ds_write_b128 v4, v[36:39] offset:3072
    ds_write_b128 v4, v[60:63] offset:4096
    ds_write_b128 v4, v[68:71] offset:5120
    ds_write_b128 v4, v[92:95] offset:6144
    ds_write_b128 v4, v[100:103] offset:7168
    v_pk_add_f32 v[104:105], v[24:25], 0
    v_pk_add_f32 v[106:107], v[26:27], 0
    v_pk_add_f32 v[108:109], v[32:33], 0
    v_pk_add_f32 v[110:111], v[34:35], 0
    v_pk_add_f32 v[112:113], v[56:57], 0
    v_pk_add_f32 v[114:115], v[58:59], 0
    v_pk_add_f32 v[116:117], v[64:65], 0
    v_pk_add_f32 v[118:119], v[66:67], 0
    v_pk_add_f32 v[120:121], v[88:89], 0
    v_pk_add_f32 v[122:123], v[90:91], 0
    v_pk_add_f32 v[124:125], v[96:97], 0
    v_pk_add_f32 v[126:127], v[98:99], 0
    s_branch g_epi_end_13
g_epi_16:
    ds_write_b128 v5, v[8:11] offset:12288
    ds_write_b128 v5, v[16:19] offset:13312
    ds_write_b128 v5, v[40:43] offset:14336
    ds_write_b128 v5, v[48:51] offset:15360
    ds_write_b128 v5, v[72:75] offset:16384
    ds_write_b128 v5, v[80:83] offset:17408
    ds_write_b128 v5, v[12:15] offset:24576
    ds_write_b128 v5, v[20:23] offset:25600
    ds_write_b128 v5, v[44:47] offset:26624
    ds_write_b128 v5, v[52:55] offset:27648
    ds_write_b128 v5, v[76:79] offset:28672
    ds_write_b128 v5, v[84:87] offset:29696
    ds_write_b128 v5, v[24:27] offset:36864
    ds_write_b128 v5, v[32:35] offset:37888
    ds_write_b128 v5, v[56:59] offset:38912
    ds_write_b128 v5, v[64:67] offset:39936
    ds_write_b128 v5, v[88:91] offset:40960
    ds_write_b128 v5, v[96:99] offset:41984
    v_pk_add_f32 v[104:105], v[28:29], 0
    v_pk_add_f32 v[106:107], v[30:31], 0
    v_pk_add_f32 v[108:109], v[36:37], 0
    v_pk_add_f32 v[110:111], v[38:39], 0
    v_pk_add_f32 v[112:113], v[60:61], 0
    v_pk_add_f32 v[114:115], v[62:63], 0
    v_pk_add_f32 v[116:117], v[68:69], 0
    v_pk_add_f32 v[118:119], v[70:71], 0
    v_pk_add_f32 v[120:121], v[92:93], 0
    v_pk_add_f32 v[122:123], v[94:95], 0
    v_pk_add_f32 v[124:125], v[100:101], 0
    v_pk_add_f32 v[126:127], v[102:103], 0
g_epi_end_13:
    s_waitcnt lgkmcnt(0)
    s_waitcnt lgkmcnt(0)
    v_mov_b32 v2, 161792
    v_mov_b32 v3, 1
    s_mov_b64 exec, 1
    ds_add_u32 v2, v3
    s_mov_b64 exec, -1
    s_mov_b32 s67, 0
gsync_20:
    ds_read_b32 v3, v2
    s_add_u32 s67, s67, 1
    s_waitcnt lgkmcnt(0)
    v_readfirstlane_b32 s66, v3
    s_cmp_gt_u32 s67, 1000000
    s_cbranch_scc1 gsync_e_21
    s_cmp_lt_u32 s66, 8
    s_cbranch_scc1 gsync_20
gsync_e_21:
    s_mul_i32 s40, s34, 18432
    v_add_u32 v2, s40, v5
    ds_read_b128 v[8:11], v2 offset:0
    ds_read_b128 v[12:15], v2 offset:1024
    ds_read_b128 v[16:19], v2 offset:2048
    ds_read_b128 v[20:23], v2 offset:3072
    ds_read_b128 v[24:27], v2 offset:4096
    ds_read_b128 v[28:31], v2 offset:5120
    ds_read_b128 v[32:35], v2 offset:6144
    ds_read_b128 v[36:39], v2 offset:7168
    ds_read_b128 v[40:43], v2 offset:8192
    ds_read_b128 v[44:47], v2 offset:9216
    ds_read_b128 v[48:51], v2 offset:10240
    ds_read_b128 v[52:55], v2 offset:11264
    ds_read_b128 v[56:59], v2 offset:12288
    ds_read_b128 v[60:63], v2 offset:13312
    ds_read_b128 v[64:67], v2 offset:14336
    ds_read_b128 v[68:71], v2 offset:15360
    ds_read_b128 v[72:75], v2 offset:16384
    ds_read_b128 v[76:79], v2 offset:17408
    v_lshrrev_b32 v6, 4, v1
    v_and_b32 v6, 1, v6
    v_mul_u32_u24 v6, 24576, v6
    v_and_b32 v3, 15, v1
    v_lshrrev_b32 v4, 5, v1
    v_lshl_add_u32 v3, v4, 4, v3
    v_lshl_add_u32 v6, v3, 4, v6
    s_mul_i32 s40, s32, 98304
    s_lshr_b32 s41, s34, 1
    s_mul_i32 s41, s41, 49152
    s_add_u32 s40, s40, s41
    s_mul_i32 s41, s33, 3072
    s_add_u32 s40, s40, s41
    s_and_b32 s41, s34, 1
    s_lshl_b32 s41, s41, 9
    s_add_u32 s40, s40, s41
    s_add_u32 s40, s40, 11534336
    s_waitcnt vmcnt(0)
    v_lshlrev_b32 v180, 16, v196
    v_lshlrev_b32 v80, 16, v184
    v_and_b32 v81, 0xffff0000, v184
    v_lshlrev_b32 v82, 16, v185
    v_and_b32 v83, 0xffff0000, v185
    v_lshlrev_b32 v84, 16, v186
    v_and_b32 v85, 0xffff0000, v186
    v_lshlrev_b32 v86, 16, v187
    v_and_b32 v87, 0xffff0000, v187
    v_lshlrev_b32 v88, 16, v188
    v_and_b32 v89, 0xffff0000, v188
    v_lshlrev_b32 v90, 16, v189
    v_and_b32 v91, 0xffff0000, v189
    v_lshlrev_b32 v92, 16, v190
    v_and_b32 v93, 0xffff0000, v190
    v_lshlrev_b32 v94, 16, v191
    v_and_b32 v95, 0xffff0000, v191
    v_lshlrev_b32 v96, 16, v192
    v_and_b32 v97, 0xffff0000, v192
    v_lshlrev_b32 v98, 16, v193
    v_and_b32 v99, 0xffff0000, v193
    v_lshlrev_b32 v100, 16, v194
    v_and_b32 v101, 0xffff0000, v194
    v_lshlrev_b32 v102, 16, v195
    v_and_b32 v103, 0xffff0000, v195
    s_waitcnt lgkmcnt(12)
    v_pk_add_f32 v[104:105], v[104:105], v[8:9]
    v_pk_add_f32 v[106:107], v[106:107], v[10:11]
    v_pk_add_f32 v[108:109], v[108:109], v[12:13]
    v_pk_add_f32 v[110:111], v[110:111], v[14:15]
    v_pk_add_f32 v[112:113], v[112:113], v[16:17]
    v_pk_add_f32 v[114:115], v[114:115], v[18:19]
    v_pk_add_f32 v[116:117], v[116:117], v[20:21]
    v_pk_add_f32 v[118:119], v[118:119], v[22:23]
    v_pk_add_f32 v[120:121], v[120:121], v[24:25]
    v_pk_add_f32 v[122:123], v[122:123], v[26:27]
    v_pk_add_f32 v[124:125], v[124:125], v[28:29]
    v_pk_add_f32 v[126:127], v[126:127], v[30:31]
    s_waitcnt lgkmcnt(6)
    v_pk_add_f32 v[104:105], v[104:105], v[32:33]
    v_pk_add_f32 v[106:107], v[106:107], v[34:35]
    v_pk_add_f32 v[108:109], v[108:109], v[36:37]
    v_pk_add_f32 v[110:111], v[110:111], v[38:39]
    v_pk_add_f32 v[112:113], v[112:113], v[40:41]
    v_pk_add_f32 v[114:115], v[114:115], v[42:43]
    v_pk_add_f32 v[116:117], v[116:117], v[44:45]
    v_pk_add_f32 v[118:119], v[118:119], v[46:47]
    v_pk_add_f32 v[120:121], v[120:121], v[48:49]
    v_pk_add_f32 v[122:123], v[122:123], v[50:51]
    v_pk_add_f32 v[124:125], v[124:125], v[52:53]
    v_pk_add_f32 v[126:127], v[126:127], v[54:55]
    s_waitcnt lgkmcnt(0)
    v_pk_add_f32 v[104:105], v[104:105], v[56:57]
    v_pk_add_f32 v[106:107], v[106:107], v[58:59]
    v_pk_add_f32 v[108:109], v[108:109], v[60:61]
    v_pk_add_f32 v[110:111], v[110:111], v[62:63]
    v_pk_add_f32 v[112:113], v[112:113], v[64:65]
    v_pk_add_f32 v[114:115], v[114:115], v[66:67]
    v_pk_add_f32 v[116:117], v[116:117], v[68:69]
    v_pk_add_f32 v[118:119], v[118:119], v[70:71]
    v_pk_add_f32 v[120:121], v[120:121], v[72:73]
    v_pk_add_f32 v[122:123], v[122:123], v[74:75]
    v_pk_add_f32 v[124:125], v[124:125], v[76:77]
    v_pk_add_f32 v[126:127], v[126:127], v[78:79]
    v_pk_add_f32 v[104:105], v[104:105], v[180:181] op_sel_hi:[1,0]
    v_pk_add_f32 v[106:107], v[106:107], v[180:181] op_sel_hi:[1,0]
    v_pk_add_f32 v[108:109], v[108:109], v[180:181] op_sel_hi:[1,0]
    v_pk_add_f32 v[110:111], v[110:111], v[180:181] op_sel_hi:[1,0]
    v_pk_add_f32 v[112:113], v[112:113], v[180:181] op_sel_hi:[1,0]
    v_pk_add_f32 v[114:115], v[114:115], v[180:181] op_sel_hi:[1,0]
    v_pk_add_f32 v[116:117], v[116:117], v[180:181] op_sel_hi:[1,0]
    v_pk_add_f32 v[118:119], v[118:119], v[180:181] op_sel_hi:[1,0]
    v_pk_add_f32 v[120:121], v[120:121], v[180:181] op_sel_hi:[1,0]
    v_pk_add_f32 v[122:123], v[122:123], v[180:181] op_sel_hi:[1,0]
    v_pk_add_f32 v[124:125], v[124:125], v[180:181] op_sel_hi:[1,0]
    v_pk_add_f32 v[126:127], v[126:127], v[180:181] op_sel_hi:[1,0]
    v_pk_mul_f32 v[104:105], v[104:105], v[80:81]
    v_pk_mul_f32 v[106:107], v[106:107], v[82:83]
    v_pk_mul_f32 v[108:109], v[108:109], v[84:85]
    v_pk_mul_f32 v[110:111], v[110:111], v[86:87]
    v_pk_mul_f32 v[112:113], v[112:113], v[88:89]
    v_pk_mul_f32 v[114:115], v[114:115], v[90:91]
    v_pk_mul_f32 v[116:117], v[116:117], v[92:93]
    v_pk_mul_f32 v[118:119], v[118:119], v[94:95]
    v_pk_mul_f32 v[120:121], v[120:121], v[96:97]
    v_pk_mul_f32 v[122:123], v[122:123], v[98:99]
    v_pk_mul_f32 v[124:125], v[124:125], v[100:101]
    v_pk_mul_f32 v[126:127], v[126:127], v[102:103]
    v_cvt_pk_bf16_f32 v8, v104, v105
    v_cvt_pk_bf16_f32 v9, v106, v107
    v_cvt_pk_bf16_f32 v10, v108, v109
    v_cvt_pk_bf16_f32 v11, v110, v111
    buffer_store_dwordx4 v[8:11], v6, s[8:11], s40 offen offset:0 sc1
    v_cvt_pk_bf16_f32 v12, v112, v113
    v_cvt_pk_bf16_f32 v13, v114, v115
    v_cvt_pk_bf16_f32 v14, v116, v117
    v_cvt_pk_bf16_f32 v15, v118, v119
    buffer_store_dwordx4 v[12:15], v6, s[8:11], s40 offen offset:1024 sc1
    v_cvt_pk_bf16_f32 v16, v120, v121
    v_cvt_pk_bf16_f32 v17, v122, v123
    v_cvt_pk_bf16_f32 v18, v124, v125
    v_cvt_pk_bf16_f32 v19, v126, v127
    buffer_store_dwordx4 v[16:19], v6, s[8:11], s40 offen offset:2048 sc1
    s_waitcnt vmcnt(0) lgkmcnt(0)
    s_barrier
    s_lshl_b32 s40, s2, 3
    s_add_u32 s40, s40, 14721024
    v_mov_b32 v2, s100
    v_mov_b32 v3, s101
    v_mov_b32 v1, 0
    s_cmp_eq_u32 s34, 0
    s_cselect_b64 exec, 1, 0
    buffer_store_dwordx2 v[2:3], v1, s[8:11], s40 offen sc1
    s_mov_b64 exec, -1
    s_load_dwordx2 s[12:13], s[0:1], 104
    s_load_dwordx2 s[8:9], s[0:1], 0
    s_load_dwordx2 s[16:17], s[0:1], 88
    s_mov_b32 s10, 2621440
    s_mov_b32 s11, 0x20000
    s_mov_b32 s14, 15990784
    s_mov_b32 s15, 0x20000
    s_mov_b32 s18, 2621440
    s_mov_b32 s19, 0x20000
    v_lshrrev_b32 v4, 6, v0
    v_and_b32 v1, 63, v0
    v_readfirstlane_b32 s34, v4
    v_lshlrev_b32 v7, 4, v1
    s_and_b32 s40, s2, 7
    s_lshr_b32 s41, s2, 3
    s_lshr_b32 s32, s40, 1
    s_lshl_b32 s32, s32, 3
    s_and_b32 s42, s41, 7
    s_add_u32 s32, s32, s42
    s_and_b32 s33, s40, 1
    s_lshl_b32 s33, s33, 2
    s_lshr_b32 s42, s41, 3
    s_add_u32 s33, s33, s42
    s_add_u32 s40, s32, s33
    s_mul_i32 s41, s40, 43
    s_lshr_b32 s41, s41, 8
    s_mul_i32 s41, s41, 6
    s_sub_u32 s48, s40, s41
    s_mul_i32 s46, s33, 122880
    s_add_u32 s46, s46, 15007744
    s_mul_i32 s40, s34, 5120
    s_add_u32 s46, s46, s40
    s_mul_i32 s47, s32, 98304
    s_mul_i32 s41, s34, 24576
    s_add_u32 s47, s47, s41
    s_add_u32 s47, s47, 11534336
    s_add_u32 s40, s48, 0
    s_sub_u32 s41, s40, 6
    s_cmp_ge_u32 s40, 6
    s_cselect_b32 s50, s41, s40
    s_add_u32 s40, s48, 1
    s_sub_u32 s41, s40, 6
    s_cmp_ge_u32 s40, 6
    s_cselect_b32 s51, s41, s40
    s_add_u32 s40, s48, 2
    s_sub_u32 s41, s40, 6
    s_cmp_ge_u32 s40, 6
    s_cselect_b32 s52, s41, s40
    s_add_u32 s40, s48, 3
    s_sub_u32 s41, s40, 6
    s_cmp_ge_u32 s40, 6
    s_cselect_b32 s53, s41, s40
    s_add_u32 s40, s48, 4
    s_sub_u32 s41, s40, 6
    s_cmp_ge_u32 s40, 6
    s_cselect_b32 s54, s41, s40
    s_add_u32 s40, s48, 5
    s_sub_u32 s41, s40, 6
    s_cmp_ge_u32 s40, 6
    s_cselect_b32 s55, s41, s40
    s_waitcnt lgkmcnt(0)
    s_mul_i32 s40, s33, 192
    s_add_u32 s40, s40, 14725120
    v_mbcnt_lo_u32_b32 v4, -1, 0
    v_mbcnt_hi_u32_b32 v4, -1, v4
    v_min_u32 v4, 23, v4
    v_lshlrev_b32 v4, 3, v4
    s_mov_b32 s67, 0
fpoll_22:
    buffer_load_dwordx2 v[8:9], v4, s[12:15], s40 offen sc1
    s_add_u32 s67, s67, 1
    s_waitcnt vmcnt(0)
    v_cmp_ne_u32 vcc, s100, v8
    v_cmp_ne_u32 s[64:65], s101, v9
    s_nop 0
    s_or_b64 vcc, vcc, s[64:65]
    s_cmp_gt_u32 s67, 100000
    s_cbranch_scc1 fpoll_e_23
    s_cmp_eq_u64 vcc, 0
    s_cbranch_scc1 fpoll_e_23
    s_sleep 2
    s_branch fpoll_22
fpoll_e_23:
    s_mul_i32 s40, s50, 20480
    s_add_u32 s40, s40, s46
    s_add_u32 s40, s40, 0
    s_mul_i32 s41, s34, 5120
    s_add_u32 m0, s41, 0
    s_nop 0
    buffer_load_dwordx4 v7, s[12:15], s40 offen sc1 lds
    s_mul_i32 s40, s50, 20480
    s_add_u32 s40, s40, s46
    s_add_u32 s40, s40, 1024
    s_mul_i32 s41, s34, 5120
    s_add_u32 m0, s41, 1024
    s_nop 0
    buffer_load_dwordx4 v7, s[12:15], s40 offen sc1 lds
    s_mul_i32 s40, s50, 20480
    s_add_u32 s40, s40, s46
    s_add_u32 s40, s40, 2048
    s_mul_i32 s41, s34, 5120
    s_add_u32 m0, s41, 2048
    s_nop 0
    buffer_load_dwordx4 v7, s[12:15], s40 offen sc1 lds
    s_mul_i32 s40, s50, 20480
    s_add_u32 s40, s40, s46
    s_add_u32 s40, s40, 3072
    s_mul_i32 s41, s34, 5120
    s_add_u32 m0, s41, 3072
    s_nop 0
    buffer_load_dwordx4 v7, s[12:15], s40 offen sc1 lds
    s_mul_i32 s40, s50, 20480
    s_add_u32 s40, s40, s46
    s_add_u32 s40, s40, 4096
    s_mul_i32 s41, s34, 5120
    s_add_u32 m0, s41, 4096
    s_nop 0
    buffer_load_dwordx4 v7, s[12:15], s40 offen sc1 lds
    s_mul_i32 s40, s51, 20480
    s_add_u32 s40, s40, s46
    s_add_u32 s40, s40, 0
    s_mul_i32 s41, s34, 5120
    s_add_u32 m0, s41, 20480
    s_nop 0
    buffer_load_dwordx4 v7, s[12:15], s40 offen sc1 lds
    s_mul_i32 s40, s51, 20480
    s_add_u32 s40, s40, s46
    s_add_u32 s40, s40, 1024
    s_mul_i32 s41, s34, 5120
    s_add_u32 m0, s41, 21504
    s_nop 0
    buffer_load_dwordx4 v7, s[12:15], s40 offen sc1 lds
    s_mul_i32 s40, s51, 20480
    s_add_u32 s40, s40, s46
    s_add_u32 s40, s40, 2048
    s_mul_i32 s41, s34, 5120
    s_add_u32 m0, s41, 22528
    s_nop 0
    buffer_load_dwordx4 v7, s[12:15], s40 offen sc1 lds
    s_mul_i32 s40, s51, 20480
    s_add_u32 s40, s40, s46
    s_add_u32 s40, s40, 3072
    s_mul_i32 s41, s34, 5120
    s_add_u32 m0, s41, 23552
    s_nop 0
    buffer_load_dwordx4 v7, s[12:15], s40 offen sc1 lds
    s_mul_i32 s40, s51, 20480
    s_add_u32 s40, s40, s46
    s_add_u32 s40, s40, 4096
    s_mul_i32 s41, s34, 5120
    s_add_u32 m0, s41, 24576
    s_nop 0
    buffer_load_dwordx4 v7, s[12:15], s40 offen sc1 lds
    s_mul_i32 s40, s52, 20480
    s_add_u32 s40, s40, s46
    s_add_u32 s40, s40, 0
    s_mul_i32 s41, s34, 5120
    s_add_u32 m0, s41, 40960
    s_nop 0
    buffer_load_dwordx4 v7, s[12:15], s40 offen sc1 lds
    s_mul_i32 s40, s52, 20480
    s_add_u32 s40, s40, s46
    s_add_u32 s40, s40, 1024
    s_mul_i32 s41, s34, 5120
    s_add_u32 m0, s41, 41984
    s_nop 0
    buffer_load_dwordx4 v7, s[12:15], s40 offen sc1 lds
    s_mul_i32 s40, s52, 20480
    s_add_u32 s40, s40, s46
    s_add_u32 s40, s40, 2048
    s_mul_i32 s41, s34, 5120
    s_add_u32 m0, s41, 43008
    s_nop 0
    buffer_load_dwordx4 v7, s[12:15], s40 offen sc1 lds
    s_mul_i32 s40, s52, 20480
    s_add_u32 s40, s40, s46
    s_add_u32 s40, s40, 3072
    s_mul_i32 s41, s34, 5120
    s_add_u32 m0, s41, 44032
    s_nop 0
    buffer_load_dwordx4 v7, s[12:15], s40 offen sc1 lds
    s_mul_i32 s40, s52, 20480
    s_add_u32 s40, s40, s46
    s_add_u32 s40, s40, 4096
    s_mul_i32 s41, s34, 5120
    s_add_u32 m0, s41, 45056
    s_nop 0
    buffer_load_dwordx4 v7, s[12:15], s40 offen sc1 lds
    s_mul_i32 s40, s53, 20480
    s_add_u32 s40, s40, s46
    s_add_u32 s40, s40, 0
    s_mul_i32 s41, s34, 5120
    s_add_u32 m0, s41, 61440
    s_nop 0
    buffer_load_dwordx4 v7, s[12:15], s40 offen sc1 lds
    s_mul_i32 s40, s53, 20480
    s_add_u32 s40, s40, s46
    s_add_u32 s40, s40, 1024
    s_mul_i32 s41, s34, 5120
    s_add_u32 m0, s41, 62464
    s_nop 0
    buffer_load_dwordx4 v7, s[12:15], s40 offen sc1 lds
    s_mul_i32 s40, s53, 20480
    s_add_u32 s40, s40, s46
    s_add_u32 s40, s40, 2048
    s_mul_i32 s41, s34, 5120
    s_add_u32 m0, s41, 63488
    s_nop 0
    buffer_load_dwordx4 v7, s[12:15], s40 offen sc1 lds
    s_mul_i32 s40, s53, 20480
    s_add_u32 s40, s40, s46
    s_add_u32 s40, s40, 3072
    s_mul_i32 s41, s34, 5120
    s_add_u32 m0, s41, 64512
    s_nop 0
    buffer_load_dwordx4 v7, s[12:15], s40 offen sc1 lds
    s_mul_i32 s40, s53, 20480
    s_add_u32 s40, s40, s46
    s_add_u32 s40, s40, 4096
    s_mul_i32 s41, s34, 5120
    s_add_u32 m0, s41, 65536
    s_nop 0
    buffer_load_dwordx4 v7, s[12:15], s40 offen sc1 lds
    s_mul_i32 s40, s54, 20480
    s_add_u32 s40, s40, s46
    s_add_u32 s40, s40, 0
    s_mul_i32 s41, s34, 5120
    s_add_u32 m0, s41, 81920
    s_nop 0
    buffer_load_dwordx4 v7, s[12:15], s40 offen sc1 lds
    s_mul_i32 s40, s54, 20480
    s_add_u32 s40, s40, s46
    s_add_u32 s40, s40, 1024
    s_mul_i32 s41, s34, 5120
    s_add_u32 m0, s41, 82944
    s_nop 0
    buffer_load_dwordx4 v7, s[12:15], s40 offen sc1 lds
    s_mul_i32 s40, s54, 20480
    s_add_u32 s40, s40, s46
    s_add_u32 s40, s40, 2048
    s_mul_i32 s41, s34, 5120
    s_add_u32 m0, s41, 83968
    s_nop 0
    buffer_load_dwordx4 v7, s[12:15], s40 offen sc1 lds
    s_mul_i32 s40, s54, 20480
    s_add_u32 s40, s40, s46
    s_add_u32 s40, s40, 3072
    s_mul_i32 s41, s34, 5120
    s_add_u32 m0, s41, 84992
    s_nop 0
    buffer_load_dwordx4 v7, s[12:15], s40 offen sc1 lds
    s_mul_i32 s40, s54, 20480
    s_add_u32 s40, s40, s46
    s_add_u32 s40, s40, 4096
    s_mul_i32 s41, s34, 5120
    s_add_u32 m0, s41, 86016
    s_nop 0
    buffer_load_dwordx4 v7, s[12:15], s40 offen sc1 lds
    s_mul_i32 s40, s55, 20480
    s_add_u32 s40, s40, s46
    s_add_u32 s40, s40, 0
    s_mul_i32 s41, s34, 5120
    s_add_u32 m0, s41, 102400
    s_nop 0
    buffer_load_dwordx4 v7, s[12:15], s40 offen sc1 lds
    s_mul_i32 s40, s55, 20480
    s_add_u32 s40, s40, s46
    s_add_u32 s40, s40, 1024
    s_mul_i32 s41, s34, 5120
    s_add_u32 m0, s41, 103424
    s_nop 0
    buffer_load_dwordx4 v7, s[12:15], s40 offen sc1 lds
    s_mul_i32 s40, s55, 20480
    s_add_u32 s40, s40, s46
    s_add_u32 s40, s40, 2048
    s_mul_i32 s41, s34, 5120
    s_add_u32 m0, s41, 104448
    s_nop 0
    buffer_load_dwordx4 v7, s[12:15], s40 offen sc1 lds
    s_mul_i32 s40, s55, 20480
    s_add_u32 s40, s40, s46
    s_add_u32 s40, s40, 3072
    s_mul_i32 s41, s34, 5120
    s_add_u32 m0, s41, 105472
    s_nop 0
    buffer_load_dwordx4 v7, s[12:15], s40 offen sc1 lds
    s_mul_i32 s40, s55, 20480
    s_add_u32 s40, s40, s46
    s_add_u32 s40, s40, 4096
    s_mul_i32 s41, s34, 5120
    s_add_u32 m0, s41, 106496
    s_nop 0
    buffer_load_dwordx4 v7, s[12:15], s40 offen sc1 lds
    v_mbcnt_lo_u32_b32 v4, -1, 0
    v_mbcnt_hi_u32_b32 v4, -1, v4
    v_lshlrev_b32 v4, 4, v4
    s_mov_b32 s66, 14721024
    s_mov_b32 s67, 0
fpoll_24:
    buffer_load_dwordx4 v[8:11], v4, s[12:15], s66 offen sc1
    buffer_load_dwordx4 v[12:15], v4, s[12:15], s66 offen offset:1024 sc1
    s_add_u32 s67, s67, 1
    s_waitcnt vmcnt(0)
    v_cmp_ne_u32 vcc, s100, v8
    v_cmp_ne_u32 s[64:65], s101, v9
    s_nop 0
    s_or_b64 vcc, vcc, s[64:65]
    v_cmp_ne_u32 s[64:65], s100, v10
    s_nop 0
    s_or_b64 vcc, vcc, s[64:65]
    v_cmp_ne_u32 s[64:65], s101, v11
    s_nop 0
    s_or_b64 vcc, vcc, s[64:65]
    v_cmp_ne_u32 s[64:65], s100, v12
    s_nop 0
    s_or_b64 vcc, vcc, s[64:65]
    v_cmp_ne_u32 s[64:65], s101, v13
    s_nop 0
    s_or_b64 vcc, vcc, s[64:65]
    v_cmp_ne_u32 s[64:65], s100, v14
    s_nop 0
    s_or_b64 vcc, vcc, s[64:65]
    v_cmp_ne_u32 s[64:65], s101, v15
    s_nop 0
    s_or_b64 vcc, vcc, s[64:65]
    s_cmp_gt_u32 s67, 100000
    s_cbranch_scc1 fpoll_e_25
    s_cmp_eq_u64 vcc, 0
    s_cbranch_scc1 fpoll_e_25
    s_sleep 2
    s_branch fpoll_24
fpoll_e_25:
    s_lshl_b32 s42, s50, 12
    s_add_u32 s42, s42, s47
    buffer_load_dwordx4 v[8:11], v7, s[12:15], s42 offen offset:0 sc1
    s_lshl_b32 s42, s50, 12
    s_add_u32 s42, s42, s47
    buffer_load_dwordx4 v[12:15], v7, s[12:15], s42 offen offset:1024 sc1
    s_lshl_b32 s42, s50, 12
    s_add_u32 s42, s42, s47
    buffer_load_dwordx4 v[16:19], v7, s[12:15], s42 offen offset:2048 sc1
    s_lshl_b32 s42, s50, 12
    s_add_u32 s42, s42, s47
    buffer_load_dwordx4 v[20:23], v7, s[12:15], s42 offen offset:3072 sc1
    s_lshl_b32 s42, s51, 12
    s_add_u32 s42, s42, s47
    buffer_load_dwordx4 v[24:27], v7, s[12:15], s42 offen offset:0 sc1
    s_lshl_b32 s42, s51, 12
    s_add_u32 s42, s42, s47
    buffer_load_dwordx4 v[28:31], v7, s[12:15], s42 offen offset:1024 sc1
    s_lshl_b32 s42, s51, 12
    s_add_u32 s42, s42, s47
    buffer_load_dwordx4 v[32:35], v7, s[12:15], s42 offen offset:2048 sc1
    s_lshl_b32 s42, s51, 12
    s_add_u32 s42, s42, s47
    buffer_load_dwordx4 v[36:39], v7, s[12:15], s42 offen offset:3072 sc1
    s_mul_i32 s44, s33, 160
    s_mul_i32 s45, s32, 81920
    s_add_u32 s45, s45, s44
    v_add_u32 v4, 0, v1
    v_mul_u32_u24 v5, 6554, v4
    v_lshrrev_b32 v5, 16, v5
    v_mul_u32_u24 v6, 10, v5
    v_sub_u32 v4, v4, v6
    v_lshlrev_b32 v4, 4, v4
    v_mul_u32_u24 v5, 1280, v5
    v_add_u32 v104, v4, v5
    v_add_u32 v4, 64, v1
    v_mul_u32_u24 v5, 6554, v4
    v_lshrrev_b32 v5, 16, v5
    v_mul_u32_u24 v6, 10, v5
    v_sub_u32 v4, v4, v6
    v_lshlrev_b32 v4, 4, v4
    v_mul_u32_u24 v5, 1280, v5
    v_add_u32 v105, v4, v5
    v_add_u32 v4, 128, v1
    v_mul_u32_u24 v5, 6554, v4
    v_lshrrev_b32 v5, 16, v5
    v_mul_u32_u24 v6, 10, v5
    v_sub_u32 v4, v4, v6
    v_lshlrev_b32 v4, 4, v4
    v_mul_u32_u24 v5, 1280, v5
    v_add_u32 v106, v4, v5
    v_add_u32 v4, 192, v1
    v_mul_u32_u24 v5, 6554, v4
    v_lshrrev_b32 v5, 16, v5
    v_mul_u32_u24 v6, 10, v5
    v_sub_u32 v4, v4, v6
    v_lshlrev_b32 v4, 4, v4
    v_mul_u32_u24 v5, 1280, v5
    v_add_u32 v107, v4, v5
    v_add_u32 v4, 256, v1
    v_mul_u32_u24 v5, 6554, v4
    v_lshrrev_b32 v5, 16, v5
    v_mul_u32_u24 v6, 10, v5
    v_sub_u32 v4, v4, v6
    v_lshlrev_b32 v4, 4, v4
    v_mul_u32_u24 v5, 1280, v5
    v_add_u32 v108, v4, v5
    v_lshrrev_b32 v2, 4, v1
    v_and_b32 v3, 15, v1
    v_mov_b32 v113, v7
    v_add_u32 v114, 61440, v7
    s_waitcnt vmcnt(33)
    s_barrier
    ds_read_b128 v[136:139], v113 offset:0
    ds_read_b128 v[140:143], v113 offset:1024
    ds_read_b128 v[144:147], v113 offset:2048
    ds_read_b128 v[148:151], v113 offset:3072
    ds_read_b128 v[152:155], v113 offset:4096
    ds_read_b128 v[156:159], v113 offset:5120
    ds_read_b128 v[160:163], v113 offset:6144
    ds_read_b128 v[164:167], v113 offset:7168
    ds_read_b128 v[168:171], v113 offset:8192
    ds_read_b128 v[172:175], v113 offset:9216
    s_waitcnt vmcnt(7)
    s_waitcnt lgkmcnt(9)
    v_mfma_f32_16x16x32_bf16 v[116:119], v[136:139], v[8:11], 0
    s_lshl_b32 s42, s52, 12
    s_add_u32 s42, s42, s47
    buffer_load_dwordx4 v[40:43], v7, s[12:15], s42 offen offset:0 sc1
    s_waitcnt lgkmcnt(8)
    v_mfma_f32_16x16x32_bf16 v[120:123], v[140:143], v[8:11], 0
    s_waitcnt lgkmcnt(7)
    v_mfma_f32_16x16x32_bf16 v[124:127], v[144:147], v[8:11], 0
    s_lshl_b32 s42, s52, 12
    s_add_u32 s42, s42, s47
    buffer_load_dwordx4 v[44:47], v7, s[12:15], s42 offen offset:1024 sc1
    s_waitcnt lgkmcnt(6)
    v_mfma_f32_16x16x32_bf16 v[128:131], v[148:151], v[8:11], 0
    s_waitcnt lgkmcnt(5)
    v_mfma_f32_16x16x32_bf16 v[132:135], v[152:155], v[8:11], 0
    s_lshl_b32 s42, s52, 12
    s_add_u32 s42, s42, s47
    buffer_load_dwordx4 v[48:51], v7, s[12:15], s42 offen offset:2048 sc1
    ds_read_b128 v[136:139], v113 offset:10240
    ds_read_b128 v[140:143], v113 offset:11264
    ds_read_b128 v[144:147], v113 offset:12288
    ds_read_b128 v[148:151], v113 offset:13312
    ds_read_b128 v[152:155], v113 offset:14336
    s_waitcnt vmcnt(9)
    s_waitcnt lgkmcnt(9)
    v_mfma_f32_16x16x32_bf16 v[116:119], v[156:159], v[12:15], v[116:119]
    s_lshl_b32 s42, s52, 12
    s_add_u32 s42, s42, s47
    buffer_load_dwordx4 v[52:55], v7, s[12:15], s42 offen offset:3072 sc1
    s_waitcnt lgkmcnt(8)
    v_mfma_f32_16x16x32_bf16 v[120:123], v[160:163], v[12:15], v[120:123]
    s_waitcnt lgkmcnt(7)
    v_mfma_f32_16x16x32_bf16 v[124:127], v[164:167], v[12:15], v[124:127]
    s_waitcnt lgkmcnt(6)
    v_mfma_f32_16x16x32_bf16 v[128:131], v[168:171], v[12:15], v[128:131]
    s_waitcnt lgkmcnt(5)
    v_mfma_f32_16x16x32_bf16 v[132:135], v[172:175], v[12:15], v[132:135]
    ds_read_b128 v[156:159], v113 offset:15360
    ds_read_b128 v[160:163], v113 offset:16384
    ds_read_b128 v[164:167], v113 offset:17408
    ds_read_b128 v[168:171], v113 offset:18432
    ds_read_b128 v[172:175], v113 offset:19456
    s_waitcnt vmcnt(9)
    s_waitcnt lgkmcnt(9)
    v_mfma_f32_16x16x32_bf16 v[116:119], v[136:139], v[16:19], v[116:119]
    s_waitcnt lgkmcnt(8)
    v_mfma_f32_16x16x32_bf16 v[120:123], v[140:143], v[16:19], v[120:123]
    s_waitcnt lgkmcnt(7)
    v_mfma_f32_16x16x32_bf16 v[124:127], v[144:147], v[16:19], v[124:127]
    s_waitcnt lgkmcnt(6)
    v_mfma_f32_16x16x32_bf16 v[128:131], v[148:151], v[16:19], v[128:131]
    s_waitcnt lgkmcnt(5)
    v_mfma_f32_16x16x32_bf16 v[132:135], v[152:155], v[16:19], v[132:135]
    s_waitcnt vmcnt(8)
    s_waitcnt lgkmcnt(4)
    v_mfma_f32_16x16x32_bf16 v[116:119], v[156:159], v[20:23], v[116:119]
    s_waitcnt lgkmcnt(3)
    v_mfma_f32_16x16x32_bf16 v[120:123], v[160:163], v[20:23], v[120:123]
    s_waitcnt lgkmcnt(2)
    v_mfma_f32_16x16x32_bf16 v[124:127], v[164:167], v[20:23], v[124:127]
    s_waitcnt lgkmcnt(1)
    v_mfma_f32_16x16x32_bf16 v[128:131], v[168:171], v[20:23], v[128:131]
    s_waitcnt lgkmcnt(0)
    v_mfma_f32_16x16x32_bf16 v[132:135], v[172:175], v[20:23], v[132:135]
    s_waitcnt vmcnt(32)
    s_barrier
    ds_read_b128 v[136:139], v113 offset:20480
    ds_read_b128 v[140:143], v113 offset:21504
    ds_read_b128 v[144:147], v113 offset:22528
    ds_read_b128 v[148:151], v113 offset:23552
    ds_read_b128 v[152:155], v113 offset:24576
    ds_read_b128 v[156:159], v113 offset:25600
    ds_read_b128 v[160:163], v113 offset:26624
    ds_read_b128 v[164:167], v113 offset:27648
    ds_read_b128 v[168:171], v113 offset:28672
    ds_read_b128 v[172:175], v113 offset:29696
    s_waitcnt vmcnt(7)
    s_waitcnt lgkmcnt(9)
    v_mfma_f32_16x16x32_bf16 v[116:119], v[136:139], v[24:27], v[116:119]
    s_lshl_b32 s42, s53, 12
    s_add_u32 s42, s42, s47
    buffer_load_dwordx4 v[56:59], v7, s[12:15], s42 offen offset:0 sc1
    s_waitcnt lgkmcnt(8)
    v_mfma_f32_16x16x32_bf16 v[120:123], v[140:143], v[24:27], v[120:123]
    s_waitcnt lgkmcnt(7)
    v_mfma_f32_16x16x32_bf16 v[124:127], v[144:147], v[24:27], v[124:127]
    s_lshl_b32 s42, s53, 12
    s_add_u32 s42, s42, s47
    buffer_load_dwordx4 v[60:63], v7, s[12:15], s42 offen offset:1024 sc1
    s_waitcnt lgkmcnt(6)
    v_mfma_f32_16x16x32_bf16 v[128:131], v[148:151], v[24:27], v[128:131]
    s_waitcnt lgkmcnt(5)
    v_mfma_f32_16x16x32_bf16 v[132:135], v[152:155], v[24:27], v[132:135]
    s_lshl_b32 s42, s53, 12
    s_add_u32 s42, s42, s47
    buffer_load_dwordx4 v[64:67], v7, s[12:15], s42 offen offset:2048 sc1
    ds_read_b128 v[136:139], v113 offset:30720
    ds_read_b128 v[140:143], v113 offset:31744
    ds_read_b128 v[144:147], v113 offset:32768
    ds_read_b128 v[148:151], v113 offset:33792
    ds_read_b128 v[152:155], v113 offset:34816
    s_waitcnt vmcnt(9)
    s_waitcnt lgkmcnt(9)
    v_mfma_f32_16x16x32_bf16 v[116:119], v[156:159], v[28:31], v[116:119]
    s_lshl_b32 s42, s53, 12
    s_add_u32 s42, s42, s47
    buffer_load_dwordx4 v[68:71], v7, s[12:15], s42 offen offset:3072 sc1
    s_waitcnt lgkmcnt(8)
    v_mfma_f32_16x16x32_bf16 v[120:123], v[160:163], v[28:31], v[120:123]
    s_waitcnt lgkmcnt(7)
    v_mfma_f32_16x16x32_bf16 v[124:127], v[164:167], v[28:31], v[124:127]
    s_waitcnt lgkmcnt(6)
    v_mfma_f32_16x16x32_bf16 v[128:131], v[168:171], v[28:31], v[128:131]
    s_waitcnt lgkmcnt(5)
    v_mfma_f32_16x16x32_bf16 v[132:135], v[172:175], v[28:31], v[132:135]
    ds_read_b128 v[156:159], v113 offset:35840
    ds_read_b128 v[160:163], v113 offset:36864
    ds_read_b128 v[164:167], v113 offset:37888
    ds_read_b128 v[168:171], v113 offset:38912
    ds_read_b128 v[172:175], v113 offset:39936
    s_waitcnt vmcnt(9)
    s_waitcnt lgkmcnt(9)
    v_mfma_f32_16x16x32_bf16 v[116:119], v[136:139], v[32:35], v[116:119]
    s_waitcnt lgkmcnt(8)
    v_mfma_f32_16x16x32_bf16 v[120:123], v[140:143], v[32:35], v[120:123]
    s_waitcnt lgkmcnt(7)
    v_mfma_f32_16x16x32_bf16 v[124:127], v[144:147], v[32:35], v[124:127]
    s_waitcnt lgkmcnt(6)
    v_mfma_f32_16x16x32_bf16 v[128:131], v[148:151], v[32:35], v[128:131]
    s_waitcnt lgkmcnt(5)
    v_mfma_f32_16x16x32_bf16 v[132:135], v[152:155], v[32:35], v[132:135]
    s_waitcnt vmcnt(8)
    s_waitcnt lgkmcnt(4)
    v_mfma_f32_16x16x32_bf16 v[116:119], v[156:159], v[36:39], v[116:119]
    s_waitcnt lgkmcnt(3)
    v_mfma_f32_16x16x32_bf16 v[120:123], v[160:163], v[36:39], v[120:123]
    s_waitcnt lgkmcnt(2)
    v_mfma_f32_16x16x32_bf16 v[124:127], v[164:167], v[36:39], v[124:127]
    s_waitcnt lgkmcnt(1)
    v_mfma_f32_16x16x32_bf16 v[128:131], v[168:171], v[36:39], v[128:131]
    s_waitcnt lgkmcnt(0)
    v_mfma_f32_16x16x32_bf16 v[132:135], v[172:175], v[36:39], v[132:135]
    s_waitcnt vmcnt(31)
    s_barrier
    ds_read_b128 v[136:139], v113 offset:40960
    ds_read_b128 v[140:143], v113 offset:41984
    ds_read_b128 v[144:147], v113 offset:43008
    ds_read_b128 v[148:151], v113 offset:44032
    ds_read_b128 v[152:155], v113 offset:45056
    ds_read_b128 v[156:159], v113 offset:46080
    ds_read_b128 v[160:163], v113 offset:47104
    ds_read_b128 v[164:167], v113 offset:48128
    ds_read_b128 v[168:171], v113 offset:49152
    ds_read_b128 v[172:175], v113 offset:50176
    s_waitcnt vmcnt(7)
    s_waitcnt lgkmcnt(9)
    v_mfma_f32_16x16x32_bf16 v[116:119], v[136:139], v[40:43], v[116:119]
    s_lshl_b32 s42, s54, 12
    s_add_u32 s42, s42, s47
    buffer_load_dwordx4 v[72:75], v7, s[12:15], s42 offen offset:0 sc1
    s_waitcnt lgkmcnt(8)
    v_mfma_f32_16x16x32_bf16 v[120:123], v[140:143], v[40:43], v[120:123]
    s_waitcnt lgkmcnt(7)
    v_mfma_f32_16x16x32_bf16 v[124:127], v[144:147], v[40:43], v[124:127]
    s_lshl_b32 s42, s54, 12
    s_add_u32 s42, s42, s47
    buffer_load_dwordx4 v[76:79], v7, s[12:15], s42 offen offset:1024 sc1
    s_waitcnt lgkmcnt(6)
    v_mfma_f32_16x16x32_bf16 v[128:131], v[148:151], v[40:43], v[128:131]
    s_waitcnt lgkmcnt(5)
    v_mfma_f32_16x16x32_bf16 v[132:135], v[152:155], v[40:43], v[132:135]
    s_lshl_b32 s42, s54, 12
    s_add_u32 s42, s42, s47
    buffer_load_dwordx4 v[80:83], v7, s[12:15], s42 offen offset:2048 sc1
    ds_read_b128 v[136:139], v113 offset:51200
    ds_read_b128 v[140:143], v113 offset:52224
    ds_read_b128 v[144:147], v113 offset:53248
    ds_read_b128 v[148:151], v113 offset:54272
    ds_read_b128 v[152:155], v113 offset:55296
    s_waitcnt vmcnt(9)
    s_waitcnt lgkmcnt(9)
    v_mfma_f32_16x16x32_bf16 v[116:119], v[156:159], v[44:47], v[116:119]
    s_lshl_b32 s42, s54, 12
    s_add_u32 s42, s42, s47
    buffer_load_dwordx4 v[84:87], v7, s[12:15], s42 offen offset:3072 sc1
    s_waitcnt lgkmcnt(8)
    v_mfma_f32_16x16x32_bf16 v[120:123], v[160:163], v[44:47], v[120:123]
    s_waitcnt lgkmcnt(7)
    v_mfma_f32_16x16x32_bf16 v[124:127], v[164:167], v[44:47], v[124:127]
    s_waitcnt lgkmcnt(6)
    v_mfma_f32_16x16x32_bf16 v[128:131], v[168:171], v[44:47], v[128:131]
    s_waitcnt lgkmcnt(5)
    v_mfma_f32_16x16x32_bf16 v[132:135], v[172:175], v[44:47], v[132:135]
    ds_read_b128 v[156:159], v113 offset:56320
    ds_read_b128 v[160:163], v113 offset:57344
    ds_read_b128 v[164:167], v113 offset:58368
    ds_read_b128 v[168:171], v113 offset:59392
    ds_read_b128 v[172:175], v113 offset:60416
    s_waitcnt vmcnt(9)
    s_waitcnt lgkmcnt(9)
    v_mfma_f32_16x16x32_bf16 v[116:119], v[136:139], v[48:51], v[116:119]
    s_waitcnt lgkmcnt(8)
    v_mfma_f32_16x16x32_bf16 v[120:123], v[140:143], v[48:51], v[120:123]
    s_waitcnt lgkmcnt(7)
    v_mfma_f32_16x16x32_bf16 v[124:127], v[144:147], v[48:51], v[124:127]
    s_waitcnt lgkmcnt(6)
    v_mfma_f32_16x16x32_bf16 v[128:131], v[148:151], v[48:51], v[128:131]
    s_waitcnt lgkmcnt(5)
    v_mfma_f32_16x16x32_bf16 v[132:135], v[152:155], v[48:51], v[132:135]
    s_waitcnt vmcnt(8)
    s_waitcnt lgkmcnt(4)
    v_mfma_f32_16x16x32_bf16 v[116:119], v[156:159], v[52:55], v[116:119]
    s_waitcnt lgkmcnt(3)
    v_mfma_f32_16x16x32_bf16 v[120:123], v[160:163], v[52:55], v[120:123]
    s_waitcnt lgkmcnt(2)
    v_mfma_f32_16x16x32_bf16 v[124:127], v[164:167], v[52:55], v[124:127]
    s_waitcnt lgkmcnt(1)
    v_mfma_f32_16x16x32_bf16 v[128:131], v[168:171], v[52:55], v[128:131]
    s_waitcnt lgkmcnt(0)
    v_mfma_f32_16x16x32_bf16 v[132:135], v[172:175], v[52:55], v[132:135]
    s_waitcnt vmcnt(30)
    s_barrier
    ds_read_b128 v[136:139], v114 offset:0
    ds_read_b128 v[140:143], v114 offset:1024
    ds_read_b128 v[144:147], v114 offset:2048
    ds_read_b128 v[148:151], v114 offset:3072
    ds_read_b128 v[152:155], v114 offset:4096
    ds_read_b128 v[156:159], v114 offset:5120
    ds_read_b128 v[160:163], v114 offset:6144
    ds_read_b128 v[164:167], v114 offset:7168
    ds_read_b128 v[168:171], v114 offset:8192
    ds_read_b128 v[172:175], v114 offset:9216
    s_waitcnt vmcnt(7)
    s_waitcnt lgkmcnt(9)
    v_mfma_f32_16x16x32_bf16 v[116:119], v[136:139], v[56:59], v[116:119]
    s_lshl_b32 s42, s55, 12
    s_add_u32 s42, s42, s47
    buffer_load_dwordx4 v[88:91], v7, s[12:15], s42 offen offset:0 sc1
    s_waitcnt lgkmcnt(8)
    v_mfma_f32_16x16x32_bf16 v[120:123], v[140:143], v[56:59], v[120:123]
    s_waitcnt lgkmcnt(7)
    v_mfma_f32_16x16x32_bf16 v[124:127], v[144:147], v[56:59], v[124:127]
    s_lshl_b32 s42, s55, 12
    s_add_u32 s42, s42, s47
    buffer_load_dwordx4 v[92:95], v7, s[12:15], s42 offen offset:1024 sc1
    s_waitcnt lgkmcnt(6)
    v_mfma_f32_16x16x32_bf16 v[128:131], v[148:151], v[56:59], v[128:131]
    s_waitcnt lgkmcnt(5)
    v_mfma_f32_16x16x32_bf16 v[132:135], v[152:155], v[56:59], v[132:135]
    s_lshl_b32 s42, s55, 12
    s_add_u32 s42, s42, s47
    buffer_load_dwordx4 v[96:99], v7, s[12:15], s42 offen offset:2048 sc1
    ds_read_b128 v[136:139], v114 offset:10240
    ds_read_b128 v[140:143], v114 offset:11264
    ds_read_b128 v[144:147], v114 offset:12288
    ds_read_b128 v[148:151], v114 offset:13312
    ds_read_b128 v[152:155], v114 offset:14336
    s_waitcnt vmcnt(9)
    s_waitcnt lgkmcnt(9)
    v_mfma_f32_16x16x32_bf16 v[116:119], v[156:159], v[60:63], v[116:119]
    s_lshl_b32 s42, s55, 12
    s_add_u32 s42, s42, s47
    buffer_load_dwordx4 v[100:103], v7, s[12:15], s42 offen offset:3072 sc1
    s_waitcnt lgkmcnt(8)
    v_mfma_f32_16x16x32_bf16 v[120:123], v[160:163], v[60:63], v[120:123]
    s_waitcnt lgkmcnt(7)
    v_mfma_f32_16x16x32_bf16 v[124:127], v[164:167], v[60:63], v[124:127]
    s_cmp_ge_u32 s34, 2
    s_cbranch_scc1 k3_y_26
    s_mul_i32 s40, s34, 40960
    s_add_u32 s40, s40, s45
    s_mul_i32 s41, s34, 5120
    s_add_u32 m0, s41, 122880
    s_nop 0
    buffer_load_dwordx4 v104, s[8:11], s40 offen lds
    s_add_u32 m0, s41, 123904
    s_nop 0
    buffer_load_dwordx4 v105, s[8:11], s40 offen lds
    s_add_u32 m0, s41, 124928
    s_nop 0
    buffer_load_dwordx4 v106, s[8:11], s40 offen lds
    s_add_u32 m0, s41, 125952
    s_nop 0
    buffer_load_dwordx4 v107, s[8:11], s40 offen lds
    s_add_u32 m0, s41, 126976
    s_nop 0
    buffer_load_dwordx4 v108, s[8:11], s40 offen lds
    s_branch k3_xy_27
k3_y_26:
    v_lshrrev_b32 v4, 3, v1
    v_lshlrev_b32 v4, 12, v4
    v_and_b32 v5, 7, v1
    v_lshl_add_u32 v112, v5, 4, v4
    s_sub_u32 s42, s34, 2
    s_mul_i32 s40, s42, 40
    s_mul_i32 s41, s33, 80
    s_add_u32 s40, s40, s41
    s_lshl_b32 s40, s40, 12
    s_lshl_b32 s41, s32, 7
    s_add_u32 s40, s40, s41
    s_add_u32 s40, s40, 8912896
    s_mul_i32 s41, s42, 5120
    s_add_u32 m0, s41, 133120
    s_nop 0
    buffer_load_dwordx4 v112, s[12:15], s40 offen sc1 lds
    s_add_u32 s40, s40, 32768
    s_add_u32 m0, s41, 134144
    s_nop 0
    buffer_load_dwordx4 v112, s[12:15], s40 offen sc1 lds
    s_add_u32 s40, s40, 32768
    s_add_u32 m0, s41, 135168
    s_nop 0
    buffer_load_dwordx4 v112, s[12:15], s40 offen sc1 lds
    s_add_u32 s40, s40, 32768
    s_add_u32 m0, s41, 136192
    s_nop 0
    buffer_load_dwordx4 v112, s[12:15], s40 offen sc1 lds
    s_add_u32 s40, s40, 32768
    s_add_u32 m0, s41, 137216
    s_nop 0
    buffer_load_dwordx4 v112, s[12:15], s40 offen sc1 lds
    s_add_u32 s40, s40, 32768
k3_xy_27:
    s_lshl_b32 s40, s32, 9
    s_lshl_b32 s41, s34, 7
    s_add_u32 s40, s40, s41
    s_add_u32 s40, s40, 14680064
    v_lshlrev_b32 v4, 3, v3
    buffer_load_dwordx2 v[110:111], v4, s[12:15], s40 offen sc1
    s_waitcnt lgkmcnt(6)
    v_mfma_f32_16x16x32_bf16 v[128:131], v[168:171], v[60:63], v[128:131]
    s_waitcnt lgkmcnt(5)
    v_mfma_f32_16x16x32_bf16 v[132:135], v[172:175], v[60:63], v[132:135]
    ds_read_b128 v[156:159], v114 offset:15360
    ds_read_b128 v[160:163], v114 offset:16384
    ds_read_b128 v[164:167], v114 offset:17408
    ds_read_b128 v[168:171], v114 offset:18432
    ds_read_b128 v[172:175], v114 offset:19456
    s_waitcnt vmcnt(15)
    s_waitcnt lgkmcnt(9)
    v_mfma_f32_16x16x32_bf16 v[116:119], v[136:139], v[64:67], v[116:119]
    s_waitcnt lgkmcnt(8)
    v_mfma_f32_16x16x32_bf16 v[120:123], v[140:143], v[64:67], v[120:123]
    s_waitcnt lgkmcnt(7)
    v_mfma_f32_16x16x32_bf16 v[124:127], v[144:147], v[64:67], v[124:127]
    s_waitcnt lgkmcnt(6)
    v_mfma_f32_16x16x32_bf16 v[128:131], v[148:151], v[64:67], v[128:131]
    s_waitcnt lgkmcnt(5)
    v_mfma_f32_16x16x32_bf16 v[132:135], v[152:155], v[64:67], v[132:135]
    s_waitcnt vmcnt(14)
    s_waitcnt lgkmcnt(4)
    v_mfma_f32_16x16x32_bf16 v[116:119], v[156:159], v[68:71], v[116:119]
    s_waitcnt lgkmcnt(3)
    v_mfma_f32_16x16x32_bf16 v[120:123], v[160:163], v[68:71], v[120:123]
    s_waitcnt lgkmcnt(2)
    v_mfma_f32_16x16x32_bf16 v[124:127], v[164:167], v[68:71], v[124:127]
    s_waitcnt lgkmcnt(1)
    v_mfma_f32_16x16x32_bf16 v[128:131], v[168:171], v[68:71], v[128:131]
    s_waitcnt lgkmcnt(0)
    v_mfma_f32_16x16x32_bf16 v[132:135], v[172:175], v[68:71], v[132:135]
    s_waitcnt vmcnt(35)
    s_barrier
    ds_read_b128 v[136:139], v114 offset:20480
    ds_read_b128 v[140:143], v114 offset:21504
    ds_read_b128 v[144:147], v114 offset:22528
    ds_read_b128 v[148:151], v114 offset:23552
    ds_read_b128 v[152:155], v114 offset:24576
    ds_read_b128 v[156:159], v114 offset:25600
    ds_read_b128 v[160:163], v114 offset:26624
    ds_read_b128 v[164:167], v114 offset:27648
    ds_read_b128 v[168:171], v114 offset:28672
    ds_read_b128 v[172:175], v114 offset:29696
    s_waitcnt vmcnt(13)
    s_waitcnt lgkmcnt(9)
    v_mfma_f32_16x16x32_bf16 v[116:119], v[136:139], v[72:75], v[116:119]
    s_waitcnt lgkmcnt(8)
    v_mfma_f32_16x16x32_bf16 v[120:123], v[140:143], v[72:75], v[120:123]
    s_waitcnt lgkmcnt(7)
    v_mfma_f32_16x16x32_bf16 v[124:127], v[144:147], v[72:75], v[124:127]
    s_waitcnt lgkmcnt(6)
    v_mfma_f32_16x16x32_bf16 v[128:131], v[148:151], v[72:75], v[128:131]
    s_waitcnt lgkmcnt(5)
    v_mfma_f32_16x16x32_bf16 v[132:135], v[152:155], v[72:75], v[132:135]
    ds_read_b128 v[136:139], v114 offset:30720
    ds_read_b128 v[140:143], v114 offset:31744
    ds_read_b128 v[144:147], v114 offset:32768
    ds_read_b128 v[148:151], v114 offset:33792
    ds_read_b128 v[152:155], v114 offset:34816
    s_waitcnt vmcnt(12)
    s_waitcnt lgkmcnt(9)
    v_mfma_f32_16x16x32_bf16 v[116:119], v[156:159], v[76:79], v[116:119]
    s_waitcnt lgkmcnt(8)
    v_mfma_f32_16x16x32_bf16 v[120:123], v[160:163], v[76:79], v[120:123]
    s_waitcnt lgkmcnt(7)
    v_mfma_f32_16x16x32_bf16 v[124:127], v[164:167], v[76:79], v[124:127]
    s_waitcnt lgkmcnt(6)
    v_mfma_f32_16x16x32_bf16 v[128:131], v[168:171], v[76:79], v[128:131]
    s_waitcnt lgkmcnt(5)
    v_mfma_f32_16x16x32_bf16 v[132:135], v[172:175], v[76:79], v[132:135]
    ds_read_b128 v[156:159], v114 offset:35840
    ds_read_b128 v[160:163], v114 offset:36864
    ds_read_b128 v[164:167], v114 offset:37888
    ds_read_b128 v[168:171], v114 offset:38912
    ds_read_b128 v[172:175], v114 offset:39936
    s_waitcnt vmcnt(11)
    s_waitcnt lgkmcnt(9)
    v_mfma_f32_16x16x32_bf16 v[116:119], v[136:139], v[80:83], v[116:119]
    s_waitcnt lgkmcnt(8)
    v_mfma_f32_16x16x32_bf16 v[120:123], v[140:143], v[80:83], v[120:123]
    s_waitcnt lgkmcnt(7)
    v_mfma_f32_16x16x32_bf16 v[124:127], v[144:147], v[80:83], v[124:127]
    s_waitcnt lgkmcnt(6)
    v_mfma_f32_16x16x32_bf16 v[128:131], v[148:151], v[80:83], v[128:131]
    s_waitcnt lgkmcnt(5)
    v_mfma_f32_16x16x32_bf16 v[132:135], v[152:155], v[80:83], v[132:135]
    s_waitcnt vmcnt(10)
    s_waitcnt lgkmcnt(4)
    v_mfma_f32_16x16x32_bf16 v[116:119], v[156:159], v[84:87], v[116:119]
    s_waitcnt lgkmcnt(3)
    v_mfma_f32_16x16x32_bf16 v[120:123], v[160:163], v[84:87], v[120:123]
    s_waitcnt lgkmcnt(2)
    v_mfma_f32_16x16x32_bf16 v[124:127], v[164:167], v[84:87], v[124:127]
    s_waitcnt lgkmcnt(1)
    v_mfma_f32_16x16x32_bf16 v[128:131], v[168:171], v[84:87], v[128:131]
    s_waitcnt lgkmcnt(0)
    v_mfma_f32_16x16x32_bf16 v[132:135], v[172:175], v[84:87], v[132:135]
    s_waitcnt vmcnt(30)
    s_barrier
    ds_read_b128 v[136:139], v114 offset:40960
    ds_read_b128 v[140:143], v114 offset:41984
    ds_read_b128 v[144:147], v114 offset:43008
    ds_read_b128 v[148:151], v114 offset:44032
    ds_read_b128 v[152:155], v114 offset:45056
    ds_read_b128 v[156:159], v114 offset:46080
    ds_read_b128 v[160:163], v114 offset:47104
    ds_read_b128 v[164:167], v114 offset:48128
    ds_read_b128 v[168:171], v114 offset:49152
    ds_read_b128 v[172:175], v114 offset:50176
    s_waitcnt vmcnt(9)
    s_waitcnt lgkmcnt(9)
    v_mfma_f32_16x16x32_bf16 v[116:119], v[136:139], v[88:91], v[116:119]
    s_waitcnt lgkmcnt(8)
    v_mfma_f32_16x16x32_bf16 v[120:123], v[140:143], v[88:91], v[120:123]
    s_waitcnt lgkmcnt(7)
    v_mfma_f32_16x16x32_bf16 v[124:127], v[144:147], v[88:91], v[124:127]
    s_waitcnt lgkmcnt(6)
    v_mfma_f32_16x16x32_bf16 v[128:131], v[148:151], v[88:91], v[128:131]
    s_waitcnt lgkmcnt(5)
    v_mfma_f32_16x16x32_bf16 v[132:135], v[152:155], v[88:91], v[132:135]
    ds_read_b128 v[136:139], v114 offset:51200
    ds_read_b128 v[140:143], v114 offset:52224
    ds_read_b128 v[144:147], v114 offset:53248
    ds_read_b128 v[148:151], v114 offset:54272
    ds_read_b128 v[152:155], v114 offset:55296
    s_waitcnt vmcnt(8)
    s_waitcnt lgkmcnt(9)
    v_mfma_f32_16x16x32_bf16 v[116:119], v[156:159], v[92:95], v[116:119]
    s_waitcnt lgkmcnt(8)
    v_mfma_f32_16x16x32_bf16 v[120:123], v[160:163], v[92:95], v[120:123]
    s_waitcnt lgkmcnt(7)
    v_mfma_f32_16x16x32_bf16 v[124:127], v[164:167], v[92:95], v[124:127]
    s_waitcnt lgkmcnt(6)
    v_mfma_f32_16x16x32_bf16 v[128:131], v[168:171], v[92:95], v[128:131]
    s_waitcnt lgkmcnt(5)
    v_mfma_f32_16x16x32_bf16 v[132:135], v[172:175], v[92:95], v[132:135]
    ds_read_b128 v[156:159], v114 offset:56320
    ds_read_b128 v[160:163], v114 offset:57344
    ds_read_b128 v[164:167], v114 offset:58368
    ds_read_b128 v[168:171], v114 offset:59392
    ds_read_b128 v[172:175], v114 offset:60416
    s_waitcnt vmcnt(7)
    s_waitcnt lgkmcnt(9)
    v_mfma_f32_16x16x32_bf16 v[116:119], v[136:139], v[96:99], v[116:119]
    s_waitcnt lgkmcnt(8)
    v_mfma_f32_16x16x32_bf16 v[120:123], v[140:143], v[96:99], v[120:123]
    s_waitcnt lgkmcnt(7)
    v_mfma_f32_16x16x32_bf16 v[124:127], v[144:147], v[96:99], v[124:127]
    s_waitcnt lgkmcnt(6)
    v_mfma_f32_16x16x32_bf16 v[128:131], v[148:151], v[96:99], v[128:131]
    s_waitcnt lgkmcnt(5)
    v_mfma_f32_16x16x32_bf16 v[132:135], v[152:155], v[96:99], v[132:135]
    s_waitcnt vmcnt(6)
    s_waitcnt lgkmcnt(4)
    v_mfma_f32_16x16x32_bf16 v[116:119], v[156:159], v[100:103], v[116:119]
    s_waitcnt lgkmcnt(3)
    v_mfma_f32_16x16x32_bf16 v[120:123], v[160:163], v[100:103], v[120:123]
    s_waitcnt lgkmcnt(2)
    v_mfma_f32_16x16x32_bf16 v[124:127], v[164:167], v[100:103], v[124:127]
    s_waitcnt lgkmcnt(1)
    v_mfma_f32_16x16x32_bf16 v[128:131], v[168:171], v[100:103], v[128:131]
    s_waitcnt lgkmcnt(0)
    v_mfma_f32_16x16x32_bf16 v[132:135], v[172:175], v[100:103], v[132:135]
    s_lshl_b32 s40, s34, 4
    v_add_u32 v4, s40, v3
    v_mul_u32_u24 v4, 160, v4
    v_lshl_add_u32 v176, v2, 3, v4
    v_add_u32 v177, 122880, v176
    v_lshrrev_b32 v5, 2, v3
    v_lshl_add_u32 v4, v2, 2, v5
    v_lshlrev_b32 v4, 7, v4
    v_and_b32 v5, 3, v3
    v_lshl_add_u32 v4, v5, 3, v4
    s_lshl_b32 s40, s34, 5
    s_add_u32 s40, s40, 133120
    v_add_u32 v178, s40, v4
    s_mov_b32 s46, 0xbfb8aa3b
    s_mov_b32 s47, 0xbfb8aa3b
    v_pk_mul_f32 v[8:9], v[116:117], s[46:47]
    v_pk_mul_f32 v[10:11], v[118:119], s[46:47]
    v_pk_mul_f32 v[12:13], v[120:121], s[46:47]
    v_pk_mul_f32 v[14:15], v[122:123], s[46:47]
    v_pk_mul_f32 v[16:17], v[124:125], s[46:47]
    v_pk_mul_f32 v[18:19], v[126:127], s[46:47]
    v_pk_mul_f32 v[20:21], v[128:129], s[46:47]
    v_pk_mul_f32 v[22:23], v[130:131], s[46:47]
    v_pk_mul_f32 v[24:25], v[132:133], s[46:47]
    v_pk_mul_f32 v[26:27], v[134:135], s[46:47]
    s_waitcnt vmcnt(0)
    s_barrier
    ds_read_b64 v[136:137], v177 offset:0
    ds_read_b64 v[138:139], v177 offset:32
    ds_read_b64 v[140:141], v177 offset:64
    ds_read_b64 v[142:143], v177 offset:96
    ds_read_b64 v[144:145], v177 offset:128
    ds_read_b64_tr_b16 v[146:147], v178 offset:0
    ds_read_b64_tr_b16 v[148:149], v178 offset:2048
    ds_read_b64_tr_b16 v[150:151], v178 offset:4096
    ds_read_b64_tr_b16 v[152:153], v178 offset:6144
    ds_read_b64_tr_b16 v[154:155], v178 offset:8192
    v_exp_f32 v8, v8
    v_exp_f32 v9, v9
    v_exp_f32 v10, v10
    v_exp_f32 v11, v11
    v_exp_f32 v12, v12
    v_exp_f32 v13, v13
    v_exp_f32 v14, v14
    v_exp_f32 v15, v15
    v_exp_f32 v16, v16
    v_exp_f32 v17, v17
    v_exp_f32 v18, v18
    v_exp_f32 v19, v19
    v_exp_f32 v20, v20
    v_exp_f32 v21, v21
    v_exp_f32 v22, v22
    v_exp_f32 v23, v23
    v_exp_f32 v24, v24
    v_exp_f32 v25, v25
    v_exp_f32 v26, v26
    v_exp_f32 v27, v27
    v_pk_add_f32 v[8:9], v[8:9], 1.0 op_sel_hi:[1,0]
    v_pk_add_f32 v[10:11], v[10:11], 1.0 op_sel_hi:[1,0]
    v_pk_add_f32 v[12:13], v[12:13], 1.0 op_sel_hi:[1,0]
    v_pk_add_f32 v[14:15], v[14:15], 1.0 op_sel_hi:[1,0]
    v_pk_add_f32 v[16:17], v[16:17], 1.0 op_sel_hi:[1,0]
    v_pk_add_f32 v[18:19], v[18:19], 1.0 op_sel_hi:[1,0]
    v_pk_add_f32 v[20:21], v[20:21], 1.0 op_sel_hi:[1,0]
    v_pk_add_f32 v[22:23], v[22:23], 1.0 op_sel_hi:[1,0]
    v_pk_add_f32 v[24:25], v[24:25], 1.0 op_sel_hi:[1,0]
    v_pk_add_f32 v[26:27], v[26:27], 1.0 op_sel_hi:[1,0]
    v_rcp_f32 v8, v8
    v_rcp_f32 v9, v9
    v_rcp_f32 v10, v10
    v_rcp_f32 v11, v11
    v_rcp_f32 v12, v12
    v_rcp_f32 v13, v13
    v_rcp_f32 v14, v14
    v_rcp_f32 v15, v15
    v_rcp_f32 v16, v16
    v_rcp_f32 v17, v17
    v_rcp_f32 v18, v18
    v_rcp_f32 v19, v19
    v_rcp_f32 v20, v20
    v_rcp_f32 v21, v21
    v_rcp_f32 v22, v22
    v_rcp_f32 v23, v23
    v_rcp_f32 v24, v24
    v_rcp_f32 v25, v25
    v_rcp_f32 v26, v26
    v_rcp_f32 v27, v27
    v_pk_mul_f32 v[8:9], v[8:9], v[116:117]
    v_pk_mul_f32 v[10:11], v[10:11], v[118:119]
    v_pk_mul_f32 v[12:13], v[12:13], v[120:121]
    v_pk_mul_f32 v[14:15], v[14:15], v[122:123]
    v_pk_mul_f32 v[16:17], v[16:17], v[124:125]
    v_pk_mul_f32 v[18:19], v[18:19], v[126:127]
    v_pk_mul_f32 v[20:21], v[20:21], v[128:129]
    v_pk_mul_f32 v[22:23], v[22:23], v[130:131]
    v_pk_mul_f32 v[24:25], v[24:25], v[132:133]
    v_pk_mul_f32 v[26:27], v[26:27], v[134:135]
    s_waitcnt lgkmcnt(0)
    v_lshlrev_b32 v28, 16, v136
    v_and_b32 v29, 0xffff0000, v136
    v_lshlrev_b32 v48, 16, v146
    v_and_b32 v49, 0xffff0000, v146
    v_lshlrev_b32 v30, 16, v137
    v_and_b32 v31, 0xffff0000, v137
    v_lshlrev_b32 v50, 16, v147
    v_and_b32 v51, 0xffff0000, v147
    v_lshlrev_b32 v32, 16, v138
    v_and_b32 v33, 0xffff0000, v138
    v_lshlrev_b32 v52, 16, v148
    v_and_b32 v53, 0xffff0000, v148
    v_lshlrev_b32 v34, 16, v139
    v_and_b32 v35, 0xffff0000, v139
    v_lshlrev_b32 v54, 16, v149
    v_and_b32 v55, 0xffff0000, v149
    v_lshlrev_b32 v36, 16, v140
    v_and_b32 v37, 0xffff0000, v140
    v_lshlrev_b32 v56, 16, v150
    v_and_b32 v57, 0xffff0000, v150
    v_lshlrev_b32 v38, 16, v141
    v_and_b32 v39, 0xffff0000, v141
    v_lshlrev_b32 v58, 16, v151
    v_and_b32 v59, 0xffff0000, v151
    v_lshlrev_b32 v40, 16, v142
    v_and_b32 v41, 0xffff0000, v142
    v_lshlrev_b32 v60, 16, v152
    v_and_b32 v61, 0xffff0000, v152
    v_lshlrev_b32 v42, 16, v143
    v_and_b32 v43, 0xffff0000, v143
    v_lshlrev_b32 v62, 16, v153
    v_and_b32 v63, 0xffff0000, v153
    v_lshlrev_b32 v44, 16, v144
    v_and_b32 v45, 0xffff0000, v144
    v_lshlrev_b32 v64, 16, v154
    v_and_b32 v65, 0xffff0000, v154
    v_lshlrev_b32 v46, 16, v145
    v_and_b32 v47, 0xffff0000, v145
    v_lshlrev_b32 v66, 16, v155
    v_and_b32 v67, 0xffff0000, v155
    v_mov_b32 v180, v111
    v_pk_add_f32 v[68:69], v[28:29], v[110:111] op_sel_hi:[1,0] neg_lo:[0,1] neg_hi:[0,1]
    v_pk_add_f32 v[70:71], v[30:31], v[110:111] op_sel_hi:[1,0] neg_lo:[0,1] neg_hi:[0,1]
    v_pk_add_f32 v[72:73], v[32:33], v[110:111] op_sel_hi:[1,0] neg_lo:[0,1] neg_hi:[0,1]
    v_pk_add_f32 v[74:75], v[34:35], v[110:111] op_sel_hi:[1,0] neg_lo:[0,1] neg_hi:[0,1]
    v_pk_add_f32 v[76:77], v[36:37], v[110:111] op_sel_hi:[1,0] neg_lo:[0,1] neg_hi:[0,1]
    v_pk_add_f32 v[78:79], v[38:39], v[110:111] op_sel_hi:[1,0] neg_lo:[0,1] neg_hi:[0,1]
    v_pk_add_f32 v[80:81], v[40:41], v[110:111] op_sel_hi:[1,0] neg_lo:[0,1] neg_hi:[0,1]
    v_pk_add_f32 v[82:83], v[42:43], v[110:111] op_sel_hi:[1,0] neg_lo:[0,1] neg_hi:[0,1]
    v_pk_add_f32 v[84:85], v[44:45], v[110:111] op_sel_hi:[1,0] neg_lo:[0,1] neg_hi:[0,1]
    v_pk_add_f32 v[86:87], v[46:47], v[110:111] op_sel_hi:[1,0] neg_lo:[0,1] neg_hi:[0,1]
    v_pk_mul_f32 v[68:69], v[68:69], v[180:181] op_sel_hi:[1,0]
    v_pk_mul_f32 v[70:71], v[70:71], v[180:181] op_sel_hi:[1,0]
    v_pk_mul_f32 v[72:73], v[72:73], v[180:181] op_sel_hi:[1,0]
    v_pk_mul_f32 v[74:75], v[74:75], v[180:181] op_sel_hi:[1,0]
    v_pk_mul_f32 v[76:77], v[76:77], v[180:181] op_sel_hi:[1,0]
    v_pk_mul_f32 v[78:79], v[78:79], v[180:181] op_sel_hi:[1,0]
    v_pk_mul_f32 v[80:81], v[80:81], v[180:181] op_sel_hi:[1,0]
    v_pk_mul_f32 v[82:83], v[82:83], v[180:181] op_sel_hi:[1,0]
    v_pk_mul_f32 v[84:85], v[84:85], v[180:181] op_sel_hi:[1,0]
    v_pk_mul_f32 v[86:87], v[86:87], v[180:181] op_sel_hi:[1,0]
    v_pk_mul_f32 v[68:69], v[68:69], v[48:49]
    v_pk_mul_f32 v[70:71], v[70:71], v[50:51]
    v_pk_mul_f32 v[72:73], v[72:73], v[52:53]
    v_pk_mul_f32 v[74:75], v[74:75], v[54:55]
    v_pk_mul_f32 v[76:77], v[76:77], v[56:57]
    v_pk_mul_f32 v[78:79], v[78:79], v[58:59]
    v_pk_mul_f32 v[80:81], v[80:81], v[60:61]
    v_pk_mul_f32 v[82:83], v[82:83], v[62:63]
    v_pk_mul_f32 v[84:85], v[84:85], v[64:65]
    v_pk_mul_f32 v[86:87], v[86:87], v[66:67]
    v_pk_fma_f32 v[68:69], v[68:69], v[8:9], v[28:29]
    v_pk_fma_f32 v[70:71], v[70:71], v[10:11], v[30:31]
    v_pk_fma_f32 v[72:73], v[72:73], v[12:13], v[32:33]
    v_pk_fma_f32 v[74:75], v[74:75], v[14:15], v[34:35]
    v_pk_fma_f32 v[76:77], v[76:77], v[16:17], v[36:37]
    v_pk_fma_f32 v[78:79], v[78:79], v[18:19], v[38:39]
    v_pk_fma_f32 v[80:81], v[80:81], v[20:21], v[40:41]
    v_pk_fma_f32 v[82:83], v[82:83], v[22:23], v[42:43]
    v_pk_fma_f32 v[84:85], v[84:85], v[24:25], v[44:45]
    v_pk_fma_f32 v[86:87], v[86:87], v[26:27], v[46:47]
    v_cvt_pk_bf16_f32 v136, v68, v69
    v_cvt_pk_bf16_f32 v137, v70, v71
    v_cvt_pk_bf16_f32 v138, v72, v73
    v_cvt_pk_bf16_f32 v139, v74, v75
    v_cvt_pk_bf16_f32 v140, v76, v77
    v_cvt_pk_bf16_f32 v141, v78, v79
    v_cvt_pk_bf16_f32 v142, v80, v81
    v_cvt_pk_bf16_f32 v143, v82, v83
    v_cvt_pk_bf16_f32 v144, v84, v85
    v_cvt_pk_bf16_f32 v145, v86, v87
    v_add_u32 v182, 143360, v176
    ds_write_b64 v182, v[136:137] offset:0
    ds_write_b64 v182, v[138:139] offset:32
    ds_write_b64 v182, v[140:141] offset:64
    ds_write_b64 v182, v[142:143] offset:96
    ds_write_b64 v182, v[144:145] offset:128
    s_mul_i32 s40, s34, 2560
    s_add_u32 s40, s40, 143360
    v_add_u32 v4, s40, v7
    s_waitcnt lgkmcnt(0)
    ds_read_b128 v[8:11], v4 offset:0
    ds_read_b128 v[12:15], v4 offset:1024
    ds_read_b128 v[16:19], v4 offset:2048
    s_mul_i32 s40, s34, 20480
    s_add_u32 s40, s40, s45
    s_waitcnt lgkmcnt(0)
    buffer_store_dwordx4 v[8:11], v104, s[16:19], s40 offen
    buffer_store_dwordx4 v[12:15], v105, s[16:19], s40 offen
    s_mov_b32 exec_hi, 0
    buffer_store_dwordx4 v[16:19], v106, s[16:19], s40 offen
    s_mov_b64 exec, -1
    s_endpgm
recurrent_scan__ssm_conv_h3__mixer_gmlp__prompt_kernel_conv:
    s_load_dwordx2 s[4:5], s[0:1], 32
    s_load_dwordx2 s[8:9], s[0:1], 104
    s_load_dwordx2 s[12:13], s[0:1], 40
    s_load_dwordx2 s[16:17], s[0:1], 64
    s_load_dwordx2 s[20:21], s[0:1], 80
    v_subrev_u32 v0, 256, v0
    s_setprio 1
    v_lshrrev_b32 v3, 6, v0
    v_and_b32 v1, 63, v0
    v_readfirstlane_b32 s34, v3
    s_mov_b32 s6, 2621440
    s_mov_b32 s7, 0x20000
    s_mov_b32 s10, 15990784
    s_mov_b32 s11, 0x20000
    s_mov_b32 s14, 1280
    s_mov_b32 s15, 0x20000
    s_mov_b32 s18, 8388608
    s_mov_b32 s19, 0x20000
    s_mov_b32 s22, 983040
    s_mov_b32 s23, 0x20000
    s_mov_b32 s32, s2
    v_lshlrev_b32 v2, 4, v0
    v_subrev_u32 v47, 16, v2
    s_mov_b32 s56, s2
    s_add_u32 s57, s2, 256
    s_lshr_b32 s58, s2, 1
    s_add_u32 s58, s58, 512
    s_waitcnt lgkmcnt(0)
    s_lshl_b32 s40, s56, 12
    buffer_load_dwordx4 v[12:15], v2, s[4:7], s40 offen
    buffer_load_dwordx4 v[8:11], v47, s[4:7], s40 offen
    s_lshl_b32 s41, s56, 1
    v_mov_b32 v3, 0
    buffer_load_ushort v44, v3, s[12:15], s41 offen
    s_lshr_b32 s47, s2, 3
    s_lshl_b32 s47, s47, 2
    s_add_u32 s47, s47, s34
    s_mul_i32 s40, s47, 12
    v_add_u32 v3, s40, v1
    v_mul_u32_u24 v4, 43691, v3
    v_lshrrev_b32 v4, 22, v4
    v_mul_u32_u24 v5, 96, v4
    v_sub_u32 v3, v3, v5
    v_mul_u32_u24 v4, 98304, v4
    v_lshl_add_u32 v57, v3, 7, v4
    s_and_b32 s40, s2, 7
    s_lshr_b32 s52, s40, 1
    s_lshl_b32 s52, s52, 21
    s_and_b32 s53, s40, 1
    s_mul_i32 s53, s53, 1572864
    s_add_u32 s53, s53, 0
    s_lshl_b32 s40, s47, 4
    v_add_u32 v3, s40, v1
    v_lshrrev_b32 v4, 2, v3
    v_lshlrev_b32 v4, 12, v4
    v_and_b32 v3, 3, v3
    v_lshl_add_u32 v56, v3, 10, v4
    s_cmp_ge_u32 s2, 192
    s_cbranch_scc1 c_wj_28
    s_mul_i32 s40, s2, 2731
    s_lshr_b32 s40, s40, 16
    s_mul_i32 s41, s40, 24
    s_sub_u32 s41, s2, s41
    s_mul_i32 s41, s41, 40960
    s_mul_i32 s40, s40, 160
    s_add_u32 s54, s40, s41
    v_mov_b32 v3, v0
    v_mul_u32_u24 v4, 6554, v3
    v_lshrrev_b32 v4, 16, v4
    v_mul_u32_u24 v5, 10, v4
    v_sub_u32 v3, v3, v5
    v_lshlrev_b32 v3, 4, v3
    v_mul_u32_u24 v4, 1280, v4
    v_add_u32 v3, v3, v4
    s_lshl_b32 s40, s34, 10
    s_add_u32 m0, s40, 156672
    s_nop 0
    buffer_load_dwordx4 v3, s[20:23], s54 offen lds
    s_cmp_lg_u32 s34, 0
    s_cbranch_scc1 c_wj2_29
    v_add_u32 v3, 256, v1
    v_mul_u32_u24 v4, 6554, v3
    v_lshrrev_b32 v4, 16, v4
    v_mul_u32_u24 v5, 10, v4
    v_sub_u32 v3, v3, v5
    v_lshlrev_b32 v3, 4, v3
    v_mul_u32_u24 v4, 1280, v4
    v_add_u32 v3, v3, v4
    s_mov_b32 m0, 160768
    s_nop 0
    buffer_load_dwordx4 v3, s[20:23], s54 offen lds
c_wj2_29:
c_wj_28:
    s_lshl_b32 s40, s57, 12
    buffer_load_dwordx4 v[20:23], v2, s[4:7], s40 offen
    buffer_load_dwordx4 v[16:19], v47, s[4:7], s40 offen
    s_lshl_b32 s41, s57, 1
    v_mov_b32 v3, 0
    buffer_load_ushort v45, v3, s[12:15], s41 offen
    s_lshl_b32 s40, s58, 12
    buffer_load_dwordx4 v[28:31], v2, s[4:7], s40 offen
    buffer_load_dwordx4 v[24:27], v47, s[4:7], s40 offen
    s_lshl_b32 s41, s58, 1
    v_mov_b32 v3, 0
    buffer_load_ushort v46, v3, s[12:15], s41 offen
    v_mov_b32 v60, 0
    v_mov_b32 v61, 0
    v_mov_b32 v62, 0
    v_mov_b32 v63, 0
    v_mul_u32_u24 v3, 4160, v0
    v_add_u32 v3, 86016, v3
    v_cmp_gt_u32 vcc, 64, v0
    s_nop 0
    s_and_saveexec_b64 s[50:51], vcc
    s_cbranch_execz c_z_30
    v_subrev_u32 v4, -118784, v2
    v_cmp_gt_u32 vcc, 8, v0
    s_nop 1
    v_cndmask_b32 v4, v4, v3, vcc
    v_add_u32 v5, -8, v0
    v_cmp_lt_u32 vcc, 23, v5
    s_nop 0
    s_and_b64 exec, exec, vcc
    ds_write_b128 v4, v[60:63]
c_z_30:
    s_mov_b64 exec, s[50:51]
    v_add_u32 v64, 86032, v2
    v_add_u32 v65, 119808, v2
    v_and_b32 v3, 7, v1
    v_mul_u32_u24 v3, 4160, v3
    v_bfe_u32 v4, v1, 3, 1
    v_lshrrev_b32 v5, 4, v1
    v_sub_u32 v4, v4, v5
    v_add_u32 v4, 3, v4
    v_lshl_add_u32 v66, v4, 4, v3
    v_add_u32 v66, 86016, v66
    v_and_b32 v3, 15, v1
    v_lshl_add_u32 v3, v3, 1, v5
    v_lshlrev_b32 v67, 4, v3
    v_add_u32 v67, 119296, v67
    v_and_b32 v3, 15, v1
    v_lshlrev_b32 v4, 3, v5
    v_sub_u32 v4, v4, v3
    v_add_u32 v4, -9, v4
    v_mov_b32 v72, 0xffff
    v_mov_b32 v73, 0xffff0000
    v_cmp_eq_u32 vcc, 0, v4
    s_nop 1
    v_cndmask_b32 v68, 0, v72, vcc
    v_cmp_eq_u32 vcc, 1, v4
    s_nop 1
    v_cndmask_b32 v68, v68, v73, vcc
    v_cmp_eq_u32 vcc, 2, v4
    s_nop 1
    v_cndmask_b32 v69, 0, v72, vcc
    v_cmp_eq_u32 vcc, 3, v4
    s_nop 1
    v_cndmask_b32 v69, v69, v73, vcc
    v_cmp_eq_u32 vcc, 4, v4
    s_nop 1
    v_cndmask_b32 v70, 0, v72, vcc
    v_cmp_eq_u32 vcc, 5, v4
    s_nop 1
    v_cndmask_b32 v70, v70, v73, vcc
    v_cmp_eq_u32 vcc, 6, v4
    s_nop 1
    v_cndmask_b32 v71, 0, v72, vcc
    v_cmp_eq_u32 vcc, 7, v4
    s_nop 1
    v_cndmask_b32 v71, v71, v73, vcc
    v_and_b32 v3, 15, v1
    v_lshlrev_b32 v3, 6, v3
    v_lshl_add_u32 v3, v5, 4, v3
    s_lshl_b32 s40, s34, 13
    s_add_u32 s40, s40, 123904
    v_add_u32 v74, s40, v3
    v_lshlrev_b32 v75, 5, v0
    v_add_u32 v75, 123904, v75
    s_waitcnt vmcnt(6)
    v_cmp_ne_u32 vcc, 0, v0
    s_nop 1
    v_cndmask_b32 v8, 0, v8, vcc
    v_cndmask_b32 v9, 0, v9, vcc
    v_cndmask_b32 v10, 0, v10, vcc
    v_cndmask_b32 v11, 0, v11, vcc
    v_alignbit_b32 v184, v9, v8, 16
    v_alignbit_b32 v185, v10, v9, 16
    v_alignbit_b32 v186, v11, v10, 16
    v_alignbit_b32 v187, v12, v11, 16
    v_alignbit_b32 v188, v13, v12, 16
    v_alignbit_b32 v189, v14, v13, 16
    v_alignbit_b32 v190, v15, v14, 16
    ds_write_b128 v64, v[184:187] offset:0
    v_mov_b32 v192, v9
    v_mov_b32 v193, v10
    v_mov_b32 v194, v11
    v_mov_b32 v195, v12
    ds_write_b128 v64, v[192:195] offset:4160
    s_nop 1
    v_mov_b32 v192, v185
    v_mov_b32 v193, v186
    v_mov_b32 v194, v187
    v_mov_b32 v195, v188
    ds_write_b128 v64, v[192:195] offset:8320
    s_nop 1
    ds_write_b128 v64, v[10:13] offset:12480
    ds_write_b128 v64, v[186:189] offset:16640
    v_mov_b32 v192, v11
    v_mov_b32 v193, v12
    v_mov_b32 v194, v13
    v_mov_b32 v195, v14
    ds_write_b128 v64, v[192:195] offset:20800
    s_nop 1
    v_mov_b32 v192, v187
    v_mov_b32 v193, v188
    v_mov_b32 v194, v189
    v_mov_b32 v195, v190
    ds_write_b128 v64, v[192:195] offset:24960
    s_nop 1
    ds_write_b128 v64, v[12:15] offset:29120
    v_mbcnt_lo_u32_b32 v3, -1, 0
    v_mbcnt_hi_u32_b32 v3, -1, v3
    v_lshlrev_b32 v3, 4, v3
    s_mov_b32 s66, 14716928
    s_mov_b32 s67, 0
fpoll_31:
    buffer_load_dwordx4 v[48:51], v3, s[8:11], s66 offen sc1
    buffer_load_dwordx4 v[52:55], v3, s[8:11], s66 offen offset:1024 sc1
    s_add_u32 s67, s67, 1
    s_waitcnt vmcnt(0)
    v_cmp_ne_u32 vcc, s100, v48
    v_cmp_ne_u32 s[64:65], s101, v49
    s_nop 0
    s_or_b64 vcc, vcc, s[64:65]
    v_cmp_ne_u32 s[64:65], s100, v50
    s_nop 0
    s_or_b64 vcc, vcc, s[64:65]
    v_cmp_ne_u32 s[64:65], s101, v51
    s_nop 0
    s_or_b64 vcc, vcc, s[64:65]
    v_cmp_ne_u32 s[64:65], s100, v52
    s_nop 0
    s_or_b64 vcc, vcc, s[64:65]
    v_cmp_ne_u32 s[64:65], s101, v53
    s_nop 0
    s_or_b64 vcc, vcc, s[64:65]
    v_cmp_ne_u32 s[64:65], s100, v54
    s_nop 0
    s_or_b64 vcc, vcc, s[64:65]
    v_cmp_ne_u32 s[64:65], s101, v55
    s_nop 0
    s_or_b64 vcc, vcc, s[64:65]
    s_cmp_gt_u32 s67, 100000
    s_cbranch_scc1 fpoll_e_32
    s_cmp_eq_u64 vcc, 0
    s_cbranch_scc1 fpoll_e_32
    s_sleep 2
    s_branch fpoll_31
fpoll_e_32:
    s_lshl_b32 s40, s56, 12
    s_add_u32 s40, s40, 6291456
    buffer_load_dwordx4 v[32:35], v2, s[8:11], s40 offen sc1
    s_lshl_b32 s40, s57, 12
    s_add_u32 s40, s40, 6291456
    buffer_load_dwordx4 v[36:39], v2, s[8:11], s40 offen sc1
    s_lshl_b32 s40, s58, 12
    s_add_u32 s40, s40, 6291456
    buffer_load_dwordx4 v[40:43], v2, s[8:11], s40 offen sc1
    s_waitcnt vmcnt(2)
    ds_write_b128 v65, v[32:35]
    v_lshlrev_b32 v3, 16, v44
    v_or_b32 v3, v3, v44
    v_and_b32 v196, v68, v3
    v_and_b32 v197, v69, v3
    v_and_b32 v198, v70, v3
    v_and_b32 v199, v71, v3
    s_waitcnt lgkmcnt(0)
    v_mov_b32 v3, 161796
    v_mov_b32 v4, 1
    s_mov_b64 exec, 1
    ds_add_u32 v3, v4
    s_mov_b64 exec, -1
    s_mov_b32 s67, 0
gsync_33:
    ds_read_b32 v4, v3
    s_add_u32 s67, s67, 1
    s_waitcnt lgkmcnt(0)
    v_readfirstlane_b32 s66, v4
    s_cmp_gt_u32 s67, 1000000
    s_cbranch_scc1 gsync_e_34
    s_cmp_lt_u32 s66, 4
    s_cbranch_scc1 gsync_33
gsync_e_34:
    s_cmp_lg_u32 s34, 0
    s_cbranch_scc1 c_pw_36
    ds_read_b128 v[108:111], v66 offset:0
    ds_read_b128 v[120:123], v67 offset:480
    ds_read_b128 v[124:127], v67 offset:992
    ds_read_b128 v[128:131], v67 offset:1504
    ds_read_b128 v[132:135], v67 offset:2016
    ds_read_b128 v[136:139], v67 offset:2528
    ds_read_b128 v[140:143], v67 offset:3040
    ds_read_b128 v[144:147], v67 offset:3552
    ds_read_b128 v[148:151], v67 offset:4064
    ds_read_b128 v[112:115], v66 offset:512
    ds_read_b128 v[116:119], v66 offset:1024
    s_waitcnt lgkmcnt(2)
    v_mfma_f32_16x16x32_bf16 v[104:107], v[108:111], v[148:151], 0
    v_mfma_f32_16x16x32_bf16 v[100:103], v[108:111], v[144:147], 0
    v_mfma_f32_16x16x32_bf16 v[96:99], v[108:111], v[140:143], 0
    v_mfma_f32_16x16x32_bf16 v[92:95], v[108:111], v[136:139], 0
    v_mfma_f32_16x16x32_bf16 v[88:91], v[108:111], v[132:135], 0
    v_mfma_f32_16x16x32_bf16 v[84:87], v[108:111], v[128:131], 0
    v_mfma_f32_16x16x32_bf16 v[80:83], v[108:111], v[124:127], 0
    v_mfma_f32_16x16x32_bf16 v[76:79], v[108:111], v[120:123], 0
    v_mfma_f32_16x16x32_bf16 v[76:79], v[196:199], v[120:123], v[76:79]
    v_mfma_f32_16x16x32_bf16 v[80:83], v[196:199], v[124:127], v[80:83]
    v_mfma_f32_16x16x32_bf16 v[84:87], v[196:199], v[128:131], v[84:87]
    v_mfma_f32_16x16x32_bf16 v[88:91], v[196:199], v[132:135], v[88:91]
    v_mfma_f32_16x16x32_bf16 v[92:95], v[196:199], v[136:139], v[92:95]
    v_mfma_f32_16x16x32_bf16 v[96:99], v[196:199], v[140:143], v[96:99]
    v_mfma_f32_16x16x32_bf16 v[100:103], v[196:199], v[144:147], v[100:103]
    v_mfma_f32_16x16x32_bf16 v[104:107], v[196:199], v[148:151], v[104:107]
    ds_read_b128 v[108:111], v66 offset:1536
    s_waitcnt lgkmcnt(2)
    v_mfma_f32_16x16x32_bf16 v[104:107], v[112:115], v[144:147], v[104:107]
    v_mfma_f32_16x16x32_bf16 v[100:103], v[112:115], v[140:143], v[100:103]
    v_mfma_f32_16x16x32_bf16 v[96:99], v[112:115], v[136:139], v[96:99]
    v_mfma_f32_16x16x32_bf16 v[92:95], v[112:115], v[132:135], v[92:95]
    v_mfma_f32_16x16x32_bf16 v[88:91], v[112:115], v[128:131], v[88:91]
    v_mfma_f32_16x16x32_bf16 v[84:87], v[112:115], v[124:127], v[84:87]
    v_mfma_f32_16x16x32_bf16 v[80:83], v[112:115], v[120:123], v[80:83]
    ds_read_b128 v[112:115], v66 offset:2048
    ds_read_b128 v[152:155], v67 offset:416
    ds_read_b128 v[156:159], v67 offset:928
    ds_read_b128 v[160:163], v67 offset:1440
    ds_read_b128 v[164:167], v67 offset:1952
    ds_read_b128 v[168:171], v67 offset:2464
    ds_read_b128 v[172:175], v67 offset:2976
    ds_read_b128 v[176:179], v67 offset:3488
    ds_read_b128 v[180:183], v67 offset:4000
    s_waitcnt lgkmcnt(10)
    v_mfma_f32_16x16x32_bf16 v[104:107], v[116:119], v[140:143], v[104:107]
    v_mfma_f32_16x16x32_bf16 v[100:103], v[116:119], v[136:139], v[100:103]
    v_mfma_f32_16x16x32_bf16 v[96:99], v[116:119], v[132:135], v[96:99]
    v_mfma_f32_16x16x32_bf16 v[92:95], v[116:119], v[128:131], v[92:95]
    v_mfma_f32_16x16x32_bf16 v[88:91], v[116:119], v[124:127], v[88:91]
    v_mfma_f32_16x16x32_bf16 v[84:87], v[116:119], v[120:123], v[84:87]
    ds_read_b128 v[116:119], v66 offset:2560
    s_waitcnt lgkmcnt(10)
    v_mfma_f32_16x16x32_bf16 v[104:107], v[108:111], v[136:139], v[104:107]
    v_mfma_f32_16x16x32_bf16 v[100:103], v[108:111], v[132:135], v[100:103]
    v_mfma_f32_16x16x32_bf16 v[96:99], v[108:111], v[128:131], v[96:99]
    v_mfma_f32_16x16x32_bf16 v[92:95], v[108:111], v[124:127], v[92:95]
    v_mfma_f32_16x16x32_bf16 v[88:91], v[108:111], v[120:123], v[88:91]
    ds_read_b128 v[108:111], v66 offset:3072
    s_waitcnt lgkmcnt(10)
    v_mfma_f32_16x16x32_bf16 v[104:107], v[112:115], v[132:135], v[104:107]
    v_mfma_f32_16x16x32_bf16 v[100:103], v[112:115], v[128:131], v[100:103]
    v_mfma_f32_16x16x32_bf16 v[96:99], v[112:115], v[124:127], v[96:99]
    v_mfma_f32_16x16x32_bf16 v[92:95], v[112:115], v[120:123], v[92:95]
    ds_read_b128 v[112:115], v66 offset:3584
    s_waitcnt lgkmcnt(2)
    v_mfma_f32_16x16x32_bf16 v[104:107], v[116:119], v[128:131], v[104:107]
    v_mfma_f32_16x16x32_bf16 v[100:103], v[116:119], v[124:127], v[100:103]
    v_mfma_f32_16x16x32_bf16 v[96:99], v[116:119], v[120:123], v[96:99]
    ds_read_b128 v[116:119], v66 offset:64
    s_waitcnt lgkmcnt(2)
    v_mfma_f32_16x16x32_bf16 v[104:107], v[108:111], v[124:127], v[104:107]
    v_mfma_f32_16x16x32_bf16 v[100:103], v[108:111], v[120:123], v[100:103]
    ds_read_b128 v[108:111], v66 offset:576
    s_waitcnt lgkmcnt(2)
    v_mfma_f32_16x16x32_bf16 v[104:107], v[112:115], v[120:123], v[104:107]
    ds_read_b128 v[112:115], v66 offset:1088
    s_waitcnt lgkmcnt(2)
    v_mfma_f32_16x16x32_bf16 v[104:107], v[116:119], v[180:183], v[104:107]
    v_mfma_f32_16x16x32_bf16 v[100:103], v[116:119], v[176:179], v[100:103]
    v_mfma_f32_16x16x32_bf16 v[96:99], v[116:119], v[172:175], v[96:99]
    v_mfma_f32_16x16x32_bf16 v[92:95], v[116:119], v[168:171], v[92:95]
    v_mfma_f32_16x16x32_bf16 v[88:91], v[116:119], v[164:167], v[88:91]
    v_mfma_f32_16x16x32_bf16 v[84:87], v[116:119], v[160:163], v[84:87]
    v_mfma_f32_16x16x32_bf16 v[80:83], v[116:119], v[156:159], v[80:83]
    v_mfma_f32_16x16x32_bf16 v[76:79], v[116:119], v[152:155], v[76:79]
    ds_read_b128 v[116:119], v66 offset:1600
    s_waitcnt lgkmcnt(2)
    v_mfma_f32_16x16x32_bf16 v[104:107], v[108:111], v[176:179], v[104:107]
    v_mfma_f32_16x16x32_bf16 v[100:103], v[108:111], v[172:175], v[100:103]
    v_mfma_f32_16x16x32_bf16 v[96:99], v[108:111], v[168:171], v[96:99]
    v_mfma_f32_16x16x32_bf16 v[92:95], v[108:111], v[164:167], v[92:95]
    v_mfma_f32_16x16x32_bf16 v[88:91], v[108:111], v[160:163], v[88:91]
    v_mfma_f32_16x16x32_bf16 v[84:87], v[108:111], v[156:159], v[84:87]
    v_mfma_f32_16x16x32_bf16 v[80:83], v[108:111], v[152:155], v[80:83]
    ds_read_b128 v[108:111], v66 offset:2112
    s_waitcnt lgkmcnt(2)
    v_mfma_f32_16x16x32_bf16 v[104:107], v[112:115], v[172:175], v[104:107]
    v_mfma_f32_16x16x32_bf16 v[100:103], v[112:115], v[168:171], v[100:103]
    v_mfma_f32_16x16x32_bf16 v[96:99], v[112:115], v[164:167], v[96:99]
    v_mfma_f32_16x16x32_bf16 v[92:95], v[112:115], v[160:163], v[92:95]
    v_mfma_f32_16x16x32_bf16 v[88:91], v[112:115], v[156:159], v[88:91]
    v_mfma_f32_16x16x32_bf16 v[84:87], v[112:115], v[152:155], v[84:87]
    ds_read_b128 v[112:115], v66 offset:2624
    s_waitcnt lgkmcnt(2)
    v_mfma_f32_16x16x32_bf16 v[104:107], v[116:119], v[168:171], v[104:107]
    v_mfma_f32_16x16x32_bf16 v[100:103], v[116:119], v[164:167], v[100:103]
    v_mfma_f32_16x16x32_bf16 v[96:99], v[116:119], v[160:163], v[96:99]
    v_mfma_f32_16x16x32_bf16 v[92:95], v[116:119], v[156:159], v[92:95]
    v_mfma_f32_16x16x32_bf16 v[88:91], v[116:119], v[152:155], v[88:91]
    ds_read_b128 v[116:119], v66 offset:3136
    s_waitcnt lgkmcnt(2)
    v_mfma_f32_16x16x32_bf16 v[104:107], v[108:111], v[164:167], v[104:107]
    v_mfma_f32_16x16x32_bf16 v[100:103], v[108:111], v[160:163], v[100:103]
    v_mfma_f32_16x16x32_bf16 v[96:99], v[108:111], v[156:159], v[96:99]
    v_mfma_f32_16x16x32_bf16 v[92:95], v[108:111], v[152:155], v[92:95]
    ds_read_b128 v[108:111], v66 offset:3648
    s_waitcnt lgkmcnt(2)
    v_mfma_f32_16x16x32_bf16 v[104:107], v[112:115], v[160:163], v[104:107]
    v_mfma_f32_16x16x32_bf16 v[100:103], v[112:115], v[156:159], v[100:103]
    v_mfma_f32_16x16x32_bf16 v[96:99], v[112:115], v[152:155], v[96:99]
    s_waitcnt lgkmcnt(1)
    v_mfma_f32_16x16x32_bf16 v[104:107], v[116:119], v[156:159], v[104:107]
    v_mfma_f32_16x16x32_bf16 v[100:103], v[116:119], v[152:155], v[100:103]
    s_waitcnt lgkmcnt(0)
    v_mfma_f32_16x16x32_bf16 v[104:107], v[108:111], v[152:155], v[104:107]
    ds_write_b128 v74, v[76:79] offset:0
    ds_write_b128 v74, v[80:83] offset:1024
    ds_write_b128 v74, v[84:87] offset:2048
    ds_write_b128 v74, v[88:91] offset:3072
    ds_write_b128 v74, v[92:95] offset:4096
    ds_write_b128 v74, v[96:99] offset:5120
    ds_write_b128 v74, v[100:103] offset:6144
    s_nop 0
    ds_write_b128 v74, v[104:107] offset:7168
    s_branch c_pw_end_35
c_pw_36:
    s_cmp_lg_u32 s34, 1
    s_cbranch_scc1 c_pw_37
    ds_read_b128 v[108:111], v66 offset:128
    ds_read_b128 v[120:123], v67 offset:352
    ds_read_b128 v[124:127], v67 offset:864
    ds_read_b128 v[128:131], v67 offset:1376
    ds_read_b128 v[132:135], v67 offset:1888
    ds_read_b128 v[136:139], v67 offset:2400
    ds_read_b128 v[140:143], v67 offset:2912
    ds_read_b128 v[144:147], v67 offset:3424
    ds_read_b128 v[148:151], v67 offset:3936
    ds_read_b128 v[112:115], v66 offset:640
    ds_read_b128 v[116:119], v66 offset:1152
    s_waitcnt lgkmcnt(2)
    v_mfma_f32_16x16x32_bf16 v[104:107], v[108:111], v[148:151], 0
    v_mfma_f32_16x16x32_bf16 v[100:103], v[108:111], v[144:147], 0
    v_mfma_f32_16x16x32_bf16 v[96:99], v[108:111], v[140:143], 0
    v_mfma_f32_16x16x32_bf16 v[92:95], v[108:111], v[136:139], 0
    v_mfma_f32_16x16x32_bf16 v[88:91], v[108:111], v[132:135], 0
    v_mfma_f32_16x16x32_bf16 v[84:87], v[108:111], v[128:131], 0
    v_mfma_f32_16x16x32_bf16 v[80:83], v[108:111], v[124:127], 0
    v_mfma_f32_16x16x32_bf16 v[76:79], v[108:111], v[120:123], 0
    ds_read_b128 v[108:111], v66 offset:1664
    s_waitcnt lgkmcnt(2)
    v_mfma_f32_16x16x32_bf16 v[104:107], v[112:115], v[144:147], v[104:107]
    v_mfma_f32_16x16x32_bf16 v[100:103], v[112:115], v[140:143], v[100:103]
    v_mfma_f32_16x16x32_bf16 v[96:99], v[112:115], v[136:139], v[96:99]
    v_mfma_f32_16x16x32_bf16 v[92:95], v[112:115], v[132:135], v[92:95]
    v_mfma_f32_16x16x32_bf16 v[88:91], v[112:115], v[128:131], v[88:91]
    v_mfma_f32_16x16x32_bf16 v[84:87], v[112:115], v[124:127], v[84:87]
    v_mfma_f32_16x16x32_bf16 v[80:83], v[112:115], v[120:123], v[80:83]
    ds_read_b128 v[112:115], v66 offset:2176
    ds_read_b128 v[152:155], v67 offset:288
    ds_read_b128 v[156:159], v67 offset:800
    ds_read_b128 v[160:163], v67 offset:1312
    ds_read_b128 v[164:167], v67 offset:1824
    ds_read_b128 v[168:171], v67 offset:2336
    ds_read_b128 v[172:175], v67 offset:2848
    ds_read_b128 v[176:179], v67 offset:3360
    ds_read_b128 v[180:183], v67 offset:3872
    s_waitcnt lgkmcnt(10)
    v_mfma_f32_16x16x32_bf16 v[104:107], v[116:119], v[140:143], v[104:107]
    v_mfma_f32_16x16x32_bf16 v[100:103], v[116:119], v[136:139], v[100:103]
    v_mfma_f32_16x16x32_bf16 v[96:99], v[116:119], v[132:135], v[96:99]
    v_mfma_f32_16x16x32_bf16 v[92:95], v[116:119], v[128:131], v[92:95]
    v_mfma_f32_16x16x32_bf16 v[88:91], v[116:119], v[124:127], v[88:91]
    v_mfma_f32_16x16x32_bf16 v[84:87], v[116:119], v[120:123], v[84:87]
    ds_read_b128 v[116:119], v66 offset:2688
    s_waitcnt lgkmcnt(10)
    v_mfma_f32_16x16x32_bf16 v[104:107], v[108:111], v[136:139], v[104:107]
    v_mfma_f32_16x16x32_bf16 v[100:103], v[108:111], v[132:135], v[100:103]
    v_mfma_f32_16x16x32_bf16 v[96:99], v[108:111], v[128:131], v[96:99]
    v_mfma_f32_16x16x32_bf16 v[92:95], v[108:111], v[124:127], v[92:95]
    v_mfma_f32_16x16x32_bf16 v[88:91], v[108:111], v[120:123], v[88:91]
    ds_read_b128 v[108:111], v66 offset:3200
    s_waitcnt lgkmcnt(10)
    v_mfma_f32_16x16x32_bf16 v[104:107], v[112:115], v[132:135], v[104:107]
    v_mfma_f32_16x16x32_bf16 v[100:103], v[112:115], v[128:131], v[100:103]
    v_mfma_f32_16x16x32_bf16 v[96:99], v[112:115], v[124:127], v[96:99]
    v_mfma_f32_16x16x32_bf16 v[92:95], v[112:115], v[120:123], v[92:95]
    ds_read_b128 v[112:115], v66 offset:3712
    s_waitcnt lgkmcnt(2)
    v_mfma_f32_16x16x32_bf16 v[104:107], v[116:119], v[128:131], v[104:107]
    v_mfma_f32_16x16x32_bf16 v[100:103], v[116:119], v[124:127], v[100:103]
    v_mfma_f32_16x16x32_bf16 v[96:99], v[116:119], v[120:123], v[96:99]
    ds_read_b128 v[116:119], v66 offset:192
    s_waitcnt lgkmcnt(2)
    v_mfma_f32_16x16x32_bf16 v[104:107], v[108:111], v[124:127], v[104:107]
    v_mfma_f32_16x16x32_bf16 v[100:103], v[108:111], v[120:123], v[100:103]
    ds_read_b128 v[108:111], v66 offset:704
    s_waitcnt lgkmcnt(2)
    v_mfma_f32_16x16x32_bf16 v[104:107], v[112:115], v[120:123], v[104:107]
    ds_read_b128 v[112:115], v66 offset:1216
    s_waitcnt lgkmcnt(2)
    v_mfma_f32_16x16x32_bf16 v[104:107], v[116:119], v[180:183], v[104:107]
    v_mfma_f32_16x16x32_bf16 v[100:103], v[116:119], v[176:179], v[100:103]
    v_mfma_f32_16x16x32_bf16 v[96:99], v[116:119], v[172:175], v[96:99]
    v_mfma_f32_16x16x32_bf16 v[92:95], v[116:119], v[168:171], v[92:95]
    v_mfma_f32_16x16x32_bf16 v[88:91], v[116:119], v[164:167], v[88:91]
    v_mfma_f32_16x16x32_bf16 v[84:87], v[116:119], v[160:163], v[84:87]
    v_mfma_f32_16x16x32_bf16 v[80:83], v[116:119], v[156:159], v[80:83]
    v_mfma_f32_16x16x32_bf16 v[76:79], v[116:119], v[152:155], v[76:79]
    ds_read_b128 v[116:119], v66 offset:1728
    s_waitcnt lgkmcnt(2)
    v_mfma_f32_16x16x32_bf16 v[104:107], v[108:111], v[176:179], v[104:107]
    v_mfma_f32_16x16x32_bf16 v[100:103], v[108:111], v[172:175], v[100:103]
    v_mfma_f32_16x16x32_bf16 v[96:99], v[108:111], v[168:171], v[96:99]
    v_mfma_f32_16x16x32_bf16 v[92:95], v[108:111], v[164:167], v[92:95]
    v_mfma_f32_16x16x32_bf16 v[88:91], v[108:111], v[160:163], v[88:91]
    v_mfma_f32_16x16x32_bf16 v[84:87], v[108:111], v[156:159], v[84:87]
    v_mfma_f32_16x16x32_bf16 v[80:83], v[108:111], v[152:155], v[80:83]
    ds_read_b128 v[108:111], v66 offset:2240
    s_waitcnt lgkmcnt(2)
    v_mfma_f32_16x16x32_bf16 v[104:107], v[112:115], v[172:175], v[104:107]
    v_mfma_f32_16x16x32_bf16 v[100:103], v[112:115], v[168:171], v[100:103]
    v_mfma_f32_16x16x32_bf16 v[96:99], v[112:115], v[164:167], v[96:99]
    v_mfma_f32_16x16x32_bf16 v[92:95], v[112:115], v[160:163], v[92:95]
    v_mfma_f32_16x16x32_bf16 v[88:91], v[112:115], v[156:159], v[88:91]
    v_mfma_f32_16x16x32_bf16 v[84:87], v[112:115], v[152:155], v[84:87]
    ds_read_b128 v[112:115], v66 offset:2752
    s_waitcnt lgkmcnt(2)
    v_mfma_f32_16x16x32_bf16 v[104:107], v[116:119], v[168:171], v[104:107]
    v_mfma_f32_16x16x32_bf16 v[100:103], v[116:119], v[164:167], v[100:103]
    v_mfma_f32_16x16x32_bf16 v[96:99], v[116:119], v[160:163], v[96:99]
    v_mfma_f32_16x16x32_bf16 v[92:95], v[116:119], v[156:159], v[92:95]
    v_mfma_f32_16x16x32_bf16 v[88:91], v[116:119], v[152:155], v[88:91]
    ds_read_b128 v[116:119], v66 offset:3264
    s_waitcnt lgkmcnt(2)
    v_mfma_f32_16x16x32_bf16 v[104:107], v[108:111], v[164:167], v[104:107]
    v_mfma_f32_16x16x32_bf16 v[100:103], v[108:111], v[160:163], v[100:103]
    v_mfma_f32_16x16x32_bf16 v[96:99], v[108:111], v[156:159], v[96:99]
    v_mfma_f32_16x16x32_bf16 v[92:95], v[108:111], v[152:155], v[92:95]
    ds_read_b128 v[108:111], v66 offset:3776
    s_waitcnt lgkmcnt(2)
    v_mfma_f32_16x16x32_bf16 v[104:107], v[112:115], v[160:163], v[104:107]
    v_mfma_f32_16x16x32_bf16 v[100:103], v[112:115], v[156:159], v[100:103]
    v_mfma_f32_16x16x32_bf16 v[96:99], v[112:115], v[152:155], v[96:99]
    s_waitcnt lgkmcnt(1)
    v_mfma_f32_16x16x32_bf16 v[104:107], v[116:119], v[156:159], v[104:107]
    v_mfma_f32_16x16x32_bf16 v[100:103], v[116:119], v[152:155], v[100:103]
    s_waitcnt lgkmcnt(0)
    v_mfma_f32_16x16x32_bf16 v[104:107], v[108:111], v[152:155], v[104:107]
    ds_write_b128 v74, v[76:79] offset:0
    ds_write_b128 v74, v[80:83] offset:1024
    ds_write_b128 v74, v[84:87] offset:2048
    ds_write_b128 v74, v[88:91] offset:3072
    ds_write_b128 v74, v[92:95] offset:4096
    ds_write_b128 v74, v[96:99] offset:5120
    ds_write_b128 v74, v[100:103] offset:6144
    s_nop 0
    ds_write_b128 v74, v[104:107] offset:7168
    s_branch c_pw_end_35
c_pw_37:
    s_cmp_lg_u32 s34, 2
    s_cbranch_scc1 c_pw_38
    ds_read_b128 v[108:111], v66 offset:256
    ds_read_b128 v[120:123], v67 offset:224
    ds_read_b128 v[124:127], v67 offset:736
    ds_read_b128 v[128:131], v67 offset:1248
    ds_read_b128 v[132:135], v67 offset:1760
    ds_read_b128 v[136:139], v67 offset:2272
    ds_read_b128 v[140:143], v67 offset:2784
    ds_read_b128 v[144:147], v67 offset:3296
    ds_read_b128 v[148:151], v67 offset:3808
    ds_read_b128 v[112:115], v66 offset:768
    ds_read_b128 v[116:119], v66 offset:1280
    s_waitcnt lgkmcnt(2)
    v_mfma_f32_16x16x32_bf16 v[104:107], v[108:111], v[148:151], 0
    v_mfma_f32_16x16x32_bf16 v[100:103], v[108:111], v[144:147], 0
    v_mfma_f32_16x16x32_bf16 v[96:99], v[108:111], v[140:143], 0
    v_mfma_f32_16x16x32_bf16 v[92:95], v[108:111], v[136:139], 0
    v_mfma_f32_16x16x32_bf16 v[88:91], v[108:111], v[132:135], 0
    v_mfma_f32_16x16x32_bf16 v[84:87], v[108:111], v[128:131], 0
    v_mfma_f32_16x16x32_bf16 v[80:83], v[108:111], v[124:127], 0
    v_mfma_f32_16x16x32_bf16 v[76:79], v[108:111], v[120:123], 0
    ds_read_b128 v[108:111], v66 offset:1792
    s_waitcnt lgkmcnt(2)
    v_mfma_f32_16x16x32_bf16 v[104:107], v[112:115], v[144:147], v[104:107]
    v_mfma_f32_16x16x32_bf16 v[100:103], v[112:115], v[140:143], v[100:103]
    v_mfma_f32_16x16x32_bf16 v[96:99], v[112:115], v[136:139], v[96:99]
    v_mfma_f32_16x16x32_bf16 v[92:95], v[112:115], v[132:135], v[92:95]
    v_mfma_f32_16x16x32_bf16 v[88:91], v[112:115], v[128:131], v[88:91]
    v_mfma_f32_16x16x32_bf16 v[84:87], v[112:115], v[124:127], v[84:87]
    v_mfma_f32_16x16x32_bf16 v[80:83], v[112:115], v[120:123], v[80:83]
    ds_read_b128 v[112:115], v66 offset:2304
    ds_read_b128 v[152:155], v67 offset:160
    ds_read_b128 v[156:159], v67 offset:672
    ds_read_b128 v[160:163], v67 offset:1184
    ds_read_b128 v[164:167], v67 offset:1696
    ds_read_b128 v[168:171], v67 offset:2208
    ds_read_b128 v[172:175], v67 offset:2720
    ds_read_b128 v[176:179], v67 offset:3232
    ds_read_b128 v[180:183], v67 offset:3744
    s_waitcnt lgkmcnt(10)
    v_mfma_f32_16x16x32_bf16 v[104:107], v[116:119], v[140:143], v[104:107]
    v_mfma_f32_16x16x32_bf16 v[100:103], v[116:119], v[136:139], v[100:103]
    v_mfma_f32_16x16x32_bf16 v[96:99], v[116:119], v[132:135], v[96:99]
    v_mfma_f32_16x16x32_bf16 v[92:95], v[116:119], v[128:131], v[92:95]
    v_mfma_f32_16x16x32_bf16 v[88:91], v[116:119], v[124:127], v[88:91]
    v_mfma_f32_16x16x32_bf16 v[84:87], v[116:119], v[120:123], v[84:87]
    ds_read_b128 v[116:119], v66 offset:2816
    s_waitcnt lgkmcnt(10)
    v_mfma_f32_16x16x32_bf16 v[104:107], v[108:111], v[136:139], v[104:107]
    v_mfma_f32_16x16x32_bf16 v[100:103], v[108:111], v[132:135], v[100:103]
    v_mfma_f32_16x16x32_bf16 v[96:99], v[108:111], v[128:131], v[96:99]
    v_mfma_f32_16x16x32_bf16 v[92:95], v[108:111], v[124:127], v[92:95]
    v_mfma_f32_16x16x32_bf16 v[88:91], v[108:111], v[120:123], v[88:91]
    ds_read_b128 v[108:111], v66 offset:3328
    s_waitcnt lgkmcnt(10)
    v_mfma_f32_16x16x32_bf16 v[104:107], v[112:115], v[132:135], v[104:107]
    v_mfma_f32_16x16x32_bf16 v[100:103], v[112:115], v[128:131], v[100:103]
    v_mfma_f32_16x16x32_bf16 v[96:99], v[112:115], v[124:127], v[96:99]
    v_mfma_f32_16x16x32_bf16 v[92:95], v[112:115], v[120:123], v[92:95]
    ds_read_b128 v[112:115], v66 offset:3840
    s_waitcnt lgkmcnt(2)
    v_mfma_f32_16x16x32_bf16 v[104:107], v[116:119], v[128:131], v[104:107]
    v_mfma_f32_16x16x32_bf16 v[100:103], v[116:119], v[124:127], v[100:103]
    v_mfma_f32_16x16x32_bf16 v[96:99], v[116:119], v[120:123], v[96:99]
    ds_read_b128 v[116:119], v66 offset:320
    s_waitcnt lgkmcnt(2)
    v_mfma_f32_16x16x32_bf16 v[104:107], v[108:111], v[124:127], v[104:107]
    v_mfma_f32_16x16x32_bf16 v[100:103], v[108:111], v[120:123], v[100:103]
    ds_read_b128 v[108:111], v66 offset:832
    s_waitcnt lgkmcnt(2)
    v_mfma_f32_16x16x32_bf16 v[104:107], v[112:115], v[120:123], v[104:107]
    ds_read_b128 v[112:115], v66 offset:1344
    s_waitcnt lgkmcnt(2)
    v_mfma_f32_16x16x32_bf16 v[104:107], v[116:119], v[180:183], v[104:107]
    v_mfma_f32_16x16x32_bf16 v[100:103], v[116:119], v[176:179], v[100:103]
    v_mfma_f32_16x16x32_bf16 v[96:99], v[116:119], v[172:175], v[96:99]
    v_mfma_f32_16x16x32_bf16 v[92:95], v[116:119], v[168:171], v[92:95]
    v_mfma_f32_16x16x32_bf16 v[88:91], v[116:119], v[164:167], v[88:91]
    v_mfma_f32_16x16x32_bf16 v[84:87], v[116:119], v[160:163], v[84:87]
    v_mfma_f32_16x16x32_bf16 v[80:83], v[116:119], v[156:159], v[80:83]
    v_mfma_f32_16x16x32_bf16 v[76:79], v[116:119], v[152:155], v[76:79]
    ds_read_b128 v[116:119], v66 offset:1856
    s_waitcnt lgkmcnt(2)
    v_mfma_f32_16x16x32_bf16 v[104:107], v[108:111], v[176:179], v[104:107]
    v_mfma_f32_16x16x32_bf16 v[100:103], v[108:111], v[172:175], v[100:103]
    v_mfma_f32_16x16x32_bf16 v[96:99], v[108:111], v[168:171], v[96:99]
    v_mfma_f32_16x16x32_bf16 v[92:95], v[108:111], v[164:167], v[92:95]
    v_mfma_f32_16x16x32_bf16 v[88:91], v[108:111], v[160:163], v[88:91]
    v_mfma_f32_16x16x32_bf16 v[84:87], v[108:111], v[156:159], v[84:87]
    v_mfma_f32_16x16x32_bf16 v[80:83], v[108:111], v[152:155], v[80:83]
    ds_read_b128 v[108:111], v66 offset:2368
    s_waitcnt lgkmcnt(2)
    v_mfma_f32_16x16x32_bf16 v[104:107], v[112:115], v[172:175], v[104:107]
    v_mfma_f32_16x16x32_bf16 v[100:103], v[112:115], v[168:171], v[100:103]
    v_mfma_f32_16x16x32_bf16 v[96:99], v[112:115], v[164:167], v[96:99]
    v_mfma_f32_16x16x32_bf16 v[92:95], v[112:115], v[160:163], v[92:95]
    v_mfma_f32_16x16x32_bf16 v[88:91], v[112:115], v[156:159], v[88:91]
    v_mfma_f32_16x16x32_bf16 v[84:87], v[112:115], v[152:155], v[84:87]
    ds_read_b128 v[112:115], v66 offset:2880
    s_waitcnt lgkmcnt(2)
    v_mfma_f32_16x16x32_bf16 v[104:107], v[116:119], v[168:171], v[104:107]
    v_mfma_f32_16x16x32_bf16 v[100:103], v[116:119], v[164:167], v[100:103]
    v_mfma_f32_16x16x32_bf16 v[96:99], v[116:119], v[160:163], v[96:99]
    v_mfma_f32_16x16x32_bf16 v[92:95], v[116:119], v[156:159], v[92:95]
    v_mfma_f32_16x16x32_bf16 v[88:91], v[116:119], v[152:155], v[88:91]
    ds_read_b128 v[116:119], v66 offset:3392
    s_waitcnt lgkmcnt(2)
    v_mfma_f32_16x16x32_bf16 v[104:107], v[108:111], v[164:167], v[104:107]
    v_mfma_f32_16x16x32_bf16 v[100:103], v[108:111], v[160:163], v[100:103]
    v_mfma_f32_16x16x32_bf16 v[96:99], v[108:111], v[156:159], v[96:99]
    v_mfma_f32_16x16x32_bf16 v[92:95], v[108:111], v[152:155], v[92:95]
    ds_read_b128 v[108:111], v66 offset:3904
    s_waitcnt lgkmcnt(2)
    v_mfma_f32_16x16x32_bf16 v[104:107], v[112:115], v[160:163], v[104:107]
    v_mfma_f32_16x16x32_bf16 v[100:103], v[112:115], v[156:159], v[100:103]
    v_mfma_f32_16x16x32_bf16 v[96:99], v[112:115], v[152:155], v[96:99]
    s_waitcnt lgkmcnt(1)
    v_mfma_f32_16x16x32_bf16 v[104:107], v[116:119], v[156:159], v[104:107]
    v_mfma_f32_16x16x32_bf16 v[100:103], v[116:119], v[152:155], v[100:103]
    s_waitcnt lgkmcnt(0)
    v_mfma_f32_16x16x32_bf16 v[104:107], v[108:111], v[152:155], v[104:107]
    ds_write_b128 v74, v[76:79] offset:0
    ds_write_b128 v74, v[80:83] offset:1024
    ds_write_b128 v74, v[84:87] offset:2048
    ds_write_b128 v74, v[88:91] offset:3072
    ds_write_b128 v74, v[92:95] offset:4096
    ds_write_b128 v74, v[96:99] offset:5120
    ds_write_b128 v74, v[100:103] offset:6144
    s_nop 0
    ds_write_b128 v74, v[104:107] offset:7168
    s_branch c_pw_end_35
c_pw_38:
    ds_read_b128 v[108:111], v66 offset:384
    ds_read_b128 v[120:123], v67 offset:96
    ds_read_b128 v[124:127], v67 offset:608
    ds_read_b128 v[128:131], v67 offset:1120
    ds_read_b128 v[132:135], v67 offset:1632
    ds_read_b128 v[136:139], v67 offset:2144
    ds_read_b128 v[140:143], v67 offset:2656
    ds_read_b128 v[144:147], v67 offset:3168
    ds_read_b128 v[148:151], v67 offset:3680
    ds_read_b128 v[112:115], v66 offset:896
    ds_read_b128 v[116:119], v66 offset:1408
    s_waitcnt lgkmcnt(2)
    v_mfma_f32_16x16x32_bf16 v[104:107], v[108:111], v[148:151], 0
    v_mfma_f32_16x16x32_bf16 v[100:103], v[108:111], v[144:147], 0
    v_mfma_f32_16x16x32_bf16 v[96:99], v[108:111], v[140:143], 0
    v_mfma_f32_16x16x32_bf16 v[92:95], v[108:111], v[136:139], 0
    v_mfma_f32_16x16x32_bf16 v[88:91], v[108:111], v[132:135], 0
    v_mfma_f32_16x16x32_bf16 v[84:87], v[108:111], v[128:131], 0
    v_mfma_f32_16x16x32_bf16 v[80:83], v[108:111], v[124:127], 0
    v_mfma_f32_16x16x32_bf16 v[76:79], v[108:111], v[120:123], 0
    ds_read_b128 v[108:111], v66 offset:1920
    s_waitcnt lgkmcnt(2)
    v_mfma_f32_16x16x32_bf16 v[104:107], v[112:115], v[144:147], v[104:107]
    v_mfma_f32_16x16x32_bf16 v[100:103], v[112:115], v[140:143], v[100:103]
    v_mfma_f32_16x16x32_bf16 v[96:99], v[112:115], v[136:139], v[96:99]
    v_mfma_f32_16x16x32_bf16 v[92:95], v[112:115], v[132:135], v[92:95]
    v_mfma_f32_16x16x32_bf16 v[88:91], v[112:115], v[128:131], v[88:91]
    v_mfma_f32_16x16x32_bf16 v[84:87], v[112:115], v[124:127], v[84:87]
    v_mfma_f32_16x16x32_bf16 v[80:83], v[112:115], v[120:123], v[80:83]
    ds_read_b128 v[112:115], v66 offset:2432
    ds_read_b128 v[152:155], v67 offset:32
    ds_read_b128 v[156:159], v67 offset:544
    ds_read_b128 v[160:163], v67 offset:1056
    ds_read_b128 v[164:167], v67 offset:1568
    ds_read_b128 v[168:171], v67 offset:2080
    ds_read_b128 v[172:175], v67 offset:2592
    ds_read_b128 v[176:179], v67 offset:3104
    ds_read_b128 v[180:183], v67 offset:3616
    s_waitcnt lgkmcnt(10)
    v_mfma_f32_16x16x32_bf16 v[104:107], v[116:119], v[140:143], v[104:107]
    v_mfma_f32_16x16x32_bf16 v[100:103], v[116:119], v[136:139], v[100:103]
    v_mfma_f32_16x16x32_bf16 v[96:99], v[116:119], v[132:135], v[96:99]
    v_mfma_f32_16x16x32_bf16 v[92:95], v[116:119], v[128:131], v[92:95]
    v_mfma_f32_16x16x32_bf16 v[88:91], v[116:119], v[124:127], v[88:91]
    v_mfma_f32_16x16x32_bf16 v[84:87], v[116:119], v[120:123], v[84:87]
    ds_read_b128 v[116:119], v66 offset:2944
    s_waitcnt lgkmcnt(10)
    v_mfma_f32_16x16x32_bf16 v[104:107], v[108:111], v[136:139], v[104:107]
    v_mfma_f32_16x16x32_bf16 v[100:103], v[108:111], v[132:135], v[100:103]
    v_mfma_f32_16x16x32_bf16 v[96:99], v[108:111], v[128:131], v[96:99]
    v_mfma_f32_16x16x32_bf16 v[92:95], v[108:111], v[124:127], v[92:95]
    v_mfma_f32_16x16x32_bf16 v[88:91], v[108:111], v[120:123], v[88:91]
    ds_read_b128 v[108:111], v66 offset:3456
    s_waitcnt lgkmcnt(10)
    v_mfma_f32_16x16x32_bf16 v[104:107], v[112:115], v[132:135], v[104:107]
    v_mfma_f32_16x16x32_bf16 v[100:103], v[112:115], v[128:131], v[100:103]
    v_mfma_f32_16x16x32_bf16 v[96:99], v[112:115], v[124:127], v[96:99]
    v_mfma_f32_16x16x32_bf16 v[92:95], v[112:115], v[120:123], v[92:95]
    ds_read_b128 v[112:115], v66 offset:3968
    s_waitcnt lgkmcnt(2)
    v_mfma_f32_16x16x32_bf16 v[104:107], v[116:119], v[128:131], v[104:107]
    v_mfma_f32_16x16x32_bf16 v[100:103], v[116:119], v[124:127], v[100:103]
    v_mfma_f32_16x16x32_bf16 v[96:99], v[116:119], v[120:123], v[96:99]
    ds_read_b128 v[116:119], v66 offset:448
    s_waitcnt lgkmcnt(2)
    v_mfma_f32_16x16x32_bf16 v[104:107], v[108:111], v[124:127], v[104:107]
    v_mfma_f32_16x16x32_bf16 v[100:103], v[108:111], v[120:123], v[100:103]
    ds_read_b128 v[108:111], v66 offset:960
    s_waitcnt lgkmcnt(2)
    v_mfma_f32_16x16x32_bf16 v[104:107], v[112:115], v[120:123], v[104:107]
    ds_read_b128 v[112:115], v66 offset:1472
    s_waitcnt lgkmcnt(2)
    v_mfma_f32_16x16x32_bf16 v[104:107], v[116:119], v[180:183], v[104:107]
    v_mfma_f32_16x16x32_bf16 v[100:103], v[116:119], v[176:179], v[100:103]
    v_mfma_f32_16x16x32_bf16 v[96:99], v[116:119], v[172:175], v[96:99]
    v_mfma_f32_16x16x32_bf16 v[92:95], v[116:119], v[168:171], v[92:95]
    v_mfma_f32_16x16x32_bf16 v[88:91], v[116:119], v[164:167], v[88:91]
    v_mfma_f32_16x16x32_bf16 v[84:87], v[116:119], v[160:163], v[84:87]
    v_mfma_f32_16x16x32_bf16 v[80:83], v[116:119], v[156:159], v[80:83]
    v_mfma_f32_16x16x32_bf16 v[76:79], v[116:119], v[152:155], v[76:79]
    ds_read_b128 v[116:119], v66 offset:1984
    s_waitcnt lgkmcnt(2)
    v_mfma_f32_16x16x32_bf16 v[104:107], v[108:111], v[176:179], v[104:107]
    v_mfma_f32_16x16x32_bf16 v[100:103], v[108:111], v[172:175], v[100:103]
    v_mfma_f32_16x16x32_bf16 v[96:99], v[108:111], v[168:171], v[96:99]
    v_mfma_f32_16x16x32_bf16 v[92:95], v[108:111], v[164:167], v[92:95]
    v_mfma_f32_16x16x32_bf16 v[88:91], v[108:111], v[160:163], v[88:91]
    v_mfma_f32_16x16x32_bf16 v[84:87], v[108:111], v[156:159], v[84:87]
    v_mfma_f32_16x16x32_bf16 v[80:83], v[108:111], v[152:155], v[80:83]
    ds_read_b128 v[108:111], v66 offset:2496
    s_waitcnt lgkmcnt(2)
    v_mfma_f32_16x16x32_bf16 v[104:107], v[112:115], v[172:175], v[104:107]
    v_mfma_f32_16x16x32_bf16 v[100:103], v[112:115], v[168:171], v[100:103]
    v_mfma_f32_16x16x32_bf16 v[96:99], v[112:115], v[164:167], v[96:99]
    v_mfma_f32_16x16x32_bf16 v[92:95], v[112:115], v[160:163], v[92:95]
    v_mfma_f32_16x16x32_bf16 v[88:91], v[112:115], v[156:159], v[88:91]
    v_mfma_f32_16x16x32_bf16 v[84:87], v[112:115], v[152:155], v[84:87]
    ds_read_b128 v[112:115], v66 offset:3008
    s_waitcnt lgkmcnt(2)
    v_mfma_f32_16x16x32_bf16 v[104:107], v[116:119], v[168:171], v[104:107]
    v_mfma_f32_16x16x32_bf16 v[100:103], v[116:119], v[164:167], v[100:103]
    v_mfma_f32_16x16x32_bf16 v[96:99], v[116:119], v[160:163], v[96:99]
    v_mfma_f32_16x16x32_bf16 v[92:95], v[116:119], v[156:159], v[92:95]
    v_mfma_f32_16x16x32_bf16 v[88:91], v[116:119], v[152:155], v[88:91]
    ds_read_b128 v[116:119], v66 offset:3520
    s_waitcnt lgkmcnt(2)
    v_mfma_f32_16x16x32_bf16 v[104:107], v[108:111], v[164:167], v[104:107]
    v_mfma_f32_16x16x32_bf16 v[100:103], v[108:111], v[160:163], v[100:103]
    v_mfma_f32_16x16x32_bf16 v[96:99], v[108:111], v[156:159], v[96:99]
    v_mfma_f32_16x16x32_bf16 v[92:95], v[108:111], v[152:155], v[92:95]
    ds_read_b128 v[108:111], v66 offset:4032
    s_waitcnt lgkmcnt(2)
    v_mfma_f32_16x16x32_bf16 v[104:107], v[112:115], v[160:163], v[104:107]
    v_mfma_f32_16x16x32_bf16 v[100:103], v[112:115], v[156:159], v[100:103]
    v_mfma_f32_16x16x32_bf16 v[96:99], v[112:115], v[152:155], v[96:99]
    s_waitcnt lgkmcnt(1)
    v_mfma_f32_16x16x32_bf16 v[104:107], v[116:119], v[156:159], v[104:107]
    v_mfma_f32_16x16x32_bf16 v[100:103], v[116:119], v[152:155], v[100:103]
    s_waitcnt lgkmcnt(0)
    v_mfma_f32_16x16x32_bf16 v[104:107], v[108:111], v[152:155], v[104:107]
    ds_write_b128 v74, v[76:79] offset:0
    ds_write_b128 v74, v[80:83] offset:1024
    ds_write_b128 v74, v[84:87] offset:2048
    ds_write_b128 v74, v[88:91] offset:3072
    ds_write_b128 v74, v[92:95] offset:4096
    ds_write_b128 v74, v[96:99] offset:5120
    ds_write_b128 v74, v[100:103] offset:6144
    s_nop 0
    ds_write_b128 v74, v[104:107] offset:7168
c_pw_end_35:
    s_waitcnt lgkmcnt(0)
    v_mov_b32 v3, 161796
    v_mov_b32 v4, 1
    s_mov_b64 exec, 1
    ds_add_u32 v3, v4
    s_mov_b64 exec, -1
    s_mov_b32 s67, 0
gsync_40:
    ds_read_b32 v4, v3
    s_add_u32 s67, s67, 1
    s_waitcnt lgkmcnt(0)
    v_readfirstlane_b32 s66, v4
    s_cmp_gt_u32 s67, 1000000
    s_cbranch_scc1 gsync_e_41
    s_cmp_lt_u32 s66, 8
    s_cbranch_scc1 gsync_40
gsync_e_41:
    ds_read_b128 v[120:123], v75 offset:0
    ds_read_b128 v[124:127], v75 offset:16
    ds_read_b128 v[128:131], v75 offset:8192
    ds_read_b128 v[132:135], v75 offset:8208
    ds_read_b128 v[136:139], v75 offset:16384
    ds_read_b128 v[140:143], v75 offset:16400
    ds_read_b128 v[144:147], v75 offset:24576
    ds_read_b128 v[148:151], v75 offset:24592
    s_lshl_b32 s40, s56, 12
    s_add_u32 s40, s40, 8912896
    s_waitcnt lgkmcnt(0)
    v_pk_add_f32 v[120:121], v[120:121], v[128:129]
    v_pk_add_f32 v[136:137], v[136:137], v[144:145]
    v_pk_add_f32 v[122:123], v[122:123], v[130:131]
    v_pk_add_f32 v[138:139], v[138:139], v[146:147]
    v_pk_add_f32 v[124:125], v[124:125], v[132:133]
    v_pk_add_f32 v[140:141], v[140:141], v[148:149]
    v_pk_add_f32 v[126:127], v[126:127], v[134:135]
    v_pk_add_f32 v[142:143], v[142:143], v[150:151]
    v_pk_add_f32 v[120:121], v[120:121], v[136:137]
    v_pk_add_f32 v[122:123], v[122:123], v[138:139]
    v_pk_add_f32 v[124:125], v[124:125], v[140:141]
    v_pk_add_f32 v[126:127], v[126:127], v[142:143]
    v_cvt_pk_bf16_f32 v192, v120, v121
    v_cvt_pk_bf16_f32 v193, v122, v123
    v_cvt_pk_bf16_f32 v194, v124, v125
    v_cvt_pk_bf16_f32 v195, v126, v127
    buffer_store_dwordx4 v[192:195], v2, s[8:11], s40 offen sc1
    s_nop 1
    s_waitcnt vmcnt(1)
    v_cmp_ne_u32 vcc, 0, v0
    s_nop 1
    v_cndmask_b32 v16, 0, v16, vcc
    v_cndmask_b32 v17, 0, v17, vcc
    v_cndmask_b32 v18, 0, v18, vcc
    v_cndmask_b32 v19, 0, v19, vcc
    v_alignbit_b32 v184, v17, v16, 16
    v_alignbit_b32 v185, v18, v17, 16
    v_alignbit_b32 v186, v19, v18, 16
    v_alignbit_b32 v187, v20, v19, 16
    v_alignbit_b32 v188, v21, v20, 16
    v_alignbit_b32 v189, v22, v21, 16
    v_alignbit_b32 v190, v23, v22, 16
    ds_write_b128 v64, v[184:187] offset:0
    v_mov_b32 v192, v17
    v_mov_b32 v193, v18
    v_mov_b32 v194, v19
    v_mov_b32 v195, v20
    ds_write_b128 v64, v[192:195] offset:4160
    s_nop 1
    v_mov_b32 v192, v185
    v_mov_b32 v193, v186
    v_mov_b32 v194, v187
    v_mov_b32 v195, v188
    ds_write_b128 v64, v[192:195] offset:8320
    s_nop 1
    ds_write_b128 v64, v[18:21] offset:12480
    ds_write_b128 v64, v[186:189] offset:16640
    v_mov_b32 v192, v19
    v_mov_b32 v193, v20
    v_mov_b32 v194, v21
    v_mov_b32 v195, v22
    ds_write_b128 v64, v[192:195] offset:20800
    s_nop 1
    v_mov_b32 v192, v187
    v_mov_b32 v193, v188
    v_mov_b32 v194, v189
    v_mov_b32 v195, v190
    ds_write_b128 v64, v[192:195] offset:24960
    s_nop 1
    ds_write_b128 v64, v[20:23] offset:29120
    ds_write_b128 v65, v[36:39]
    v_lshlrev_b32 v3, 16, v45
    v_or_b32 v3, v3, v45
    v_and_b32 v196, v68, v3
    v_and_b32 v197, v69, v3
    v_and_b32 v198, v70, v3
    v_and_b32 v199, v71, v3
    s_waitcnt lgkmcnt(0)
    v_mov_b32 v3, 161796
    v_mov_b32 v4, 1
    s_mov_b64 exec, 1
    ds_add_u32 v3, v4
    s_mov_b64 exec, -1
    s_mov_b32 s67, 0
gsync_42:
    ds_read_b32 v4, v3
    s_add_u32 s67, s67, 1
    s_waitcnt lgkmcnt(0)
    v_readfirstlane_b32 s66, v4
    s_cmp_gt_u32 s67, 1000000
    s_cbranch_scc1 gsync_e_43
    s_cmp_lt_u32 s66, 12
    s_cbranch_scc1 gsync_42
gsync_e_43:
    s_cmp_ge_u32 s2, 192
    s_cbranch_scc1 c_wj3_44
    v_lshrrev_b32 v3, 4, v1
    v_and_b32 v5, 15, v1
    v_lshrrev_b32 v4, 2, v5
    v_lshl_add_u32 v3, v3, 2, v4
    v_mul_u32_u24 v3, 160, v3
    v_and_b32 v4, 3, v5
    v_lshl_add_u32 v3, v4, 3, v3
    v_lshlrev_b32 v5, 4, v1
    s_lshl_b32 s40, s34, 5
    s_add_u32 s41, s40, 156672
    v_add_u32 v4, s41, v3
    ds_read_b64_tr_b16 v[192:193], v4
    ds_read_b64_tr_b16 v[194:195], v4 offset:2560
    s_mul_i32 s41, s2, 5120
    s_lshl_b32 s40, s40, 5
    s_add_u32 s41, s41, s40
    s_add_u32 s41, s41, 15007744
    s_waitcnt lgkmcnt(0)
    buffer_store_dwordx4 v[192:195], v5, s[8:11], s41 offen sc1
    s_nop 1
    s_cmp_lg_u32 s34, 0
    s_cbranch_scc1 c_wj4_45
    s_mov_b32 s40, 128
    s_add_u32 s41, s40, 156672
    v_add_u32 v4, s41, v3
    ds_read_b64_tr_b16 v[192:193], v4
    ds_read_b64_tr_b16 v[194:195], v4 offset:2560
    s_mul_i32 s41, s2, 5120
    s_lshl_b32 s40, s40, 5
    s_add_u32 s41, s41, s40
    s_add_u32 s41, s41, 15007744
    s_waitcnt lgkmcnt(0)
    buffer_store_dwordx4 v[192:195], v5, s[8:11], s41 offen sc1
    s_nop 1
c_wj4_45:
c_wj3_44:
    s_cmp_lg_u32 s34, 0
    s_cbranch_scc1 c_pw_47
    ds_read_b128 v[108:111], v66 offset:0
    ds_read_b128 v[120:123], v67 offset:480
    ds_read_b128 v[124:127], v67 offset:992
    ds_read_b128 v[128:131], v67 offset:1504
    ds_read_b128 v[132:135], v67 offset:2016
    ds_read_b128 v[136:139], v67 offset:2528
    ds_read_b128 v[140:143], v67 offset:3040
    ds_read_b128 v[144:147], v67 offset:3552
    ds_read_b128 v[148:151], v67 offset:4064
    ds_read_b128 v[112:115], v66 offset:512
    ds_read_b128 v[116:119], v66 offset:1024
    s_waitcnt lgkmcnt(2)
    v_mfma_f32_16x16x32_bf16 v[104:107], v[108:111], v[148:151], 0
    v_mfma_f32_16x16x32_bf16 v[100:103], v[108:111], v[144:147], 0
    v_mfma_f32_16x16x32_bf16 v[96:99], v[108:111], v[140:143], 0
    v_mfma_f32_16x16x32_bf16 v[92:95], v[108:111], v[136:139], 0
    v_mfma_f32_16x16x32_bf16 v[88:91], v[108:111], v[132:135], 0
    v_mfma_f32_16x16x32_bf16 v[84:87], v[108:111], v[128:131], 0
    v_mfma_f32_16x16x32_bf16 v[80:83], v[108:111], v[124:127], 0
    v_mfma_f32_16x16x32_bf16 v[76:79], v[108:111], v[120:123], 0
    v_mfma_f32_16x16x32_bf16 v[76:79], v[196:199], v[120:123], v[76:79]
    v_mfma_f32_16x16x32_bf16 v[80:83], v[196:199], v[124:127], v[80:83]
    v_mfma_f32_16x16x32_bf16 v[84:87], v[196:199], v[128:131], v[84:87]
    v_mfma_f32_16x16x32_bf16 v[88:91], v[196:199], v[132:135], v[88:91]
    v_mfma_f32_16x16x32_bf16 v[92:95], v[196:199], v[136:139], v[92:95]
    v_mfma_f32_16x16x32_bf16 v[96:99], v[196:199], v[140:143], v[96:99]
    v_mfma_f32_16x16x32_bf16 v[100:103], v[196:199], v[144:147], v[100:103]
    v_mfma_f32_16x16x32_bf16 v[104:107], v[196:199], v[148:151], v[104:107]
    ds_read_b128 v[108:111], v66 offset:1536
    s_waitcnt lgkmcnt(2)
    v_mfma_f32_16x16x32_bf16 v[104:107], v[112:115], v[144:147], v[104:107]
    v_mfma_f32_16x16x32_bf16 v[100:103], v[112:115], v[140:143], v[100:103]
    v_mfma_f32_16x16x32_bf16 v[96:99], v[112:115], v[136:139], v[96:99]
    v_mfma_f32_16x16x32_bf16 v[92:95], v[112:115], v[132:135], v[92:95]
    v_mfma_f32_16x16x32_bf16 v[88:91], v[112:115], v[128:131], v[88:91]
    v_mfma_f32_16x16x32_bf16 v[84:87], v[112:115], v[124:127], v[84:87]
    v_mfma_f32_16x16x32_bf16 v[80:83], v[112:115], v[120:123], v[80:83]
    ds_read_b128 v[112:115], v66 offset:2048
    ds_read_b128 v[152:155], v67 offset:416
    ds_read_b128 v[156:159], v67 offset:928
    ds_read_b128 v[160:163], v67 offset:1440
    ds_read_b128 v[164:167], v67 offset:1952
    ds_read_b128 v[168:171], v67 offset:2464
    ds_read_b128 v[172:175], v67 offset:2976
    ds_read_b128 v[176:179], v67 offset:3488
    ds_read_b128 v[180:183], v67 offset:4000
    s_waitcnt lgkmcnt(10)
    v_mfma_f32_16x16x32_bf16 v[104:107], v[116:119], v[140:143], v[104:107]
    v_mfma_f32_16x16x32_bf16 v[100:103], v[116:119], v[136:139], v[100:103]
    v_mfma_f32_16x16x32_bf16 v[96:99], v[116:119], v[132:135], v[96:99]
    v_mfma_f32_16x16x32_bf16 v[92:95], v[116:119], v[128:131], v[92:95]
    v_mfma_f32_16x16x32_bf16 v[88:91], v[116:119], v[124:127], v[88:91]
    v_mfma_f32_16x16x32_bf16 v[84:87], v[116:119], v[120:123], v[84:87]
    ds_read_b128 v[116:119], v66 offset:2560
    s_waitcnt lgkmcnt(10)
    v_mfma_f32_16x16x32_bf16 v[104:107], v[108:111], v[136:139], v[104:107]
    v_mfma_f32_16x16x32_bf16 v[100:103], v[108:111], v[132:135], v[100:103]
    v_mfma_f32_16x16x32_bf16 v[96:99], v[108:111], v[128:131], v[96:99]
    v_mfma_f32_16x16x32_bf16 v[92:95], v[108:111], v[124:127], v[92:95]
    v_mfma_f32_16x16x32_bf16 v[88:91], v[108:111], v[120:123], v[88:91]
    ds_read_b128 v[108:111], v66 offset:3072
    s_waitcnt lgkmcnt(10)
    v_mfma_f32_16x16x32_bf16 v[104:107], v[112:115], v[132:135], v[104:107]
    v_mfma_f32_16x16x32_bf16 v[100:103], v[112:115], v[128:131], v[100:103]
    v_mfma_f32_16x16x32_bf16 v[96:99], v[112:115], v[124:127], v[96:99]
    v_mfma_f32_16x16x32_bf16 v[92:95], v[112:115], v[120:123], v[92:95]
    ds_read_b128 v[112:115], v66 offset:3584
    s_waitcnt lgkmcnt(2)
    v_mfma_f32_16x16x32_bf16 v[104:107], v[116:119], v[128:131], v[104:107]
    v_mfma_f32_16x16x32_bf16 v[100:103], v[116:119], v[124:127], v[100:103]
    v_mfma_f32_16x16x32_bf16 v[96:99], v[116:119], v[120:123], v[96:99]
    ds_read_b128 v[116:119], v66 offset:64
    s_waitcnt lgkmcnt(2)
    v_mfma_f32_16x16x32_bf16 v[104:107], v[108:111], v[124:127], v[104:107]
    v_mfma_f32_16x16x32_bf16 v[100:103], v[108:111], v[120:123], v[100:103]
    ds_read_b128 v[108:111], v66 offset:576
    s_waitcnt lgkmcnt(2)
    v_mfma_f32_16x16x32_bf16 v[104:107], v[112:115], v[120:123], v[104:107]
    ds_read_b128 v[112:115], v66 offset:1088
    s_waitcnt lgkmcnt(2)
    v_mfma_f32_16x16x32_bf16 v[104:107], v[116:119], v[180:183], v[104:107]
    v_mfma_f32_16x16x32_bf16 v[100:103], v[116:119], v[176:179], v[100:103]
    v_mfma_f32_16x16x32_bf16 v[96:99], v[116:119], v[172:175], v[96:99]
    v_mfma_f32_16x16x32_bf16 v[92:95], v[116:119], v[168:171], v[92:95]
    v_mfma_f32_16x16x32_bf16 v[88:91], v[116:119], v[164:167], v[88:91]
    v_mfma_f32_16x16x32_bf16 v[84:87], v[116:119], v[160:163], v[84:87]
    v_mfma_f32_16x16x32_bf16 v[80:83], v[116:119], v[156:159], v[80:83]
    v_mfma_f32_16x16x32_bf16 v[76:79], v[116:119], v[152:155], v[76:79]
    ds_read_b128 v[116:119], v66 offset:1600
    s_waitcnt lgkmcnt(2)
    v_mfma_f32_16x16x32_bf16 v[104:107], v[108:111], v[176:179], v[104:107]
    v_mfma_f32_16x16x32_bf16 v[100:103], v[108:111], v[172:175], v[100:103]
    v_mfma_f32_16x16x32_bf16 v[96:99], v[108:111], v[168:171], v[96:99]
    v_mfma_f32_16x16x32_bf16 v[92:95], v[108:111], v[164:167], v[92:95]
    v_mfma_f32_16x16x32_bf16 v[88:91], v[108:111], v[160:163], v[88:91]
    v_mfma_f32_16x16x32_bf16 v[84:87], v[108:111], v[156:159], v[84:87]
    v_mfma_f32_16x16x32_bf16 v[80:83], v[108:111], v[152:155], v[80:83]
    ds_read_b128 v[108:111], v66 offset:2112
    s_waitcnt lgkmcnt(2)
    v_mfma_f32_16x16x32_bf16 v[104:107], v[112:115], v[172:175], v[104:107]
    v_mfma_f32_16x16x32_bf16 v[100:103], v[112:115], v[168:171], v[100:103]
    v_mfma_f32_16x16x32_bf16 v[96:99], v[112:115], v[164:167], v[96:99]
    v_mfma_f32_16x16x32_bf16 v[92:95], v[112:115], v[160:163], v[92:95]
    v_mfma_f32_16x16x32_bf16 v[88:91], v[112:115], v[156:159], v[88:91]
    v_mfma_f32_16x16x32_bf16 v[84:87], v[112:115], v[152:155], v[84:87]
    ds_read_b128 v[112:115], v66 offset:2624
    s_waitcnt lgkmcnt(2)
    v_mfma_f32_16x16x32_bf16 v[104:107], v[116:119], v[168:171], v[104:107]
    v_mfma_f32_16x16x32_bf16 v[100:103], v[116:119], v[164:167], v[100:103]
    v_mfma_f32_16x16x32_bf16 v[96:99], v[116:119], v[160:163], v[96:99]
    v_mfma_f32_16x16x32_bf16 v[92:95], v[116:119], v[156:159], v[92:95]
    v_mfma_f32_16x16x32_bf16 v[88:91], v[116:119], v[152:155], v[88:91]
    ds_read_b128 v[116:119], v66 offset:3136
    s_waitcnt lgkmcnt(2)
    v_mfma_f32_16x16x32_bf16 v[104:107], v[108:111], v[164:167], v[104:107]
    v_mfma_f32_16x16x32_bf16 v[100:103], v[108:111], v[160:163], v[100:103]
    v_mfma_f32_16x16x32_bf16 v[96:99], v[108:111], v[156:159], v[96:99]
    v_mfma_f32_16x16x32_bf16 v[92:95], v[108:111], v[152:155], v[92:95]
    ds_read_b128 v[108:111], v66 offset:3648
    s_waitcnt lgkmcnt(2)
    v_mfma_f32_16x16x32_bf16 v[104:107], v[112:115], v[160:163], v[104:107]
    v_mfma_f32_16x16x32_bf16 v[100:103], v[112:115], v[156:159], v[100:103]
    v_mfma_f32_16x16x32_bf16 v[96:99], v[112:115], v[152:155], v[96:99]
    s_waitcnt lgkmcnt(1)
    v_mfma_f32_16x16x32_bf16 v[104:107], v[116:119], v[156:159], v[104:107]
    v_mfma_f32_16x16x32_bf16 v[100:103], v[116:119], v[152:155], v[100:103]
    s_waitcnt lgkmcnt(0)
    v_mfma_f32_16x16x32_bf16 v[104:107], v[108:111], v[152:155], v[104:107]
    ds_write_b128 v74, v[76:79] offset:0
    ds_write_b128 v74, v[80:83] offset:1024
    ds_write_b128 v74, v[84:87] offset:2048
    ds_write_b128 v74, v[88:91] offset:3072
    ds_write_b128 v74, v[92:95] offset:4096
    ds_write_b128 v74, v[96:99] offset:5120
    ds_write_b128 v74, v[100:103] offset:6144
    s_nop 0
    ds_write_b128 v74, v[104:107] offset:7168
    s_branch c_pw_end_46
c_pw_47:
    s_cmp_lg_u32 s34, 1
    s_cbranch_scc1 c_pw_48
    ds_read_b128 v[108:111], v66 offset:128
    ds_read_b128 v[120:123], v67 offset:352
    ds_read_b128 v[124:127], v67 offset:864
    ds_read_b128 v[128:131], v67 offset:1376
    ds_read_b128 v[132:135], v67 offset:1888
    ds_read_b128 v[136:139], v67 offset:2400
    ds_read_b128 v[140:143], v67 offset:2912
    ds_read_b128 v[144:147], v67 offset:3424
    ds_read_b128 v[148:151], v67 offset:3936
    ds_read_b128 v[112:115], v66 offset:640
    ds_read_b128 v[116:119], v66 offset:1152
    s_waitcnt lgkmcnt(2)
    v_mfma_f32_16x16x32_bf16 v[104:107], v[108:111], v[148:151], 0
    v_mfma_f32_16x16x32_bf16 v[100:103], v[108:111], v[144:147], 0
    v_mfma_f32_16x16x32_bf16 v[96:99], v[108:111], v[140:143], 0
    v_mfma_f32_16x16x32_bf16 v[92:95], v[108:111], v[136:139], 0
    v_mfma_f32_16x16x32_bf16 v[88:91], v[108:111], v[132:135], 0
    v_mfma_f32_16x16x32_bf16 v[84:87], v[108:111], v[128:131], 0
    v_mfma_f32_16x16x32_bf16 v[80:83], v[108:111], v[124:127], 0
    v_mfma_f32_16x16x32_bf16 v[76:79], v[108:111], v[120:123], 0
    ds_read_b128 v[108:111], v66 offset:1664
    s_waitcnt lgkmcnt(2)
    v_mfma_f32_16x16x32_bf16 v[104:107], v[112:115], v[144:147], v[104:107]
    v_mfma_f32_16x16x32_bf16 v[100:103], v[112:115], v[140:143], v[100:103]
    v_mfma_f32_16x16x32_bf16 v[96:99], v[112:115], v[136:139], v[96:99]
    v_mfma_f32_16x16x32_bf16 v[92:95], v[112:115], v[132:135], v[92:95]
    v_mfma_f32_16x16x32_bf16 v[88:91], v[112:115], v[128:131], v[88:91]
    v_mfma_f32_16x16x32_bf16 v[84:87], v[112:115], v[124:127], v[84:87]
    v_mfma_f32_16x16x32_bf16 v[80:83], v[112:115], v[120:123], v[80:83]
    ds_read_b128 v[112:115], v66 offset:2176
    ds_read_b128 v[152:155], v67 offset:288
    ds_read_b128 v[156:159], v67 offset:800
    ds_read_b128 v[160:163], v67 offset:1312
    ds_read_b128 v[164:167], v67 offset:1824
    ds_read_b128 v[168:171], v67 offset:2336
    ds_read_b128 v[172:175], v67 offset:2848
    ds_read_b128 v[176:179], v67 offset:3360
    ds_read_b128 v[180:183], v67 offset:3872
    s_waitcnt lgkmcnt(10)
    v_mfma_f32_16x16x32_bf16 v[104:107], v[116:119], v[140:143], v[104:107]
    v_mfma_f32_16x16x32_bf16 v[100:103], v[116:119], v[136:139], v[100:103]
    v_mfma_f32_16x16x32_bf16 v[96:99], v[116:119], v[132:135], v[96:99]
    v_mfma_f32_16x16x32_bf16 v[92:95], v[116:119], v[128:131], v[92:95]
    v_mfma_f32_16x16x32_bf16 v[88:91], v[116:119], v[124:127], v[88:91]
    v_mfma_f32_16x16x32_bf16 v[84:87], v[116:119], v[120:123], v[84:87]
    ds_read_b128 v[116:119], v66 offset:2688
    s_waitcnt lgkmcnt(10)
    v_mfma_f32_16x16x32_bf16 v[104:107], v[108:111], v[136:139], v[104:107]
    v_mfma_f32_16x16x32_bf16 v[100:103], v[108:111], v[132:135], v[100:103]
    v_mfma_f32_16x16x32_bf16 v[96:99], v[108:111], v[128:131], v[96:99]
    v_mfma_f32_16x16x32_bf16 v[92:95], v[108:111], v[124:127], v[92:95]
    v_mfma_f32_16x16x32_bf16 v[88:91], v[108:111], v[120:123], v[88:91]
    ds_read_b128 v[108:111], v66 offset:3200
    s_waitcnt lgkmcnt(10)
    v_mfma_f32_16x16x32_bf16 v[104:107], v[112:115], v[132:135], v[104:107]
    v_mfma_f32_16x16x32_bf16 v[100:103], v[112:115], v[128:131], v[100:103]
    v_mfma_f32_16x16x32_bf16 v[96:99], v[112:115], v[124:127], v[96:99]
    v_mfma_f32_16x16x32_bf16 v[92:95], v[112:115], v[120:123], v[92:95]
    ds_read_b128 v[112:115], v66 offset:3712
    s_waitcnt lgkmcnt(2)
    v_mfma_f32_16x16x32_bf16 v[104:107], v[116:119], v[128:131], v[104:107]
    v_mfma_f32_16x16x32_bf16 v[100:103], v[116:119], v[124:127], v[100:103]
    v_mfma_f32_16x16x32_bf16 v[96:99], v[116:119], v[120:123], v[96:99]
    ds_read_b128 v[116:119], v66 offset:192
    s_waitcnt lgkmcnt(2)
    v_mfma_f32_16x16x32_bf16 v[104:107], v[108:111], v[124:127], v[104:107]
    v_mfma_f32_16x16x32_bf16 v[100:103], v[108:111], v[120:123], v[100:103]
    ds_read_b128 v[108:111], v66 offset:704
    s_waitcnt lgkmcnt(2)
    v_mfma_f32_16x16x32_bf16 v[104:107], v[112:115], v[120:123], v[104:107]
    ds_read_b128 v[112:115], v66 offset:1216
    s_waitcnt lgkmcnt(2)
    v_mfma_f32_16x16x32_bf16 v[104:107], v[116:119], v[180:183], v[104:107]
    v_mfma_f32_16x16x32_bf16 v[100:103], v[116:119], v[176:179], v[100:103]
    v_mfma_f32_16x16x32_bf16 v[96:99], v[116:119], v[172:175], v[96:99]
    v_mfma_f32_16x16x32_bf16 v[92:95], v[116:119], v[168:171], v[92:95]
    v_mfma_f32_16x16x32_bf16 v[88:91], v[116:119], v[164:167], v[88:91]
    v_mfma_f32_16x16x32_bf16 v[84:87], v[116:119], v[160:163], v[84:87]
    v_mfma_f32_16x16x32_bf16 v[80:83], v[116:119], v[156:159], v[80:83]
    v_mfma_f32_16x16x32_bf16 v[76:79], v[116:119], v[152:155], v[76:79]
    ds_read_b128 v[116:119], v66 offset:1728
    s_waitcnt lgkmcnt(2)
    v_mfma_f32_16x16x32_bf16 v[104:107], v[108:111], v[176:179], v[104:107]
    v_mfma_f32_16x16x32_bf16 v[100:103], v[108:111], v[172:175], v[100:103]
    v_mfma_f32_16x16x32_bf16 v[96:99], v[108:111], v[168:171], v[96:99]
    v_mfma_f32_16x16x32_bf16 v[92:95], v[108:111], v[164:167], v[92:95]
    v_mfma_f32_16x16x32_bf16 v[88:91], v[108:111], v[160:163], v[88:91]
    v_mfma_f32_16x16x32_bf16 v[84:87], v[108:111], v[156:159], v[84:87]
    v_mfma_f32_16x16x32_bf16 v[80:83], v[108:111], v[152:155], v[80:83]
    ds_read_b128 v[108:111], v66 offset:2240
    s_waitcnt lgkmcnt(2)
    v_mfma_f32_16x16x32_bf16 v[104:107], v[112:115], v[172:175], v[104:107]
    v_mfma_f32_16x16x32_bf16 v[100:103], v[112:115], v[168:171], v[100:103]
    v_mfma_f32_16x16x32_bf16 v[96:99], v[112:115], v[164:167], v[96:99]
    v_mfma_f32_16x16x32_bf16 v[92:95], v[112:115], v[160:163], v[92:95]
    v_mfma_f32_16x16x32_bf16 v[88:91], v[112:115], v[156:159], v[88:91]
    v_mfma_f32_16x16x32_bf16 v[84:87], v[112:115], v[152:155], v[84:87]
    ds_read_b128 v[112:115], v66 offset:2752
    s_waitcnt lgkmcnt(2)
    v_mfma_f32_16x16x32_bf16 v[104:107], v[116:119], v[168:171], v[104:107]
    v_mfma_f32_16x16x32_bf16 v[100:103], v[116:119], v[164:167], v[100:103]
    v_mfma_f32_16x16x32_bf16 v[96:99], v[116:119], v[160:163], v[96:99]
    v_mfma_f32_16x16x32_bf16 v[92:95], v[116:119], v[156:159], v[92:95]
    v_mfma_f32_16x16x32_bf16 v[88:91], v[116:119], v[152:155], v[88:91]
    ds_read_b128 v[116:119], v66 offset:3264
    s_waitcnt lgkmcnt(2)
    v_mfma_f32_16x16x32_bf16 v[104:107], v[108:111], v[164:167], v[104:107]
    v_mfma_f32_16x16x32_bf16 v[100:103], v[108:111], v[160:163], v[100:103]
    v_mfma_f32_16x16x32_bf16 v[96:99], v[108:111], v[156:159], v[96:99]
    v_mfma_f32_16x16x32_bf16 v[92:95], v[108:111], v[152:155], v[92:95]
    ds_read_b128 v[108:111], v66 offset:3776
    s_waitcnt lgkmcnt(2)
    v_mfma_f32_16x16x32_bf16 v[104:107], v[112:115], v[160:163], v[104:107]
    v_mfma_f32_16x16x32_bf16 v[100:103], v[112:115], v[156:159], v[100:103]
    v_mfma_f32_16x16x32_bf16 v[96:99], v[112:115], v[152:155], v[96:99]
    s_waitcnt lgkmcnt(1)
    v_mfma_f32_16x16x32_bf16 v[104:107], v[116:119], v[156:159], v[104:107]
    v_mfma_f32_16x16x32_bf16 v[100:103], v[116:119], v[152:155], v[100:103]
    s_waitcnt lgkmcnt(0)
    v_mfma_f32_16x16x32_bf16 v[104:107], v[108:111], v[152:155], v[104:107]
    ds_write_b128 v74, v[76:79] offset:0
    ds_write_b128 v74, v[80:83] offset:1024
    ds_write_b128 v74, v[84:87] offset:2048
    ds_write_b128 v74, v[88:91] offset:3072
    ds_write_b128 v74, v[92:95] offset:4096
    ds_write_b128 v74, v[96:99] offset:5120
    ds_write_b128 v74, v[100:103] offset:6144
    s_nop 0
    ds_write_b128 v74, v[104:107] offset:7168
    s_branch c_pw_end_46
c_pw_48:
    s_cmp_lg_u32 s34, 2
    s_cbranch_scc1 c_pw_49
    ds_read_b128 v[108:111], v66 offset:256
    ds_read_b128 v[120:123], v67 offset:224
    ds_read_b128 v[124:127], v67 offset:736
    ds_read_b128 v[128:131], v67 offset:1248
    ds_read_b128 v[132:135], v67 offset:1760
    ds_read_b128 v[136:139], v67 offset:2272
    ds_read_b128 v[140:143], v67 offset:2784
    ds_read_b128 v[144:147], v67 offset:3296
    ds_read_b128 v[148:151], v67 offset:3808
    ds_read_b128 v[112:115], v66 offset:768
    ds_read_b128 v[116:119], v66 offset:1280
    s_waitcnt lgkmcnt(2)
    v_mfma_f32_16x16x32_bf16 v[104:107], v[108:111], v[148:151], 0
    v_mfma_f32_16x16x32_bf16 v[100:103], v[108:111], v[144:147], 0
    v_mfma_f32_16x16x32_bf16 v[96:99], v[108:111], v[140:143], 0
    v_mfma_f32_16x16x32_bf16 v[92:95], v[108:111], v[136:139], 0
    v_mfma_f32_16x16x32_bf16 v[88:91], v[108:111], v[132:135], 0
    v_mfma_f32_16x16x32_bf16 v[84:87], v[108:111], v[128:131], 0
    v_mfma_f32_16x16x32_bf16 v[80:83], v[108:111], v[124:127], 0
    v_mfma_f32_16x16x32_bf16 v[76:79], v[108:111], v[120:123], 0
    ds_read_b128 v[108:111], v66 offset:1792
    s_waitcnt lgkmcnt(2)
    v_mfma_f32_16x16x32_bf16 v[104:107], v[112:115], v[144:147], v[104:107]
    v_mfma_f32_16x16x32_bf16 v[100:103], v[112:115], v[140:143], v[100:103]
    v_mfma_f32_16x16x32_bf16 v[96:99], v[112:115], v[136:139], v[96:99]
    v_mfma_f32_16x16x32_bf16 v[92:95], v[112:115], v[132:135], v[92:95]
    v_mfma_f32_16x16x32_bf16 v[88:91], v[112:115], v[128:131], v[88:91]
    v_mfma_f32_16x16x32_bf16 v[84:87], v[112:115], v[124:127], v[84:87]
    v_mfma_f32_16x16x32_bf16 v[80:83], v[112:115], v[120:123], v[80:83]
    ds_read_b128 v[112:115], v66 offset:2304
    ds_read_b128 v[152:155], v67 offset:160
    ds_read_b128 v[156:159], v67 offset:672
    ds_read_b128 v[160:163], v67 offset:1184
    ds_read_b128 v[164:167], v67 offset:1696
    ds_read_b128 v[168:171], v67 offset:2208
    ds_read_b128 v[172:175], v67 offset:2720
    ds_read_b128 v[176:179], v67 offset:3232
    ds_read_b128 v[180:183], v67 offset:3744
    s_waitcnt lgkmcnt(10)
    v_mfma_f32_16x16x32_bf16 v[104:107], v[116:119], v[140:143], v[104:107]
    v_mfma_f32_16x16x32_bf16 v[100:103], v[116:119], v[136:139], v[100:103]
    v_mfma_f32_16x16x32_bf16 v[96:99], v[116:119], v[132:135], v[96:99]
    v_mfma_f32_16x16x32_bf16 v[92:95], v[116:119], v[128:131], v[92:95]
    v_mfma_f32_16x16x32_bf16 v[88:91], v[116:119], v[124:127], v[88:91]
    v_mfma_f32_16x16x32_bf16 v[84:87], v[116:119], v[120:123], v[84:87]
    ds_read_b128 v[116:119], v66 offset:2816
    s_waitcnt lgkmcnt(10)
    v_mfma_f32_16x16x32_bf16 v[104:107], v[108:111], v[136:139], v[104:107]
    v_mfma_f32_16x16x32_bf16 v[100:103], v[108:111], v[132:135], v[100:103]
    v_mfma_f32_16x16x32_bf16 v[96:99], v[108:111], v[128:131], v[96:99]
    v_mfma_f32_16x16x32_bf16 v[92:95], v[108:111], v[124:127], v[92:95]
    v_mfma_f32_16x16x32_bf16 v[88:91], v[108:111], v[120:123], v[88:91]
    ds_read_b128 v[108:111], v66 offset:3328
    s_waitcnt lgkmcnt(10)
    v_mfma_f32_16x16x32_bf16 v[104:107], v[112:115], v[132:135], v[104:107]
    v_mfma_f32_16x16x32_bf16 v[100:103], v[112:115], v[128:131], v[100:103]
    v_mfma_f32_16x16x32_bf16 v[96:99], v[112:115], v[124:127], v[96:99]
    v_mfma_f32_16x16x32_bf16 v[92:95], v[112:115], v[120:123], v[92:95]
    ds_read_b128 v[112:115], v66 offset:3840
    s_waitcnt lgkmcnt(2)
    v_mfma_f32_16x16x32_bf16 v[104:107], v[116:119], v[128:131], v[104:107]
    v_mfma_f32_16x16x32_bf16 v[100:103], v[116:119], v[124:127], v[100:103]
    v_mfma_f32_16x16x32_bf16 v[96:99], v[116:119], v[120:123], v[96:99]
    ds_read_b128 v[116:119], v66 offset:320
    s_waitcnt lgkmcnt(2)
    v_mfma_f32_16x16x32_bf16 v[104:107], v[108:111], v[124:127], v[104:107]
    v_mfma_f32_16x16x32_bf16 v[100:103], v[108:111], v[120:123], v[100:103]
    ds_read_b128 v[108:111], v66 offset:832
    s_waitcnt lgkmcnt(2)
    v_mfma_f32_16x16x32_bf16 v[104:107], v[112:115], v[120:123], v[104:107]
    ds_read_b128 v[112:115], v66 offset:1344
    s_waitcnt lgkmcnt(2)
    v_mfma_f32_16x16x32_bf16 v[104:107], v[116:119], v[180:183], v[104:107]
    v_mfma_f32_16x16x32_bf16 v[100:103], v[116:119], v[176:179], v[100:103]
    v_mfma_f32_16x16x32_bf16 v[96:99], v[116:119], v[172:175], v[96:99]
    v_mfma_f32_16x16x32_bf16 v[92:95], v[116:119], v[168:171], v[92:95]
    v_mfma_f32_16x16x32_bf16 v[88:91], v[116:119], v[164:167], v[88:91]
    v_mfma_f32_16x16x32_bf16 v[84:87], v[116:119], v[160:163], v[84:87]
    v_mfma_f32_16x16x32_bf16 v[80:83], v[116:119], v[156:159], v[80:83]
    v_mfma_f32_16x16x32_bf16 v[76:79], v[116:119], v[152:155], v[76:79]
    ds_read_b128 v[116:119], v66 offset:1856
    s_waitcnt lgkmcnt(2)
    v_mfma_f32_16x16x32_bf16 v[104:107], v[108:111], v[176:179], v[104:107]
    v_mfma_f32_16x16x32_bf16 v[100:103], v[108:111], v[172:175], v[100:103]
    v_mfma_f32_16x16x32_bf16 v[96:99], v[108:111], v[168:171], v[96:99]
    v_mfma_f32_16x16x32_bf16 v[92:95], v[108:111], v[164:167], v[92:95]
    v_mfma_f32_16x16x32_bf16 v[88:91], v[108:111], v[160:163], v[88:91]
    v_mfma_f32_16x16x32_bf16 v[84:87], v[108:111], v[156:159], v[84:87]
    v_mfma_f32_16x16x32_bf16 v[80:83], v[108:111], v[152:155], v[80:83]
    ds_read_b128 v[108:111], v66 offset:2368
    s_waitcnt lgkmcnt(2)
    v_mfma_f32_16x16x32_bf16 v[104:107], v[112:115], v[172:175], v[104:107]
    v_mfma_f32_16x16x32_bf16 v[100:103], v[112:115], v[168:171], v[100:103]
    v_mfma_f32_16x16x32_bf16 v[96:99], v[112:115], v[164:167], v[96:99]
    v_mfma_f32_16x16x32_bf16 v[92:95], v[112:115], v[160:163], v[92:95]
    v_mfma_f32_16x16x32_bf16 v[88:91], v[112:115], v[156:159], v[88:91]
    v_mfma_f32_16x16x32_bf16 v[84:87], v[112:115], v[152:155], v[84:87]
    ds_read_b128 v[112:115], v66 offset:2880
    s_waitcnt lgkmcnt(2)
    v_mfma_f32_16x16x32_bf16 v[104:107], v[116:119], v[168:171], v[104:107]
    v_mfma_f32_16x16x32_bf16 v[100:103], v[116:119], v[164:167], v[100:103]
    v_mfma_f32_16x16x32_bf16 v[96:99], v[116:119], v[160:163], v[96:99]
    v_mfma_f32_16x16x32_bf16 v[92:95], v[116:119], v[156:159], v[92:95]
    v_mfma_f32_16x16x32_bf16 v[88:91], v[116:119], v[152:155], v[88:91]
    ds_read_b128 v[116:119], v66 offset:3392
    s_waitcnt lgkmcnt(2)
    v_mfma_f32_16x16x32_bf16 v[104:107], v[108:111], v[164:167], v[104:107]
    v_mfma_f32_16x16x32_bf16 v[100:103], v[108:111], v[160:163], v[100:103]
    v_mfma_f32_16x16x32_bf16 v[96:99], v[108:111], v[156:159], v[96:99]
    v_mfma_f32_16x16x32_bf16 v[92:95], v[108:111], v[152:155], v[92:95]
    ds_read_b128 v[108:111], v66 offset:3904
    s_waitcnt lgkmcnt(2)
    v_mfma_f32_16x16x32_bf16 v[104:107], v[112:115], v[160:163], v[104:107]
    v_mfma_f32_16x16x32_bf16 v[100:103], v[112:115], v[156:159], v[100:103]
    v_mfma_f32_16x16x32_bf16 v[96:99], v[112:115], v[152:155], v[96:99]
    s_waitcnt lgkmcnt(1)
    v_mfma_f32_16x16x32_bf16 v[104:107], v[116:119], v[156:159], v[104:107]
    v_mfma_f32_16x16x32_bf16 v[100:103], v[116:119], v[152:155], v[100:103]
    s_waitcnt lgkmcnt(0)
    v_mfma_f32_16x16x32_bf16 v[104:107], v[108:111], v[152:155], v[104:107]
    ds_write_b128 v74, v[76:79] offset:0
    ds_write_b128 v74, v[80:83] offset:1024
    ds_write_b128 v74, v[84:87] offset:2048
    ds_write_b128 v74, v[88:91] offset:3072
    ds_write_b128 v74, v[92:95] offset:4096
    ds_write_b128 v74, v[96:99] offset:5120
    ds_write_b128 v74, v[100:103] offset:6144
    s_nop 0
    ds_write_b128 v74, v[104:107] offset:7168
    s_branch c_pw_end_46
c_pw_49:
    ds_read_b128 v[108:111], v66 offset:384
    ds_read_b128 v[120:123], v67 offset:96
    ds_read_b128 v[124:127], v67 offset:608
    ds_read_b128 v[128:131], v67 offset:1120
    ds_read_b128 v[132:135], v67 offset:1632
    ds_read_b128 v[136:139], v67 offset:2144
    ds_read_b128 v[140:143], v67 offset:2656
    ds_read_b128 v[144:147], v67 offset:3168
    ds_read_b128 v[148:151], v67 offset:3680
    ds_read_b128 v[112:115], v66 offset:896
    ds_read_b128 v[116:119], v66 offset:1408
    s_waitcnt lgkmcnt(2)
    v_mfma_f32_16x16x32_bf16 v[104:107], v[108:111], v[148:151], 0
    v_mfma_f32_16x16x32_bf16 v[100:103], v[108:111], v[144:147], 0
    v_mfma_f32_16x16x32_bf16 v[96:99], v[108:111], v[140:143], 0
    v_mfma_f32_16x16x32_bf16 v[92:95], v[108:111], v[136:139], 0
    v_mfma_f32_16x16x32_bf16 v[88:91], v[108:111], v[132:135], 0
    v_mfma_f32_16x16x32_bf16 v[84:87], v[108:111], v[128:131], 0
    v_mfma_f32_16x16x32_bf16 v[80:83], v[108:111], v[124:127], 0
    v_mfma_f32_16x16x32_bf16 v[76:79], v[108:111], v[120:123], 0
    ds_read_b128 v[108:111], v66 offset:1920
    s_waitcnt lgkmcnt(2)
    v_mfma_f32_16x16x32_bf16 v[104:107], v[112:115], v[144:147], v[104:107]
    v_mfma_f32_16x16x32_bf16 v[100:103], v[112:115], v[140:143], v[100:103]
    v_mfma_f32_16x16x32_bf16 v[96:99], v[112:115], v[136:139], v[96:99]
    v_mfma_f32_16x16x32_bf16 v[92:95], v[112:115], v[132:135], v[92:95]
    v_mfma_f32_16x16x32_bf16 v[88:91], v[112:115], v[128:131], v[88:91]
    v_mfma_f32_16x16x32_bf16 v[84:87], v[112:115], v[124:127], v[84:87]
    v_mfma_f32_16x16x32_bf16 v[80:83], v[112:115], v[120:123], v[80:83]
    ds_read_b128 v[112:115], v66 offset:2432
    ds_read_b128 v[152:155], v67 offset:32
    ds_read_b128 v[156:159], v67 offset:544
    ds_read_b128 v[160:163], v67 offset:1056
    ds_read_b128 v[164:167], v67 offset:1568
    ds_read_b128 v[168:171], v67 offset:2080
    ds_read_b128 v[172:175], v67 offset:2592
    ds_read_b128 v[176:179], v67 offset:3104
    ds_read_b128 v[180:183], v67 offset:3616
    s_waitcnt lgkmcnt(10)
    v_mfma_f32_16x16x32_bf16 v[104:107], v[116:119], v[140:143], v[104:107]
    v_mfma_f32_16x16x32_bf16 v[100:103], v[116:119], v[136:139], v[100:103]
    v_mfma_f32_16x16x32_bf16 v[96:99], v[116:119], v[132:135], v[96:99]
    v_mfma_f32_16x16x32_bf16 v[92:95], v[116:119], v[128:131], v[92:95]
    v_mfma_f32_16x16x32_bf16 v[88:91], v[116:119], v[124:127], v[88:91]
    v_mfma_f32_16x16x32_bf16 v[84:87], v[116:119], v[120:123], v[84:87]
    ds_read_b128 v[116:119], v66 offset:2944
    s_waitcnt lgkmcnt(10)
    v_mfma_f32_16x16x32_bf16 v[104:107], v[108:111], v[136:139], v[104:107]
    v_mfma_f32_16x16x32_bf16 v[100:103], v[108:111], v[132:135], v[100:103]
    v_mfma_f32_16x16x32_bf16 v[96:99], v[108:111], v[128:131], v[96:99]
    v_mfma_f32_16x16x32_bf16 v[92:95], v[108:111], v[124:127], v[92:95]
    v_mfma_f32_16x16x32_bf16 v[88:91], v[108:111], v[120:123], v[88:91]
    ds_read_b128 v[108:111], v66 offset:3456
    s_waitcnt lgkmcnt(10)
    v_mfma_f32_16x16x32_bf16 v[104:107], v[112:115], v[132:135], v[104:107]
    v_mfma_f32_16x16x32_bf16 v[100:103], v[112:115], v[128:131], v[100:103]
    v_mfma_f32_16x16x32_bf16 v[96:99], v[112:115], v[124:127], v[96:99]
    v_mfma_f32_16x16x32_bf16 v[92:95], v[112:115], v[120:123], v[92:95]
    ds_read_b128 v[112:115], v66 offset:3968
    s_waitcnt lgkmcnt(2)
    v_mfma_f32_16x16x32_bf16 v[104:107], v[116:119], v[128:131], v[104:107]
    v_mfma_f32_16x16x32_bf16 v[100:103], v[116:119], v[124:127], v[100:103]
    v_mfma_f32_16x16x32_bf16 v[96:99], v[116:119], v[120:123], v[96:99]
    ds_read_b128 v[116:119], v66 offset:448
    s_waitcnt lgkmcnt(2)
    v_mfma_f32_16x16x32_bf16 v[104:107], v[108:111], v[124:127], v[104:107]
    v_mfma_f32_16x16x32_bf16 v[100:103], v[108:111], v[120:123], v[100:103]
    ds_read_b128 v[108:111], v66 offset:960
    s_waitcnt lgkmcnt(2)
    v_mfma_f32_16x16x32_bf16 v[104:107], v[112:115], v[120:123], v[104:107]
    ds_read_b128 v[112:115], v66 offset:1472
    s_waitcnt lgkmcnt(2)
    v_mfma_f32_16x16x32_bf16 v[104:107], v[116:119], v[180:183], v[104:107]
    v_mfma_f32_16x16x32_bf16 v[100:103], v[116:119], v[176:179], v[100:103]
    v_mfma_f32_16x16x32_bf16 v[96:99], v[116:119], v[172:175], v[96:99]
    v_mfma_f32_16x16x32_bf16 v[92:95], v[116:119], v[168:171], v[92:95]
    v_mfma_f32_16x16x32_bf16 v[88:91], v[116:119], v[164:167], v[88:91]
    v_mfma_f32_16x16x32_bf16 v[84:87], v[116:119], v[160:163], v[84:87]
    v_mfma_f32_16x16x32_bf16 v[80:83], v[116:119], v[156:159], v[80:83]
    v_mfma_f32_16x16x32_bf16 v[76:79], v[116:119], v[152:155], v[76:79]
    ds_read_b128 v[116:119], v66 offset:1984
    s_waitcnt lgkmcnt(2)
    v_mfma_f32_16x16x32_bf16 v[104:107], v[108:111], v[176:179], v[104:107]
    v_mfma_f32_16x16x32_bf16 v[100:103], v[108:111], v[172:175], v[100:103]
    v_mfma_f32_16x16x32_bf16 v[96:99], v[108:111], v[168:171], v[96:99]
    v_mfma_f32_16x16x32_bf16 v[92:95], v[108:111], v[164:167], v[92:95]
    v_mfma_f32_16x16x32_bf16 v[88:91], v[108:111], v[160:163], v[88:91]
    v_mfma_f32_16x16x32_bf16 v[84:87], v[108:111], v[156:159], v[84:87]
    v_mfma_f32_16x16x32_bf16 v[80:83], v[108:111], v[152:155], v[80:83]
    ds_read_b128 v[108:111], v66 offset:2496
    s_waitcnt lgkmcnt(2)
    v_mfma_f32_16x16x32_bf16 v[104:107], v[112:115], v[172:175], v[104:107]
    v_mfma_f32_16x16x32_bf16 v[100:103], v[112:115], v[168:171], v[100:103]
    v_mfma_f32_16x16x32_bf16 v[96:99], v[112:115], v[164:167], v[96:99]
    v_mfma_f32_16x16x32_bf16 v[92:95], v[112:115], v[160:163], v[92:95]
    v_mfma_f32_16x16x32_bf16 v[88:91], v[112:115], v[156:159], v[88:91]
    v_mfma_f32_16x16x32_bf16 v[84:87], v[112:115], v[152:155], v[84:87]
    ds_read_b128 v[112:115], v66 offset:3008
    s_waitcnt lgkmcnt(2)
    v_mfma_f32_16x16x32_bf16 v[104:107], v[116:119], v[168:171], v[104:107]
    v_mfma_f32_16x16x32_bf16 v[100:103], v[116:119], v[164:167], v[100:103]
    v_mfma_f32_16x16x32_bf16 v[96:99], v[116:119], v[160:163], v[96:99]
    v_mfma_f32_16x16x32_bf16 v[92:95], v[116:119], v[156:159], v[92:95]
    v_mfma_f32_16x16x32_bf16 v[88:91], v[116:119], v[152:155], v[88:91]
    ds_read_b128 v[116:119], v66 offset:3520
    s_waitcnt lgkmcnt(2)
    v_mfma_f32_16x16x32_bf16 v[104:107], v[108:111], v[164:167], v[104:107]
    v_mfma_f32_16x16x32_bf16 v[100:103], v[108:111], v[160:163], v[100:103]
    v_mfma_f32_16x16x32_bf16 v[96:99], v[108:111], v[156:159], v[96:99]
    v_mfma_f32_16x16x32_bf16 v[92:95], v[108:111], v[152:155], v[92:95]
    ds_read_b128 v[108:111], v66 offset:4032
    s_waitcnt lgkmcnt(2)
    v_mfma_f32_16x16x32_bf16 v[104:107], v[112:115], v[160:163], v[104:107]
    v_mfma_f32_16x16x32_bf16 v[100:103], v[112:115], v[156:159], v[100:103]
    v_mfma_f32_16x16x32_bf16 v[96:99], v[112:115], v[152:155], v[96:99]
    s_waitcnt lgkmcnt(1)
    v_mfma_f32_16x16x32_bf16 v[104:107], v[116:119], v[156:159], v[104:107]
    v_mfma_f32_16x16x32_bf16 v[100:103], v[116:119], v[152:155], v[100:103]
    s_waitcnt lgkmcnt(0)
    v_mfma_f32_16x16x32_bf16 v[104:107], v[108:111], v[152:155], v[104:107]
    ds_write_b128 v74, v[76:79] offset:0
    ds_write_b128 v74, v[80:83] offset:1024
    ds_write_b128 v74, v[84:87] offset:2048
    ds_write_b128 v74, v[88:91] offset:3072
    ds_write_b128 v74, v[92:95] offset:4096
    ds_write_b128 v74, v[96:99] offset:5120
    ds_write_b128 v74, v[100:103] offset:6144
    s_nop 0
    ds_write_b128 v74, v[104:107] offset:7168
c_pw_end_46:
    s_waitcnt vmcnt(0)
    s_waitcnt lgkmcnt(0)
    v_mov_b32 v3, 161796
    v_mov_b32 v4, 1
    s_mov_b64 exec, 1
    ds_add_u32 v3, v4
    s_mov_b64 exec, -1
    s_mov_b32 s67, 0
gsync_51:
    ds_read_b32 v4, v3
    s_add_u32 s67, s67, 1
    s_waitcnt lgkmcnt(0)
    v_readfirstlane_b32 s66, v4
    s_cmp_gt_u32 s67, 1000000
    s_cbranch_scc1 gsync_e_52
    s_cmp_lt_u32 s66, 16
    s_cbranch_scc1 gsync_51
gsync_e_52:
    s_lshl_b32 s40, s2, 3
    s_add_u32 s40, s40, 14725120
    v_mov_b32 v48, s100
    v_mov_b32 v49, s101
    v_mov_b32 v3, 0
    s_cmp_eq_u32 s34, 0
    s_cselect_b64 exec, 1, 0
    s_cmp_lt_u32 s2, 192
    s_cselect_b64 exec, exec, 0
    buffer_store_dwordx2 v[48:49], v3, s[8:11], s40 offen sc1
    s_mov_b64 exec, -1
    ds_read_b128 v[120:123], v75 offset:0
    ds_read_b128 v[124:127], v75 offset:16
    ds_read_b128 v[128:131], v75 offset:8192
    ds_read_b128 v[132:135], v75 offset:8208
    ds_read_b128 v[136:139], v75 offset:16384
    ds_read_b128 v[140:143], v75 offset:16400
    ds_read_b128 v[144:147], v75 offset:24576
    ds_read_b128 v[148:151], v75 offset:24592
    s_lshl_b32 s40, s57, 12
    s_add_u32 s40, s40, 8912896
    s_waitcnt lgkmcnt(0)
    v_pk_add_f32 v[120:121], v[120:121], v[128:129]
    v_pk_add_f32 v[136:137], v[136:137], v[144:145]
    v_pk_add_f32 v[122:123], v[122:123], v[130:131]
    v_pk_add_f32 v[138:139], v[138:139], v[146:147]
    v_pk_add_f32 v[124:125], v[124:125], v[132:133]
    v_pk_add_f32 v[140:141], v[140:141], v[148:149]
    v_pk_add_f32 v[126:127], v[126:127], v[134:135]
    v_pk_add_f32 v[142:143], v[142:143], v[150:151]
    v_pk_add_f32 v[120:121], v[120:121], v[136:137]
    v_pk_add_f32 v[122:123], v[122:123], v[138:139]
    v_pk_add_f32 v[124:125], v[124:125], v[140:141]
    v_pk_add_f32 v[126:127], v[126:127], v[142:143]
    v_cvt_pk_bf16_f32 v192, v120, v121
    v_cvt_pk_bf16_f32 v193, v122, v123
    v_cvt_pk_bf16_f32 v194, v124, v125
    v_cvt_pk_bf16_f32 v195, v126, v127
    buffer_store_dwordx4 v[192:195], v2, s[8:11], s40 offen sc1
    s_nop 1
    s_waitcnt vmcnt(0)
    v_cmp_ne_u32 vcc, 0, v0
    s_nop 1
    v_cndmask_b32 v24, 0, v24, vcc
    v_cndmask_b32 v25, 0, v25, vcc
    v_cndmask_b32 v26, 0, v26, vcc
    v_cndmask_b32 v27, 0, v27, vcc
    v_alignbit_b32 v184, v25, v24, 16
    v_alignbit_b32 v185, v26, v25, 16
    v_alignbit_b32 v186, v27, v26, 16
    v_alignbit_b32 v187, v28, v27, 16
    v_alignbit_b32 v188, v29, v28, 16
    v_alignbit_b32 v189, v30, v29, 16
    v_alignbit_b32 v190, v31, v30, 16
    ds_write_b128 v64, v[184:187] offset:0
    v_mov_b32 v192, v25
    v_mov_b32 v193, v26
    v_mov_b32 v194, v27
    v_mov_b32 v195, v28
    ds_write_b128 v64, v[192:195] offset:4160
    s_nop 1
    v_mov_b32 v192, v185
    v_mov_b32 v193, v186
    v_mov_b32 v194, v187
    v_mov_b32 v195, v188
    ds_write_b128 v64, v[192:195] offset:8320
    s_nop 1
    ds_write_b128 v64, v[26:29] offset:12480
    ds_write_b128 v64, v[186:189] offset:16640
    v_mov_b32 v192, v27
    v_mov_b32 v193, v28
    v_mov_b32 v194, v29
    v_mov_b32 v195, v30
    ds_write_b128 v64, v[192:195] offset:20800
    s_nop 1
    v_mov_b32 v192, v187
    v_mov_b32 v193, v188
    v_mov_b32 v194, v189
    v_mov_b32 v195, v190
    ds_write_b128 v64, v[192:195] offset:24960
    s_nop 1
    ds_write_b128 v64, v[28:31] offset:29120
    ds_write_b128 v65, v[40:43]
    v_lshlrev_b32 v3, 16, v46
    v_or_b32 v3, v3, v46
    v_and_b32 v196, v68, v3
    v_and_b32 v197, v69, v3
    v_and_b32 v198, v70, v3
    v_and_b32 v199, v71, v3
    s_waitcnt lgkmcnt(0)
    v_mov_b32 v3, 161796
    v_mov_b32 v4, 1
    s_mov_b64 exec, 1
    ds_add_u32 v3, v4
    s_mov_b64 exec, -1
    s_mov_b32 s67, 0
gsync_53:
    ds_read_b32 v4, v3
    s_add_u32 s67, s67, 1
    s_waitcnt lgkmcnt(0)
    v_readfirstlane_b32 s66, v4
    s_cmp_gt_u32 s67, 1000000
    s_cbranch_scc1 gsync_e_54
    s_cmp_lt_u32 s66, 20
    s_cbranch_scc1 gsync_53
gsync_e_54:
    s_bitcmp1_b32 s2, 0
    s_cbranch_scc1 c_halfB_55
    s_cmp_lg_u32 s34, 0
    s_cbranch_scc1 c_pw_58
    ds_read_b128 v[108:111], v66 offset:0
    ds_read_b128 v[120:123], v67 offset:480
    ds_read_b128 v[124:127], v67 offset:992
    ds_read_b128 v[128:131], v67 offset:1504
    ds_read_b128 v[132:135], v67 offset:2016
    ds_read_b128 v[136:139], v67 offset:2528
    ds_read_b128 v[140:143], v67 offset:3040
    ds_read_b128 v[144:147], v67 offset:3552
    ds_read_b128 v[148:151], v67 offset:4064
    ds_read_b128 v[112:115], v66 offset:512
    ds_read_b128 v[116:119], v66 offset:1024
    s_waitcnt lgkmcnt(2)
    v_mfma_f32_16x16x32_bf16 v[104:107], v[108:111], v[148:151], 0
    v_mfma_f32_16x16x32_bf16 v[100:103], v[108:111], v[144:147], 0
    v_mfma_f32_16x16x32_bf16 v[84:87], v[108:111], v[128:131], 0
    v_mfma_f32_16x16x32_bf16 v[84:87], v[196:199], v[128:131], v[84:87]
    v_mfma_f32_16x16x32_bf16 v[100:103], v[196:199], v[144:147], v[100:103]
    v_mfma_f32_16x16x32_bf16 v[104:107], v[196:199], v[148:151], v[104:107]
    ds_read_b128 v[108:111], v66 offset:1536
    s_waitcnt lgkmcnt(2)
    v_mfma_f32_16x16x32_bf16 v[104:107], v[112:115], v[144:147], v[104:107]
    v_mfma_f32_16x16x32_bf16 v[100:103], v[112:115], v[140:143], v[100:103]
    v_mfma_f32_16x16x32_bf16 v[84:87], v[112:115], v[124:127], v[84:87]
    ds_read_b128 v[112:115], v66 offset:2048
    ds_read_b128 v[152:155], v67 offset:416
    ds_read_b128 v[156:159], v67 offset:928
    ds_read_b128 v[160:163], v67 offset:1440
    ds_read_b128 v[164:167], v67 offset:1952
    ds_read_b128 v[168:171], v67 offset:2464
    ds_read_b128 v[172:175], v67 offset:2976
    ds_read_b128 v[176:179], v67 offset:3488
    ds_read_b128 v[180:183], v67 offset:4000
    s_waitcnt lgkmcnt(10)
    v_mfma_f32_16x16x32_bf16 v[104:107], v[116:119], v[140:143], v[104:107]
    v_mfma_f32_16x16x32_bf16 v[100:103], v[116:119], v[136:139], v[100:103]
    v_mfma_f32_16x16x32_bf16 v[84:87], v[116:119], v[120:123], v[84:87]
    ds_read_b128 v[116:119], v66 offset:2560
    s_waitcnt lgkmcnt(10)
    v_mfma_f32_16x16x32_bf16 v[104:107], v[108:111], v[136:139], v[104:107]
    v_mfma_f32_16x16x32_bf16 v[100:103], v[108:111], v[132:135], v[100:103]
    ds_read_b128 v[108:111], v66 offset:3072
    s_waitcnt lgkmcnt(10)
    v_mfma_f32_16x16x32_bf16 v[104:107], v[112:115], v[132:135], v[104:107]
    v_mfma_f32_16x16x32_bf16 v[100:103], v[112:115], v[128:131], v[100:103]
    ds_read_b128 v[112:115], v66 offset:3584
    s_waitcnt lgkmcnt(2)
    v_mfma_f32_16x16x32_bf16 v[104:107], v[116:119], v[128:131], v[104:107]
    v_mfma_f32_16x16x32_bf16 v[100:103], v[116:119], v[124:127], v[100:103]
    ds_read_b128 v[116:119], v66 offset:64
    s_waitcnt lgkmcnt(2)
    v_mfma_f32_16x16x32_bf16 v[104:107], v[108:111], v[124:127], v[104:107]
    v_mfma_f32_16x16x32_bf16 v[100:103], v[108:111], v[120:123], v[100:103]
    ds_read_b128 v[108:111], v66 offset:576
    s_waitcnt lgkmcnt(2)
    v_mfma_f32_16x16x32_bf16 v[104:107], v[112:115], v[120:123], v[104:107]
    ds_read_b128 v[112:115], v66 offset:1088
    s_waitcnt lgkmcnt(2)
    v_mfma_f32_16x16x32_bf16 v[104:107], v[116:119], v[180:183], v[104:107]
    v_mfma_f32_16x16x32_bf16 v[100:103], v[116:119], v[176:179], v[100:103]
    v_mfma_f32_16x16x32_bf16 v[84:87], v[116:119], v[160:163], v[84:87]
    ds_read_b128 v[116:119], v66 offset:1600
    s_waitcnt lgkmcnt(2)
    v_mfma_f32_16x16x32_bf16 v[104:107], v[108:111], v[176:179], v[104:107]
    v_mfma_f32_16x16x32_bf16 v[100:103], v[108:111], v[172:175], v[100:103]
    v_mfma_f32_16x16x32_bf16 v[84:87], v[108:111], v[156:159], v[84:87]
    ds_read_b128 v[108:111], v66 offset:2112
    s_waitcnt lgkmcnt(2)
    v_mfma_f32_16x16x32_bf16 v[104:107], v[112:115], v[172:175], v[104:107]
    v_mfma_f32_16x16x32_bf16 v[100:103], v[112:115], v[168:171], v[100:103]
    v_mfma_f32_16x16x32_bf16 v[84:87], v[112:115], v[152:155], v[84:87]
    ds_read_b128 v[112:115], v66 offset:2624
    s_waitcnt lgkmcnt(2)
    v_mfma_f32_16x16x32_bf16 v[104:107], v[116:119], v[168:171], v[104:107]
    v_mfma_f32_16x16x32_bf16 v[100:103], v[116:119], v[164:167], v[100:103]
    ds_read_b128 v[116:119], v66 offset:3136
    s_waitcnt lgkmcnt(2)
    v_mfma_f32_16x16x32_bf16 v[104:107], v[108:111], v[164:167], v[104:107]
    v_mfma_f32_16x16x32_bf16 v[100:103], v[108:111], v[160:163], v[100:103]
    ds_read_b128 v[108:111], v66 offset:3648
    s_waitcnt lgkmcnt(2)
    v_mfma_f32_16x16x32_bf16 v[104:107], v[112:115], v[160:163], v[104:107]
    v_mfma_f32_16x16x32_bf16 v[100:103], v[112:115], v[156:159], v[100:103]
    s_waitcnt lgkmcnt(1)
    v_mfma_f32_16x16x32_bf16 v[104:107], v[116:119], v[156:159], v[104:107]
    v_mfma_f32_16x16x32_bf16 v[100:103], v[116:119], v[152:155], v[100:103]
    s_waitcnt lgkmcnt(0)
    v_mfma_f32_16x16x32_bf16 v[104:107], v[108:111], v[152:155], v[104:107]
    ds_write_b128 v74, v[84:87] offset:2048
    s_nop 4
    ds_write_b128 v74, v[100:103] offset:6144
    s_nop 0
    ds_write_b128 v74, v[104:107] offset:7168
    s_branch c_pw_end_57
c_pw_58:
    s_cmp_lg_u32 s34, 1
    s_cbranch_scc1 c_pw_59
    ds_read_b128 v[108:111], v66 offset:128
    ds_read_b128 v[120:123], v67 offset:352
    ds_read_b128 v[124:127], v67 offset:864
    ds_read_b128 v[128:131], v67 offset:1376
    ds_read_b128 v[132:135], v67 offset:1888
    ds_read_b128 v[136:139], v67 offset:2400
    ds_read_b128 v[140:143], v67 offset:2912
    ds_read_b128 v[144:147], v67 offset:3424
    ds_read_b128 v[148:151], v67 offset:3936
    ds_read_b128 v[112:115], v66 offset:640
    ds_read_b128 v[116:119], v66 offset:1152
    s_waitcnt lgkmcnt(2)
    v_mfma_f32_16x16x32_bf16 v[104:107], v[108:111], v[148:151], 0
    v_mfma_f32_16x16x32_bf16 v[100:103], v[108:111], v[144:147], 0
    v_mfma_f32_16x16x32_bf16 v[84:87], v[108:111], v[128:131], 0
    ds_read_b128 v[108:111], v66 offset:1664
    s_waitcnt lgkmcnt(2)
    v_mfma_f32_16x16x32_bf16 v[104:107], v[112:115], v[144:147], v[104:107]
    v_mfma_f32_16x16x32_bf16 v[100:103], v[112:115], v[140:143], v[100:103]
    v_mfma_f32_16x16x32_bf16 v[84:87], v[112:115], v[124:127], v[84:87]
    ds_read_b128 v[112:115], v66 offset:2176
    ds_read_b128 v[152:155], v67 offset:288
    ds_read_b128 v[156:159], v67 offset:800
    ds_read_b128 v[160:163], v67 offset:1312
    ds_read_b128 v[164:167], v67 offset:1824
    ds_read_b128 v[168:171], v67 offset:2336
    ds_read_b128 v[172:175], v67 offset:2848
    ds_read_b128 v[176:179], v67 offset:3360
    ds_read_b128 v[180:183], v67 offset:3872
    s_waitcnt lgkmcnt(10)
    v_mfma_f32_16x16x32_bf16 v[104:107], v[116:119], v[140:143], v[104:107]
    v_mfma_f32_16x16x32_bf16 v[100:103], v[116:119], v[136:139], v[100:103]
    v_mfma_f32_16x16x32_bf16 v[84:87], v[116:119], v[120:123], v[84:87]
    ds_read_b128 v[116:119], v66 offset:2688
    s_waitcnt lgkmcnt(10)
    v_mfma_f32_16x16x32_bf16 v[104:107], v[108:111], v[136:139], v[104:107]
    v_mfma_f32_16x16x32_bf16 v[100:103], v[108:111], v[132:135], v[100:103]
    ds_read_b128 v[108:111], v66 offset:3200
    s_waitcnt lgkmcnt(10)
    v_mfma_f32_16x16x32_bf16 v[104:107], v[112:115], v[132:135], v[104:107]
    v_mfma_f32_16x16x32_bf16 v[100:103], v[112:115], v[128:131], v[100:103]
    ds_read_b128 v[112:115], v66 offset:3712
    s_waitcnt lgkmcnt(2)
    v_mfma_f32_16x16x32_bf16 v[104:107], v[116:119], v[128:131], v[104:107]
    v_mfma_f32_16x16x32_bf16 v[100:103], v[116:119], v[124:127], v[100:103]
    ds_read_b128 v[116:119], v66 offset:192
    s_waitcnt lgkmcnt(2)
    v_mfma_f32_16x16x32_bf16 v[104:107], v[108:111], v[124:127], v[104:107]
    v_mfma_f32_16x16x32_bf16 v[100:103], v[108:111], v[120:123], v[100:103]
    ds_read_b128 v[108:111], v66 offset:704
    s_waitcnt lgkmcnt(2)
    v_mfma_f32_16x16x32_bf16 v[104:107], v[112:115], v[120:123], v[104:107]
    ds_read_b128 v[112:115], v66 offset:1216
    s_waitcnt lgkmcnt(2)
    v_mfma_f32_16x16x32_bf16 v[104:107], v[116:119], v[180:183], v[104:107]
    v_mfma_f32_16x16x32_bf16 v[100:103], v[116:119], v[176:179], v[100:103]
    v_mfma_f32_16x16x32_bf16 v[84:87], v[116:119], v[160:163], v[84:87]
    ds_read_b128 v[116:119], v66 offset:1728
    s_waitcnt lgkmcnt(2)
    v_mfma_f32_16x16x32_bf16 v[104:107], v[108:111], v[176:179], v[104:107]
    v_mfma_f32_16x16x32_bf16 v[100:103], v[108:111], v[172:175], v[100:103]
    v_mfma_f32_16x16x32_bf16 v[84:87], v[108:111], v[156:159], v[84:87]
    ds_read_b128 v[108:111], v66 offset:2240
    s_waitcnt lgkmcnt(2)
    v_mfma_f32_16x16x32_bf16 v[104:107], v[112:115], v[172:175], v[104:107]
    v_mfma_f32_16x16x32_bf16 v[100:103], v[112:115], v[168:171], v[100:103]
    v_mfma_f32_16x16x32_bf16 v[84:87], v[112:115], v[152:155], v[84:87]
    ds_read_b128 v[112:115], v66 offset:2752
    s_waitcnt lgkmcnt(2)
    v_mfma_f32_16x16x32_bf16 v[104:107], v[116:119], v[168:171], v[104:107]
    v_mfma_f32_16x16x32_bf16 v[100:103], v[116:119], v[164:167], v[100:103]
    ds_read_b128 v[116:119], v66 offset:3264
    s_waitcnt lgkmcnt(2)
    v_mfma_f32_16x16x32_bf16 v[104:107], v[108:111], v[164:167], v[104:107]
    v_mfma_f32_16x16x32_bf16 v[100:103], v[108:111], v[160:163], v[100:103]
    ds_read_b128 v[108:111], v66 offset:3776
    s_waitcnt lgkmcnt(2)
    v_mfma_f32_16x16x32_bf16 v[104:107], v[112:115], v[160:163], v[104:107]
    v_mfma_f32_16x16x32_bf16 v[100:103], v[112:115], v[156:159], v[100:103]
    s_waitcnt lgkmcnt(1)
    v_mfma_f32_16x16x32_bf16 v[104:107], v[116:119], v[156:159], v[104:107]
    v_mfma_f32_16x16x32_bf16 v[100:103], v[116:119], v[152:155], v[100:103]
    s_waitcnt lgkmcnt(0)
    v_mfma_f32_16x16x32_bf16 v[104:107], v[108:111], v[152:155], v[104:107]
    ds_write_b128 v74, v[84:87] offset:2048
    s_nop 4
    ds_write_b128 v74, v[100:103] offset:6144
    s_nop 0
    ds_write_b128 v74, v[104:107] offset:7168
    s_branch c_pw_end_57
c_pw_59:
    s_cmp_lg_u32 s34, 2
    s_cbranch_scc1 c_pw_60
    ds_read_b128 v[108:111], v66 offset:256
    ds_read_b128 v[120:123], v67 offset:224
    ds_read_b128 v[124:127], v67 offset:736
    ds_read_b128 v[128:131], v67 offset:1248
    ds_read_b128 v[132:135], v67 offset:1760
    ds_read_b128 v[136:139], v67 offset:2272
    ds_read_b128 v[140:143], v67 offset:2784
    ds_read_b128 v[144:147], v67 offset:3296
    ds_read_b128 v[148:151], v67 offset:3808
    ds_read_b128 v[112:115], v66 offset:768
    ds_read_b128 v[116:119], v66 offset:1280
    s_waitcnt lgkmcnt(2)
    v_mfma_f32_16x16x32_bf16 v[104:107], v[108:111], v[148:151], 0
    v_mfma_f32_16x16x32_bf16 v[100:103], v[108:111], v[144:147], 0
    v_mfma_f32_16x16x32_bf16 v[84:87], v[108:111], v[128:131], 0
    ds_read_b128 v[108:111], v66 offset:1792
    s_waitcnt lgkmcnt(2)
    v_mfma_f32_16x16x32_bf16 v[104:107], v[112:115], v[144:147], v[104:107]
    v_mfma_f32_16x16x32_bf16 v[100:103], v[112:115], v[140:143], v[100:103]
    v_mfma_f32_16x16x32_bf16 v[84:87], v[112:115], v[124:127], v[84:87]
    ds_read_b128 v[112:115], v66 offset:2304
    ds_read_b128 v[152:155], v67 offset:160
    ds_read_b128 v[156:159], v67 offset:672
    ds_read_b128 v[160:163], v67 offset:1184
    ds_read_b128 v[164:167], v67 offset:1696
    ds_read_b128 v[168:171], v67 offset:2208
    ds_read_b128 v[172:175], v67 offset:2720
    ds_read_b128 v[176:179], v67 offset:3232
    ds_read_b128 v[180:183], v67 offset:3744
    s_waitcnt lgkmcnt(10)
    v_mfma_f32_16x16x32_bf16 v[104:107], v[116:119], v[140:143], v[104:107]
    v_mfma_f32_16x16x32_bf16 v[100:103], v[116:119], v[136:139], v[100:103]
    v_mfma_f32_16x16x32_bf16 v[84:87], v[116:119], v[120:123], v[84:87]
    ds_read_b128 v[116:119], v66 offset:2816
    s_waitcnt lgkmcnt(10)
    v_mfma_f32_16x16x32_bf16 v[104:107], v[108:111], v[136:139], v[104:107]
    v_mfma_f32_16x16x32_bf16 v[100:103], v[108:111], v[132:135], v[100:103]
    ds_read_b128 v[108:111], v66 offset:3328
    s_waitcnt lgkmcnt(10)
    v_mfma_f32_16x16x32_bf16 v[104:107], v[112:115], v[132:135], v[104:107]
    v_mfma_f32_16x16x32_bf16 v[100:103], v[112:115], v[128:131], v[100:103]
    ds_read_b128 v[112:115], v66 offset:3840
    s_waitcnt lgkmcnt(2)
    v_mfma_f32_16x16x32_bf16 v[104:107], v[116:119], v[128:131], v[104:107]
    v_mfma_f32_16x16x32_bf16 v[100:103], v[116:119], v[124:127], v[100:103]
    ds_read_b128 v[116:119], v66 offset:320
    s_waitcnt lgkmcnt(2)
    v_mfma_f32_16x16x32_bf16 v[104:107], v[108:111], v[124:127], v[104:107]
    v_mfma_f32_16x16x32_bf16 v[100:103], v[108:111], v[120:123], v[100:103]
    ds_read_b128 v[108:111], v66 offset:832
    s_waitcnt lgkmcnt(2)
    v_mfma_f32_16x16x32_bf16 v[104:107], v[112:115], v[120:123], v[104:107]
    ds_read_b128 v[112:115], v66 offset:1344
    s_waitcnt lgkmcnt(2)
    v_mfma_f32_16x16x32_bf16 v[104:107], v[116:119], v[180:183], v[104:107]
    v_mfma_f32_16x16x32_bf16 v[100:103], v[116:119], v[176:179], v[100:103]
    v_mfma_f32_16x16x32_bf16 v[84:87], v[116:119], v[160:163], v[84:87]
    ds_read_b128 v[116:119], v66 offset:1856
    s_waitcnt lgkmcnt(2)
    v_mfma_f32_16x16x32_bf16 v[104:107], v[108:111], v[176:179], v[104:107]
    v_mfma_f32_16x16x32_bf16 v[100:103], v[108:111], v[172:175], v[100:103]
    v_mfma_f32_16x16x32_bf16 v[84:87], v[108:111], v[156:159], v[84:87]
    ds_read_b128 v[108:111], v66 offset:2368
    s_waitcnt lgkmcnt(2)
    v_mfma_f32_16x16x32_bf16 v[104:107], v[112:115], v[172:175], v[104:107]
    v_mfma_f32_16x16x32_bf16 v[100:103], v[112:115], v[168:171], v[100:103]
    v_mfma_f32_16x16x32_bf16 v[84:87], v[112:115], v[152:155], v[84:87]
    ds_read_b128 v[112:115], v66 offset:2880
    s_waitcnt lgkmcnt(2)
    v_mfma_f32_16x16x32_bf16 v[104:107], v[116:119], v[168:171], v[104:107]
    v_mfma_f32_16x16x32_bf16 v[100:103], v[116:119], v[164:167], v[100:103]
    ds_read_b128 v[116:119], v66 offset:3392
    s_waitcnt lgkmcnt(2)
    v_mfma_f32_16x16x32_bf16 v[104:107], v[108:111], v[164:167], v[104:107]
    v_mfma_f32_16x16x32_bf16 v[100:103], v[108:111], v[160:163], v[100:103]
    ds_read_b128 v[108:111], v66 offset:3904
    s_waitcnt lgkmcnt(2)
    v_mfma_f32_16x16x32_bf16 v[104:107], v[112:115], v[160:163], v[104:107]
    v_mfma_f32_16x16x32_bf16 v[100:103], v[112:115], v[156:159], v[100:103]
    s_waitcnt lgkmcnt(1)
    v_mfma_f32_16x16x32_bf16 v[104:107], v[116:119], v[156:159], v[104:107]
    v_mfma_f32_16x16x32_bf16 v[100:103], v[116:119], v[152:155], v[100:103]
    s_waitcnt lgkmcnt(0)
    v_mfma_f32_16x16x32_bf16 v[104:107], v[108:111], v[152:155], v[104:107]
    ds_write_b128 v74, v[84:87] offset:2048
    s_nop 4
    ds_write_b128 v74, v[100:103] offset:6144
    s_nop 0
    ds_write_b128 v74, v[104:107] offset:7168
    s_branch c_pw_end_57
c_pw_60:
    ds_read_b128 v[108:111], v66 offset:384
    ds_read_b128 v[120:123], v67 offset:96
    ds_read_b128 v[124:127], v67 offset:608
    ds_read_b128 v[128:131], v67 offset:1120
    ds_read_b128 v[132:135], v67 offset:1632
    ds_read_b128 v[136:139], v67 offset:2144
    ds_read_b128 v[140:143], v67 offset:2656
    ds_read_b128 v[144:147], v67 offset:3168
    ds_read_b128 v[148:151], v67 offset:3680
    ds_read_b128 v[112:115], v66 offset:896
    ds_read_b128 v[116:119], v66 offset:1408
    s_waitcnt lgkmcnt(2)
    v_mfma_f32_16x16x32_bf16 v[104:107], v[108:111], v[148:151], 0
    v_mfma_f32_16x16x32_bf16 v[100:103], v[108:111], v[144:147], 0
    v_mfma_f32_16x16x32_bf16 v[84:87], v[108:111], v[128:131], 0
    ds_read_b128 v[108:111], v66 offset:1920
    s_waitcnt lgkmcnt(2)
    v_mfma_f32_16x16x32_bf16 v[104:107], v[112:115], v[144:147], v[104:107]
    v_mfma_f32_16x16x32_bf16 v[100:103], v[112:115], v[140:143], v[100:103]
    v_mfma_f32_16x16x32_bf16 v[84:87], v[112:115], v[124:127], v[84:87]
    ds_read_b128 v[112:115], v66 offset:2432
    ds_read_b128 v[152:155], v67 offset:32
    ds_read_b128 v[156:159], v67 offset:544
    ds_read_b128 v[160:163], v67 offset:1056
    ds_read_b128 v[164:167], v67 offset:1568
    ds_read_b128 v[168:171], v67 offset:2080
    ds_read_b128 v[172:175], v67 offset:2592
    ds_read_b128 v[176:179], v67 offset:3104
    ds_read_b128 v[180:183], v67 offset:3616
    s_waitcnt lgkmcnt(10)
    v_mfma_f32_16x16x32_bf16 v[104:107], v[116:119], v[140:143], v[104:107]
    v_mfma_f32_16x16x32_bf16 v[100:103], v[116:119], v[136:139], v[100:103]
    v_mfma_f32_16x16x32_bf16 v[84:87], v[116:119], v[120:123], v[84:87]
    ds_read_b128 v[116:119], v66 offset:2944
    s_waitcnt lgkmcnt(10)
    v_mfma_f32_16x16x32_bf16 v[104:107], v[108:111], v[136:139], v[104:107]
    v_mfma_f32_16x16x32_bf16 v[100:103], v[108:111], v[132:135], v[100:103]
    ds_read_b128 v[108:111], v66 offset:3456
    s_waitcnt lgkmcnt(10)
    v_mfma_f32_16x16x32_bf16 v[104:107], v[112:115], v[132:135], v[104:107]
    v_mfma_f32_16x16x32_bf16 v[100:103], v[112:115], v[128:131], v[100:103]
    ds_read_b128 v[112:115], v66 offset:3968
    s_waitcnt lgkmcnt(2)
    v_mfma_f32_16x16x32_bf16 v[104:107], v[116:119], v[128:131], v[104:107]
    v_mfma_f32_16x16x32_bf16 v[100:103], v[116:119], v[124:127], v[100:103]
    ds_read_b128 v[116:119], v66 offset:448
    s_waitcnt lgkmcnt(2)
    v_mfma_f32_16x16x32_bf16 v[104:107], v[108:111], v[124:127], v[104:107]
    v_mfma_f32_16x16x32_bf16 v[100:103], v[108:111], v[120:123], v[100:103]
    ds_read_b128 v[108:111], v66 offset:960
    s_waitcnt lgkmcnt(2)
    v_mfma_f32_16x16x32_bf16 v[104:107], v[112:115], v[120:123], v[104:107]
    ds_read_b128 v[112:115], v66 offset:1472
    s_waitcnt lgkmcnt(2)
    v_mfma_f32_16x16x32_bf16 v[104:107], v[116:119], v[180:183], v[104:107]
    v_mfma_f32_16x16x32_bf16 v[100:103], v[116:119], v[176:179], v[100:103]
    v_mfma_f32_16x16x32_bf16 v[84:87], v[116:119], v[160:163], v[84:87]
    ds_read_b128 v[116:119], v66 offset:1984
    s_waitcnt lgkmcnt(2)
    v_mfma_f32_16x16x32_bf16 v[104:107], v[108:111], v[176:179], v[104:107]
    v_mfma_f32_16x16x32_bf16 v[100:103], v[108:111], v[172:175], v[100:103]
    v_mfma_f32_16x16x32_bf16 v[84:87], v[108:111], v[156:159], v[84:87]
    ds_read_b128 v[108:111], v66 offset:2496
    s_waitcnt lgkmcnt(2)
    v_mfma_f32_16x16x32_bf16 v[104:107], v[112:115], v[172:175], v[104:107]
    v_mfma_f32_16x16x32_bf16 v[100:103], v[112:115], v[168:171], v[100:103]
    v_mfma_f32_16x16x32_bf16 v[84:87], v[112:115], v[152:155], v[84:87]
    ds_read_b128 v[112:115], v66 offset:3008
    s_waitcnt lgkmcnt(2)
    v_mfma_f32_16x16x32_bf16 v[104:107], v[116:119], v[168:171], v[104:107]
    v_mfma_f32_16x16x32_bf16 v[100:103], v[116:119], v[164:167], v[100:103]
    ds_read_b128 v[116:119], v66 offset:3520
    s_waitcnt lgkmcnt(2)
    v_mfma_f32_16x16x32_bf16 v[104:107], v[108:111], v[164:167], v[104:107]
    v_mfma_f32_16x16x32_bf16 v[100:103], v[108:111], v[160:163], v[100:103]
    ds_read_b128 v[108:111], v66 offset:4032
    s_waitcnt lgkmcnt(2)
    v_mfma_f32_16x16x32_bf16 v[104:107], v[112:115], v[160:163], v[104:107]
    v_mfma_f32_16x16x32_bf16 v[100:103], v[112:115], v[156:159], v[100:103]
    s_waitcnt lgkmcnt(1)
    v_mfma_f32_16x16x32_bf16 v[104:107], v[116:119], v[156:159], v[104:107]
    v_mfma_f32_16x16x32_bf16 v[100:103], v[116:119], v[152:155], v[100:103]
    s_waitcnt lgkmcnt(0)
    v_mfma_f32_16x16x32_bf16 v[104:107], v[108:111], v[152:155], v[104:107]
    ds_write_b128 v74, v[84:87] offset:2048
    s_nop 4
    ds_write_b128 v74, v[100:103] offset:6144
    s_nop 0
    ds_write_b128 v74, v[104:107] offset:7168
c_pw_end_57:
    s_waitcnt lgkmcnt(0)
    v_mov_b32 v3, 161796
    v_mov_b32 v4, 1
    s_mov_b64 exec, 1
    ds_add_u32 v3, v4
    s_mov_b64 exec, -1
    s_mov_b32 s67, 0
gsync_62:
    ds_read_b32 v4, v3
    s_add_u32 s67, s67, 1
    s_waitcnt lgkmcnt(0)
    v_readfirstlane_b32 s66, v4
    s_cmp_gt_u32 s67, 1000000
    s_cbranch_scc1 gsync_e_63
    s_cmp_lt_u32 s66, 24
    s_cbranch_scc1 gsync_62
gsync_e_63:
    s_mov_b64 exec, 0
    s_cmp_eq_u32 s34, 0
    s_cselect_b32 exec_lo, 0, exec_lo
    s_cselect_b32 exec_hi, 0, exec_hi
    s_cmp_eq_u32 s34, 1
    s_cselect_b32 exec_lo, -1, exec_lo
    s_cselect_b32 exec_hi, 0, exec_hi
    s_cmp_eq_u32 s34, 2
    s_cselect_b32 exec_lo, 0, exec_lo
    s_cselect_b32 exec_hi, 0, exec_hi
    s_cmp_eq_u32 s34, 3
    s_cselect_b32 exec_lo, -1, exec_lo
    s_cselect_b32 exec_hi, -1, exec_hi
    s_cbranch_execz c_fskip_65
    ds_read_b128 v[120:123], v75 offset:0
    ds_read_b128 v[124:127], v75 offset:16
    ds_read_b128 v[128:131], v75 offset:8192
    ds_read_b128 v[132:135], v75 offset:8208
    ds_read_b128 v[136:139], v75 offset:16384
    ds_read_b128 v[140:143], v75 offset:16400
    ds_read_b128 v[144:147], v75 offset:24576
    ds_read_b128 v[148:151], v75 offset:24592
    s_lshl_b32 s40, s58, 12
    s_add_u32 s40, s40, 8912896
    s_waitcnt lgkmcnt(0)
    v_pk_add_f32 v[120:121], v[120:121], v[128:129]
    v_pk_add_f32 v[136:137], v[136:137], v[144:145]
    v_pk_add_f32 v[122:123], v[122:123], v[130:131]
    v_pk_add_f32 v[138:139], v[138:139], v[146:147]
    v_pk_add_f32 v[124:125], v[124:125], v[132:133]
    v_pk_add_f32 v[140:141], v[140:141], v[148:149]
    v_pk_add_f32 v[126:127], v[126:127], v[134:135]
    v_pk_add_f32 v[142:143], v[142:143], v[150:151]
    v_pk_add_f32 v[120:121], v[120:121], v[136:137]
    v_pk_add_f32 v[122:123], v[122:123], v[138:139]
    v_pk_add_f32 v[124:125], v[124:125], v[140:141]
    v_pk_add_f32 v[126:127], v[126:127], v[142:143]
    v_cvt_pk_bf16_f32 v192, v120, v121
    v_cvt_pk_bf16_f32 v193, v122, v123
    v_cvt_pk_bf16_f32 v194, v124, v125
    v_cvt_pk_bf16_f32 v195, v126, v127
    buffer_store_dwordx4 v[192:195], v2, s[8:11], s40 offen sc1
c_fskip_65:
    s_mov_b64 exec, -1
    s_nop 1
    s_branch c_halfE_56
c_halfB_55:
    s_cmp_lg_u32 s34, 0
    s_cbranch_scc1 c_pw_67
    ds_read_b128 v[108:111], v66 offset:0
    ds_read_b128 v[120:123], v67 offset:480
    ds_read_b128 v[124:127], v67 offset:992
    ds_read_b128 v[128:131], v67 offset:1504
    ds_read_b128 v[132:135], v67 offset:2016
    ds_read_b128 v[136:139], v67 offset:2528
    ds_read_b128 v[140:143], v67 offset:3040
    ds_read_b128 v[112:115], v66 offset:512
    ds_read_b128 v[116:119], v66 offset:1024
    s_waitcnt lgkmcnt(2)
    v_mfma_f32_16x16x32_bf16 v[96:99], v[108:111], v[140:143], 0
    v_mfma_f32_16x16x32_bf16 v[92:95], v[108:111], v[136:139], 0
    v_mfma_f32_16x16x32_bf16 v[88:91], v[108:111], v[132:135], 0
    v_mfma_f32_16x16x32_bf16 v[80:83], v[108:111], v[124:127], 0
    v_mfma_f32_16x16x32_bf16 v[76:79], v[108:111], v[120:123], 0
    v_mfma_f32_16x16x32_bf16 v[76:79], v[196:199], v[120:123], v[76:79]
    v_mfma_f32_16x16x32_bf16 v[80:83], v[196:199], v[124:127], v[80:83]
    v_mfma_f32_16x16x32_bf16 v[88:91], v[196:199], v[132:135], v[88:91]
    v_mfma_f32_16x16x32_bf16 v[92:95], v[196:199], v[136:139], v[92:95]
    v_mfma_f32_16x16x32_bf16 v[96:99], v[196:199], v[140:143], v[96:99]
    ds_read_b128 v[108:111], v66 offset:1536
    s_waitcnt lgkmcnt(2)
    v_mfma_f32_16x16x32_bf16 v[96:99], v[112:115], v[136:139], v[96:99]
    v_mfma_f32_16x16x32_bf16 v[92:95], v[112:115], v[132:135], v[92:95]
    v_mfma_f32_16x16x32_bf16 v[88:91], v[112:115], v[128:131], v[88:91]
    v_mfma_f32_16x16x32_bf16 v[80:83], v[112:115], v[120:123], v[80:83]
    ds_read_b128 v[112:115], v66 offset:2048
    ds_read_b128 v[152:155], v67 offset:416
    ds_read_b128 v[156:159], v67 offset:928
    ds_read_b128 v[160:163], v67 offset:1440
    ds_read_b128 v[164:167], v67 offset:1952
    ds_read_b128 v[168:171], v67 offset:2464
    ds_read_b128 v[172:175], v67 offset:2976
    s_waitcnt lgkmcnt(8)
    v_mfma_f32_16x16x32_bf16 v[96:99], v[116:119], v[132:135], v[96:99]
    v_mfma_f32_16x16x32_bf16 v[92:95], v[116:119], v[128:131], v[92:95]
    v_mfma_f32_16x16x32_bf16 v[88:91], v[116:119], v[124:127], v[88:91]
    ds_read_b128 v[116:119], v66 offset:2560
    s_waitcnt lgkmcnt(8)
    v_mfma_f32_16x16x32_bf16 v[96:99], v[108:111], v[128:131], v[96:99]
    v_mfma_f32_16x16x32_bf16 v[92:95], v[108:111], v[124:127], v[92:95]
    v_mfma_f32_16x16x32_bf16 v[88:91], v[108:111], v[120:123], v[88:91]
    ds_read_b128 v[108:111], v66 offset:64
    s_waitcnt lgkmcnt(8)
    v_mfma_f32_16x16x32_bf16 v[96:99], v[112:115], v[124:127], v[96:99]
    v_mfma_f32_16x16x32_bf16 v[92:95], v[112:115], v[120:123], v[92:95]
    ds_read_b128 v[112:115], v66 offset:576
    s_waitcnt lgkmcnt(2)
    v_mfma_f32_16x16x32_bf16 v[96:99], v[116:119], v[120:123], v[96:99]
    ds_read_b128 v[116:119], v66 offset:1088
    s_waitcnt lgkmcnt(2)
    v_mfma_f32_16x16x32_bf16 v[96:99], v[108:111], v[172:175], v[96:99]
    v_mfma_f32_16x16x32_bf16 v[92:95], v[108:111], v[168:171], v[92:95]
    v_mfma_f32_16x16x32_bf16 v[88:91], v[108:111], v[164:167], v[88:91]
    v_mfma_f32_16x16x32_bf16 v[80:83], v[108:111], v[156:159], v[80:83]
    v_mfma_f32_16x16x32_bf16 v[76:79], v[108:111], v[152:155], v[76:79]
    ds_read_b128 v[108:111], v66 offset:1600
    s_waitcnt lgkmcnt(2)
    v_mfma_f32_16x16x32_bf16 v[96:99], v[112:115], v[168:171], v[96:99]
    v_mfma_f32_16x16x32_bf16 v[92:95], v[112:115], v[164:167], v[92:95]
    v_mfma_f32_16x16x32_bf16 v[88:91], v[112:115], v[160:163], v[88:91]
    v_mfma_f32_16x16x32_bf16 v[80:83], v[112:115], v[152:155], v[80:83]
    ds_read_b128 v[112:115], v66 offset:2112
    s_waitcnt lgkmcnt(2)
    v_mfma_f32_16x16x32_bf16 v[96:99], v[116:119], v[164:167], v[96:99]
    v_mfma_f32_16x16x32_bf16 v[92:95], v[116:119], v[160:163], v[92:95]
    v_mfma_f32_16x16x32_bf16 v[88:91], v[116:119], v[156:159], v[88:91]
    ds_read_b128 v[116:119], v66 offset:2624
    s_waitcnt lgkmcnt(2)
    v_mfma_f32_16x16x32_bf16 v[96:99], v[108:111], v[160:163], v[96:99]
    v_mfma_f32_16x16x32_bf16 v[92:95], v[108:111], v[156:159], v[92:95]
    v_mfma_f32_16x16x32_bf16 v[88:91], v[108:111], v[152:155], v[88:91]
    s_waitcnt lgkmcnt(1)
    v_mfma_f32_16x16x32_bf16 v[96:99], v[112:115], v[156:159], v[96:99]
    v_mfma_f32_16x16x32_bf16 v[92:95], v[112:115], v[152:155], v[92:95]
    s_waitcnt lgkmcnt(0)
    v_mfma_f32_16x16x32_bf16 v[96:99], v[116:119], v[152:155], v[96:99]
    ds_write_b128 v74, v[76:79] offset:0
    ds_write_b128 v74, v[80:83] offset:1024
    s_nop 0
    ds_write_b128 v74, v[88:91] offset:3072
    s_nop 1
    ds_write_b128 v74, v[92:95] offset:4096
    s_nop 0
    ds_write_b128 v74, v[96:99] offset:5120
    s_branch c_pw_end_66
c_pw_67:
    s_cmp_lg_u32 s34, 1
    s_cbranch_scc1 c_pw_68
    ds_read_b128 v[108:111], v66 offset:128
    ds_read_b128 v[120:123], v67 offset:352
    ds_read_b128 v[124:127], v67 offset:864
    ds_read_b128 v[128:131], v67 offset:1376
    ds_read_b128 v[132:135], v67 offset:1888
    ds_read_b128 v[136:139], v67 offset:2400
    ds_read_b128 v[140:143], v67 offset:2912
    ds_read_b128 v[112:115], v66 offset:640
    ds_read_b128 v[116:119], v66 offset:1152
    s_waitcnt lgkmcnt(2)
    v_mfma_f32_16x16x32_bf16 v[96:99], v[108:111], v[140:143], 0
    v_mfma_f32_16x16x32_bf16 v[92:95], v[108:111], v[136:139], 0
    v_mfma_f32_16x16x32_bf16 v[88:91], v[108:111], v[132:135], 0
    v_mfma_f32_16x16x32_bf16 v[80:83], v[108:111], v[124:127], 0
    v_mfma_f32_16x16x32_bf16 v[76:79], v[108:111], v[120:123], 0
    ds_read_b128 v[108:111], v66 offset:1664
    s_waitcnt lgkmcnt(2)
    v_mfma_f32_16x16x32_bf16 v[96:99], v[112:115], v[136:139], v[96:99]
    v_mfma_f32_16x16x32_bf16 v[92:95], v[112:115], v[132:135], v[92:95]
    v_mfma_f32_16x16x32_bf16 v[88:91], v[112:115], v[128:131], v[88:91]
    v_mfma_f32_16x16x32_bf16 v[80:83], v[112:115], v[120:123], v[80:83]
    ds_read_b128 v[112:115], v66 offset:2176
    ds_read_b128 v[152:155], v67 offset:288
    ds_read_b128 v[156:159], v67 offset:800
    ds_read_b128 v[160:163], v67 offset:1312
    ds_read_b128 v[164:167], v67 offset:1824
    ds_read_b128 v[168:171], v67 offset:2336
    ds_read_b128 v[172:175], v67 offset:2848
    s_waitcnt lgkmcnt(8)
    v_mfma_f32_16x16x32_bf16 v[96:99], v[116:119], v[132:135], v[96:99]
    v_mfma_f32_16x16x32_bf16 v[92:95], v[116:119], v[128:131], v[92:95]
    v_mfma_f32_16x16x32_bf16 v[88:91], v[116:119], v[124:127], v[88:91]
    ds_read_b128 v[116:119], v66 offset:2688
    s_waitcnt lgkmcnt(8)
    v_mfma_f32_16x16x32_bf16 v[96:99], v[108:111], v[128:131], v[96:99]
    v_mfma_f32_16x16x32_bf16 v[92:95], v[108:111], v[124:127], v[92:95]
    v_mfma_f32_16x16x32_bf16 v[88:91], v[108:111], v[120:123], v[88:91]
    ds_read_b128 v[108:111], v66 offset:192
    s_waitcnt lgkmcnt(8)
    v_mfma_f32_16x16x32_bf16 v[96:99], v[112:115], v[124:127], v[96:99]
    v_mfma_f32_16x16x32_bf16 v[92:95], v[112:115], v[120:123], v[92:95]
    ds_read_b128 v[112:115], v66 offset:704
    s_waitcnt lgkmcnt(2)
    v_mfma_f32_16x16x32_bf16 v[96:99], v[116:119], v[120:123], v[96:99]
    ds_read_b128 v[116:119], v66 offset:1216
    s_waitcnt lgkmcnt(2)
    v_mfma_f32_16x16x32_bf16 v[96:99], v[108:111], v[172:175], v[96:99]
    v_mfma_f32_16x16x32_bf16 v[92:95], v[108:111], v[168:171], v[92:95]
    v_mfma_f32_16x16x32_bf16 v[88:91], v[108:111], v[164:167], v[88:91]
    v_mfma_f32_16x16x32_bf16 v[80:83], v[108:111], v[156:159], v[80:83]
    v_mfma_f32_16x16x32_bf16 v[76:79], v[108:111], v[152:155], v[76:79]
    ds_read_b128 v[108:111], v66 offset:1728
    s_waitcnt lgkmcnt(2)
    v_mfma_f32_16x16x32_bf16 v[96:99], v[112:115], v[168:171], v[96:99]
    v_mfma_f32_16x16x32_bf16 v[92:95], v[112:115], v[164:167], v[92:95]
    v_mfma_f32_16x16x32_bf16 v[88:91], v[112:115], v[160:163], v[88:91]
    v_mfma_f32_16x16x32_bf16 v[80:83], v[112:115], v[152:155], v[80:83]
    ds_read_b128 v[112:115], v66 offset:2240
    s_waitcnt lgkmcnt(2)
    v_mfma_f32_16x16x32_bf16 v[96:99], v[116:119], v[164:167], v[96:99]
    v_mfma_f32_16x16x32_bf16 v[92:95], v[116:119], v[160:163], v[92:95]
    v_mfma_f32_16x16x32_bf16 v[88:91], v[116:119], v[156:159], v[88:91]
    ds_read_b128 v[116:119], v66 offset:2752
    s_waitcnt lgkmcnt(2)
    v_mfma_f32_16x16x32_bf16 v[96:99], v[108:111], v[160:163], v[96:99]
    v_mfma_f32_16x16x32_bf16 v[92:95], v[108:111], v[156:159], v[92:95]
    v_mfma_f32_16x16x32_bf16 v[88:91], v[108:111], v[152:155], v[88:91]
    s_waitcnt lgkmcnt(1)
    v_mfma_f32_16x16x32_bf16 v[96:99], v[112:115], v[156:159], v[96:99]
    v_mfma_f32_16x16x32_bf16 v[92:95], v[112:115], v[152:155], v[92:95]
    s_waitcnt lgkmcnt(0)
    v_mfma_f32_16x16x32_bf16 v[96:99], v[116:119], v[152:155], v[96:99]
    ds_write_b128 v74, v[76:79] offset:0
    ds_write_b128 v74, v[80:83] offset:1024
    s_nop 0
    ds_write_b128 v74, v[88:91] offset:3072
    s_nop 1
    ds_write_b128 v74, v[92:95] offset:4096
    s_nop 0
    ds_write_b128 v74, v[96:99] offset:5120
    s_branch c_pw_end_66
c_pw_68:
    s_cmp_lg_u32 s34, 2
    s_cbranch_scc1 c_pw_69
    ds_read_b128 v[108:111], v66 offset:256
    ds_read_b128 v[120:123], v67 offset:224
    ds_read_b128 v[124:127], v67 offset:736
    ds_read_b128 v[128:131], v67 offset:1248
    ds_read_b128 v[132:135], v67 offset:1760
    ds_read_b128 v[136:139], v67 offset:2272
    ds_read_b128 v[140:143], v67 offset:2784
    ds_read_b128 v[112:115], v66 offset:768
    ds_read_b128 v[116:119], v66 offset:1280
    s_waitcnt lgkmcnt(2)
    v_mfma_f32_16x16x32_bf16 v[96:99], v[108:111], v[140:143], 0
    v_mfma_f32_16x16x32_bf16 v[92:95], v[108:111], v[136:139], 0
    v_mfma_f32_16x16x32_bf16 v[88:91], v[108:111], v[132:135], 0
    v_mfma_f32_16x16x32_bf16 v[80:83], v[108:111], v[124:127], 0
    v_mfma_f32_16x16x32_bf16 v[76:79], v[108:111], v[120:123], 0
    ds_read_b128 v[108:111], v66 offset:1792
    s_waitcnt lgkmcnt(2)
    v_mfma_f32_16x16x32_bf16 v[96:99], v[112:115], v[136:139], v[96:99]
    v_mfma_f32_16x16x32_bf16 v[92:95], v[112:115], v[132:135], v[92:95]
    v_mfma_f32_16x16x32_bf16 v[88:91], v[112:115], v[128:131], v[88:91]
    v_mfma_f32_16x16x32_bf16 v[80:83], v[112:115], v[120:123], v[80:83]
    ds_read_b128 v[112:115], v66 offset:2304
    ds_read_b128 v[152:155], v67 offset:160
    ds_read_b128 v[156:159], v67 offset:672
    ds_read_b128 v[160:163], v67 offset:1184
    ds_read_b128 v[164:167], v67 offset:1696
    ds_read_b128 v[168:171], v67 offset:2208
    ds_read_b128 v[172:175], v67 offset:2720
    s_waitcnt lgkmcnt(8)
    v_mfma_f32_16x16x32_bf16 v[96:99], v[116:119], v[132:135], v[96:99]
    v_mfma_f32_16x16x32_bf16 v[92:95], v[116:119], v[128:131], v[92:95]
    v_mfma_f32_16x16x32_bf16 v[88:91], v[116:119], v[124:127], v[88:91]
    ds_read_b128 v[116:119], v66 offset:2816
    s_waitcnt lgkmcnt(8)
    v_mfma_f32_16x16x32_bf16 v[96:99], v[108:111], v[128:131], v[96:99]
    v_mfma_f32_16x16x32_bf16 v[92:95], v[108:111], v[124:127], v[92:95]
    v_mfma_f32_16x16x32_bf16 v[88:91], v[108:111], v[120:123], v[88:91]
    ds_read_b128 v[108:111], v66 offset:320
    s_waitcnt lgkmcnt(8)
    v_mfma_f32_16x16x32_bf16 v[96:99], v[112:115], v[124:127], v[96:99]
    v_mfma_f32_16x16x32_bf16 v[92:95], v[112:115], v[120:123], v[92:95]
    ds_read_b128 v[112:115], v66 offset:832
    s_waitcnt lgkmcnt(2)
    v_mfma_f32_16x16x32_bf16 v[96:99], v[116:119], v[120:123], v[96:99]
    ds_read_b128 v[116:119], v66 offset:1344
    s_waitcnt lgkmcnt(2)
    v_mfma_f32_16x16x32_bf16 v[96:99], v[108:111], v[172:175], v[96:99]
    v_mfma_f32_16x16x32_bf16 v[92:95], v[108:111], v[168:171], v[92:95]
    v_mfma_f32_16x16x32_bf16 v[88:91], v[108:111], v[164:167], v[88:91]
    v_mfma_f32_16x16x32_bf16 v[80:83], v[108:111], v[156:159], v[80:83]
    v_mfma_f32_16x16x32_bf16 v[76:79], v[108:111], v[152:155], v[76:79]
    ds_read_b128 v[108:111], v66 offset:1856
    s_waitcnt lgkmcnt(2)
    v_mfma_f32_16x16x32_bf16 v[96:99], v[112:115], v[168:171], v[96:99]
    v_mfma_f32_16x16x32_bf16 v[92:95], v[112:115], v[164:167], v[92:95]
    v_mfma_f32_16x16x32_bf16 v[88:91], v[112:115], v[160:163], v[88:91]
    v_mfma_f32_16x16x32_bf16 v[80:83], v[112:115], v[152:155], v[80:83]
    ds_read_b128 v[112:115], v66 offset:2368
    s_waitcnt lgkmcnt(2)
    v_mfma_f32_16x16x32_bf16 v[96:99], v[116:119], v[164:167], v[96:99]
    v_mfma_f32_16x16x32_bf16 v[92:95], v[116:119], v[160:163], v[92:95]
    v_mfma_f32_16x16x32_bf16 v[88:91], v[116:119], v[156:159], v[88:91]
    ds_read_b128 v[116:119], v66 offset:2880
    s_waitcnt lgkmcnt(2)
    v_mfma_f32_16x16x32_bf16 v[96:99], v[108:111], v[160:163], v[96:99]
    v_mfma_f32_16x16x32_bf16 v[92:95], v[108:111], v[156:159], v[92:95]
    v_mfma_f32_16x16x32_bf16 v[88:91], v[108:111], v[152:155], v[88:91]
    s_waitcnt lgkmcnt(1)
    v_mfma_f32_16x16x32_bf16 v[96:99], v[112:115], v[156:159], v[96:99]
    v_mfma_f32_16x16x32_bf16 v[92:95], v[112:115], v[152:155], v[92:95]
    s_waitcnt lgkmcnt(0)
    v_mfma_f32_16x16x32_bf16 v[96:99], v[116:119], v[152:155], v[96:99]
    ds_write_b128 v74, v[76:79] offset:0
    ds_write_b128 v74, v[80:83] offset:1024
    s_nop 0
    ds_write_b128 v74, v[88:91] offset:3072
    s_nop 1
    ds_write_b128 v74, v[92:95] offset:4096
    s_nop 0
    ds_write_b128 v74, v[96:99] offset:5120
    s_branch c_pw_end_66
c_pw_69:
    ds_read_b128 v[108:111], v66 offset:384
    ds_read_b128 v[120:123], v67 offset:96
    ds_read_b128 v[124:127], v67 offset:608
    ds_read_b128 v[128:131], v67 offset:1120
    ds_read_b128 v[132:135], v67 offset:1632
    ds_read_b128 v[136:139], v67 offset:2144
    ds_read_b128 v[140:143], v67 offset:2656
    ds_read_b128 v[112:115], v66 offset:896
    ds_read_b128 v[116:119], v66 offset:1408
    s_waitcnt lgkmcnt(2)
    v_mfma_f32_16x16x32_bf16 v[96:99], v[108:111], v[140:143], 0
    v_mfma_f32_16x16x32_bf16 v[92:95], v[108:111], v[136:139], 0
    v_mfma_f32_16x16x32_bf16 v[88:91], v[108:111], v[132:135], 0
    v_mfma_f32_16x16x32_bf16 v[80:83], v[108:111], v[124:127], 0
    v_mfma_f32_16x16x32_bf16 v[76:79], v[108:111], v[120:123], 0
    ds_read_b128 v[108:111], v66 offset:1920
    s_waitcnt lgkmcnt(2)
    v_mfma_f32_16x16x32_bf16 v[96:99], v[112:115], v[136:139], v[96:99]
    v_mfma_f32_16x16x32_bf16 v[92:95], v[112:115], v[132:135], v[92:95]
    v_mfma_f32_16x16x32_bf16 v[88:91], v[112:115], v[128:131], v[88:91]
    v_mfma_f32_16x16x32_bf16 v[80:83], v[112:115], v[120:123], v[80:83]
    ds_read_b128 v[112:115], v66 offset:2432
    ds_read_b128 v[152:155], v67 offset:32
    ds_read_b128 v[156:159], v67 offset:544
    ds_read_b128 v[160:163], v67 offset:1056
    ds_read_b128 v[164:167], v67 offset:1568
    ds_read_b128 v[168:171], v67 offset:2080
    ds_read_b128 v[172:175], v67 offset:2592
    s_waitcnt lgkmcnt(8)
    v_mfma_f32_16x16x32_bf16 v[96:99], v[116:119], v[132:135], v[96:99]
    v_mfma_f32_16x16x32_bf16 v[92:95], v[116:119], v[128:131], v[92:95]
    v_mfma_f32_16x16x32_bf16 v[88:91], v[116:119], v[124:127], v[88:91]
    ds_read_b128 v[116:119], v66 offset:2944
    s_waitcnt lgkmcnt(8)
    v_mfma_f32_16x16x32_bf16 v[96:99], v[108:111], v[128:131], v[96:99]
    v_mfma_f32_16x16x32_bf16 v[92:95], v[108:111], v[124:127], v[92:95]
    v_mfma_f32_16x16x32_bf16 v[88:91], v[108:111], v[120:123], v[88:91]
    ds_read_b128 v[108:111], v66 offset:448
    s_waitcnt lgkmcnt(8)
    v_mfma_f32_16x16x32_bf16 v[96:99], v[112:115], v[124:127], v[96:99]
    v_mfma_f32_16x16x32_bf16 v[92:95], v[112:115], v[120:123], v[92:95]
    ds_read_b128 v[112:115], v66 offset:960
    s_waitcnt lgkmcnt(2)
    v_mfma_f32_16x16x32_bf16 v[96:99], v[116:119], v[120:123], v[96:99]
    ds_read_b128 v[116:119], v66 offset:1472
    s_waitcnt lgkmcnt(2)
    v_mfma_f32_16x16x32_bf16 v[96:99], v[108:111], v[172:175], v[96:99]
    v_mfma_f32_16x16x32_bf16 v[92:95], v[108:111], v[168:171], v[92:95]
    v_mfma_f32_16x16x32_bf16 v[88:91], v[108:111], v[164:167], v[88:91]
    v_mfma_f32_16x16x32_bf16 v[80:83], v[108:111], v[156:159], v[80:83]
    v_mfma_f32_16x16x32_bf16 v[76:79], v[108:111], v[152:155], v[76:79]
    ds_read_b128 v[108:111], v66 offset:1984
    s_waitcnt lgkmcnt(2)
    v_mfma_f32_16x16x32_bf16 v[96:99], v[112:115], v[168:171], v[96:99]
    v_mfma_f32_16x16x32_bf16 v[92:95], v[112:115], v[164:167], v[92:95]
    v_mfma_f32_16x16x32_bf16 v[88:91], v[112:115], v[160:163], v[88:91]
    v_mfma_f32_16x16x32_bf16 v[80:83], v[112:115], v[152:155], v[80:83]
    ds_read_b128 v[112:115], v66 offset:2496
    s_waitcnt lgkmcnt(2)
    v_mfma_f32_16x16x32_bf16 v[96:99], v[116:119], v[164:167], v[96:99]
    v_mfma_f32_16x16x32_bf16 v[92:95], v[116:119], v[160:163], v[92:95]
    v_mfma_f32_16x16x32_bf16 v[88:91], v[116:119], v[156:159], v[88:91]
    ds_read_b128 v[116:119], v66 offset:3008
    s_waitcnt lgkmcnt(2)
    v_mfma_f32_16x16x32_bf16 v[96:99], v[108:111], v[160:163], v[96:99]
    v_mfma_f32_16x16x32_bf16 v[92:95], v[108:111], v[156:159], v[92:95]
    v_mfma_f32_16x16x32_bf16 v[88:91], v[108:111], v[152:155], v[88:91]
    s_waitcnt lgkmcnt(1)
    v_mfma_f32_16x16x32_bf16 v[96:99], v[112:115], v[156:159], v[96:99]
    v_mfma_f32_16x16x32_bf16 v[92:95], v[112:115], v[152:155], v[92:95]
    s_waitcnt lgkmcnt(0)
    v_mfma_f32_16x16x32_bf16 v[96:99], v[116:119], v[152:155], v[96:99]
    ds_write_b128 v74, v[76:79] offset:0
    ds_write_b128 v74, v[80:83] offset:1024
    s_nop 0
    ds_write_b128 v74, v[88:91] offset:3072
    s_nop 1
    ds_write_b128 v74, v[92:95] offset:4096
    s_nop 0
    ds_write_b128 v74, v[96:99] offset:5120
c_pw_end_66:
    s_waitcnt lgkmcnt(0)
    v_mov_b32 v3, 161796
    v_mov_b32 v4, 1
    s_mov_b64 exec, 1
    ds_add_u32 v3, v4
    s_mov_b64 exec, -1
    s_mov_b32 s67, 0
gsync_71:
    ds_read_b32 v4, v3
    s_add_u32 s67, s67, 1
    s_waitcnt lgkmcnt(0)
    v_readfirstlane_b32 s66, v4
    s_cmp_gt_u32 s67, 1000000
    s_cbranch_scc1 gsync_e_72
    s_cmp_lt_u32 s66, 24
    s_cbranch_scc1 gsync_71
gsync_e_72:
    s_mov_b64 exec, 0
    s_cmp_eq_u32 s34, 0
    s_cselect_b32 exec_lo, -1, exec_lo
    s_cselect_b32 exec_hi, -1, exec_hi
    s_cmp_eq_u32 s34, 1
    s_cselect_b32 exec_lo, 0, exec_lo
    s_cselect_b32 exec_hi, -1, exec_hi
    s_cmp_eq_u32 s34, 2
    s_cselect_b32 exec_lo, -1, exec_lo
    s_cselect_b32 exec_hi, -1, exec_hi
    s_cmp_eq_u32 s34, 3
    s_cselect_b32 exec_lo, 0, exec_lo
    s_cselect_b32 exec_hi, 0, exec_hi
    s_cbranch_execz c_fskip_74
    ds_read_b128 v[120:123], v75 offset:0
    ds_read_b128 v[124:127], v75 offset:16
    ds_read_b128 v[128:131], v75 offset:8192
    ds_read_b128 v[132:135], v75 offset:8208
    ds_read_b128 v[136:139], v75 offset:16384
    ds_read_b128 v[140:143], v75 offset:16400
    ds_read_b128 v[144:147], v75 offset:24576
    ds_read_b128 v[148:151], v75 offset:24592
    s_lshl_b32 s40, s58, 12
    s_add_u32 s40, s40, 8912896
    s_waitcnt lgkmcnt(0)
    v_pk_add_f32 v[120:121], v[120:121], v[128:129]
    v_pk_add_f32 v[136:137], v[136:137], v[144:145]
    v_pk_add_f32 v[122:123], v[122:123], v[130:131]
    v_pk_add_f32 v[138:139], v[138:139], v[146:147]
    v_pk_add_f32 v[124:125], v[124:125], v[132:133]
    v_pk_add_f32 v[140:141], v[140:141], v[148:149]
    v_pk_add_f32 v[126:127], v[126:127], v[134:135]
    v_pk_add_f32 v[142:143], v[142:143], v[150:151]
    v_pk_add_f32 v[120:121], v[120:121], v[136:137]
    v_pk_add_f32 v[122:123], v[122:123], v[138:139]
    v_pk_add_f32 v[124:125], v[124:125], v[140:141]
    v_pk_add_f32 v[126:127], v[126:127], v[142:143]
    v_cvt_pk_bf16_f32 v192, v120, v121
    v_cvt_pk_bf16_f32 v193, v122, v123
    v_cvt_pk_bf16_f32 v194, v124, v125
    v_cvt_pk_bf16_f32 v195, v126, v127
    buffer_store_dwordx4 v[192:195], v2, s[8:11], s40 offen sc1
c_fskip_74:
    s_mov_b64 exec, -1
    s_nop 1
c_halfE_56:
    s_waitcnt vmcnt(0) lgkmcnt(0)
    s_barrier
recurrent_scan__ssm_conv_h3__mixer_gmlp__prompt_kernel_end:
    s_endpgm
.section .rodata,"a"
.p2align 6
.amdhsa_kernel recurrent_scan__ssm_conv_h3__mixer_gmlp__prompt_kernel
  .amdhsa_next_free_vgpr 248
  .amdhsa_next_free_sgpr 102
  .amdhsa_accum_offset 248
  .amdhsa_group_segment_fixed_size 0
  .amdhsa_kernarg_size 112
  .amdhsa_user_sgpr_count 2
  .amdhsa_user_sgpr_kernarg_segment_ptr 1
  .amdhsa_system_sgpr_workgroup_id_x 1
.end_amdhsa_kernel
```

```asm
; @launch grid=(256,1,1) block=(512,1,1) lds=163840
.amdgcn_target "amdgcn-amd-amdhsa--gfx950"
.text
.globl recurrent_scan__ssm_conv_h3__mixer_gmlp__prompt_kernel
.p2align 8
.type recurrent_scan__ssm_conv_h3__mixer_gmlp__prompt_kernel,@function
recurrent_scan__ssm_conv_h3__mixer_gmlp__prompt_kernel:
    s_cmp_ge_u32 s2, 256
    s_cbranch_scc1 recurrent_scan__ssm_conv_h3__mixer_gmlp__prompt_kernel_end
    s_load_dwordx2 s[4:5], s[0:1], 0
    s_load_dwordx2 s[8:9], s[0:1], 56
    s_load_dwordx2 s[12:13], s[0:1], 8
    s_load_dwordx2 s[16:17], s[0:1], 16
    s_load_dwordx2 s[20:21], s[0:1], 24
    s_load_dwordx2 s[24:25], s[0:1], 104
    s_load_dwordx2 s[28:29], s[0:1], 96
    s_load_dwordx2 s[32:33], s[0:1], 64
    s_load_dwordx2 s[36:37], s[0:1], 32
    s_load_dwordx2 s[84:85], s[0:1], 80
    v_lshrrev_b32 v2, 6, v0
    v_and_b32 v1, 63, v0
    v_readfirstlane_b32 s42, v2
    v_lshrrev_b32 v2, 4, v1
    v_and_b32 v3, 15, v1
    s_and_b32 s48, s2, 7
    s_lshr_b32 s49, s2, 3
    s_lshr_b32 s66, s48, 1
    s_and_b32 s67, s48, 1
    s_lshl_b32 s40, s66, 3
    s_and_b32 s48, s49, 7
    s_add_u32 s40, s40, s48
    s_lshl_b32 s41, s67, 2
    s_lshr_b32 s48, s49, 3
    s_add_u32 s41, s41, s48
    s_mul_i32 s52, s40, 81920
    s_mul_i32 s54, s41, 192
    s_add_u32 s53, s54, 1536
    s_lshl_b32 s60, s42, 11
    s_mul_i32 s61, s42, 3072
    s_mov_b32 s6, 2621440
    s_mov_b32 s7, 0x20000
    s_mov_b32 s10, 1966080
    s_mov_b32 s11, 0x20000
    s_lshl_b32 s48, s42, 3
    v_add_u32 v4, s48, v2
    v_and_b32 v5, 15, v4
    v_xor_b32 v5, v5, v3
    v_mul_u32_u24 v4, 1280, v4
    v_lshl_add_u32 v38, v5, 4, v4
    v_add_u32 v4, s48, v2
    v_add_u32 v4, 4, v4
    v_and_b32 v5, 15, v4
    v_xor_b32 v5, v5, v3
    v_mul_u32_u24 v4, 1280, v4
    v_lshl_add_u32 v39, v5, 4, v4
    s_mul_i32 s48, s42, 192
    v_add_u32 v4, s48, v1
    v_mul_u32_u24 v5, 43691, v4
    v_lshrrev_b32 v5, 19, v5
    v_mul_u32_u24 v6, 12, v5
    v_sub_u32 v4, v4, v6
    v_lshrrev_b32 v6, 2, v5
    v_and_b32 v6, 2, v6
    v_xor_b32 v4, v4, v6
    v_mul_u32_u24 v5, 3072, v5
    v_lshl_add_u32 v40, v4, 4, v5
    v_add_u32 v4, s48, v1
    v_add_u32 v4, 64, v4
    v_mul_u32_u24 v5, 43691, v4
    v_lshrrev_b32 v5, 19, v5
    v_mul_u32_u24 v6, 12, v5
    v_sub_u32 v4, v4, v6
    v_lshrrev_b32 v6, 2, v5
    v_and_b32 v6, 2, v6
    v_xor_b32 v4, v4, v6
    v_mul_u32_u24 v5, 3072, v5
    v_lshl_add_u32 v41, v4, 4, v5
    v_add_u32 v4, s48, v1
    v_add_u32 v4, 128, v4
    v_mul_u32_u24 v5, 43691, v4
    v_lshrrev_b32 v5, 19, v5
    v_mul_u32_u24 v6, 12, v5
    v_sub_u32 v4, v4, v6
    v_lshrrev_b32 v6, 2, v5
    v_and_b32 v6, 2, v6
    v_xor_b32 v4, v4, v6
    v_mul_u32_u24 v5, 3072, v5
    v_lshl_add_u32 v42, v4, 4, v5
    s_add_u32 s48, s40, s41
    s_mul_i32 s49, s48, 52
    s_lshr_b32 s49, s49, 8
    s_mul_i32 s49, s49, 5
    s_sub_u32 s51, s48, s49
    s_add_u32 s49, s51, 0
    s_sub_u32 s50, s49, 5
    s_cmp_ge_u32 s49, 5
    s_cselect_b32 s49, s50, s49
    s_lshl_b32 s90, s49, 8
    s_mul_i32 s95, s49, 393216
    s_add_u32 s49, s51, 1
    s_sub_u32 s50, s49, 5
    s_cmp_ge_u32 s49, 5
    s_cselect_b32 s49, s50, s49
    s_lshl_b32 s91, s49, 8
    s_mul_i32 s96, s49, 393216
    s_waitcnt lgkmcnt(0)
    s_add_u32 s65, s52, s90
    s_add_u32 m0, s60, 0
    s_nop 0
    buffer_load_dwordx4 v38, s[4:7], s65 offen lds
    s_add_u32 s65, s52, s90
    s_add_u32 m0, s60, 1024
    s_nop 0
    buffer_load_dwordx4 v39, s[4:7], s65 offen lds
    s_add_u32 s65, s53, s95
    s_add_u32 m0, s61, 81920
    s_nop 0
    buffer_load_dwordx4 v40, s[8:11], s65 offen lds
    s_add_u32 s65, s53, s95
    s_add_u32 m0, s61, 82944
    s_nop 0
    buffer_load_dwordx4 v41, s[8:11], s65 offen lds
    s_add_u32 s65, s53, s95
    s_add_u32 m0, s61, 83968
    s_nop 0
    buffer_load_dwordx4 v42, s[8:11], s65 offen lds
    s_mov_b32 s48, 14712832
    s_load_dwordx2 s[100:101], s[24:25], s48
    s_add_u32 s49, s51, 2
    s_sub_u32 s50, s49, 5
    s_cmp_ge_u32 s49, 5
    s_cselect_b32 s49, s50, s49
    s_lshl_b32 s92, s49, 8
    s_mul_i32 s97, s49, 393216
    s_add_u32 s49, s51, 3
    s_sub_u32 s50, s49, 5
    s_cmp_ge_u32 s49, 5
    s_cselect_b32 s49, s50, s49
    s_lshl_b32 s93, s49, 8
    s_mul_i32 s98, s49, 393216
    s_add_u32 s49, s51, 4
    s_sub_u32 s50, s49, 5
    s_cmp_ge_u32 s49, 5
    s_cselect_b32 s49, s50, s49
    s_lshl_b32 s94, s49, 8
    s_mul_i32 s99, s49, 393216
    s_mov_b32 s14, 2621440
    s_mov_b32 s15, 0x20000
    s_mov_b32 s18, 2621440
    s_mov_b32 s19, 0x20000
    s_mov_b32 s22, 5120
    s_mov_b32 s23, 0x20000
    s_mov_b32 s26, 15990784
    s_mov_b32 s27, 0x20000
    s_mov_b32 s30, 256
    s_mov_b32 s31, 0x20000
    s_mov_b32 s34, 8388608
    s_mov_b32 s35, 0x20000
    s_mov_b32 s38, 2621440
    s_mov_b32 s39, 0x20000
    s_mov_b32 s86, 983040
    s_mov_b32 s87, 0x20000
    v_lshlrev_b32 v36, 7, v1
    v_mov_b32 v4, 161792
    v_mov_b32 v8, 0
    v_mov_b32 v9, 0
    ds_write_b64 v4, v[8:9]
    s_barrier
    s_add_u32 s65, s52, s91
    s_add_u32 m0, s60, 16384
    s_nop 0
    buffer_load_dwordx4 v38, s[4:7], s65 offen lds
    s_add_u32 s65, s52, s91
    s_add_u32 m0, s60, 17408
    s_nop 0
    buffer_load_dwordx4 v39, s[4:7], s65 offen lds
    s_add_u32 s65, s53, s96
    s_add_u32 m0, s61, 106496
    s_nop 0
    buffer_load_dwordx4 v40, s[8:11], s65 offen lds
    s_add_u32 s65, s53, s96
    s_add_u32 m0, s61, 107520
    s_nop 0
    buffer_load_dwordx4 v41, s[8:11], s65 offen lds
    s_add_u32 s65, s53, s96
    s_add_u32 m0, s61, 108544
    s_nop 0
    buffer_load_dwordx4 v42, s[8:11], s65 offen lds
    s_cmp_lg_u32 s42, 7
    s_cbranch_scc1 k1_shk_1
    v_lshlrev_b32 v4, 4, v1
    s_mul_i32 s48, s41, 640
    s_mov_b32 m0, 160768
    s_mov_b32 exec_lo, -1
    s_mov_b32 exec_hi, 0xff
    buffer_load_dwordx4 v4, s[20:23], s48 offen lds
    s_mov_b64 exec, -1
k1_shk_1:
    s_and_b32 s43, s42, 1
    s_lshr_b32 s44, s42, 1
    s_and_b32 s44, s44, 1
    s_lshr_b32 s45, s42, 2
    s_xor_b32 s46, s43, s45
    s_lshl_b32 s47, s44, 1
    s_add_u32 s47, s47, s46
    s_mov_b32 s55, 0x3727c5ac
    s_mov_b32 s56, 0x3f803f80
    s_mov_b32 s58, 0xbdd2d3e8
    s_mov_b32 s59, 0xbdd2d3e8
    s_lshl_b32 s48, s45, 1
    s_add_u32 s63, s48, s44
    s_xor_b32 s64, s63, 1
    v_xor_b32 v4, v2, v3
    v_lshlrev_b32 v6, 8, v3
    s_lshl_b32 s48, s44, 13
    s_lshl_b32 s49, s46, 12
    s_add_u32 s50, s48, s49
    s_xor_b32 s49, s49, 4096
    s_add_u32 s51, s48, s49
    s_lshl_b32 s48, s63, 2
    v_xor_b32 v5, s48, v4
    v_lshl_add_u32 v5, v5, 4, v6
    v_add_u32 v45, s50, v5
    v_add_u32 v46, s51, v5
    s_lshl_b32 s48, s64, 2
    v_xor_b32 v5, s48, v4
    v_lshl_add_u32 v5, v5, 4, v6
    v_add_u32 v47, s50, v5
    v_add_u32 v216, s51, v5
    v_lshrrev_b32 v5, 2, v3
    v_lshl_add_u32 v4, v2, 3, v5
    v_mul_u32_u24 v4, 192, v4
    v_and_b32 v5, 3, v3
    v_lshl_add_u32 v4, v5, 3, v4
    v_and_b32 v5, 1, v2
    s_mul_i32 s51, s43, 3
    s_mul_i32 s49, s63, 6144
    s_add_u32 s49, s49, 81920
    s_mul_i32 s50, s64, 6144
    s_add_u32 s50, s50, 81920
    s_add_u32 s48, s51, 0
    v_xor_b32 v6, s48, v5
    v_lshl_add_u32 v6, v6, 5, v4
    v_add_u32 v217, s49, v6
    v_add_u32 v220, s50, v6
    s_add_u32 s48, s51, 1
    v_xor_b32 v6, s48, v5
    v_lshl_add_u32 v6, v6, 5, v4
    v_add_u32 v218, s49, v6
    v_add_u32 v221, s50, v6
    s_add_u32 s48, s51, 2
    v_xor_b32 v6, s48, v5
    v_lshl_add_u32 v6, v6, 5, v4
    v_add_u32 v219, s49, v6
    v_add_u32 v222, s50, v6
    v_mov_b32 v244, s56
    v_mov_b32 v245, s56
    v_mov_b32 v246, s56
    v_mov_b32 v247, s56
    v_mul_u32_u24 v43, 205, v1
    v_lshrrev_b32 v43, 11, v43
    v_mul_u32_u24 v4, 10, v43
    v_sub_u32 v44, v1, v4
    s_lshl_b32 s48, s42, 3
    v_lshl_add_u32 v4, v43, 1, s48
    v_min_u32 v4, 62, v4
    v_mul_u32_u24 v4, 160, v4
    v_lshl_add_u32 v7, v44, 4, v4
    v_lshlrev_b32 v215, 10, v1
    s_lshl_b32 s89, s2, 3
    s_add_u32 s89, s89, s42
    s_mul_i32 s70, s42, 3072
    s_add_u32 s70, s70, 16384
    s_xor_b32 s48, s42, 4
    s_mul_i32 s71, s48, 3072
    s_add_u32 s71, s71, 16384
    s_lshl_b32 s48, s43, 2
    s_lshl_b32 s49, s44, 1
    s_add_u32 s48, s48, s49
    s_add_u32 s48, s48, s45
    s_mul_i32 s72, s48, 192
    s_add_u32 s72, s72, 155648
    s_mul_i32 s73, s43, 768
    s_add_u32 s73, s73, 155648
    s_lshl_b32 s48, s47, 1
    s_add_u32 s48, s48, s45
    s_lshl_b32 s48, s48, 7
    s_add_u32 s74, s48, 158720
    s_lshl_b32 s48, s47, 8
    s_add_u32 s75, s48, 158720
    s_lshl_b32 s48, s47, 7
    s_lshl_b32 s49, s43, 9
    s_add_u32 s48, s48, s49
    s_add_u32 s76, s48, 159744
    s_lshl_b32 s48, s40, 3
    s_add_u32 s48, s48, s41
    s_lshl_b32 s49, s48, 10
    s_add_u32 s77, s49, 14745600
    s_mov_b32 s48, 0
    s_lshr_b32 s49, s47, 1
    s_mul_i32 s49, s49, 6144
    s_add_u32 s48, s48, s49
    s_and_b32 s49, s47, 1
    s_lshl_b32 s49, s49, 8
    s_add_u32 s48, s48, s49
    s_add_u32 s48, s48, 73728
    s_mul_i32 s49, s43, 3
    s_add_u32 s49, s49, 0
    s_lshr_b32 s50, s49, 1
    s_lshl_b32 s50, s50, 10
    s_and_b32 s49, s49, 1
    s_lshl_b32 s49, s49, 3
    s_add_u32 s80, s48, s49
    s_add_u32 s80, s80, s50
    s_mul_i32 s49, s43, 3
    s_add_u32 s49, s49, 1
    s_lshr_b32 s50, s49, 1
    s_lshl_b32 s50, s50, 10
    s_and_b32 s49, s49, 1
    s_lshl_b32 s49, s49, 3
    s_add_u32 s81, s48, s49
    s_add_u32 s81, s81, s50
    s_mul_i32 s49, s43, 3
    s_add_u32 s49, s49, 2
    s_lshr_b32 s50, s49, 1
    s_lshl_b32 s50, s50, 10
    s_and_b32 s49, s49, 1
    s_lshl_b32 s49, s49, 3
    s_add_u32 s82, s48, s49
    s_add_u32 s82, s82, s50
    s_lshl_b32 s48, s40, 13
    s_lshl_b32 s49, s47, 8
    s_add_u32 s48, s48, s49
    s_add_u32 s78, s48, 14745600
    s_lshl_b32 s48, s40, 9
    s_lshl_b32 s49, s47, 7
    s_add_u32 s48, s48, s49
    s_add_u32 s79, s48, 14680064
    s_mul_i32 s48, s41, 327680
    s_lshl_b32 s49, s40, 7
    s_add_u32 s48, s48, s49
    s_add_u32 s83, s48, 6291456
    s_lshr_b32 s48, s2, 3
    s_lshl_b32 s48, s48, 3
    s_add_u32 s48, s48, s42
    s_lshl_b32 s48, s48, 13
    s_lshl_b32 s49, s66, 21
    s_add_u32 s66, s48, s49
    s_add_u32 s51, s42, 0
    s_mul_i32 s48, s51, 43
    s_lshr_b32 s48, s48, 7
    s_mul_i32 s49, s48, 3
    s_sub_u32 s49, s51, s49
    s_mul_i32 s48, s48, 3200
    s_lshl_b32 s49, s49, 6
    s_add_u32 s48, s48, s49
    s_add_u32 s88, s48, 0
    s_lshl_b32 s48, s41, 7
    s_lshl_b32 s49, s40, 2
    s_add_u32 s48, s48, s49
    s_mul_i32 s48, s48, 3
    s_add_u32 s48, s48, s51
    s_lshl_b32 s48, s48, 10
    s_add_u32 s64, s48, 0
    s_add_u32 s51, s42, 8
    s_mul_i32 s48, s51, 43
    s_lshr_b32 s48, s48, 7
    s_mul_i32 s49, s48, 3
    s_sub_u32 s49, s51, s49
    s_mul_i32 s48, s48, 3200
    s_lshl_b32 s49, s49, 6
    s_add_u32 s48, s48, s49
    s_add_u32 s63, s48, 0
    s_lshl_b32 s48, s41, 7
    s_lshl_b32 s49, s40, 2
    s_add_u32 s48, s48, s49
    s_mul_i32 s48, s48, 3
    s_add_u32 s48, s48, s51
    s_lshl_b32 s48, s48, 10
    s_add_u32 s67, s48, 0
    s_waitcnt vmcnt(5)
    s_waitcnt lgkmcnt(0)
    s_add_u32 s100, s100, 1
    s_addc_u32 s101, s101, 0
    s_barrier
    ds_read_b64_tr_b16 v[128:129], v217 offset:0
    ds_read_b64_tr_b16 v[130:131], v217 offset:768
    ds_read_b64_tr_b16 v[132:133], v218 offset:0
    ds_read_b64_tr_b16 v[134:135], v218 offset:768
    ds_read_b64_tr_b16 v[136:137], v219 offset:0
    ds_read_b64_tr_b16 v[138:139], v219 offset:768
    ds_read_b64_tr_b16 v[140:141], v220 offset:0
    ds_read_b64_tr_b16 v[142:143], v220 offset:768
    ds_read_b64_tr_b16 v[144:145], v221 offset:0
    ds_read_b64_tr_b16 v[146:147], v221 offset:768
    ds_read_b64_tr_b16 v[148:149], v222 offset:0
    ds_read_b64_tr_b16 v[150:151], v222 offset:768
    ds_read_b128 v[48:51], v45 offset:0
    ds_read_b128 v[52:55], v46 offset:0
    ds_read_b128 v[56:59], v47 offset:0
    ds_read_b128 v[60:63], v216 offset:0
    s_add_u32 s65, s52, s92
    s_add_u32 m0, s60, 32768
    s_nop 0
    buffer_load_dwordx4 v38, s[4:7], s65 offen lds
    s_add_u32 s65, s52, s92
    s_add_u32 m0, s60, 33792
    s_nop 0
    buffer_load_dwordx4 v39, s[4:7], s65 offen lds
    s_add_u32 s65, s53, s97
    s_add_u32 m0, s61, 131072
    s_nop 0
    buffer_load_dwordx4 v40, s[8:11], s65 offen lds
    s_add_u32 s65, s53, s97
    s_add_u32 m0, s61, 132096
    s_nop 0
    buffer_load_dwordx4 v41, s[8:11], s65 offen lds
    s_add_u32 s65, s53, s97
    s_add_u32 m0, s61, 133120
    s_nop 0
    buffer_load_dwordx4 v42, s[8:11], s65 offen lds
    s_waitcnt vmcnt(5)
    s_waitcnt lgkmcnt(0)
    s_barrier
    v_mfma_f32_16x16x32_bf16 v[176:179], v[128:131], v[48:51], 0
    ds_read_b64_tr_b16 v[152:153], v217 offset:24576
    ds_read_b64_tr_b16 v[154:155], v217 offset:25344
    v_mfma_f32_16x16x32_bf16 v[180:183], v[128:131], v[52:55], 0
    s_add_u32 s65, s52, s93
    s_add_u32 m0, s60, 49152
    s_nop 0
    buffer_load_dwordx4 v38, s[4:7], s65 offen lds
    ds_read_b64_tr_b16 v[156:157], v218 offset:24576
    ds_read_b64_tr_b16 v[158:159], v218 offset:25344
    v_mfma_f32_16x16x32_bf16 v[224:227], v[128:131], v[244:247], 0
    ds_read_b64_tr_b16 v[160:161], v219 offset:24576
    ds_read_b64_tr_b16 v[162:163], v219 offset:25344
    v_mfma_f32_16x16x32_bf16 v[184:187], v[132:135], v[48:51], 0
    ds_read_b64_tr_b16 v[164:165], v220 offset:24576
    ds_read_b64_tr_b16 v[166:167], v220 offset:25344
    v_mfma_f32_16x16x32_bf16 v[188:191], v[132:135], v[52:55], 0
    s_add_u32 s65, s52, s93
    s_add_u32 m0, s60, 50176
    s_nop 0
    buffer_load_dwordx4 v39, s[4:7], s65 offen lds
    ds_read_b64_tr_b16 v[168:169], v221 offset:24576
    ds_read_b64_tr_b16 v[170:171], v221 offset:25344
    v_mfma_f32_16x16x32_bf16 v[228:231], v[132:135], v[244:247], 0
    ds_read_b64_tr_b16 v[172:173], v222 offset:24576
    ds_read_b64_tr_b16 v[174:175], v222 offset:25344
    v_mfma_f32_16x16x32_bf16 v[192:195], v[136:139], v[48:51], 0
    ds_read_b128 v[64:67], v45 offset:16384
    ds_read_b128 v[68:71], v46 offset:16384
    v_mfma_f32_16x16x32_bf16 v[196:199], v[136:139], v[52:55], 0
    s_add_u32 s65, s53, s98
    s_add_u32 m0, s61, 81920
    s_nop 0
    buffer_load_dwordx4 v40, s[8:11], s65 offen lds
    ds_read_b128 v[72:75], v47 offset:16384
    ds_read_b128 v[76:79], v216 offset:16384
    v_mfma_f32_16x16x32_bf16 v[232:235], v[136:139], v[244:247], 0
    v_mfma_f32_16x16x32_bf16 v[236:239], v[244:247], v[48:51], 0
    v_mfma_f32_16x16x32_bf16 v[240:243], v[48:51], v[48:51], 0
    s_add_u32 s65, s53, s98
    s_add_u32 m0, s61, 82944
    s_nop 0
    buffer_load_dwordx4 v41, s[8:11], s65 offen lds
    v_mfma_f32_16x16x32_bf16 v[176:179], v[140:143], v[56:59], v[176:179]
    v_mfma_f32_16x16x32_bf16 v[180:183], v[140:143], v[60:63], v[180:183]
    v_mfma_f32_16x16x32_bf16 v[184:187], v[144:147], v[56:59], v[184:187]
    s_add_u32 s65, s53, s98
    s_add_u32 m0, s61, 83968
    s_nop 0
    buffer_load_dwordx4 v42, s[8:11], s65 offen lds
    v_mfma_f32_16x16x32_bf16 v[188:191], v[144:147], v[60:63], v[188:191]
    v_mfma_f32_16x16x32_bf16 v[192:195], v[148:151], v[56:59], v[192:195]
    v_mfma_f32_16x16x32_bf16 v[196:199], v[148:151], v[60:63], v[196:199]
    v_mfma_f32_16x16x32_bf16 v[236:239], v[244:247], v[56:59], v[236:239]
    v_mfma_f32_16x16x32_bf16 v[240:243], v[56:59], v[56:59], v[240:243]
    s_waitcnt vmcnt(5)
    s_waitcnt lgkmcnt(0)
    s_barrier
    v_mfma_f32_16x16x32_bf16 v[176:179], v[152:155], v[64:67], v[176:179]
    ds_read_b64_tr_b16 v[128:129], v217 offset:49152
    ds_read_b64_tr_b16 v[130:131], v217 offset:49920
    v_mfma_f32_16x16x32_bf16 v[180:183], v[152:155], v[68:71], v[180:183]
    s_add_u32 s65, s52, s94
    s_add_u32 m0, s60, 65536
    s_nop 0
    buffer_load_dwordx4 v38, s[4:7], s65 offen lds
    ds_read_b64_tr_b16 v[132:133], v218 offset:49152
    ds_read_b64_tr_b16 v[134:135], v218 offset:49920
    v_mfma_f32_16x16x32_bf16 v[224:227], v[152:155], v[244:247], v[224:227]
    ds_read_b64_tr_b16 v[136:137], v219 offset:49152
    ds_read_b64_tr_b16 v[138:139], v219 offset:49920
    v_mfma_f32_16x16x32_bf16 v[184:187], v[156:159], v[64:67], v[184:187]
    ds_read_b64_tr_b16 v[140:141], v220 offset:49152
    ds_read_b64_tr_b16 v[142:143], v220 offset:49920
    v_mfma_f32_16x16x32_bf16 v[188:191], v[156:159], v[68:71], v[188:191]
    s_add_u32 s65, s52, s94
    s_add_u32 m0, s60, 66560
    s_nop 0
    buffer_load_dwordx4 v39, s[4:7], s65 offen lds
    ds_read_b64_tr_b16 v[144:145], v221 offset:49152
    ds_read_b64_tr_b16 v[146:147], v221 offset:49920
    v_mfma_f32_16x16x32_bf16 v[228:231], v[156:159], v[244:247], v[228:231]
    ds_read_b64_tr_b16 v[148:149], v222 offset:49152
    ds_read_b64_tr_b16 v[150:151], v222 offset:49920
    v_mfma_f32_16x16x32_bf16 v[192:195], v[160:163], v[64:67], v[192:195]
    ds_read_b128 v[80:83], v45 offset:32768
    ds_read_b128 v[84:87], v46 offset:32768
    v_mfma_f32_16x16x32_bf16 v[196:199], v[160:163], v[68:71], v[196:199]
    s_add_u32 s65, s53, s99
    s_add_u32 m0, s61, 106496
    s_nop 0
    buffer_load_dwordx4 v40, s[8:11], s65 offen lds
    ds_read_b128 v[88:91], v47 offset:32768
    ds_read_b128 v[92:95], v216 offset:32768
    v_mfma_f32_16x16x32_bf16 v[232:235], v[160:163], v[244:247], v[232:235]
    v_mfma_f32_16x16x32_bf16 v[236:239], v[244:247], v[64:67], v[236:239]
    v_mfma_f32_16x16x32_bf16 v[240:243], v[64:67], v[64:67], v[240:243]
    s_add_u32 s65, s53, s99
    s_add_u32 m0, s61, 107520
    s_nop 0
    buffer_load_dwordx4 v41, s[8:11], s65 offen lds
    v_mfma_f32_16x16x32_bf16 v[176:179], v[164:167], v[72:75], v[176:179]
    v_mfma_f32_16x16x32_bf16 v[180:183], v[164:167], v[76:79], v[180:183]
    v_mfma_f32_16x16x32_bf16 v[184:187], v[168:171], v[72:75], v[184:187]
    s_add_u32 s65, s53, s99
    s_add_u32 m0, s61, 108544
    s_nop 0
    buffer_load_dwordx4 v42, s[8:11], s65 offen lds
    v_mfma_f32_16x16x32_bf16 v[188:191], v[168:171], v[76:79], v[188:191]
    v_mfma_f32_16x16x32_bf16 v[192:195], v[172:175], v[72:75], v[192:195]
    v_mfma_f32_16x16x32_bf16 v[196:199], v[172:175], v[76:79], v[196:199]
    v_mfma_f32_16x16x32_bf16 v[236:239], v[244:247], v[72:75], v[236:239]
    v_mfma_f32_16x16x32_bf16 v[240:243], v[72:75], v[72:75], v[240:243]
    s_waitcnt vmcnt(5)
    s_waitcnt lgkmcnt(0)
    s_barrier
    v_mfma_f32_16x16x32_bf16 v[176:179], v[128:131], v[80:83], v[176:179]
    ds_read_b64_tr_b16 v[152:153], v217 offset:0
    ds_read_b64_tr_b16 v[154:155], v217 offset:768
    v_mfma_f32_16x16x32_bf16 v[180:183], v[128:131], v[84:87], v[180:183]
    s_add_u32 s65, s54, s95
    s_add_u32 m0, s61, 131072
    s_nop 0
    buffer_load_dwordx4 v40, s[8:11], s65 offen lds
    ds_read_b64_tr_b16 v[156:157], v218 offset:0
    ds_read_b64_tr_b16 v[158:159], v218 offset:768
    v_mfma_f32_16x16x32_bf16 v[224:227], v[128:131], v[244:247], v[224:227]
    ds_read_b64_tr_b16 v[160:161], v219 offset:0
    ds_read_b64_tr_b16 v[162:163], v219 offset:768
    v_mfma_f32_16x16x32_bf16 v[184:187], v[132:135], v[80:83], v[184:187]
    ds_read_b64_tr_b16 v[164:165], v220 offset:0
    ds_read_b64_tr_b16 v[166:167], v220 offset:768
    v_mfma_f32_16x16x32_bf16 v[188:191], v[132:135], v[84:87], v[188:191]
    s_add_u32 s65, s54, s95
    s_add_u32 m0, s61, 132096
    s_nop 0
    buffer_load_dwordx4 v41, s[8:11], s65 offen lds
    ds_read_b64_tr_b16 v[168:169], v221 offset:0
    ds_read_b64_tr_b16 v[170:171], v221 offset:768
    v_mfma_f32_16x16x32_bf16 v[228:231], v[132:135], v[244:247], v[228:231]
    ds_read_b64_tr_b16 v[172:173], v222 offset:0
    ds_read_b64_tr_b16 v[174:175], v222 offset:768
    v_mfma_f32_16x16x32_bf16 v[192:195], v[136:139], v[80:83], v[192:195]
    ds_read_b128 v[96:99], v45 offset:49152
    ds_read_b128 v[100:103], v46 offset:49152
    v_mfma_f32_16x16x32_bf16 v[196:199], v[136:139], v[84:87], v[196:199]
    s_add_u32 s65, s54, s95
    s_add_u32 m0, s61, 133120
    s_nop 0
    buffer_load_dwordx4 v42, s[8:11], s65 offen lds
    ds_read_b128 v[104:107], v47 offset:49152
    ds_read_b128 v[108:111], v216 offset:49152
    v_mfma_f32_16x16x32_bf16 v[232:235], v[136:139], v[244:247], v[232:235]
    v_mfma_f32_16x16x32_bf16 v[236:239], v[244:247], v[80:83], v[236:239]
    v_mfma_f32_16x16x32_bf16 v[240:243], v[80:83], v[80:83], v[240:243]
    s_mul_i32 s48, s89, 1280
    s_add_u32 s48, s48, 0
    s_mov_b64 exec, 0x1f
    buffer_load_dword v37, v36, s[36:39], s48 offen
    s_mov_b64 exec, -1
    v_mfma_f32_16x16x32_bf16 v[176:179], v[140:143], v[88:91], v[176:179]
    v_mfma_f32_16x16x32_bf16 v[180:183], v[140:143], v[92:95], v[180:183]
    v_mfma_f32_16x16x32_bf16 v[184:187], v[144:147], v[88:91], v[184:187]
    v_mfma_f32_16x16x32_bf16 v[188:191], v[144:147], v[92:95], v[188:191]
    v_mfma_f32_16x16x32_bf16 v[192:195], v[148:151], v[88:91], v[192:195]
    v_mfma_f32_16x16x32_bf16 v[196:199], v[148:151], v[92:95], v[196:199]
    v_mfma_f32_16x16x32_bf16 v[236:239], v[244:247], v[88:91], v[236:239]
    v_mfma_f32_16x16x32_bf16 v[240:243], v[88:91], v[88:91], v[240:243]
    s_waitcnt vmcnt(4)
    s_waitcnt lgkmcnt(0)
    s_barrier
    v_mfma_f32_16x16x32_bf16 v[176:179], v[152:155], v[96:99], v[176:179]
    ds_read_b64_tr_b16 v[128:129], v217 offset:24576
    ds_read_b64_tr_b16 v[130:131], v217 offset:25344
    v_mfma_f32_16x16x32_bf16 v[180:183], v[152:155], v[100:103], v[180:183]
    s_add_u32 s65, s54, s96
    s_add_u32 m0, s61, 81920
    s_nop 0
    buffer_load_dwordx4 v40, s[8:11], s65 offen lds
    ds_read_b64_tr_b16 v[132:133], v218 offset:24576
    ds_read_b64_tr_b16 v[134:135], v218 offset:25344
    v_mfma_f32_16x16x32_bf16 v[224:227], v[152:155], v[244:247], v[224:227]
    ds_read_b64_tr_b16 v[136:137], v219 offset:24576
    ds_read_b64_tr_b16 v[138:139], v219 offset:25344
    v_mfma_f32_16x16x32_bf16 v[184:187], v[156:159], v[96:99], v[184:187]
    ds_read_b64_tr_b16 v[140:141], v220 offset:24576
    ds_read_b64_tr_b16 v[142:143], v220 offset:25344
    v_mfma_f32_16x16x32_bf16 v[188:191], v[156:159], v[100:103], v[188:191]
    s_add_u32 s65, s54, s96
    s_add_u32 m0, s61, 82944
    s_nop 0
    buffer_load_dwordx4 v41, s[8:11], s65 offen lds
    ds_read_b64_tr_b16 v[144:145], v221 offset:24576
    ds_read_b64_tr_b16 v[146:147], v221 offset:25344
    v_mfma_f32_16x16x32_bf16 v[228:231], v[156:159], v[244:247], v[228:231]
    ds_read_b64_tr_b16 v[148:149], v222 offset:24576
    ds_read_b64_tr_b16 v[150:151], v222 offset:25344
    v_mfma_f32_16x16x32_bf16 v[192:195], v[160:163], v[96:99], v[192:195]
    v_add_u32 v45, 0x10000, v45
    v_add_u32 v46, 0x10000, v46
    v_add_u32 v47, 0x10000, v47
    v_add_u32 v216, 0x10000, v216
    ds_read_b128 v[112:115], v45 offset:0
    ds_read_b128 v[116:119], v46 offset:0
    v_mfma_f32_16x16x32_bf16 v[196:199], v[160:163], v[100:103], v[196:199]
    s_add_u32 s65, s54, s96
    s_add_u32 m0, s61, 83968
    s_nop 0
    buffer_load_dwordx4 v42, s[8:11], s65 offen lds
    ds_read_b128 v[120:123], v47 offset:0
    ds_read_b128 v[124:127], v216 offset:0
    v_mfma_f32_16x16x32_bf16 v[232:235], v[160:163], v[244:247], v[232:235]
    v_mfma_f32_16x16x32_bf16 v[236:239], v[244:247], v[96:99], v[236:239]
    v_mfma_f32_16x16x32_bf16 v[240:243], v[96:99], v[96:99], v[240:243]
    v_mfma_f32_16x16x32_bf16 v[176:179], v[164:167], v[104:107], v[176:179]
    v_mfma_f32_16x16x32_bf16 v[180:183], v[164:167], v[108:111], v[180:183]
    v_mfma_f32_16x16x32_bf16 v[184:187], v[168:171], v[104:107], v[184:187]
    v_mfma_f32_16x16x32_bf16 v[188:191], v[168:171], v[108:111], v[188:191]
    v_mfma_f32_16x16x32_bf16 v[192:195], v[172:175], v[104:107], v[192:195]
    v_mfma_f32_16x16x32_bf16 v[196:199], v[172:175], v[108:111], v[196:199]
    v_mfma_f32_16x16x32_bf16 v[236:239], v[244:247], v[104:107], v[236:239]
    v_mfma_f32_16x16x32_bf16 v[240:243], v[104:107], v[104:107], v[240:243]
    s_waitcnt vmcnt(4)
    s_waitcnt lgkmcnt(0)
    s_barrier
    v_mfma_f32_16x16x32_bf16 v[176:179], v[128:131], v[112:115], v[176:179]
    ds_read_b64_tr_b16 v[152:153], v217 offset:49152
    ds_read_b64_tr_b16 v[154:155], v217 offset:49920
    v_mfma_f32_16x16x32_bf16 v[180:183], v[128:131], v[116:119], v[180:183]
    s_add_u32 s65, s54, s97
    s_add_u32 m0, s61, 106496
    s_nop 0
    buffer_load_dwordx4 v40, s[8:11], s65 offen lds
    ds_read_b64_tr_b16 v[156:157], v218 offset:49152
    ds_read_b64_tr_b16 v[158:159], v218 offset:49920
    v_mfma_f32_16x16x32_bf16 v[224:227], v[128:131], v[244:247], v[224:227]
    ds_read_b64_tr_b16 v[160:161], v219 offset:49152
    ds_read_b64_tr_b16 v[162:163], v219 offset:49920
    v_mfma_f32_16x16x32_bf16 v[184:187], v[132:135], v[112:115], v[184:187]
    ds_read_b64_tr_b16 v[164:165], v220 offset:49152
    ds_read_b64_tr_b16 v[166:167], v220 offset:49920
    v_mfma_f32_16x16x32_bf16 v[188:191], v[132:135], v[116:119], v[188:191]
    s_add_u32 s65, s54, s97
    s_add_u32 m0, s61, 107520
    s_nop 0
    buffer_load_dwordx4 v41, s[8:11], s65 offen lds
    ds_read_b64_tr_b16 v[168:169], v221 offset:49152
    ds_read_b64_tr_b16 v[170:171], v221 offset:49920
    v_mfma_f32_16x16x32_bf16 v[228:231], v[132:135], v[244:247], v[228:231]
    ds_read_b64_tr_b16 v[172:173], v222 offset:49152
    ds_read_b64_tr_b16 v[174:175], v222 offset:49920
    v_mfma_f32_16x16x32_bf16 v[192:195], v[136:139], v[112:115], v[192:195]
    v_mfma_f32_16x16x32_bf16 v[196:199], v[136:139], v[116:119], v[196:199]
    s_add_u32 s65, s54, s97
    s_add_u32 m0, s61, 108544
    s_nop 0
    buffer_load_dwordx4 v42, s[8:11], s65 offen lds
    v_mfma_f32_16x16x32_bf16 v[232:235], v[136:139], v[244:247], v[232:235]
    v_mfma_f32_16x16x32_bf16 v[236:239], v[244:247], v[112:115], v[236:239]
    v_mfma_f32_16x16x32_bf16 v[240:243], v[112:115], v[112:115], v[240:243]
    v_mfma_f32_16x16x32_bf16 v[176:179], v[140:143], v[120:123], v[176:179]
    v_mfma_f32_16x16x32_bf16 v[180:183], v[140:143], v[124:127], v[180:183]
    v_mfma_f32_16x16x32_bf16 v[184:187], v[144:147], v[120:123], v[184:187]
    v_mfma_f32_16x16x32_bf16 v[188:191], v[144:147], v[124:127], v[188:191]
    v_mfma_f32_16x16x32_bf16 v[192:195], v[148:151], v[120:123], v[192:195]
    v_mfma_f32_16x16x32_bf16 v[196:199], v[148:151], v[124:127], v[196:199]
    v_mfma_f32_16x16x32_bf16 v[236:239], v[244:247], v[120:123], v[236:239]
    v_mfma_f32_16x16x32_bf16 v[240:243], v[120:123], v[120:123], v[240:243]
    v_lshl_add_u32 v4, v1, 4, s70
    v_lshl_add_u32 v5, v2, 4, s72
    ds_write_b128 v4, v[180:183] offset:0
    s_nop 0
    ds_write_b128 v4, v[188:191] offset:1024
    s_nop 0
    ds_write_b128 v4, v[196:199] offset:2048
    s_mov_b32 exec_lo, 0x00010001
    s_mov_b32 exec_hi, 0x00010001
    ds_write_b128 v5, v[224:227] offset:0
    ds_write_b128 v5, v[228:231] offset:64
    ds_write_b128 v5, v[232:235] offset:128
    s_mov_b64 exec, -1
    v_and_b32 v8, 3, v3
    v_cmp_eq_u32 vcc, 1, v8
    s_nop 1
    v_cndmask_b32 v237, v240, v241, vcc
    v_cmp_eq_u32 vcc, 2, v8
    s_nop 1
    v_cndmask_b32 v237, v237, v242, vcc
    v_cmp_eq_u32 vcc, 3, v8
    s_nop 1
    v_cndmask_b32 v237, v237, v243, vcc
    v_lshl_add_u32 v6, v3, 3, s74
    s_mov_b32 exec_lo, 0x00F0000F
    s_mov_b32 exec_hi, 0xF0000F00
    ds_write_b64 v6, v[236:237]
    s_mov_b64 exec, -1
    v_pk_add_f32 v[200:201], v[176:177], 0
    v_pk_add_f32 v[202:203], v[178:179], 0
    v_pk_add_f32 v[204:205], v[184:185], 0
    v_pk_add_f32 v[206:207], v[186:187], 0
    v_pk_add_f32 v[208:209], v[192:193], 0
    v_pk_add_f32 v[210:211], v[194:195], 0
    v_mov_b32 v238, 0xc0135761
    v_mov_b32 v239, 0xc0135761
    s_waitcnt vmcnt(3)
    s_waitcnt lgkmcnt(0)
    s_barrier
    v_lshl_add_u32 v4, v1, 4, s71
    v_lshl_add_u32 v5, v3, 3, s75
    ds_read_b64 v[20:21], v5
    ds_read_b64 v[22:23], v5 offset:128
    ds_read_b128 v[8:11], v4 offset:0
    ds_read_b128 v[12:15], v4 offset:1024
    ds_read_b128 v[16:19], v4 offset:2048
    v_lshl_add_u32 v6, v2, 4, s73
    ds_read_b128 v[24:27], v6 offset:0
    ds_read_b128 v[28:31], v6 offset:64
    ds_read_b128 v[32:35], v6 offset:128
    ds_read_b128 v[176:179], v6 offset:192
    ds_read_b128 v[180:183], v6 offset:256
    ds_read_b128 v[184:187], v6 offset:320
    ds_read_b128 v[188:191], v6 offset:384
    ds_read_b128 v[192:195], v6 offset:448
    ds_read_b128 v[196:199], v6 offset:512
    ds_read_b128 v[224:227], v6 offset:576
    ds_read_b128 v[228:231], v6 offset:640
    ds_read_b128 v[232:235], v6 offset:704
    s_waitcnt lgkmcnt(15)
    v_pk_add_f32 v[240:241], v[20:21], v[22:23]
    v_mul_f32 v240, 0x3acccccd, v240
    v_mul_f32 v241, 0x3acccccd, v241
    v_fma_f32 v241, -v240, v240, v241
    v_max_f32 v241, 0, v241
    v_cvt_pk_bf16_f32 v241, v241, v240
    v_and_b32 v240, 0xffff0000, v241
    v_lshlrev_b32 v241, 16, v241
    v_add_f32 v241, s55, v241
    v_cvt_pk_bf16_f32 v241, v241, v241
    v_and_b32 v241, 0xffff0000, v241
    v_sqrt_f32 v241, v241
    s_nop 0
    v_cvt_pk_bf16_f32 v241, v241, v241
    v_and_b32 v241, 0xffff0000, v241
    v_rcp_f32 v241, v241
    s_nop 0
    v_mov_b32 v242, v241
    s_waitcnt lgkmcnt(12)
    v_pk_add_f32 v[200:201], v[200:201], v[8:9]
    v_pk_add_f32 v[202:203], v[202:203], v[10:11]
    v_pk_add_f32 v[204:205], v[204:205], v[12:13]
    v_pk_add_f32 v[206:207], v[206:207], v[14:15]
    v_pk_add_f32 v[208:209], v[208:209], v[16:17]
    v_pk_add_f32 v[210:211], v[210:211], v[18:19]
    s_waitcnt lgkmcnt(6)
    v_pk_add_f32 v[24:25], v[24:25], v[176:177]
    v_pk_add_f32 v[26:27], v[26:27], v[178:179]
    v_pk_add_f32 v[28:29], v[28:29], v[180:181]
    v_pk_add_f32 v[30:31], v[30:31], v[182:183]
    v_pk_add_f32 v[32:33], v[32:33], v[184:185]
    v_pk_add_f32 v[34:35], v[34:35], v[186:187]
    s_waitcnt lgkmcnt(0)
    v_pk_add_f32 v[188:189], v[188:189], v[224:225]
    v_pk_add_f32 v[190:191], v[190:191], v[226:227]
    v_pk_add_f32 v[192:193], v[192:193], v[228:229]
    v_pk_add_f32 v[194:195], v[194:195], v[230:231]
    v_pk_add_f32 v[196:197], v[196:197], v[232:233]
    v_pk_add_f32 v[198:199], v[198:199], v[234:235]
    v_pk_add_f32 v[24:25], v[24:25], v[188:189]
    v_pk_add_f32 v[26:27], v[26:27], v[190:191]
    v_pk_add_f32 v[28:29], v[28:29], v[192:193]
    v_pk_add_f32 v[30:31], v[30:31], v[194:195]
    v_pk_add_f32 v[32:33], v[32:33], v[196:197]
    v_pk_add_f32 v[34:35], v[34:35], v[198:199]
    v_pk_fma_f32 v[200:201], v[24:25], v[240:241], v[200:201] op_sel_hi:[1,0,1] neg_lo:[0,1,0] neg_hi:[0,1,0]
    v_pk_fma_f32 v[202:203], v[26:27], v[240:241], v[202:203] op_sel_hi:[1,0,1] neg_lo:[0,1,0] neg_hi:[0,1,0]
    v_pk_fma_f32 v[204:205], v[28:29], v[240:241], v[204:205] op_sel_hi:[1,0,1] neg_lo:[0,1,0] neg_hi:[0,1,0]
    v_pk_fma_f32 v[206:207], v[30:31], v[240:241], v[206:207] op_sel_hi:[1,0,1] neg_lo:[0,1,0] neg_hi:[0,1,0]
    v_pk_fma_f32 v[208:209], v[32:33], v[240:241], v[208:209] op_sel_hi:[1,0,1] neg_lo:[0,1,0] neg_hi:[0,1,0]
    v_pk_fma_f32 v[210:211], v[34:35], v[240:241], v[210:211] op_sel_hi:[1,0,1] neg_lo:[0,1,0] neg_hi:[0,1,0]
    v_pk_mul_f32 v[200:201], v[200:201], v[242:243] op_sel_hi:[1,0]
    v_pk_mul_f32 v[202:203], v[202:203], v[242:243] op_sel_hi:[1,0]
    v_pk_mul_f32 v[204:205], v[204:205], v[242:243] op_sel_hi:[1,0]
    v_pk_mul_f32 v[206:207], v[206:207], v[242:243] op_sel_hi:[1,0]
    v_pk_mul_f32 v[208:209], v[208:209], v[242:243] op_sel_hi:[1,0]
    v_pk_mul_f32 v[210:211], v[210:211], v[242:243] op_sel_hi:[1,0]
    v_pk_mul_f32 v[8:9], v[200:201], v[200:201]
    v_pk_mul_f32 v[10:11], v[202:203], v[202:203]
    v_pk_mul_f32 v[12:13], v[204:205], v[204:205]
    v_pk_mul_f32 v[14:15], v[206:207], v[206:207]
    v_pk_mul_f32 v[16:17], v[208:209], v[208:209]
    v_pk_mul_f32 v[18:19], v[210:211], v[210:211]
    v_pk_fma_f32 v[8:9], v[8:9], s[58:59], v[238:239]
    v_pk_fma_f32 v[10:11], v[10:11], s[58:59], v[238:239]
    v_pk_fma_f32 v[12:13], v[12:13], s[58:59], v[238:239]
    v_pk_fma_f32 v[14:15], v[14:15], s[58:59], v[238:239]
    v_pk_fma_f32 v[16:17], v[16:17], s[58:59], v[238:239]
    v_pk_fma_f32 v[18:19], v[18:19], s[58:59], v[238:239]
    v_pk_mul_f32 v[8:9], v[8:9], v[200:201]
    v_pk_mul_f32 v[10:11], v[10:11], v[202:203]
    v_pk_mul_f32 v[12:13], v[12:13], v[204:205]
    v_pk_mul_f32 v[14:15], v[14:15], v[206:207]
    v_pk_mul_f32 v[16:17], v[16:17], v[208:209]
    v_pk_mul_f32 v[18:19], v[18:19], v[210:211]
    v_exp_f32 v8, v8
    v_exp_f32 v9, v9
    v_exp_f32 v10, v10
    v_exp_f32 v11, v11
    v_exp_f32 v12, v12
    v_exp_f32 v13, v13
    v_exp_f32 v14, v14
    v_exp_f32 v15, v15
    v_exp_f32 v16, v16
    v_exp_f32 v17, v17
    v_exp_f32 v18, v18
    v_exp_f32 v19, v19
    v_pk_add_f32 v[8:9], v[8:9], 1.0 op_sel_hi:[1,0]
    v_pk_add_f32 v[10:11], v[10:11], 1.0 op_sel_hi:[1,0]
    v_pk_add_f32 v[12:13], v[12:13], 1.0 op_sel_hi:[1,0]
    v_pk_add_f32 v[14:15], v[14:15], 1.0 op_sel_hi:[1,0]
    v_pk_add_f32 v[16:17], v[16:17], 1.0 op_sel_hi:[1,0]
    v_pk_add_f32 v[18:19], v[18:19], 1.0 op_sel_hi:[1,0]
    v_rcp_f32 v8, v8
    v_rcp_f32 v9, v9
    v_rcp_f32 v10, v10
    v_rcp_f32 v11, v11
    v_rcp_f32 v12, v12
    v_rcp_f32 v13, v13
    v_rcp_f32 v14, v14
    v_rcp_f32 v15, v15
    v_rcp_f32 v16, v16
    v_rcp_f32 v17, v17
    v_rcp_f32 v18, v18
    v_rcp_f32 v19, v19
    v_pk_mul_f32 v[200:201], v[200:201], v[8:9]
    v_pk_mul_f32 v[202:203], v[202:203], v[10:11]
    v_pk_mul_f32 v[204:205], v[204:205], v[12:13]
    v_pk_mul_f32 v[206:207], v[206:207], v[14:15]
    v_pk_mul_f32 v[208:209], v[208:209], v[16:17]
    v_pk_mul_f32 v[210:211], v[210:211], v[18:19]
    v_pk_add_f32 v[14:15], v[200:201], v[202:203]
    v_pk_mul_f32 v[16:17], v[200:201], v[200:201]
    v_pk_add_f32 v[18:19], v[204:205], v[206:207]
    v_pk_fma_f32 v[16:17], v[202:203], v[202:203], v[16:17]
    v_pk_add_f32 v[20:21], v[208:209], v[210:211]
    v_pk_fma_f32 v[16:17], v[204:205], v[204:205], v[16:17]
    v_pk_add_f32 v[14:15], v[14:15], v[18:19]
    v_pk_fma_f32 v[16:17], v[206:207], v[206:207], v[16:17]
    v_pk_add_f32 v[14:15], v[14:15], v[20:21]
    v_pk_fma_f32 v[16:17], v[208:209], v[208:209], v[16:17]
    v_pk_fma_f32 v[16:17], v[210:211], v[210:211], v[16:17]
    v_add_f32 v8, v14, v15
    v_add_f32 v9, v16, v17
    v_lshl_add_u32 v4, v3, 3, s76
    v_mov_b32 v12, v8
    v_mov_b32 v13, v9
    s_nop 0
    v_permlane16_swap_b32 v8, v12
    v_permlane16_swap_b32 v9, v13
    v_add_f32 v8, v8, v12
    v_add_f32 v9, v9, v13
    v_mov_b32 v12, v8
    v_mov_b32 v13, v9
    s_nop 0
    v_permlane32_swap_b32 v8, v12
    v_permlane32_swap_b32 v9, v13
    v_add_f32 v8, v8, v12
    v_add_f32 v9, v9, v13
    s_mov_b64 exec, 0xffff
    ds_write_b64 v4, v[8:9]
    s_mov_b64 exec, -1
    s_or_b32 s48, s41, s43
    s_cmp_eq_u32 s48, 0
    v_lshlrev_b32 v4, 3, v3
    s_cselect_b64 exec, 0xffff, 0
    buffer_store_dwordx2 v[240:241], v4, s[24:27], s79 offen sc1
    s_mov_b64 exec, -1
    v_mfma_f32_16x16x32_bf16 v[176:179], v[152:155], v[48:51], 0
    ds_read_b64_tr_b16 v[128:129], v217 offset:0
    ds_read_b64_tr_b16 v[130:131], v217 offset:768
    v_mfma_f32_16x16x32_bf16 v[180:183], v[152:155], v[52:55], 0
    s_add_u32 s65, s54, s98
    s_add_u32 m0, s61, 131072
    s_nop 0
    buffer_load_dwordx4 v40, s[8:11], s65 offen lds
    ds_read_b64_tr_b16 v[132:133], v218 offset:0
    ds_read_b64_tr_b16 v[134:135], v218 offset:768
    v_mfma_f32_16x16x32_bf16 v[224:227], v[152:155], v[244:247], 0
    ds_read_b64_tr_b16 v[136:137], v219 offset:0
    ds_read_b64_tr_b16 v[138:139], v219 offset:768
    v_mfma_f32_16x16x32_bf16 v[184:187], v[156:159], v[48:51], 0
    ds_read_b64_tr_b16 v[140:141], v220 offset:0
    ds_read_b64_tr_b16 v[142:143], v220 offset:768
    v_mfma_f32_16x16x32_bf16 v[188:191], v[156:159], v[52:55], 0
    s_add_u32 s65, s54, s98
    s_add_u32 m0, s61, 132096
    s_nop 0
    buffer_load_dwordx4 v41, s[8:11], s65 offen lds
    ds_read_b64_tr_b16 v[144:145], v221 offset:0
    ds_read_b64_tr_b16 v[146:147], v221 offset:768
    v_mfma_f32_16x16x32_bf16 v[228:231], v[156:159], v[244:247], 0
    ds_read_b64_tr_b16 v[148:149], v222 offset:0
    ds_read_b64_tr_b16 v[150:151], v222 offset:768
    v_mfma_f32_16x16x32_bf16 v[192:195], v[160:163], v[48:51], 0
    v_mfma_f32_16x16x32_bf16 v[196:199], v[160:163], v[52:55], 0
    s_add_u32 s65, s54, s98
    s_add_u32 m0, s61, 133120
    s_nop 0
    buffer_load_dwordx4 v42, s[8:11], s65 offen lds
    v_mfma_f32_16x16x32_bf16 v[232:235], v[160:163], v[244:247], 0
    v_mfma_f32_16x16x32_bf16 v[176:179], v[164:167], v[56:59], v[176:179]
    v_mfma_f32_16x16x32_bf16 v[180:183], v[164:167], v[60:63], v[180:183]
    v_mul_u32_u24 v4, 1280, v43
    v_lshl_add_u32 v4, v44, 4, v4
    s_mul_i32 s51, s41, 160
    s_add_u32 s51, s51, s52
    s_mul_i32 s48, s42, 7680
    s_add_u32 s48, s48, s51
    s_sub_i32 s48, s48, 3840
    s_cmp_lt_i32 s48, 0
    s_cselect_b32 s49, 3840, 0
    s_add_u32 s48, s48, s49
    v_subrev_u32 v5, s49, v4
    s_mul_i32 s50, s42, 960
    s_add_u32 m0, s50, 65536
    s_mov_b32 exec_lo, -1
    s_mov_b32 exec_hi, 0xfffffff
    buffer_load_dwordx4 v5, s[12:15], s48 offen lds
    s_mov_b64 exec, -1
    v_mfma_f32_16x16x32_bf16 v[184:187], v[168:171], v[56:59], v[184:187]
    v_mfma_f32_16x16x32_bf16 v[188:191], v[168:171], v[60:63], v[188:191]
    v_mfma_f32_16x16x32_bf16 v[192:195], v[172:175], v[56:59], v[192:195]
    s_cmp_ge_u32 s42, 4
    s_mov_b32 exec_lo, -1
    s_mov_b32 exec_hi, 0xfffffff
    s_cbranch_scc1 k1_kvv_2
    s_mul_i32 s48, s42, 7680
    s_add_u32 s48, s48, s51
    s_add_u32 s48, s48, 57600
    s_mul_i32 s50, s42, 960
    s_add_u32 m0, s50, 73216
    s_nop 0
    buffer_load_dwordx4 v4, s[12:15], s48 offen lds
    s_branch k1_kve_3
k1_kvv_2:
    s_sub_u32 s49, s42, 4
    s_mul_i32 s48, s49, 7680
    s_add_u32 s48, s48, s51
    s_mul_i32 s50, s49, 960
    s_add_u32 m0, s50, 49152
    s_nop 0
    buffer_load_dwordx4 v4, s[16:19], s48 offen lds
k1_kve_3:
    s_mov_b64 exec, -1
    v_mfma_f32_16x16x32_bf16 v[196:199], v[172:175], v[60:63], v[196:199]
    s_add_u32 s49, s42, 4
    s_mul_i32 s48, s49, 7680
    s_add_u32 s48, s48, s51
    s_mul_i32 s50, s49, 960
    s_add_u32 m0, s50, 49152
    s_mov_b32 exec_lo, -1
    s_mov_b32 exec_hi, 0xfffffff
    buffer_load_dwordx4 v4, s[16:19], s48 offen lds
    s_mov_b64 exec, -1
    s_mul_i32 s48, s89, 1280
    s_add_u32 s48, s48, 640
    s_mov_b64 exec, 0x1f
    buffer_load_dword v37, v36, s[36:39], s48 offen
    s_mov_b64 exec, -1
    s_waitcnt vmcnt(8)
    s_waitcnt lgkmcnt(0)
    s_barrier
    s_cmp_lg_u32 s42, 0
    s_cbranch_scc1 k1_pub_4
    v_lshlrev_b32 v4, 3, v1
    v_add_u32 v5, 159744, v4
    ds_read_b64 v[8:9], v5
    ds_read_b64 v[12:13], v5 offset:512
    v_lshlrev_b32 v4, 4, v1
    v_mov_b32 v10, s100
    v_mov_b32 v11, s101
    s_waitcnt lgkmcnt(0)
    v_pk_add_f32 v[8:9], v[8:9], v[12:13]
k1_pub_4:
    s_cmp_eq_u32 s42, 0
    s_cselect_b64 exec, -1, 0
    buffer_store_dwordx4 v[8:11], v4, s[24:27], s77 offen sc1
    s_mov_b64 exec, -1
    v_mfma_f32_16x16x32_bf16 v[176:179], v[128:131], v[64:67], v[176:179]
    ds_read_b64_tr_b16 v[152:153], v217 offset:24576
    ds_read_b64_tr_b16 v[154:155], v217 offset:25344
    v_mfma_f32_16x16x32_bf16 v[180:183], v[128:131], v[68:71], v[180:183]
    s_add_u32 s65, s54, s99
    s_add_u32 m0, s61, 81920
    s_nop 0
    buffer_load_dwordx4 v40, s[8:11], s65 offen lds
    ds_read_b64_tr_b16 v[156:157], v218 offset:24576
    ds_read_b64_tr_b16 v[158:159], v218 offset:25344
    v_mfma_f32_16x16x32_bf16 v[224:227], v[128:131], v[244:247], v[224:227]
    ds_read_b64_tr_b16 v[160:161], v219 offset:24576
    ds_read_b64_tr_b16 v[162:163], v219 offset:25344
    v_mfma_f32_16x16x32_bf16 v[184:187], v[132:135], v[64:67], v[184:187]
    ds_read_b64_tr_b16 v[164:165], v220 offset:24576
    ds_read_b64_tr_b16 v[166:167], v220 offset:25344
    v_mfma_f32_16x16x32_bf16 v[188:191], v[132:135], v[68:71], v[188:191]
    s_add_u32 s65, s54, s99
    s_add_u32 m0, s61, 82944
    s_nop 0
    buffer_load_dwordx4 v41, s[8:11], s65 offen lds
    ds_read_b64_tr_b16 v[168:169], v221 offset:24576
    ds_read_b64_tr_b16 v[170:171], v221 offset:25344
    v_mfma_f32_16x16x32_bf16 v[228:231], v[132:135], v[244:247], v[228:231]
    ds_read_b64_tr_b16 v[172:173], v222 offset:24576
    ds_read_b64_tr_b16 v[174:175], v222 offset:25344
    v_mfma_f32_16x16x32_bf16 v[192:195], v[136:139], v[64:67], v[192:195]
    v_mfma_f32_16x16x32_bf16 v[196:199], v[136:139], v[68:71], v[196:199]
    s_add_u32 s65, s54, s99
    s_add_u32 m0, s61, 83968
    s_nop 0
    buffer_load_dwordx4 v42, s[8:11], s65 offen lds
    v_mfma_f32_16x16x32_bf16 v[232:235], v[136:139], v[244:247], v[232:235]
    v_mfma_f32_16x16x32_bf16 v[176:179], v[140:143], v[72:75], v[176:179]
    v_mfma_f32_16x16x32_bf16 v[180:183], v[140:143], v[76:79], v[180:183]
    v_mfma_f32_16x16x32_bf16 v[184:187], v[144:147], v[72:75], v[184:187]
    v_mfma_f32_16x16x32_bf16 v[188:191], v[144:147], v[76:79], v[188:191]
    v_mfma_f32_16x16x32_bf16 v[192:195], v[148:151], v[72:75], v[192:195]
    v_mfma_f32_16x16x32_bf16 v[196:199], v[148:151], v[76:79], v[196:199]
    s_waitcnt vmcnt(8)
    s_waitcnt lgkmcnt(0)
    s_barrier
    v_mfma_f32_16x16x32_bf16 v[176:179], v[152:155], v[80:83], v[176:179]
    ds_read_b64_tr_b16 v[128:129], v217 offset:49152
    ds_read_b64_tr_b16 v[130:131], v217 offset:49920
    v_mfma_f32_16x16x32_bf16 v[180:183], v[152:155], v[84:87], v[180:183]
    s_add_u32 s48, s66, 0
    s_mov_b64 exec, 0xff
    buffer_load_dword v37, v215, s[32:35], s48 offen
    s_mov_b64 exec, -1
    ds_read_b64_tr_b16 v[132:133], v218 offset:49152
    ds_read_b64_tr_b16 v[134:135], v218 offset:49920
    v_mfma_f32_16x16x32_bf16 v[224:227], v[152:155], v[244:247], v[224:227]
    ds_read_b64_tr_b16 v[136:137], v219 offset:49152
    ds_read_b64_tr_b16 v[138:139], v219 offset:49920
    v_mfma_f32_16x16x32_bf16 v[184:187], v[156:159], v[80:83], v[184:187]
    ds_read_b64_tr_b16 v[140:141], v220 offset:49152
    ds_read_b64_tr_b16 v[142:143], v220 offset:49920
    v_mfma_f32_16x16x32_bf16 v[188:191], v[156:159], v[84:87], v[188:191]
    s_add_u32 s48, s66, 128
    s_mov_b64 exec, 0xff
    buffer_load_dword v37, v215, s[32:35], s48 offen
    s_mov_b64 exec, -1
    ds_read_b64_tr_b16 v[144:145], v221 offset:49152
    ds_read_b64_tr_b16 v[146:147], v221 offset:49920
    v_mfma_f32_16x16x32_bf16 v[228:231], v[156:159], v[244:247], v[228:231]
    ds_read_b64_tr_b16 v[148:149], v222 offset:49152
    ds_read_b64_tr_b16 v[150:151], v222 offset:49920
    v_mfma_f32_16x16x32_bf16 v[192:195], v[160:163], v[80:83], v[192:195]
    v_mfma_f32_16x16x32_bf16 v[196:199], v[160:163], v[84:87], v[196:199]
    s_add_u32 s48, s66, 256
    s_mov_b64 exec, 0xff
    buffer_load_dword v37, v215, s[32:35], s48 offen
    s_mov_b64 exec, -1
    v_mfma_f32_16x16x32_bf16 v[232:235], v[160:163], v[244:247], v[232:235]
    v_mfma_f32_16x16x32_bf16 v[176:179], v[164:167], v[88:91], v[176:179]
    v_mfma_f32_16x16x32_bf16 v[180:183], v[164:167], v[92:95], v[180:183]
    s_add_u32 s48, s66, 384
    s_mov_b64 exec, 0xff
    buffer_load_dword v37, v215, s[32:35], s48 offen
    s_mov_b64 exec, -1
    v_mfma_f32_16x16x32_bf16 v[184:187], v[168:171], v[88:91], v[184:187]
    v_mfma_f32_16x16x32_bf16 v[188:191], v[168:171], v[92:95], v[188:191]
    v_mfma_f32_16x16x32_bf16 v[192:195], v[172:175], v[88:91], v[192:195]
    s_mul_i32 s48, s89, 512
    s_add_u32 s48, s48, 0
    s_mov_b64 exec, 0xf
    buffer_load_dword v37, v36, s[84:87], s48 offen
    s_mov_b64 exec, -1
    v_mfma_f32_16x16x32_bf16 v[196:199], v[172:175], v[92:95], v[196:199]
    s_waitcnt vmcnt(5)
    s_waitcnt lgkmcnt(0)
    s_barrier
    v_lshlrev_b32 v38, 4, v3
    v_lshl_add_u32 v38, v2, 11, v38
    buffer_load_dwordx4 v[28:31], v38, s[24:27], s78 offen sc1
    buffer_load_dwordx4 v[32:35], v38, s[24:27], s78 offen offset:1024 sc1
    v_mfma_f32_16x16x32_bf16 v[176:179], v[128:131], v[96:99], v[176:179]
    ds_read_b64_tr_b16 v[152:153], v217 offset:0
    ds_read_b64_tr_b16 v[154:155], v217 offset:768
    v_mfma_f32_16x16x32_bf16 v[180:183], v[128:131], v[100:103], v[180:183]
    s_add_u32 s48, s66, 512
    s_mov_b64 exec, 0xff
    buffer_load_dword v37, v215, s[32:35], s48 offen
    s_mov_b64 exec, -1
    ds_read_b64_tr_b16 v[156:157], v218 offset:0
    ds_read_b64_tr_b16 v[158:159], v218 offset:768
    v_mfma_f32_16x16x32_bf16 v[224:227], v[128:131], v[244:247], v[224:227]
    ds_read_b64_tr_b16 v[160:161], v219 offset:0
    ds_read_b64_tr_b16 v[162:163], v219 offset:768
    v_mfma_f32_16x16x32_bf16 v[184:187], v[132:135], v[96:99], v[184:187]
    ds_read_b64_tr_b16 v[164:165], v220 offset:0
    ds_read_b64_tr_b16 v[166:167], v220 offset:768
    v_mfma_f32_16x16x32_bf16 v[188:191], v[132:135], v[100:103], v[188:191]
    s_add_u32 s48, s66, 640
    s_mov_b64 exec, 0xff
    buffer_load_dword v37, v215, s[32:35], s48 offen
    s_mov_b64 exec, -1
    ds_read_b64_tr_b16 v[168:169], v221 offset:0
    ds_read_b64_tr_b16 v[170:171], v221 offset:768
    v_mfma_f32_16x16x32_bf16 v[228:231], v[132:135], v[244:247], v[228:231]
    ds_read_b64_tr_b16 v[172:173], v222 offset:0
    ds_read_b64_tr_b16 v[174:175], v222 offset:768
    v_mfma_f32_16x16x32_bf16 v[192:195], v[136:139], v[96:99], v[192:195]
    v_mfma_f32_16x16x32_bf16 v[196:199], v[136:139], v[100:103], v[196:199]
    s_add_u32 s48, s66, 768
    s_mov_b64 exec, 0xff
    buffer_load_dword v37, v215, s[32:35], s48 offen
    s_mov_b64 exec, -1
    v_mfma_f32_16x16x32_bf16 v[232:235], v[136:139], v[244:247], v[232:235]
    v_mfma_f32_16x16x32_bf16 v[176:179], v[140:143], v[104:107], v[176:179]
    v_mfma_f32_16x16x32_bf16 v[180:183], v[140:143], v[108:111], v[180:183]
    s_add_u32 s48, s66, 896
    s_mov_b64 exec, 0xff
    buffer_load_dword v37, v215, s[32:35], s48 offen
    s_mov_b64 exec, -1
    v_mfma_f32_16x16x32_bf16 v[184:187], v[144:147], v[104:107], v[184:187]
    v_mfma_f32_16x16x32_bf16 v[188:191], v[144:147], v[108:111], v[188:191]
    v_mfma_f32_16x16x32_bf16 v[192:195], v[148:151], v[104:107], v[192:195]
    v_mfma_f32_16x16x32_bf16 v[196:199], v[148:151], v[108:111], v[196:199]
    v_add_u32 v4, 65536, v7
    ds_read_b128 v[48:51], v4 offset:0
    ds_read_b128 v[52:55], v4 offset:160
    ds_read_b128 v[56:59], v4 offset:320
    ds_read_b128 v[60:63], v4 offset:480
    ds_read_b128 v[64:67], v4 offset:640
    v_add_u32 v4, 49152, v7
    ds_read_b128 v[68:71], v4
    ds_read_b128 v[72:75], v4 offset:160
    s_waitcnt lgkmcnt(0)
    v_mul_u32_u24 v7, 1152, v44
    v_lshlrev_b32 v102, 2, v43
    v_sub_u32 v7, v7, v102
    s_lshl_b32 s48, s42, 4
    s_add_u32 s48, s48, 106508
    v_add_u32 v7, s48, v7
    v_lshlrev_b32 v44, 6, v44
    v_add_u32 v44, 160768, v44
    ds_read_b128 v[104:107], v44 offset:0
    ds_read_b128 v[108:111], v44 offset:16
    v_lshlrev_b32 v76, 16, v48
    v_and_b32 v77, 0xffff0000, v48
    v_lshlrev_b32 v78, 16, v52
    v_and_b32 v79, 0xffff0000, v52
    v_lshlrev_b32 v80, 16, v56
    v_and_b32 v81, 0xffff0000, v56
    v_lshlrev_b32 v82, 16, v60
    v_and_b32 v83, 0xffff0000, v60
    v_lshlrev_b32 v84, 16, v64
    v_and_b32 v85, 0xffff0000, v64
    s_waitcnt lgkmcnt(0)
    v_lshlrev_b32 v86, 16, v104
    v_lshlrev_b32 v87, 16, v106
    v_and_b32 v88, 0xffff0000, v104
    v_and_b32 v89, 0xffff0000, v106
    v_lshlrev_b32 v90, 16, v105
    v_lshlrev_b32 v91, 16, v107
    v_and_b32 v92, 0xffff0000, v105
    v_and_b32 v93, 0xffff0000, v107
    v_pk_mul_f32 v[94:95], v[82:83], v[86:87]
    v_pk_mul_f32 v[96:97], v[84:85], v[86:87]
    v_pk_fma_f32 v[94:95], v[80:81], v[88:89], v[94:95]
    v_pk_fma_f32 v[96:97], v[82:83], v[88:89], v[96:97]
    v_pk_fma_f32 v[94:95], v[78:79], v[90:91], v[94:95]
    v_pk_fma_f32 v[96:97], v[80:81], v[90:91], v[96:97]
    v_pk_fma_f32 v[94:95], v[76:77], v[92:93], v[94:95]
    v_pk_fma_f32 v[96:97], v[78:79], v[92:93], v[96:97]
    v_lshlrev_b32 v98, 16, v68
    v_and_b32 v99, 0xffff0000, v68
    v_lshlrev_b32 v100, 16, v72
    v_and_b32 v101, 0xffff0000, v72
    v_pk_mul_f32 v[94:95], v[94:95], v[98:99]
    v_pk_mul_f32 v[96:97], v[96:97], v[100:101]
    v_cvt_pk_bf16_f32 v102, v96, v94
    v_cvt_pk_bf16_f32 v103, v97, v95
    s_mov_b32 exec_hi, 0xff
    ds_write_b32 v7, v102 offset:0
    ds_write_b32 v7, v103 offset:144
    s_mov_b32 exec_hi, -1
    v_lshlrev_b32 v76, 16, v49
    v_and_b32 v77, 0xffff0000, v49
    v_lshlrev_b32 v78, 16, v53
    v_and_b32 v79, 0xffff0000, v53
    v_lshlrev_b32 v80, 16, v57
    v_and_b32 v81, 0xffff0000, v57
    v_lshlrev_b32 v82, 16, v61
    v_and_b32 v83, 0xffff0000, v61
    v_lshlrev_b32 v84, 16, v65
    v_and_b32 v85, 0xffff0000, v65
    v_lshlrev_b32 v86, 16, v108
    v_lshlrev_b32 v87, 16, v110
    v_and_b32 v88, 0xffff0000, v108
    v_and_b32 v89, 0xffff0000, v110
    v_lshlrev_b32 v90, 16, v109
    v_lshlrev_b32 v91, 16, v111
    v_and_b32 v92, 0xffff0000, v109
    v_and_b32 v93, 0xffff0000, v111
    v_pk_mul_f32 v[94:95], v[82:83], v[86:87]
    v_pk_mul_f32 v[96:97], v[84:85], v[86:87]
    v_pk_fma_f32 v[94:95], v[80:81], v[88:89], v[94:95]
    v_pk_fma_f32 v[96:97], v[82:83], v[88:89], v[96:97]
    v_pk_fma_f32 v[94:95], v[78:79], v[90:91], v[94:95]
    v_pk_fma_f32 v[96:97], v[80:81], v[90:91], v[96:97]
    v_pk_fma_f32 v[94:95], v[76:77], v[92:93], v[94:95]
    v_pk_fma_f32 v[96:97], v[78:79], v[92:93], v[96:97]
    v_lshlrev_b32 v98, 16, v69
    v_and_b32 v99, 0xffff0000, v69
    v_lshlrev_b32 v100, 16, v73
    v_and_b32 v101, 0xffff0000, v73
    v_pk_mul_f32 v[94:95], v[94:95], v[98:99]
    v_pk_mul_f32 v[96:97], v[96:97], v[100:101]
    v_cvt_pk_bf16_f32 v102, v96, v94
    v_cvt_pk_bf16_f32 v103, v97, v95
    s_mov_b32 exec_hi, 0xff
    ds_write_b32 v7, v102 offset:288
    ds_write_b32 v7, v103 offset:432
    s_mov_b32 exec_hi, -1
    ds_read_b128 v[104:107], v44 offset:32
    ds_read_b128 v[108:111], v44 offset:48
    v_lshlrev_b32 v76, 16, v50
    v_and_b32 v77, 0xffff0000, v50
    v_lshlrev_b32 v78, 16, v54
    v_and_b32 v79, 0xffff0000, v54
    v_lshlrev_b32 v80, 16, v58
    v_and_b32 v81, 0xffff0000, v58
    v_lshlrev_b32 v82, 16, v62
    v_and_b32 v83, 0xffff0000, v62
    v_lshlrev_b32 v84, 16, v66
    v_and_b32 v85, 0xffff0000, v66
    s_waitcnt lgkmcnt(0)
    v_lshlrev_b32 v86, 16, v104
    v_lshlrev_b32 v87, 16, v106
    v_and_b32 v88, 0xffff0000, v104
    v_and_b32 v89, 0xffff0000, v106
    v_lshlrev_b32 v90, 16, v105
    v_lshlrev_b32 v91, 16, v107
    v_and_b32 v92, 0xffff0000, v105
    v_and_b32 v93, 0xffff0000, v107
    v_pk_mul_f32 v[94:95], v[82:83], v[86:87]
    v_pk_mul_f32 v[96:97], v[84:85], v[86:87]
    v_pk_fma_f32 v[94:95], v[80:81], v[88:89], v[94:95]
    v_pk_fma_f32 v[96:97], v[82:83], v[88:89], v[96:97]
    v_pk_fma_f32 v[94:95], v[78:79], v[90:91], v[94:95]
    v_pk_fma_f32 v[96:97], v[80:81], v[90:91], v[96:97]
    v_pk_fma_f32 v[94:95], v[76:77], v[92:93], v[94:95]
    v_pk_fma_f32 v[96:97], v[78:79], v[92:93], v[96:97]
    v_lshlrev_b32 v98, 16, v70
    v_and_b32 v99, 0xffff0000, v70
    v_lshlrev_b32 v100, 16, v74
    v_and_b32 v101, 0xffff0000, v74
    v_pk_mul_f32 v[94:95], v[94:95], v[98:99]
    v_pk_mul_f32 v[96:97], v[96:97], v[100:101]
    v_cvt_pk_bf16_f32 v102, v96, v94
    v_cvt_pk_bf16_f32 v103, v97, v95
    s_mov_b32 exec_hi, 0xff
    ds_write_b32 v7, v102 offset:576
    ds_write_b32 v7, v103 offset:720
    s_mov_b32 exec_hi, -1
    v_lshlrev_b32 v76, 16, v51
    v_and_b32 v77, 0xffff0000, v51
    v_lshlrev_b32 v78, 16, v55
    v_and_b32 v79, 0xffff0000, v55
    v_lshlrev_b32 v80, 16, v59
    v_and_b32 v81, 0xffff0000, v59
    v_lshlrev_b32 v82, 16, v63
    v_and_b32 v83, 0xffff0000, v63
    v_lshlrev_b32 v84, 16, v67
    v_and_b32 v85, 0xffff0000, v67
    v_lshlrev_b32 v86, 16, v108
    v_lshlrev_b32 v87, 16, v110
    v_and_b32 v88, 0xffff0000, v108
    v_and_b32 v89, 0xffff0000, v110
    v_lshlrev_b32 v90, 16, v109
    v_lshlrev_b32 v91, 16, v111
    v_and_b32 v92, 0xffff0000, v109
    v_and_b32 v93, 0xffff0000, v111
    v_pk_mul_f32 v[94:95], v[82:83], v[86:87]
    v_pk_mul_f32 v[96:97], v[84:85], v[86:87]
    v_pk_fma_f32 v[94:95], v[80:81], v[88:89], v[94:95]
    v_pk_fma_f32 v[96:97], v[82:83], v[88:89], v[96:97]
    v_pk_fma_f32 v[94:95], v[78:79], v[90:91], v[94:95]
    v_pk_fma_f32 v[96:97], v[80:81], v[90:91], v[96:97]
    v_pk_fma_f32 v[94:95], v[76:77], v[92:93], v[94:95]
    v_pk_fma_f32 v[96:97], v[78:79], v[92:93], v[96:97]
    v_lshlrev_b32 v98, 16, v71
    v_and_b32 v99, 0xffff0000, v71
    v_lshlrev_b32 v100, 16, v75
    v_and_b32 v101, 0xffff0000, v75
    v_pk_mul_f32 v[94:95], v[94:95], v[98:99]
    v_pk_mul_f32 v[96:97], v[96:97], v[100:101]
    v_cvt_pk_bf16_f32 v102, v96, v94
    v_cvt_pk_bf16_f32 v103, v97, v95
    s_mov_b32 exec_hi, 0xff
    ds_write_b32 v7, v102 offset:864
    ds_write_b32 v7, v103 offset:1008
    s_mov_b32 exec_hi, -1
    s_lshl_b32 s48, s47, 4
    v_add_u32 v43, s48, v3
    v_mul_u32_u24 v43, 200, v43
    v_lshl_add_u32 v43, v2, 3, v43
    s_mul_i32 s48, s43, 96
    s_add_u32 s48, s48, 0
    v_add_u32 v43, s48, v43
    s_waitcnt vmcnt(4)
    s_mov_b32 s65, 0
k1_poll_5:
    s_add_u32 s65, s65, 1
    s_cmp_gt_u32 s65, 100000
    s_cbranch_scc1 k1_polled_6
    v_cmp_ne_u32 vcc, s100, v30
    v_cmp_ne_u32 s[50:51], s101, v31
    s_nop 0
    s_or_b64 vcc, vcc, s[50:51]
    v_cmp_ne_u32 s[50:51], s100, v34
    s_nop 0
    s_or_b64 vcc, vcc, s[50:51]
    v_cmp_ne_u32 s[50:51], s101, v35
    s_nop 0
    s_or_b64 vcc, vcc, s[50:51]
    s_cmp_eq_u64 vcc, 0
    s_cbranch_scc1 k1_polled_6
    s_sleep 4
    buffer_load_dwordx4 v[28:31], v38, s[24:27], s78 offen sc1
    buffer_load_dwordx4 v[32:35], v38, s[24:27], s78 offen offset:1024 sc1
    s_waitcnt vmcnt(0)
    s_branch k1_poll_5
k1_polled_6:
    s_xor_b32 s48, s42, 1
    s_or_b32 s48, s48, s41
    s_cmp_lg_u32 s48, 0
    s_cbranch_scc1 k1_ep_7
    v_mov_b32 v4, 0
    v_mov_b32 v44, 1
    s_mov_b64 exec, 1
    buffer_atomic_add v44, v4, s[28:31], 0 offen sc0
    s_mov_b64 exec, -1
k1_ep_7:
    v_pk_add_f32 v[8:9], v[28:29], v[32:33]
    v_mov_b32 v10, v8
    v_mov_b32 v11, v9
    s_nop 0
    v_permlane16_swap_b32 v8, v10
    v_permlane16_swap_b32 v9, v11
    v_add_f32 v8, v8, v10
    v_add_f32 v9, v9, v11
    v_mov_b32 v10, v8
    v_mov_b32 v11, v9
    s_nop 0
    v_permlane32_swap_b32 v8, v10
    v_permlane32_swap_b32 v9, v11
    v_add_f32 v8, v8, v10
    v_add_f32 v9, v9, v11
    v_mul_f32 v8, 0x3aaaaaab, v8
    v_mul_f32 v9, 0x3aaaaaab, v9
    v_fma_f32 v9, -v8, v8, v9
    v_max_f32 v9, 0, v9
    v_cvt_pk_bf16_f32 v9, v9, v8
    v_and_b32 v8, 0xffff0000, v9
    v_lshlrev_b32 v9, 16, v9
    v_add_f32 v9, s55, v9
    v_cvt_pk_bf16_f32 v9, v9, v9
    v_and_b32 v9, 0xffff0000, v9
    v_sqrt_f32 v9, v9
    s_nop 0
    v_cvt_pk_bf16_f32 v9, v9, v9
    v_and_b32 v9, 0xffff0000, v9
    v_rcp_f32 v9, v9
    s_nop 0
    v_mov_b32 v10, v9
    v_pk_add_f32 v[200:201], v[200:201], v[8:9] op_sel_hi:[1,0] neg_lo:[0,1] neg_hi:[0,1]
    v_pk_add_f32 v[202:203], v[202:203], v[8:9] op_sel_hi:[1,0] neg_lo:[0,1] neg_hi:[0,1]
    v_pk_add_f32 v[204:205], v[204:205], v[8:9] op_sel_hi:[1,0] neg_lo:[0,1] neg_hi:[0,1]
    v_pk_add_f32 v[206:207], v[206:207], v[8:9] op_sel_hi:[1,0] neg_lo:[0,1] neg_hi:[0,1]
    v_pk_add_f32 v[208:209], v[208:209], v[8:9] op_sel_hi:[1,0] neg_lo:[0,1] neg_hi:[0,1]
    v_pk_add_f32 v[210:211], v[210:211], v[8:9] op_sel_hi:[1,0] neg_lo:[0,1] neg_hi:[0,1]
    v_pk_mul_f32 v[200:201], v[200:201], v[10:11] op_sel_hi:[1,0]
    v_pk_mul_f32 v[202:203], v[202:203], v[10:11] op_sel_hi:[1,0]
    v_pk_mul_f32 v[204:205], v[204:205], v[10:11] op_sel_hi:[1,0]
    v_pk_mul_f32 v[206:207], v[206:207], v[10:11] op_sel_hi:[1,0]
    v_pk_mul_f32 v[208:209], v[208:209], v[10:11] op_sel_hi:[1,0]
    v_pk_mul_f32 v[210:211], v[210:211], v[10:11] op_sel_hi:[1,0]
    v_cvt_pk_bf16_f32 v16, v200, v201
    v_cvt_pk_bf16_f32 v17, v202, v203
    ds_write_b64 v43, v[16:17] offset:0
    v_cvt_pk_bf16_f32 v18, v204, v205
    v_cvt_pk_bf16_f32 v19, v206, v207
    ds_write_b64 v43, v[18:19] offset:32
    v_cvt_pk_bf16_f32 v20, v208, v209
    v_cvt_pk_bf16_f32 v21, v210, v211
    ds_write_b64 v43, v[20:21] offset:64
    v_lshrrev_b32 v212, 1, v2
    v_lshrrev_b32 v5, 2, v3
    v_lshl_add_u32 v212, v212, 3, v5
    v_mul_u32_u24 v212, 200, v212
    v_and_b32 v5, 1, v2
    v_lshl_add_u32 v212, v5, 5, v212
    v_and_b32 v5, 3, v3
    v_lshl_add_u32 v212, v5, 3, v212
    v_lshlrev_b32 v213, 4, v1
    s_waitcnt lgkmcnt(0)
    s_barrier
    v_add_u32 v5, s88, v212
    ds_read_b64_tr_b16 v[8:9], v5
    ds_read_b64_tr_b16 v[10:11], v5 offset:800
    s_waitcnt lgkmcnt(0)
    buffer_store_dwordx4 v[8:11], v213, s[24:27], s64 offen sc1
    s_cmp_ge_u32 s42, 4
    s_cbranch_scc1 k1_fr_8
    v_add_u32 v5, s63, v212
    ds_read_b64_tr_b16 v[12:13], v5
    ds_read_b64_tr_b16 v[14:15], v5 offset:800
    s_waitcnt lgkmcnt(0)
    buffer_store_dwordx4 v[12:15], v213, s[24:27], s67 offen sc1
k1_fr_8:
    s_lshl_b32 s48, s42, 3
    v_lshrrev_b32 v4, 3, v1
    v_add_u32 v4, s48, v4
    v_and_b32 v5, 7, v1
    v_lshlrev_b32 v5, 4, v5
    v_mul_u32_u24 v6, 144, v4
    v_add_u32 v6, v6, v5
    v_add_u32 v6, 106496, v6
    ds_read_b128 v[16:19], v6
    v_lshlrev_b32 v4, 12, v4
    v_add_u32 v4, v4, v5
    s_waitcnt lgkmcnt(0)
    buffer_store_dwordx4 v[16:19], v4, s[24:27], s83 offen sc1
    s_lshl_b32 s48, s42, 3
    s_add_u32 s48, s48, 64
    v_lshrrev_b32 v4, 3, v1
    v_add_u32 v4, s48, v4
    v_and_b32 v5, 7, v1
    v_lshlrev_b32 v5, 4, v5
    v_mul_u32_u24 v6, 144, v4
    v_add_u32 v6, v6, v5
    v_add_u32 v6, 106496, v6
    ds_read_b128 v[20:23], v6
    v_lshlrev_b32 v4, 12, v4
    v_add_u32 v4, v4, v5
    s_waitcnt lgkmcnt(0)
    s_cmp_ge_u32 s42, 2
    s_cbranch_scc1 k1_kvskip_9
    buffer_store_dwordx4 v[20:23], v4, s[24:27], s83 offen sc1
k1_kvskip_9:
    v_mfma_f32_16x16x32_bf16 v[176:179], v[152:155], v[112:115], v[176:179]
    v_mfma_f32_16x16x32_bf16 v[180:183], v[152:155], v[116:119], v[180:183]
    v_mfma_f32_16x16x32_bf16 v[224:227], v[152:155], v[244:247], v[224:227]
    v_mfma_f32_16x16x32_bf16 v[184:187], v[156:159], v[112:115], v[184:187]
    v_mfma_f32_16x16x32_bf16 v[188:191], v[156:159], v[116:119], v[188:191]
    v_mfma_f32_16x16x32_bf16 v[228:231], v[156:159], v[244:247], v[228:231]
    v_mfma_f32_16x16x32_bf16 v[192:195], v[160:163], v[112:115], v[192:195]
    v_mfma_f32_16x16x32_bf16 v[196:199], v[160:163], v[116:119], v[196:199]
    v_mfma_f32_16x16x32_bf16 v[232:235], v[160:163], v[244:247], v[232:235]
    v_mfma_f32_16x16x32_bf16 v[176:179], v[164:167], v[120:123], v[176:179]
    v_mfma_f32_16x16x32_bf16 v[180:183], v[164:167], v[124:127], v[180:183]
    v_mfma_f32_16x16x32_bf16 v[184:187], v[168:171], v[120:123], v[184:187]
    v_mfma_f32_16x16x32_bf16 v[188:191], v[168:171], v[124:127], v[188:191]
    v_mfma_f32_16x16x32_bf16 v[192:195], v[172:175], v[120:123], v[192:195]
    v_mfma_f32_16x16x32_bf16 v[196:199], v[172:175], v[124:127], v[196:199]
    v_lshl_add_u32 v4, v1, 4, s70
    v_lshl_add_u32 v5, v2, 4, s72
    s_nop 1
    ds_write_b128 v4, v[180:183] offset:0
    s_nop 0
    ds_write_b128 v4, v[188:191] offset:1024
    s_nop 0
    ds_write_b128 v4, v[196:199] offset:2048
    s_mov_b32 exec_lo, 0x00010001
    s_mov_b32 exec_hi, 0x00010001
    ds_write_b128 v5, v[224:227] offset:1536
    ds_write_b128 v5, v[228:231] offset:1600
    ds_write_b128 v5, v[232:235] offset:1664
    s_mov_b64 exec, -1
    v_pk_add_f32 v[128:129], v[176:177], 0
    v_pk_add_f32 v[130:131], v[178:179], 0
    v_pk_add_f32 v[132:133], v[184:185], 0
    v_pk_add_f32 v[134:135], v[186:187], 0
    v_pk_add_f32 v[136:137], v[192:193], 0
    v_pk_add_f32 v[138:139], v[194:195], 0
    s_waitcnt vmcnt(0) lgkmcnt(0)
    s_barrier
    s_lshl_b32 s48, s41, 8
    s_lshl_b32 s49, s40, 3
    s_add_u32 s48, s48, s49
    s_add_u32 s48, s48, 14716928
    v_mov_b32 v8, s100
    v_mov_b32 v9, s101
    v_mov_b32 v4, 0
    s_cmp_eq_u32 s42, 0
    s_cselect_b64 exec, 1, 0
    buffer_store_dwordx2 v[8:9], v4, s[24:27], s48 offen sc1
    s_mov_b64 exec, -1
    v_lshl_add_u32 v4, v1, 4, s71
    ds_read_b128 v[48:51], v4 offset:0
    ds_read_b128 v[52:55], v4 offset:1024
    ds_read_b128 v[56:59], v4 offset:2048
    v_lshl_add_u32 v6, v2, 4, s73
    ds_read_b128 v[64:67], v6 offset:1536
    ds_read_b128 v[68:71], v6 offset:1600
    ds_read_b128 v[72:75], v6 offset:1664
    ds_read_b128 v[76:79], v6 offset:1728
    ds_read_b128 v[80:83], v6 offset:1792
    ds_read_b128 v[84:87], v6 offset:1856
    ds_read_b128 v[88:91], v6 offset:1920
    ds_read_b128 v[92:95], v6 offset:1984
    ds_read_b128 v[96:99], v6 offset:2048
    ds_read_b128 v[100:103], v6 offset:2112
    ds_read_b128 v[104:107], v6 offset:2176
    ds_read_b128 v[108:111], v6 offset:2240
    s_waitcnt lgkmcnt(12)
    v_pk_add_f32 v[128:129], v[128:129], v[48:49]
    v_pk_add_f32 v[130:131], v[130:131], v[50:51]
    v_pk_add_f32 v[132:133], v[132:133], v[52:53]
    v_pk_add_f32 v[134:135], v[134:135], v[54:55]
    v_pk_add_f32 v[136:137], v[136:137], v[56:57]
    v_pk_add_f32 v[138:139], v[138:139], v[58:59]
    s_waitcnt lgkmcnt(6)
    v_pk_add_f32 v[64:65], v[64:65], v[76:77]
    v_pk_add_f32 v[66:67], v[66:67], v[78:79]
    v_pk_add_f32 v[68:69], v[68:69], v[80:81]
    v_pk_add_f32 v[70:71], v[70:71], v[82:83]
    v_pk_add_f32 v[72:73], v[72:73], v[84:85]
    v_pk_add_f32 v[74:75], v[74:75], v[86:87]
    s_waitcnt lgkmcnt(0)
    v_pk_add_f32 v[88:89], v[88:89], v[100:101]
    v_pk_add_f32 v[90:91], v[90:91], v[102:103]
    v_pk_add_f32 v[92:93], v[92:93], v[104:105]
    v_pk_add_f32 v[94:95], v[94:95], v[106:107]
    v_pk_add_f32 v[96:97], v[96:97], v[108:109]
    v_pk_add_f32 v[98:99], v[98:99], v[110:111]
    v_pk_add_f32 v[64:65], v[64:65], v[88:89]
    v_pk_add_f32 v[66:67], v[66:67], v[90:91]
    v_pk_add_f32 v[68:69], v[68:69], v[92:93]
    v_pk_add_f32 v[70:71], v[70:71], v[94:95]
    v_pk_add_f32 v[72:73], v[72:73], v[96:97]
    v_pk_add_f32 v[74:75], v[74:75], v[98:99]
    v_pk_fma_f32 v[128:129], v[64:65], v[240:241], v[128:129] op_sel_hi:[1,0,1] neg_lo:[0,1,0] neg_hi:[0,1,0]
    v_pk_fma_f32 v[130:131], v[66:67], v[240:241], v[130:131] op_sel_hi:[1,0,1] neg_lo:[0,1,0] neg_hi:[0,1,0]
    v_pk_fma_f32 v[132:133], v[68:69], v[240:241], v[132:133] op_sel_hi:[1,0,1] neg_lo:[0,1,0] neg_hi:[0,1,0]
    v_pk_fma_f32 v[134:135], v[70:71], v[240:241], v[134:135] op_sel_hi:[1,0,1] neg_lo:[0,1,0] neg_hi:[0,1,0]
    v_pk_fma_f32 v[136:137], v[72:73], v[240:241], v[136:137] op_sel_hi:[1,0,1] neg_lo:[0,1,0] neg_hi:[0,1,0]
    v_pk_fma_f32 v[138:139], v[74:75], v[240:241], v[138:139] op_sel_hi:[1,0,1] neg_lo:[0,1,0] neg_hi:[0,1,0]
    v_pk_mul_f32 v[128:129], v[128:129], v[242:243] op_sel_hi:[1,0]
    v_pk_mul_f32 v[130:131], v[130:131], v[242:243] op_sel_hi:[1,0]
    v_pk_mul_f32 v[132:133], v[132:133], v[242:243] op_sel_hi:[1,0]
    v_pk_mul_f32 v[134:135], v[134:135], v[242:243] op_sel_hi:[1,0]
    v_pk_mul_f32 v[136:137], v[136:137], v[242:243] op_sel_hi:[1,0]
    v_pk_mul_f32 v[138:139], v[138:139], v[242:243] op_sel_hi:[1,0]
    v_pk_mul_f32 v[48:49], v[128:129], v[128:129]
    v_pk_mul_f32 v[50:51], v[130:131], v[130:131]
    v_pk_mul_f32 v[52:53], v[132:133], v[132:133]
    v_pk_mul_f32 v[54:55], v[134:135], v[134:135]
    v_pk_mul_f32 v[56:57], v[136:137], v[136:137]
    v_pk_mul_f32 v[58:59], v[138:139], v[138:139]
    v_pk_fma_f32 v[48:49], v[48:49], s[58:59], v[238:239]
    v_pk_fma_f32 v[50:51], v[50:51], s[58:59], v[238:239]
    v_pk_fma_f32 v[52:53], v[52:53], s[58:59], v[238:239]
    v_pk_fma_f32 v[54:55], v[54:55], s[58:59], v[238:239]
    v_pk_fma_f32 v[56:57], v[56:57], s[58:59], v[238:239]
    v_pk_fma_f32 v[58:59], v[58:59], s[58:59], v[238:239]
    v_pk_mul_f32 v[48:49], v[48:49], v[128:129]
    v_pk_mul_f32 v[50:51], v[50:51], v[130:131]
    v_pk_mul_f32 v[52:53], v[52:53], v[132:133]
    v_pk_mul_f32 v[54:55], v[54:55], v[134:135]
    v_pk_mul_f32 v[56:57], v[56:57], v[136:137]
    v_pk_mul_f32 v[58:59], v[58:59], v[138:139]
    v_exp_f32 v48, v48
    v_exp_f32 v49, v49
    v_exp_f32 v50, v50
    v_exp_f32 v51, v51
    v_exp_f32 v52, v52
    v_exp_f32 v53, v53
    v_exp_f32 v54, v54
    v_exp_f32 v55, v55
    v_exp_f32 v56, v56
    v_exp_f32 v57, v57
    v_exp_f32 v58, v58
    v_exp_f32 v59, v59
    v_pk_add_f32 v[48:49], v[48:49], 1.0 op_sel_hi:[1,0]
    v_pk_add_f32 v[50:51], v[50:51], 1.0 op_sel_hi:[1,0]
    v_pk_add_f32 v[52:53], v[52:53], 1.0 op_sel_hi:[1,0]
    v_pk_add_f32 v[54:55], v[54:55], 1.0 op_sel_hi:[1,0]
    v_pk_add_f32 v[56:57], v[56:57], 1.0 op_sel_hi:[1,0]
    v_pk_add_f32 v[58:59], v[58:59], 1.0 op_sel_hi:[1,0]
    v_rcp_f32 v48, v48
    v_rcp_f32 v49, v49
    v_rcp_f32 v50, v50
    v_rcp_f32 v51, v51
    v_rcp_f32 v52, v52
    v_rcp_f32 v53, v53
    v_rcp_f32 v54, v54
    v_rcp_f32 v55, v55
    v_rcp_f32 v56, v56
    v_rcp_f32 v57, v57
    v_rcp_f32 v58, v58
    v_rcp_f32 v59, v59
    v_pk_mul_f32 v[128:129], v[128:129], v[48:49]
    v_pk_mul_f32 v[130:131], v[130:131], v[50:51]
    v_pk_mul_f32 v[132:133], v[132:133], v[52:53]
    v_pk_mul_f32 v[134:135], v[134:135], v[54:55]
    v_pk_mul_f32 v[136:137], v[136:137], v[56:57]
    v_pk_mul_f32 v[138:139], v[138:139], v[58:59]
    v_lshrrev_b32 v4, 1, v2
    v_mul_u32_u24 v4, 3072, v4
    v_and_b32 v5, 1, v2
    v_lshlrev_b32 v5, 5, v5
    v_add_u32 v5, v5, v3
    v_lshl_add_u32 v4, v5, 4, v4
    v_cvt_pk_bf16_f32 v48, v128, v129
    v_cvt_pk_bf16_f32 v49, v130, v131
    v_add_u32 v5, s80, v4
    ds_write_b64 v5, v[48:49]
    v_cvt_pk_bf16_f32 v50, v132, v133
    v_cvt_pk_bf16_f32 v51, v134, v135
    v_add_u32 v5, s81, v4
    ds_write_b64 v5, v[50:51]
    v_cvt_pk_bf16_f32 v52, v136, v137
    v_cvt_pk_bf16_f32 v53, v138, v139
    v_add_u32 v5, s82, v4
    ds_write_b64 v5, v[52:53]
    s_xor_b32 s48, s42, 1
    s_or_b32 s48, s48, s41
    s_cmp_lg_u32 s48, 0
    s_cbranch_scc1 k1_ep2_10
    s_waitcnt vmcnt(0)
    v_readfirstlane_b32 s48, v44
    s_nop 0
    s_cmp_lg_u32 s48, 31
    s_cbranch_scc1 k1_ep2_10
    v_mov_b32 v8, s100
    v_mov_b32 v9, s101
    v_mov_b32 v4, 14712832
    s_mov_b64 exec, 1
    buffer_store_dwordx2 v[8:9], v4, s[24:27], 0 offen sc1
    s_mov_b64 exec, -1
k1_ep2_10:
    s_waitcnt lgkmcnt(0)
    s_barrier
    s_cmp_ge_u32 s42, 4
    s_cbranch_scc1 recurrent_scan__ssm_conv_h3__mixer_gmlp__prompt_kernel_conv
    s_load_dwordx2 s[4:5], s[0:1], 64
    s_load_dwordx2 s[8:9], s[0:1], 104
    s_load_dwordx2 s[12:13], s[0:1], 72
    v_lshrrev_b32 v2, 6, v0
    v_and_b32 v1, 63, v0
    v_readfirstlane_b32 s34, v2
    s_mov_b32 s6, 8388608
    s_mov_b32 s7, 0x20000
    s_mov_b32 s10, 15990784
    s_mov_b32 s11, 0x20000
    s_mov_b32 s14, 4096
    s_mov_b32 s15, 0x20000
    s_and_b32 s40, s2, 7
    s_lshr_b32 s41, s2, 3
    s_and_b32 s41, s41, 31
    s_lshr_b32 s32, s40, 1
    s_lshl_b32 s32, s32, 3
    s_and_b32 s42, s41, 7
    s_add_u32 s32, s32, s42
    s_and_b32 s33, s40, 1
    s_lshl_b32 s33, s33, 2
    s_lshr_b32 s42, s41, 3
    s_add_u32 s33, s33, s42
    s_lshl_b32 s44, s33, 7
    s_lshl_b32 s40, s34, 5
    s_add_u32 s44, s44, s40
    s_mul_i32 s44, s44, 3072
    s_add_u32 s44, s44, 0
    s_lshl_b32 s45, s32, 18
    s_lshl_b32 s40, s34, 10
    s_add_u32 s45, s45, s40
    s_lshl_b32 s46, s34, 14
    v_lshlrev_b32 v5, 4, v1
    v_lshrrev_b32 v2, 3, v1
    v_lshlrev_b32 v2, 12, v2
    v_and_b32 v3, 7, v1
    v_lshrrev_b32 v4, 4, v1
    v_xor_b32 v3, v3, v4
    v_lshl_add_u32 v6, v3, 4, v2
    v_xor_b32 v7, 64, v6
    s_mov_b32 s50, 0
    s_waitcnt lgkmcnt(0)
    s_add_u32 s54, s50, 0
    s_and_b32 s54, s54, 7
    s_lshl_b32 s54, s54, 7
    s_add_u32 s54, s54, s45
    s_add_u32 s42, s54, 0
    s_add_u32 m0, s46, 0
    s_nop 0
    buffer_load_dwordx4 v6, s[4:7], s42 offen lds
    s_add_u32 s42, s54, 32768
    s_add_u32 m0, s46, 1024
    s_nop 0
    buffer_load_dwordx4 v7, s[4:7], s42 offen lds
    s_add_u32 s42, s54, 65536
    s_add_u32 m0, s46, 2048
    s_nop 0
    buffer_load_dwordx4 v6, s[4:7], s42 offen lds
    s_add_u32 s42, s54, 98304
    s_add_u32 m0, s46, 3072
    s_nop 0
    buffer_load_dwordx4 v7, s[4:7], s42 offen lds
    s_add_u32 s42, s54, 131072
    s_add_u32 m0, s46, 4096
    s_nop 0
    buffer_load_dwordx4 v6, s[4:7], s42 offen lds
    s_add_u32 s42, s54, 163840
    s_add_u32 m0, s46, 5120
    s_nop 0
    buffer_load_dwordx4 v7, s[4:7], s42 offen lds
    s_add_u32 s42, s54, 196608
    s_add_u32 m0, s46, 6144
    s_nop 0
    buffer_load_dwordx4 v6, s[4:7], s42 offen lds
    s_add_u32 s42, s54, 229376
    s_add_u32 m0, s46, 7168
    s_nop 0
    buffer_load_dwordx4 v7, s[4:7], s42 offen lds
    s_lshl_b32 s43, s33, 8
    s_add_u32 s43, s43, 14716928
    v_mbcnt_lo_u32_b32 v2, -1, 0
    v_mbcnt_hi_u32_b32 v2, -1, v2
    v_and_b32 v2, 31, v2
    v_lshlrev_b32 v2, 3, v2
    s_mov_b32 s67, 0
fpoll_11:
    buffer_load_dwordx2 v[104:105], v2, s[8:11], s43 offen sc1
    s_add_u32 s67, s67, 1
    s_waitcnt vmcnt(0)
    v_cmp_ne_u32 vcc, s100, v104
    v_cmp_ne_u32 s[64:65], s101, v105
    s_nop 0
    s_or_b64 vcc, vcc, s[64:65]
    s_cmp_gt_u32 s67, 100000
    s_cbranch_scc1 fpoll_e_12
    s_cmp_eq_u64 vcc, 0
    s_cbranch_scc1 fpoll_e_12
    s_sleep 2
    s_branch fpoll_11
fpoll_e_12:
    s_add_u32 s52, s50, 0
    s_and_b32 s52, s52, 7
    s_mul_i32 s52, s52, 12288
    s_add_u32 s52, s52, s44
    buffer_load_dwordx4 v[104:107], v5, s[8:11], s52 offen offset:0 sc1
    buffer_load_dwordx4 v[108:111], v5, s[8:11], s52 offen offset:1024 sc1
    buffer_load_dwordx4 v[112:115], v5, s[8:11], s52 offen offset:2048 sc1
    s_add_u32 s41, s52, 3072
    buffer_load_dwordx4 v[116:119], v5, s[8:11], s41 offen offset:0 sc1
    s_add_u32 s41, s52, 3072
    buffer_load_dwordx4 v[120:123], v5, s[8:11], s41 offen offset:1024 sc1
    s_add_u32 s41, s52, 3072
    buffer_load_dwordx4 v[124:127], v5, s[8:11], s41 offen offset:2048 sc1
    s_add_u32 s41, s52, 6144
    buffer_load_dwordx4 v[128:131], v5, s[8:11], s41 offen offset:0 sc1
    s_add_u32 s41, s52, 6144
    buffer_load_dwordx4 v[132:135], v5, s[8:11], s41 offen offset:1024 sc1
    s_add_u32 s41, s52, 6144
    buffer_load_dwordx4 v[136:139], v5, s[8:11], s41 offen offset:2048 sc1
    s_add_u32 s41, s52, 9216
    buffer_load_dwordx4 v[140:143], v5, s[8:11], s41 offen offset:0 sc1
    s_add_u32 s41, s52, 9216
    buffer_load_dwordx4 v[144:147], v5, s[8:11], s41 offen offset:1024 sc1
    s_add_u32 s41, s52, 9216
    buffer_load_dwordx4 v[148:151], v5, s[8:11], s41 offen offset:2048 sc1
    v_and_b32 v2, 31, v1
    v_lshrrev_b32 v3, 1, v2
    v_and_b32 v3, 7, v3
    v_lshrrev_b32 v4, 5, v1
    v_xor_b32 v3, v3, v4
    v_lshl_add_u32 v2, v2, 7, s46
    v_xor_b32 v4, 0, v3
    v_lshl_add_u32 v180, v4, 4, v2
    v_xor_b32 v4, 2, v3
    v_lshl_add_u32 v181, v4, 4, v2
    v_xor_b32 v4, 4, v3
    v_lshl_add_u32 v182, v4, 4, v2
    v_xor_b32 v4, 6, v3
    v_lshl_add_u32 v183, v4, 4, v2
    s_waitcnt vmcnt(12)
    s_setprio 2
    ds_read_b128 v[164:167], v180 offset:0
    ds_read_b128 v[168:171], v180 offset:4096
    s_waitcnt vmcnt(9)
    s_waitcnt lgkmcnt(0)
    v_mfma_f32_32x32x16_bf16 v[8:23], v[104:107], v[164:167], 0
    ds_read_b128 v[172:175], v181 offset:0
    ds_read_b128 v[176:179], v181 offset:4096
    v_mfma_f32_32x32x16_bf16 v[24:39], v[104:107], v[168:171], 0
    s_add_u32 s53, s50, 1
    s_and_b32 s53, s53, 7
    s_mul_i32 s53, s53, 12288
    s_add_u32 s53, s53, s44
    buffer_load_dwordx4 v[152:155], v5, s[8:11], s53 offen offset:0 sc1
    v_mfma_f32_32x32x16_bf16 v[40:55], v[108:111], v[164:167], 0
    buffer_load_dwordx4 v[156:159], v5, s[8:11], s53 offen offset:1024 sc1
    v_mfma_f32_32x32x16_bf16 v[56:71], v[108:111], v[168:171], 0
    buffer_load_dwordx4 v[160:163], v5, s[8:11], s53 offen offset:2048 sc1
    v_mfma_f32_32x32x16_bf16 v[72:87], v[112:115], v[164:167], 0
    s_add_u32 s55, s50, 1
    s_and_b32 s55, s55, 7
    s_lshl_b32 s55, s55, 7
    s_add_u32 s55, s55, s45
    s_add_u32 s42, s55, 0
    s_add_u32 m0, s46, 8192
    s_nop 0
    buffer_load_dwordx4 v6, s[4:7], s42 offen lds
    v_mfma_f32_32x32x16_bf16 v[88:103], v[112:115], v[168:171], 0
    s_add_u32 s42, s55, 32768
    s_add_u32 m0, s46, 9216
    s_nop 0
    buffer_load_dwordx4 v7, s[4:7], s42 offen lds
    s_add_u32 s42, s55, 65536
    s_add_u32 m0, s46, 10240
    s_nop 0
    buffer_load_dwordx4 v6, s[4:7], s42 offen lds
    s_add_u32 s42, s55, 98304
    s_add_u32 m0, s46, 11264
    s_nop 0
    buffer_load_dwordx4 v7, s[4:7], s42 offen lds
    s_waitcnt vmcnt(13)
    s_waitcnt lgkmcnt(0)
    v_mfma_f32_32x32x16_bf16 v[8:23], v[116:119], v[172:175], v[8:23]
    ds_read_b128 v[164:167], v182 offset:0
    ds_read_b128 v[168:171], v182 offset:4096
    v_mfma_f32_32x32x16_bf16 v[24:39], v[116:119], v[176:179], v[24:39]
    s_add_u32 s41, s53, 3072
    buffer_load_dwordx4 v[104:107], v5, s[8:11], s41 offen offset:0 sc1
    v_mfma_f32_32x32x16_bf16 v[40:55], v[120:123], v[172:175], v[40:55]
    s_add_u32 s41, s53, 3072
    buffer_load_dwordx4 v[108:111], v5, s[8:11], s41 offen offset:1024 sc1
    v_mfma_f32_32x32x16_bf16 v[56:71], v[120:123], v[176:179], v[56:71]
    s_add_u32 s41, s53, 3072
    buffer_load_dwordx4 v[112:115], v5, s[8:11], s41 offen offset:2048 sc1
    v_mfma_f32_32x32x16_bf16 v[72:87], v[124:127], v[172:175], v[72:87]
    s_add_u32 s42, s55, 131072
    s_add_u32 m0, s46, 12288
    s_nop 0
    buffer_load_dwordx4 v6, s[4:7], s42 offen lds
    v_mfma_f32_32x32x16_bf16 v[88:103], v[124:127], v[176:179], v[88:103]
    s_add_u32 s42, s55, 163840
    s_add_u32 m0, s46, 13312
    s_nop 0
    buffer_load_dwordx4 v7, s[4:7], s42 offen lds
    s_add_u32 s42, s55, 196608
    s_add_u32 m0, s46, 14336
    s_nop 0
    buffer_load_dwordx4 v6, s[4:7], s42 offen lds
    s_add_u32 s42, s55, 229376
    s_add_u32 m0, s46, 15360
    s_nop 0
    buffer_load_dwordx4 v7, s[4:7], s42 offen lds
    s_waitcnt vmcnt(17)
    s_waitcnt lgkmcnt(0)
    v_mfma_f32_32x32x16_bf16 v[8:23], v[128:131], v[164:167], v[8:23]
    ds_read_b128 v[172:175], v183 offset:0
    ds_read_b128 v[176:179], v183 offset:4096
    v_mfma_f32_32x32x16_bf16 v[24:39], v[128:131], v[168:171], v[24:39]
    s_add_u32 s41, s53, 6144
    buffer_load_dwordx4 v[116:119], v5, s[8:11], s41 offen offset:0 sc1
    v_mfma_f32_32x32x16_bf16 v[40:55], v[132:135], v[164:167], v[40:55]
    s_add_u32 s41, s53, 6144
    buffer_load_dwordx4 v[120:123], v5, s[8:11], s41 offen offset:1024 sc1
    v_mfma_f32_32x32x16_bf16 v[56:71], v[132:135], v[168:171], v[56:71]
    s_add_u32 s41, s53, 6144
    buffer_load_dwordx4 v[124:127], v5, s[8:11], s41 offen offset:2048 sc1
    v_mfma_f32_32x32x16_bf16 v[72:87], v[136:139], v[164:167], v[72:87]
    v_mfma_f32_32x32x16_bf16 v[88:103], v[136:139], v[168:171], v[88:103]
    s_waitcnt vmcnt(17)
    s_waitcnt lgkmcnt(0)
    v_mfma_f32_32x32x16_bf16 v[8:23], v[140:143], v[172:175], v[8:23]
    s_waitcnt vmcnt(3)
    ds_read_b128 v[164:167], v180 offset:8192
    ds_read_b128 v[168:171], v180 offset:12288
    v_mfma_f32_32x32x16_bf16 v[24:39], v[140:143], v[176:179], v[24:39]
    s_add_u32 s41, s53, 9216
    buffer_load_dwordx4 v[128:131], v5, s[8:11], s41 offen offset:0 sc1
    v_mfma_f32_32x32x16_bf16 v[40:55], v[144:147], v[172:175], v[40:55]
    s_add_u32 s41, s53, 9216
    buffer_load_dwordx4 v[132:135], v5, s[8:11], s41 offen offset:1024 sc1
    v_mfma_f32_32x32x16_bf16 v[56:71], v[144:147], v[176:179], v[56:71]
    s_add_u32 s41, s53, 9216
    buffer_load_dwordx4 v[136:139], v5, s[8:11], s41 offen offset:2048 sc1
    v_mfma_f32_32x32x16_bf16 v[72:87], v[148:151], v[172:175], v[72:87]
    s_add_u32 s54, s50, 2
    s_and_b32 s54, s54, 7
    s_lshl_b32 s54, s54, 7
    s_add_u32 s54, s54, s45
    s_add_u32 s42, s54, 0
    s_add_u32 m0, s46, 0
    s_nop 0
    buffer_load_dwordx4 v6, s[4:7], s42 offen lds
    v_mfma_f32_32x32x16_bf16 v[88:103], v[148:151], v[176:179], v[88:103]
    s_add_u32 s42, s54, 32768
    s_add_u32 m0, s46, 1024
    s_nop 0
    buffer_load_dwordx4 v7, s[4:7], s42 offen lds
    s_waitcnt vmcnt(19)
    s_waitcnt lgkmcnt(0)
    v_mfma_f32_32x32x16_bf16 v[8:23], v[152:155], v[164:167], v[8:23]
    ds_read_b128 v[172:175], v181 offset:8192
    ds_read_b128 v[176:179], v181 offset:12288
    v_mfma_f32_32x32x16_bf16 v[24:39], v[152:155], v[168:171], v[24:39]
    s_add_u32 s52, s50, 2
    s_and_b32 s52, s52, 7
    s_mul_i32 s52, s52, 12288
    s_add_u32 s52, s52, s44
    buffer_load_dwordx4 v[140:143], v5, s[8:11], s52 offen offset:0 sc1
    v_mfma_f32_32x32x16_bf16 v[40:55], v[156:159], v[164:167], v[40:55]
    buffer_load_dwordx4 v[144:147], v5, s[8:11], s52 offen offset:1024 sc1
    v_mfma_f32_32x32x16_bf16 v[56:71], v[156:159], v[168:171], v[56:71]
    buffer_load_dwordx4 v[148:151], v5, s[8:11], s52 offen offset:2048 sc1
    v_mfma_f32_32x32x16_bf16 v[72:87], v[160:163], v[164:167], v[72:87]
    s_add_u32 s42, s54, 65536
    s_add_u32 m0, s46, 2048
    s_nop 0
    buffer_load_dwordx4 v6, s[4:7], s42 offen lds
    v_mfma_f32_32x32x16_bf16 v[88:103], v[160:163], v[168:171], v[88:103]
    s_add_u32 s42, s54, 98304
    s_add_u32 m0, s46, 3072
    s_nop 0
    buffer_load_dwordx4 v7, s[4:7], s42 offen lds
    s_add_u32 s42, s54, 131072
    s_add_u32 m0, s46, 4096
    s_nop 0
    buffer_load_dwordx4 v6, s[4:7], s42 offen lds
    s_waitcnt vmcnt(18)
    s_waitcnt lgkmcnt(0)
    v_mfma_f32_32x32x16_bf16 v[8:23], v[104:107], v[172:175], v[8:23]
    ds_read_b128 v[164:167], v182 offset:8192
    ds_read_b128 v[168:171], v182 offset:12288
    v_mfma_f32_32x32x16_bf16 v[24:39], v[104:107], v[176:179], v[24:39]
    s_add_u32 s41, s52, 3072
    buffer_load_dwordx4 v[152:155], v5, s[8:11], s41 offen offset:0 sc1
    v_mfma_f32_32x32x16_bf16 v[40:55], v[108:111], v[172:175], v[40:55]
    s_add_u32 s41, s52, 3072
    buffer_load_dwordx4 v[156:159], v5, s[8:11], s41 offen offset:1024 sc1
    v_mfma_f32_32x32x16_bf16 v[56:71], v[108:111], v[176:179], v[56:71]
    s_add_u32 s41, s52, 3072
    buffer_load_dwordx4 v[160:163], v5, s[8:11], s41 offen offset:2048 sc1
    v_mfma_f32_32x32x16_bf16 v[72:87], v[112:115], v[172:175], v[72:87]
    s_add_u32 s42, s54, 163840
    s_add_u32 m0, s46, 5120
    s_nop 0
    buffer_load_dwordx4 v7, s[4:7], s42 offen lds
    v_mfma_f32_32x32x16_bf16 v[88:103], v[112:115], v[176:179], v[88:103]
    s_add_u32 s42, s54, 196608
    s_add_u32 m0, s46, 6144
    s_nop 0
    buffer_load_dwordx4 v6, s[4:7], s42 offen lds
    s_add_u32 s42, s54, 229376
    s_add_u32 m0, s46, 7168
    s_nop 0
    buffer_load_dwordx4 v7, s[4:7], s42 offen lds
    s_waitcnt vmcnt(17)
    s_waitcnt lgkmcnt(0)
    v_mfma_f32_32x32x16_bf16 v[8:23], v[116:119], v[164:167], v[8:23]
    ds_read_b128 v[172:175], v183 offset:8192
    ds_read_b128 v[176:179], v183 offset:12288
    v_mfma_f32_32x32x16_bf16 v[24:39], v[116:119], v[168:171], v[24:39]
    s_add_u32 s41, s52, 6144
    buffer_load_dwordx4 v[104:107], v5, s[8:11], s41 offen offset:0 sc1
    v_mfma_f32_32x32x16_bf16 v[40:55], v[120:123], v[164:167], v[40:55]
    s_add_u32 s41, s52, 6144
    buffer_load_dwordx4 v[108:111], v5, s[8:11], s41 offen offset:1024 sc1
    v_mfma_f32_32x32x16_bf16 v[56:71], v[120:123], v[168:171], v[56:71]
    s_add_u32 s41, s52, 6144
    buffer_load_dwordx4 v[112:115], v5, s[8:11], s41 offen offset:2048 sc1
    v_mfma_f32_32x32x16_bf16 v[72:87], v[124:127], v[164:167], v[72:87]
    v_mfma_f32_32x32x16_bf16 v[88:103], v[124:127], v[168:171], v[88:103]
    s_waitcnt vmcnt(17)
    s_waitcnt lgkmcnt(0)
    v_mfma_f32_32x32x16_bf16 v[8:23], v[128:131], v[172:175], v[8:23]
    s_waitcnt vmcnt(3)
    ds_read_b128 v[164:167], v180 offset:0
    ds_read_b128 v[168:171], v180 offset:4096
    v_mfma_f32_32x32x16_bf16 v[24:39], v[128:131], v[176:179], v[24:39]
    s_add_u32 s41, s52, 9216
    buffer_load_dwordx4 v[116:119], v5, s[8:11], s41 offen offset:0 sc1
    v_mfma_f32_32x32x16_bf16 v[40:55], v[132:135], v[172:175], v[40:55]
    s_add_u32 s41, s52, 9216
    buffer_load_dwordx4 v[120:123], v5, s[8:11], s41 offen offset:1024 sc1
    v_mfma_f32_32x32x16_bf16 v[56:71], v[132:135], v[176:179], v[56:71]
    s_add_u32 s41, s52, 9216
    buffer_load_dwordx4 v[124:127], v5, s[8:11], s41 offen offset:2048 sc1
    v_mfma_f32_32x32x16_bf16 v[72:87], v[136:139], v[172:175], v[72:87]
    s_add_u32 s55, s50, 3
    s_and_b32 s55, s55, 7
    s_lshl_b32 s55, s55, 7
    s_add_u32 s55, s55, s45
    s_add_u32 s42, s55, 0
    s_add_u32 m0, s46, 8192
    s_nop 0
    buffer_load_dwordx4 v6, s[4:7], s42 offen lds
    v_mfma_f32_32x32x16_bf16 v[88:103], v[136:139], v[176:179], v[88:103]
    s_add_u32 s42, s55, 32768
    s_add_u32 m0, s46, 9216
    s_nop 0
    buffer_load_dwordx4 v7, s[4:7], s42 offen lds
    s_waitcnt vmcnt(17)
    s_waitcnt lgkmcnt(0)
    v_mfma_f32_32x32x16_bf16 v[8:23], v[140:143], v[164:167], v[8:23]
    ds_read_b128 v[172:175], v181 offset:0
    ds_read_b128 v[176:179], v181 offset:4096
    v_mfma_f32_32x32x16_bf16 v[24:39], v[140:143], v[168:171], v[24:39]
    s_add_u32 s53, s50, 3
    s_and_b32 s53, s53, 7
    s_mul_i32 s53, s53, 12288
    s_add_u32 s53, s53, s44
    buffer_load_dwordx4 v[128:131], v5, s[8:11], s53 offen offset:0 sc1
    v_mfma_f32_32x32x16_bf16 v[40:55], v[144:147], v[164:167], v[40:55]
    buffer_load_dwordx4 v[132:135], v5, s[8:11], s53 offen offset:1024 sc1
    v_mfma_f32_32x32x16_bf16 v[56:71], v[144:147], v[168:171], v[56:71]
    buffer_load_dwordx4 v[136:139], v5, s[8:11], s53 offen offset:2048 sc1
    v_mfma_f32_32x32x16_bf16 v[72:87], v[148:151], v[164:167], v[72:87]
    s_add_u32 s42, s55, 65536
    s_add_u32 m0, s46, 10240
    s_nop 0
    buffer_load_dwordx4 v6, s[4:7], s42 offen lds
    v_mfma_f32_32x32x16_bf16 v[88:103], v[148:151], v[168:171], v[88:103]
    s_add_u32 s42, s55, 98304
    s_add_u32 m0, s46, 11264
    s_nop 0
    buffer_load_dwordx4 v7, s[4:7], s42 offen lds
    s_add_u32 s42, s55, 131072
    s_add_u32 m0, s46, 12288
    s_nop 0
    buffer_load_dwordx4 v6, s[4:7], s42 offen lds
    s_waitcnt vmcnt(17)
    s_waitcnt lgkmcnt(0)
    v_mfma_f32_32x32x16_bf16 v[8:23], v[152:155], v[172:175], v[8:23]
    ds_read_b128 v[164:167], v182 offset:0
    ds_read_b128 v[168:171], v182 offset:4096
    v_mfma_f32_32x32x16_bf16 v[24:39], v[152:155], v[176:179], v[24:39]
    s_add_u32 s41, s53, 3072
    buffer_load_dwordx4 v[140:143], v5, s[8:11], s41 offen offset:0 sc1
    v_mfma_f32_32x32x16_bf16 v[40:55], v[156:159], v[172:175], v[40:55]
    s_add_u32 s41, s53, 3072
    buffer_load_dwordx4 v[144:147], v5, s[8:11], s41 offen offset:1024 sc1
    v_mfma_f32_32x32x16_bf16 v[56:71], v[156:159], v[176:179], v[56:71]
    s_add_u32 s41, s53, 3072
    buffer_load_dwordx4 v[148:151], v5, s[8:11], s41 offen offset:2048 sc1
    v_mfma_f32_32x32x16_bf16 v[72:87], v[160:163], v[172:175], v[72:87]
    s_add_u32 s42, s55, 163840
    s_add_u32 m0, s46, 13312
    s_nop 0
    buffer_load_dwordx4 v7, s[4:7], s42 offen lds
    v_mfma_f32_32x32x16_bf16 v[88:103], v[160:163], v[176:179], v[88:103]
    s_add_u32 s42, s55, 196608
    s_add_u32 m0, s46, 14336
    s_nop 0
    buffer_load_dwordx4 v6, s[4:7], s42 offen lds
    s_add_u32 s42, s55, 229376
    s_add_u32 m0, s46, 15360
    s_nop 0
    buffer_load_dwordx4 v7, s[4:7], s42 offen lds
    s_waitcnt vmcnt(17)
    s_waitcnt lgkmcnt(0)
    v_mfma_f32_32x32x16_bf16 v[8:23], v[104:107], v[164:167], v[8:23]
    ds_read_b128 v[172:175], v183 offset:0
    ds_read_b128 v[176:179], v183 offset:4096
    v_mfma_f32_32x32x16_bf16 v[24:39], v[104:107], v[168:171], v[24:39]
    s_add_u32 s41, s53, 6144
    buffer_load_dwordx4 v[152:155], v5, s[8:11], s41 offen offset:0 sc1
    v_mfma_f32_32x32x16_bf16 v[40:55], v[108:111], v[164:167], v[40:55]
    s_add_u32 s41, s53, 6144
    buffer_load_dwordx4 v[156:159], v5, s[8:11], s41 offen offset:1024 sc1
    v_mfma_f32_32x32x16_bf16 v[56:71], v[108:111], v[168:171], v[56:71]
    s_add_u32 s41, s53, 6144
    buffer_load_dwordx4 v[160:163], v5, s[8:11], s41 offen offset:2048 sc1
    v_mfma_f32_32x32x16_bf16 v[72:87], v[112:115], v[164:167], v[72:87]
    v_mfma_f32_32x32x16_bf16 v[88:103], v[112:115], v[168:171], v[88:103]
    s_waitcnt vmcnt(17)
    s_waitcnt lgkmcnt(0)
    v_mfma_f32_32x32x16_bf16 v[8:23], v[116:119], v[172:175], v[8:23]
    s_waitcnt vmcnt(3)
    ds_read_b128 v[164:167], v180 offset:8192
    ds_read_b128 v[168:171], v180 offset:12288
    v_mfma_f32_32x32x16_bf16 v[24:39], v[116:119], v[176:179], v[24:39]
    s_add_u32 s41, s53, 9216
    buffer_load_dwordx4 v[104:107], v5, s[8:11], s41 offen offset:0 sc1
    v_mfma_f32_32x32x16_bf16 v[40:55], v[120:123], v[172:175], v[40:55]
    s_add_u32 s41, s53, 9216
    buffer_load_dwordx4 v[108:111], v5, s[8:11], s41 offen offset:1024 sc1
    v_mfma_f32_32x32x16_bf16 v[56:71], v[120:123], v[176:179], v[56:71]
    s_add_u32 s41, s53, 9216
    buffer_load_dwordx4 v[112:115], v5, s[8:11], s41 offen offset:2048 sc1
    v_mfma_f32_32x32x16_bf16 v[72:87], v[124:127], v[172:175], v[72:87]
    s_add_u32 s54, s50, 4
    s_and_b32 s54, s54, 7
    s_lshl_b32 s54, s54, 7
    s_add_u32 s54, s54, s45
    s_add_u32 s42, s54, 0
    s_add_u32 m0, s46, 0
    s_nop 0
    buffer_load_dwordx4 v6, s[4:7], s42 offen lds
    v_mfma_f32_32x32x16_bf16 v[88:103], v[124:127], v[176:179], v[88:103]
    s_add_u32 s42, s54, 32768
    s_add_u32 m0, s46, 1024
    s_nop 0
    buffer_load_dwordx4 v7, s[4:7], s42 offen lds
    s_setprio 0
    s_waitcnt vmcnt(17)
    s_waitcnt lgkmcnt(0)
    v_mfma_f32_32x32x16_bf16 v[8:23], v[128:131], v[164:167], v[8:23]
    ds_read_b128 v[172:175], v181 offset:8192
    ds_read_b128 v[176:179], v181 offset:12288
    v_mfma_f32_32x32x16_bf16 v[24:39], v[128:131], v[168:171], v[24:39]
    s_add_u32 s52, s50, 4
    s_and_b32 s52, s52, 7
    s_mul_i32 s52, s52, 12288
    s_add_u32 s52, s52, s44
    buffer_load_dwordx4 v[116:119], v5, s[8:11], s52 offen offset:0 sc1
    v_mfma_f32_32x32x16_bf16 v[40:55], v[132:135], v[164:167], v[40:55]
    buffer_load_dwordx4 v[120:123], v5, s[8:11], s52 offen offset:1024 sc1
    v_mfma_f32_32x32x16_bf16 v[56:71], v[132:135], v[168:171], v[56:71]
    buffer_load_dwordx4 v[124:127], v5, s[8:11], s52 offen offset:2048 sc1
    v_mfma_f32_32x32x16_bf16 v[72:87], v[136:139], v[164:167], v[72:87]
    s_add_u32 s42, s54, 65536
    s_add_u32 m0, s46, 2048
    s_nop 0
    buffer_load_dwordx4 v6, s[4:7], s42 offen lds
    v_mfma_f32_32x32x16_bf16 v[88:103], v[136:139], v[168:171], v[88:103]
    s_add_u32 s42, s54, 98304
    s_add_u32 m0, s46, 3072
    s_nop 0
    buffer_load_dwordx4 v7, s[4:7], s42 offen lds
    s_add_u32 s42, s54, 131072
    s_add_u32 m0, s46, 4096
    s_nop 0
    buffer_load_dwordx4 v6, s[4:7], s42 offen lds
    s_waitcnt vmcnt(17)
    s_waitcnt lgkmcnt(0)
    v_mfma_f32_32x32x16_bf16 v[8:23], v[140:143], v[172:175], v[8:23]
    ds_read_b128 v[164:167], v182 offset:8192
    ds_read_b128 v[168:171], v182 offset:12288
    v_mfma_f32_32x32x16_bf16 v[24:39], v[140:143], v[176:179], v[24:39]
    s_add_u32 s41, s52, 3072
    buffer_load_dwordx4 v[128:131], v5, s[8:11], s41 offen offset:0 sc1
    v_mfma_f32_32x32x16_bf16 v[40:55], v[144:147], v[172:175], v[40:55]
    s_add_u32 s41, s52, 3072
    buffer_load_dwordx4 v[132:135], v5, s[8:11], s41 offen offset:1024 sc1
    v_mfma_f32_32x32x16_bf16 v[56:71], v[144:147], v[176:179], v[56:71]
    s_add_u32 s41, s52, 3072
    buffer_load_dwordx4 v[136:139], v5, s[8:11], s41 offen offset:2048 sc1
    v_mfma_f32_32x32x16_bf16 v[72:87], v[148:151], v[172:175], v[72:87]
    s_add_u32 s42, s54, 163840
    s_add_u32 m0, s46, 5120
    s_nop 0
    buffer_load_dwordx4 v7, s[4:7], s42 offen lds
    v_mfma_f32_32x32x16_bf16 v[88:103], v[148:151], v[176:179], v[88:103]
    s_add_u32 s42, s54, 196608
    s_add_u32 m0, s46, 6144
    s_nop 0
    buffer_load_dwordx4 v6, s[4:7], s42 offen lds
    s_add_u32 s42, s54, 229376
    s_add_u32 m0, s46, 7168
    s_nop 0
    buffer_load_dwordx4 v7, s[4:7], s42 offen lds
    s_waitcnt vmcnt(17)
    s_waitcnt lgkmcnt(0)
    v_mfma_f32_32x32x16_bf16 v[8:23], v[152:155], v[164:167], v[8:23]
    ds_read_b128 v[172:175], v183 offset:8192
    ds_read_b128 v[176:179], v183 offset:12288
    v_mfma_f32_32x32x16_bf16 v[24:39], v[152:155], v[168:171], v[24:39]
    s_add_u32 s41, s52, 6144
    buffer_load_dwordx4 v[140:143], v5, s[8:11], s41 offen offset:0 sc1
    v_mfma_f32_32x32x16_bf16 v[40:55], v[156:159], v[164:167], v[40:55]
    s_add_u32 s41, s52, 6144
    buffer_load_dwordx4 v[144:147], v5, s[8:11], s41 offen offset:1024 sc1
    v_mfma_f32_32x32x16_bf16 v[56:71], v[156:159], v[168:171], v[56:71]
    s_add_u32 s41, s52, 6144
    buffer_load_dwordx4 v[148:151], v5, s[8:11], s41 offen offset:2048 sc1
    v_mfma_f32_32x32x16_bf16 v[72:87], v[160:163], v[164:167], v[72:87]
    v_mfma_f32_32x32x16_bf16 v[88:103], v[160:163], v[168:171], v[88:103]
    s_waitcnt vmcnt(17)
    s_waitcnt lgkmcnt(0)
    v_mfma_f32_32x32x16_bf16 v[8:23], v[104:107], v[172:175], v[8:23]
    s_waitcnt vmcnt(3)
    ds_read_b128 v[164:167], v180 offset:0
    ds_read_b128 v[168:171], v180 offset:4096
    v_mfma_f32_32x32x16_bf16 v[24:39], v[104:107], v[176:179], v[24:39]
    s_add_u32 s41, s52, 9216
    buffer_load_dwordx4 v[152:155], v5, s[8:11], s41 offen offset:0 sc1
    v_mfma_f32_32x32x16_bf16 v[40:55], v[108:111], v[172:175], v[40:55]
    s_add_u32 s41, s52, 9216
    buffer_load_dwordx4 v[156:159], v5, s[8:11], s41 offen offset:1024 sc1
    v_mfma_f32_32x32x16_bf16 v[56:71], v[108:111], v[176:179], v[56:71]
    s_add_u32 s41, s52, 9216
    buffer_load_dwordx4 v[160:163], v5, s[8:11], s41 offen offset:2048 sc1
    v_mfma_f32_32x32x16_bf16 v[72:87], v[112:115], v[172:175], v[72:87]
    s_add_u32 s55, s50, 5
    s_and_b32 s55, s55, 7
    s_lshl_b32 s55, s55, 7
    s_add_u32 s55, s55, s45
    s_add_u32 s42, s55, 0
    s_add_u32 m0, s46, 8192
    s_nop 0
    buffer_load_dwordx4 v6, s[4:7], s42 offen lds
    v_mfma_f32_32x32x16_bf16 v[88:103], v[112:115], v[176:179], v[88:103]
    s_add_u32 s42, s55, 32768
    s_add_u32 m0, s46, 9216
    s_nop 0
    buffer_load_dwordx4 v7, s[4:7], s42 offen lds
    s_waitcnt vmcnt(17)
    s_waitcnt lgkmcnt(0)
    v_mfma_f32_32x32x16_bf16 v[8:23], v[116:119], v[164:167], v[8:23]
    ds_read_b128 v[172:175], v181 offset:0
    ds_read_b128 v[176:179], v181 offset:4096
    v_mfma_f32_32x32x16_bf16 v[24:39], v[116:119], v[168:171], v[24:39]
    s_add_u32 s53, s50, 5
    s_and_b32 s53, s53, 7
    s_mul_i32 s53, s53, 12288
    s_add_u32 s53, s53, s44
    buffer_load_dwordx4 v[104:107], v5, s[8:11], s53 offen offset:0 sc1
    v_mfma_f32_32x32x16_bf16 v[40:55], v[120:123], v[164:167], v[40:55]
    buffer_load_dwordx4 v[108:111], v5, s[8:11], s53 offen offset:1024 sc1
    v_mfma_f32_32x32x16_bf16 v[56:71], v[120:123], v[168:171], v[56:71]
    buffer_load_dwordx4 v[112:115], v5, s[8:11], s53 offen offset:2048 sc1
    v_mfma_f32_32x32x16_bf16 v[72:87], v[124:127], v[164:167], v[72:87]
    s_add_u32 s42, s55, 65536
    s_add_u32 m0, s46, 10240
    s_nop 0
    buffer_load_dwordx4 v6, s[4:7], s42 offen lds
    v_mfma_f32_32x32x16_bf16 v[88:103], v[124:127], v[168:171], v[88:103]
    s_add_u32 s42, s55, 98304
    s_add_u32 m0, s46, 11264
    s_nop 0
    buffer_load_dwordx4 v7, s[4:7], s42 offen lds
    s_add_u32 s42, s55, 131072
    s_add_u32 m0, s46, 12288
    s_nop 0
    buffer_load_dwordx4 v6, s[4:7], s42 offen lds
    s_waitcnt vmcnt(17)
    s_waitcnt lgkmcnt(0)
    v_mfma_f32_32x32x16_bf16 v[8:23], v[128:131], v[172:175], v[8:23]
    ds_read_b128 v[164:167], v182 offset:0
    ds_read_b128 v[168:171], v182 offset:4096
    v_mfma_f32_32x32x16_bf16 v[24:39], v[128:131], v[176:179], v[24:39]
    s_add_u32 s41, s53, 3072
    buffer_load_dwordx4 v[116:119], v5, s[8:11], s41 offen offset:0 sc1
    v_mfma_f32_32x32x16_bf16 v[40:55], v[132:135], v[172:175], v[40:55]
    s_add_u32 s41, s53, 3072
    buffer_load_dwordx4 v[120:123], v5, s[8:11], s41 offen offset:1024 sc1
    v_mfma_f32_32x32x16_bf16 v[56:71], v[132:135], v[176:179], v[56:71]
    s_add_u32 s41, s53, 3072
    buffer_load_dwordx4 v[124:127], v5, s[8:11], s41 offen offset:2048 sc1
    v_mfma_f32_32x32x16_bf16 v[72:87], v[136:139], v[172:175], v[72:87]
    s_add_u32 s42, s55, 163840
    s_add_u32 m0, s46, 13312
    s_nop 0
    buffer_load_dwordx4 v7, s[4:7], s42 offen lds
    v_mfma_f32_32x32x16_bf16 v[88:103], v[136:139], v[176:179], v[88:103]
    s_add_u32 s42, s55, 196608
    s_add_u32 m0, s46, 14336
    s_nop 0
    buffer_load_dwordx4 v6, s[4:7], s42 offen lds
    s_add_u32 s42, s55, 229376
    s_add_u32 m0, s46, 15360
    s_nop 0
    buffer_load_dwordx4 v7, s[4:7], s42 offen lds
    s_waitcnt vmcnt(17)
    s_waitcnt lgkmcnt(0)
    v_mfma_f32_32x32x16_bf16 v[8:23], v[140:143], v[164:167], v[8:23]
    ds_read_b128 v[172:175], v183 offset:0
    ds_read_b128 v[176:179], v183 offset:4096
    v_mfma_f32_32x32x16_bf16 v[24:39], v[140:143], v[168:171], v[24:39]
    s_add_u32 s41, s53, 6144
    buffer_load_dwordx4 v[128:131], v5, s[8:11], s41 offen offset:0 sc1
    v_mfma_f32_32x32x16_bf16 v[40:55], v[144:147], v[164:167], v[40:55]
    s_add_u32 s41, s53, 6144
    buffer_load_dwordx4 v[132:135], v5, s[8:11], s41 offen offset:1024 sc1
    v_mfma_f32_32x32x16_bf16 v[56:71], v[144:147], v[168:171], v[56:71]
    s_add_u32 s41, s53, 6144
    buffer_load_dwordx4 v[136:139], v5, s[8:11], s41 offen offset:2048 sc1
    v_mfma_f32_32x32x16_bf16 v[72:87], v[148:151], v[164:167], v[72:87]
    v_mfma_f32_32x32x16_bf16 v[88:103], v[148:151], v[168:171], v[88:103]
    s_waitcnt vmcnt(17)
    s_waitcnt lgkmcnt(0)
    v_mfma_f32_32x32x16_bf16 v[8:23], v[152:155], v[172:175], v[8:23]
    s_waitcnt vmcnt(3)
    ds_read_b128 v[164:167], v180 offset:8192
    ds_read_b128 v[168:171], v180 offset:12288
    v_mfma_f32_32x32x16_bf16 v[24:39], v[152:155], v[176:179], v[24:39]
    s_add_u32 s41, s53, 9216
    buffer_load_dwordx4 v[140:143], v5, s[8:11], s41 offen offset:0 sc1
    v_mfma_f32_32x32x16_bf16 v[40:55], v[156:159], v[172:175], v[40:55]
    s_add_u32 s41, s53, 9216
    buffer_load_dwordx4 v[144:147], v5, s[8:11], s41 offen offset:1024 sc1
    v_mfma_f32_32x32x16_bf16 v[56:71], v[156:159], v[176:179], v[56:71]
    s_add_u32 s41, s53, 9216
    buffer_load_dwordx4 v[148:151], v5, s[8:11], s41 offen offset:2048 sc1
    v_mfma_f32_32x32x16_bf16 v[72:87], v[160:163], v[172:175], v[72:87]
    s_add_u32 s54, s50, 6
    s_and_b32 s54, s54, 7
    s_lshl_b32 s54, s54, 7
    s_add_u32 s54, s54, s45
    s_add_u32 s42, s54, 0
    s_add_u32 m0, s46, 0
    s_nop 0
    buffer_load_dwordx4 v6, s[4:7], s42 offen lds
    v_mfma_f32_32x32x16_bf16 v[88:103], v[160:163], v[176:179], v[88:103]
    s_add_u32 s42, s54, 32768
    s_add_u32 m0, s46, 1024
    s_nop 0
    buffer_load_dwordx4 v7, s[4:7], s42 offen lds
    s_waitcnt vmcnt(17)
    s_waitcnt lgkmcnt(0)
    v_mfma_f32_32x32x16_bf16 v[8:23], v[104:107], v[164:167], v[8:23]
    ds_read_b128 v[172:175], v181 offset:8192
    ds_read_b128 v[176:179], v181 offset:12288
    v_mfma_f32_32x32x16_bf16 v[24:39], v[104:107], v[168:171], v[24:39]
    s_add_u32 s52, s50, 6
    s_and_b32 s52, s52, 7
    s_mul_i32 s52, s52, 12288
    s_add_u32 s52, s52, s44
    buffer_load_dwordx4 v[152:155], v5, s[8:11], s52 offen offset:0 sc1
    v_mfma_f32_32x32x16_bf16 v[40:55], v[108:111], v[164:167], v[40:55]
    buffer_load_dwordx4 v[156:159], v5, s[8:11], s52 offen offset:1024 sc1
    v_mfma_f32_32x32x16_bf16 v[56:71], v[108:111], v[168:171], v[56:71]
    buffer_load_dwordx4 v[160:163], v5, s[8:11], s52 offen offset:2048 sc1
    v_mfma_f32_32x32x16_bf16 v[72:87], v[112:115], v[164:167], v[72:87]
    s_add_u32 s42, s54, 65536
    s_add_u32 m0, s46, 2048
    s_nop 0
    buffer_load_dwordx4 v6, s[4:7], s42 offen lds
    v_mfma_f32_32x32x16_bf16 v[88:103], v[112:115], v[168:171], v[88:103]
    s_add_u32 s42, s54, 98304
    s_add_u32 m0, s46, 3072
    s_nop 0
    buffer_load_dwordx4 v7, s[4:7], s42 offen lds
    s_add_u32 s42, s54, 131072
    s_add_u32 m0, s46, 4096
    s_nop 0
    buffer_load_dwordx4 v6, s[4:7], s42 offen lds
    s_waitcnt vmcnt(17)
    s_waitcnt lgkmcnt(0)
    v_mfma_f32_32x32x16_bf16 v[8:23], v[116:119], v[172:175], v[8:23]
    ds_read_b128 v[164:167], v182 offset:8192
    ds_read_b128 v[168:171], v182 offset:12288
    v_mfma_f32_32x32x16_bf16 v[24:39], v[116:119], v[176:179], v[24:39]
    s_add_u32 s41, s52, 3072
    buffer_load_dwordx4 v[104:107], v5, s[8:11], s41 offen offset:0 sc1
    v_mfma_f32_32x32x16_bf16 v[40:55], v[120:123], v[172:175], v[40:55]
    s_add_u32 s41, s52, 3072
    buffer_load_dwordx4 v[108:111], v5, s[8:11], s41 offen offset:1024 sc1
    v_mfma_f32_32x32x16_bf16 v[56:71], v[120:123], v[176:179], v[56:71]
    s_add_u32 s41, s52, 3072
    buffer_load_dwordx4 v[112:115], v5, s[8:11], s41 offen offset:2048 sc1
    v_mfma_f32_32x32x16_bf16 v[72:87], v[124:127], v[172:175], v[72:87]
    s_add_u32 s42, s54, 163840
    s_add_u32 m0, s46, 5120
    s_nop 0
    buffer_load_dwordx4 v7, s[4:7], s42 offen lds
    v_mfma_f32_32x32x16_bf16 v[88:103], v[124:127], v[176:179], v[88:103]
    s_add_u32 s42, s54, 196608
    s_add_u32 m0, s46, 6144
    s_nop 0
    buffer_load_dwordx4 v6, s[4:7], s42 offen lds
    s_add_u32 s42, s54, 229376
    s_add_u32 m0, s46, 7168
    s_nop 0
    buffer_load_dwordx4 v7, s[4:7], s42 offen lds
    s_waitcnt vmcnt(17)
    s_waitcnt lgkmcnt(0)
    v_mfma_f32_32x32x16_bf16 v[8:23], v[128:131], v[164:167], v[8:23]
    ds_read_b128 v[172:175], v183 offset:8192
    ds_read_b128 v[176:179], v183 offset:12288
    v_mfma_f32_32x32x16_bf16 v[24:39], v[128:131], v[168:171], v[24:39]
    s_add_u32 s41, s52, 6144
    buffer_load_dwordx4 v[116:119], v5, s[8:11], s41 offen offset:0 sc1
    v_mfma_f32_32x32x16_bf16 v[40:55], v[132:135], v[164:167], v[40:55]
    s_add_u32 s41, s52, 6144
    buffer_load_dwordx4 v[120:123], v5, s[8:11], s41 offen offset:1024 sc1
    v_mfma_f32_32x32x16_bf16 v[56:71], v[132:135], v[168:171], v[56:71]
    s_add_u32 s41, s52, 6144
    buffer_load_dwordx4 v[124:127], v5, s[8:11], s41 offen offset:2048 sc1
    v_mfma_f32_32x32x16_bf16 v[72:87], v[136:139], v[164:167], v[72:87]
    v_mfma_f32_32x32x16_bf16 v[88:103], v[136:139], v[168:171], v[88:103]
    s_waitcnt vmcnt(17)
    s_waitcnt lgkmcnt(0)
    v_mfma_f32_32x32x16_bf16 v[8:23], v[140:143], v[172:175], v[8:23]
    s_waitcnt vmcnt(3)
    ds_read_b128 v[164:167], v180 offset:0
    ds_read_b128 v[168:171], v180 offset:4096
    v_mfma_f32_32x32x16_bf16 v[24:39], v[140:143], v[176:179], v[24:39]
    s_add_u32 s41, s52, 9216
    buffer_load_dwordx4 v[128:131], v5, s[8:11], s41 offen offset:0 sc1
    v_mfma_f32_32x32x16_bf16 v[40:55], v[144:147], v[172:175], v[40:55]
    s_add_u32 s41, s52, 9216
    buffer_load_dwordx4 v[132:135], v5, s[8:11], s41 offen offset:1024 sc1
    v_mfma_f32_32x32x16_bf16 v[56:71], v[144:147], v[176:179], v[56:71]
    s_add_u32 s41, s52, 9216
    buffer_load_dwordx4 v[136:139], v5, s[8:11], s41 offen offset:2048 sc1
    v_mfma_f32_32x32x16_bf16 v[72:87], v[148:151], v[172:175], v[72:87]
    s_add_u32 s55, s50, 7
    s_and_b32 s55, s55, 7
    s_lshl_b32 s55, s55, 7
    s_add_u32 s55, s55, s45
    s_add_u32 s42, s55, 0
    s_add_u32 m0, s46, 8192
    s_nop 0
    buffer_load_dwordx4 v6, s[4:7], s42 offen lds
    v_mfma_f32_32x32x16_bf16 v[88:103], v[148:151], v[176:179], v[88:103]
    s_add_u32 s42, s55, 32768
    s_add_u32 m0, s46, 9216
    s_nop 0
    buffer_load_dwordx4 v7, s[4:7], s42 offen lds
    s_waitcnt vmcnt(17)
    s_waitcnt lgkmcnt(0)
    v_mfma_f32_32x32x16_bf16 v[8:23], v[152:155], v[164:167], v[8:23]
    ds_read_b128 v[172:175], v181 offset:0
    ds_read_b128 v[176:179], v181 offset:4096
    v_mfma_f32_32x32x16_bf16 v[24:39], v[152:155], v[168:171], v[24:39]
    s_add_u32 s53, s50, 7
    s_and_b32 s53, s53, 7
    s_mul_i32 s53, s53, 12288
    s_add_u32 s53, s53, s44
    buffer_load_dwordx4 v[140:143], v5, s[8:11], s53 offen offset:0 sc1
    v_mfma_f32_32x32x16_bf16 v[40:55], v[156:159], v[164:167], v[40:55]
    buffer_load_dwordx4 v[144:147], v5, s[8:11], s53 offen offset:1024 sc1
    v_mfma_f32_32x32x16_bf16 v[56:71], v[156:159], v[168:171], v[56:71]
    buffer_load_dwordx4 v[148:151], v5, s[8:11], s53 offen offset:2048 sc1
    v_mfma_f32_32x32x16_bf16 v[72:87], v[160:163], v[164:167], v[72:87]
    s_add_u32 s42, s55, 65536
    s_add_u32 m0, s46, 10240
    s_nop 0
    buffer_load_dwordx4 v6, s[4:7], s42 offen lds
    v_mfma_f32_32x32x16_bf16 v[88:103], v[160:163], v[168:171], v[88:103]
    s_add_u32 s42, s55, 98304
    s_add_u32 m0, s46, 11264
    s_nop 0
    buffer_load_dwordx4 v7, s[4:7], s42 offen lds
    s_add_u32 s42, s55, 131072
    s_add_u32 m0, s46, 12288
    s_nop 0
    buffer_load_dwordx4 v6, s[4:7], s42 offen lds
    s_waitcnt vmcnt(17)
    s_waitcnt lgkmcnt(0)
    v_mfma_f32_32x32x16_bf16 v[8:23], v[104:107], v[172:175], v[8:23]
    ds_read_b128 v[164:167], v182 offset:0
    ds_read_b128 v[168:171], v182 offset:4096
    v_mfma_f32_32x32x16_bf16 v[24:39], v[104:107], v[176:179], v[24:39]
    s_add_u32 s41, s53, 3072
    buffer_load_dwordx4 v[152:155], v5, s[8:11], s41 offen offset:0 sc1
    v_mfma_f32_32x32x16_bf16 v[40:55], v[108:111], v[172:175], v[40:55]
    s_add_u32 s41, s53, 3072
    buffer_load_dwordx4 v[156:159], v5, s[8:11], s41 offen offset:1024 sc1
    v_mfma_f32_32x32x16_bf16 v[56:71], v[108:111], v[176:179], v[56:71]
    s_add_u32 s41, s53, 3072
    buffer_load_dwordx4 v[160:163], v5, s[8:11], s41 offen offset:2048 sc1
    v_mfma_f32_32x32x16_bf16 v[72:87], v[112:115], v[172:175], v[72:87]
    s_add_u32 s42, s55, 163840
    s_add_u32 m0, s46, 13312
    s_nop 0
    buffer_load_dwordx4 v7, s[4:7], s42 offen lds
    v_mfma_f32_32x32x16_bf16 v[88:103], v[112:115], v[176:179], v[88:103]
    s_add_u32 s42, s55, 196608
    s_add_u32 m0, s46, 14336
    s_nop 0
    buffer_load_dwordx4 v6, s[4:7], s42 offen lds
    s_add_u32 s42, s55, 229376
    s_add_u32 m0, s46, 15360
    s_nop 0
    buffer_load_dwordx4 v7, s[4:7], s42 offen lds
    s_waitcnt vmcnt(17)
    s_waitcnt lgkmcnt(0)
    v_mfma_f32_32x32x16_bf16 v[8:23], v[116:119], v[164:167], v[8:23]
    ds_read_b128 v[172:175], v183 offset:0
    ds_read_b128 v[176:179], v183 offset:4096
    v_mfma_f32_32x32x16_bf16 v[24:39], v[116:119], v[168:171], v[24:39]
    s_add_u32 s41, s53, 6144
    buffer_load_dwordx4 v[104:107], v5, s[8:11], s41 offen offset:0 sc1
    v_mfma_f32_32x32x16_bf16 v[40:55], v[120:123], v[164:167], v[40:55]
    s_add_u32 s41, s53, 6144
    buffer_load_dwordx4 v[108:111], v5, s[8:11], s41 offen offset:1024 sc1
    v_mfma_f32_32x32x16_bf16 v[56:71], v[120:123], v[168:171], v[56:71]
    s_add_u32 s41, s53, 6144
    buffer_load_dwordx4 v[112:115], v5, s[8:11], s41 offen offset:2048 sc1
    v_mfma_f32_32x32x16_bf16 v[72:87], v[124:127], v[164:167], v[72:87]
    v_mfma_f32_32x32x16_bf16 v[88:103], v[124:127], v[168:171], v[88:103]
    s_waitcnt vmcnt(17)
    s_waitcnt lgkmcnt(0)
    v_mfma_f32_32x32x16_bf16 v[8:23], v[128:131], v[172:175], v[8:23]
    s_waitcnt vmcnt(3)
    ds_read_b128 v[164:167], v180 offset:8192
    ds_read_b128 v[168:171], v180 offset:12288
    v_mfma_f32_32x32x16_bf16 v[24:39], v[128:131], v[176:179], v[24:39]
    s_add_u32 s41, s53, 9216
    buffer_load_dwordx4 v[116:119], v5, s[8:11], s41 offen offset:0 sc1
    v_mfma_f32_32x32x16_bf16 v[40:55], v[132:135], v[172:175], v[40:55]
    s_add_u32 s41, s53, 9216
    buffer_load_dwordx4 v[120:123], v5, s[8:11], s41 offen offset:1024 sc1
    v_mfma_f32_32x32x16_bf16 v[56:71], v[132:135], v[176:179], v[56:71]
    s_add_u32 s41, s53, 9216
    buffer_load_dwordx4 v[124:127], v5, s[8:11], s41 offen offset:2048 sc1
    v_mfma_f32_32x32x16_bf16 v[72:87], v[136:139], v[172:175], v[72:87]
    v_mfma_f32_32x32x16_bf16 v[88:103], v[136:139], v[176:179], v[88:103]
    s_waitcnt vmcnt(15)
    s_waitcnt lgkmcnt(0)
    v_mfma_f32_32x32x16_bf16 v[8:23], v[140:143], v[164:167], v[8:23]
    ds_read_b128 v[172:175], v181 offset:8192
    ds_read_b128 v[176:179], v181 offset:12288
    v_mfma_f32_32x32x16_bf16 v[24:39], v[140:143], v[168:171], v[24:39]
    v_mfma_f32_32x32x16_bf16 v[40:55], v[144:147], v[164:167], v[40:55]
    v_mfma_f32_32x32x16_bf16 v[56:71], v[144:147], v[168:171], v[56:71]
    v_mfma_f32_32x32x16_bf16 v[72:87], v[148:151], v[164:167], v[72:87]
    v_mfma_f32_32x32x16_bf16 v[88:103], v[148:151], v[168:171], v[88:103]
    s_waitcnt vmcnt(9)
    s_waitcnt lgkmcnt(0)
    v_mfma_f32_32x32x16_bf16 v[8:23], v[152:155], v[172:175], v[8:23]
    ds_read_b128 v[164:167], v182 offset:8192
    ds_read_b128 v[168:171], v182 offset:12288
    v_mfma_f32_32x32x16_bf16 v[24:39], v[152:155], v[176:179], v[24:39]
    v_mfma_f32_32x32x16_bf16 v[40:55], v[156:159], v[172:175], v[40:55]
    v_mfma_f32_32x32x16_bf16 v[56:71], v[156:159], v[176:179], v[56:71]
    v_mfma_f32_32x32x16_bf16 v[72:87], v[160:163], v[172:175], v[72:87]
    v_mfma_f32_32x32x16_bf16 v[88:103], v[160:163], v[176:179], v[88:103]
    s_waitcnt vmcnt(3)
    s_waitcnt lgkmcnt(0)
    v_mfma_f32_32x32x16_bf16 v[8:23], v[104:107], v[164:167], v[8:23]
    ds_read_b128 v[172:175], v183 offset:8192
    ds_read_b128 v[176:179], v183 offset:12288
    v_mfma_f32_32x32x16_bf16 v[24:39], v[104:107], v[168:171], v[24:39]
    s_lshl_b32 s40, s32, 3
    s_add_u32 s40, s40, s33
    s_lshl_b32 s40, s40, 2
    s_add_u32 s40, s40, s34
    s_mul_i32 s40, s40, 3072
    s_add_u32 s40, s40, 3145728
    s_mul_i32 s40, s34, 3072
    s_add_u32 s40, s40, 73728
    v_add_u32 v3, s40, v5
    ds_read_b128 v[184:187], v3 offset:0
    v_mfma_f32_32x32x16_bf16 v[40:55], v[108:111], v[164:167], v[40:55]
    ds_read_b128 v[188:191], v3 offset:1024
    v_mfma_f32_32x32x16_bf16 v[56:71], v[108:111], v[168:171], v[56:71]
    ds_read_b128 v[192:195], v3 offset:2048
    v_mfma_f32_32x32x16_bf16 v[72:87], v[112:115], v[164:167], v[72:87]
    v_and_b32 v2, 31, v1
    v_lshlrev_b32 v2, 1, v2
    s_lshr_b32 s40, s34, 1
    s_lshl_b32 s40, s40, 6
    s_lshl_b32 s43, s32, 7
    s_add_u32 s40, s40, s43
    buffer_load_ushort v196, v2, s[12:15], s40 offen
    v_mfma_f32_32x32x16_bf16 v[88:103], v[112:115], v[168:171], v[88:103]
    s_waitcnt vmcnt(1)
    s_waitcnt lgkmcnt(3)
    v_mfma_f32_32x32x16_bf16 v[8:23], v[116:119], v[172:175], v[8:23]
    v_mfma_f32_32x32x16_bf16 v[24:39], v[116:119], v[176:179], v[24:39]
    v_mfma_f32_32x32x16_bf16 v[40:55], v[120:123], v[172:175], v[40:55]
    v_mfma_f32_32x32x16_bf16 v[56:71], v[120:123], v[176:179], v[56:71]
    v_mfma_f32_32x32x16_bf16 v[72:87], v[124:127], v[172:175], v[72:87]
    v_mfma_f32_32x32x16_bf16 v[88:103], v[124:127], v[176:179], v[88:103]
    s_setprio 0
    v_add_u32 v4, 0x10000, v5
    s_nop 15
    s_waitcnt lgkmcnt(0)
    v_mov_b32 v2, 161792
    v_mov_b32 v3, 1
    s_mov_b64 exec, 1
    ds_add_u32 v2, v3
    s_mov_b64 exec, -1
    s_mov_b32 s67, 0
gsync_18:
    ds_read_b32 v3, v2
    s_add_u32 s67, s67, 1
    s_waitcnt lgkmcnt(0)
    v_readfirstlane_b32 s66, v3
    s_cmp_gt_u32 s67, 1000000
    s_cbranch_scc1 gsync_e_19
    s_cmp_lt_u32 s66, 4
    s_cbranch_scc1 gsync_18
gsync_e_19:
    s_cmp_lg_u32 s34, 0
    s_cbranch_scc1 g_epi_14
    ds_write_b128 v5, v[12:15] offset:30720
    ds_write_b128 v5, v[20:23] offset:31744
    ds_write_b128 v5, v[44:47] offset:32768
    ds_write_b128 v5, v[52:55] offset:33792
    ds_write_b128 v5, v[76:79] offset:34816
    ds_write_b128 v5, v[84:87] offset:35840
    ds_write_b128 v5, v[24:27] offset:43008
    ds_write_b128 v5, v[32:35] offset:44032
    ds_write_b128 v5, v[56:59] offset:45056
    ds_write_b128 v5, v[64:67] offset:46080
    ds_write_b128 v5, v[88:91] offset:47104
    ds_write_b128 v5, v[96:99] offset:48128
    ds_write_b128 v5, v[28:31] offset:55296
    ds_write_b128 v5, v[36:39] offset:56320
    ds_write_b128 v5, v[60:63] offset:57344
    ds_write_b128 v5, v[68:71] offset:58368
    ds_write_b128 v5, v[92:95] offset:59392
    ds_write_b128 v5, v[100:103] offset:60416
    v_pk_add_f32 v[104:105], v[8:9], 0
    v_pk_add_f32 v[106:107], v[10:11], 0
    v_pk_add_f32 v[108:109], v[16:17], 0
    v_pk_add_f32 v[110:111], v[18:19], 0
    v_pk_add_f32 v[112:113], v[40:41], 0
    v_pk_add_f32 v[114:115], v[42:43], 0
    v_pk_add_f32 v[116:117], v[48:49], 0
    v_pk_add_f32 v[118:119], v[50:51], 0
    v_pk_add_f32 v[120:121], v[72:73], 0
    v_pk_add_f32 v[122:123], v[74:75], 0
    v_pk_add_f32 v[124:125], v[80:81], 0
    v_pk_add_f32 v[126:127], v[82:83], 0
    s_branch g_epi_end_13
g_epi_14:
    s_cmp_lg_u32 s34, 1
    s_cbranch_scc1 g_epi_15
    ds_write_b128 v5, v[8:11] offset:0
    ds_write_b128 v5, v[16:19] offset:1024
    ds_write_b128 v5, v[40:43] offset:2048
    ds_write_b128 v5, v[48:51] offset:3072
    ds_write_b128 v5, v[72:75] offset:4096
    ds_write_b128 v5, v[80:83] offset:5120
    ds_write_b128 v5, v[24:27] offset:49152
    ds_write_b128 v5, v[32:35] offset:50176
    ds_write_b128 v5, v[56:59] offset:51200
    ds_write_b128 v5, v[64:67] offset:52224
    ds_write_b128 v5, v[88:91] offset:53248
    ds_write_b128 v5, v[96:99] offset:54272
    ds_write_b128 v5, v[28:31] offset:61440
    ds_write_b128 v5, v[36:39] offset:62464
    ds_write_b128 v5, v[60:63] offset:63488
    ds_write_b128 v5, v[68:71] offset:64512
    ds_write_b128 v4, v[92:95] offset:0
    ds_write_b128 v4, v[100:103] offset:1024
    v_pk_add_f32 v[104:105], v[12:13], 0
    v_pk_add_f32 v[106:107], v[14:15], 0
    v_pk_add_f32 v[108:109], v[20:21], 0
    v_pk_add_f32 v[110:111], v[22:23], 0
    v_pk_add_f32 v[112:113], v[44:45], 0
    v_pk_add_f32 v[114:115], v[46:47], 0
    v_pk_add_f32 v[116:117], v[52:53], 0
    v_pk_add_f32 v[118:119], v[54:55], 0
    v_pk_add_f32 v[120:121], v[76:77], 0
    v_pk_add_f32 v[122:123], v[78:79], 0
    v_pk_add_f32 v[124:125], v[84:85], 0
    v_pk_add_f32 v[126:127], v[86:87], 0
    s_branch g_epi_end_13
g_epi_15:
    s_cmp_lg_u32 s34, 2
    s_cbranch_scc1 g_epi_16
    ds_write_b128 v5, v[8:11] offset:6144
    ds_write_b128 v5, v[16:19] offset:7168
    ds_write_b128 v5, v[40:43] offset:8192
    ds_write_b128 v5, v[48:51] offset:9216
    ds_write_b128 v5, v[72:75] offset:10240
    ds_write_b128 v5, v[80:83] offset:11264
    ds_write_b128 v5, v[12:15] offset:18432
    ds_write_b128 v5, v[20:23] offset:19456
    ds_write_b128 v5, v[44:47] offset:20480
    ds_write_b128 v5, v[52:55] offset:21504
    ds_write_b128 v5, v[76:79] offset:22528
    ds_write_b128 v5, v[84:87] offset:23552
    ds_write_b128 v4, v[28:31] offset:2048
    ds_write_b128 v4, v[36:39] offset:3072
    ds_write_b128 v4, v[60:63] offset:4096
    ds_write_b128 v4, v[68:71] offset:5120
    ds_write_b128 v4, v[92:95] offset:6144
    ds_write_b128 v4, v[100:103] offset:7168
    v_pk_add_f32 v[104:105], v[24:25], 0
    v_pk_add_f32 v[106:107], v[26:27], 0
    v_pk_add_f32 v[108:109], v[32:33], 0
    v_pk_add_f32 v[110:111], v[34:35], 0
    v_pk_add_f32 v[112:113], v[56:57], 0
    v_pk_add_f32 v[114:115], v[58:59], 0
    v_pk_add_f32 v[116:117], v[64:65], 0
    v_pk_add_f32 v[118:119], v[66:67], 0
    v_pk_add_f32 v[120:121], v[88:89], 0
    v_pk_add_f32 v[122:123], v[90:91], 0
    v_pk_add_f32 v[124:125], v[96:97], 0
    v_pk_add_f32 v[126:127], v[98:99], 0
    s_branch g_epi_end_13
g_epi_16:
    ds_write_b128 v5, v[8:11] offset:12288
    ds_write_b128 v5, v[16:19] offset:13312
    ds_write_b128 v5, v[40:43] offset:14336
    ds_write_b128 v5, v[48:51] offset:15360
    ds_write_b128 v5, v[72:75] offset:16384
    ds_write_b128 v5, v[80:83] offset:17408
    ds_write_b128 v5, v[12:15] offset:24576
    ds_write_b128 v5, v[20:23] offset:25600
    ds_write_b128 v5, v[44:47] offset:26624
    ds_write_b128 v5, v[52:55] offset:27648
    ds_write_b128 v5, v[76:79] offset:28672
    ds_write_b128 v5, v[84:87] offset:29696
    ds_write_b128 v5, v[24:27] offset:36864
    ds_write_b128 v5, v[32:35] offset:37888
    ds_write_b128 v5, v[56:59] offset:38912
    ds_write_b128 v5, v[64:67] offset:39936
    ds_write_b128 v5, v[88:91] offset:40960
    ds_write_b128 v5, v[96:99] offset:41984
    v_pk_add_f32 v[104:105], v[28:29], 0
    v_pk_add_f32 v[106:107], v[30:31], 0
    v_pk_add_f32 v[108:109], v[36:37], 0
    v_pk_add_f32 v[110:111], v[38:39], 0
    v_pk_add_f32 v[112:113], v[60:61], 0
    v_pk_add_f32 v[114:115], v[62:63], 0
    v_pk_add_f32 v[116:117], v[68:69], 0
    v_pk_add_f32 v[118:119], v[70:71], 0
    v_pk_add_f32 v[120:121], v[92:93], 0
    v_pk_add_f32 v[122:123], v[94:95], 0
    v_pk_add_f32 v[124:125], v[100:101], 0
    v_pk_add_f32 v[126:127], v[102:103], 0
g_epi_end_13:
    s_waitcnt lgkmcnt(0)
    s_waitcnt lgkmcnt(0)
    v_mov_b32 v2, 161792
    v_mov_b32 v3, 1
    s_mov_b64 exec, 1
    ds_add_u32 v2, v3
    s_mov_b64 exec, -1
    s_mov_b32 s67, 0
gsync_20:
    ds_read_b32 v3, v2
    s_add_u32 s67, s67, 1
    s_waitcnt lgkmcnt(0)
    v_readfirstlane_b32 s66, v3
    s_cmp_gt_u32 s67, 1000000
    s_cbranch_scc1 gsync_e_21
    s_cmp_lt_u32 s66, 8
    s_cbranch_scc1 gsync_20
gsync_e_21:
    s_mul_i32 s40, s34, 18432
    v_add_u32 v2, s40, v5
    ds_read_b128 v[8:11], v2 offset:0
    ds_read_b128 v[12:15], v2 offset:1024
    ds_read_b128 v[16:19], v2 offset:2048
    ds_read_b128 v[20:23], v2 offset:3072
    ds_read_b128 v[24:27], v2 offset:4096
    ds_read_b128 v[28:31], v2 offset:5120
    ds_read_b128 v[32:35], v2 offset:6144
    ds_read_b128 v[36:39], v2 offset:7168
    ds_read_b128 v[40:43], v2 offset:8192
    ds_read_b128 v[44:47], v2 offset:9216
    ds_read_b128 v[48:51], v2 offset:10240
    ds_read_b128 v[52:55], v2 offset:11264
    ds_read_b128 v[56:59], v2 offset:12288
    ds_read_b128 v[60:63], v2 offset:13312
    ds_read_b128 v[64:67], v2 offset:14336
    ds_read_b128 v[68:71], v2 offset:15360
    ds_read_b128 v[72:75], v2 offset:16384
    ds_read_b128 v[76:79], v2 offset:17408
    v_lshrrev_b32 v6, 4, v1
    v_and_b32 v6, 1, v6
    v_mul_u32_u24 v6, 24576, v6
    v_and_b32 v3, 15, v1
    v_lshrrev_b32 v4, 5, v1
    v_lshl_add_u32 v3, v4, 4, v3
    v_lshl_add_u32 v6, v3, 4, v6
    s_mul_i32 s40, s32, 98304
    s_lshr_b32 s41, s34, 1
    s_mul_i32 s41, s41, 49152
    s_add_u32 s40, s40, s41
    s_mul_i32 s41, s33, 3072
    s_add_u32 s40, s40, s41
    s_and_b32 s41, s34, 1
    s_lshl_b32 s41, s41, 9
    s_add_u32 s40, s40, s41
    s_add_u32 s40, s40, 11534336
    s_waitcnt vmcnt(0)
    v_lshlrev_b32 v180, 16, v196
    v_lshlrev_b32 v80, 16, v184
    v_and_b32 v81, 0xffff0000, v184
    v_lshlrev_b32 v82, 16, v185
    v_and_b32 v83, 0xffff0000, v185
    v_lshlrev_b32 v84, 16, v186
    v_and_b32 v85, 0xffff0000, v186
    v_lshlrev_b32 v86, 16, v187
    v_and_b32 v87, 0xffff0000, v187
    v_lshlrev_b32 v88, 16, v188
    v_and_b32 v89, 0xffff0000, v188
    v_lshlrev_b32 v90, 16, v189
    v_and_b32 v91, 0xffff0000, v189
    v_lshlrev_b32 v92, 16, v190
    v_and_b32 v93, 0xffff0000, v190
    v_lshlrev_b32 v94, 16, v191
    v_and_b32 v95, 0xffff0000, v191
    v_lshlrev_b32 v96, 16, v192
    v_and_b32 v97, 0xffff0000, v192
    v_lshlrev_b32 v98, 16, v193
    v_and_b32 v99, 0xffff0000, v193
    v_lshlrev_b32 v100, 16, v194
    v_and_b32 v101, 0xffff0000, v194
    v_lshlrev_b32 v102, 16, v195
    v_and_b32 v103, 0xffff0000, v195
    s_waitcnt lgkmcnt(12)
    v_pk_add_f32 v[104:105], v[104:105], v[8:9]
    v_pk_add_f32 v[106:107], v[106:107], v[10:11]
    v_pk_add_f32 v[108:109], v[108:109], v[12:13]
    v_pk_add_f32 v[110:111], v[110:111], v[14:15]
    v_pk_add_f32 v[112:113], v[112:113], v[16:17]
    v_pk_add_f32 v[114:115], v[114:115], v[18:19]
    v_pk_add_f32 v[116:117], v[116:117], v[20:21]
    v_pk_add_f32 v[118:119], v[118:119], v[22:23]
    v_pk_add_f32 v[120:121], v[120:121], v[24:25]
    v_pk_add_f32 v[122:123], v[122:123], v[26:27]
    v_pk_add_f32 v[124:125], v[124:125], v[28:29]
    v_pk_add_f32 v[126:127], v[126:127], v[30:31]
    s_waitcnt lgkmcnt(6)
    v_pk_add_f32 v[104:105], v[104:105], v[32:33]
    v_pk_add_f32 v[106:107], v[106:107], v[34:35]
    v_pk_add_f32 v[108:109], v[108:109], v[36:37]
    v_pk_add_f32 v[110:111], v[110:111], v[38:39]
    v_pk_add_f32 v[112:113], v[112:113], v[40:41]
    v_pk_add_f32 v[114:115], v[114:115], v[42:43]
    v_pk_add_f32 v[116:117], v[116:117], v[44:45]
    v_pk_add_f32 v[118:119], v[118:119], v[46:47]
    v_pk_add_f32 v[120:121], v[120:121], v[48:49]
    v_pk_add_f32 v[122:123], v[122:123], v[50:51]
    v_pk_add_f32 v[124:125], v[124:125], v[52:53]
    v_pk_add_f32 v[126:127], v[126:127], v[54:55]
    s_waitcnt lgkmcnt(0)
    v_pk_add_f32 v[104:105], v[104:105], v[56:57]
    v_pk_add_f32 v[106:107], v[106:107], v[58:59]
    v_pk_add_f32 v[108:109], v[108:109], v[60:61]
    v_pk_add_f32 v[110:111], v[110:111], v[62:63]
    v_pk_add_f32 v[112:113], v[112:113], v[64:65]
    v_pk_add_f32 v[114:115], v[114:115], v[66:67]
    v_pk_add_f32 v[116:117], v[116:117], v[68:69]
    v_pk_add_f32 v[118:119], v[118:119], v[70:71]
    v_pk_add_f32 v[120:121], v[120:121], v[72:73]
    v_pk_add_f32 v[122:123], v[122:123], v[74:75]
    v_pk_add_f32 v[124:125], v[124:125], v[76:77]
    v_pk_add_f32 v[126:127], v[126:127], v[78:79]
    v_pk_add_f32 v[104:105], v[104:105], v[180:181] op_sel_hi:[1,0]
    v_pk_add_f32 v[106:107], v[106:107], v[180:181] op_sel_hi:[1,0]
    v_pk_add_f32 v[108:109], v[108:109], v[180:181] op_sel_hi:[1,0]
    v_pk_add_f32 v[110:111], v[110:111], v[180:181] op_sel_hi:[1,0]
    v_pk_add_f32 v[112:113], v[112:113], v[180:181] op_sel_hi:[1,0]
    v_pk_add_f32 v[114:115], v[114:115], v[180:181] op_sel_hi:[1,0]
    v_pk_add_f32 v[116:117], v[116:117], v[180:181] op_sel_hi:[1,0]
    v_pk_add_f32 v[118:119], v[118:119], v[180:181] op_sel_hi:[1,0]
    v_pk_add_f32 v[120:121], v[120:121], v[180:181] op_sel_hi:[1,0]
    v_pk_add_f32 v[122:123], v[122:123], v[180:181] op_sel_hi:[1,0]
    v_pk_add_f32 v[124:125], v[124:125], v[180:181] op_sel_hi:[1,0]
    v_pk_add_f32 v[126:127], v[126:127], v[180:181] op_sel_hi:[1,0]
    v_pk_mul_f32 v[104:105], v[104:105], v[80:81]
    v_pk_mul_f32 v[106:107], v[106:107], v[82:83]
    v_pk_mul_f32 v[108:109], v[108:109], v[84:85]
    v_pk_mul_f32 v[110:111], v[110:111], v[86:87]
    v_pk_mul_f32 v[112:113], v[112:113], v[88:89]
    v_pk_mul_f32 v[114:115], v[114:115], v[90:91]
    v_pk_mul_f32 v[116:117], v[116:117], v[92:93]
    v_pk_mul_f32 v[118:119], v[118:119], v[94:95]
    v_pk_mul_f32 v[120:121], v[120:121], v[96:97]
    v_pk_mul_f32 v[122:123], v[122:123], v[98:99]
    v_pk_mul_f32 v[124:125], v[124:125], v[100:101]
    v_pk_mul_f32 v[126:127], v[126:127], v[102:103]
    v_cvt_pk_bf16_f32 v8, v104, v105
    v_cvt_pk_bf16_f32 v9, v106, v107
    v_cvt_pk_bf16_f32 v10, v108, v109
    v_cvt_pk_bf16_f32 v11, v110, v111
    buffer_store_dwordx4 v[8:11], v6, s[8:11], s40 offen offset:0 sc1
    v_cvt_pk_bf16_f32 v12, v112, v113
    v_cvt_pk_bf16_f32 v13, v114, v115
    v_cvt_pk_bf16_f32 v14, v116, v117
    v_cvt_pk_bf16_f32 v15, v118, v119
    buffer_store_dwordx4 v[12:15], v6, s[8:11], s40 offen offset:1024 sc1
    v_cvt_pk_bf16_f32 v16, v120, v121
    v_cvt_pk_bf16_f32 v17, v122, v123
    v_cvt_pk_bf16_f32 v18, v124, v125
    v_cvt_pk_bf16_f32 v19, v126, v127
    buffer_store_dwordx4 v[16:19], v6, s[8:11], s40 offen offset:2048 sc1
    s_waitcnt vmcnt(0) lgkmcnt(0)
    s_barrier
    s_lshl_b32 s58, s2, 3
    s_add_u32 s58, s58, 14721024
    v_mov_b32 v250, s100
    v_mov_b32 v251, s101
    v_mov_b32 v252, 0
    s_cmp_eq_u32 s34, 0
    s_cselect_b64 exec, 1, 0
    buffer_store_dwordx2 v[250:251], v252, s[8:11], s58 offen sc1
    s_mov_b64 exec, -1
    s_load_dwordx2 s[12:13], s[0:1], 104
    s_load_dwordx2 s[8:9], s[0:1], 0
    s_load_dwordx2 s[16:17], s[0:1], 88
    s_mov_b32 s10, 2621440
    s_mov_b32 s11, 0x20000
    s_mov_b32 s14, 15990784
    s_mov_b32 s15, 0x20000
    s_mov_b32 s18, 2621440
    s_mov_b32 s19, 0x20000
    v_lshrrev_b32 v4, 6, v0
    v_and_b32 v1, 63, v0
    v_readfirstlane_b32 s34, v4
    v_lshlrev_b32 v7, 4, v1
    s_and_b32 s40, s2, 7
    s_lshr_b32 s41, s2, 3
    s_lshr_b32 s32, s40, 1
    s_lshl_b32 s32, s32, 3
    s_and_b32 s42, s41, 7
    s_add_u32 s32, s32, s42
    s_and_b32 s33, s40, 1
    s_lshl_b32 s33, s33, 2
    s_lshr_b32 s42, s41, 3
    s_add_u32 s33, s33, s42
    s_add_u32 s40, s32, s33
    s_mul_i32 s41, s40, 43
    s_lshr_b32 s41, s41, 8
    s_mul_i32 s41, s41, 6
    s_sub_u32 s48, s40, s41
    s_mul_i32 s46, s33, 122880
    s_add_u32 s46, s46, 15007744
    s_mul_i32 s40, s34, 5120
    s_add_u32 s46, s46, s40
    s_mul_i32 s47, s32, 98304
    s_mul_i32 s41, s34, 24576
    s_add_u32 s47, s47, s41
    s_add_u32 s47, s47, 11534336
    s_add_u32 s40, s48, 0
    s_sub_u32 s41, s40, 6
    s_cmp_ge_u32 s40, 6
    s_cselect_b32 s50, s41, s40
    s_add_u32 s40, s48, 1
    s_sub_u32 s41, s40, 6
    s_cmp_ge_u32 s40, 6
    s_cselect_b32 s51, s41, s40
    s_add_u32 s40, s48, 2
    s_sub_u32 s41, s40, 6
    s_cmp_ge_u32 s40, 6
    s_cselect_b32 s52, s41, s40
    s_add_u32 s40, s48, 3
    s_sub_u32 s41, s40, 6
    s_cmp_ge_u32 s40, 6
    s_cselect_b32 s53, s41, s40
    s_add_u32 s40, s48, 4
    s_sub_u32 s41, s40, 6
    s_cmp_ge_u32 s40, 6
    s_cselect_b32 s54, s41, s40
    s_add_u32 s40, s48, 5
    s_sub_u32 s41, s40, 6
    s_cmp_ge_u32 s40, 6
    s_cselect_b32 s55, s41, s40
    s_waitcnt lgkmcnt(0)
    s_mul_i32 s40, s33, 192
    s_add_u32 s40, s40, 14725120
    v_mbcnt_lo_u32_b32 v4, -1, 0
    v_mbcnt_hi_u32_b32 v4, -1, v4
    v_min_u32 v4, 23, v4
    v_lshlrev_b32 v4, 3, v4
    s_mov_b32 s67, 0
fpoll_22:
    buffer_load_dwordx2 v[8:9], v4, s[12:15], s40 offen sc1
    s_add_u32 s67, s67, 1
    s_waitcnt vmcnt(0)
    v_cmp_ne_u32 vcc, s100, v8
    v_cmp_ne_u32 s[64:65], s101, v9
    s_nop 0
    s_or_b64 vcc, vcc, s[64:65]
    s_cmp_gt_u32 s67, 100000
    s_cbranch_scc1 fpoll_e_23
    s_cmp_eq_u64 vcc, 0
    s_cbranch_scc1 fpoll_e_23
    s_sleep 2
    s_branch fpoll_22
fpoll_e_23:
    s_mul_i32 s40, s50, 20480
    s_add_u32 s40, s40, s46
    s_add_u32 s40, s40, 0
    s_mul_i32 s41, s34, 5120
    s_add_u32 m0, s41, 0
    s_nop 0
    buffer_load_dwordx4 v7, s[12:15], s40 offen sc1 lds
    s_mul_i32 s40, s50, 20480
    s_add_u32 s40, s40, s46
    s_add_u32 s40, s40, 1024
    s_mul_i32 s41, s34, 5120
    s_add_u32 m0, s41, 1024
    s_nop 0
    buffer_load_dwordx4 v7, s[12:15], s40 offen sc1 lds
    s_mul_i32 s40, s50, 20480
    s_add_u32 s40, s40, s46
    s_add_u32 s40, s40, 2048
    s_mul_i32 s41, s34, 5120
    s_add_u32 m0, s41, 2048
    s_nop 0
    buffer_load_dwordx4 v7, s[12:15], s40 offen sc1 lds
    s_mul_i32 s40, s50, 20480
    s_add_u32 s40, s40, s46
    s_add_u32 s40, s40, 3072
    s_mul_i32 s41, s34, 5120
    s_add_u32 m0, s41, 3072
    s_nop 0
    buffer_load_dwordx4 v7, s[12:15], s40 offen sc1 lds
    s_mul_i32 s40, s50, 20480
    s_add_u32 s40, s40, s46
    s_add_u32 s40, s40, 4096
    s_mul_i32 s41, s34, 5120
    s_add_u32 m0, s41, 4096
    s_nop 0
    buffer_load_dwordx4 v7, s[12:15], s40 offen sc1 lds
    s_mul_i32 s40, s51, 20480
    s_add_u32 s40, s40, s46
    s_add_u32 s40, s40, 0
    s_mul_i32 s41, s34, 5120
    s_add_u32 m0, s41, 20480
    s_nop 0
    buffer_load_dwordx4 v7, s[12:15], s40 offen sc1 lds
    s_mul_i32 s40, s51, 20480
    s_add_u32 s40, s40, s46
    s_add_u32 s40, s40, 1024
    s_mul_i32 s41, s34, 5120
    s_add_u32 m0, s41, 21504
    s_nop 0
    buffer_load_dwordx4 v7, s[12:15], s40 offen sc1 lds
    s_mul_i32 s40, s51, 20480
    s_add_u32 s40, s40, s46
    s_add_u32 s40, s40, 2048
    s_mul_i32 s41, s34, 5120
    s_add_u32 m0, s41, 22528
    s_nop 0
    buffer_load_dwordx4 v7, s[12:15], s40 offen sc1 lds
    s_mul_i32 s40, s51, 20480
    s_add_u32 s40, s40, s46
    s_add_u32 s40, s40, 3072
    s_mul_i32 s41, s34, 5120
    s_add_u32 m0, s41, 23552
    s_nop 0
    buffer_load_dwordx4 v7, s[12:15], s40 offen sc1 lds
    s_mul_i32 s40, s51, 20480
    s_add_u32 s40, s40, s46
    s_add_u32 s40, s40, 4096
    s_mul_i32 s41, s34, 5120
    s_add_u32 m0, s41, 24576
    s_nop 0
    buffer_load_dwordx4 v7, s[12:15], s40 offen sc1 lds
    s_mul_i32 s40, s52, 20480
    s_add_u32 s40, s40, s46
    s_add_u32 s40, s40, 0
    s_mul_i32 s41, s34, 5120
    s_add_u32 m0, s41, 40960
    s_nop 0
    buffer_load_dwordx4 v7, s[12:15], s40 offen sc1 lds
    s_mul_i32 s40, s52, 20480
    s_add_u32 s40, s40, s46
    s_add_u32 s40, s40, 1024
    s_mul_i32 s41, s34, 5120
    s_add_u32 m0, s41, 41984
    s_nop 0
    buffer_load_dwordx4 v7, s[12:15], s40 offen sc1 lds
    s_mul_i32 s40, s52, 20480
    s_add_u32 s40, s40, s46
    s_add_u32 s40, s40, 2048
    s_mul_i32 s41, s34, 5120
    s_add_u32 m0, s41, 43008
    s_nop 0
    buffer_load_dwordx4 v7, s[12:15], s40 offen sc1 lds
    s_mul_i32 s40, s52, 20480
    s_add_u32 s40, s40, s46
    s_add_u32 s40, s40, 3072
    s_mul_i32 s41, s34, 5120
    s_add_u32 m0, s41, 44032
    s_nop 0
    buffer_load_dwordx4 v7, s[12:15], s40 offen sc1 lds
    s_mul_i32 s40, s52, 20480
    s_add_u32 s40, s40, s46
    s_add_u32 s40, s40, 4096
    s_mul_i32 s41, s34, 5120
    s_add_u32 m0, s41, 45056
    s_nop 0
    buffer_load_dwordx4 v7, s[12:15], s40 offen sc1 lds
    s_mul_i32 s40, s53, 20480
    s_add_u32 s40, s40, s46
    s_add_u32 s40, s40, 0
    s_mul_i32 s41, s34, 5120
    s_add_u32 m0, s41, 61440
    s_nop 0
    buffer_load_dwordx4 v7, s[12:15], s40 offen sc1 lds
    s_mul_i32 s40, s53, 20480
    s_add_u32 s40, s40, s46
    s_add_u32 s40, s40, 1024
    s_mul_i32 s41, s34, 5120
    s_add_u32 m0, s41, 62464
    s_nop 0
    buffer_load_dwordx4 v7, s[12:15], s40 offen sc1 lds
    s_mul_i32 s40, s53, 20480
    s_add_u32 s40, s40, s46
    s_add_u32 s40, s40, 2048
    s_mul_i32 s41, s34, 5120
    s_add_u32 m0, s41, 63488
    s_nop 0
    buffer_load_dwordx4 v7, s[12:15], s40 offen sc1 lds
    s_mul_i32 s40, s53, 20480
    s_add_u32 s40, s40, s46
    s_add_u32 s40, s40, 3072
    s_mul_i32 s41, s34, 5120
    s_add_u32 m0, s41, 64512
    s_nop 0
    buffer_load_dwordx4 v7, s[12:15], s40 offen sc1 lds
    s_mul_i32 s40, s53, 20480
    s_add_u32 s40, s40, s46
    s_add_u32 s40, s40, 4096
    s_mul_i32 s41, s34, 5120
    s_add_u32 m0, s41, 65536
    s_nop 0
    buffer_load_dwordx4 v7, s[12:15], s40 offen sc1 lds
    s_mul_i32 s40, s54, 20480
    s_add_u32 s40, s40, s46
    s_add_u32 s40, s40, 0
    s_mul_i32 s41, s34, 5120
    s_add_u32 m0, s41, 81920
    s_nop 0
    buffer_load_dwordx4 v7, s[12:15], s40 offen sc1 lds
    s_mul_i32 s40, s54, 20480
    s_add_u32 s40, s40, s46
    s_add_u32 s40, s40, 1024
    s_mul_i32 s41, s34, 5120
    s_add_u32 m0, s41, 82944
    s_nop 0
    buffer_load_dwordx4 v7, s[12:15], s40 offen sc1 lds
    s_mul_i32 s40, s54, 20480
    s_add_u32 s40, s40, s46
    s_add_u32 s40, s40, 2048
    s_mul_i32 s41, s34, 5120
    s_add_u32 m0, s41, 83968
    s_nop 0
    buffer_load_dwordx4 v7, s[12:15], s40 offen sc1 lds
    s_mul_i32 s40, s54, 20480
    s_add_u32 s40, s40, s46
    s_add_u32 s40, s40, 3072
    s_mul_i32 s41, s34, 5120
    s_add_u32 m0, s41, 84992
    s_nop 0
    buffer_load_dwordx4 v7, s[12:15], s40 offen sc1 lds
    s_mul_i32 s40, s54, 20480
    s_add_u32 s40, s40, s46
    s_add_u32 s40, s40, 4096
    s_mul_i32 s41, s34, 5120
    s_add_u32 m0, s41, 86016
    s_nop 0
    buffer_load_dwordx4 v7, s[12:15], s40 offen sc1 lds
    s_mul_i32 s40, s55, 20480
    s_add_u32 s40, s40, s46
    s_add_u32 s40, s40, 0
    s_mul_i32 s41, s34, 5120
    s_add_u32 m0, s41, 102400
    s_nop 0
    buffer_load_dwordx4 v7, s[12:15], s40 offen sc1 lds
    s_mul_i32 s40, s55, 20480
    s_add_u32 s40, s40, s46
    s_add_u32 s40, s40, 1024
    s_mul_i32 s41, s34, 5120
    s_add_u32 m0, s41, 103424
    s_nop 0
    buffer_load_dwordx4 v7, s[12:15], s40 offen sc1 lds
    s_mul_i32 s40, s55, 20480
    s_add_u32 s40, s40, s46
    s_add_u32 s40, s40, 2048
    s_mul_i32 s41, s34, 5120
    s_add_u32 m0, s41, 104448
    s_nop 0
    buffer_load_dwordx4 v7, s[12:15], s40 offen sc1 lds
    s_mul_i32 s40, s55, 20480
    s_add_u32 s40, s40, s46
    s_add_u32 s40, s40, 3072
    s_mul_i32 s41, s34, 5120
    s_add_u32 m0, s41, 105472
    s_nop 0
    buffer_load_dwordx4 v7, s[12:15], s40 offen sc1 lds
    s_mul_i32 s40, s55, 20480
    s_add_u32 s40, s40, s46
    s_add_u32 s40, s40, 4096
    s_mul_i32 s41, s34, 5120
    s_add_u32 m0, s41, 106496
    s_nop 0
    buffer_load_dwordx4 v7, s[12:15], s40 offen sc1 lds
    v_mbcnt_lo_u32_b32 v4, -1, 0
    v_mbcnt_hi_u32_b32 v4, -1, v4
    v_lshlrev_b32 v4, 4, v4
    s_mov_b32 s66, 14721024
    s_mov_b32 s67, 0
fpoll_24:
    buffer_load_dwordx4 v[8:11], v4, s[12:15], s66 offen sc1
    buffer_load_dwordx4 v[12:15], v4, s[12:15], s66 offen offset:1024 sc1
    s_add_u32 s67, s67, 1
    s_waitcnt vmcnt(0)
    v_cmp_ne_u32 vcc, s100, v8
    v_cmp_ne_u32 s[64:65], s101, v9
    s_nop 0
    s_or_b64 vcc, vcc, s[64:65]
    v_cmp_ne_u32 s[64:65], s100, v10
    s_nop 0
    s_or_b64 vcc, vcc, s[64:65]
    v_cmp_ne_u32 s[64:65], s101, v11
    s_nop 0
    s_or_b64 vcc, vcc, s[64:65]
    v_cmp_ne_u32 s[64:65], s100, v12
    s_nop 0
    s_or_b64 vcc, vcc, s[64:65]
    v_cmp_ne_u32 s[64:65], s101, v13
    s_nop 0
    s_or_b64 vcc, vcc, s[64:65]
    v_cmp_ne_u32 s[64:65], s100, v14
    s_nop 0
    s_or_b64 vcc, vcc, s[64:65]
    v_cmp_ne_u32 s[64:65], s101, v15
    s_nop 0
    s_or_b64 vcc, vcc, s[64:65]
    s_cmp_gt_u32 s67, 100000
    s_cbranch_scc1 fpoll_e_25
    s_cmp_eq_u64 vcc, 0
    s_cbranch_scc1 fpoll_e_25
    s_sleep 2
    s_branch fpoll_24
fpoll_e_25:
    s_lshl_b32 s42, s50, 12
    s_add_u32 s42, s42, s47
    buffer_load_dwordx4 v[8:11], v7, s[12:15], s42 offen offset:0 sc1
    s_lshl_b32 s42, s50, 12
    s_add_u32 s42, s42, s47
    buffer_load_dwordx4 v[12:15], v7, s[12:15], s42 offen offset:1024 sc1
    s_lshl_b32 s42, s50, 12
    s_add_u32 s42, s42, s47
    buffer_load_dwordx4 v[16:19], v7, s[12:15], s42 offen offset:2048 sc1
    s_lshl_b32 s42, s50, 12
    s_add_u32 s42, s42, s47
    buffer_load_dwordx4 v[20:23], v7, s[12:15], s42 offen offset:3072 sc1
    s_lshl_b32 s42, s51, 12
    s_add_u32 s42, s42, s47
    buffer_load_dwordx4 v[24:27], v7, s[12:15], s42 offen offset:0 sc1
    s_lshl_b32 s42, s51, 12
    s_add_u32 s42, s42, s47
    buffer_load_dwordx4 v[28:31], v7, s[12:15], s42 offen offset:1024 sc1
    s_lshl_b32 s42, s51, 12
    s_add_u32 s42, s42, s47
    buffer_load_dwordx4 v[32:35], v7, s[12:15], s42 offen offset:2048 sc1
    s_lshl_b32 s42, s51, 12
    s_add_u32 s42, s42, s47
    buffer_load_dwordx4 v[36:39], v7, s[12:15], s42 offen offset:3072 sc1
    s_mul_i32 s44, s33, 160
    s_mul_i32 s45, s32, 81920
    s_add_u32 s45, s45, s44
    v_add_u32 v4, 0, v1
    v_mul_u32_u24 v5, 6554, v4
    v_lshrrev_b32 v5, 16, v5
    v_mul_u32_u24 v6, 10, v5
    v_sub_u32 v4, v4, v6
    v_lshlrev_b32 v4, 4, v4
    v_mul_u32_u24 v5, 1280, v5
    v_add_u32 v104, v4, v5
    v_add_u32 v4, 64, v1
    v_mul_u32_u24 v5, 6554, v4
    v_lshrrev_b32 v5, 16, v5
    v_mul_u32_u24 v6, 10, v5
    v_sub_u32 v4, v4, v6
    v_lshlrev_b32 v4, 4, v4
    v_mul_u32_u24 v5, 1280, v5
    v_add_u32 v105, v4, v5
    v_add_u32 v4, 128, v1
    v_mul_u32_u24 v5, 6554, v4
    v_lshrrev_b32 v5, 16, v5
    v_mul_u32_u24 v6, 10, v5
    v_sub_u32 v4, v4, v6
    v_lshlrev_b32 v4, 4, v4
    v_mul_u32_u24 v5, 1280, v5
    v_add_u32 v106, v4, v5
    v_add_u32 v4, 192, v1
    v_mul_u32_u24 v5, 6554, v4
    v_lshrrev_b32 v5, 16, v5
    v_mul_u32_u24 v6, 10, v5
    v_sub_u32 v4, v4, v6
    v_lshlrev_b32 v4, 4, v4
    v_mul_u32_u24 v5, 1280, v5
    v_add_u32 v107, v4, v5
    v_add_u32 v4, 256, v1
    v_mul_u32_u24 v5, 6554, v4
    v_lshrrev_b32 v5, 16, v5
    v_mul_u32_u24 v6, 10, v5
    v_sub_u32 v4, v4, v6
    v_lshlrev_b32 v4, 4, v4
    v_mul_u32_u24 v5, 1280, v5
    v_add_u32 v108, v4, v5
    v_lshrrev_b32 v2, 4, v1
    v_and_b32 v3, 15, v1
    v_mov_b32 v113, v7
    v_add_u32 v114, 61440, v7
    s_waitcnt vmcnt(33)
    s_barrier
    ds_read_b128 v[136:139], v113 offset:0
    ds_read_b128 v[140:143], v113 offset:1024
    ds_read_b128 v[144:147], v113 offset:2048
    ds_read_b128 v[148:151], v113 offset:3072
    ds_read_b128 v[152:155], v113 offset:4096
    ds_read_b128 v[156:159], v113 offset:5120
    ds_read_b128 v[160:163], v113 offset:6144
    ds_read_b128 v[164:167], v113 offset:7168
    ds_read_b128 v[168:171], v113 offset:8192
    ds_read_b128 v[172:175], v113 offset:9216
    s_waitcnt vmcnt(7)
    s_waitcnt lgkmcnt(9)
    v_mfma_f32_16x16x32_bf16 v[116:119], v[136:139], v[8:11], 0
    s_lshl_b32 s42, s52, 12
    s_add_u32 s42, s42, s47
    buffer_load_dwordx4 v[40:43], v7, s[12:15], s42 offen offset:0 sc1
    s_waitcnt lgkmcnt(8)
    v_mfma_f32_16x16x32_bf16 v[120:123], v[140:143], v[8:11], 0
    s_waitcnt lgkmcnt(7)
    v_mfma_f32_16x16x32_bf16 v[124:127], v[144:147], v[8:11], 0
    s_lshl_b32 s42, s52, 12
    s_add_u32 s42, s42, s47
    buffer_load_dwordx4 v[44:47], v7, s[12:15], s42 offen offset:1024 sc1
    s_waitcnt lgkmcnt(6)
    v_mfma_f32_16x16x32_bf16 v[128:131], v[148:151], v[8:11], 0
    s_waitcnt lgkmcnt(5)
    v_mfma_f32_16x16x32_bf16 v[132:135], v[152:155], v[8:11], 0
    s_lshl_b32 s42, s52, 12
    s_add_u32 s42, s42, s47
    buffer_load_dwordx4 v[48:51], v7, s[12:15], s42 offen offset:2048 sc1
    ds_read_b128 v[136:139], v113 offset:10240
    ds_read_b128 v[140:143], v113 offset:11264
    ds_read_b128 v[144:147], v113 offset:12288
    ds_read_b128 v[148:151], v113 offset:13312
    ds_read_b128 v[152:155], v113 offset:14336
    s_waitcnt vmcnt(9)
    s_waitcnt lgkmcnt(9)
    v_mfma_f32_16x16x32_bf16 v[116:119], v[156:159], v[12:15], v[116:119]
    s_lshl_b32 s42, s52, 12
    s_add_u32 s42, s42, s47
    buffer_load_dwordx4 v[52:55], v7, s[12:15], s42 offen offset:3072 sc1
    s_waitcnt lgkmcnt(8)
    v_mfma_f32_16x16x32_bf16 v[120:123], v[160:163], v[12:15], v[120:123]
    s_waitcnt lgkmcnt(7)
    v_mfma_f32_16x16x32_bf16 v[124:127], v[164:167], v[12:15], v[124:127]
    s_waitcnt lgkmcnt(6)
    v_mfma_f32_16x16x32_bf16 v[128:131], v[168:171], v[12:15], v[128:131]
    s_waitcnt lgkmcnt(5)
    v_mfma_f32_16x16x32_bf16 v[132:135], v[172:175], v[12:15], v[132:135]
    ds_read_b128 v[156:159], v113 offset:15360
    ds_read_b128 v[160:163], v113 offset:16384
    ds_read_b128 v[164:167], v113 offset:17408
    ds_read_b128 v[168:171], v113 offset:18432
    ds_read_b128 v[172:175], v113 offset:19456
    s_waitcnt vmcnt(9)
    s_waitcnt lgkmcnt(9)
    v_mfma_f32_16x16x32_bf16 v[116:119], v[136:139], v[16:19], v[116:119]
    s_waitcnt lgkmcnt(8)
    v_mfma_f32_16x16x32_bf16 v[120:123], v[140:143], v[16:19], v[120:123]
    s_waitcnt lgkmcnt(7)
    v_mfma_f32_16x16x32_bf16 v[124:127], v[144:147], v[16:19], v[124:127]
    s_waitcnt lgkmcnt(6)
    v_mfma_f32_16x16x32_bf16 v[128:131], v[148:151], v[16:19], v[128:131]
    s_waitcnt lgkmcnt(5)
    v_mfma_f32_16x16x32_bf16 v[132:135], v[152:155], v[16:19], v[132:135]
    s_waitcnt vmcnt(8)
    s_waitcnt lgkmcnt(4)
    v_mfma_f32_16x16x32_bf16 v[116:119], v[156:159], v[20:23], v[116:119]
    s_waitcnt lgkmcnt(3)
    v_mfma_f32_16x16x32_bf16 v[120:123], v[160:163], v[20:23], v[120:123]
    s_waitcnt lgkmcnt(2)
    v_mfma_f32_16x16x32_bf16 v[124:127], v[164:167], v[20:23], v[124:127]
    s_waitcnt lgkmcnt(1)
    v_mfma_f32_16x16x32_bf16 v[128:131], v[168:171], v[20:23], v[128:131]
    s_waitcnt lgkmcnt(0)
    v_mfma_f32_16x16x32_bf16 v[132:135], v[172:175], v[20:23], v[132:135]
    s_waitcnt vmcnt(32)
    s_barrier
    ds_read_b128 v[136:139], v113 offset:20480
    ds_read_b128 v[140:143], v113 offset:21504
    ds_read_b128 v[144:147], v113 offset:22528
    ds_read_b128 v[148:151], v113 offset:23552
    ds_read_b128 v[152:155], v113 offset:24576
    ds_read_b128 v[156:159], v113 offset:25600
    ds_read_b128 v[160:163], v113 offset:26624
    ds_read_b128 v[164:167], v113 offset:27648
    ds_read_b128 v[168:171], v113 offset:28672
    ds_read_b128 v[172:175], v113 offset:29696
    s_waitcnt vmcnt(7)
    s_waitcnt lgkmcnt(9)
    v_mfma_f32_16x16x32_bf16 v[116:119], v[136:139], v[24:27], v[116:119]
    s_lshl_b32 s42, s53, 12
    s_add_u32 s42, s42, s47
    buffer_load_dwordx4 v[56:59], v7, s[12:15], s42 offen offset:0 sc1
    s_waitcnt lgkmcnt(8)
    v_mfma_f32_16x16x32_bf16 v[120:123], v[140:143], v[24:27], v[120:123]
    s_waitcnt lgkmcnt(7)
    v_mfma_f32_16x16x32_bf16 v[124:127], v[144:147], v[24:27], v[124:127]
    s_lshl_b32 s42, s53, 12
    s_add_u32 s42, s42, s47
    buffer_load_dwordx4 v[60:63], v7, s[12:15], s42 offen offset:1024 sc1
    s_waitcnt lgkmcnt(6)
    v_mfma_f32_16x16x32_bf16 v[128:131], v[148:151], v[24:27], v[128:131]
    s_waitcnt lgkmcnt(5)
    v_mfma_f32_16x16x32_bf16 v[132:135], v[152:155], v[24:27], v[132:135]
    s_lshl_b32 s42, s53, 12
    s_add_u32 s42, s42, s47
    buffer_load_dwordx4 v[64:67], v7, s[12:15], s42 offen offset:2048 sc1
    ds_read_b128 v[136:139], v113 offset:30720
    ds_read_b128 v[140:143], v113 offset:31744
    ds_read_b128 v[144:147], v113 offset:32768
    ds_read_b128 v[148:151], v113 offset:33792
    ds_read_b128 v[152:155], v113 offset:34816
    s_waitcnt vmcnt(9)
    s_waitcnt lgkmcnt(9)
    v_mfma_f32_16x16x32_bf16 v[116:119], v[156:159], v[28:31], v[116:119]
    s_lshl_b32 s42, s53, 12
    s_add_u32 s42, s42, s47
    buffer_load_dwordx4 v[68:71], v7, s[12:15], s42 offen offset:3072 sc1
    s_waitcnt lgkmcnt(8)
    v_mfma_f32_16x16x32_bf16 v[120:123], v[160:163], v[28:31], v[120:123]
    s_waitcnt lgkmcnt(7)
    v_mfma_f32_16x16x32_bf16 v[124:127], v[164:167], v[28:31], v[124:127]
    s_waitcnt lgkmcnt(6)
    v_mfma_f32_16x16x32_bf16 v[128:131], v[168:171], v[28:31], v[128:131]
    s_waitcnt lgkmcnt(5)
    v_mfma_f32_16x16x32_bf16 v[132:135], v[172:175], v[28:31], v[132:135]
    ds_read_b128 v[156:159], v113 offset:35840
    ds_read_b128 v[160:163], v113 offset:36864
    ds_read_b128 v[164:167], v113 offset:37888
    ds_read_b128 v[168:171], v113 offset:38912
    ds_read_b128 v[172:175], v113 offset:39936
    s_waitcnt vmcnt(9)
    s_waitcnt lgkmcnt(9)
    v_mfma_f32_16x16x32_bf16 v[116:119], v[136:139], v[32:35], v[116:119]
    s_waitcnt lgkmcnt(8)
    v_mfma_f32_16x16x32_bf16 v[120:123], v[140:143], v[32:35], v[120:123]
    s_waitcnt lgkmcnt(7)
    v_mfma_f32_16x16x32_bf16 v[124:127], v[144:147], v[32:35], v[124:127]
    s_waitcnt lgkmcnt(6)
    v_mfma_f32_16x16x32_bf16 v[128:131], v[148:151], v[32:35], v[128:131]
    s_waitcnt lgkmcnt(5)
    v_mfma_f32_16x16x32_bf16 v[132:135], v[152:155], v[32:35], v[132:135]
    s_waitcnt vmcnt(8)
    s_waitcnt lgkmcnt(4)
    v_mfma_f32_16x16x32_bf16 v[116:119], v[156:159], v[36:39], v[116:119]
    s_waitcnt lgkmcnt(3)
    v_mfma_f32_16x16x32_bf16 v[120:123], v[160:163], v[36:39], v[120:123]
    s_waitcnt lgkmcnt(2)
    v_mfma_f32_16x16x32_bf16 v[124:127], v[164:167], v[36:39], v[124:127]
    s_waitcnt lgkmcnt(1)
    v_mfma_f32_16x16x32_bf16 v[128:131], v[168:171], v[36:39], v[128:131]
    s_waitcnt lgkmcnt(0)
    v_mfma_f32_16x16x32_bf16 v[132:135], v[172:175], v[36:39], v[132:135]
    s_waitcnt vmcnt(31)
    s_barrier
    ds_read_b128 v[136:139], v113 offset:40960
    ds_read_b128 v[140:143], v113 offset:41984
    ds_read_b128 v[144:147], v113 offset:43008
    ds_read_b128 v[148:151], v113 offset:44032
    ds_read_b128 v[152:155], v113 offset:45056
    ds_read_b128 v[156:159], v113 offset:46080
    ds_read_b128 v[160:163], v113 offset:47104
    ds_read_b128 v[164:167], v113 offset:48128
    ds_read_b128 v[168:171], v113 offset:49152
    ds_read_b128 v[172:175], v113 offset:50176
    s_waitcnt vmcnt(7)
    s_waitcnt lgkmcnt(9)
    v_mfma_f32_16x16x32_bf16 v[116:119], v[136:139], v[40:43], v[116:119]
    s_lshl_b32 s42, s54, 12
    s_add_u32 s42, s42, s47
    buffer_load_dwordx4 v[72:75], v7, s[12:15], s42 offen offset:0 sc1
    s_waitcnt lgkmcnt(8)
    v_mfma_f32_16x16x32_bf16 v[120:123], v[140:143], v[40:43], v[120:123]
    s_waitcnt lgkmcnt(7)
    v_mfma_f32_16x16x32_bf16 v[124:127], v[144:147], v[40:43], v[124:127]
    s_lshl_b32 s42, s54, 12
    s_add_u32 s42, s42, s47
    buffer_load_dwordx4 v[76:79], v7, s[12:15], s42 offen offset:1024 sc1
    s_waitcnt lgkmcnt(6)
    v_mfma_f32_16x16x32_bf16 v[128:131], v[148:151], v[40:43], v[128:131]
    s_waitcnt lgkmcnt(5)
    v_mfma_f32_16x16x32_bf16 v[132:135], v[152:155], v[40:43], v[132:135]
    s_lshl_b32 s42, s54, 12
    s_add_u32 s42, s42, s47
    buffer_load_dwordx4 v[80:83], v7, s[12:15], s42 offen offset:2048 sc1
    ds_read_b128 v[136:139], v113 offset:51200
    ds_read_b128 v[140:143], v113 offset:52224
    ds_read_b128 v[144:147], v113 offset:53248
    ds_read_b128 v[148:151], v113 offset:54272
    ds_read_b128 v[152:155], v113 offset:55296
    s_waitcnt vmcnt(9)
    s_waitcnt lgkmcnt(9)
    v_mfma_f32_16x16x32_bf16 v[116:119], v[156:159], v[44:47], v[116:119]
    s_lshl_b32 s42, s54, 12
    s_add_u32 s42, s42, s47
    buffer_load_dwordx4 v[84:87], v7, s[12:15], s42 offen offset:3072 sc1
    s_waitcnt lgkmcnt(8)
    v_mfma_f32_16x16x32_bf16 v[120:123], v[160:163], v[44:47], v[120:123]
    s_waitcnt lgkmcnt(7)
    v_mfma_f32_16x16x32_bf16 v[124:127], v[164:167], v[44:47], v[124:127]
    s_waitcnt lgkmcnt(6)
    v_mfma_f32_16x16x32_bf16 v[128:131], v[168:171], v[44:47], v[128:131]
    s_waitcnt lgkmcnt(5)
    v_mfma_f32_16x16x32_bf16 v[132:135], v[172:175], v[44:47], v[132:135]
    ds_read_b128 v[156:159], v113 offset:56320
    ds_read_b128 v[160:163], v113 offset:57344
    ds_read_b128 v[164:167], v113 offset:58368
    ds_read_b128 v[168:171], v113 offset:59392
    ds_read_b128 v[172:175], v113 offset:60416
    s_waitcnt vmcnt(9)
    s_waitcnt lgkmcnt(9)
    v_mfma_f32_16x16x32_bf16 v[116:119], v[136:139], v[48:51], v[116:119]
    s_waitcnt lgkmcnt(8)
    v_mfma_f32_16x16x32_bf16 v[120:123], v[140:143], v[48:51], v[120:123]
    s_waitcnt lgkmcnt(7)
    v_mfma_f32_16x16x32_bf16 v[124:127], v[144:147], v[48:51], v[124:127]
    s_waitcnt lgkmcnt(6)
    v_mfma_f32_16x16x32_bf16 v[128:131], v[148:151], v[48:51], v[128:131]
    s_waitcnt lgkmcnt(5)
    v_mfma_f32_16x16x32_bf16 v[132:135], v[152:155], v[48:51], v[132:135]
    s_waitcnt vmcnt(8)
    s_waitcnt lgkmcnt(4)
    v_mfma_f32_16x16x32_bf16 v[116:119], v[156:159], v[52:55], v[116:119]
    s_waitcnt lgkmcnt(3)
    v_mfma_f32_16x16x32_bf16 v[120:123], v[160:163], v[52:55], v[120:123]
    s_waitcnt lgkmcnt(2)
    v_mfma_f32_16x16x32_bf16 v[124:127], v[164:167], v[52:55], v[124:127]
    s_waitcnt lgkmcnt(1)
    v_mfma_f32_16x16x32_bf16 v[128:131], v[168:171], v[52:55], v[128:131]
    s_waitcnt lgkmcnt(0)
    v_mfma_f32_16x16x32_bf16 v[132:135], v[172:175], v[52:55], v[132:135]
    s_waitcnt vmcnt(30)
    s_barrier
    ds_read_b128 v[136:139], v114 offset:0
    ds_read_b128 v[140:143], v114 offset:1024
    ds_read_b128 v[144:147], v114 offset:2048
    ds_read_b128 v[148:151], v114 offset:3072
    ds_read_b128 v[152:155], v114 offset:4096
    ds_read_b128 v[156:159], v114 offset:5120
    ds_read_b128 v[160:163], v114 offset:6144
    ds_read_b128 v[164:167], v114 offset:7168
    ds_read_b128 v[168:171], v114 offset:8192
    ds_read_b128 v[172:175], v114 offset:9216
    s_waitcnt vmcnt(7)
    s_waitcnt lgkmcnt(9)
    v_mfma_f32_16x16x32_bf16 v[116:119], v[136:139], v[56:59], v[116:119]
    s_lshl_b32 s42, s55, 12
    s_add_u32 s42, s42, s47
    buffer_load_dwordx4 v[88:91], v7, s[12:15], s42 offen offset:0 sc1
    s_waitcnt lgkmcnt(8)
    v_mfma_f32_16x16x32_bf16 v[120:123], v[140:143], v[56:59], v[120:123]
    s_waitcnt lgkmcnt(7)
    v_mfma_f32_16x16x32_bf16 v[124:127], v[144:147], v[56:59], v[124:127]
    s_lshl_b32 s42, s55, 12
    s_add_u32 s42, s42, s47
    buffer_load_dwordx4 v[92:95], v7, s[12:15], s42 offen offset:1024 sc1
    s_waitcnt lgkmcnt(6)
    v_mfma_f32_16x16x32_bf16 v[128:131], v[148:151], v[56:59], v[128:131]
    s_waitcnt lgkmcnt(5)
    v_mfma_f32_16x16x32_bf16 v[132:135], v[152:155], v[56:59], v[132:135]
    s_lshl_b32 s42, s55, 12
    s_add_u32 s42, s42, s47
    buffer_load_dwordx4 v[96:99], v7, s[12:15], s42 offen offset:2048 sc1
    ds_read_b128 v[136:139], v114 offset:10240
    ds_read_b128 v[140:143], v114 offset:11264
    ds_read_b128 v[144:147], v114 offset:12288
    ds_read_b128 v[148:151], v114 offset:13312
    ds_read_b128 v[152:155], v114 offset:14336
    s_waitcnt vmcnt(9)
    s_waitcnt lgkmcnt(9)
    v_mfma_f32_16x16x32_bf16 v[116:119], v[156:159], v[60:63], v[116:119]
    s_lshl_b32 s42, s55, 12
    s_add_u32 s42, s42, s47
    buffer_load_dwordx4 v[100:103], v7, s[12:15], s42 offen offset:3072 sc1
    s_waitcnt lgkmcnt(8)
    v_mfma_f32_16x16x32_bf16 v[120:123], v[160:163], v[60:63], v[120:123]
    s_waitcnt lgkmcnt(7)
    v_mfma_f32_16x16x32_bf16 v[124:127], v[164:167], v[60:63], v[124:127]
    s_cmp_ge_u32 s34, 2
    s_cbranch_scc1 k3_y_26
    s_mul_i32 s40, s34, 40960
    s_add_u32 s40, s40, s45
    s_mul_i32 s41, s34, 5120
    s_add_u32 m0, s41, 122880
    s_nop 0
    buffer_load_dwordx4 v104, s[8:11], s40 offen lds
    s_add_u32 m0, s41, 123904
    s_nop 0
    buffer_load_dwordx4 v105, s[8:11], s40 offen lds
    s_add_u32 m0, s41, 124928
    s_nop 0
    buffer_load_dwordx4 v106, s[8:11], s40 offen lds
    s_add_u32 m0, s41, 125952
    s_nop 0
    buffer_load_dwordx4 v107, s[8:11], s40 offen lds
    s_add_u32 m0, s41, 126976
    s_nop 0
    buffer_load_dwordx4 v108, s[8:11], s40 offen lds
    s_branch k3_xy_27
k3_y_26:
    v_lshrrev_b32 v4, 3, v1
    v_lshlrev_b32 v4, 12, v4
    v_and_b32 v5, 7, v1
    v_lshl_add_u32 v112, v5, 4, v4
    s_sub_u32 s42, s34, 2
    s_mul_i32 s40, s42, 40
    s_mul_i32 s41, s33, 80
    s_add_u32 s40, s40, s41
    s_lshl_b32 s40, s40, 12
    s_lshl_b32 s41, s32, 7
    s_add_u32 s40, s40, s41
    s_add_u32 s40, s40, 8912896
    s_mul_i32 s41, s42, 5120
    s_add_u32 m0, s41, 133120
    s_nop 0
    buffer_load_dwordx4 v112, s[12:15], s40 offen sc1 lds
    s_add_u32 s40, s40, 32768
    s_add_u32 m0, s41, 134144
    s_nop 0
    buffer_load_dwordx4 v112, s[12:15], s40 offen sc1 lds
    s_add_u32 s40, s40, 32768
    s_add_u32 m0, s41, 135168
    s_nop 0
    buffer_load_dwordx4 v112, s[12:15], s40 offen sc1 lds
    s_add_u32 s40, s40, 32768
    s_add_u32 m0, s41, 136192
    s_nop 0
    buffer_load_dwordx4 v112, s[12:15], s40 offen sc1 lds
    s_add_u32 s40, s40, 32768
    s_add_u32 m0, s41, 137216
    s_nop 0
    buffer_load_dwordx4 v112, s[12:15], s40 offen sc1 lds
    s_add_u32 s40, s40, 32768
k3_xy_27:
    s_lshl_b32 s40, s32, 9
    s_lshl_b32 s41, s34, 7
    s_add_u32 s40, s40, s41
    s_add_u32 s40, s40, 14680064
    v_lshlrev_b32 v4, 3, v3
    buffer_load_dwordx2 v[110:111], v4, s[12:15], s40 offen sc1
    s_waitcnt lgkmcnt(6)
    v_mfma_f32_16x16x32_bf16 v[128:131], v[168:171], v[60:63], v[128:131]
    s_waitcnt lgkmcnt(5)
    v_mfma_f32_16x16x32_bf16 v[132:135], v[172:175], v[60:63], v[132:135]
    ds_read_b128 v[156:159], v114 offset:15360
    ds_read_b128 v[160:163], v114 offset:16384
    ds_read_b128 v[164:167], v114 offset:17408
    ds_read_b128 v[168:171], v114 offset:18432
    ds_read_b128 v[172:175], v114 offset:19456
    s_waitcnt vmcnt(15)
    s_waitcnt lgkmcnt(9)
    v_mfma_f32_16x16x32_bf16 v[116:119], v[136:139], v[64:67], v[116:119]
    s_waitcnt lgkmcnt(8)
    v_mfma_f32_16x16x32_bf16 v[120:123], v[140:143], v[64:67], v[120:123]
    s_waitcnt lgkmcnt(7)
    v_mfma_f32_16x16x32_bf16 v[124:127], v[144:147], v[64:67], v[124:127]
    s_waitcnt lgkmcnt(6)
    v_mfma_f32_16x16x32_bf16 v[128:131], v[148:151], v[64:67], v[128:131]
    s_waitcnt lgkmcnt(5)
    v_mfma_f32_16x16x32_bf16 v[132:135], v[152:155], v[64:67], v[132:135]
    s_waitcnt vmcnt(14)
    s_waitcnt lgkmcnt(4)
    v_mfma_f32_16x16x32_bf16 v[116:119], v[156:159], v[68:71], v[116:119]
    s_waitcnt lgkmcnt(3)
    v_mfma_f32_16x16x32_bf16 v[120:123], v[160:163], v[68:71], v[120:123]
    s_waitcnt lgkmcnt(2)
    v_mfma_f32_16x16x32_bf16 v[124:127], v[164:167], v[68:71], v[124:127]
    s_waitcnt lgkmcnt(1)
    v_mfma_f32_16x16x32_bf16 v[128:131], v[168:171], v[68:71], v[128:131]
    s_waitcnt lgkmcnt(0)
    v_mfma_f32_16x16x32_bf16 v[132:135], v[172:175], v[68:71], v[132:135]
    s_waitcnt vmcnt(35)
    s_barrier
    ds_read_b128 v[136:139], v114 offset:20480
    ds_read_b128 v[140:143], v114 offset:21504
    ds_read_b128 v[144:147], v114 offset:22528
    ds_read_b128 v[148:151], v114 offset:23552
    ds_read_b128 v[152:155], v114 offset:24576
    ds_read_b128 v[156:159], v114 offset:25600
    ds_read_b128 v[160:163], v114 offset:26624
    ds_read_b128 v[164:167], v114 offset:27648
    ds_read_b128 v[168:171], v114 offset:28672
    ds_read_b128 v[172:175], v114 offset:29696
    s_waitcnt vmcnt(13)
    s_waitcnt lgkmcnt(9)
    v_mfma_f32_16x16x32_bf16 v[116:119], v[136:139], v[72:75], v[116:119]
    s_waitcnt lgkmcnt(8)
    v_mfma_f32_16x16x32_bf16 v[120:123], v[140:143], v[72:75], v[120:123]
    s_waitcnt lgkmcnt(7)
    v_mfma_f32_16x16x32_bf16 v[124:127], v[144:147], v[72:75], v[124:127]
    s_waitcnt lgkmcnt(6)
    v_mfma_f32_16x16x32_bf16 v[128:131], v[148:151], v[72:75], v[128:131]
    s_waitcnt lgkmcnt(5)
    v_mfma_f32_16x16x32_bf16 v[132:135], v[152:155], v[72:75], v[132:135]
    ds_read_b128 v[136:139], v114 offset:30720
    ds_read_b128 v[140:143], v114 offset:31744
    ds_read_b128 v[144:147], v114 offset:32768
    ds_read_b128 v[148:151], v114 offset:33792
    ds_read_b128 v[152:155], v114 offset:34816
    s_waitcnt vmcnt(12)
    s_waitcnt lgkmcnt(9)
    v_mfma_f32_16x16x32_bf16 v[116:119], v[156:159], v[76:79], v[116:119]
    s_waitcnt lgkmcnt(8)
    v_mfma_f32_16x16x32_bf16 v[120:123], v[160:163], v[76:79], v[120:123]
    s_waitcnt lgkmcnt(7)
    v_mfma_f32_16x16x32_bf16 v[124:127], v[164:167], v[76:79], v[124:127]
    s_waitcnt lgkmcnt(6)
    v_mfma_f32_16x16x32_bf16 v[128:131], v[168:171], v[76:79], v[128:131]
    s_waitcnt lgkmcnt(5)
    v_mfma_f32_16x16x32_bf16 v[132:135], v[172:175], v[76:79], v[132:135]
    ds_read_b128 v[156:159], v114 offset:35840
    ds_read_b128 v[160:163], v114 offset:36864
    ds_read_b128 v[164:167], v114 offset:37888
    ds_read_b128 v[168:171], v114 offset:38912
    ds_read_b128 v[172:175], v114 offset:39936
    s_waitcnt vmcnt(11)
    s_waitcnt lgkmcnt(9)
    v_mfma_f32_16x16x32_bf16 v[116:119], v[136:139], v[80:83], v[116:119]
    s_waitcnt lgkmcnt(8)
    v_mfma_f32_16x16x32_bf16 v[120:123], v[140:143], v[80:83], v[120:123]
    s_waitcnt lgkmcnt(7)
    v_mfma_f32_16x16x32_bf16 v[124:127], v[144:147], v[80:83], v[124:127]
    s_waitcnt lgkmcnt(6)
    v_mfma_f32_16x16x32_bf16 v[128:131], v[148:151], v[80:83], v[128:131]
    s_waitcnt lgkmcnt(5)
    v_mfma_f32_16x16x32_bf16 v[132:135], v[152:155], v[80:83], v[132:135]
    s_waitcnt vmcnt(10)
    s_waitcnt lgkmcnt(4)
    v_mfma_f32_16x16x32_bf16 v[116:119], v[156:159], v[84:87], v[116:119]
    s_waitcnt lgkmcnt(3)
    v_mfma_f32_16x16x32_bf16 v[120:123], v[160:163], v[84:87], v[120:123]
    s_waitcnt lgkmcnt(2)
    v_mfma_f32_16x16x32_bf16 v[124:127], v[164:167], v[84:87], v[124:127]
    s_waitcnt lgkmcnt(1)
    v_mfma_f32_16x16x32_bf16 v[128:131], v[168:171], v[84:87], v[128:131]
    s_waitcnt lgkmcnt(0)
    v_mfma_f32_16x16x32_bf16 v[132:135], v[172:175], v[84:87], v[132:135]
    s_waitcnt vmcnt(30)
    s_barrier
    ds_read_b128 v[136:139], v114 offset:40960
    ds_read_b128 v[140:143], v114 offset:41984
    ds_read_b128 v[144:147], v114 offset:43008
    ds_read_b128 v[148:151], v114 offset:44032
    ds_read_b128 v[152:155], v114 offset:45056
    ds_read_b128 v[156:159], v114 offset:46080
    ds_read_b128 v[160:163], v114 offset:47104
    ds_read_b128 v[164:167], v114 offset:48128
    ds_read_b128 v[168:171], v114 offset:49152
    ds_read_b128 v[172:175], v114 offset:50176
    s_waitcnt vmcnt(9)
    s_waitcnt lgkmcnt(9)
    v_mfma_f32_16x16x32_bf16 v[116:119], v[136:139], v[88:91], v[116:119]
    s_waitcnt lgkmcnt(8)
    v_mfma_f32_16x16x32_bf16 v[120:123], v[140:143], v[88:91], v[120:123]
    s_waitcnt lgkmcnt(7)
    v_mfma_f32_16x16x32_bf16 v[124:127], v[144:147], v[88:91], v[124:127]
    s_waitcnt lgkmcnt(6)
    v_mfma_f32_16x16x32_bf16 v[128:131], v[148:151], v[88:91], v[128:131]
    s_waitcnt lgkmcnt(5)
    v_mfma_f32_16x16x32_bf16 v[132:135], v[152:155], v[88:91], v[132:135]
    ds_read_b128 v[136:139], v114 offset:51200
    ds_read_b128 v[140:143], v114 offset:52224
    ds_read_b128 v[144:147], v114 offset:53248
    ds_read_b128 v[148:151], v114 offset:54272
    ds_read_b128 v[152:155], v114 offset:55296
    s_waitcnt vmcnt(8)
    s_waitcnt lgkmcnt(9)
    v_mfma_f32_16x16x32_bf16 v[116:119], v[156:159], v[92:95], v[116:119]
    s_waitcnt lgkmcnt(8)
    v_mfma_f32_16x16x32_bf16 v[120:123], v[160:163], v[92:95], v[120:123]
    s_waitcnt lgkmcnt(7)
    v_mfma_f32_16x16x32_bf16 v[124:127], v[164:167], v[92:95], v[124:127]
    s_waitcnt lgkmcnt(6)
    v_mfma_f32_16x16x32_bf16 v[128:131], v[168:171], v[92:95], v[128:131]
    s_waitcnt lgkmcnt(5)
    v_mfma_f32_16x16x32_bf16 v[132:135], v[172:175], v[92:95], v[132:135]
    ds_read_b128 v[156:159], v114 offset:56320
    ds_read_b128 v[160:163], v114 offset:57344
    ds_read_b128 v[164:167], v114 offset:58368
    ds_read_b128 v[168:171], v114 offset:59392
    ds_read_b128 v[172:175], v114 offset:60416
    s_waitcnt vmcnt(7)
    s_waitcnt lgkmcnt(9)
    v_mfma_f32_16x16x32_bf16 v[116:119], v[136:139], v[96:99], v[116:119]
    s_waitcnt lgkmcnt(8)
    v_mfma_f32_16x16x32_bf16 v[120:123], v[140:143], v[96:99], v[120:123]
    s_waitcnt lgkmcnt(7)
    v_mfma_f32_16x16x32_bf16 v[124:127], v[144:147], v[96:99], v[124:127]
    s_waitcnt lgkmcnt(6)
    v_mfma_f32_16x16x32_bf16 v[128:131], v[148:151], v[96:99], v[128:131]
    s_waitcnt lgkmcnt(5)
    v_mfma_f32_16x16x32_bf16 v[132:135], v[152:155], v[96:99], v[132:135]
    s_waitcnt vmcnt(6)
    s_waitcnt lgkmcnt(4)
    v_mfma_f32_16x16x32_bf16 v[116:119], v[156:159], v[100:103], v[116:119]
    s_waitcnt lgkmcnt(3)
    v_mfma_f32_16x16x32_bf16 v[120:123], v[160:163], v[100:103], v[120:123]
    s_waitcnt lgkmcnt(2)
    v_mfma_f32_16x16x32_bf16 v[124:127], v[164:167], v[100:103], v[124:127]
    s_waitcnt lgkmcnt(1)
    v_mfma_f32_16x16x32_bf16 v[128:131], v[168:171], v[100:103], v[128:131]
    s_waitcnt lgkmcnt(0)
    v_mfma_f32_16x16x32_bf16 v[132:135], v[172:175], v[100:103], v[132:135]
    s_lshl_b32 s40, s34, 4
    v_add_u32 v4, s40, v3
    v_mul_u32_u24 v4, 160, v4
    v_lshl_add_u32 v176, v2, 3, v4
    v_add_u32 v177, 122880, v176
    v_lshrrev_b32 v5, 2, v3
    v_lshl_add_u32 v4, v2, 2, v5
    v_lshlrev_b32 v4, 7, v4
    v_and_b32 v5, 3, v3
    v_lshl_add_u32 v4, v5, 3, v4
    s_lshl_b32 s40, s34, 5
    s_add_u32 s40, s40, 133120
    v_add_u32 v178, s40, v4
    s_mov_b32 s46, 0xbfb8aa3b
    s_mov_b32 s47, 0xbfb8aa3b
    v_pk_mul_f32 v[8:9], v[116:117], s[46:47]
    v_pk_mul_f32 v[10:11], v[118:119], s[46:47]
    v_pk_mul_f32 v[12:13], v[120:121], s[46:47]
    v_pk_mul_f32 v[14:15], v[122:123], s[46:47]
    v_pk_mul_f32 v[16:17], v[124:125], s[46:47]
    v_pk_mul_f32 v[18:19], v[126:127], s[46:47]
    v_pk_mul_f32 v[20:21], v[128:129], s[46:47]
    v_pk_mul_f32 v[22:23], v[130:131], s[46:47]
    v_pk_mul_f32 v[24:25], v[132:133], s[46:47]
    v_pk_mul_f32 v[26:27], v[134:135], s[46:47]
    s_waitcnt vmcnt(0)
    s_barrier
    ds_read_b64 v[136:137], v177 offset:0
    ds_read_b64 v[138:139], v177 offset:32
    ds_read_b64 v[140:141], v177 offset:64
    ds_read_b64 v[142:143], v177 offset:96
    ds_read_b64 v[144:145], v177 offset:128
    ds_read_b64_tr_b16 v[146:147], v178 offset:0
    ds_read_b64_tr_b16 v[148:149], v178 offset:2048
    ds_read_b64_tr_b16 v[150:151], v178 offset:4096
    ds_read_b64_tr_b16 v[152:153], v178 offset:6144
    ds_read_b64_tr_b16 v[154:155], v178 offset:8192
    v_exp_f32 v8, v8
    v_exp_f32 v9, v9
    v_exp_f32 v10, v10
    v_exp_f32 v11, v11
    v_exp_f32 v12, v12
    v_exp_f32 v13, v13
    v_exp_f32 v14, v14
    v_exp_f32 v15, v15
    v_exp_f32 v16, v16
    v_exp_f32 v17, v17
    v_exp_f32 v18, v18
    v_exp_f32 v19, v19
    v_exp_f32 v20, v20
    v_exp_f32 v21, v21
    v_exp_f32 v22, v22
    v_exp_f32 v23, v23
    v_exp_f32 v24, v24
    v_exp_f32 v25, v25
    v_exp_f32 v26, v26
    v_exp_f32 v27, v27
    v_pk_add_f32 v[8:9], v[8:9], 1.0 op_sel_hi:[1,0]
    v_pk_add_f32 v[10:11], v[10:11], 1.0 op_sel_hi:[1,0]
    v_pk_add_f32 v[12:13], v[12:13], 1.0 op_sel_hi:[1,0]
    v_pk_add_f32 v[14:15], v[14:15], 1.0 op_sel_hi:[1,0]
    v_pk_add_f32 v[16:17], v[16:17], 1.0 op_sel_hi:[1,0]
    v_pk_add_f32 v[18:19], v[18:19], 1.0 op_sel_hi:[1,0]
    v_pk_add_f32 v[20:21], v[20:21], 1.0 op_sel_hi:[1,0]
    v_pk_add_f32 v[22:23], v[22:23], 1.0 op_sel_hi:[1,0]
    v_pk_add_f32 v[24:25], v[24:25], 1.0 op_sel_hi:[1,0]
    v_pk_add_f32 v[26:27], v[26:27], 1.0 op_sel_hi:[1,0]
    v_rcp_f32 v8, v8
    v_rcp_f32 v9, v9
    v_rcp_f32 v10, v10
    v_rcp_f32 v11, v11
    v_rcp_f32 v12, v12
    v_rcp_f32 v13, v13
    v_rcp_f32 v14, v14
    v_rcp_f32 v15, v15
    v_rcp_f32 v16, v16
    v_rcp_f32 v17, v17
    v_rcp_f32 v18, v18
    v_rcp_f32 v19, v19
    v_rcp_f32 v20, v20
    v_rcp_f32 v21, v21
    v_rcp_f32 v22, v22
    v_rcp_f32 v23, v23
    v_rcp_f32 v24, v24
    v_rcp_f32 v25, v25
    v_rcp_f32 v26, v26
    v_rcp_f32 v27, v27
    v_pk_mul_f32 v[8:9], v[8:9], v[116:117]
    v_pk_mul_f32 v[10:11], v[10:11], v[118:119]
    v_pk_mul_f32 v[12:13], v[12:13], v[120:121]
    v_pk_mul_f32 v[14:15], v[14:15], v[122:123]
    v_pk_mul_f32 v[16:17], v[16:17], v[124:125]
    v_pk_mul_f32 v[18:19], v[18:19], v[126:127]
    v_pk_mul_f32 v[20:21], v[20:21], v[128:129]
    v_pk_mul_f32 v[22:23], v[22:23], v[130:131]
    v_pk_mul_f32 v[24:25], v[24:25], v[132:133]
    v_pk_mul_f32 v[26:27], v[26:27], v[134:135]
    s_waitcnt lgkmcnt(0)
    v_lshlrev_b32 v28, 16, v136
    v_and_b32 v29, 0xffff0000, v136
    v_lshlrev_b32 v48, 16, v146
    v_and_b32 v49, 0xffff0000, v146
    v_lshlrev_b32 v30, 16, v137
    v_and_b32 v31, 0xffff0000, v137
    v_lshlrev_b32 v50, 16, v147
    v_and_b32 v51, 0xffff0000, v147
    v_lshlrev_b32 v32, 16, v138
    v_and_b32 v33, 0xffff0000, v138
    v_lshlrev_b32 v52, 16, v148
    v_and_b32 v53, 0xffff0000, v148
    v_lshlrev_b32 v34, 16, v139
    v_and_b32 v35, 0xffff0000, v139
    v_lshlrev_b32 v54, 16, v149
    v_and_b32 v55, 0xffff0000, v149
    v_lshlrev_b32 v36, 16, v140
    v_and_b32 v37, 0xffff0000, v140
    v_lshlrev_b32 v56, 16, v150
    v_and_b32 v57, 0xffff0000, v150
    v_lshlrev_b32 v38, 16, v141
    v_and_b32 v39, 0xffff0000, v141
    v_lshlrev_b32 v58, 16, v151
    v_and_b32 v59, 0xffff0000, v151
    v_lshlrev_b32 v40, 16, v142
    v_and_b32 v41, 0xffff0000, v142
    v_lshlrev_b32 v60, 16, v152
    v_and_b32 v61, 0xffff0000, v152
    v_lshlrev_b32 v42, 16, v143
    v_and_b32 v43, 0xffff0000, v143
    v_lshlrev_b32 v62, 16, v153
    v_and_b32 v63, 0xffff0000, v153
    v_lshlrev_b32 v44, 16, v144
    v_and_b32 v45, 0xffff0000, v144
    v_lshlrev_b32 v64, 16, v154
    v_and_b32 v65, 0xffff0000, v154
    v_lshlrev_b32 v46, 16, v145
    v_and_b32 v47, 0xffff0000, v145
    v_lshlrev_b32 v66, 16, v155
    v_and_b32 v67, 0xffff0000, v155
    v_mov_b32 v180, v111
    v_pk_add_f32 v[68:69], v[28:29], v[110:111] op_sel_hi:[1,0] neg_lo:[0,1] neg_hi:[0,1]
    v_pk_add_f32 v[70:71], v[30:31], v[110:111] op_sel_hi:[1,0] neg_lo:[0,1] neg_hi:[0,1]
    v_pk_add_f32 v[72:73], v[32:33], v[110:111] op_sel_hi:[1,0] neg_lo:[0,1] neg_hi:[0,1]
    v_pk_add_f32 v[74:75], v[34:35], v[110:111] op_sel_hi:[1,0] neg_lo:[0,1] neg_hi:[0,1]
    v_pk_add_f32 v[76:77], v[36:37], v[110:111] op_sel_hi:[1,0] neg_lo:[0,1] neg_hi:[0,1]
    v_pk_add_f32 v[78:79], v[38:39], v[110:111] op_sel_hi:[1,0] neg_lo:[0,1] neg_hi:[0,1]
    v_pk_add_f32 v[80:81], v[40:41], v[110:111] op_sel_hi:[1,0] neg_lo:[0,1] neg_hi:[0,1]
    v_pk_add_f32 v[82:83], v[42:43], v[110:111] op_sel_hi:[1,0] neg_lo:[0,1] neg_hi:[0,1]
    v_pk_add_f32 v[84:85], v[44:45], v[110:111] op_sel_hi:[1,0] neg_lo:[0,1] neg_hi:[0,1]
    v_pk_add_f32 v[86:87], v[46:47], v[110:111] op_sel_hi:[1,0] neg_lo:[0,1] neg_hi:[0,1]
    v_pk_mul_f32 v[68:69], v[68:69], v[180:181] op_sel_hi:[1,0]
    v_pk_mul_f32 v[70:71], v[70:71], v[180:181] op_sel_hi:[1,0]
    v_pk_mul_f32 v[72:73], v[72:73], v[180:181] op_sel_hi:[1,0]
    v_pk_mul_f32 v[74:75], v[74:75], v[180:181] op_sel_hi:[1,0]
    v_pk_mul_f32 v[76:77], v[76:77], v[180:181] op_sel_hi:[1,0]
    v_pk_mul_f32 v[78:79], v[78:79], v[180:181] op_sel_hi:[1,0]
    v_pk_mul_f32 v[80:81], v[80:81], v[180:181] op_sel_hi:[1,0]
    v_pk_mul_f32 v[82:83], v[82:83], v[180:181] op_sel_hi:[1,0]
    v_pk_mul_f32 v[84:85], v[84:85], v[180:181] op_sel_hi:[1,0]
    v_pk_mul_f32 v[86:87], v[86:87], v[180:181] op_sel_hi:[1,0]
    v_pk_mul_f32 v[68:69], v[68:69], v[48:49]
    v_pk_mul_f32 v[70:71], v[70:71], v[50:51]
    v_pk_mul_f32 v[72:73], v[72:73], v[52:53]
    v_pk_mul_f32 v[74:75], v[74:75], v[54:55]
    v_pk_mul_f32 v[76:77], v[76:77], v[56:57]
    v_pk_mul_f32 v[78:79], v[78:79], v[58:59]
    v_pk_mul_f32 v[80:81], v[80:81], v[60:61]
    v_pk_mul_f32 v[82:83], v[82:83], v[62:63]
    v_pk_mul_f32 v[84:85], v[84:85], v[64:65]
    v_pk_mul_f32 v[86:87], v[86:87], v[66:67]
    v_pk_fma_f32 v[68:69], v[68:69], v[8:9], v[28:29]
    v_pk_fma_f32 v[70:71], v[70:71], v[10:11], v[30:31]
    v_pk_fma_f32 v[72:73], v[72:73], v[12:13], v[32:33]
    v_pk_fma_f32 v[74:75], v[74:75], v[14:15], v[34:35]
    v_pk_fma_f32 v[76:77], v[76:77], v[16:17], v[36:37]
    v_pk_fma_f32 v[78:79], v[78:79], v[18:19], v[38:39]
    v_pk_fma_f32 v[80:81], v[80:81], v[20:21], v[40:41]
    v_pk_fma_f32 v[82:83], v[82:83], v[22:23], v[42:43]
    v_pk_fma_f32 v[84:85], v[84:85], v[24:25], v[44:45]
    v_pk_fma_f32 v[86:87], v[86:87], v[26:27], v[46:47]
    v_cvt_pk_bf16_f32 v136, v68, v69
    v_cvt_pk_bf16_f32 v137, v70, v71
    v_cvt_pk_bf16_f32 v138, v72, v73
    v_cvt_pk_bf16_f32 v139, v74, v75
    v_cvt_pk_bf16_f32 v140, v76, v77
    v_cvt_pk_bf16_f32 v141, v78, v79
    v_cvt_pk_bf16_f32 v142, v80, v81
    v_cvt_pk_bf16_f32 v143, v82, v83
    v_cvt_pk_bf16_f32 v144, v84, v85
    v_cvt_pk_bf16_f32 v145, v86, v87
    v_add_u32 v182, 143360, v176
    ds_write_b64 v182, v[136:137] offset:0
    ds_write_b64 v182, v[138:139] offset:32
    ds_write_b64 v182, v[140:141] offset:64
    ds_write_b64 v182, v[142:143] offset:96
    ds_write_b64 v182, v[144:145] offset:128
    s_mul_i32 s40, s34, 2560
    s_add_u32 s40, s40, 143360
    v_add_u32 v4, s40, v7
    s_waitcnt lgkmcnt(0)
    ds_read_b128 v[8:11], v4 offset:0
    ds_read_b128 v[12:15], v4 offset:1024
    ds_read_b128 v[16:19], v4 offset:2048
    s_mul_i32 s40, s34, 20480
    s_add_u32 s40, s40, s45
    s_waitcnt lgkmcnt(0)
    buffer_store_dwordx4 v[8:11], v104, s[16:19], s40 offen
    buffer_store_dwordx4 v[12:15], v105, s[16:19], s40 offen
    s_mov_b32 exec_hi, 0
    buffer_store_dwordx4 v[16:19], v106, s[16:19], s40 offen
    s_mov_b64 exec, -1
    s_endpgm
recurrent_scan__ssm_conv_h3__mixer_gmlp__prompt_kernel_conv:
    s_load_dwordx2 s[4:5], s[0:1], 32
    s_load_dwordx2 s[8:9], s[0:1], 104
    s_load_dwordx2 s[12:13], s[0:1], 40
    s_load_dwordx2 s[16:17], s[0:1], 64
    s_load_dwordx2 s[20:21], s[0:1], 80
    v_subrev_u32 v0, 256, v0
    s_setprio 1
    v_lshrrev_b32 v3, 6, v0
    v_and_b32 v1, 63, v0
    v_readfirstlane_b32 s34, v3
    s_mov_b32 s6, 2621440
    s_mov_b32 s7, 0x20000
    s_mov_b32 s10, 15990784
    s_mov_b32 s11, 0x20000
    s_mov_b32 s14, 1280
    s_mov_b32 s15, 0x20000
    s_mov_b32 s18, 8388608
    s_mov_b32 s19, 0x20000
    s_mov_b32 s22, 983040
    s_mov_b32 s23, 0x20000
    s_mov_b32 s32, s2
    v_lshlrev_b32 v2, 4, v0
    v_subrev_u32 v47, 16, v2
    s_mov_b32 s56, s2
    s_add_u32 s57, s2, 256
    s_lshr_b32 s58, s2, 1
    s_add_u32 s58, s58, 512
    s_waitcnt lgkmcnt(0)
    s_lshl_b32 s40, s56, 12
    buffer_load_dwordx4 v[12:15], v2, s[4:7], s40 offen
    buffer_load_dwordx4 v[8:11], v47, s[4:7], s40 offen
    s_lshl_b32 s41, s56, 1
    v_mov_b32 v3, 0
    buffer_load_ushort v44, v3, s[12:15], s41 offen
    s_lshr_b32 s47, s2, 3
    s_lshl_b32 s47, s47, 2
    s_add_u32 s47, s47, s34
    s_mul_i32 s40, s47, 12
    v_add_u32 v3, s40, v1
    v_mul_u32_u24 v4, 43691, v3
    v_lshrrev_b32 v4, 22, v4
    v_mul_u32_u24 v5, 96, v4
    v_sub_u32 v3, v3, v5
    v_mul_u32_u24 v4, 98304, v4
    v_lshl_add_u32 v57, v3, 7, v4
    s_and_b32 s40, s2, 7
    s_lshr_b32 s52, s40, 1
    s_lshl_b32 s52, s52, 21
    s_and_b32 s53, s40, 1
    s_mul_i32 s53, s53, 1572864
    s_add_u32 s53, s53, 0
    s_lshl_b32 s40, s47, 4
    v_add_u32 v3, s40, v1
    v_lshrrev_b32 v4, 2, v3
    v_lshlrev_b32 v4, 12, v4
    v_and_b32 v3, 3, v3
    v_lshl_add_u32 v56, v3, 10, v4
    s_cmp_ge_u32 s2, 192
    s_cbranch_scc1 c_wj_28
    s_mul_i32 s40, s2, 2731
    s_lshr_b32 s40, s40, 16
    s_mul_i32 s41, s40, 24
    s_sub_u32 s41, s2, s41
    s_mul_i32 s41, s41, 40960
    s_mul_i32 s40, s40, 160
    s_add_u32 s54, s40, s41
    v_mov_b32 v3, v0
    v_mul_u32_u24 v4, 6554, v3
    v_lshrrev_b32 v4, 16, v4
    v_mul_u32_u24 v5, 10, v4
    v_sub_u32 v3, v3, v5
    v_lshlrev_b32 v3, 4, v3
    v_mul_u32_u24 v4, 1280, v4
    v_add_u32 v3, v3, v4
    s_lshl_b32 s40, s34, 10
    s_add_u32 m0, s40, 156672
    s_nop 0
    buffer_load_dwordx4 v3, s[20:23], s54 offen lds
    s_cmp_lg_u32 s34, 0
    s_cbranch_scc1 c_wj2_29
    v_add_u32 v3, 256, v1
    v_mul_u32_u24 v4, 6554, v3
    v_lshrrev_b32 v4, 16, v4
    v_mul_u32_u24 v5, 10, v4
    v_sub_u32 v3, v3, v5
    v_lshlrev_b32 v3, 4, v3
    v_mul_u32_u24 v4, 1280, v4
    v_add_u32 v3, v3, v4
    s_mov_b32 m0, 160768
    s_nop 0
    buffer_load_dwordx4 v3, s[20:23], s54 offen lds
c_wj2_29:
c_wj_28:
    s_lshl_b32 s40, s57, 12
    buffer_load_dwordx4 v[20:23], v2, s[4:7], s40 offen
    buffer_load_dwordx4 v[16:19], v47, s[4:7], s40 offen
    s_lshl_b32 s41, s57, 1
    v_mov_b32 v3, 0
    buffer_load_ushort v45, v3, s[12:15], s41 offen
    s_lshl_b32 s40, s58, 12
    buffer_load_dwordx4 v[28:31], v2, s[4:7], s40 offen
    buffer_load_dwordx4 v[24:27], v47, s[4:7], s40 offen
    s_lshl_b32 s41, s58, 1
    v_mov_b32 v3, 0
    buffer_load_ushort v46, v3, s[12:15], s41 offen
    v_mov_b32 v60, 0
    v_mov_b32 v61, 0
    v_mov_b32 v62, 0
    v_mov_b32 v63, 0
    v_mul_u32_u24 v3, 4160, v0
    v_add_u32 v3, 86016, v3
    v_cmp_gt_u32 vcc, 64, v0
    s_nop 0
    s_and_saveexec_b64 s[50:51], vcc
    s_cbranch_execz c_z_30
    v_subrev_u32 v4, -118784, v2
    v_cmp_gt_u32 vcc, 8, v0
    s_nop 1
    v_cndmask_b32 v4, v4, v3, vcc
    v_add_u32 v5, -8, v0
    v_cmp_lt_u32 vcc, 23, v5
    s_nop 0
    s_and_b64 exec, exec, vcc
    ds_write_b128 v4, v[60:63]
c_z_30:
    s_mov_b64 exec, s[50:51]
    v_add_u32 v64, 86032, v2
    v_add_u32 v65, 119808, v2
    v_and_b32 v3, 7, v1
    v_mul_u32_u24 v3, 4160, v3
    v_bfe_u32 v4, v1, 3, 1
    v_lshrrev_b32 v5, 4, v1
    v_sub_u32 v4, v4, v5
    v_add_u32 v4, 3, v4
    v_lshl_add_u32 v66, v4, 4, v3
    v_add_u32 v66, 86016, v66
    v_and_b32 v3, 15, v1
    v_lshl_add_u32 v3, v3, 1, v5
    v_lshlrev_b32 v67, 4, v3
    v_add_u32 v67, 119296, v67
    v_and_b32 v3, 15, v1
    v_lshlrev_b32 v4, 3, v5
    v_sub_u32 v4, v4, v3
    v_add_u32 v4, -9, v4
    v_mov_b32 v72, 0xffff
    v_mov_b32 v73, 0xffff0000
    v_cmp_eq_u32 vcc, 0, v4
    s_nop 1
    v_cndmask_b32 v68, 0, v72, vcc
    v_cmp_eq_u32 vcc, 1, v4
    s_nop 1
    v_cndmask_b32 v68, v68, v73, vcc
    v_cmp_eq_u32 vcc, 2, v4
    s_nop 1
    v_cndmask_b32 v69, 0, v72, vcc
    v_cmp_eq_u32 vcc, 3, v4
    s_nop 1
    v_cndmask_b32 v69, v69, v73, vcc
    v_cmp_eq_u32 vcc, 4, v4
    s_nop 1
    v_cndmask_b32 v70, 0, v72, vcc
    v_cmp_eq_u32 vcc, 5, v4
    s_nop 1
    v_cndmask_b32 v70, v70, v73, vcc
    v_cmp_eq_u32 vcc, 6, v4
    s_nop 1
    v_cndmask_b32 v71, 0, v72, vcc
    v_cmp_eq_u32 vcc, 7, v4
    s_nop 1
    v_cndmask_b32 v71, v71, v73, vcc
    v_and_b32 v3, 15, v1
    v_lshlrev_b32 v3, 6, v3
    v_lshl_add_u32 v3, v5, 4, v3
    s_lshl_b32 s40, s34, 13
    s_add_u32 s40, s40, 123904
    v_add_u32 v74, s40, v3
    v_lshlrev_b32 v75, 5, v0
    v_add_u32 v75, 123904, v75
    s_waitcnt vmcnt(6)
    v_cmp_ne_u32 vcc, 0, v0
    s_nop 1
    v_cndmask_b32 v8, 0, v8, vcc
    v_cndmask_b32 v9, 0, v9, vcc
    v_cndmask_b32 v10, 0, v10, vcc
    v_cndmask_b32 v11, 0, v11, vcc
    v_alignbit_b32 v184, v9, v8, 16
    v_alignbit_b32 v185, v10, v9, 16
    v_alignbit_b32 v186, v11, v10, 16
    v_alignbit_b32 v187, v12, v11, 16
    v_alignbit_b32 v188, v13, v12, 16
    v_alignbit_b32 v189, v14, v13, 16
    v_alignbit_b32 v190, v15, v14, 16
    ds_write_b128 v64, v[184:187] offset:0
    v_mov_b32 v192, v9
    v_mov_b32 v193, v10
    v_mov_b32 v194, v11
    v_mov_b32 v195, v12
    ds_write_b128 v64, v[192:195] offset:4160
    s_nop 1
    v_mov_b32 v192, v185
    v_mov_b32 v193, v186
    v_mov_b32 v194, v187
    v_mov_b32 v195, v188
    ds_write_b128 v64, v[192:195] offset:8320
    s_nop 1
    ds_write_b128 v64, v[10:13] offset:12480
    ds_write_b128 v64, v[186:189] offset:16640
    v_mov_b32 v192, v11
    v_mov_b32 v193, v12
    v_mov_b32 v194, v13
    v_mov_b32 v195, v14
    ds_write_b128 v64, v[192:195] offset:20800
    s_nop 1
    v_mov_b32 v192, v187
    v_mov_b32 v193, v188
    v_mov_b32 v194, v189
    v_mov_b32 v195, v190
    ds_write_b128 v64, v[192:195] offset:24960
    s_nop 1
    ds_write_b128 v64, v[12:15] offset:29120
    v_mbcnt_lo_u32_b32 v3, -1, 0
    v_mbcnt_hi_u32_b32 v3, -1, v3
    v_lshlrev_b32 v3, 4, v3
    s_mov_b32 s66, 14716928
    s_mov_b32 s67, 0
fpoll_31:
    buffer_load_dwordx4 v[48:51], v3, s[8:11], s66 offen sc1
    buffer_load_dwordx4 v[52:55], v3, s[8:11], s66 offen offset:1024 sc1
    s_add_u32 s67, s67, 1
    s_waitcnt vmcnt(0)
    v_cmp_ne_u32 vcc, s100, v48
    v_cmp_ne_u32 s[64:65], s101, v49
    s_nop 0
    s_or_b64 vcc, vcc, s[64:65]
    v_cmp_ne_u32 s[64:65], s100, v50
    s_nop 0
    s_or_b64 vcc, vcc, s[64:65]
    v_cmp_ne_u32 s[64:65], s101, v51
    s_nop 0
    s_or_b64 vcc, vcc, s[64:65]
    v_cmp_ne_u32 s[64:65], s100, v52
    s_nop 0
    s_or_b64 vcc, vcc, s[64:65]
    v_cmp_ne_u32 s[64:65], s101, v53
    s_nop 0
    s_or_b64 vcc, vcc, s[64:65]
    v_cmp_ne_u32 s[64:65], s100, v54
    s_nop 0
    s_or_b64 vcc, vcc, s[64:65]
    v_cmp_ne_u32 s[64:65], s101, v55
    s_nop 0
    s_or_b64 vcc, vcc, s[64:65]
    s_cmp_gt_u32 s67, 100000
    s_cbranch_scc1 fpoll_e_32
    s_cmp_eq_u64 vcc, 0
    s_cbranch_scc1 fpoll_e_32
    s_sleep 2
    s_branch fpoll_31
fpoll_e_32:
    s_lshl_b32 s40, s56, 12
    s_add_u32 s40, s40, 6291456
    buffer_load_dwordx4 v[32:35], v2, s[8:11], s40 offen sc1
    s_lshl_b32 s40, s57, 12
    s_add_u32 s40, s40, 6291456
    buffer_load_dwordx4 v[36:39], v2, s[8:11], s40 offen sc1
    s_lshl_b32 s40, s58, 12
    s_add_u32 s40, s40, 6291456
    buffer_load_dwordx4 v[40:43], v2, s[8:11], s40 offen sc1
    s_waitcnt vmcnt(2)
    ds_write_b128 v65, v[32:35]
    v_lshlrev_b32 v3, 16, v44
    v_or_b32 v3, v3, v44
    v_and_b32 v196, v68, v3
    v_and_b32 v197, v69, v3
    v_and_b32 v198, v70, v3
    v_and_b32 v199, v71, v3
    s_waitcnt lgkmcnt(0)
    v_mov_b32 v3, 161796
    v_mov_b32 v4, 1
    s_mov_b64 exec, 1
    ds_add_u32 v3, v4
    s_mov_b64 exec, -1
    s_mov_b32 s67, 0
gsync_33:
    ds_read_b32 v4, v3
    s_add_u32 s67, s67, 1
    s_waitcnt lgkmcnt(0)
    v_readfirstlane_b32 s66, v4
    s_cmp_gt_u32 s67, 1000000
    s_cbranch_scc1 gsync_e_34
    s_cmp_lt_u32 s66, 4
    s_cbranch_scc1 gsync_33
gsync_e_34:
    s_cmp_lg_u32 s34, 0
    s_cbranch_scc1 c_pw_36
    ds_read_b128 v[108:111], v66 offset:0
    ds_read_b128 v[120:123], v67 offset:480
    ds_read_b128 v[124:127], v67 offset:992
    ds_read_b128 v[128:131], v67 offset:1504
    ds_read_b128 v[132:135], v67 offset:2016
    ds_read_b128 v[136:139], v67 offset:2528
    ds_read_b128 v[140:143], v67 offset:3040
    ds_read_b128 v[144:147], v67 offset:3552
    ds_read_b128 v[148:151], v67 offset:4064
    ds_read_b128 v[112:115], v66 offset:512
    ds_read_b128 v[116:119], v66 offset:1024
    s_waitcnt lgkmcnt(2)
    v_mfma_f32_16x16x32_bf16 v[104:107], v[108:111], v[148:151], 0
    v_mfma_f32_16x16x32_bf16 v[100:103], v[108:111], v[144:147], 0
    v_mfma_f32_16x16x32_bf16 v[96:99], v[108:111], v[140:143], 0
    v_mfma_f32_16x16x32_bf16 v[92:95], v[108:111], v[136:139], 0
    v_mfma_f32_16x16x32_bf16 v[88:91], v[108:111], v[132:135], 0
    v_mfma_f32_16x16x32_bf16 v[84:87], v[108:111], v[128:131], 0
    v_mfma_f32_16x16x32_bf16 v[80:83], v[108:111], v[124:127], 0
    v_mfma_f32_16x16x32_bf16 v[76:79], v[108:111], v[120:123], 0
    v_mfma_f32_16x16x32_bf16 v[76:79], v[196:199], v[120:123], v[76:79]
    v_mfma_f32_16x16x32_bf16 v[80:83], v[196:199], v[124:127], v[80:83]
    v_mfma_f32_16x16x32_bf16 v[84:87], v[196:199], v[128:131], v[84:87]
    v_mfma_f32_16x16x32_bf16 v[88:91], v[196:199], v[132:135], v[88:91]
    v_mfma_f32_16x16x32_bf16 v[92:95], v[196:199], v[136:139], v[92:95]
    v_mfma_f32_16x16x32_bf16 v[96:99], v[196:199], v[140:143], v[96:99]
    v_mfma_f32_16x16x32_bf16 v[100:103], v[196:199], v[144:147], v[100:103]
    v_mfma_f32_16x16x32_bf16 v[104:107], v[196:199], v[148:151], v[104:107]
    ds_read_b128 v[108:111], v66 offset:1536
    s_waitcnt lgkmcnt(2)
    v_mfma_f32_16x16x32_bf16 v[104:107], v[112:115], v[144:147], v[104:107]
    v_mfma_f32_16x16x32_bf16 v[100:103], v[112:115], v[140:143], v[100:103]
    v_mfma_f32_16x16x32_bf16 v[96:99], v[112:115], v[136:139], v[96:99]
    v_mfma_f32_16x16x32_bf16 v[92:95], v[112:115], v[132:135], v[92:95]
    v_mfma_f32_16x16x32_bf16 v[88:91], v[112:115], v[128:131], v[88:91]
    v_mfma_f32_16x16x32_bf16 v[84:87], v[112:115], v[124:127], v[84:87]
    v_mfma_f32_16x16x32_bf16 v[80:83], v[112:115], v[120:123], v[80:83]
    ds_read_b128 v[112:115], v66 offset:2048
    ds_read_b128 v[152:155], v67 offset:416
    ds_read_b128 v[156:159], v67 offset:928
    ds_read_b128 v[160:163], v67 offset:1440
    ds_read_b128 v[164:167], v67 offset:1952
    ds_read_b128 v[168:171], v67 offset:2464
    ds_read_b128 v[172:175], v67 offset:2976
    ds_read_b128 v[176:179], v67 offset:3488
    ds_read_b128 v[180:183], v67 offset:4000
    s_waitcnt lgkmcnt(10)
    v_mfma_f32_16x16x32_bf16 v[104:107], v[116:119], v[140:143], v[104:107]
    v_mfma_f32_16x16x32_bf16 v[100:103], v[116:119], v[136:139], v[100:103]
    v_mfma_f32_16x16x32_bf16 v[96:99], v[116:119], v[132:135], v[96:99]
    v_mfma_f32_16x16x32_bf16 v[92:95], v[116:119], v[128:131], v[92:95]
    v_mfma_f32_16x16x32_bf16 v[88:91], v[116:119], v[124:127], v[88:91]
    v_mfma_f32_16x16x32_bf16 v[84:87], v[116:119], v[120:123], v[84:87]
    ds_read_b128 v[116:119], v66 offset:2560
    s_waitcnt lgkmcnt(10)
    v_mfma_f32_16x16x32_bf16 v[104:107], v[108:111], v[136:139], v[104:107]
    v_mfma_f32_16x16x32_bf16 v[100:103], v[108:111], v[132:135], v[100:103]
    v_mfma_f32_16x16x32_bf16 v[96:99], v[108:111], v[128:131], v[96:99]
    v_mfma_f32_16x16x32_bf16 v[92:95], v[108:111], v[124:127], v[92:95]
    v_mfma_f32_16x16x32_bf16 v[88:91], v[108:111], v[120:123], v[88:91]
    ds_read_b128 v[108:111], v66 offset:3072
    s_waitcnt lgkmcnt(10)
    v_mfma_f32_16x16x32_bf16 v[104:107], v[112:115], v[132:135], v[104:107]
    v_mfma_f32_16x16x32_bf16 v[100:103], v[112:115], v[128:131], v[100:103]
    v_mfma_f32_16x16x32_bf16 v[96:99], v[112:115], v[124:127], v[96:99]
    v_mfma_f32_16x16x32_bf16 v[92:95], v[112:115], v[120:123], v[92:95]
    ds_read_b128 v[112:115], v66 offset:3584
    s_waitcnt lgkmcnt(2)
    v_mfma_f32_16x16x32_bf16 v[104:107], v[116:119], v[128:131], v[104:107]
    v_mfma_f32_16x16x32_bf16 v[100:103], v[116:119], v[124:127], v[100:103]
    v_mfma_f32_16x16x32_bf16 v[96:99], v[116:119], v[120:123], v[96:99]
    ds_read_b128 v[116:119], v66 offset:64
    s_waitcnt lgkmcnt(2)
    v_mfma_f32_16x16x32_bf16 v[104:107], v[108:111], v[124:127], v[104:107]
    v_mfma_f32_16x16x32_bf16 v[100:103], v[108:111], v[120:123], v[100:103]
    ds_read_b128 v[108:111], v66 offset:576
    s_waitcnt lgkmcnt(2)
    v_mfma_f32_16x16x32_bf16 v[104:107], v[112:115], v[120:123], v[104:107]
    ds_read_b128 v[112:115], v66 offset:1088
    s_waitcnt lgkmcnt(2)
    v_mfma_f32_16x16x32_bf16 v[104:107], v[116:119], v[180:183], v[104:107]
    v_mfma_f32_16x16x32_bf16 v[100:103], v[116:119], v[176:179], v[100:103]
    v_mfma_f32_16x16x32_bf16 v[96:99], v[116:119], v[172:175], v[96:99]
    v_mfma_f32_16x16x32_bf16 v[92:95], v[116:119], v[168:171], v[92:95]
    v_mfma_f32_16x16x32_bf16 v[88:91], v[116:119], v[164:167], v[88:91]
    v_mfma_f32_16x16x32_bf16 v[84:87], v[116:119], v[160:163], v[84:87]
    v_mfma_f32_16x16x32_bf16 v[80:83], v[116:119], v[156:159], v[80:83]
    v_mfma_f32_16x16x32_bf16 v[76:79], v[116:119], v[152:155], v[76:79]
    ds_read_b128 v[116:119], v66 offset:1600
    s_waitcnt lgkmcnt(2)
    v_mfma_f32_16x16x32_bf16 v[104:107], v[108:111], v[176:179], v[104:107]
    v_mfma_f32_16x16x32_bf16 v[100:103], v[108:111], v[172:175], v[100:103]
    v_mfma_f32_16x16x32_bf16 v[96:99], v[108:111], v[168:171], v[96:99]
    v_mfma_f32_16x16x32_bf16 v[92:95], v[108:111], v[164:167], v[92:95]
    v_mfma_f32_16x16x32_bf16 v[88:91], v[108:111], v[160:163], v[88:91]
    v_mfma_f32_16x16x32_bf16 v[84:87], v[108:111], v[156:159], v[84:87]
    v_mfma_f32_16x16x32_bf16 v[80:83], v[108:111], v[152:155], v[80:83]
    ds_read_b128 v[108:111], v66 offset:2112
    s_waitcnt lgkmcnt(2)
    v_mfma_f32_16x16x32_bf16 v[104:107], v[112:115], v[172:175], v[104:107]
    v_mfma_f32_16x16x32_bf16 v[100:103], v[112:115], v[168:171], v[100:103]
    v_mfma_f32_16x16x32_bf16 v[96:99], v[112:115], v[164:167], v[96:99]
    v_mfma_f32_16x16x32_bf16 v[92:95], v[112:115], v[160:163], v[92:95]
    v_mfma_f32_16x16x32_bf16 v[88:91], v[112:115], v[156:159], v[88:91]
    v_mfma_f32_16x16x32_bf16 v[84:87], v[112:115], v[152:155], v[84:87]
    ds_read_b128 v[112:115], v66 offset:2624
    s_waitcnt lgkmcnt(2)
    v_mfma_f32_16x16x32_bf16 v[104:107], v[116:119], v[168:171], v[104:107]
    v_mfma_f32_16x16x32_bf16 v[100:103], v[116:119], v[164:167], v[100:103]
    v_mfma_f32_16x16x32_bf16 v[96:99], v[116:119], v[160:163], v[96:99]
    v_mfma_f32_16x16x32_bf16 v[92:95], v[116:119], v[156:159], v[92:95]
    v_mfma_f32_16x16x32_bf16 v[88:91], v[116:119], v[152:155], v[88:91]
    ds_read_b128 v[116:119], v66 offset:3136
    s_waitcnt lgkmcnt(2)
    v_mfma_f32_16x16x32_bf16 v[104:107], v[108:111], v[164:167], v[104:107]
    v_mfma_f32_16x16x32_bf16 v[100:103], v[108:111], v[160:163], v[100:103]
    v_mfma_f32_16x16x32_bf16 v[96:99], v[108:111], v[156:159], v[96:99]
    v_mfma_f32_16x16x32_bf16 v[92:95], v[108:111], v[152:155], v[92:95]
    ds_read_b128 v[108:111], v66 offset:3648
    s_waitcnt lgkmcnt(2)
    v_mfma_f32_16x16x32_bf16 v[104:107], v[112:115], v[160:163], v[104:107]
    v_mfma_f32_16x16x32_bf16 v[100:103], v[112:115], v[156:159], v[100:103]
    v_mfma_f32_16x16x32_bf16 v[96:99], v[112:115], v[152:155], v[96:99]
    s_waitcnt lgkmcnt(1)
    v_mfma_f32_16x16x32_bf16 v[104:107], v[116:119], v[156:159], v[104:107]
    v_mfma_f32_16x16x32_bf16 v[100:103], v[116:119], v[152:155], v[100:103]
    s_waitcnt lgkmcnt(0)
    v_mfma_f32_16x16x32_bf16 v[104:107], v[108:111], v[152:155], v[104:107]
    ds_write_b128 v74, v[76:79] offset:0
    ds_write_b128 v74, v[80:83] offset:1024
    ds_write_b128 v74, v[84:87] offset:2048
    ds_write_b128 v74, v[88:91] offset:3072
    ds_write_b128 v74, v[92:95] offset:4096
    ds_write_b128 v74, v[96:99] offset:5120
    ds_write_b128 v74, v[100:103] offset:6144
    s_nop 0
    ds_write_b128 v74, v[104:107] offset:7168
    s_branch c_pw_end_35
c_pw_36:
    s_cmp_lg_u32 s34, 1
    s_cbranch_scc1 c_pw_37
    ds_read_b128 v[108:111], v66 offset:128
    ds_read_b128 v[120:123], v67 offset:352
    ds_read_b128 v[124:127], v67 offset:864
    ds_read_b128 v[128:131], v67 offset:1376
    ds_read_b128 v[132:135], v67 offset:1888
    ds_read_b128 v[136:139], v67 offset:2400
    ds_read_b128 v[140:143], v67 offset:2912
    ds_read_b128 v[144:147], v67 offset:3424
    ds_read_b128 v[148:151], v67 offset:3936
    ds_read_b128 v[112:115], v66 offset:640
    ds_read_b128 v[116:119], v66 offset:1152
    s_waitcnt lgkmcnt(2)
    v_mfma_f32_16x16x32_bf16 v[104:107], v[108:111], v[148:151], 0
    v_mfma_f32_16x16x32_bf16 v[100:103], v[108:111], v[144:147], 0
    v_mfma_f32_16x16x32_bf16 v[96:99], v[108:111], v[140:143], 0
    v_mfma_f32_16x16x32_bf16 v[92:95], v[108:111], v[136:139], 0
    v_mfma_f32_16x16x32_bf16 v[88:91], v[108:111], v[132:135], 0
    v_mfma_f32_16x16x32_bf16 v[84:87], v[108:111], v[128:131], 0
    v_mfma_f32_16x16x32_bf16 v[80:83], v[108:111], v[124:127], 0
    v_mfma_f32_16x16x32_bf16 v[76:79], v[108:111], v[120:123], 0
    ds_read_b128 v[108:111], v66 offset:1664
    s_waitcnt lgkmcnt(2)
    v_mfma_f32_16x16x32_bf16 v[104:107], v[112:115], v[144:147], v[104:107]
    v_mfma_f32_16x16x32_bf16 v[100:103], v[112:115], v[140:143], v[100:103]
    v_mfma_f32_16x16x32_bf16 v[96:99], v[112:115], v[136:139], v[96:99]
    v_mfma_f32_16x16x32_bf16 v[92:95], v[112:115], v[132:135], v[92:95]
    v_mfma_f32_16x16x32_bf16 v[88:91], v[112:115], v[128:131], v[88:91]
    v_mfma_f32_16x16x32_bf16 v[84:87], v[112:115], v[124:127], v[84:87]
    v_mfma_f32_16x16x32_bf16 v[80:83], v[112:115], v[120:123], v[80:83]
    ds_read_b128 v[112:115], v66 offset:2176
    ds_read_b128 v[152:155], v67 offset:288
    ds_read_b128 v[156:159], v67 offset:800
    ds_read_b128 v[160:163], v67 offset:1312
    ds_read_b128 v[164:167], v67 offset:1824
    ds_read_b128 v[168:171], v67 offset:2336
    ds_read_b128 v[172:175], v67 offset:2848
    ds_read_b128 v[176:179], v67 offset:3360
    ds_read_b128 v[180:183], v67 offset:3872
    s_waitcnt lgkmcnt(10)
    v_mfma_f32_16x16x32_bf16 v[104:107], v[116:119], v[140:143], v[104:107]
    v_mfma_f32_16x16x32_bf16 v[100:103], v[116:119], v[136:139], v[100:103]
    v_mfma_f32_16x16x32_bf16 v[96:99], v[116:119], v[132:135], v[96:99]
    v_mfma_f32_16x16x32_bf16 v[92:95], v[116:119], v[128:131], v[92:95]
    v_mfma_f32_16x16x32_bf16 v[88:91], v[116:119], v[124:127], v[88:91]
    v_mfma_f32_16x16x32_bf16 v[84:87], v[116:119], v[120:123], v[84:87]
    ds_read_b128 v[116:119], v66 offset:2688
    s_waitcnt lgkmcnt(10)
    v_mfma_f32_16x16x32_bf16 v[104:107], v[108:111], v[136:139], v[104:107]
    v_mfma_f32_16x16x32_bf16 v[100:103], v[108:111], v[132:135], v[100:103]
    v_mfma_f32_16x16x32_bf16 v[96:99], v[108:111], v[128:131], v[96:99]
    v_mfma_f32_16x16x32_bf16 v[92:95], v[108:111], v[124:127], v[92:95]
    v_mfma_f32_16x16x32_bf16 v[88:91], v[108:111], v[120:123], v[88:91]
    ds_read_b128 v[108:111], v66 offset:3200
    s_waitcnt lgkmcnt(10)
    v_mfma_f32_16x16x32_bf16 v[104:107], v[112:115], v[132:135], v[104:107]
    v_mfma_f32_16x16x32_bf16 v[100:103], v[112:115], v[128:131], v[100:103]
    v_mfma_f32_16x16x32_bf16 v[96:99], v[112:115], v[124:127], v[96:99]
    v_mfma_f32_16x16x32_bf16 v[92:95], v[112:115], v[120:123], v[92:95]
    ds_read_b128 v[112:115], v66 offset:3712
    s_waitcnt lgkmcnt(2)
    v_mfma_f32_16x16x32_bf16 v[104:107], v[116:119], v[128:131], v[104:107]
    v_mfma_f32_16x16x32_bf16 v[100:103], v[116:119], v[124:127], v[100:103]
    v_mfma_f32_16x16x32_bf16 v[96:99], v[116:119], v[120:123], v[96:99]
    ds_read_b128 v[116:119], v66 offset:192
    s_waitcnt lgkmcnt(2)
    v_mfma_f32_16x16x32_bf16 v[104:107], v[108:111], v[124:127], v[104:107]
    v_mfma_f32_16x16x32_bf16 v[100:103], v[108:111], v[120:123], v[100:103]
    ds_read_b128 v[108:111], v66 offset:704
    s_waitcnt lgkmcnt(2)
    v_mfma_f32_16x16x32_bf16 v[104:107], v[112:115], v[120:123], v[104:107]
    ds_read_b128 v[112:115], v66 offset:1216
    s_waitcnt lgkmcnt(2)
    v_mfma_f32_16x16x32_bf16 v[104:107], v[116:119], v[180:183], v[104:107]
    v_mfma_f32_16x16x32_bf16 v[100:103], v[116:119], v[176:179], v[100:103]
    v_mfma_f32_16x16x32_bf16 v[96:99], v[116:119], v[172:175], v[96:99]
    v_mfma_f32_16x16x32_bf16 v[92:95], v[116:119], v[168:171], v[92:95]
    v_mfma_f32_16x16x32_bf16 v[88:91], v[116:119], v[164:167], v[88:91]
    v_mfma_f32_16x16x32_bf16 v[84:87], v[116:119], v[160:163], v[84:87]
    v_mfma_f32_16x16x32_bf16 v[80:83], v[116:119], v[156:159], v[80:83]
    v_mfma_f32_16x16x32_bf16 v[76:79], v[116:119], v[152:155], v[76:79]
    ds_read_b128 v[116:119], v66 offset:1728
    s_waitcnt lgkmcnt(2)
    v_mfma_f32_16x16x32_bf16 v[104:107], v[108:111], v[176:179], v[104:107]
    v_mfma_f32_16x16x32_bf16 v[100:103], v[108:111], v[172:175], v[100:103]
    v_mfma_f32_16x16x32_bf16 v[96:99], v[108:111], v[168:171], v[96:99]
    v_mfma_f32_16x16x32_bf16 v[92:95], v[108:111], v[164:167], v[92:95]
    v_mfma_f32_16x16x32_bf16 v[88:91], v[108:111], v[160:163], v[88:91]
    v_mfma_f32_16x16x32_bf16 v[84:87], v[108:111], v[156:159], v[84:87]
    v_mfma_f32_16x16x32_bf16 v[80:83], v[108:111], v[152:155], v[80:83]
    ds_read_b128 v[108:111], v66 offset:2240
    s_waitcnt lgkmcnt(2)
    v_mfma_f32_16x16x32_bf16 v[104:107], v[112:115], v[172:175], v[104:107]
    v_mfma_f32_16x16x32_bf16 v[100:103], v[112:115], v[168:171], v[100:103]
    v_mfma_f32_16x16x32_bf16 v[96:99], v[112:115], v[164:167], v[96:99]
    v_mfma_f32_16x16x32_bf16 v[92:95], v[112:115], v[160:163], v[92:95]
    v_mfma_f32_16x16x32_bf16 v[88:91], v[112:115], v[156:159], v[88:91]
    v_mfma_f32_16x16x32_bf16 v[84:87], v[112:115], v[152:155], v[84:87]
    ds_read_b128 v[112:115], v66 offset:2752
    s_waitcnt lgkmcnt(2)
    v_mfma_f32_16x16x32_bf16 v[104:107], v[116:119], v[168:171], v[104:107]
    v_mfma_f32_16x16x32_bf16 v[100:103], v[116:119], v[164:167], v[100:103]
    v_mfma_f32_16x16x32_bf16 v[96:99], v[116:119], v[160:163], v[96:99]
    v_mfma_f32_16x16x32_bf16 v[92:95], v[116:119], v[156:159], v[92:95]
    v_mfma_f32_16x16x32_bf16 v[88:91], v[116:119], v[152:155], v[88:91]
    ds_read_b128 v[116:119], v66 offset:3264
    s_waitcnt lgkmcnt(2)
    v_mfma_f32_16x16x32_bf16 v[104:107], v[108:111], v[164:167], v[104:107]
    v_mfma_f32_16x16x32_bf16 v[100:103], v[108:111], v[160:163], v[100:103]
    v_mfma_f32_16x16x32_bf16 v[96:99], v[108:111], v[156:159], v[96:99]
    v_mfma_f32_16x16x32_bf16 v[92:95], v[108:111], v[152:155], v[92:95]
    ds_read_b128 v[108:111], v66 offset:3776
    s_waitcnt lgkmcnt(2)
    v_mfma_f32_16x16x32_bf16 v[104:107], v[112:115], v[160:163], v[104:107]
    v_mfma_f32_16x16x32_bf16 v[100:103], v[112:115], v[156:159], v[100:103]
    v_mfma_f32_16x16x32_bf16 v[96:99], v[112:115], v[152:155], v[96:99]
    s_waitcnt lgkmcnt(1)
    v_mfma_f32_16x16x32_bf16 v[104:107], v[116:119], v[156:159], v[104:107]
    v_mfma_f32_16x16x32_bf16 v[100:103], v[116:119], v[152:155], v[100:103]
    s_waitcnt lgkmcnt(0)
    v_mfma_f32_16x16x32_bf16 v[104:107], v[108:111], v[152:155], v[104:107]
    ds_write_b128 v74, v[76:79] offset:0
    ds_write_b128 v74, v[80:83] offset:1024
    ds_write_b128 v74, v[84:87] offset:2048
    ds_write_b128 v74, v[88:91] offset:3072
    ds_write_b128 v74, v[92:95] offset:4096
    ds_write_b128 v74, v[96:99] offset:5120
    ds_write_b128 v74, v[100:103] offset:6144
    s_nop 0
    ds_write_b128 v74, v[104:107] offset:7168
    s_branch c_pw_end_35
c_pw_37:
    s_cmp_lg_u32 s34, 2
    s_cbranch_scc1 c_pw_38
    ds_read_b128 v[108:111], v66 offset:256
    ds_read_b128 v[120:123], v67 offset:224
    ds_read_b128 v[124:127], v67 offset:736
    ds_read_b128 v[128:131], v67 offset:1248
    ds_read_b128 v[132:135], v67 offset:1760
    ds_read_b128 v[136:139], v67 offset:2272
    ds_read_b128 v[140:143], v67 offset:2784
    ds_read_b128 v[144:147], v67 offset:3296
    ds_read_b128 v[148:151], v67 offset:3808
    ds_read_b128 v[112:115], v66 offset:768
    ds_read_b128 v[116:119], v66 offset:1280
    s_waitcnt lgkmcnt(2)
    v_mfma_f32_16x16x32_bf16 v[104:107], v[108:111], v[148:151], 0
    v_mfma_f32_16x16x32_bf16 v[100:103], v[108:111], v[144:147], 0
    v_mfma_f32_16x16x32_bf16 v[96:99], v[108:111], v[140:143], 0
    v_mfma_f32_16x16x32_bf16 v[92:95], v[108:111], v[136:139], 0
    v_mfma_f32_16x16x32_bf16 v[88:91], v[108:111], v[132:135], 0
    v_mfma_f32_16x16x32_bf16 v[84:87], v[108:111], v[128:131], 0
    v_mfma_f32_16x16x32_bf16 v[80:83], v[108:111], v[124:127], 0
    v_mfma_f32_16x16x32_bf16 v[76:79], v[108:111], v[120:123], 0
    ds_read_b128 v[108:111], v66 offset:1792
    s_waitcnt lgkmcnt(2)
    v_mfma_f32_16x16x32_bf16 v[104:107], v[112:115], v[144:147], v[104:107]
    v_mfma_f32_16x16x32_bf16 v[100:103], v[112:115], v[140:143], v[100:103]
    v_mfma_f32_16x16x32_bf16 v[96:99], v[112:115], v[136:139], v[96:99]
    v_mfma_f32_16x16x32_bf16 v[92:95], v[112:115], v[132:135], v[92:95]
    v_mfma_f32_16x16x32_bf16 v[88:91], v[112:115], v[128:131], v[88:91]
    v_mfma_f32_16x16x32_bf16 v[84:87], v[112:115], v[124:127], v[84:87]
    v_mfma_f32_16x16x32_bf16 v[80:83], v[112:115], v[120:123], v[80:83]
    ds_read_b128 v[112:115], v66 offset:2304
    ds_read_b128 v[152:155], v67 offset:160
    ds_read_b128 v[156:159], v67 offset:672
    ds_read_b128 v[160:163], v67 offset:1184
    ds_read_b128 v[164:167], v67 offset:1696
    ds_read_b128 v[168:171], v67 offset:2208
    ds_read_b128 v[172:175], v67 offset:2720
    ds_read_b128 v[176:179], v67 offset:3232
    ds_read_b128 v[180:183], v67 offset:3744
    s_waitcnt lgkmcnt(10)
    v_mfma_f32_16x16x32_bf16 v[104:107], v[116:119], v[140:143], v[104:107]
    v_mfma_f32_16x16x32_bf16 v[100:103], v[116:119], v[136:139], v[100:103]
    v_mfma_f32_16x16x32_bf16 v[96:99], v[116:119], v[132:135], v[96:99]
    v_mfma_f32_16x16x32_bf16 v[92:95], v[116:119], v[128:131], v[92:95]
    v_mfma_f32_16x16x32_bf16 v[88:91], v[116:119], v[124:127], v[88:91]
    v_mfma_f32_16x16x32_bf16 v[84:87], v[116:119], v[120:123], v[84:87]
    ds_read_b128 v[116:119], v66 offset:2816
    s_waitcnt lgkmcnt(10)
    v_mfma_f32_16x16x32_bf16 v[104:107], v[108:111], v[136:139], v[104:107]
    v_mfma_f32_16x16x32_bf16 v[100:103], v[108:111], v[132:135], v[100:103]
    v_mfma_f32_16x16x32_bf16 v[96:99], v[108:111], v[128:131], v[96:99]
    v_mfma_f32_16x16x32_bf16 v[92:95], v[108:111], v[124:127], v[92:95]
    v_mfma_f32_16x16x32_bf16 v[88:91], v[108:111], v[120:123], v[88:91]
    ds_read_b128 v[108:111], v66 offset:3328
    s_waitcnt lgkmcnt(10)
    v_mfma_f32_16x16x32_bf16 v[104:107], v[112:115], v[132:135], v[104:107]
    v_mfma_f32_16x16x32_bf16 v[100:103], v[112:115], v[128:131], v[100:103]
    v_mfma_f32_16x16x32_bf16 v[96:99], v[112:115], v[124:127], v[96:99]
    v_mfma_f32_16x16x32_bf16 v[92:95], v[112:115], v[120:123], v[92:95]
    ds_read_b128 v[112:115], v66 offset:3840
    s_waitcnt lgkmcnt(2)
    v_mfma_f32_16x16x32_bf16 v[104:107], v[116:119], v[128:131], v[104:107]
    v_mfma_f32_16x16x32_bf16 v[100:103], v[116:119], v[124:127], v[100:103]
    v_mfma_f32_16x16x32_bf16 v[96:99], v[116:119], v[120:123], v[96:99]
    ds_read_b128 v[116:119], v66 offset:320
    s_waitcnt lgkmcnt(2)
    v_mfma_f32_16x16x32_bf16 v[104:107], v[108:111], v[124:127], v[104:107]
    v_mfma_f32_16x16x32_bf16 v[100:103], v[108:111], v[120:123], v[100:103]
    ds_read_b128 v[108:111], v66 offset:832
    s_waitcnt lgkmcnt(2)
    v_mfma_f32_16x16x32_bf16 v[104:107], v[112:115], v[120:123], v[104:107]
    ds_read_b128 v[112:115], v66 offset:1344
    s_waitcnt lgkmcnt(2)
    v_mfma_f32_16x16x32_bf16 v[104:107], v[116:119], v[180:183], v[104:107]
    v_mfma_f32_16x16x32_bf16 v[100:103], v[116:119], v[176:179], v[100:103]
    v_mfma_f32_16x16x32_bf16 v[96:99], v[116:119], v[172:175], v[96:99]
    v_mfma_f32_16x16x32_bf16 v[92:95], v[116:119], v[168:171], v[92:95]
    v_mfma_f32_16x16x32_bf16 v[88:91], v[116:119], v[164:167], v[88:91]
    v_mfma_f32_16x16x32_bf16 v[84:87], v[116:119], v[160:163], v[84:87]
    v_mfma_f32_16x16x32_bf16 v[80:83], v[116:119], v[156:159], v[80:83]
    v_mfma_f32_16x16x32_bf16 v[76:79], v[116:119], v[152:155], v[76:79]
    ds_read_b128 v[116:119], v66 offset:1856
    s_waitcnt lgkmcnt(2)
    v_mfma_f32_16x16x32_bf16 v[104:107], v[108:111], v[176:179], v[104:107]
    v_mfma_f32_16x16x32_bf16 v[100:103], v[108:111], v[172:175], v[100:103]
    v_mfma_f32_16x16x32_bf16 v[96:99], v[108:111], v[168:171], v[96:99]
    v_mfma_f32_16x16x32_bf16 v[92:95], v[108:111], v[164:167], v[92:95]
    v_mfma_f32_16x16x32_bf16 v[88:91], v[108:111], v[160:163], v[88:91]
    v_mfma_f32_16x16x32_bf16 v[84:87], v[108:111], v[156:159], v[84:87]
    v_mfma_f32_16x16x32_bf16 v[80:83], v[108:111], v[152:155], v[80:83]
    ds_read_b128 v[108:111], v66 offset:2368
    s_waitcnt lgkmcnt(2)
    v_mfma_f32_16x16x32_bf16 v[104:107], v[112:115], v[172:175], v[104:107]
    v_mfma_f32_16x16x32_bf16 v[100:103], v[112:115], v[168:171], v[100:103]
    v_mfma_f32_16x16x32_bf16 v[96:99], v[112:115], v[164:167], v[96:99]
    v_mfma_f32_16x16x32_bf16 v[92:95], v[112:115], v[160:163], v[92:95]
    v_mfma_f32_16x16x32_bf16 v[88:91], v[112:115], v[156:159], v[88:91]
    v_mfma_f32_16x16x32_bf16 v[84:87], v[112:115], v[152:155], v[84:87]
    ds_read_b128 v[112:115], v66 offset:2880
    s_waitcnt lgkmcnt(2)
    v_mfma_f32_16x16x32_bf16 v[104:107], v[116:119], v[168:171], v[104:107]
    v_mfma_f32_16x16x32_bf16 v[100:103], v[116:119], v[164:167], v[100:103]
    v_mfma_f32_16x16x32_bf16 v[96:99], v[116:119], v[160:163], v[96:99]
    v_mfma_f32_16x16x32_bf16 v[92:95], v[116:119], v[156:159], v[92:95]
    v_mfma_f32_16x16x32_bf16 v[88:91], v[116:119], v[152:155], v[88:91]
    ds_read_b128 v[116:119], v66 offset:3392
    s_waitcnt lgkmcnt(2)
    v_mfma_f32_16x16x32_bf16 v[104:107], v[108:111], v[164:167], v[104:107]
    v_mfma_f32_16x16x32_bf16 v[100:103], v[108:111], v[160:163], v[100:103]
    v_mfma_f32_16x16x32_bf16 v[96:99], v[108:111], v[156:159], v[96:99]
    v_mfma_f32_16x16x32_bf16 v[92:95], v[108:111], v[152:155], v[92:95]
    ds_read_b128 v[108:111], v66 offset:3904
    s_waitcnt lgkmcnt(2)
    v_mfma_f32_16x16x32_bf16 v[104:107], v[112:115], v[160:163], v[104:107]
    v_mfma_f32_16x16x32_bf16 v[100:103], v[112:115], v[156:159], v[100:103]
    v_mfma_f32_16x16x32_bf16 v[96:99], v[112:115], v[152:155], v[96:99]
    s_waitcnt lgkmcnt(1)
    v_mfma_f32_16x16x32_bf16 v[104:107], v[116:119], v[156:159], v[104:107]
    v_mfma_f32_16x16x32_bf16 v[100:103], v[116:119], v[152:155], v[100:103]
    s_waitcnt lgkmcnt(0)
    v_mfma_f32_16x16x32_bf16 v[104:107], v[108:111], v[152:155], v[104:107]
    ds_write_b128 v74, v[76:79] offset:0
    ds_write_b128 v74, v[80:83] offset:1024
    ds_write_b128 v74, v[84:87] offset:2048
    ds_write_b128 v74, v[88:91] offset:3072
    ds_write_b128 v74, v[92:95] offset:4096
    ds_write_b128 v74, v[96:99] offset:5120
    ds_write_b128 v74, v[100:103] offset:6144
    s_nop 0
    ds_write_b128 v74, v[104:107] offset:7168
    s_branch c_pw_end_35
c_pw_38:
    ds_read_b128 v[108:111], v66 offset:384
    ds_read_b128 v[120:123], v67 offset:96
    ds_read_b128 v[124:127], v67 offset:608
    ds_read_b128 v[128:131], v67 offset:1120
    ds_read_b128 v[132:135], v67 offset:1632
    ds_read_b128 v[136:139], v67 offset:2144
    ds_read_b128 v[140:143], v67 offset:2656
    ds_read_b128 v[144:147], v67 offset:3168
    ds_read_b128 v[148:151], v67 offset:3680
    ds_read_b128 v[112:115], v66 offset:896
    ds_read_b128 v[116:119], v66 offset:1408
    s_waitcnt lgkmcnt(2)
    v_mfma_f32_16x16x32_bf16 v[104:107], v[108:111], v[148:151], 0
    v_mfma_f32_16x16x32_bf16 v[100:103], v[108:111], v[144:147], 0
    v_mfma_f32_16x16x32_bf16 v[96:99], v[108:111], v[140:143], 0
    v_mfma_f32_16x16x32_bf16 v[92:95], v[108:111], v[136:139], 0
    v_mfma_f32_16x16x32_bf16 v[88:91], v[108:111], v[132:135], 0
    v_mfma_f32_16x16x32_bf16 v[84:87], v[108:111], v[128:131], 0
    v_mfma_f32_16x16x32_bf16 v[80:83], v[108:111], v[124:127], 0
    v_mfma_f32_16x16x32_bf16 v[76:79], v[108:111], v[120:123], 0
    ds_read_b128 v[108:111], v66 offset:1920
    s_waitcnt lgkmcnt(2)
    v_mfma_f32_16x16x32_bf16 v[104:107], v[112:115], v[144:147], v[104:107]
    v_mfma_f32_16x16x32_bf16 v[100:103], v[112:115], v[140:143], v[100:103]
    v_mfma_f32_16x16x32_bf16 v[96:99], v[112:115], v[136:139], v[96:99]
    v_mfma_f32_16x16x32_bf16 v[92:95], v[112:115], v[132:135], v[92:95]
    v_mfma_f32_16x16x32_bf16 v[88:91], v[112:115], v[128:131], v[88:91]
    v_mfma_f32_16x16x32_bf16 v[84:87], v[112:115], v[124:127], v[84:87]
    v_mfma_f32_16x16x32_bf16 v[80:83], v[112:115], v[120:123], v[80:83]
    ds_read_b128 v[112:115], v66 offset:2432
    ds_read_b128 v[152:155], v67 offset:32
    ds_read_b128 v[156:159], v67 offset:544
    ds_read_b128 v[160:163], v67 offset:1056
    ds_read_b128 v[164:167], v67 offset:1568
    ds_read_b128 v[168:171], v67 offset:2080
    ds_read_b128 v[172:175], v67 offset:2592
    ds_read_b128 v[176:179], v67 offset:3104
    ds_read_b128 v[180:183], v67 offset:3616
    s_waitcnt lgkmcnt(10)
    v_mfma_f32_16x16x32_bf16 v[104:107], v[116:119], v[140:143], v[104:107]
    v_mfma_f32_16x16x32_bf16 v[100:103], v[116:119], v[136:139], v[100:103]
    v_mfma_f32_16x16x32_bf16 v[96:99], v[116:119], v[132:135], v[96:99]
    v_mfma_f32_16x16x32_bf16 v[92:95], v[116:119], v[128:131], v[92:95]
    v_mfma_f32_16x16x32_bf16 v[88:91], v[116:119], v[124:127], v[88:91]
    v_mfma_f32_16x16x32_bf16 v[84:87], v[116:119], v[120:123], v[84:87]
    ds_read_b128 v[116:119], v66 offset:2944
    s_waitcnt lgkmcnt(10)
    v_mfma_f32_16x16x32_bf16 v[104:107], v[108:111], v[136:139], v[104:107]
    v_mfma_f32_16x16x32_bf16 v[100:103], v[108:111], v[132:135], v[100:103]
    v_mfma_f32_16x16x32_bf16 v[96:99], v[108:111], v[128:131], v[96:99]
    v_mfma_f32_16x16x32_bf16 v[92:95], v[108:111], v[124:127], v[92:95]
    v_mfma_f32_16x16x32_bf16 v[88:91], v[108:111], v[120:123], v[88:91]
    ds_read_b128 v[108:111], v66 offset:3456
    s_waitcnt lgkmcnt(10)
    v_mfma_f32_16x16x32_bf16 v[104:107], v[112:115], v[132:135], v[104:107]
    v_mfma_f32_16x16x32_bf16 v[100:103], v[112:115], v[128:131], v[100:103]
    v_mfma_f32_16x16x32_bf16 v[96:99], v[112:115], v[124:127], v[96:99]
    v_mfma_f32_16x16x32_bf16 v[92:95], v[112:115], v[120:123], v[92:95]
    ds_read_b128 v[112:115], v66 offset:3968
    s_waitcnt lgkmcnt(2)
    v_mfma_f32_16x16x32_bf16 v[104:107], v[116:119], v[128:131], v[104:107]
    v_mfma_f32_16x16x32_bf16 v[100:103], v[116:119], v[124:127], v[100:103]
    v_mfma_f32_16x16x32_bf16 v[96:99], v[116:119], v[120:123], v[96:99]
    ds_read_b128 v[116:119], v66 offset:448
    s_waitcnt lgkmcnt(2)
    v_mfma_f32_16x16x32_bf16 v[104:107], v[108:111], v[124:127], v[104:107]
    v_mfma_f32_16x16x32_bf16 v[100:103], v[108:111], v[120:123], v[100:103]
    ds_read_b128 v[108:111], v66 offset:960
    s_waitcnt lgkmcnt(2)
    v_mfma_f32_16x16x32_bf16 v[104:107], v[112:115], v[120:123], v[104:107]
    ds_read_b128 v[112:115], v66 offset:1472
    s_waitcnt lgkmcnt(2)
    v_mfma_f32_16x16x32_bf16 v[104:107], v[116:119], v[180:183], v[104:107]
    v_mfma_f32_16x16x32_bf16 v[100:103], v[116:119], v[176:179], v[100:103]
    v_mfma_f32_16x16x32_bf16 v[96:99], v[116:119], v[172:175], v[96:99]
    v_mfma_f32_16x16x32_bf16 v[92:95], v[116:119], v[168:171], v[92:95]
    v_mfma_f32_16x16x32_bf16 v[88:91], v[116:119], v[164:167], v[88:91]
    v_mfma_f32_16x16x32_bf16 v[84:87], v[116:119], v[160:163], v[84:87]
    v_mfma_f32_16x16x32_bf16 v[80:83], v[116:119], v[156:159], v[80:83]
    v_mfma_f32_16x16x32_bf16 v[76:79], v[116:119], v[152:155], v[76:79]
    ds_read_b128 v[116:119], v66 offset:1984
    s_waitcnt lgkmcnt(2)
    v_mfma_f32_16x16x32_bf16 v[104:107], v[108:111], v[176:179], v[104:107]
    v_mfma_f32_16x16x32_bf16 v[100:103], v[108:111], v[172:175], v[100:103]
    v_mfma_f32_16x16x32_bf16 v[96:99], v[108:111], v[168:171], v[96:99]
    v_mfma_f32_16x16x32_bf16 v[92:95], v[108:111], v[164:167], v[92:95]
    v_mfma_f32_16x16x32_bf16 v[88:91], v[108:111], v[160:163], v[88:91]
    v_mfma_f32_16x16x32_bf16 v[84:87], v[108:111], v[156:159], v[84:87]
    v_mfma_f32_16x16x32_bf16 v[80:83], v[108:111], v[152:155], v[80:83]
    ds_read_b128 v[108:111], v66 offset:2496
    s_waitcnt lgkmcnt(2)
    v_mfma_f32_16x16x32_bf16 v[104:107], v[112:115], v[172:175], v[104:107]
    v_mfma_f32_16x16x32_bf16 v[100:103], v[112:115], v[168:171], v[100:103]
    v_mfma_f32_16x16x32_bf16 v[96:99], v[112:115], v[164:167], v[96:99]
    v_mfma_f32_16x16x32_bf16 v[92:95], v[112:115], v[160:163], v[92:95]
    v_mfma_f32_16x16x32_bf16 v[88:91], v[112:115], v[156:159], v[88:91]
    v_mfma_f32_16x16x32_bf16 v[84:87], v[112:115], v[152:155], v[84:87]
    ds_read_b128 v[112:115], v66 offset:3008
    s_waitcnt lgkmcnt(2)
    v_mfma_f32_16x16x32_bf16 v[104:107], v[116:119], v[168:171], v[104:107]
    v_mfma_f32_16x16x32_bf16 v[100:103], v[116:119], v[164:167], v[100:103]
    v_mfma_f32_16x16x32_bf16 v[96:99], v[116:119], v[160:163], v[96:99]
    v_mfma_f32_16x16x32_bf16 v[92:95], v[116:119], v[156:159], v[92:95]
    v_mfma_f32_16x16x32_bf16 v[88:91], v[116:119], v[152:155], v[88:91]
    ds_read_b128 v[116:119], v66 offset:3520
    s_waitcnt lgkmcnt(2)
    v_mfma_f32_16x16x32_bf16 v[104:107], v[108:111], v[164:167], v[104:107]
    v_mfma_f32_16x16x32_bf16 v[100:103], v[108:111], v[160:163], v[100:103]
    v_mfma_f32_16x16x32_bf16 v[96:99], v[108:111], v[156:159], v[96:99]
    v_mfma_f32_16x16x32_bf16 v[92:95], v[108:111], v[152:155], v[92:95]
    ds_read_b128 v[108:111], v66 offset:4032
    s_waitcnt lgkmcnt(2)
    v_mfma_f32_16x16x32_bf16 v[104:107], v[112:115], v[160:163], v[104:107]
    v_mfma_f32_16x16x32_bf16 v[100:103], v[112:115], v[156:159], v[100:103]
    v_mfma_f32_16x16x32_bf16 v[96:99], v[112:115], v[152:155], v[96:99]
    s_waitcnt lgkmcnt(1)
    v_mfma_f32_16x16x32_bf16 v[104:107], v[116:119], v[156:159], v[104:107]
    v_mfma_f32_16x16x32_bf16 v[100:103], v[116:119], v[152:155], v[100:103]
    s_waitcnt lgkmcnt(0)
    v_mfma_f32_16x16x32_bf16 v[104:107], v[108:111], v[152:155], v[104:107]
    ds_write_b128 v74, v[76:79] offset:0
    ds_write_b128 v74, v[80:83] offset:1024
    ds_write_b128 v74, v[84:87] offset:2048
    ds_write_b128 v74, v[88:91] offset:3072
    ds_write_b128 v74, v[92:95] offset:4096
    ds_write_b128 v74, v[96:99] offset:5120
    ds_write_b128 v74, v[100:103] offset:6144
    s_nop 0
    ds_write_b128 v74, v[104:107] offset:7168
c_pw_end_35:
    s_waitcnt lgkmcnt(0)
    v_mov_b32 v3, 161796
    v_mov_b32 v4, 1
    s_mov_b64 exec, 1
    ds_add_u32 v3, v4
    s_mov_b64 exec, -1
    s_mov_b32 s67, 0
gsync_40:
    ds_read_b32 v4, v3
    s_add_u32 s67, s67, 1
    s_waitcnt lgkmcnt(0)
    v_readfirstlane_b32 s66, v4
    s_cmp_gt_u32 s67, 1000000
    s_cbranch_scc1 gsync_e_41
    s_cmp_lt_u32 s66, 8
    s_cbranch_scc1 gsync_40
gsync_e_41:
    ds_read_b128 v[120:123], v75 offset:0
    ds_read_b128 v[124:127], v75 offset:16
    ds_read_b128 v[128:131], v75 offset:8192
    ds_read_b128 v[132:135], v75 offset:8208
    ds_read_b128 v[136:139], v75 offset:16384
    ds_read_b128 v[140:143], v75 offset:16400
    ds_read_b128 v[144:147], v75 offset:24576
    ds_read_b128 v[148:151], v75 offset:24592
    s_lshl_b32 s40, s56, 12
    s_add_u32 s40, s40, 8912896
    s_waitcnt lgkmcnt(0)
    v_pk_add_f32 v[120:121], v[120:121], v[128:129]
    v_pk_add_f32 v[136:137], v[136:137], v[144:145]
    v_pk_add_f32 v[122:123], v[122:123], v[130:131]
    v_pk_add_f32 v[138:139], v[138:139], v[146:147]
    v_pk_add_f32 v[124:125], v[124:125], v[132:133]
    v_pk_add_f32 v[140:141], v[140:141], v[148:149]
    v_pk_add_f32 v[126:127], v[126:127], v[134:135]
    v_pk_add_f32 v[142:143], v[142:143], v[150:151]
    v_pk_add_f32 v[120:121], v[120:121], v[136:137]
    v_pk_add_f32 v[122:123], v[122:123], v[138:139]
    v_pk_add_f32 v[124:125], v[124:125], v[140:141]
    v_pk_add_f32 v[126:127], v[126:127], v[142:143]
    v_cvt_pk_bf16_f32 v192, v120, v121
    v_cvt_pk_bf16_f32 v193, v122, v123
    v_cvt_pk_bf16_f32 v194, v124, v125
    v_cvt_pk_bf16_f32 v195, v126, v127
    buffer_store_dwordx4 v[192:195], v2, s[8:11], s40 offen sc1
    s_nop 1
    s_waitcnt vmcnt(1)
    v_cmp_ne_u32 vcc, 0, v0
    s_nop 1
    v_cndmask_b32 v16, 0, v16, vcc
    v_cndmask_b32 v17, 0, v17, vcc
    v_cndmask_b32 v18, 0, v18, vcc
    v_cndmask_b32 v19, 0, v19, vcc
    v_alignbit_b32 v184, v17, v16, 16
    v_alignbit_b32 v185, v18, v17, 16
    v_alignbit_b32 v186, v19, v18, 16
    v_alignbit_b32 v187, v20, v19, 16
    v_alignbit_b32 v188, v21, v20, 16
    v_alignbit_b32 v189, v22, v21, 16
    v_alignbit_b32 v190, v23, v22, 16
    ds_write_b128 v64, v[184:187] offset:0
    v_mov_b32 v192, v17
    v_mov_b32 v193, v18
    v_mov_b32 v194, v19
    v_mov_b32 v195, v20
    ds_write_b128 v64, v[192:195] offset:4160
    s_nop 1
    v_mov_b32 v192, v185
    v_mov_b32 v193, v186
    v_mov_b32 v194, v187
    v_mov_b32 v195, v188
    ds_write_b128 v64, v[192:195] offset:8320
    s_nop 1
    ds_write_b128 v64, v[18:21] offset:12480
    ds_write_b128 v64, v[186:189] offset:16640
    v_mov_b32 v192, v19
    v_mov_b32 v193, v20
    v_mov_b32 v194, v21
    v_mov_b32 v195, v22
    ds_write_b128 v64, v[192:195] offset:20800
    s_nop 1
    v_mov_b32 v192, v187
    v_mov_b32 v193, v188
    v_mov_b32 v194, v189
    v_mov_b32 v195, v190
    ds_write_b128 v64, v[192:195] offset:24960
    s_nop 1
    ds_write_b128 v64, v[20:23] offset:29120
    ds_write_b128 v65, v[36:39]
    v_lshlrev_b32 v3, 16, v45
    v_or_b32 v3, v3, v45
    v_and_b32 v196, v68, v3
    v_and_b32 v197, v69, v3
    v_and_b32 v198, v70, v3
    v_and_b32 v199, v71, v3
    s_waitcnt lgkmcnt(0)
    v_mov_b32 v3, 161796
    v_mov_b32 v4, 1
    s_mov_b64 exec, 1
    ds_add_u32 v3, v4
    s_mov_b64 exec, -1
    s_mov_b32 s67, 0
gsync_42:
    ds_read_b32 v4, v3
    s_add_u32 s67, s67, 1
    s_waitcnt lgkmcnt(0)
    v_readfirstlane_b32 s66, v4
    s_cmp_gt_u32 s67, 1000000
    s_cbranch_scc1 gsync_e_43
    s_cmp_lt_u32 s66, 12
    s_cbranch_scc1 gsync_42
gsync_e_43:
    s_cmp_ge_u32 s2, 192
    s_cbranch_scc1 c_wj3_44
    v_lshrrev_b32 v3, 4, v1
    v_and_b32 v5, 15, v1
    v_lshrrev_b32 v4, 2, v5
    v_lshl_add_u32 v3, v3, 2, v4
    v_mul_u32_u24 v3, 160, v3
    v_and_b32 v4, 3, v5
    v_lshl_add_u32 v3, v4, 3, v3
    v_lshlrev_b32 v5, 4, v1
    s_lshl_b32 s40, s34, 5
    s_add_u32 s41, s40, 156672
    v_add_u32 v4, s41, v3
    ds_read_b64_tr_b16 v[192:193], v4
    ds_read_b64_tr_b16 v[194:195], v4 offset:2560
    s_mul_i32 s41, s2, 5120
    s_lshl_b32 s40, s40, 5
    s_add_u32 s41, s41, s40
    s_add_u32 s41, s41, 15007744
    s_waitcnt lgkmcnt(0)
    buffer_store_dwordx4 v[192:195], v5, s[8:11], s41 offen sc1
    s_nop 1
    s_cmp_lg_u32 s34, 0
    s_cbranch_scc1 c_wj4_45
    s_mov_b32 s40, 128
    s_add_u32 s41, s40, 156672
    v_add_u32 v4, s41, v3
    ds_read_b64_tr_b16 v[192:193], v4
    ds_read_b64_tr_b16 v[194:195], v4 offset:2560
    s_mul_i32 s41, s2, 5120
    s_lshl_b32 s40, s40, 5
    s_add_u32 s41, s41, s40
    s_add_u32 s41, s41, 15007744
    s_waitcnt lgkmcnt(0)
    buffer_store_dwordx4 v[192:195], v5, s[8:11], s41 offen sc1
    s_nop 1
c_wj4_45:
c_wj3_44:
    s_cmp_lg_u32 s34, 0
    s_cbranch_scc1 c_pw_47
    ds_read_b128 v[108:111], v66 offset:0
    ds_read_b128 v[120:123], v67 offset:480
    ds_read_b128 v[124:127], v67 offset:992
    ds_read_b128 v[128:131], v67 offset:1504
    ds_read_b128 v[132:135], v67 offset:2016
    ds_read_b128 v[136:139], v67 offset:2528
    ds_read_b128 v[140:143], v67 offset:3040
    ds_read_b128 v[144:147], v67 offset:3552
    ds_read_b128 v[148:151], v67 offset:4064
    ds_read_b128 v[112:115], v66 offset:512
    ds_read_b128 v[116:119], v66 offset:1024
    s_waitcnt lgkmcnt(2)
    v_mfma_f32_16x16x32_bf16 v[104:107], v[108:111], v[148:151], 0
    v_mfma_f32_16x16x32_bf16 v[100:103], v[108:111], v[144:147], 0
    v_mfma_f32_16x16x32_bf16 v[96:99], v[108:111], v[140:143], 0
    v_mfma_f32_16x16x32_bf16 v[92:95], v[108:111], v[136:139], 0
    v_mfma_f32_16x16x32_bf16 v[88:91], v[108:111], v[132:135], 0
    v_mfma_f32_16x16x32_bf16 v[84:87], v[108:111], v[128:131], 0
    v_mfma_f32_16x16x32_bf16 v[80:83], v[108:111], v[124:127], 0
    v_mfma_f32_16x16x32_bf16 v[76:79], v[108:111], v[120:123], 0
    v_mfma_f32_16x16x32_bf16 v[76:79], v[196:199], v[120:123], v[76:79]
    v_mfma_f32_16x16x32_bf16 v[80:83], v[196:199], v[124:127], v[80:83]
    v_mfma_f32_16x16x32_bf16 v[84:87], v[196:199], v[128:131], v[84:87]
    v_mfma_f32_16x16x32_bf16 v[88:91], v[196:199], v[132:135], v[88:91]
    v_mfma_f32_16x16x32_bf16 v[92:95], v[196:199], v[136:139], v[92:95]
    v_mfma_f32_16x16x32_bf16 v[96:99], v[196:199], v[140:143], v[96:99]
    v_mfma_f32_16x16x32_bf16 v[100:103], v[196:199], v[144:147], v[100:103]
    v_mfma_f32_16x16x32_bf16 v[104:107], v[196:199], v[148:151], v[104:107]
    ds_read_b128 v[108:111], v66 offset:1536
    s_waitcnt lgkmcnt(2)
    v_mfma_f32_16x16x32_bf16 v[104:107], v[112:115], v[144:147], v[104:107]
    v_mfma_f32_16x16x32_bf16 v[100:103], v[112:115], v[140:143], v[100:103]
    v_mfma_f32_16x16x32_bf16 v[96:99], v[112:115], v[136:139], v[96:99]
    v_mfma_f32_16x16x32_bf16 v[92:95], v[112:115], v[132:135], v[92:95]
    v_mfma_f32_16x16x32_bf16 v[88:91], v[112:115], v[128:131], v[88:91]
    v_mfma_f32_16x16x32_bf16 v[84:87], v[112:115], v[124:127], v[84:87]
    v_mfma_f32_16x16x32_bf16 v[80:83], v[112:115], v[120:123], v[80:83]
    ds_read_b128 v[112:115], v66 offset:2048
    ds_read_b128 v[152:155], v67 offset:416
    ds_read_b128 v[156:159], v67 offset:928
    ds_read_b128 v[160:163], v67 offset:1440
    ds_read_b128 v[164:167], v67 offset:1952
    ds_read_b128 v[168:171], v67 offset:2464
    ds_read_b128 v[172:175], v67 offset:2976
    ds_read_b128 v[176:179], v67 offset:3488
    ds_read_b128 v[180:183], v67 offset:4000
    s_waitcnt lgkmcnt(10)
    v_mfma_f32_16x16x32_bf16 v[104:107], v[116:119], v[140:143], v[104:107]
    v_mfma_f32_16x16x32_bf16 v[100:103], v[116:119], v[136:139], v[100:103]
    v_mfma_f32_16x16x32_bf16 v[96:99], v[116:119], v[132:135], v[96:99]
    v_mfma_f32_16x16x32_bf16 v[92:95], v[116:119], v[128:131], v[92:95]
    v_mfma_f32_16x16x32_bf16 v[88:91], v[116:119], v[124:127], v[88:91]
    v_mfma_f32_16x16x32_bf16 v[84:87], v[116:119], v[120:123], v[84:87]
    ds_read_b128 v[116:119], v66 offset:2560
    s_waitcnt lgkmcnt(10)
    v_mfma_f32_16x16x32_bf16 v[104:107], v[108:111], v[136:139], v[104:107]
    v_mfma_f32_16x16x32_bf16 v[100:103], v[108:111], v[132:135], v[100:103]
    v_mfma_f32_16x16x32_bf16 v[96:99], v[108:111], v[128:131], v[96:99]
    v_mfma_f32_16x16x32_bf16 v[92:95], v[108:111], v[124:127], v[92:95]
    v_mfma_f32_16x16x32_bf16 v[88:91], v[108:111], v[120:123], v[88:91]
    ds_read_b128 v[108:111], v66 offset:3072
    s_waitcnt lgkmcnt(10)
    v_mfma_f32_16x16x32_bf16 v[104:107], v[112:115], v[132:135], v[104:107]
    v_mfma_f32_16x16x32_bf16 v[100:103], v[112:115], v[128:131], v[100:103]
    v_mfma_f32_16x16x32_bf16 v[96:99], v[112:115], v[124:127], v[96:99]
    v_mfma_f32_16x16x32_bf16 v[92:95], v[112:115], v[120:123], v[92:95]
    ds_read_b128 v[112:115], v66 offset:3584
    s_waitcnt lgkmcnt(2)
    v_mfma_f32_16x16x32_bf16 v[104:107], v[116:119], v[128:131], v[104:107]
    v_mfma_f32_16x16x32_bf16 v[100:103], v[116:119], v[124:127], v[100:103]
    v_mfma_f32_16x16x32_bf16 v[96:99], v[116:119], v[120:123], v[96:99]
    ds_read_b128 v[116:119], v66 offset:64
    s_waitcnt lgkmcnt(2)
    v_mfma_f32_16x16x32_bf16 v[104:107], v[108:111], v[124:127], v[104:107]
    v_mfma_f32_16x16x32_bf16 v[100:103], v[108:111], v[120:123], v[100:103]
    ds_read_b128 v[108:111], v66 offset:576
    s_waitcnt lgkmcnt(2)
    v_mfma_f32_16x16x32_bf16 v[104:107], v[112:115], v[120:123], v[104:107]
    ds_read_b128 v[112:115], v66 offset:1088
    s_waitcnt lgkmcnt(2)
    v_mfma_f32_16x16x32_bf16 v[104:107], v[116:119], v[180:183], v[104:107]
    v_mfma_f32_16x16x32_bf16 v[100:103], v[116:119], v[176:179], v[100:103]
    v_mfma_f32_16x16x32_bf16 v[96:99], v[116:119], v[172:175], v[96:99]
    v_mfma_f32_16x16x32_bf16 v[92:95], v[116:119], v[168:171], v[92:95]
    v_mfma_f32_16x16x32_bf16 v[88:91], v[116:119], v[164:167], v[88:91]
    v_mfma_f32_16x16x32_bf16 v[84:87], v[116:119], v[160:163], v[84:87]
    v_mfma_f32_16x16x32_bf16 v[80:83], v[116:119], v[156:159], v[80:83]
    v_mfma_f32_16x16x32_bf16 v[76:79], v[116:119], v[152:155], v[76:79]
    ds_read_b128 v[116:119], v66 offset:1600
    s_waitcnt lgkmcnt(2)
    v_mfma_f32_16x16x32_bf16 v[104:107], v[108:111], v[176:179], v[104:107]
    v_mfma_f32_16x16x32_bf16 v[100:103], v[108:111], v[172:175], v[100:103]
    v_mfma_f32_16x16x32_bf16 v[96:99], v[108:111], v[168:171], v[96:99]
    v_mfma_f32_16x16x32_bf16 v[92:95], v[108:111], v[164:167], v[92:95]
    v_mfma_f32_16x16x32_bf16 v[88:91], v[108:111], v[160:163], v[88:91]
    v_mfma_f32_16x16x32_bf16 v[84:87], v[108:111], v[156:159], v[84:87]
    v_mfma_f32_16x16x32_bf16 v[80:83], v[108:111], v[152:155], v[80:83]
    ds_read_b128 v[108:111], v66 offset:2112
    s_waitcnt lgkmcnt(2)
    v_mfma_f32_16x16x32_bf16 v[104:107], v[112:115], v[172:175], v[104:107]
    v_mfma_f32_16x16x32_bf16 v[100:103], v[112:115], v[168:171], v[100:103]
    v_mfma_f32_16x16x32_bf16 v[96:99], v[112:115], v[164:167], v[96:99]
    v_mfma_f32_16x16x32_bf16 v[92:95], v[112:115], v[160:163], v[92:95]
    v_mfma_f32_16x16x32_bf16 v[88:91], v[112:115], v[156:159], v[88:91]
    v_mfma_f32_16x16x32_bf16 v[84:87], v[112:115], v[152:155], v[84:87]
    ds_read_b128 v[112:115], v66 offset:2624
    s_waitcnt lgkmcnt(2)
    v_mfma_f32_16x16x32_bf16 v[104:107], v[116:119], v[168:171], v[104:107]
    v_mfma_f32_16x16x32_bf16 v[100:103], v[116:119], v[164:167], v[100:103]
    v_mfma_f32_16x16x32_bf16 v[96:99], v[116:119], v[160:163], v[96:99]
    v_mfma_f32_16x16x32_bf16 v[92:95], v[116:119], v[156:159], v[92:95]
    v_mfma_f32_16x16x32_bf16 v[88:91], v[116:119], v[152:155], v[88:91]
    ds_read_b128 v[116:119], v66 offset:3136
    s_waitcnt lgkmcnt(2)
    v_mfma_f32_16x16x32_bf16 v[104:107], v[108:111], v[164:167], v[104:107]
    v_mfma_f32_16x16x32_bf16 v[100:103], v[108:111], v[160:163], v[100:103]
    v_mfma_f32_16x16x32_bf16 v[96:99], v[108:111], v[156:159], v[96:99]
    v_mfma_f32_16x16x32_bf16 v[92:95], v[108:111], v[152:155], v[92:95]
    ds_read_b128 v[108:111], v66 offset:3648
    s_waitcnt lgkmcnt(2)
    v_mfma_f32_16x16x32_bf16 v[104:107], v[112:115], v[160:163], v[104:107]
    v_mfma_f32_16x16x32_bf16 v[100:103], v[112:115], v[156:159], v[100:103]
    v_mfma_f32_16x16x32_bf16 v[96:99], v[112:115], v[152:155], v[96:99]
    s_waitcnt lgkmcnt(1)
    v_mfma_f32_16x16x32_bf16 v[104:107], v[116:119], v[156:159], v[104:107]
    v_mfma_f32_16x16x32_bf16 v[100:103], v[116:119], v[152:155], v[100:103]
    s_waitcnt lgkmcnt(0)
    v_mfma_f32_16x16x32_bf16 v[104:107], v[108:111], v[152:155], v[104:107]
    ds_write_b128 v74, v[76:79] offset:0
    ds_write_b128 v74, v[80:83] offset:1024
    ds_write_b128 v74, v[84:87] offset:2048
    ds_write_b128 v74, v[88:91] offset:3072
    ds_write_b128 v74, v[92:95] offset:4096
    ds_write_b128 v74, v[96:99] offset:5120
    ds_write_b128 v74, v[100:103] offset:6144
    s_nop 0
    ds_write_b128 v74, v[104:107] offset:7168
    s_branch c_pw_end_46
c_pw_47:
    s_cmp_lg_u32 s34, 1
    s_cbranch_scc1 c_pw_48
    ds_read_b128 v[108:111], v66 offset:128
    ds_read_b128 v[120:123], v67 offset:352
    ds_read_b128 v[124:127], v67 offset:864
    ds_read_b128 v[128:131], v67 offset:1376
    ds_read_b128 v[132:135], v67 offset:1888
    ds_read_b128 v[136:139], v67 offset:2400
    ds_read_b128 v[140:143], v67 offset:2912
    ds_read_b128 v[144:147], v67 offset:3424
    ds_read_b128 v[148:151], v67 offset:3936
    ds_read_b128 v[112:115], v66 offset:640
    ds_read_b128 v[116:119], v66 offset:1152
    s_waitcnt lgkmcnt(2)
    v_mfma_f32_16x16x32_bf16 v[104:107], v[108:111], v[148:151], 0
    v_mfma_f32_16x16x32_bf16 v[100:103], v[108:111], v[144:147], 0
    v_mfma_f32_16x16x32_bf16 v[96:99], v[108:111], v[140:143], 0
    v_mfma_f32_16x16x32_bf16 v[92:95], v[108:111], v[136:139], 0
    v_mfma_f32_16x16x32_bf16 v[88:91], v[108:111], v[132:135], 0
    v_mfma_f32_16x16x32_bf16 v[84:87], v[108:111], v[128:131], 0
    v_mfma_f32_16x16x32_bf16 v[80:83], v[108:111], v[124:127], 0
    v_mfma_f32_16x16x32_bf16 v[76:79], v[108:111], v[120:123], 0
    ds_read_b128 v[108:111], v66 offset:1664
    s_waitcnt lgkmcnt(2)
    v_mfma_f32_16x16x32_bf16 v[104:107], v[112:115], v[144:147], v[104:107]
    v_mfma_f32_16x16x32_bf16 v[100:103], v[112:115], v[140:143], v[100:103]
    v_mfma_f32_16x16x32_bf16 v[96:99], v[112:115], v[136:139], v[96:99]
    v_mfma_f32_16x16x32_bf16 v[92:95], v[112:115], v[132:135], v[92:95]
    v_mfma_f32_16x16x32_bf16 v[88:91], v[112:115], v[128:131], v[88:91]
    v_mfma_f32_16x16x32_bf16 v[84:87], v[112:115], v[124:127], v[84:87]
    v_mfma_f32_16x16x32_bf16 v[80:83], v[112:115], v[120:123], v[80:83]
    ds_read_b128 v[112:115], v66 offset:2176
    ds_read_b128 v[152:155], v67 offset:288
    ds_read_b128 v[156:159], v67 offset:800
    ds_read_b128 v[160:163], v67 offset:1312
    ds_read_b128 v[164:167], v67 offset:1824
    ds_read_b128 v[168:171], v67 offset:2336
    ds_read_b128 v[172:175], v67 offset:2848
    ds_read_b128 v[176:179], v67 offset:3360
    ds_read_b128 v[180:183], v67 offset:3872
    s_waitcnt lgkmcnt(10)
    v_mfma_f32_16x16x32_bf16 v[104:107], v[116:119], v[140:143], v[104:107]
    v_mfma_f32_16x16x32_bf16 v[100:103], v[116:119], v[136:139], v[100:103]
    v_mfma_f32_16x16x32_bf16 v[96:99], v[116:119], v[132:135], v[96:99]
    v_mfma_f32_16x16x32_bf16 v[92:95], v[116:119], v[128:131], v[92:95]
    v_mfma_f32_16x16x32_bf16 v[88:91], v[116:119], v[124:127], v[88:91]
    v_mfma_f32_16x16x32_bf16 v[84:87], v[116:119], v[120:123], v[84:87]
    ds_read_b128 v[116:119], v66 offset:2688
    s_waitcnt lgkmcnt(10)
    v_mfma_f32_16x16x32_bf16 v[104:107], v[108:111], v[136:139], v[104:107]
    v_mfma_f32_16x16x32_bf16 v[100:103], v[108:111], v[132:135], v[100:103]
    v_mfma_f32_16x16x32_bf16 v[96:99], v[108:111], v[128:131], v[96:99]
    v_mfma_f32_16x16x32_bf16 v[92:95], v[108:111], v[124:127], v[92:95]
    v_mfma_f32_16x16x32_bf16 v[88:91], v[108:111], v[120:123], v[88:91]
    ds_read_b128 v[108:111], v66 offset:3200
    s_waitcnt lgkmcnt(10)
    v_mfma_f32_16x16x32_bf16 v[104:107], v[112:115], v[132:135], v[104:107]
    v_mfma_f32_16x16x32_bf16 v[100:103], v[112:115], v[128:131], v[100:103]
    v_mfma_f32_16x16x32_bf16 v[96:99], v[112:115], v[124:127], v[96:99]
    v_mfma_f32_16x16x32_bf16 v[92:95], v[112:115], v[120:123], v[92:95]
    ds_read_b128 v[112:115], v66 offset:3712
    s_waitcnt lgkmcnt(2)
    v_mfma_f32_16x16x32_bf16 v[104:107], v[116:119], v[128:131], v[104:107]
    v_mfma_f32_16x16x32_bf16 v[100:103], v[116:119], v[124:127], v[100:103]
    v_mfma_f32_16x16x32_bf16 v[96:99], v[116:119], v[120:123], v[96:99]
    ds_read_b128 v[116:119], v66 offset:192
    s_waitcnt lgkmcnt(2)
    v_mfma_f32_16x16x32_bf16 v[104:107], v[108:111], v[124:127], v[104:107]
    v_mfma_f32_16x16x32_bf16 v[100:103], v[108:111], v[120:123], v[100:103]
    ds_read_b128 v[108:111], v66 offset:704
    s_waitcnt lgkmcnt(2)
    v_mfma_f32_16x16x32_bf16 v[104:107], v[112:115], v[120:123], v[104:107]
    ds_read_b128 v[112:115], v66 offset:1216
    s_waitcnt lgkmcnt(2)
    v_mfma_f32_16x16x32_bf16 v[104:107], v[116:119], v[180:183], v[104:107]
    v_mfma_f32_16x16x32_bf16 v[100:103], v[116:119], v[176:179], v[100:103]
    v_mfma_f32_16x16x32_bf16 v[96:99], v[116:119], v[172:175], v[96:99]
    v_mfma_f32_16x16x32_bf16 v[92:95], v[116:119], v[168:171], v[92:95]
    v_mfma_f32_16x16x32_bf16 v[88:91], v[116:119], v[164:167], v[88:91]
    v_mfma_f32_16x16x32_bf16 v[84:87], v[116:119], v[160:163], v[84:87]
    v_mfma_f32_16x16x32_bf16 v[80:83], v[116:119], v[156:159], v[80:83]
    v_mfma_f32_16x16x32_bf16 v[76:79], v[116:119], v[152:155], v[76:79]
    ds_read_b128 v[116:119], v66 offset:1728
    s_waitcnt lgkmcnt(2)
    v_mfma_f32_16x16x32_bf16 v[104:107], v[108:111], v[176:179], v[104:107]
    v_mfma_f32_16x16x32_bf16 v[100:103], v[108:111], v[172:175], v[100:103]
    v_mfma_f32_16x16x32_bf16 v[96:99], v[108:111], v[168:171], v[96:99]
    v_mfma_f32_16x16x32_bf16 v[92:95], v[108:111], v[164:167], v[92:95]
    v_mfma_f32_16x16x32_bf16 v[88:91], v[108:111], v[160:163], v[88:91]
    v_mfma_f32_16x16x32_bf16 v[84:87], v[108:111], v[156:159], v[84:87]
    v_mfma_f32_16x16x32_bf16 v[80:83], v[108:111], v[152:155], v[80:83]
    ds_read_b128 v[108:111], v66 offset:2240
    s_waitcnt lgkmcnt(2)
    v_mfma_f32_16x16x32_bf16 v[104:107], v[112:115], v[172:175], v[104:107]
    v_mfma_f32_16x16x32_bf16 v[100:103], v[112:115], v[168:171], v[100:103]
    v_mfma_f32_16x16x32_bf16 v[96:99], v[112:115], v[164:167], v[96:99]
    v_mfma_f32_16x16x32_bf16 v[92:95], v[112:115], v[160:163], v[92:95]
    v_mfma_f32_16x16x32_bf16 v[88:91], v[112:115], v[156:159], v[88:91]
    v_mfma_f32_16x16x32_bf16 v[84:87], v[112:115], v[152:155], v[84:87]
    ds_read_b128 v[112:115], v66 offset:2752
    s_waitcnt lgkmcnt(2)
    v_mfma_f32_16x16x32_bf16 v[104:107], v[116:119], v[168:171], v[104:107]
    v_mfma_f32_16x16x32_bf16 v[100:103], v[116:119], v[164:167], v[100:103]
    v_mfma_f32_16x16x32_bf16 v[96:99], v[116:119], v[160:163], v[96:99]
    v_mfma_f32_16x16x32_bf16 v[92:95], v[116:119], v[156:159], v[92:95]
    v_mfma_f32_16x16x32_bf16 v[88:91], v[116:119], v[152:155], v[88:91]
    ds_read_b128 v[116:119], v66 offset:3264
    s_waitcnt lgkmcnt(2)
    v_mfma_f32_16x16x32_bf16 v[104:107], v[108:111], v[164:167], v[104:107]
    v_mfma_f32_16x16x32_bf16 v[100:103], v[108:111], v[160:163], v[100:103]
    v_mfma_f32_16x16x32_bf16 v[96:99], v[108:111], v[156:159], v[96:99]
    v_mfma_f32_16x16x32_bf16 v[92:95], v[108:111], v[152:155], v[92:95]
    ds_read_b128 v[108:111], v66 offset:3776
    s_waitcnt lgkmcnt(2)
    v_mfma_f32_16x16x32_bf16 v[104:107], v[112:115], v[160:163], v[104:107]
    v_mfma_f32_16x16x32_bf16 v[100:103], v[112:115], v[156:159], v[100:103]
    v_mfma_f32_16x16x32_bf16 v[96:99], v[112:115], v[152:155], v[96:99]
    s_waitcnt lgkmcnt(1)
    v_mfma_f32_16x16x32_bf16 v[104:107], v[116:119], v[156:159], v[104:107]
    v_mfma_f32_16x16x32_bf16 v[100:103], v[116:119], v[152:155], v[100:103]
    s_waitcnt lgkmcnt(0)
    v_mfma_f32_16x16x32_bf16 v[104:107], v[108:111], v[152:155], v[104:107]
    ds_write_b128 v74, v[76:79] offset:0
    ds_write_b128 v74, v[80:83] offset:1024
    ds_write_b128 v74, v[84:87] offset:2048
    ds_write_b128 v74, v[88:91] offset:3072
    ds_write_b128 v74, v[92:95] offset:4096
    ds_write_b128 v74, v[96:99] offset:5120
    ds_write_b128 v74, v[100:103] offset:6144
    s_nop 0
    ds_write_b128 v74, v[104:107] offset:7168
    s_branch c_pw_end_46
c_pw_48:
    s_cmp_lg_u32 s34, 2
    s_cbranch_scc1 c_pw_49
    ds_read_b128 v[108:111], v66 offset:256
    ds_read_b128 v[120:123], v67 offset:224
    ds_read_b128 v[124:127], v67 offset:736
    ds_read_b128 v[128:131], v67 offset:1248
    ds_read_b128 v[132:135], v67 offset:1760
    ds_read_b128 v[136:139], v67 offset:2272
    ds_read_b128 v[140:143], v67 offset:2784
    ds_read_b128 v[144:147], v67 offset:3296
    ds_read_b128 v[148:151], v67 offset:3808
    ds_read_b128 v[112:115], v66 offset:768
    ds_read_b128 v[116:119], v66 offset:1280
    s_waitcnt lgkmcnt(2)
    v_mfma_f32_16x16x32_bf16 v[104:107], v[108:111], v[148:151], 0
    v_mfma_f32_16x16x32_bf16 v[100:103], v[108:111], v[144:147], 0
    v_mfma_f32_16x16x32_bf16 v[96:99], v[108:111], v[140:143], 0
    v_mfma_f32_16x16x32_bf16 v[92:95], v[108:111], v[136:139], 0
    v_mfma_f32_16x16x32_bf16 v[88:91], v[108:111], v[132:135], 0
    v_mfma_f32_16x16x32_bf16 v[84:87], v[108:111], v[128:131], 0
    v_mfma_f32_16x16x32_bf16 v[80:83], v[108:111], v[124:127], 0
    v_mfma_f32_16x16x32_bf16 v[76:79], v[108:111], v[120:123], 0
    ds_read_b128 v[108:111], v66 offset:1792
    s_waitcnt lgkmcnt(2)
    v_mfma_f32_16x16x32_bf16 v[104:107], v[112:115], v[144:147], v[104:107]
    v_mfma_f32_16x16x32_bf16 v[100:103], v[112:115], v[140:143], v[100:103]
    v_mfma_f32_16x16x32_bf16 v[96:99], v[112:115], v[136:139], v[96:99]
    v_mfma_f32_16x16x32_bf16 v[92:95], v[112:115], v[132:135], v[92:95]
    v_mfma_f32_16x16x32_bf16 v[88:91], v[112:115], v[128:131], v[88:91]
    v_mfma_f32_16x16x32_bf16 v[84:87], v[112:115], v[124:127], v[84:87]
    v_mfma_f32_16x16x32_bf16 v[80:83], v[112:115], v[120:123], v[80:83]
    ds_read_b128 v[112:115], v66 offset:2304
    ds_read_b128 v[152:155], v67 offset:160
    ds_read_b128 v[156:159], v67 offset:672
    ds_read_b128 v[160:163], v67 offset:1184
    ds_read_b128 v[164:167], v67 offset:1696
    ds_read_b128 v[168:171], v67 offset:2208
    ds_read_b128 v[172:175], v67 offset:2720
    ds_read_b128 v[176:179], v67 offset:3232
    ds_read_b128 v[180:183], v67 offset:3744
    s_waitcnt lgkmcnt(10)
    v_mfma_f32_16x16x32_bf16 v[104:107], v[116:119], v[140:143], v[104:107]
    v_mfma_f32_16x16x32_bf16 v[100:103], v[116:119], v[136:139], v[100:103]
    v_mfma_f32_16x16x32_bf16 v[96:99], v[116:119], v[132:135], v[96:99]
    v_mfma_f32_16x16x32_bf16 v[92:95], v[116:119], v[128:131], v[92:95]
    v_mfma_f32_16x16x32_bf16 v[88:91], v[116:119], v[124:127], v[88:91]
    v_mfma_f32_16x16x32_bf16 v[84:87], v[116:119], v[120:123], v[84:87]
    ds_read_b128 v[116:119], v66 offset:2816
    s_waitcnt lgkmcnt(10)
    v_mfma_f32_16x16x32_bf16 v[104:107], v[108:111], v[136:139], v[104:107]
    v_mfma_f32_16x16x32_bf16 v[100:103], v[108:111], v[132:135], v[100:103]
    v_mfma_f32_16x16x32_bf16 v[96:99], v[108:111], v[128:131], v[96:99]
    v_mfma_f32_16x16x32_bf16 v[92:95], v[108:111], v[124:127], v[92:95]
    v_mfma_f32_16x16x32_bf16 v[88:91], v[108:111], v[120:123], v[88:91]
    ds_read_b128 v[108:111], v66 offset:3328
    s_waitcnt lgkmcnt(10)
    v_mfma_f32_16x16x32_bf16 v[104:107], v[112:115], v[132:135], v[104:107]
    v_mfma_f32_16x16x32_bf16 v[100:103], v[112:115], v[128:131], v[100:103]
    v_mfma_f32_16x16x32_bf16 v[96:99], v[112:115], v[124:127], v[96:99]
    v_mfma_f32_16x16x32_bf16 v[92:95], v[112:115], v[120:123], v[92:95]
    ds_read_b128 v[112:115], v66 offset:3840
    s_waitcnt lgkmcnt(2)
    v_mfma_f32_16x16x32_bf16 v[104:107], v[116:119], v[128:131], v[104:107]
    v_mfma_f32_16x16x32_bf16 v[100:103], v[116:119], v[124:127], v[100:103]
    v_mfma_f32_16x16x32_bf16 v[96:99], v[116:119], v[120:123], v[96:99]
    ds_read_b128 v[116:119], v66 offset:320
    s_waitcnt lgkmcnt(2)
    v_mfma_f32_16x16x32_bf16 v[104:107], v[108:111], v[124:127], v[104:107]
    v_mfma_f32_16x16x32_bf16 v[100:103], v[108:111], v[120:123], v[100:103]
    ds_read_b128 v[108:111], v66 offset:832
    s_waitcnt lgkmcnt(2)
    v_mfma_f32_16x16x32_bf16 v[104:107], v[112:115], v[120:123], v[104:107]
    ds_read_b128 v[112:115], v66 offset:1344
    s_waitcnt lgkmcnt(2)
    v_mfma_f32_16x16x32_bf16 v[104:107], v[116:119], v[180:183], v[104:107]
    v_mfma_f32_16x16x32_bf16 v[100:103], v[116:119], v[176:179], v[100:103]
    v_mfma_f32_16x16x32_bf16 v[96:99], v[116:119], v[172:175], v[96:99]
    v_mfma_f32_16x16x32_bf16 v[92:95], v[116:119], v[168:171], v[92:95]
    v_mfma_f32_16x16x32_bf16 v[88:91], v[116:119], v[164:167], v[88:91]
    v_mfma_f32_16x16x32_bf16 v[84:87], v[116:119], v[160:163], v[84:87]
    v_mfma_f32_16x16x32_bf16 v[80:83], v[116:119], v[156:159], v[80:83]
    v_mfma_f32_16x16x32_bf16 v[76:79], v[116:119], v[152:155], v[76:79]
    ds_read_b128 v[116:119], v66 offset:1856
    s_waitcnt lgkmcnt(2)
    v_mfma_f32_16x16x32_bf16 v[104:107], v[108:111], v[176:179], v[104:107]
    v_mfma_f32_16x16x32_bf16 v[100:103], v[108:111], v[172:175], v[100:103]
    v_mfma_f32_16x16x32_bf16 v[96:99], v[108:111], v[168:171], v[96:99]
    v_mfma_f32_16x16x32_bf16 v[92:95], v[108:111], v[164:167], v[92:95]
    v_mfma_f32_16x16x32_bf16 v[88:91], v[108:111], v[160:163], v[88:91]
    v_mfma_f32_16x16x32_bf16 v[84:87], v[108:111], v[156:159], v[84:87]
    v_mfma_f32_16x16x32_bf16 v[80:83], v[108:111], v[152:155], v[80:83]
    ds_read_b128 v[108:111], v66 offset:2368
    s_waitcnt lgkmcnt(2)
    v_mfma_f32_16x16x32_bf16 v[104:107], v[112:115], v[172:175], v[104:107]
    v_mfma_f32_16x16x32_bf16 v[100:103], v[112:115], v[168:171], v[100:103]
    v_mfma_f32_16x16x32_bf16 v[96:99], v[112:115], v[164:167], v[96:99]
    v_mfma_f32_16x16x32_bf16 v[92:95], v[112:115], v[160:163], v[92:95]
    v_mfma_f32_16x16x32_bf16 v[88:91], v[112:115], v[156:159], v[88:91]
    v_mfma_f32_16x16x32_bf16 v[84:87], v[112:115], v[152:155], v[84:87]
    ds_read_b128 v[112:115], v66 offset:2880
    s_waitcnt lgkmcnt(2)
    v_mfma_f32_16x16x32_bf16 v[104:107], v[116:119], v[168:171], v[104:107]
    v_mfma_f32_16x16x32_bf16 v[100:103], v[116:119], v[164:167], v[100:103]
    v_mfma_f32_16x16x32_bf16 v[96:99], v[116:119], v[160:163], v[96:99]
    v_mfma_f32_16x16x32_bf16 v[92:95], v[116:119], v[156:159], v[92:95]
    v_mfma_f32_16x16x32_bf16 v[88:91], v[116:119], v[152:155], v[88:91]
    ds_read_b128 v[116:119], v66 offset:3392
    s_waitcnt lgkmcnt(2)
    v_mfma_f32_16x16x32_bf16 v[104:107], v[108:111], v[164:167], v[104:107]
    v_mfma_f32_16x16x32_bf16 v[100:103], v[108:111], v[160:163], v[100:103]
    v_mfma_f32_16x16x32_bf16 v[96:99], v[108:111], v[156:159], v[96:99]
    v_mfma_f32_16x16x32_bf16 v[92:95], v[108:111], v[152:155], v[92:95]
    ds_read_b128 v[108:111], v66 offset:3904
    s_waitcnt lgkmcnt(2)
    v_mfma_f32_16x16x32_bf16 v[104:107], v[112:115], v[160:163], v[104:107]
    v_mfma_f32_16x16x32_bf16 v[100:103], v[112:115], v[156:159], v[100:103]
    v_mfma_f32_16x16x32_bf16 v[96:99], v[112:115], v[152:155], v[96:99]
    s_waitcnt lgkmcnt(1)
    v_mfma_f32_16x16x32_bf16 v[104:107], v[116:119], v[156:159], v[104:107]
    v_mfma_f32_16x16x32_bf16 v[100:103], v[116:119], v[152:155], v[100:103]
    s_waitcnt lgkmcnt(0)
    v_mfma_f32_16x16x32_bf16 v[104:107], v[108:111], v[152:155], v[104:107]
    ds_write_b128 v74, v[76:79] offset:0
    ds_write_b128 v74, v[80:83] offset:1024
    ds_write_b128 v74, v[84:87] offset:2048
    ds_write_b128 v74, v[88:91] offset:3072
    ds_write_b128 v74, v[92:95] offset:4096
    ds_write_b128 v74, v[96:99] offset:5120
    ds_write_b128 v74, v[100:103] offset:6144
    s_nop 0
    ds_write_b128 v74, v[104:107] offset:7168
    s_branch c_pw_end_46
c_pw_49:
    ds_read_b128 v[108:111], v66 offset:384
    ds_read_b128 v[120:123], v67 offset:96
    ds_read_b128 v[124:127], v67 offset:608
    ds_read_b128 v[128:131], v67 offset:1120
    ds_read_b128 v[132:135], v67 offset:1632
    ds_read_b128 v[136:139], v67 offset:2144
    ds_read_b128 v[140:143], v67 offset:2656
    ds_read_b128 v[144:147], v67 offset:3168
    ds_read_b128 v[148:151], v67 offset:3680
    ds_read_b128 v[112:115], v66 offset:896
    ds_read_b128 v[116:119], v66 offset:1408
    s_waitcnt lgkmcnt(2)
    v_mfma_f32_16x16x32_bf16 v[104:107], v[108:111], v[148:151], 0
    v_mfma_f32_16x16x32_bf16 v[100:103], v[108:111], v[144:147], 0
    v_mfma_f32_16x16x32_bf16 v[96:99], v[108:111], v[140:143], 0
    v_mfma_f32_16x16x32_bf16 v[92:95], v[108:111], v[136:139], 0
    v_mfma_f32_16x16x32_bf16 v[88:91], v[108:111], v[132:135], 0
    v_mfma_f32_16x16x32_bf16 v[84:87], v[108:111], v[128:131], 0
    v_mfma_f32_16x16x32_bf16 v[80:83], v[108:111], v[124:127], 0
    v_mfma_f32_16x16x32_bf16 v[76:79], v[108:111], v[120:123], 0
    ds_read_b128 v[108:111], v66 offset:1920
    s_waitcnt lgkmcnt(2)
    v_mfma_f32_16x16x32_bf16 v[104:107], v[112:115], v[144:147], v[104:107]
    v_mfma_f32_16x16x32_bf16 v[100:103], v[112:115], v[140:143], v[100:103]
    v_mfma_f32_16x16x32_bf16 v[96:99], v[112:115], v[136:139], v[96:99]
    v_mfma_f32_16x16x32_bf16 v[92:95], v[112:115], v[132:135], v[92:95]
    v_mfma_f32_16x16x32_bf16 v[88:91], v[112:115], v[128:131], v[88:91]
    v_mfma_f32_16x16x32_bf16 v[84:87], v[112:115], v[124:127], v[84:87]
    v_mfma_f32_16x16x32_bf16 v[80:83], v[112:115], v[120:123], v[80:83]
    ds_read_b128 v[112:115], v66 offset:2432
    ds_read_b128 v[152:155], v67 offset:32
    ds_read_b128 v[156:159], v67 offset:544
    ds_read_b128 v[160:163], v67 offset:1056
    ds_read_b128 v[164:167], v67 offset:1568
    ds_read_b128 v[168:171], v67 offset:2080
    ds_read_b128 v[172:175], v67 offset:2592
    ds_read_b128 v[176:179], v67 offset:3104
    ds_read_b128 v[180:183], v67 offset:3616
    s_waitcnt lgkmcnt(10)
    v_mfma_f32_16x16x32_bf16 v[104:107], v[116:119], v[140:143], v[104:107]
    v_mfma_f32_16x16x32_bf16 v[100:103], v[116:119], v[136:139], v[100:103]
    v_mfma_f32_16x16x32_bf16 v[96:99], v[116:119], v[132:135], v[96:99]
    v_mfma_f32_16x16x32_bf16 v[92:95], v[116:119], v[128:131], v[92:95]
    v_mfma_f32_16x16x32_bf16 v[88:91], v[116:119], v[124:127], v[88:91]
    v_mfma_f32_16x16x32_bf16 v[84:87], v[116:119], v[120:123], v[84:87]
    ds_read_b128 v[116:119], v66 offset:2944
    s_waitcnt lgkmcnt(10)
    v_mfma_f32_16x16x32_bf16 v[104:107], v[108:111], v[136:139], v[104:107]
    v_mfma_f32_16x16x32_bf16 v[100:103], v[108:111], v[132:135], v[100:103]
    v_mfma_f32_16x16x32_bf16 v[96:99], v[108:111], v[128:131], v[96:99]
    v_mfma_f32_16x16x32_bf16 v[92:95], v[108:111], v[124:127], v[92:95]
    v_mfma_f32_16x16x32_bf16 v[88:91], v[108:111], v[120:123], v[88:91]
    ds_read_b128 v[108:111], v66 offset:3456
    s_waitcnt lgkmcnt(10)
    v_mfma_f32_16x16x32_bf16 v[104:107], v[112:115], v[132:135], v[104:107]
    v_mfma_f32_16x16x32_bf16 v[100:103], v[112:115], v[128:131], v[100:103]
    v_mfma_f32_16x16x32_bf16 v[96:99], v[112:115], v[124:127], v[96:99]
    v_mfma_f32_16x16x32_bf16 v[92:95], v[112:115], v[120:123], v[92:95]
    ds_read_b128 v[112:115], v66 offset:3968
    s_waitcnt lgkmcnt(2)
    v_mfma_f32_16x16x32_bf16 v[104:107], v[116:119], v[128:131], v[104:107]
    v_mfma_f32_16x16x32_bf16 v[100:103], v[116:119], v[124:127], v[100:103]
    v_mfma_f32_16x16x32_bf16 v[96:99], v[116:119], v[120:123], v[96:99]
    ds_read_b128 v[116:119], v66 offset:448
    s_waitcnt lgkmcnt(2)
    v_mfma_f32_16x16x32_bf16 v[104:107], v[108:111], v[124:127], v[104:107]
    v_mfma_f32_16x16x32_bf16 v[100:103], v[108:111], v[120:123], v[100:103]
    ds_read_b128 v[108:111], v66 offset:960
    s_waitcnt lgkmcnt(2)
    v_mfma_f32_16x16x32_bf16 v[104:107], v[112:115], v[120:123], v[104:107]
    ds_read_b128 v[112:115], v66 offset:1472
    s_waitcnt lgkmcnt(2)
    v_mfma_f32_16x16x32_bf16 v[104:107], v[116:119], v[180:183], v[104:107]
    v_mfma_f32_16x16x32_bf16 v[100:103], v[116:119], v[176:179], v[100:103]
    v_mfma_f32_16x16x32_bf16 v[96:99], v[116:119], v[172:175], v[96:99]
    v_mfma_f32_16x16x32_bf16 v[92:95], v[116:119], v[168:171], v[92:95]
    v_mfma_f32_16x16x32_bf16 v[88:91], v[116:119], v[164:167], v[88:91]
    v_mfma_f32_16x16x32_bf16 v[84:87], v[116:119], v[160:163], v[84:87]
    v_mfma_f32_16x16x32_bf16 v[80:83], v[116:119], v[156:159], v[80:83]
    v_mfma_f32_16x16x32_bf16 v[76:79], v[116:119], v[152:155], v[76:79]
    ds_read_b128 v[116:119], v66 offset:1984
    s_waitcnt lgkmcnt(2)
    v_mfma_f32_16x16x32_bf16 v[104:107], v[108:111], v[176:179], v[104:107]
    v_mfma_f32_16x16x32_bf16 v[100:103], v[108:111], v[172:175], v[100:103]
    v_mfma_f32_16x16x32_bf16 v[96:99], v[108:111], v[168:171], v[96:99]
    v_mfma_f32_16x16x32_bf16 v[92:95], v[108:111], v[164:167], v[92:95]
    v_mfma_f32_16x16x32_bf16 v[88:91], v[108:111], v[160:163], v[88:91]
    v_mfma_f32_16x16x32_bf16 v[84:87], v[108:111], v[156:159], v[84:87]
    v_mfma_f32_16x16x32_bf16 v[80:83], v[108:111], v[152:155], v[80:83]
    ds_read_b128 v[108:111], v66 offset:2496
    s_waitcnt lgkmcnt(2)
    v_mfma_f32_16x16x32_bf16 v[104:107], v[112:115], v[172:175], v[104:107]
    v_mfma_f32_16x16x32_bf16 v[100:103], v[112:115], v[168:171], v[100:103]
    v_mfma_f32_16x16x32_bf16 v[96:99], v[112:115], v[164:167], v[96:99]
    v_mfma_f32_16x16x32_bf16 v[92:95], v[112:115], v[160:163], v[92:95]
    v_mfma_f32_16x16x32_bf16 v[88:91], v[112:115], v[156:159], v[88:91]
    v_mfma_f32_16x16x32_bf16 v[84:87], v[112:115], v[152:155], v[84:87]
    ds_read_b128 v[112:115], v66 offset:3008
    s_waitcnt lgkmcnt(2)
    v_mfma_f32_16x16x32_bf16 v[104:107], v[116:119], v[168:171], v[104:107]
    v_mfma_f32_16x16x32_bf16 v[100:103], v[116:119], v[164:167], v[100:103]
    v_mfma_f32_16x16x32_bf16 v[96:99], v[116:119], v[160:163], v[96:99]
    v_mfma_f32_16x16x32_bf16 v[92:95], v[116:119], v[156:159], v[92:95]
    v_mfma_f32_16x16x32_bf16 v[88:91], v[116:119], v[152:155], v[88:91]
    ds_read_b128 v[116:119], v66 offset:3520
    s_waitcnt lgkmcnt(2)
    v_mfma_f32_16x16x32_bf16 v[104:107], v[108:111], v[164:167], v[104:107]
    v_mfma_f32_16x16x32_bf16 v[100:103], v[108:111], v[160:163], v[100:103]
    v_mfma_f32_16x16x32_bf16 v[96:99], v[108:111], v[156:159], v[96:99]
    v_mfma_f32_16x16x32_bf16 v[92:95], v[108:111], v[152:155], v[92:95]
    ds_read_b128 v[108:111], v66 offset:4032
    s_waitcnt lgkmcnt(2)
    v_mfma_f32_16x16x32_bf16 v[104:107], v[112:115], v[160:163], v[104:107]
    v_mfma_f32_16x16x32_bf16 v[100:103], v[112:115], v[156:159], v[100:103]
    v_mfma_f32_16x16x32_bf16 v[96:99], v[112:115], v[152:155], v[96:99]
    s_waitcnt lgkmcnt(1)
    v_mfma_f32_16x16x32_bf16 v[104:107], v[116:119], v[156:159], v[104:107]
    v_mfma_f32_16x16x32_bf16 v[100:103], v[116:119], v[152:155], v[100:103]
    s_waitcnt lgkmcnt(0)
    v_mfma_f32_16x16x32_bf16 v[104:107], v[108:111], v[152:155], v[104:107]
    ds_write_b128 v74, v[76:79] offset:0
    ds_write_b128 v74, v[80:83] offset:1024
    ds_write_b128 v74, v[84:87] offset:2048
    ds_write_b128 v74, v[88:91] offset:3072
    ds_write_b128 v74, v[92:95] offset:4096
    ds_write_b128 v74, v[96:99] offset:5120
    ds_write_b128 v74, v[100:103] offset:6144
    s_nop 0
    ds_write_b128 v74, v[104:107] offset:7168
c_pw_end_46:
    s_waitcnt vmcnt(0)
    s_waitcnt lgkmcnt(0)
    v_mov_b32 v3, 161796
    v_mov_b32 v4, 1
    s_mov_b64 exec, 1
    ds_add_u32 v3, v4
    s_mov_b64 exec, -1
    s_mov_b32 s67, 0
gsync_51:
    ds_read_b32 v4, v3
    s_add_u32 s67, s67, 1
    s_waitcnt lgkmcnt(0)
    v_readfirstlane_b32 s66, v4
    s_cmp_gt_u32 s67, 1000000
    s_cbranch_scc1 gsync_e_52
    s_cmp_lt_u32 s66, 16
    s_cbranch_scc1 gsync_51
gsync_e_52:
    s_lshl_b32 s40, s2, 3
    s_add_u32 s40, s40, 14725120
    v_mov_b32 v48, s100
    v_mov_b32 v49, s101
    v_mov_b32 v3, 0
    s_cmp_eq_u32 s34, 0
    s_cselect_b64 exec, 1, 0
    s_cmp_lt_u32 s2, 192
    s_cselect_b64 exec, exec, 0
    buffer_store_dwordx2 v[48:49], v3, s[8:11], s40 offen sc1
    s_mov_b64 exec, -1
    ds_read_b128 v[120:123], v75 offset:0
    ds_read_b128 v[124:127], v75 offset:16
    ds_read_b128 v[128:131], v75 offset:8192
    ds_read_b128 v[132:135], v75 offset:8208
    ds_read_b128 v[136:139], v75 offset:16384
    ds_read_b128 v[140:143], v75 offset:16400
    ds_read_b128 v[144:147], v75 offset:24576
    ds_read_b128 v[148:151], v75 offset:24592
    s_lshl_b32 s40, s57, 12
    s_add_u32 s40, s40, 8912896
    s_waitcnt lgkmcnt(0)
    v_pk_add_f32 v[120:121], v[120:121], v[128:129]
    v_pk_add_f32 v[136:137], v[136:137], v[144:145]
    v_pk_add_f32 v[122:123], v[122:123], v[130:131]
    v_pk_add_f32 v[138:139], v[138:139], v[146:147]
    v_pk_add_f32 v[124:125], v[124:125], v[132:133]
    v_pk_add_f32 v[140:141], v[140:141], v[148:149]
    v_pk_add_f32 v[126:127], v[126:127], v[134:135]
    v_pk_add_f32 v[142:143], v[142:143], v[150:151]
    v_pk_add_f32 v[120:121], v[120:121], v[136:137]
    v_pk_add_f32 v[122:123], v[122:123], v[138:139]
    v_pk_add_f32 v[124:125], v[124:125], v[140:141]
    v_pk_add_f32 v[126:127], v[126:127], v[142:143]
    v_cvt_pk_bf16_f32 v192, v120, v121
    v_cvt_pk_bf16_f32 v193, v122, v123
    v_cvt_pk_bf16_f32 v194, v124, v125
    v_cvt_pk_bf16_f32 v195, v126, v127
    buffer_store_dwordx4 v[192:195], v2, s[8:11], s40 offen sc1
    s_nop 1
    s_waitcnt vmcnt(0)
    v_cmp_ne_u32 vcc, 0, v0
    s_nop 1
    v_cndmask_b32 v24, 0, v24, vcc
    v_cndmask_b32 v25, 0, v25, vcc
    v_cndmask_b32 v26, 0, v26, vcc
    v_cndmask_b32 v27, 0, v27, vcc
    v_alignbit_b32 v184, v25, v24, 16
    v_alignbit_b32 v185, v26, v25, 16
    v_alignbit_b32 v186, v27, v26, 16
    v_alignbit_b32 v187, v28, v27, 16
    v_alignbit_b32 v188, v29, v28, 16
    v_alignbit_b32 v189, v30, v29, 16
    v_alignbit_b32 v190, v31, v30, 16
    ds_write_b128 v64, v[184:187] offset:0
    v_mov_b32 v192, v25
    v_mov_b32 v193, v26
    v_mov_b32 v194, v27
    v_mov_b32 v195, v28
    ds_write_b128 v64, v[192:195] offset:4160
    s_nop 1
    v_mov_b32 v192, v185
    v_mov_b32 v193, v186
    v_mov_b32 v194, v187
    v_mov_b32 v195, v188
    ds_write_b128 v64, v[192:195] offset:8320
    s_nop 1
    ds_write_b128 v64, v[26:29] offset:12480
    ds_write_b128 v64, v[186:189] offset:16640
    v_mov_b32 v192, v27
    v_mov_b32 v193, v28
    v_mov_b32 v194, v29
    v_mov_b32 v195, v30
    ds_write_b128 v64, v[192:195] offset:20800
    s_nop 1
    v_mov_b32 v192, v187
    v_mov_b32 v193, v188
    v_mov_b32 v194, v189
    v_mov_b32 v195, v190
    ds_write_b128 v64, v[192:195] offset:24960
    s_nop 1
    ds_write_b128 v64, v[28:31] offset:29120
    ds_write_b128 v65, v[40:43]
    v_lshlrev_b32 v3, 16, v46
    v_or_b32 v3, v3, v46
    v_and_b32 v196, v68, v3
    v_and_b32 v197, v69, v3
    v_and_b32 v198, v70, v3
    v_and_b32 v199, v71, v3
    s_waitcnt lgkmcnt(0)
    v_mov_b32 v3, 161796
    v_mov_b32 v4, 1
    s_mov_b64 exec, 1
    ds_add_u32 v3, v4
    s_mov_b64 exec, -1
    s_mov_b32 s67, 0
gsync_53:
    ds_read_b32 v4, v3
    s_add_u32 s67, s67, 1
    s_waitcnt lgkmcnt(0)
    v_readfirstlane_b32 s66, v4
    s_cmp_gt_u32 s67, 1000000
    s_cbranch_scc1 gsync_e_54
    s_cmp_lt_u32 s66, 20
    s_cbranch_scc1 gsync_53
gsync_e_54:
    s_bitcmp1_b32 s2, 0
    s_cbranch_scc1 c_halfB_55
    s_cmp_lg_u32 s34, 0
    s_cbranch_scc1 c_pw_58
    ds_read_b128 v[108:111], v66 offset:0
    ds_read_b128 v[120:123], v67 offset:480
    ds_read_b128 v[124:127], v67 offset:992
    ds_read_b128 v[128:131], v67 offset:1504
    ds_read_b128 v[132:135], v67 offset:2016
    ds_read_b128 v[136:139], v67 offset:2528
    ds_read_b128 v[140:143], v67 offset:3040
    ds_read_b128 v[144:147], v67 offset:3552
    ds_read_b128 v[148:151], v67 offset:4064
    ds_read_b128 v[112:115], v66 offset:512
    ds_read_b128 v[116:119], v66 offset:1024
    s_waitcnt lgkmcnt(2)
    v_mfma_f32_16x16x32_bf16 v[104:107], v[108:111], v[148:151], 0
    v_mfma_f32_16x16x32_bf16 v[100:103], v[108:111], v[144:147], 0
    v_mfma_f32_16x16x32_bf16 v[84:87], v[108:111], v[128:131], 0
    v_mfma_f32_16x16x32_bf16 v[84:87], v[196:199], v[128:131], v[84:87]
    v_mfma_f32_16x16x32_bf16 v[100:103], v[196:199], v[144:147], v[100:103]
    v_mfma_f32_16x16x32_bf16 v[104:107], v[196:199], v[148:151], v[104:107]
    ds_read_b128 v[108:111], v66 offset:1536
    s_waitcnt lgkmcnt(2)
    v_mfma_f32_16x16x32_bf16 v[104:107], v[112:115], v[144:147], v[104:107]
    v_mfma_f32_16x16x32_bf16 v[100:103], v[112:115], v[140:143], v[100:103]
    v_mfma_f32_16x16x32_bf16 v[84:87], v[112:115], v[124:127], v[84:87]
    ds_read_b128 v[112:115], v66 offset:2048
    ds_read_b128 v[152:155], v67 offset:416
    ds_read_b128 v[156:159], v67 offset:928
    ds_read_b128 v[160:163], v67 offset:1440
    ds_read_b128 v[164:167], v67 offset:1952
    ds_read_b128 v[168:171], v67 offset:2464
    ds_read_b128 v[172:175], v67 offset:2976
    ds_read_b128 v[176:179], v67 offset:3488
    ds_read_b128 v[180:183], v67 offset:4000
    s_waitcnt lgkmcnt(10)
    v_mfma_f32_16x16x32_bf16 v[104:107], v[116:119], v[140:143], v[104:107]
    v_mfma_f32_16x16x32_bf16 v[100:103], v[116:119], v[136:139], v[100:103]
    v_mfma_f32_16x16x32_bf16 v[84:87], v[116:119], v[120:123], v[84:87]
    ds_read_b128 v[116:119], v66 offset:2560
    s_waitcnt lgkmcnt(10)
    v_mfma_f32_16x16x32_bf16 v[104:107], v[108:111], v[136:139], v[104:107]
    v_mfma_f32_16x16x32_bf16 v[100:103], v[108:111], v[132:135], v[100:103]
    ds_read_b128 v[108:111], v66 offset:3072
    s_waitcnt lgkmcnt(10)
    v_mfma_f32_16x16x32_bf16 v[104:107], v[112:115], v[132:135], v[104:107]
    v_mfma_f32_16x16x32_bf16 v[100:103], v[112:115], v[128:131], v[100:103]
    ds_read_b128 v[112:115], v66 offset:3584
    s_waitcnt lgkmcnt(2)
    v_mfma_f32_16x16x32_bf16 v[104:107], v[116:119], v[128:131], v[104:107]
    v_mfma_f32_16x16x32_bf16 v[100:103], v[116:119], v[124:127], v[100:103]
    ds_read_b128 v[116:119], v66 offset:64
    s_waitcnt lgkmcnt(2)
    v_mfma_f32_16x16x32_bf16 v[104:107], v[108:111], v[124:127], v[104:107]
    v_mfma_f32_16x16x32_bf16 v[100:103], v[108:111], v[120:123], v[100:103]
    ds_read_b128 v[108:111], v66 offset:576
    s_waitcnt lgkmcnt(2)
    v_mfma_f32_16x16x32_bf16 v[104:107], v[112:115], v[120:123], v[104:107]
    ds_read_b128 v[112:115], v66 offset:1088
    s_waitcnt lgkmcnt(2)
    v_mfma_f32_16x16x32_bf16 v[104:107], v[116:119], v[180:183], v[104:107]
    v_mfma_f32_16x16x32_bf16 v[100:103], v[116:119], v[176:179], v[100:103]
    v_mfma_f32_16x16x32_bf16 v[84:87], v[116:119], v[160:163], v[84:87]
    ds_read_b128 v[116:119], v66 offset:1600
    s_waitcnt lgkmcnt(2)
    v_mfma_f32_16x16x32_bf16 v[104:107], v[108:111], v[176:179], v[104:107]
    v_mfma_f32_16x16x32_bf16 v[100:103], v[108:111], v[172:175], v[100:103]
    v_mfma_f32_16x16x32_bf16 v[84:87], v[108:111], v[156:159], v[84:87]
    ds_read_b128 v[108:111], v66 offset:2112
    s_waitcnt lgkmcnt(2)
    v_mfma_f32_16x16x32_bf16 v[104:107], v[112:115], v[172:175], v[104:107]
    v_mfma_f32_16x16x32_bf16 v[100:103], v[112:115], v[168:171], v[100:103]
    v_mfma_f32_16x16x32_bf16 v[84:87], v[112:115], v[152:155], v[84:87]
    ds_read_b128 v[112:115], v66 offset:2624
    s_waitcnt lgkmcnt(2)
    v_mfma_f32_16x16x32_bf16 v[104:107], v[116:119], v[168:171], v[104:107]
    v_mfma_f32_16x16x32_bf16 v[100:103], v[116:119], v[164:167], v[100:103]
    ds_read_b128 v[116:119], v66 offset:3136
    s_waitcnt lgkmcnt(2)
    v_mfma_f32_16x16x32_bf16 v[104:107], v[108:111], v[164:167], v[104:107]
    v_mfma_f32_16x16x32_bf16 v[100:103], v[108:111], v[160:163], v[100:103]
    ds_read_b128 v[108:111], v66 offset:3648
    s_waitcnt lgkmcnt(2)
    v_mfma_f32_16x16x32_bf16 v[104:107], v[112:115], v[160:163], v[104:107]
    v_mfma_f32_16x16x32_bf16 v[100:103], v[112:115], v[156:159], v[100:103]
    s_waitcnt lgkmcnt(1)
    v_mfma_f32_16x16x32_bf16 v[104:107], v[116:119], v[156:159], v[104:107]
    v_mfma_f32_16x16x32_bf16 v[100:103], v[116:119], v[152:155], v[100:103]
    s_waitcnt lgkmcnt(0)
    v_mfma_f32_16x16x32_bf16 v[104:107], v[108:111], v[152:155], v[104:107]
    ds_write_b128 v74, v[84:87] offset:2048
    s_nop 4
    ds_write_b128 v74, v[100:103] offset:6144
    s_nop 0
    ds_write_b128 v74, v[104:107] offset:7168
    s_branch c_pw_end_57
c_pw_58:
    s_cmp_lg_u32 s34, 1
    s_cbranch_scc1 c_pw_59
    ds_read_b128 v[108:111], v66 offset:128
    ds_read_b128 v[120:123], v67 offset:352
    ds_read_b128 v[124:127], v67 offset:864
    ds_read_b128 v[128:131], v67 offset:1376
    ds_read_b128 v[132:135], v67 offset:1888
    ds_read_b128 v[136:139], v67 offset:2400
    ds_read_b128 v[140:143], v67 offset:2912
    ds_read_b128 v[144:147], v67 offset:3424
    ds_read_b128 v[148:151], v67 offset:3936
    ds_read_b128 v[112:115], v66 offset:640
    ds_read_b128 v[116:119], v66 offset:1152
    s_waitcnt lgkmcnt(2)
    v_mfma_f32_16x16x32_bf16 v[104:107], v[108:111], v[148:151], 0
    v_mfma_f32_16x16x32_bf16 v[100:103], v[108:111], v[144:147], 0
    v_mfma_f32_16x16x32_bf16 v[84:87], v[108:111], v[128:131], 0
    ds_read_b128 v[108:111], v66 offset:1664
    s_waitcnt lgkmcnt(2)
    v_mfma_f32_16x16x32_bf16 v[104:107], v[112:115], v[144:147], v[104:107]
    v_mfma_f32_16x16x32_bf16 v[100:103], v[112:115], v[140:143], v[100:103]
    v_mfma_f32_16x16x32_bf16 v[84:87], v[112:115], v[124:127], v[84:87]
    ds_read_b128 v[112:115], v66 offset:2176
    ds_read_b128 v[152:155], v67 offset:288
    ds_read_b128 v[156:159], v67 offset:800
    ds_read_b128 v[160:163], v67 offset:1312
    ds_read_b128 v[164:167], v67 offset:1824
    ds_read_b128 v[168:171], v67 offset:2336
    ds_read_b128 v[172:175], v67 offset:2848
    ds_read_b128 v[176:179], v67 offset:3360
    ds_read_b128 v[180:183], v67 offset:3872
    s_waitcnt lgkmcnt(10)
    v_mfma_f32_16x16x32_bf16 v[104:107], v[116:119], v[140:143], v[104:107]
    v_mfma_f32_16x16x32_bf16 v[100:103], v[116:119], v[136:139], v[100:103]
    v_mfma_f32_16x16x32_bf16 v[84:87], v[116:119], v[120:123], v[84:87]
    ds_read_b128 v[116:119], v66 offset:2688
    s_waitcnt lgkmcnt(10)
    v_mfma_f32_16x16x32_bf16 v[104:107], v[108:111], v[136:139], v[104:107]
    v_mfma_f32_16x16x32_bf16 v[100:103], v[108:111], v[132:135], v[100:103]
    ds_read_b128 v[108:111], v66 offset:3200
    s_waitcnt lgkmcnt(10)
    v_mfma_f32_16x16x32_bf16 v[104:107], v[112:115], v[132:135], v[104:107]
    v_mfma_f32_16x16x32_bf16 v[100:103], v[112:115], v[128:131], v[100:103]
    ds_read_b128 v[112:115], v66 offset:3712
    s_waitcnt lgkmcnt(2)
    v_mfma_f32_16x16x32_bf16 v[104:107], v[116:119], v[128:131], v[104:107]
    v_mfma_f32_16x16x32_bf16 v[100:103], v[116:119], v[124:127], v[100:103]
    ds_read_b128 v[116:119], v66 offset:192
    s_waitcnt lgkmcnt(2)
    v_mfma_f32_16x16x32_bf16 v[104:107], v[108:111], v[124:127], v[104:107]
    v_mfma_f32_16x16x32_bf16 v[100:103], v[108:111], v[120:123], v[100:103]
    ds_read_b128 v[108:111], v66 offset:704
    s_waitcnt lgkmcnt(2)
    v_mfma_f32_16x16x32_bf16 v[104:107], v[112:115], v[120:123], v[104:107]
    ds_read_b128 v[112:115], v66 offset:1216
    s_waitcnt lgkmcnt(2)
    v_mfma_f32_16x16x32_bf16 v[104:107], v[116:119], v[180:183], v[104:107]
    v_mfma_f32_16x16x32_bf16 v[100:103], v[116:119], v[176:179], v[100:103]
    v_mfma_f32_16x16x32_bf16 v[84:87], v[116:119], v[160:163], v[84:87]
    ds_read_b128 v[116:119], v66 offset:1728
    s_waitcnt lgkmcnt(2)
    v_mfma_f32_16x16x32_bf16 v[104:107], v[108:111], v[176:179], v[104:107]
    v_mfma_f32_16x16x32_bf16 v[100:103], v[108:111], v[172:175], v[100:103]
    v_mfma_f32_16x16x32_bf16 v[84:87], v[108:111], v[156:159], v[84:87]
    ds_read_b128 v[108:111], v66 offset:2240
    s_waitcnt lgkmcnt(2)
    v_mfma_f32_16x16x32_bf16 v[104:107], v[112:115], v[172:175], v[104:107]
    v_mfma_f32_16x16x32_bf16 v[100:103], v[112:115], v[168:171], v[100:103]
    v_mfma_f32_16x16x32_bf16 v[84:87], v[112:115], v[152:155], v[84:87]
    ds_read_b128 v[112:115], v66 offset:2752
    s_waitcnt lgkmcnt(2)
    v_mfma_f32_16x16x32_bf16 v[104:107], v[116:119], v[168:171], v[104:107]
    v_mfma_f32_16x16x32_bf16 v[100:103], v[116:119], v[164:167], v[100:103]
    ds_read_b128 v[116:119], v66 offset:3264
    s_waitcnt lgkmcnt(2)
    v_mfma_f32_16x16x32_bf16 v[104:107], v[108:111], v[164:167], v[104:107]
    v_mfma_f32_16x16x32_bf16 v[100:103], v[108:111], v[160:163], v[100:103]
    ds_read_b128 v[108:111], v66 offset:3776
    s_waitcnt lgkmcnt(2)
    v_mfma_f32_16x16x32_bf16 v[104:107], v[112:115], v[160:163], v[104:107]
    v_mfma_f32_16x16x32_bf16 v[100:103], v[112:115], v[156:159], v[100:103]
    s_waitcnt lgkmcnt(1)
    v_mfma_f32_16x16x32_bf16 v[104:107], v[116:119], v[156:159], v[104:107]
    v_mfma_f32_16x16x32_bf16 v[100:103], v[116:119], v[152:155], v[100:103]
    s_waitcnt lgkmcnt(0)
    v_mfma_f32_16x16x32_bf16 v[104:107], v[108:111], v[152:155], v[104:107]
    ds_write_b128 v74, v[84:87] offset:2048
    s_nop 4
    ds_write_b128 v74, v[100:103] offset:6144
    s_nop 0
    ds_write_b128 v74, v[104:107] offset:7168
    s_branch c_pw_end_57
c_pw_59:
    s_cmp_lg_u32 s34, 2
    s_cbranch_scc1 c_pw_60
    ds_read_b128 v[108:111], v66 offset:256
    ds_read_b128 v[120:123], v67 offset:224
    ds_read_b128 v[124:127], v67 offset:736
    ds_read_b128 v[128:131], v67 offset:1248
    ds_read_b128 v[132:135], v67 offset:1760
    ds_read_b128 v[136:139], v67 offset:2272
    ds_read_b128 v[140:143], v67 offset:2784
    ds_read_b128 v[144:147], v67 offset:3296
    ds_read_b128 v[148:151], v67 offset:3808
    ds_read_b128 v[112:115], v66 offset:768
    ds_read_b128 v[116:119], v66 offset:1280
    s_waitcnt lgkmcnt(2)
    v_mfma_f32_16x16x32_bf16 v[104:107], v[108:111], v[148:151], 0
    v_mfma_f32_16x16x32_bf16 v[100:103], v[108:111], v[144:147], 0
    v_mfma_f32_16x16x32_bf16 v[84:87], v[108:111], v[128:131], 0
    ds_read_b128 v[108:111], v66 offset:1792
    s_waitcnt lgkmcnt(2)
    v_mfma_f32_16x16x32_bf16 v[104:107], v[112:115], v[144:147], v[104:107]
    v_mfma_f32_16x16x32_bf16 v[100:103], v[112:115], v[140:143], v[100:103]
    v_mfma_f32_16x16x32_bf16 v[84:87], v[112:115], v[124:127], v[84:87]
    ds_read_b128 v[112:115], v66 offset:2304
    ds_read_b128 v[152:155], v67 offset:160
    ds_read_b128 v[156:159], v67 offset:672
    ds_read_b128 v[160:163], v67 offset:1184
    ds_read_b128 v[164:167], v67 offset:1696
    ds_read_b128 v[168:171], v67 offset:2208
    ds_read_b128 v[172:175], v67 offset:2720
    ds_read_b128 v[176:179], v67 offset:3232
    ds_read_b128 v[180:183], v67 offset:3744
    s_waitcnt lgkmcnt(10)
    v_mfma_f32_16x16x32_bf16 v[104:107], v[116:119], v[140:143], v[104:107]
    v_mfma_f32_16x16x32_bf16 v[100:103], v[116:119], v[136:139], v[100:103]
    v_mfma_f32_16x16x32_bf16 v[84:87], v[116:119], v[120:123], v[84:87]
    ds_read_b128 v[116:119], v66 offset:2816
    s_waitcnt lgkmcnt(10)
    v_mfma_f32_16x16x32_bf16 v[104:107], v[108:111], v[136:139], v[104:107]
    v_mfma_f32_16x16x32_bf16 v[100:103], v[108:111], v[132:135], v[100:103]
    ds_read_b128 v[108:111], v66 offset:3328
    s_waitcnt lgkmcnt(10)
    v_mfma_f32_16x16x32_bf16 v[104:107], v[112:115], v[132:135], v[104:107]
    v_mfma_f32_16x16x32_bf16 v[100:103], v[112:115], v[128:131], v[100:103]
    ds_read_b128 v[112:115], v66 offset:3840
    s_waitcnt lgkmcnt(2)
    v_mfma_f32_16x16x32_bf16 v[104:107], v[116:119], v[128:131], v[104:107]
    v_mfma_f32_16x16x32_bf16 v[100:103], v[116:119], v[124:127], v[100:103]
    ds_read_b128 v[116:119], v66 offset:320
    s_waitcnt lgkmcnt(2)
    v_mfma_f32_16x16x32_bf16 v[104:107], v[108:111], v[124:127], v[104:107]
    v_mfma_f32_16x16x32_bf16 v[100:103], v[108:111], v[120:123], v[100:103]
    ds_read_b128 v[108:111], v66 offset:832
    s_waitcnt lgkmcnt(2)
    v_mfma_f32_16x16x32_bf16 v[104:107], v[112:115], v[120:123], v[104:107]
    ds_read_b128 v[112:115], v66 offset:1344
    s_waitcnt lgkmcnt(2)
    v_mfma_f32_16x16x32_bf16 v[104:107], v[116:119], v[180:183], v[104:107]
    v_mfma_f32_16x16x32_bf16 v[100:103], v[116:119], v[176:179], v[100:103]
    v_mfma_f32_16x16x32_bf16 v[84:87], v[116:119], v[160:163], v[84:87]
    ds_read_b128 v[116:119], v66 offset:1856
    s_waitcnt lgkmcnt(2)
    v_mfma_f32_16x16x32_bf16 v[104:107], v[108:111], v[176:179], v[104:107]
    v_mfma_f32_16x16x32_bf16 v[100:103], v[108:111], v[172:175], v[100:103]
    v_mfma_f32_16x16x32_bf16 v[84:87], v[108:111], v[156:159], v[84:87]
    ds_read_b128 v[108:111], v66 offset:2368
    s_waitcnt lgkmcnt(2)
    v_mfma_f32_16x16x32_bf16 v[104:107], v[112:115], v[172:175], v[104:107]
    v_mfma_f32_16x16x32_bf16 v[100:103], v[112:115], v[168:171], v[100:103]
    v_mfma_f32_16x16x32_bf16 v[84:87], v[112:115], v[152:155], v[84:87]
    ds_read_b128 v[112:115], v66 offset:2880
    s_waitcnt lgkmcnt(2)
    v_mfma_f32_16x16x32_bf16 v[104:107], v[116:119], v[168:171], v[104:107]
    v_mfma_f32_16x16x32_bf16 v[100:103], v[116:119], v[164:167], v[100:103]
    ds_read_b128 v[116:119], v66 offset:3392
    s_waitcnt lgkmcnt(2)
    v_mfma_f32_16x16x32_bf16 v[104:107], v[108:111], v[164:167], v[104:107]
    v_mfma_f32_16x16x32_bf16 v[100:103], v[108:111], v[160:163], v[100:103]
    ds_read_b128 v[108:111], v66 offset:3904
    s_waitcnt lgkmcnt(2)
    v_mfma_f32_16x16x32_bf16 v[104:107], v[112:115], v[160:163], v[104:107]
    v_mfma_f32_16x16x32_bf16 v[100:103], v[112:115], v[156:159], v[100:103]
    s_waitcnt lgkmcnt(1)
    v_mfma_f32_16x16x32_bf16 v[104:107], v[116:119], v[156:159], v[104:107]
    v_mfma_f32_16x16x32_bf16 v[100:103], v[116:119], v[152:155], v[100:103]
    s_waitcnt lgkmcnt(0)
    v_mfma_f32_16x16x32_bf16 v[104:107], v[108:111], v[152:155], v[104:107]
    ds_write_b128 v74, v[84:87] offset:2048
    s_nop 4
    ds_write_b128 v74, v[100:103] offset:6144
    s_nop 0
    ds_write_b128 v74, v[104:107] offset:7168
    s_branch c_pw_end_57
c_pw_60:
    ds_read_b128 v[108:111], v66 offset:384
    ds_read_b128 v[120:123], v67 offset:96
    ds_read_b128 v[124:127], v67 offset:608
    ds_read_b128 v[128:131], v67 offset:1120
    ds_read_b128 v[132:135], v67 offset:1632
    ds_read_b128 v[136:139], v67 offset:2144
    ds_read_b128 v[140:143], v67 offset:2656
    ds_read_b128 v[144:147], v67 offset:3168
    ds_read_b128 v[148:151], v67 offset:3680
    ds_read_b128 v[112:115], v66 offset:896
    ds_read_b128 v[116:119], v66 offset:1408
    s_waitcnt lgkmcnt(2)
    v_mfma_f32_16x16x32_bf16 v[104:107], v[108:111], v[148:151], 0
    v_mfma_f32_16x16x32_bf16 v[100:103], v[108:111], v[144:147], 0
    v_mfma_f32_16x16x32_bf16 v[84:87], v[108:111], v[128:131], 0
    ds_read_b128 v[108:111], v66 offset:1920
    s_waitcnt lgkmcnt(2)
    v_mfma_f32_16x16x32_bf16 v[104:107], v[112:115], v[144:147], v[104:107]
    v_mfma_f32_16x16x32_bf16 v[100:103], v[112:115], v[140:143], v[100:103]
    v_mfma_f32_16x16x32_bf16 v[84:87], v[112:115], v[124:127], v[84:87]
    ds_read_b128 v[112:115], v66 offset:2432
    ds_read_b128 v[152:155], v67 offset:32
    ds_read_b128 v[156:159], v67 offset:544
    ds_read_b128 v[160:163], v67 offset:1056
    ds_read_b128 v[164:167], v67 offset:1568
    ds_read_b128 v[168:171], v67 offset:2080
    ds_read_b128 v[172:175], v67 offset:2592
    ds_read_b128 v[176:179], v67 offset:3104
    ds_read_b128 v[180:183], v67 offset:3616
    s_waitcnt lgkmcnt(10)
    v_mfma_f32_16x16x32_bf16 v[104:107], v[116:119], v[140:143], v[104:107]
    v_mfma_f32_16x16x32_bf16 v[100:103], v[116:119], v[136:139], v[100:103]
    v_mfma_f32_16x16x32_bf16 v[84:87], v[116:119], v[120:123], v[84:87]
    ds_read_b128 v[116:119], v66 offset:2944
    s_waitcnt lgkmcnt(10)
    v_mfma_f32_16x16x32_bf16 v[104:107], v[108:111], v[136:139], v[104:107]
    v_mfma_f32_16x16x32_bf16 v[100:103], v[108:111], v[132:135], v[100:103]
    ds_read_b128 v[108:111], v66 offset:3456
    s_waitcnt lgkmcnt(10)
    v_mfma_f32_16x16x32_bf16 v[104:107], v[112:115], v[132:135], v[104:107]
    v_mfma_f32_16x16x32_bf16 v[100:103], v[112:115], v[128:131], v[100:103]
    ds_read_b128 v[112:115], v66 offset:3968
    s_waitcnt lgkmcnt(2)
    v_mfma_f32_16x16x32_bf16 v[104:107], v[116:119], v[128:131], v[104:107]
    v_mfma_f32_16x16x32_bf16 v[100:103], v[116:119], v[124:127], v[100:103]
    ds_read_b128 v[116:119], v66 offset:448
    s_waitcnt lgkmcnt(2)
    v_mfma_f32_16x16x32_bf16 v[104:107], v[108:111], v[124:127], v[104:107]
    v_mfma_f32_16x16x32_bf16 v[100:103], v[108:111], v[120:123], v[100:103]
    ds_read_b128 v[108:111], v66 offset:960
    s_waitcnt lgkmcnt(2)
    v_mfma_f32_16x16x32_bf16 v[104:107], v[112:115], v[120:123], v[104:107]
    ds_read_b128 v[112:115], v66 offset:1472
    s_waitcnt lgkmcnt(2)
    v_mfma_f32_16x16x32_bf16 v[104:107], v[116:119], v[180:183], v[104:107]
    v_mfma_f32_16x16x32_bf16 v[100:103], v[116:119], v[176:179], v[100:103]
    v_mfma_f32_16x16x32_bf16 v[84:87], v[116:119], v[160:163], v[84:87]
    ds_read_b128 v[116:119], v66 offset:1984
    s_waitcnt lgkmcnt(2)
    v_mfma_f32_16x16x32_bf16 v[104:107], v[108:111], v[176:179], v[104:107]
    v_mfma_f32_16x16x32_bf16 v[100:103], v[108:111], v[172:175], v[100:103]
    v_mfma_f32_16x16x32_bf16 v[84:87], v[108:111], v[156:159], v[84:87]
    ds_read_b128 v[108:111], v66 offset:2496
    s_waitcnt lgkmcnt(2)
    v_mfma_f32_16x16x32_bf16 v[104:107], v[112:115], v[172:175], v[104:107]
    v_mfma_f32_16x16x32_bf16 v[100:103], v[112:115], v[168:171], v[100:103]
    v_mfma_f32_16x16x32_bf16 v[84:87], v[112:115], v[152:155], v[84:87]
    ds_read_b128 v[112:115], v66 offset:3008
    s_waitcnt lgkmcnt(2)
    v_mfma_f32_16x16x32_bf16 v[104:107], v[116:119], v[168:171], v[104:107]
    v_mfma_f32_16x16x32_bf16 v[100:103], v[116:119], v[164:167], v[100:103]
    ds_read_b128 v[116:119], v66 offset:3520
    s_waitcnt lgkmcnt(2)
    v_mfma_f32_16x16x32_bf16 v[104:107], v[108:111], v[164:167], v[104:107]
    v_mfma_f32_16x16x32_bf16 v[100:103], v[108:111], v[160:163], v[100:103]
    ds_read_b128 v[108:111], v66 offset:4032
    s_waitcnt lgkmcnt(2)
    v_mfma_f32_16x16x32_bf16 v[104:107], v[112:115], v[160:163], v[104:107]
    v_mfma_f32_16x16x32_bf16 v[100:103], v[112:115], v[156:159], v[100:103]
    s_waitcnt lgkmcnt(1)
    v_mfma_f32_16x16x32_bf16 v[104:107], v[116:119], v[156:159], v[104:107]
    v_mfma_f32_16x16x32_bf16 v[100:103], v[116:119], v[152:155], v[100:103]
    s_waitcnt lgkmcnt(0)
    v_mfma_f32_16x16x32_bf16 v[104:107], v[108:111], v[152:155], v[104:107]
    ds_write_b128 v74, v[84:87] offset:2048
    s_nop 4
    ds_write_b128 v74, v[100:103] offset:6144
    s_nop 0
    ds_write_b128 v74, v[104:107] offset:7168
c_pw_end_57:
    s_waitcnt lgkmcnt(0)
    v_mov_b32 v3, 161796
    v_mov_b32 v4, 1
    s_mov_b64 exec, 1
    ds_add_u32 v3, v4
    s_mov_b64 exec, -1
    s_mov_b32 s67, 0
gsync_62:
    ds_read_b32 v4, v3
    s_add_u32 s67, s67, 1
    s_waitcnt lgkmcnt(0)
    v_readfirstlane_b32 s66, v4
    s_cmp_gt_u32 s67, 1000000
    s_cbranch_scc1 gsync_e_63
    s_cmp_lt_u32 s66, 24
    s_cbranch_scc1 gsync_62
gsync_e_63:
    s_mov_b64 exec, 0
    s_cmp_eq_u32 s34, 0
    s_cselect_b32 exec_lo, 0, exec_lo
    s_cselect_b32 exec_hi, 0, exec_hi
    s_cmp_eq_u32 s34, 1
    s_cselect_b32 exec_lo, -1, exec_lo
    s_cselect_b32 exec_hi, 0, exec_hi
    s_cmp_eq_u32 s34, 2
    s_cselect_b32 exec_lo, 0, exec_lo
    s_cselect_b32 exec_hi, 0, exec_hi
    s_cmp_eq_u32 s34, 3
    s_cselect_b32 exec_lo, -1, exec_lo
    s_cselect_b32 exec_hi, -1, exec_hi
    s_cbranch_execz c_fskip_65
    ds_read_b128 v[120:123], v75 offset:0
    ds_read_b128 v[124:127], v75 offset:16
    ds_read_b128 v[128:131], v75 offset:8192
    ds_read_b128 v[132:135], v75 offset:8208
    ds_read_b128 v[136:139], v75 offset:16384
    ds_read_b128 v[140:143], v75 offset:16400
    ds_read_b128 v[144:147], v75 offset:24576
    ds_read_b128 v[148:151], v75 offset:24592
    s_lshl_b32 s40, s58, 12
    s_add_u32 s40, s40, 8912896
    s_waitcnt lgkmcnt(0)
    v_pk_add_f32 v[120:121], v[120:121], v[128:129]
    v_pk_add_f32 v[136:137], v[136:137], v[144:145]
    v_pk_add_f32 v[122:123], v[122:123], v[130:131]
    v_pk_add_f32 v[138:139], v[138:139], v[146:147]
    v_pk_add_f32 v[124:125], v[124:125], v[132:133]
    v_pk_add_f32 v[140:141], v[140:141], v[148:149]
    v_pk_add_f32 v[126:127], v[126:127], v[134:135]
    v_pk_add_f32 v[142:143], v[142:143], v[150:151]
    v_pk_add_f32 v[120:121], v[120:121], v[136:137]
    v_pk_add_f32 v[122:123], v[122:123], v[138:139]
    v_pk_add_f32 v[124:125], v[124:125], v[140:141]
    v_pk_add_f32 v[126:127], v[126:127], v[142:143]
    v_cvt_pk_bf16_f32 v192, v120, v121
    v_cvt_pk_bf16_f32 v193, v122, v123
    v_cvt_pk_bf16_f32 v194, v124, v125
    v_cvt_pk_bf16_f32 v195, v126, v127
    buffer_store_dwordx4 v[192:195], v2, s[8:11], s40 offen sc1
c_fskip_65:
    s_mov_b64 exec, -1
    s_nop 1
    s_branch c_halfE_56
c_halfB_55:
    s_cmp_lg_u32 s34, 0
    s_cbranch_scc1 c_pw_67
    ds_read_b128 v[108:111], v66 offset:0
    ds_read_b128 v[120:123], v67 offset:480
    ds_read_b128 v[124:127], v67 offset:992
    ds_read_b128 v[128:131], v67 offset:1504
    ds_read_b128 v[132:135], v67 offset:2016
    ds_read_b128 v[136:139], v67 offset:2528
    ds_read_b128 v[140:143], v67 offset:3040
    ds_read_b128 v[112:115], v66 offset:512
    ds_read_b128 v[116:119], v66 offset:1024
    s_waitcnt lgkmcnt(2)
    v_mfma_f32_16x16x32_bf16 v[96:99], v[108:111], v[140:143], 0
    v_mfma_f32_16x16x32_bf16 v[92:95], v[108:111], v[136:139], 0
    v_mfma_f32_16x16x32_bf16 v[88:91], v[108:111], v[132:135], 0
    v_mfma_f32_16x16x32_bf16 v[80:83], v[108:111], v[124:127], 0
    v_mfma_f32_16x16x32_bf16 v[76:79], v[108:111], v[120:123], 0
    v_mfma_f32_16x16x32_bf16 v[76:79], v[196:199], v[120:123], v[76:79]
    v_mfma_f32_16x16x32_bf16 v[80:83], v[196:199], v[124:127], v[80:83]
    v_mfma_f32_16x16x32_bf16 v[88:91], v[196:199], v[132:135], v[88:91]
    v_mfma_f32_16x16x32_bf16 v[92:95], v[196:199], v[136:139], v[92:95]
    v_mfma_f32_16x16x32_bf16 v[96:99], v[196:199], v[140:143], v[96:99]
    ds_read_b128 v[108:111], v66 offset:1536
    s_waitcnt lgkmcnt(2)
    v_mfma_f32_16x16x32_bf16 v[96:99], v[112:115], v[136:139], v[96:99]
    v_mfma_f32_16x16x32_bf16 v[92:95], v[112:115], v[132:135], v[92:95]
    v_mfma_f32_16x16x32_bf16 v[88:91], v[112:115], v[128:131], v[88:91]
    v_mfma_f32_16x16x32_bf16 v[80:83], v[112:115], v[120:123], v[80:83]
    ds_read_b128 v[112:115], v66 offset:2048
    ds_read_b128 v[152:155], v67 offset:416
    ds_read_b128 v[156:159], v67 offset:928
    ds_read_b128 v[160:163], v67 offset:1440
    ds_read_b128 v[164:167], v67 offset:1952
    ds_read_b128 v[168:171], v67 offset:2464
    ds_read_b128 v[172:175], v67 offset:2976
    s_waitcnt lgkmcnt(8)
    v_mfma_f32_16x16x32_bf16 v[96:99], v[116:119], v[132:135], v[96:99]
    v_mfma_f32_16x16x32_bf16 v[92:95], v[116:119], v[128:131], v[92:95]
    v_mfma_f32_16x16x32_bf16 v[88:91], v[116:119], v[124:127], v[88:91]
    ds_read_b128 v[116:119], v66 offset:2560
    s_waitcnt lgkmcnt(8)
    v_mfma_f32_16x16x32_bf16 v[96:99], v[108:111], v[128:131], v[96:99]
    v_mfma_f32_16x16x32_bf16 v[92:95], v[108:111], v[124:127], v[92:95]
    v_mfma_f32_16x16x32_bf16 v[88:91], v[108:111], v[120:123], v[88:91]
    ds_read_b128 v[108:111], v66 offset:64
    s_waitcnt lgkmcnt(8)
    v_mfma_f32_16x16x32_bf16 v[96:99], v[112:115], v[124:127], v[96:99]
    v_mfma_f32_16x16x32_bf16 v[92:95], v[112:115], v[120:123], v[92:95]
    ds_read_b128 v[112:115], v66 offset:576
    s_waitcnt lgkmcnt(2)
    v_mfma_f32_16x16x32_bf16 v[96:99], v[116:119], v[120:123], v[96:99]
    ds_read_b128 v[116:119], v66 offset:1088
    s_waitcnt lgkmcnt(2)
    v_mfma_f32_16x16x32_bf16 v[96:99], v[108:111], v[172:175], v[96:99]
    v_mfma_f32_16x16x32_bf16 v[92:95], v[108:111], v[168:171], v[92:95]
    v_mfma_f32_16x16x32_bf16 v[88:91], v[108:111], v[164:167], v[88:91]
    v_mfma_f32_16x16x32_bf16 v[80:83], v[108:111], v[156:159], v[80:83]
    v_mfma_f32_16x16x32_bf16 v[76:79], v[108:111], v[152:155], v[76:79]
    ds_read_b128 v[108:111], v66 offset:1600
    s_waitcnt lgkmcnt(2)
    v_mfma_f32_16x16x32_bf16 v[96:99], v[112:115], v[168:171], v[96:99]
    v_mfma_f32_16x16x32_bf16 v[92:95], v[112:115], v[164:167], v[92:95]
    v_mfma_f32_16x16x32_bf16 v[88:91], v[112:115], v[160:163], v[88:91]
    v_mfma_f32_16x16x32_bf16 v[80:83], v[112:115], v[152:155], v[80:83]
    ds_read_b128 v[112:115], v66 offset:2112
    s_waitcnt lgkmcnt(2)
    v_mfma_f32_16x16x32_bf16 v[96:99], v[116:119], v[164:167], v[96:99]
    v_mfma_f32_16x16x32_bf16 v[92:95], v[116:119], v[160:163], v[92:95]
    v_mfma_f32_16x16x32_bf16 v[88:91], v[116:119], v[156:159], v[88:91]
    ds_read_b128 v[116:119], v66 offset:2624
    s_waitcnt lgkmcnt(2)
    v_mfma_f32_16x16x32_bf16 v[96:99], v[108:111], v[160:163], v[96:99]
    v_mfma_f32_16x16x32_bf16 v[92:95], v[108:111], v[156:159], v[92:95]
    v_mfma_f32_16x16x32_bf16 v[88:91], v[108:111], v[152:155], v[88:91]
    s_waitcnt lgkmcnt(1)
    v_mfma_f32_16x16x32_bf16 v[96:99], v[112:115], v[156:159], v[96:99]
    v_mfma_f32_16x16x32_bf16 v[92:95], v[112:115], v[152:155], v[92:95]
    s_waitcnt lgkmcnt(0)
    v_mfma_f32_16x16x32_bf16 v[96:99], v[116:119], v[152:155], v[96:99]
    ds_write_b128 v74, v[76:79] offset:0
    ds_write_b128 v74, v[80:83] offset:1024
    s_nop 0
    ds_write_b128 v74, v[88:91] offset:3072
    s_nop 1
    ds_write_b128 v74, v[92:95] offset:4096
    s_nop 0
    ds_write_b128 v74, v[96:99] offset:5120
    s_branch c_pw_end_66
c_pw_67:
    s_cmp_lg_u32 s34, 1
    s_cbranch_scc1 c_pw_68
    ds_read_b128 v[108:111], v66 offset:128
    ds_read_b128 v[120:123], v67 offset:352
    ds_read_b128 v[124:127], v67 offset:864
    ds_read_b128 v[128:131], v67 offset:1376
    ds_read_b128 v[132:135], v67 offset:1888
    ds_read_b128 v[136:139], v67 offset:2400
    ds_read_b128 v[140:143], v67 offset:2912
    ds_read_b128 v[112:115], v66 offset:640
    ds_read_b128 v[116:119], v66 offset:1152
    s_waitcnt lgkmcnt(2)
    v_mfma_f32_16x16x32_bf16 v[96:99], v[108:111], v[140:143], 0
    v_mfma_f32_16x16x32_bf16 v[92:95], v[108:111], v[136:139], 0
    v_mfma_f32_16x16x32_bf16 v[88:91], v[108:111], v[132:135], 0
    v_mfma_f32_16x16x32_bf16 v[80:83], v[108:111], v[124:127], 0
    v_mfma_f32_16x16x32_bf16 v[76:79], v[108:111], v[120:123], 0
    ds_read_b128 v[108:111], v66 offset:1664
    s_waitcnt lgkmcnt(2)
    v_mfma_f32_16x16x32_bf16 v[96:99], v[112:115], v[136:139], v[96:99]
    v_mfma_f32_16x16x32_bf16 v[92:95], v[112:115], v[132:135], v[92:95]
    v_mfma_f32_16x16x32_bf16 v[88:91], v[112:115], v[128:131], v[88:91]
    v_mfma_f32_16x16x32_bf16 v[80:83], v[112:115], v[120:123], v[80:83]
    ds_read_b128 v[112:115], v66 offset:2176
    ds_read_b128 v[152:155], v67 offset:288
    ds_read_b128 v[156:159], v67 offset:800
    ds_read_b128 v[160:163], v67 offset:1312
    ds_read_b128 v[164:167], v67 offset:1824
    ds_read_b128 v[168:171], v67 offset:2336
    ds_read_b128 v[172:175], v67 offset:2848
    s_waitcnt lgkmcnt(8)
    v_mfma_f32_16x16x32_bf16 v[96:99], v[116:119], v[132:135], v[96:99]
    v_mfma_f32_16x16x32_bf16 v[92:95], v[116:119], v[128:131], v[92:95]
    v_mfma_f32_16x16x32_bf16 v[88:91], v[116:119], v[124:127], v[88:91]
    ds_read_b128 v[116:119], v66 offset:2688
    s_waitcnt lgkmcnt(8)
    v_mfma_f32_16x16x32_bf16 v[96:99], v[108:111], v[128:131], v[96:99]
    v_mfma_f32_16x16x32_bf16 v[92:95], v[108:111], v[124:127], v[92:95]
    v_mfma_f32_16x16x32_bf16 v[88:91], v[108:111], v[120:123], v[88:91]
    ds_read_b128 v[108:111], v66 offset:192
    s_waitcnt lgkmcnt(8)
    v_mfma_f32_16x16x32_bf16 v[96:99], v[112:115], v[124:127], v[96:99]
    v_mfma_f32_16x16x32_bf16 v[92:95], v[112:115], v[120:123], v[92:95]
    ds_read_b128 v[112:115], v66 offset:704
    s_waitcnt lgkmcnt(2)
    v_mfma_f32_16x16x32_bf16 v[96:99], v[116:119], v[120:123], v[96:99]
    ds_read_b128 v[116:119], v66 offset:1216
    s_waitcnt lgkmcnt(2)
    v_mfma_f32_16x16x32_bf16 v[96:99], v[108:111], v[172:175], v[96:99]
    v_mfma_f32_16x16x32_bf16 v[92:95], v[108:111], v[168:171], v[92:95]
    v_mfma_f32_16x16x32_bf16 v[88:91], v[108:111], v[164:167], v[88:91]
    v_mfma_f32_16x16x32_bf16 v[80:83], v[108:111], v[156:159], v[80:83]
    v_mfma_f32_16x16x32_bf16 v[76:79], v[108:111], v[152:155], v[76:79]
    ds_read_b128 v[108:111], v66 offset:1728
    s_waitcnt lgkmcnt(2)
    v_mfma_f32_16x16x32_bf16 v[96:99], v[112:115], v[168:171], v[96:99]
    v_mfma_f32_16x16x32_bf16 v[92:95], v[112:115], v[164:167], v[92:95]
    v_mfma_f32_16x16x32_bf16 v[88:91], v[112:115], v[160:163], v[88:91]
    v_mfma_f32_16x16x32_bf16 v[80:83], v[112:115], v[152:155], v[80:83]
    ds_read_b128 v[112:115], v66 offset:2240
    s_waitcnt lgkmcnt(2)
    v_mfma_f32_16x16x32_bf16 v[96:99], v[116:119], v[164:167], v[96:99]
    v_mfma_f32_16x16x32_bf16 v[92:95], v[116:119], v[160:163], v[92:95]
    v_mfma_f32_16x16x32_bf16 v[88:91], v[116:119], v[156:159], v[88:91]
    ds_read_b128 v[116:119], v66 offset:2752
    s_waitcnt lgkmcnt(2)
    v_mfma_f32_16x16x32_bf16 v[96:99], v[108:111], v[160:163], v[96:99]
    v_mfma_f32_16x16x32_bf16 v[92:95], v[108:111], v[156:159], v[92:95]
    v_mfma_f32_16x16x32_bf16 v[88:91], v[108:111], v[152:155], v[88:91]
    s_waitcnt lgkmcnt(1)
    v_mfma_f32_16x16x32_bf16 v[96:99], v[112:115], v[156:159], v[96:99]
    v_mfma_f32_16x16x32_bf16 v[92:95], v[112:115], v[152:155], v[92:95]
    s_waitcnt lgkmcnt(0)
    v_mfma_f32_16x16x32_bf16 v[96:99], v[116:119], v[152:155], v[96:99]
    ds_write_b128 v74, v[76:79] offset:0
    ds_write_b128 v74, v[80:83] offset:1024
    s_nop 0
    ds_write_b128 v74, v[88:91] offset:3072
    s_nop 1
    ds_write_b128 v74, v[92:95] offset:4096
    s_nop 0
    ds_write_b128 v74, v[96:99] offset:5120
    s_branch c_pw_end_66
c_pw_68:
    s_cmp_lg_u32 s34, 2
    s_cbranch_scc1 c_pw_69
    ds_read_b128 v[108:111], v66 offset:256
    ds_read_b128 v[120:123], v67 offset:224
    ds_read_b128 v[124:127], v67 offset:736
    ds_read_b128 v[128:131], v67 offset:1248
    ds_read_b128 v[132:135], v67 offset:1760
    ds_read_b128 v[136:139], v67 offset:2272
    ds_read_b128 v[140:143], v67 offset:2784
    ds_read_b128 v[112:115], v66 offset:768
    ds_read_b128 v[116:119], v66 offset:1280
    s_waitcnt lgkmcnt(2)
    v_mfma_f32_16x16x32_bf16 v[96:99], v[108:111], v[140:143], 0
    v_mfma_f32_16x16x32_bf16 v[92:95], v[108:111], v[136:139], 0
    v_mfma_f32_16x16x32_bf16 v[88:91], v[108:111], v[132:135], 0
    v_mfma_f32_16x16x32_bf16 v[80:83], v[108:111], v[124:127], 0
    v_mfma_f32_16x16x32_bf16 v[76:79], v[108:111], v[120:123], 0
    ds_read_b128 v[108:111], v66 offset:1792
    s_waitcnt lgkmcnt(2)
    v_mfma_f32_16x16x32_bf16 v[96:99], v[112:115], v[136:139], v[96:99]
    v_mfma_f32_16x16x32_bf16 v[92:95], v[112:115], v[132:135], v[92:95]
    v_mfma_f32_16x16x32_bf16 v[88:91], v[112:115], v[128:131], v[88:91]
    v_mfma_f32_16x16x32_bf16 v[80:83], v[112:115], v[120:123], v[80:83]
    ds_read_b128 v[112:115], v66 offset:2304
    ds_read_b128 v[152:155], v67 offset:160
    ds_read_b128 v[156:159], v67 offset:672
    ds_read_b128 v[160:163], v67 offset:1184
    ds_read_b128 v[164:167], v67 offset:1696
    ds_read_b128 v[168:171], v67 offset:2208
    ds_read_b128 v[172:175], v67 offset:2720
    s_waitcnt lgkmcnt(8)
    v_mfma_f32_16x16x32_bf16 v[96:99], v[116:119], v[132:135], v[96:99]
    v_mfma_f32_16x16x32_bf16 v[92:95], v[116:119], v[128:131], v[92:95]
    v_mfma_f32_16x16x32_bf16 v[88:91], v[116:119], v[124:127], v[88:91]
    ds_read_b128 v[116:119], v66 offset:2816
    s_waitcnt lgkmcnt(8)
    v_mfma_f32_16x16x32_bf16 v[96:99], v[108:111], v[128:131], v[96:99]
    v_mfma_f32_16x16x32_bf16 v[92:95], v[108:111], v[124:127], v[92:95]
    v_mfma_f32_16x16x32_bf16 v[88:91], v[108:111], v[120:123], v[88:91]
    ds_read_b128 v[108:111], v66 offset:320
    s_waitcnt lgkmcnt(8)
    v_mfma_f32_16x16x32_bf16 v[96:99], v[112:115], v[124:127], v[96:99]
    v_mfma_f32_16x16x32_bf16 v[92:95], v[112:115], v[120:123], v[92:95]
    ds_read_b128 v[112:115], v66 offset:832
    s_waitcnt lgkmcnt(2)
    v_mfma_f32_16x16x32_bf16 v[96:99], v[116:119], v[120:123], v[96:99]
    ds_read_b128 v[116:119], v66 offset:1344
    s_waitcnt lgkmcnt(2)
    v_mfma_f32_16x16x32_bf16 v[96:99], v[108:111], v[172:175], v[96:99]
    v_mfma_f32_16x16x32_bf16 v[92:95], v[108:111], v[168:171], v[92:95]
    v_mfma_f32_16x16x32_bf16 v[88:91], v[108:111], v[164:167], v[88:91]
    v_mfma_f32_16x16x32_bf16 v[80:83], v[108:111], v[156:159], v[80:83]
    v_mfma_f32_16x16x32_bf16 v[76:79], v[108:111], v[152:155], v[76:79]
    ds_read_b128 v[108:111], v66 offset:1856
    s_waitcnt lgkmcnt(2)
    v_mfma_f32_16x16x32_bf16 v[96:99], v[112:115], v[168:171], v[96:99]
    v_mfma_f32_16x16x32_bf16 v[92:95], v[112:115], v[164:167], v[92:95]
    v_mfma_f32_16x16x32_bf16 v[88:91], v[112:115], v[160:163], v[88:91]
    v_mfma_f32_16x16x32_bf16 v[80:83], v[112:115], v[152:155], v[80:83]
    ds_read_b128 v[112:115], v66 offset:2368
    s_waitcnt lgkmcnt(2)
    v_mfma_f32_16x16x32_bf16 v[96:99], v[116:119], v[164:167], v[96:99]
    v_mfma_f32_16x16x32_bf16 v[92:95], v[116:119], v[160:163], v[92:95]
    v_mfma_f32_16x16x32_bf16 v[88:91], v[116:119], v[156:159], v[88:91]
    ds_read_b128 v[116:119], v66 offset:2880
    s_waitcnt lgkmcnt(2)
    v_mfma_f32_16x16x32_bf16 v[96:99], v[108:111], v[160:163], v[96:99]
    v_mfma_f32_16x16x32_bf16 v[92:95], v[108:111], v[156:159], v[92:95]
    v_mfma_f32_16x16x32_bf16 v[88:91], v[108:111], v[152:155], v[88:91]
    s_waitcnt lgkmcnt(1)
    v_mfma_f32_16x16x32_bf16 v[96:99], v[112:115], v[156:159], v[96:99]
    v_mfma_f32_16x16x32_bf16 v[92:95], v[112:115], v[152:155], v[92:95]
    s_waitcnt lgkmcnt(0)
    v_mfma_f32_16x16x32_bf16 v[96:99], v[116:119], v[152:155], v[96:99]
    ds_write_b128 v74, v[76:79] offset:0
    ds_write_b128 v74, v[80:83] offset:1024
    s_nop 0
    ds_write_b128 v74, v[88:91] offset:3072
    s_nop 1
    ds_write_b128 v74, v[92:95] offset:4096
    s_nop 0
    ds_write_b128 v74, v[96:99] offset:5120
    s_branch c_pw_end_66
c_pw_69:
    ds_read_b128 v[108:111], v66 offset:384
    ds_read_b128 v[120:123], v67 offset:96
    ds_read_b128 v[124:127], v67 offset:608
    ds_read_b128 v[128:131], v67 offset:1120
    ds_read_b128 v[132:135], v67 offset:1632
    ds_read_b128 v[136:139], v67 offset:2144
    ds_read_b128 v[140:143], v67 offset:2656
    ds_read_b128 v[112:115], v66 offset:896
    ds_read_b128 v[116:119], v66 offset:1408
    s_waitcnt lgkmcnt(2)
    v_mfma_f32_16x16x32_bf16 v[96:99], v[108:111], v[140:143], 0
    v_mfma_f32_16x16x32_bf16 v[92:95], v[108:111], v[136:139], 0
    v_mfma_f32_16x16x32_bf16 v[88:91], v[108:111], v[132:135], 0
    v_mfma_f32_16x16x32_bf16 v[80:83], v[108:111], v[124:127], 0
    v_mfma_f32_16x16x32_bf16 v[76:79], v[108:111], v[120:123], 0
    ds_read_b128 v[108:111], v66 offset:1920
    s_waitcnt lgkmcnt(2)
    v_mfma_f32_16x16x32_bf16 v[96:99], v[112:115], v[136:139], v[96:99]
    v_mfma_f32_16x16x32_bf16 v[92:95], v[112:115], v[132:135], v[92:95]
    v_mfma_f32_16x16x32_bf16 v[88:91], v[112:115], v[128:131], v[88:91]
    v_mfma_f32_16x16x32_bf16 v[80:83], v[112:115], v[120:123], v[80:83]
    ds_read_b128 v[112:115], v66 offset:2432
    ds_read_b128 v[152:155], v67 offset:32
    ds_read_b128 v[156:159], v67 offset:544
    ds_read_b128 v[160:163], v67 offset:1056
    ds_read_b128 v[164:167], v67 offset:1568
    ds_read_b128 v[168:171], v67 offset:2080
    ds_read_b128 v[172:175], v67 offset:2592
    s_waitcnt lgkmcnt(8)
    v_mfma_f32_16x16x32_bf16 v[96:99], v[116:119], v[132:135], v[96:99]
    v_mfma_f32_16x16x32_bf16 v[92:95], v[116:119], v[128:131], v[92:95]
    v_mfma_f32_16x16x32_bf16 v[88:91], v[116:119], v[124:127], v[88:91]
    ds_read_b128 v[116:119], v66 offset:2944
    s_waitcnt lgkmcnt(8)
    v_mfma_f32_16x16x32_bf16 v[96:99], v[108:111], v[128:131], v[96:99]
    v_mfma_f32_16x16x32_bf16 v[92:95], v[108:111], v[124:127], v[92:95]
    v_mfma_f32_16x16x32_bf16 v[88:91], v[108:111], v[120:123], v[88:91]
    ds_read_b128 v[108:111], v66 offset:448
    s_waitcnt lgkmcnt(8)
    v_mfma_f32_16x16x32_bf16 v[96:99], v[112:115], v[124:127], v[96:99]
    v_mfma_f32_16x16x32_bf16 v[92:95], v[112:115], v[120:123], v[92:95]
    ds_read_b128 v[112:115], v66 offset:960
    s_waitcnt lgkmcnt(2)
    v_mfma_f32_16x16x32_bf16 v[96:99], v[116:119], v[120:123], v[96:99]
    ds_read_b128 v[116:119], v66 offset:1472
    s_waitcnt lgkmcnt(2)
    v_mfma_f32_16x16x32_bf16 v[96:99], v[108:111], v[172:175], v[96:99]
    v_mfma_f32_16x16x32_bf16 v[92:95], v[108:111], v[168:171], v[92:95]
    v_mfma_f32_16x16x32_bf16 v[88:91], v[108:111], v[164:167], v[88:91]
    v_mfma_f32_16x16x32_bf16 v[80:83], v[108:111], v[156:159], v[80:83]
    v_mfma_f32_16x16x32_bf16 v[76:79], v[108:111], v[152:155], v[76:79]
    ds_read_b128 v[108:111], v66 offset:1984
    s_waitcnt lgkmcnt(2)
    v_mfma_f32_16x16x32_bf16 v[96:99], v[112:115], v[168:171], v[96:99]
    v_mfma_f32_16x16x32_bf16 v[92:95], v[112:115], v[164:167], v[92:95]
    v_mfma_f32_16x16x32_bf16 v[88:91], v[112:115], v[160:163], v[88:91]
    v_mfma_f32_16x16x32_bf16 v[80:83], v[112:115], v[152:155], v[80:83]
    ds_read_b128 v[112:115], v66 offset:2496
    s_waitcnt lgkmcnt(2)
    v_mfma_f32_16x16x32_bf16 v[96:99], v[116:119], v[164:167], v[96:99]
    v_mfma_f32_16x16x32_bf16 v[92:95], v[116:119], v[160:163], v[92:95]
    v_mfma_f32_16x16x32_bf16 v[88:91], v[116:119], v[156:159], v[88:91]
    ds_read_b128 v[116:119], v66 offset:3008
    s_waitcnt lgkmcnt(2)
    v_mfma_f32_16x16x32_bf16 v[96:99], v[108:111], v[160:163], v[96:99]
    v_mfma_f32_16x16x32_bf16 v[92:95], v[108:111], v[156:159], v[92:95]
    v_mfma_f32_16x16x32_bf16 v[88:91], v[108:111], v[152:155], v[88:91]
    s_waitcnt lgkmcnt(1)
    v_mfma_f32_16x16x32_bf16 v[96:99], v[112:115], v[156:159], v[96:99]
    v_mfma_f32_16x16x32_bf16 v[92:95], v[112:115], v[152:155], v[92:95]
    s_waitcnt lgkmcnt(0)
    v_mfma_f32_16x16x32_bf16 v[96:99], v[116:119], v[152:155], v[96:99]
    ds_write_b128 v74, v[76:79] offset:0
    ds_write_b128 v74, v[80:83] offset:1024
    s_nop 0
    ds_write_b128 v74, v[88:91] offset:3072
    s_nop 1
    ds_write_b128 v74, v[92:95] offset:4096
    s_nop 0
    ds_write_b128 v74, v[96:99] offset:5120
c_pw_end_66:
    s_waitcnt lgkmcnt(0)
    v_mov_b32 v3, 161796
    v_mov_b32 v4, 1
    s_mov_b64 exec, 1
    ds_add_u32 v3, v4
    s_mov_b64 exec, -1
    s_mov_b32 s67, 0
gsync_71:
    ds_read_b32 v4, v3
    s_add_u32 s67, s67, 1
    s_waitcnt lgkmcnt(0)
    v_readfirstlane_b32 s66, v4
    s_cmp_gt_u32 s67, 1000000
    s_cbranch_scc1 gsync_e_72
    s_cmp_lt_u32 s66, 24
    s_cbranch_scc1 gsync_71
gsync_e_72:
    s_mov_b64 exec, 0
    s_cmp_eq_u32 s34, 0
    s_cselect_b32 exec_lo, -1, exec_lo
    s_cselect_b32 exec_hi, -1, exec_hi
    s_cmp_eq_u32 s34, 1
    s_cselect_b32 exec_lo, 0, exec_lo
    s_cselect_b32 exec_hi, -1, exec_hi
    s_cmp_eq_u32 s34, 2
    s_cselect_b32 exec_lo, -1, exec_lo
    s_cselect_b32 exec_hi, -1, exec_hi
    s_cmp_eq_u32 s34, 3
    s_cselect_b32 exec_lo, 0, exec_lo
    s_cselect_b32 exec_hi, 0, exec_hi
    s_cbranch_execz c_fskip_74
    ds_read_b128 v[120:123], v75 offset:0
    ds_read_b128 v[124:127], v75 offset:16
    ds_read_b128 v[128:131], v75 offset:8192
    ds_read_b128 v[132:135], v75 offset:8208
    ds_read_b128 v[136:139], v75 offset:16384
    ds_read_b128 v[140:143], v75 offset:16400
    ds_read_b128 v[144:147], v75 offset:24576
    ds_read_b128 v[148:151], v75 offset:24592
    s_lshl_b32 s40, s58, 12
    s_add_u32 s40, s40, 8912896
    s_waitcnt lgkmcnt(0)
    v_pk_add_f32 v[120:121], v[120:121], v[128:129]
    v_pk_add_f32 v[136:137], v[136:137], v[144:145]
    v_pk_add_f32 v[122:123], v[122:123], v[130:131]
    v_pk_add_f32 v[138:139], v[138:139], v[146:147]
    v_pk_add_f32 v[124:125], v[124:125], v[132:133]
    v_pk_add_f32 v[140:141], v[140:141], v[148:149]
    v_pk_add_f32 v[126:127], v[126:127], v[134:135]
    v_pk_add_f32 v[142:143], v[142:143], v[150:151]
    v_pk_add_f32 v[120:121], v[120:121], v[136:137]
    v_pk_add_f32 v[122:123], v[122:123], v[138:139]
    v_pk_add_f32 v[124:125], v[124:125], v[140:141]
    v_pk_add_f32 v[126:127], v[126:127], v[142:143]
    v_cvt_pk_bf16_f32 v192, v120, v121
    v_cvt_pk_bf16_f32 v193, v122, v123
    v_cvt_pk_bf16_f32 v194, v124, v125
    v_cvt_pk_bf16_f32 v195, v126, v127
    buffer_store_dwordx4 v[192:195], v2, s[8:11], s40 offen sc1
c_fskip_74:
    s_mov_b64 exec, -1
    s_nop 1
c_halfE_56:
    s_waitcnt vmcnt(0) lgkmcnt(0)
    s_barrier
recurrent_scan__ssm_conv_h3__mixer_gmlp__prompt_kernel_end:
    s_endpgm
.section .rodata,"a"
.p2align 6
.amdhsa_kernel recurrent_scan__ssm_conv_h3__mixer_gmlp__prompt_kernel
  .amdhsa_next_free_vgpr 254
  .amdhsa_next_free_sgpr 102
  .amdhsa_accum_offset 256
  .amdhsa_group_segment_fixed_size 0
  .amdhsa_kernarg_size 112
  .amdhsa_user_sgpr_count 2
  .amdhsa_user_sgpr_kernarg_segment_ptr 1
  .amdhsa_system_sgpr_workgroup_id_x 1
.end_amdhsa_kernel
```

```asm
; @launch grid=(256,1,1) block=(512,1,1) lds=163840
.amdgcn_target "amdgcn-amd-amdhsa--gfx950"
.text
.globl recurrent_scan__ssm_conv_h3__mixer_gmlp__prompt_kernel
.p2align 8
.type recurrent_scan__ssm_conv_h3__mixer_gmlp__prompt_kernel,@function
recurrent_scan__ssm_conv_h3__mixer_gmlp__prompt_kernel:
    s_cmp_ge_u32 s2, 256
    s_cbranch_scc1 recurrent_scan__ssm_conv_h3__mixer_gmlp__prompt_kernel_end
    s_load_dwordx2 s[4:5], s[0:1], 0
    s_load_dwordx2 s[8:9], s[0:1], 56
    s_load_dwordx2 s[12:13], s[0:1], 8
    s_load_dwordx2 s[16:17], s[0:1], 16
    s_load_dwordx2 s[20:21], s[0:1], 24
    s_load_dwordx2 s[24:25], s[0:1], 104
    s_load_dwordx2 s[28:29], s[0:1], 96
    s_load_dwordx2 s[32:33], s[0:1], 64
    s_load_dwordx2 s[36:37], s[0:1], 32
    s_load_dwordx2 s[84:85], s[0:1], 80
    v_lshrrev_b32 v2, 6, v0
    v_and_b32 v1, 63, v0
    v_readfirstlane_b32 s42, v2
    v_lshrrev_b32 v2, 4, v1
    v_and_b32 v3, 15, v1
    s_and_b32 s48, s2, 7
    s_lshr_b32 s49, s2, 3
    s_lshr_b32 s66, s48, 1
    s_and_b32 s67, s48, 1
    s_lshl_b32 s40, s66, 3
    s_and_b32 s48, s49, 7
    s_add_u32 s40, s40, s48
    s_lshl_b32 s41, s67, 2
    s_lshr_b32 s48, s49, 3
    s_add_u32 s41, s41, s48
    s_mul_i32 s52, s40, 81920
    s_mul_i32 s54, s41, 192
    s_add_u32 s53, s54, 1536
    s_lshl_b32 s60, s42, 11
    s_mul_i32 s61, s42, 3072
    s_mov_b32 s6, 2621440
    s_mov_b32 s7, 0x20000
    s_mov_b32 s10, 1966080
    s_mov_b32 s11, 0x20000
    s_lshl_b32 s48, s42, 3
    v_add_u32 v4, s48, v2
    v_and_b32 v5, 15, v4
    v_xor_b32 v5, v5, v3
    v_mul_u32_u24 v4, 1280, v4
    v_lshl_add_u32 v38, v5, 4, v4
    v_add_u32 v4, s48, v2
    v_add_u32 v4, 4, v4
    v_and_b32 v5, 15, v4
    v_xor_b32 v5, v5, v3
    v_mul_u32_u24 v4, 1280, v4
    v_lshl_add_u32 v39, v5, 4, v4
    s_mul_i32 s48, s42, 192
    v_add_u32 v4, s48, v1
    v_mul_u32_u24 v5, 43691, v4
    v_lshrrev_b32 v5, 19, v5
    v_mul_u32_u24 v6, 12, v5
    v_sub_u32 v4, v4, v6
    v_lshrrev_b32 v6, 2, v5
    v_and_b32 v6, 2, v6
    v_xor_b32 v4, v4, v6
    v_mul_u32_u24 v5, 3072, v5
    v_lshl_add_u32 v40, v4, 4, v5
    v_add_u32 v4, s48, v1
    v_add_u32 v4, 64, v4
    v_mul_u32_u24 v5, 43691, v4
    v_lshrrev_b32 v5, 19, v5
    v_mul_u32_u24 v6, 12, v5
    v_sub_u32 v4, v4, v6
    v_lshrrev_b32 v6, 2, v5
    v_and_b32 v6, 2, v6
    v_xor_b32 v4, v4, v6
    v_mul_u32_u24 v5, 3072, v5
    v_lshl_add_u32 v41, v4, 4, v5
    v_add_u32 v4, s48, v1
    v_add_u32 v4, 128, v4
    v_mul_u32_u24 v5, 43691, v4
    v_lshrrev_b32 v5, 19, v5
    v_mul_u32_u24 v6, 12, v5
    v_sub_u32 v4, v4, v6
    v_lshrrev_b32 v6, 2, v5
    v_and_b32 v6, 2, v6
    v_xor_b32 v4, v4, v6
    v_mul_u32_u24 v5, 3072, v5
    v_lshl_add_u32 v42, v4, 4, v5
    s_add_u32 s48, s40, s41
    s_mul_i32 s49, s48, 52
    s_lshr_b32 s49, s49, 8
    s_mul_i32 s49, s49, 5
    s_sub_u32 s51, s48, s49
    s_add_u32 s49, s51, 0
    s_sub_u32 s50, s49, 5
    s_cmp_ge_u32 s49, 5
    s_cselect_b32 s49, s50, s49
    s_lshl_b32 s90, s49, 8
    s_mul_i32 s95, s49, 393216
    s_add_u32 s49, s51, 1
    s_sub_u32 s50, s49, 5
    s_cmp_ge_u32 s49, 5
    s_cselect_b32 s49, s50, s49
    s_lshl_b32 s91, s49, 8
    s_mul_i32 s96, s49, 393216
    s_waitcnt lgkmcnt(0)
    s_add_u32 s65, s52, s90
    s_add_u32 m0, s60, 0
    s_nop 0
    buffer_load_dwordx4 v38, s[4:7], s65 offen lds
    s_add_u32 s65, s52, s90
    s_add_u32 m0, s60, 1024
    s_nop 0
    buffer_load_dwordx4 v39, s[4:7], s65 offen lds
    s_add_u32 s65, s53, s95
    s_add_u32 m0, s61, 81920
    s_nop 0
    buffer_load_dwordx4 v40, s[8:11], s65 offen lds
    s_add_u32 s65, s53, s95
    s_add_u32 m0, s61, 82944
    s_nop 0
    buffer_load_dwordx4 v41, s[8:11], s65 offen lds
    s_add_u32 s65, s53, s95
    s_add_u32 m0, s61, 83968
    s_nop 0
    buffer_load_dwordx4 v42, s[8:11], s65 offen lds
    s_mov_b32 s48, 14712832
    s_load_dwordx2 s[100:101], s[24:25], s48
    s_add_u32 s49, s51, 2
    s_sub_u32 s50, s49, 5
    s_cmp_ge_u32 s49, 5
    s_cselect_b32 s49, s50, s49
    s_lshl_b32 s92, s49, 8
    s_mul_i32 s97, s49, 393216
    s_add_u32 s49, s51, 3
    s_sub_u32 s50, s49, 5
    s_cmp_ge_u32 s49, 5
    s_cselect_b32 s49, s50, s49
    s_lshl_b32 s93, s49, 8
    s_mul_i32 s98, s49, 393216
    s_add_u32 s49, s51, 4
    s_sub_u32 s50, s49, 5
    s_cmp_ge_u32 s49, 5
    s_cselect_b32 s49, s50, s49
    s_lshl_b32 s94, s49, 8
    s_mul_i32 s99, s49, 393216
    s_mov_b32 s14, 2621440
    s_mov_b32 s15, 0x20000
    s_mov_b32 s18, 2621440
    s_mov_b32 s19, 0x20000
    s_mov_b32 s22, 5120
    s_mov_b32 s23, 0x20000
    s_mov_b32 s26, 15990784
    s_mov_b32 s27, 0x20000
    s_mov_b32 s30, 256
    s_mov_b32 s31, 0x20000
    s_mov_b32 s34, 8388608
    s_mov_b32 s35, 0x20000
    s_mov_b32 s38, 2621440
    s_mov_b32 s39, 0x20000
    s_mov_b32 s86, 983040
    s_mov_b32 s87, 0x20000
    v_lshlrev_b32 v36, 7, v1
    v_mov_b32 v4, 161792
    v_mov_b32 v8, 0
    v_mov_b32 v9, 0
    ds_write_b64 v4, v[8:9]
    s_barrier
    s_add_u32 s65, s52, s91
    s_add_u32 m0, s60, 16384
    s_nop 0
    buffer_load_dwordx4 v38, s[4:7], s65 offen lds
    s_add_u32 s65, s52, s91
    s_add_u32 m0, s60, 17408
    s_nop 0
    buffer_load_dwordx4 v39, s[4:7], s65 offen lds
    s_add_u32 s65, s53, s96
    s_add_u32 m0, s61, 106496
    s_nop 0
    buffer_load_dwordx4 v40, s[8:11], s65 offen lds
    s_add_u32 s65, s53, s96
    s_add_u32 m0, s61, 107520
    s_nop 0
    buffer_load_dwordx4 v41, s[8:11], s65 offen lds
    s_add_u32 s65, s53, s96
    s_add_u32 m0, s61, 108544
    s_nop 0
    buffer_load_dwordx4 v42, s[8:11], s65 offen lds
    s_cmp_lg_u32 s42, 7
    s_cbranch_scc1 k1_shk_1
    v_lshlrev_b32 v4, 4, v1
    s_mul_i32 s48, s41, 640
    s_mov_b32 m0, 160768
    s_mov_b32 exec_lo, -1
    s_mov_b32 exec_hi, 0xff
    buffer_load_dwordx4 v4, s[20:23], s48 offen lds
    s_mov_b64 exec, -1
k1_shk_1:
    s_and_b32 s43, s42, 1
    s_lshr_b32 s44, s42, 1
    s_and_b32 s44, s44, 1
    s_lshr_b32 s45, s42, 2
    s_xor_b32 s46, s43, s45
    s_lshl_b32 s47, s44, 1
    s_add_u32 s47, s47, s46
    s_mov_b32 s55, 0x3727c5ac
    s_mov_b32 s56, 0x3f803f80
    s_mov_b32 s58, 0xbdd2d3e8
    s_mov_b32 s59, 0xbdd2d3e8
    s_lshl_b32 s48, s45, 1
    s_add_u32 s63, s48, s44
    s_xor_b32 s64, s63, 1
    v_xor_b32 v4, v2, v3
    v_lshlrev_b32 v6, 8, v3
    s_lshl_b32 s48, s44, 13
    s_lshl_b32 s49, s46, 12
    s_add_u32 s50, s48, s49
    s_xor_b32 s49, s49, 4096
    s_add_u32 s51, s48, s49
    s_lshl_b32 s48, s63, 2
    v_xor_b32 v5, s48, v4
    v_lshl_add_u32 v5, v5, 4, v6
    v_add_u32 v45, s50, v5
    v_add_u32 v46, s51, v5
    s_lshl_b32 s48, s64, 2
    v_xor_b32 v5, s48, v4
    v_lshl_add_u32 v5, v5, 4, v6
    v_add_u32 v47, s50, v5
    v_add_u32 v216, s51, v5
    v_lshrrev_b32 v5, 2, v3
    v_lshl_add_u32 v4, v2, 3, v5
    v_mul_u32_u24 v4, 192, v4
    v_and_b32 v5, 3, v3
    v_lshl_add_u32 v4, v5, 3, v4
    v_and_b32 v5, 1, v2
    s_mul_i32 s51, s43, 3
    s_mul_i32 s49, s63, 6144
    s_add_u32 s49, s49, 81920
    s_mul_i32 s50, s64, 6144
    s_add_u32 s50, s50, 81920
    s_add_u32 s48, s51, 0
    v_xor_b32 v6, s48, v5
    v_lshl_add_u32 v6, v6, 5, v4
    v_add_u32 v217, s49, v6
    v_add_u32 v220, s50, v6
    s_add_u32 s48, s51, 1
    v_xor_b32 v6, s48, v5
    v_lshl_add_u32 v6, v6, 5, v4
    v_add_u32 v218, s49, v6
    v_add_u32 v221, s50, v6
    s_add_u32 s48, s51, 2
    v_xor_b32 v6, s48, v5
    v_lshl_add_u32 v6, v6, 5, v4
    v_add_u32 v219, s49, v6
    v_add_u32 v222, s50, v6
    v_mov_b32 v244, s56
    v_mov_b32 v245, s56
    v_mov_b32 v246, s56
    v_mov_b32 v247, s56
    v_mul_u32_u24 v43, 205, v1
    v_lshrrev_b32 v43, 11, v43
    v_mul_u32_u24 v4, 10, v43
    v_sub_u32 v44, v1, v4
    s_lshl_b32 s48, s42, 3
    v_lshl_add_u32 v4, v43, 1, s48
    v_min_u32 v4, 62, v4
    v_mul_u32_u24 v4, 160, v4
    v_lshl_add_u32 v7, v44, 4, v4
    v_lshlrev_b32 v215, 10, v1
    s_lshl_b32 s89, s2, 3
    s_add_u32 s89, s89, s42
    s_mul_i32 s70, s42, 3072
    s_add_u32 s70, s70, 16384
    s_xor_b32 s48, s42, 4
    s_mul_i32 s71, s48, 3072
    s_add_u32 s71, s71, 16384
    s_lshl_b32 s48, s43, 2
    s_lshl_b32 s49, s44, 1
    s_add_u32 s48, s48, s49
    s_add_u32 s48, s48, s45
    s_mul_i32 s72, s48, 192
    s_add_u32 s72, s72, 155648
    s_mul_i32 s73, s43, 768
    s_add_u32 s73, s73, 155648
    s_lshl_b32 s48, s47, 1
    s_add_u32 s48, s48, s45
    s_lshl_b32 s48, s48, 7
    s_add_u32 s74, s48, 158720
    s_lshl_b32 s48, s47, 8
    s_add_u32 s75, s48, 158720
    s_lshl_b32 s48, s47, 7
    s_lshl_b32 s49, s43, 9
    s_add_u32 s48, s48, s49
    s_add_u32 s76, s48, 159744
    s_lshl_b32 s48, s40, 3
    s_add_u32 s48, s48, s41
    s_lshl_b32 s49, s48, 10
    s_add_u32 s77, s49, 14745600
    s_mov_b32 s48, 0
    s_lshr_b32 s49, s47, 1
    s_mul_i32 s49, s49, 6144
    s_add_u32 s48, s48, s49
    s_and_b32 s49, s47, 1
    s_lshl_b32 s49, s49, 8
    s_add_u32 s48, s48, s49
    s_add_u32 s48, s48, 73728
    s_mul_i32 s49, s43, 3
    s_add_u32 s49, s49, 0
    s_lshr_b32 s50, s49, 1
    s_lshl_b32 s50, s50, 10
    s_and_b32 s49, s49, 1
    s_lshl_b32 s49, s49, 3
    s_add_u32 s80, s48, s49
    s_add_u32 s80, s80, s50
    s_mul_i32 s49, s43, 3
    s_add_u32 s49, s49, 1
    s_lshr_b32 s50, s49, 1
    s_lshl_b32 s50, s50, 10
    s_and_b32 s49, s49, 1
    s_lshl_b32 s49, s49, 3
    s_add_u32 s81, s48, s49
    s_add_u32 s81, s81, s50
    s_mul_i32 s49, s43, 3
    s_add_u32 s49, s49, 2
    s_lshr_b32 s50, s49, 1
    s_lshl_b32 s50, s50, 10
    s_and_b32 s49, s49, 1
    s_lshl_b32 s49, s49, 3
    s_add_u32 s82, s48, s49
    s_add_u32 s82, s82, s50
    s_lshl_b32 s48, s40, 13
    s_lshl_b32 s49, s47, 8
    s_add_u32 s48, s48, s49
    s_add_u32 s78, s48, 14745600
    s_lshl_b32 s48, s40, 9
    s_lshl_b32 s49, s47, 7
    s_add_u32 s48, s48, s49
    s_add_u32 s79, s48, 14680064
    s_mul_i32 s48, s41, 327680
    s_lshl_b32 s49, s40, 7
    s_add_u32 s48, s48, s49
    s_add_u32 s83, s48, 6291456
    s_lshr_b32 s48, s2, 3
    s_lshl_b32 s48, s48, 3
    s_add_u32 s48, s48, s42
    s_lshl_b32 s48, s48, 13
    s_lshl_b32 s49, s66, 21
    s_add_u32 s66, s48, s49
    s_add_u32 s51, s42, 0
    s_mul_i32 s48, s51, 43
    s_lshr_b32 s48, s48, 7
    s_mul_i32 s49, s48, 3
    s_sub_u32 s49, s51, s49
    s_mul_i32 s48, s48, 3200
    s_lshl_b32 s49, s49, 6
    s_add_u32 s48, s48, s49
    s_add_u32 s88, s48, 0
    s_lshl_b32 s48, s41, 7
    s_lshl_b32 s49, s40, 2
    s_add_u32 s48, s48, s49
    s_mul_i32 s48, s48, 3
    s_add_u32 s48, s48, s51
    s_lshl_b32 s48, s48, 10
    s_add_u32 s64, s48, 0
    s_add_u32 s51, s42, 8
    s_mul_i32 s48, s51, 43
    s_lshr_b32 s48, s48, 7
    s_mul_i32 s49, s48, 3
    s_sub_u32 s49, s51, s49
    s_mul_i32 s48, s48, 3200
    s_lshl_b32 s49, s49, 6
    s_add_u32 s48, s48, s49
    s_add_u32 s63, s48, 0
    s_lshl_b32 s48, s41, 7
    s_lshl_b32 s49, s40, 2
    s_add_u32 s48, s48, s49
    s_mul_i32 s48, s48, 3
    s_add_u32 s48, s48, s51
    s_lshl_b32 s48, s48, 10
    s_add_u32 s67, s48, 0
    s_waitcnt vmcnt(5)
    s_waitcnt lgkmcnt(0)
    s_add_u32 s100, s100, 1
    s_addc_u32 s101, s101, 0
    s_barrier
    ds_read_b64_tr_b16 v[128:129], v217 offset:0
    ds_read_b64_tr_b16 v[130:131], v217 offset:768
    ds_read_b64_tr_b16 v[132:133], v218 offset:0
    ds_read_b64_tr_b16 v[134:135], v218 offset:768
    ds_read_b64_tr_b16 v[136:137], v219 offset:0
    ds_read_b64_tr_b16 v[138:139], v219 offset:768
    ds_read_b64_tr_b16 v[140:141], v220 offset:0
    ds_read_b64_tr_b16 v[142:143], v220 offset:768
    ds_read_b64_tr_b16 v[144:145], v221 offset:0
    ds_read_b64_tr_b16 v[146:147], v221 offset:768
    ds_read_b64_tr_b16 v[148:149], v222 offset:0
    ds_read_b64_tr_b16 v[150:151], v222 offset:768
    ds_read_b128 v[48:51], v45 offset:0
    ds_read_b128 v[52:55], v46 offset:0
    ds_read_b128 v[56:59], v47 offset:0
    ds_read_b128 v[60:63], v216 offset:0
    s_add_u32 s65, s52, s92
    s_add_u32 m0, s60, 32768
    s_nop 0
    buffer_load_dwordx4 v38, s[4:7], s65 offen lds
    s_add_u32 s65, s52, s92
    s_add_u32 m0, s60, 33792
    s_nop 0
    buffer_load_dwordx4 v39, s[4:7], s65 offen lds
    s_add_u32 s65, s53, s97
    s_add_u32 m0, s61, 131072
    s_nop 0
    buffer_load_dwordx4 v40, s[8:11], s65 offen lds
    s_add_u32 s65, s53, s97
    s_add_u32 m0, s61, 132096
    s_nop 0
    buffer_load_dwordx4 v41, s[8:11], s65 offen lds
    s_add_u32 s65, s53, s97
    s_add_u32 m0, s61, 133120
    s_nop 0
    buffer_load_dwordx4 v42, s[8:11], s65 offen lds
    s_waitcnt vmcnt(5)
    s_waitcnt lgkmcnt(0)
    s_barrier
    v_mfma_f32_16x16x32_bf16 v[176:179], v[128:131], v[48:51], 0
    ds_read_b64_tr_b16 v[152:153], v217 offset:24576
    ds_read_b64_tr_b16 v[154:155], v217 offset:25344
    v_mfma_f32_16x16x32_bf16 v[180:183], v[128:131], v[52:55], 0
    s_add_u32 s65, s52, s93
    s_add_u32 m0, s60, 49152
    s_nop 0
    buffer_load_dwordx4 v38, s[4:7], s65 offen lds
    ds_read_b64_tr_b16 v[156:157], v218 offset:24576
    ds_read_b64_tr_b16 v[158:159], v218 offset:25344
    v_mfma_f32_16x16x32_bf16 v[224:227], v[128:131], v[244:247], 0
    ds_read_b64_tr_b16 v[160:161], v219 offset:24576
    ds_read_b64_tr_b16 v[162:163], v219 offset:25344
    v_mfma_f32_16x16x32_bf16 v[184:187], v[132:135], v[48:51], 0
    ds_read_b64_tr_b16 v[164:165], v220 offset:24576
    ds_read_b64_tr_b16 v[166:167], v220 offset:25344
    v_mfma_f32_16x16x32_bf16 v[188:191], v[132:135], v[52:55], 0
    s_add_u32 s65, s52, s93
    s_add_u32 m0, s60, 50176
    s_nop 0
    buffer_load_dwordx4 v39, s[4:7], s65 offen lds
    ds_read_b64_tr_b16 v[168:169], v221 offset:24576
    ds_read_b64_tr_b16 v[170:171], v221 offset:25344
    v_mfma_f32_16x16x32_bf16 v[228:231], v[132:135], v[244:247], 0
    ds_read_b64_tr_b16 v[172:173], v222 offset:24576
    ds_read_b64_tr_b16 v[174:175], v222 offset:25344
    v_mfma_f32_16x16x32_bf16 v[192:195], v[136:139], v[48:51], 0
    ds_read_b128 v[64:67], v45 offset:16384
    ds_read_b128 v[68:71], v46 offset:16384
    v_mfma_f32_16x16x32_bf16 v[196:199], v[136:139], v[52:55], 0
    s_add_u32 s65, s53, s98
    s_add_u32 m0, s61, 81920
    s_nop 0
    buffer_load_dwordx4 v40, s[8:11], s65 offen lds
    ds_read_b128 v[72:75], v47 offset:16384
    ds_read_b128 v[76:79], v216 offset:16384
    v_mfma_f32_16x16x32_bf16 v[232:235], v[136:139], v[244:247], 0
    v_mfma_f32_16x16x32_bf16 v[236:239], v[244:247], v[48:51], 0
    v_mfma_f32_16x16x32_bf16 v[240:243], v[48:51], v[48:51], 0
    s_add_u32 s65, s53, s98
    s_add_u32 m0, s61, 82944
    s_nop 0
    buffer_load_dwordx4 v41, s[8:11], s65 offen lds
    v_mfma_f32_16x16x32_bf16 v[176:179], v[140:143], v[56:59], v[176:179]
    v_mfma_f32_16x16x32_bf16 v[180:183], v[140:143], v[60:63], v[180:183]
    v_mfma_f32_16x16x32_bf16 v[184:187], v[144:147], v[56:59], v[184:187]
    s_add_u32 s65, s53, s98
    s_add_u32 m0, s61, 83968
    s_nop 0
    buffer_load_dwordx4 v42, s[8:11], s65 offen lds
    v_mfma_f32_16x16x32_bf16 v[188:191], v[144:147], v[60:63], v[188:191]
    v_mfma_f32_16x16x32_bf16 v[192:195], v[148:151], v[56:59], v[192:195]
    v_mfma_f32_16x16x32_bf16 v[196:199], v[148:151], v[60:63], v[196:199]
    v_mfma_f32_16x16x32_bf16 v[236:239], v[244:247], v[56:59], v[236:239]
    v_mfma_f32_16x16x32_bf16 v[240:243], v[56:59], v[56:59], v[240:243]
    s_waitcnt vmcnt(5)
    s_waitcnt lgkmcnt(0)
    s_barrier
    v_mfma_f32_16x16x32_bf16 v[176:179], v[152:155], v[64:67], v[176:179]
    ds_read_b64_tr_b16 v[128:129], v217 offset:49152
    ds_read_b64_tr_b16 v[130:131], v217 offset:49920
    v_mfma_f32_16x16x32_bf16 v[180:183], v[152:155], v[68:71], v[180:183]
    s_add_u32 s65, s52, s94
    s_add_u32 m0, s60, 65536
    s_nop 0
    buffer_load_dwordx4 v38, s[4:7], s65 offen lds
    ds_read_b64_tr_b16 v[132:133], v218 offset:49152
    ds_read_b64_tr_b16 v[134:135], v218 offset:49920
    v_mfma_f32_16x16x32_bf16 v[224:227], v[152:155], v[244:247], v[224:227]
    ds_read_b64_tr_b16 v[136:137], v219 offset:49152
    ds_read_b64_tr_b16 v[138:139], v219 offset:49920
    v_mfma_f32_16x16x32_bf16 v[184:187], v[156:159], v[64:67], v[184:187]
    ds_read_b64_tr_b16 v[140:141], v220 offset:49152
    ds_read_b64_tr_b16 v[142:143], v220 offset:49920
    v_mfma_f32_16x16x32_bf16 v[188:191], v[156:159], v[68:71], v[188:191]
    s_add_u32 s65, s52, s94
    s_add_u32 m0, s60, 66560
    s_nop 0
    buffer_load_dwordx4 v39, s[4:7], s65 offen lds
    ds_read_b64_tr_b16 v[144:145], v221 offset:49152
    ds_read_b64_tr_b16 v[146:147], v221 offset:49920
    v_mfma_f32_16x16x32_bf16 v[228:231], v[156:159], v[244:247], v[228:231]
    ds_read_b64_tr_b16 v[148:149], v222 offset:49152
    ds_read_b64_tr_b16 v[150:151], v222 offset:49920
    v_mfma_f32_16x16x32_bf16 v[192:195], v[160:163], v[64:67], v[192:195]
    ds_read_b128 v[80:83], v45 offset:32768
    ds_read_b128 v[84:87], v46 offset:32768
    v_mfma_f32_16x16x32_bf16 v[196:199], v[160:163], v[68:71], v[196:199]
    s_add_u32 s65, s53, s99
    s_add_u32 m0, s61, 106496
    s_nop 0
    buffer_load_dwordx4 v40, s[8:11], s65 offen lds
    ds_read_b128 v[88:91], v47 offset:32768
    ds_read_b128 v[92:95], v216 offset:32768
    v_mfma_f32_16x16x32_bf16 v[232:235], v[160:163], v[244:247], v[232:235]
    v_mfma_f32_16x16x32_bf16 v[236:239], v[244:247], v[64:67], v[236:239]
    v_mfma_f32_16x16x32_bf16 v[240:243], v[64:67], v[64:67], v[240:243]
    s_add_u32 s65, s53, s99
    s_add_u32 m0, s61, 107520
    s_nop 0
    buffer_load_dwordx4 v41, s[8:11], s65 offen lds
    v_mfma_f32_16x16x32_bf16 v[176:179], v[164:167], v[72:75], v[176:179]
    v_mfma_f32_16x16x32_bf16 v[180:183], v[164:167], v[76:79], v[180:183]
    v_mfma_f32_16x16x32_bf16 v[184:187], v[168:171], v[72:75], v[184:187]
    s_add_u32 s65, s53, s99
    s_add_u32 m0, s61, 108544
    s_nop 0
    buffer_load_dwordx4 v42, s[8:11], s65 offen lds
    v_mfma_f32_16x16x32_bf16 v[188:191], v[168:171], v[76:79], v[188:191]
    v_mfma_f32_16x16x32_bf16 v[192:195], v[172:175], v[72:75], v[192:195]
    v_mfma_f32_16x16x32_bf16 v[196:199], v[172:175], v[76:79], v[196:199]
    v_mfma_f32_16x16x32_bf16 v[236:239], v[244:247], v[72:75], v[236:239]
    v_mfma_f32_16x16x32_bf16 v[240:243], v[72:75], v[72:75], v[240:243]
    s_waitcnt vmcnt(5)
    s_waitcnt lgkmcnt(0)
    s_barrier
    v_mfma_f32_16x16x32_bf16 v[176:179], v[128:131], v[80:83], v[176:179]
    ds_read_b64_tr_b16 v[152:153], v217 offset:0
    ds_read_b64_tr_b16 v[154:155], v217 offset:768
    v_mfma_f32_16x16x32_bf16 v[180:183], v[128:131], v[84:87], v[180:183]
    s_add_u32 s65, s54, s95
    s_add_u32 m0, s61, 131072
    s_nop 0
    buffer_load_dwordx4 v40, s[8:11], s65 offen lds
    ds_read_b64_tr_b16 v[156:157], v218 offset:0
    ds_read_b64_tr_b16 v[158:159], v218 offset:768
    v_mfma_f32_16x16x32_bf16 v[224:227], v[128:131], v[244:247], v[224:227]
    ds_read_b64_tr_b16 v[160:161], v219 offset:0
    ds_read_b64_tr_b16 v[162:163], v219 offset:768
    v_mfma_f32_16x16x32_bf16 v[184:187], v[132:135], v[80:83], v[184:187]
    ds_read_b64_tr_b16 v[164:165], v220 offset:0
    ds_read_b64_tr_b16 v[166:167], v220 offset:768
    v_mfma_f32_16x16x32_bf16 v[188:191], v[132:135], v[84:87], v[188:191]
    s_add_u32 s65, s54, s95
    s_add_u32 m0, s61, 132096
    s_nop 0
    buffer_load_dwordx4 v41, s[8:11], s65 offen lds
    ds_read_b64_tr_b16 v[168:169], v221 offset:0
    ds_read_b64_tr_b16 v[170:171], v221 offset:768
    v_mfma_f32_16x16x32_bf16 v[228:231], v[132:135], v[244:247], v[228:231]
    ds_read_b64_tr_b16 v[172:173], v222 offset:0
    ds_read_b64_tr_b16 v[174:175], v222 offset:768
    v_mfma_f32_16x16x32_bf16 v[192:195], v[136:139], v[80:83], v[192:195]
    ds_read_b128 v[96:99], v45 offset:49152
    ds_read_b128 v[100:103], v46 offset:49152
    v_mfma_f32_16x16x32_bf16 v[196:199], v[136:139], v[84:87], v[196:199]
    s_add_u32 s65, s54, s95
    s_add_u32 m0, s61, 133120
    s_nop 0
    buffer_load_dwordx4 v42, s[8:11], s65 offen lds
    ds_read_b128 v[104:107], v47 offset:49152
    ds_read_b128 v[108:111], v216 offset:49152
    v_mfma_f32_16x16x32_bf16 v[232:235], v[136:139], v[244:247], v[232:235]
    v_mfma_f32_16x16x32_bf16 v[236:239], v[244:247], v[80:83], v[236:239]
    v_mfma_f32_16x16x32_bf16 v[240:243], v[80:83], v[80:83], v[240:243]
    s_mul_i32 s48, s89, 1280
    s_add_u32 s48, s48, 0
    s_mov_b64 exec, 0x1f
    buffer_load_dword v37, v36, s[36:39], s48 offen
    s_mov_b64 exec, -1
    v_mfma_f32_16x16x32_bf16 v[176:179], v[140:143], v[88:91], v[176:179]
    v_mfma_f32_16x16x32_bf16 v[180:183], v[140:143], v[92:95], v[180:183]
    v_mfma_f32_16x16x32_bf16 v[184:187], v[144:147], v[88:91], v[184:187]
    v_mfma_f32_16x16x32_bf16 v[188:191], v[144:147], v[92:95], v[188:191]
    v_mfma_f32_16x16x32_bf16 v[192:195], v[148:151], v[88:91], v[192:195]
    v_mfma_f32_16x16x32_bf16 v[196:199], v[148:151], v[92:95], v[196:199]
    v_mfma_f32_16x16x32_bf16 v[236:239], v[244:247], v[88:91], v[236:239]
    v_mfma_f32_16x16x32_bf16 v[240:243], v[88:91], v[88:91], v[240:243]
    s_waitcnt vmcnt(4)
    s_waitcnt lgkmcnt(0)
    s_barrier
    v_mfma_f32_16x16x32_bf16 v[176:179], v[152:155], v[96:99], v[176:179]
    ds_read_b64_tr_b16 v[128:129], v217 offset:24576
    ds_read_b64_tr_b16 v[130:131], v217 offset:25344
    v_mfma_f32_16x16x32_bf16 v[180:183], v[152:155], v[100:103], v[180:183]
    s_add_u32 s65, s54, s96
    s_add_u32 m0, s61, 81920
    s_nop 0
    buffer_load_dwordx4 v40, s[8:11], s65 offen lds
    ds_read_b64_tr_b16 v[132:133], v218 offset:24576
    ds_read_b64_tr_b16 v[134:135], v218 offset:25344
    v_mfma_f32_16x16x32_bf16 v[224:227], v[152:155], v[244:247], v[224:227]
    ds_read_b64_tr_b16 v[136:137], v219 offset:24576
    ds_read_b64_tr_b16 v[138:139], v219 offset:25344
    v_mfma_f32_16x16x32_bf16 v[184:187], v[156:159], v[96:99], v[184:187]
    ds_read_b64_tr_b16 v[140:141], v220 offset:24576
    ds_read_b64_tr_b16 v[142:143], v220 offset:25344
    v_mfma_f32_16x16x32_bf16 v[188:191], v[156:159], v[100:103], v[188:191]
    s_add_u32 s65, s54, s96
    s_add_u32 m0, s61, 82944
    s_nop 0
    buffer_load_dwordx4 v41, s[8:11], s65 offen lds
    ds_read_b64_tr_b16 v[144:145], v221 offset:24576
    ds_read_b64_tr_b16 v[146:147], v221 offset:25344
    v_mfma_f32_16x16x32_bf16 v[228:231], v[156:159], v[244:247], v[228:231]
    ds_read_b64_tr_b16 v[148:149], v222 offset:24576
    ds_read_b64_tr_b16 v[150:151], v222 offset:25344
    v_mfma_f32_16x16x32_bf16 v[192:195], v[160:163], v[96:99], v[192:195]
    v_add_u32 v45, 0x10000, v45
    v_add_u32 v46, 0x10000, v46
    v_add_u32 v47, 0x10000, v47
    v_add_u32 v216, 0x10000, v216
    ds_read_b128 v[112:115], v45 offset:0
    ds_read_b128 v[116:119], v46 offset:0
    v_mfma_f32_16x16x32_bf16 v[196:199], v[160:163], v[100:103], v[196:199]
    s_add_u32 s65, s54, s96
    s_add_u32 m0, s61, 83968
    s_nop 0
    buffer_load_dwordx4 v42, s[8:11], s65 offen lds
    ds_read_b128 v[120:123], v47 offset:0
    ds_read_b128 v[124:127], v216 offset:0
    v_mfma_f32_16x16x32_bf16 v[232:235], v[160:163], v[244:247], v[232:235]
    v_mfma_f32_16x16x32_bf16 v[236:239], v[244:247], v[96:99], v[236:239]
    v_mfma_f32_16x16x32_bf16 v[240:243], v[96:99], v[96:99], v[240:243]
    v_mfma_f32_16x16x32_bf16 v[176:179], v[164:167], v[104:107], v[176:179]
    v_mfma_f32_16x16x32_bf16 v[180:183], v[164:167], v[108:111], v[180:183]
    v_mfma_f32_16x16x32_bf16 v[184:187], v[168:171], v[104:107], v[184:187]
    v_mfma_f32_16x16x32_bf16 v[188:191], v[168:171], v[108:111], v[188:191]
    v_mfma_f32_16x16x32_bf16 v[192:195], v[172:175], v[104:107], v[192:195]
    v_mfma_f32_16x16x32_bf16 v[196:199], v[172:175], v[108:111], v[196:199]
    v_mfma_f32_16x16x32_bf16 v[236:239], v[244:247], v[104:107], v[236:239]
    v_mfma_f32_16x16x32_bf16 v[240:243], v[104:107], v[104:107], v[240:243]
    s_waitcnt vmcnt(4)
    s_waitcnt lgkmcnt(0)
    s_barrier
    v_mfma_f32_16x16x32_bf16 v[176:179], v[128:131], v[112:115], v[176:179]
    ds_read_b64_tr_b16 v[152:153], v217 offset:49152
    ds_read_b64_tr_b16 v[154:155], v217 offset:49920
    v_mfma_f32_16x16x32_bf16 v[180:183], v[128:131], v[116:119], v[180:183]
    s_add_u32 s65, s54, s97
    s_add_u32 m0, s61, 106496
    s_nop 0
    buffer_load_dwordx4 v40, s[8:11], s65 offen lds
    ds_read_b64_tr_b16 v[156:157], v218 offset:49152
    ds_read_b64_tr_b16 v[158:159], v218 offset:49920
    v_mfma_f32_16x16x32_bf16 v[224:227], v[128:131], v[244:247], v[224:227]
    ds_read_b64_tr_b16 v[160:161], v219 offset:49152
    ds_read_b64_tr_b16 v[162:163], v219 offset:49920
    v_mfma_f32_16x16x32_bf16 v[184:187], v[132:135], v[112:115], v[184:187]
    ds_read_b64_tr_b16 v[164:165], v220 offset:49152
    ds_read_b64_tr_b16 v[166:167], v220 offset:49920
    v_mfma_f32_16x16x32_bf16 v[188:191], v[132:135], v[116:119], v[188:191]
    s_add_u32 s65, s54, s97
    s_add_u32 m0, s61, 107520
    s_nop 0
    buffer_load_dwordx4 v41, s[8:11], s65 offen lds
    ds_read_b64_tr_b16 v[168:169], v221 offset:49152
    ds_read_b64_tr_b16 v[170:171], v221 offset:49920
    v_mfma_f32_16x16x32_bf16 v[228:231], v[132:135], v[244:247], v[228:231]
    ds_read_b64_tr_b16 v[172:173], v222 offset:49152
    ds_read_b64_tr_b16 v[174:175], v222 offset:49920
    v_mfma_f32_16x16x32_bf16 v[192:195], v[136:139], v[112:115], v[192:195]
    v_mfma_f32_16x16x32_bf16 v[196:199], v[136:139], v[116:119], v[196:199]
    s_add_u32 s65, s54, s97
    s_add_u32 m0, s61, 108544
    s_nop 0
    buffer_load_dwordx4 v42, s[8:11], s65 offen lds
    v_mfma_f32_16x16x32_bf16 v[232:235], v[136:139], v[244:247], v[232:235]
    v_mfma_f32_16x16x32_bf16 v[236:239], v[244:247], v[112:115], v[236:239]
    v_mfma_f32_16x16x32_bf16 v[240:243], v[112:115], v[112:115], v[240:243]
    v_mfma_f32_16x16x32_bf16 v[176:179], v[140:143], v[120:123], v[176:179]
    v_mfma_f32_16x16x32_bf16 v[180:183], v[140:143], v[124:127], v[180:183]
    v_mfma_f32_16x16x32_bf16 v[184:187], v[144:147], v[120:123], v[184:187]
    v_mfma_f32_16x16x32_bf16 v[188:191], v[144:147], v[124:127], v[188:191]
    v_mfma_f32_16x16x32_bf16 v[192:195], v[148:151], v[120:123], v[192:195]
    v_mfma_f32_16x16x32_bf16 v[196:199], v[148:151], v[124:127], v[196:199]
    v_mfma_f32_16x16x32_bf16 v[236:239], v[244:247], v[120:123], v[236:239]
    v_mfma_f32_16x16x32_bf16 v[240:243], v[120:123], v[120:123], v[240:243]
    v_lshl_add_u32 v4, v1, 4, s70
    v_lshl_add_u32 v5, v2, 4, s72
    ds_write_b128 v4, v[180:183] offset:0
    s_nop 0
    ds_write_b128 v4, v[188:191] offset:1024
    s_nop 0
    ds_write_b128 v4, v[196:199] offset:2048
    s_mov_b32 exec_lo, 0x00010001
    s_mov_b32 exec_hi, 0x00010001
    ds_write_b128 v5, v[224:227] offset:0
    ds_write_b128 v5, v[228:231] offset:64
    ds_write_b128 v5, v[232:235] offset:128
    s_mov_b64 exec, -1
    v_and_b32 v8, 3, v3
    v_cmp_eq_u32 vcc, 1, v8
    s_nop 1
    v_cndmask_b32 v237, v240, v241, vcc
    v_cmp_eq_u32 vcc, 2, v8
    s_nop 1
    v_cndmask_b32 v237, v237, v242, vcc
    v_cmp_eq_u32 vcc, 3, v8
    s_nop 1
    v_cndmask_b32 v237, v237, v243, vcc
    v_lshl_add_u32 v6, v3, 3, s74
    s_mov_b32 exec_lo, 0x00F0000F
    s_mov_b32 exec_hi, 0xF0000F00
    ds_write_b64 v6, v[236:237]
    s_mov_b64 exec, -1
    v_pk_add_f32 v[200:201], v[176:177], 0
    v_pk_add_f32 v[202:203], v[178:179], 0
    v_pk_add_f32 v[204:205], v[184:185], 0
    v_pk_add_f32 v[206:207], v[186:187], 0
    v_pk_add_f32 v[208:209], v[192:193], 0
    v_pk_add_f32 v[210:211], v[194:195], 0
    v_mov_b32 v238, 0xc0135761
    v_mov_b32 v239, 0xc0135761
    s_waitcnt vmcnt(3)
    s_waitcnt lgkmcnt(0)
    s_barrier
    v_lshl_add_u32 v4, v1, 4, s71
    v_lshl_add_u32 v5, v3, 3, s75
    ds_read_b64 v[20:21], v5
    ds_read_b64 v[22:23], v5 offset:128
    ds_read_b128 v[8:11], v4 offset:0
    ds_read_b128 v[12:15], v4 offset:1024
    ds_read_b128 v[16:19], v4 offset:2048
    v_lshl_add_u32 v6, v2, 4, s73
    ds_read_b128 v[24:27], v6 offset:0
    ds_read_b128 v[28:31], v6 offset:64
    ds_read_b128 v[32:35], v6 offset:128
    ds_read_b128 v[176:179], v6 offset:192
    ds_read_b128 v[180:183], v6 offset:256
    ds_read_b128 v[184:187], v6 offset:320
    ds_read_b128 v[188:191], v6 offset:384
    ds_read_b128 v[192:195], v6 offset:448
    ds_read_b128 v[196:199], v6 offset:512
    ds_read_b128 v[224:227], v6 offset:576
    ds_read_b128 v[228:231], v6 offset:640
    ds_read_b128 v[232:235], v6 offset:704
    s_waitcnt lgkmcnt(15)
    v_pk_add_f32 v[240:241], v[20:21], v[22:23]
    v_mul_f32 v240, 0x3acccccd, v240
    v_mul_f32 v241, 0x3acccccd, v241
    v_fma_f32 v241, -v240, v240, v241
    v_max_f32 v241, 0, v241
    v_cvt_pk_bf16_f32 v241, v241, v240
    v_and_b32 v240, 0xffff0000, v241
    v_lshlrev_b32 v241, 16, v241
    v_add_f32 v241, s55, v241
    v_cvt_pk_bf16_f32 v241, v241, v241
    v_and_b32 v241, 0xffff0000, v241
    v_sqrt_f32 v241, v241
    s_nop 0
    v_cvt_pk_bf16_f32 v241, v241, v241
    v_and_b32 v241, 0xffff0000, v241
    v_rcp_f32 v241, v241
    s_nop 0
    v_mov_b32 v242, v241
    s_waitcnt lgkmcnt(12)
    v_pk_add_f32 v[200:201], v[200:201], v[8:9]
    v_pk_add_f32 v[202:203], v[202:203], v[10:11]
    v_pk_add_f32 v[204:205], v[204:205], v[12:13]
    v_pk_add_f32 v[206:207], v[206:207], v[14:15]
    v_pk_add_f32 v[208:209], v[208:209], v[16:17]
    v_pk_add_f32 v[210:211], v[210:211], v[18:19]
    s_waitcnt lgkmcnt(6)
    v_pk_add_f32 v[24:25], v[24:25], v[176:177]
    v_pk_add_f32 v[26:27], v[26:27], v[178:179]
    v_pk_add_f32 v[28:29], v[28:29], v[180:181]
    v_pk_add_f32 v[30:31], v[30:31], v[182:183]
    v_pk_add_f32 v[32:33], v[32:33], v[184:185]
    v_pk_add_f32 v[34:35], v[34:35], v[186:187]
    s_waitcnt lgkmcnt(0)
    v_pk_add_f32 v[188:189], v[188:189], v[224:225]
    v_pk_add_f32 v[190:191], v[190:191], v[226:227]
    v_pk_add_f32 v[192:193], v[192:193], v[228:229]
    v_pk_add_f32 v[194:195], v[194:195], v[230:231]
    v_pk_add_f32 v[196:197], v[196:197], v[232:233]
    v_pk_add_f32 v[198:199], v[198:199], v[234:235]
    v_pk_add_f32 v[24:25], v[24:25], v[188:189]
    v_pk_add_f32 v[26:27], v[26:27], v[190:191]
    v_pk_add_f32 v[28:29], v[28:29], v[192:193]
    v_pk_add_f32 v[30:31], v[30:31], v[194:195]
    v_pk_add_f32 v[32:33], v[32:33], v[196:197]
    v_pk_add_f32 v[34:35], v[34:35], v[198:199]
    v_pk_fma_f32 v[200:201], v[24:25], v[240:241], v[200:201] op_sel_hi:[1,0,1] neg_lo:[0,1,0] neg_hi:[0,1,0]
    v_pk_fma_f32 v[202:203], v[26:27], v[240:241], v[202:203] op_sel_hi:[1,0,1] neg_lo:[0,1,0] neg_hi:[0,1,0]
    v_pk_fma_f32 v[204:205], v[28:29], v[240:241], v[204:205] op_sel_hi:[1,0,1] neg_lo:[0,1,0] neg_hi:[0,1,0]
    v_pk_fma_f32 v[206:207], v[30:31], v[240:241], v[206:207] op_sel_hi:[1,0,1] neg_lo:[0,1,0] neg_hi:[0,1,0]
    v_pk_fma_f32 v[208:209], v[32:33], v[240:241], v[208:209] op_sel_hi:[1,0,1] neg_lo:[0,1,0] neg_hi:[0,1,0]
    v_pk_fma_f32 v[210:211], v[34:35], v[240:241], v[210:211] op_sel_hi:[1,0,1] neg_lo:[0,1,0] neg_hi:[0,1,0]
    v_pk_mul_f32 v[200:201], v[200:201], v[242:243] op_sel_hi:[1,0]
    v_pk_mul_f32 v[202:203], v[202:203], v[242:243] op_sel_hi:[1,0]
    v_pk_mul_f32 v[204:205], v[204:205], v[242:243] op_sel_hi:[1,0]
    v_pk_mul_f32 v[206:207], v[206:207], v[242:243] op_sel_hi:[1,0]
    v_pk_mul_f32 v[208:209], v[208:209], v[242:243] op_sel_hi:[1,0]
    v_pk_mul_f32 v[210:211], v[210:211], v[242:243] op_sel_hi:[1,0]
    v_pk_mul_f32 v[8:9], v[200:201], v[200:201]
    v_pk_mul_f32 v[10:11], v[202:203], v[202:203]
    v_pk_mul_f32 v[12:13], v[204:205], v[204:205]
    v_pk_mul_f32 v[14:15], v[206:207], v[206:207]
    v_pk_mul_f32 v[16:17], v[208:209], v[208:209]
    v_pk_mul_f32 v[18:19], v[210:211], v[210:211]
    v_pk_fma_f32 v[8:9], v[8:9], s[58:59], v[238:239]
    v_pk_fma_f32 v[10:11], v[10:11], s[58:59], v[238:239]
    v_pk_fma_f32 v[12:13], v[12:13], s[58:59], v[238:239]
    v_pk_fma_f32 v[14:15], v[14:15], s[58:59], v[238:239]
    v_pk_fma_f32 v[16:17], v[16:17], s[58:59], v[238:239]
    v_pk_fma_f32 v[18:19], v[18:19], s[58:59], v[238:239]
    v_pk_mul_f32 v[8:9], v[8:9], v[200:201]
    v_pk_mul_f32 v[10:11], v[10:11], v[202:203]
    v_pk_mul_f32 v[12:13], v[12:13], v[204:205]
    v_pk_mul_f32 v[14:15], v[14:15], v[206:207]
    v_pk_mul_f32 v[16:17], v[16:17], v[208:209]
    v_pk_mul_f32 v[18:19], v[18:19], v[210:211]
    v_exp_f32 v8, v8
    v_exp_f32 v9, v9
    v_exp_f32 v10, v10
    v_exp_f32 v11, v11
    v_exp_f32 v12, v12
    v_exp_f32 v13, v13
    v_exp_f32 v14, v14
    v_exp_f32 v15, v15
    v_exp_f32 v16, v16
    v_exp_f32 v17, v17
    v_exp_f32 v18, v18
    v_exp_f32 v19, v19
    v_pk_add_f32 v[8:9], v[8:9], 1.0 op_sel_hi:[1,0]
    v_pk_add_f32 v[10:11], v[10:11], 1.0 op_sel_hi:[1,0]
    v_pk_add_f32 v[12:13], v[12:13], 1.0 op_sel_hi:[1,0]
    v_pk_add_f32 v[14:15], v[14:15], 1.0 op_sel_hi:[1,0]
    v_pk_add_f32 v[16:17], v[16:17], 1.0 op_sel_hi:[1,0]
    v_pk_add_f32 v[18:19], v[18:19], 1.0 op_sel_hi:[1,0]
    v_rcp_f32 v8, v8
    v_rcp_f32 v9, v9
    v_rcp_f32 v10, v10
    v_rcp_f32 v11, v11
    v_rcp_f32 v12, v12
    v_rcp_f32 v13, v13
    v_rcp_f32 v14, v14
    v_rcp_f32 v15, v15
    v_rcp_f32 v16, v16
    v_rcp_f32 v17, v17
    v_rcp_f32 v18, v18
    v_rcp_f32 v19, v19
    v_pk_mul_f32 v[200:201], v[200:201], v[8:9]
    v_pk_mul_f32 v[202:203], v[202:203], v[10:11]
    v_pk_mul_f32 v[204:205], v[204:205], v[12:13]
    v_pk_mul_f32 v[206:207], v[206:207], v[14:15]
    v_pk_mul_f32 v[208:209], v[208:209], v[16:17]
    v_pk_mul_f32 v[210:211], v[210:211], v[18:19]
    v_pk_add_f32 v[14:15], v[200:201], v[202:203]
    v_pk_mul_f32 v[16:17], v[200:201], v[200:201]
    v_pk_add_f32 v[18:19], v[204:205], v[206:207]
    v_pk_fma_f32 v[16:17], v[202:203], v[202:203], v[16:17]
    v_pk_add_f32 v[20:21], v[208:209], v[210:211]
    v_pk_fma_f32 v[16:17], v[204:205], v[204:205], v[16:17]
    v_pk_add_f32 v[14:15], v[14:15], v[18:19]
    v_pk_fma_f32 v[16:17], v[206:207], v[206:207], v[16:17]
    v_pk_add_f32 v[14:15], v[14:15], v[20:21]
    v_pk_fma_f32 v[16:17], v[208:209], v[208:209], v[16:17]
    v_pk_fma_f32 v[16:17], v[210:211], v[210:211], v[16:17]
    v_add_f32 v8, v14, v15
    v_add_f32 v9, v16, v17
    v_lshl_add_u32 v4, v3, 3, s76
    v_mov_b32 v12, v8
    v_mov_b32 v13, v9
    s_nop 0
    v_permlane16_swap_b32 v8, v12
    v_permlane16_swap_b32 v9, v13
    v_add_f32 v8, v8, v12
    v_add_f32 v9, v9, v13
    v_mov_b32 v12, v8
    v_mov_b32 v13, v9
    s_nop 0
    v_permlane32_swap_b32 v8, v12
    v_permlane32_swap_b32 v9, v13
    v_add_f32 v8, v8, v12
    v_add_f32 v9, v9, v13
    s_mov_b64 exec, 0xffff
    ds_write_b64 v4, v[8:9]
    s_mov_b64 exec, -1
    s_or_b32 s48, s41, s43
    s_cmp_eq_u32 s48, 0
    v_lshlrev_b32 v4, 3, v3
    s_cselect_b64 exec, 0xffff, 0
    buffer_store_dwordx2 v[240:241], v4, s[24:27], s79 offen sc1
    s_mov_b64 exec, -1
    v_mfma_f32_16x16x32_bf16 v[176:179], v[152:155], v[48:51], 0
    ds_read_b64_tr_b16 v[128:129], v217 offset:0
    ds_read_b64_tr_b16 v[130:131], v217 offset:768
    v_mfma_f32_16x16x32_bf16 v[180:183], v[152:155], v[52:55], 0
    s_add_u32 s65, s54, s98
    s_add_u32 m0, s61, 131072
    s_nop 0
    buffer_load_dwordx4 v40, s[8:11], s65 offen lds
    ds_read_b64_tr_b16 v[132:133], v218 offset:0
    ds_read_b64_tr_b16 v[134:135], v218 offset:768
    v_mfma_f32_16x16x32_bf16 v[224:227], v[152:155], v[244:247], 0
    ds_read_b64_tr_b16 v[136:137], v219 offset:0
    ds_read_b64_tr_b16 v[138:139], v219 offset:768
    v_mfma_f32_16x16x32_bf16 v[184:187], v[156:159], v[48:51], 0
    ds_read_b64_tr_b16 v[140:141], v220 offset:0
    ds_read_b64_tr_b16 v[142:143], v220 offset:768
    v_mfma_f32_16x16x32_bf16 v[188:191], v[156:159], v[52:55], 0
    s_add_u32 s65, s54, s98
    s_add_u32 m0, s61, 132096
    s_nop 0
    buffer_load_dwordx4 v41, s[8:11], s65 offen lds
    ds_read_b64_tr_b16 v[144:145], v221 offset:0
    ds_read_b64_tr_b16 v[146:147], v221 offset:768
    v_mfma_f32_16x16x32_bf16 v[228:231], v[156:159], v[244:247], 0
    ds_read_b64_tr_b16 v[148:149], v222 offset:0
    ds_read_b64_tr_b16 v[150:151], v222 offset:768
    v_mfma_f32_16x16x32_bf16 v[192:195], v[160:163], v[48:51], 0
    v_mfma_f32_16x16x32_bf16 v[196:199], v[160:163], v[52:55], 0
    s_add_u32 s65, s54, s98
    s_add_u32 m0, s61, 133120
    s_nop 0
    buffer_load_dwordx4 v42, s[8:11], s65 offen lds
    v_mfma_f32_16x16x32_bf16 v[232:235], v[160:163], v[244:247], 0
    v_mfma_f32_16x16x32_bf16 v[176:179], v[164:167], v[56:59], v[176:179]
    v_mfma_f32_16x16x32_bf16 v[180:183], v[164:167], v[60:63], v[180:183]
    v_mul_u32_u24 v4, 1280, v43
    v_lshl_add_u32 v4, v44, 4, v4
    s_mul_i32 s51, s41, 160
    s_add_u32 s51, s51, s52
    s_mul_i32 s48, s42, 7680
    s_add_u32 s48, s48, s51
    s_sub_i32 s48, s48, 3840
    s_cmp_lt_i32 s48, 0
    s_cselect_b32 s49, 3840, 0
    s_add_u32 s48, s48, s49
    v_subrev_u32 v5, s49, v4
    s_mul_i32 s50, s42, 960
    s_add_u32 m0, s50, 65536
    s_mov_b32 exec_lo, -1
    s_mov_b32 exec_hi, 0xfffffff
    buffer_load_dwordx4 v5, s[12:15], s48 offen lds
    s_mov_b64 exec, -1
    v_mfma_f32_16x16x32_bf16 v[184:187], v[168:171], v[56:59], v[184:187]
    v_mfma_f32_16x16x32_bf16 v[188:191], v[168:171], v[60:63], v[188:191]
    v_mfma_f32_16x16x32_bf16 v[192:195], v[172:175], v[56:59], v[192:195]
    s_cmp_ge_u32 s42, 4
    s_mov_b32 exec_lo, -1
    s_mov_b32 exec_hi, 0xfffffff
    s_cbranch_scc1 k1_kvv_2
    s_mul_i32 s48, s42, 7680
    s_add_u32 s48, s48, s51
    s_add_u32 s48, s48, 57600
    s_mul_i32 s50, s42, 960
    s_add_u32 m0, s50, 73216
    s_nop 0
    buffer_load_dwordx4 v4, s[12:15], s48 offen lds
    s_branch k1_kve_3
k1_kvv_2:
    s_sub_u32 s49, s42, 4
    s_mul_i32 s48, s49, 7680
    s_add_u32 s48, s48, s51
    s_mul_i32 s50, s49, 960
    s_add_u32 m0, s50, 49152
    s_nop 0
    buffer_load_dwordx4 v4, s[16:19], s48 offen lds
k1_kve_3:
    s_mov_b64 exec, -1
    v_mfma_f32_16x16x32_bf16 v[196:199], v[172:175], v[60:63], v[196:199]
    s_add_u32 s49, s42, 4
    s_mul_i32 s48, s49, 7680
    s_add_u32 s48, s48, s51
    s_mul_i32 s50, s49, 960
    s_add_u32 m0, s50, 49152
    s_mov_b32 exec_lo, -1
    s_mov_b32 exec_hi, 0xfffffff
    buffer_load_dwordx4 v4, s[16:19], s48 offen lds
    s_mov_b64 exec, -1
    s_mul_i32 s48, s89, 1280
    s_add_u32 s48, s48, 640
    s_mov_b64 exec, 0x1f
    buffer_load_dword v37, v36, s[36:39], s48 offen
    s_mov_b64 exec, -1
    s_waitcnt vmcnt(8)
    s_waitcnt lgkmcnt(0)
    s_barrier
    s_cmp_lg_u32 s42, 0
    s_cbranch_scc1 k1_pub_4
    v_lshlrev_b32 v4, 3, v1
    v_add_u32 v5, 159744, v4
    ds_read_b64 v[8:9], v5
    ds_read_b64 v[12:13], v5 offset:512
    v_lshlrev_b32 v4, 4, v1
    v_mov_b32 v10, s100
    v_mov_b32 v11, s101
    s_waitcnt lgkmcnt(0)
    v_pk_add_f32 v[8:9], v[8:9], v[12:13]
k1_pub_4:
    s_cmp_eq_u32 s42, 0
    s_cselect_b64 exec, -1, 0
    buffer_store_dwordx4 v[8:11], v4, s[24:27], s77 offen sc1
    s_mov_b64 exec, -1
    v_mfma_f32_16x16x32_bf16 v[176:179], v[128:131], v[64:67], v[176:179]
    ds_read_b64_tr_b16 v[152:153], v217 offset:24576
    ds_read_b64_tr_b16 v[154:155], v217 offset:25344
    v_mfma_f32_16x16x32_bf16 v[180:183], v[128:131], v[68:71], v[180:183]
    s_add_u32 s65, s54, s99
    s_add_u32 m0, s61, 81920
    s_nop 0
    buffer_load_dwordx4 v40, s[8:11], s65 offen lds
    ds_read_b64_tr_b16 v[156:157], v218 offset:24576
    ds_read_b64_tr_b16 v[158:159], v218 offset:25344
    v_mfma_f32_16x16x32_bf16 v[224:227], v[128:131], v[244:247], v[224:227]
    ds_read_b64_tr_b16 v[160:161], v219 offset:24576
    ds_read_b64_tr_b16 v[162:163], v219 offset:25344
    v_mfma_f32_16x16x32_bf16 v[184:187], v[132:135], v[64:67], v[184:187]
    ds_read_b64_tr_b16 v[164:165], v220 offset:24576
    ds_read_b64_tr_b16 v[166:167], v220 offset:25344
    v_mfma_f32_16x16x32_bf16 v[188:191], v[132:135], v[68:71], v[188:191]
    s_add_u32 s65, s54, s99
    s_add_u32 m0, s61, 82944
    s_nop 0
    buffer_load_dwordx4 v41, s[8:11], s65 offen lds
    ds_read_b64_tr_b16 v[168:169], v221 offset:24576
    ds_read_b64_tr_b16 v[170:171], v221 offset:25344
    v_mfma_f32_16x16x32_bf16 v[228:231], v[132:135], v[244:247], v[228:231]
    ds_read_b64_tr_b16 v[172:173], v222 offset:24576
    ds_read_b64_tr_b16 v[174:175], v222 offset:25344
    v_mfma_f32_16x16x32_bf16 v[192:195], v[136:139], v[64:67], v[192:195]
    v_mfma_f32_16x16x32_bf16 v[196:199], v[136:139], v[68:71], v[196:199]
    s_add_u32 s65, s54, s99
    s_add_u32 m0, s61, 83968
    s_nop 0
    buffer_load_dwordx4 v42, s[8:11], s65 offen lds
    v_mfma_f32_16x16x32_bf16 v[232:235], v[136:139], v[244:247], v[232:235]
    v_mfma_f32_16x16x32_bf16 v[176:179], v[140:143], v[72:75], v[176:179]
    v_mfma_f32_16x16x32_bf16 v[180:183], v[140:143], v[76:79], v[180:183]
    v_mfma_f32_16x16x32_bf16 v[184:187], v[144:147], v[72:75], v[184:187]
    v_mfma_f32_16x16x32_bf16 v[188:191], v[144:147], v[76:79], v[188:191]
    v_mfma_f32_16x16x32_bf16 v[192:195], v[148:151], v[72:75], v[192:195]
    v_mfma_f32_16x16x32_bf16 v[196:199], v[148:151], v[76:79], v[196:199]
    s_waitcnt vmcnt(8)
    s_waitcnt lgkmcnt(0)
    s_barrier
    v_mfma_f32_16x16x32_bf16 v[176:179], v[152:155], v[80:83], v[176:179]
    ds_read_b64_tr_b16 v[128:129], v217 offset:49152
    ds_read_b64_tr_b16 v[130:131], v217 offset:49920
    v_mfma_f32_16x16x32_bf16 v[180:183], v[152:155], v[84:87], v[180:183]
    s_add_u32 s48, s66, 0
    s_mov_b64 exec, 0xff
    buffer_load_dword v37, v215, s[32:35], s48 offen
    s_mov_b64 exec, -1
    ds_read_b64_tr_b16 v[132:133], v218 offset:49152
    ds_read_b64_tr_b16 v[134:135], v218 offset:49920
    v_mfma_f32_16x16x32_bf16 v[224:227], v[152:155], v[244:247], v[224:227]
    ds_read_b64_tr_b16 v[136:137], v219 offset:49152
    ds_read_b64_tr_b16 v[138:139], v219 offset:49920
    v_mfma_f32_16x16x32_bf16 v[184:187], v[156:159], v[80:83], v[184:187]
    ds_read_b64_tr_b16 v[140:141], v220 offset:49152
    ds_read_b64_tr_b16 v[142:143], v220 offset:49920
    v_mfma_f32_16x16x32_bf16 v[188:191], v[156:159], v[84:87], v[188:191]
    s_add_u32 s48, s66, 128
    s_mov_b64 exec, 0xff
    buffer_load_dword v37, v215, s[32:35], s48 offen
    s_mov_b64 exec, -1
    ds_read_b64_tr_b16 v[144:145], v221 offset:49152
    ds_read_b64_tr_b16 v[146:147], v221 offset:49920
    v_mfma_f32_16x16x32_bf16 v[228:231], v[156:159], v[244:247], v[228:231]
    ds_read_b64_tr_b16 v[148:149], v222 offset:49152
    ds_read_b64_tr_b16 v[150:151], v222 offset:49920
    v_mfma_f32_16x16x32_bf16 v[192:195], v[160:163], v[80:83], v[192:195]
    v_mfma_f32_16x16x32_bf16 v[196:199], v[160:163], v[84:87], v[196:199]
    s_add_u32 s48, s66, 256
    s_mov_b64 exec, 0xff
    buffer_load_dword v37, v215, s[32:35], s48 offen
    s_mov_b64 exec, -1
    v_mfma_f32_16x16x32_bf16 v[232:235], v[160:163], v[244:247], v[232:235]
    v_mfma_f32_16x16x32_bf16 v[176:179], v[164:167], v[88:91], v[176:179]
    v_mfma_f32_16x16x32_bf16 v[180:183], v[164:167], v[92:95], v[180:183]
    s_add_u32 s48, s66, 384
    s_mov_b64 exec, 0xff
    buffer_load_dword v37, v215, s[32:35], s48 offen
    s_mov_b64 exec, -1
    v_mfma_f32_16x16x32_bf16 v[184:187], v[168:171], v[88:91], v[184:187]
    v_mfma_f32_16x16x32_bf16 v[188:191], v[168:171], v[92:95], v[188:191]
    v_mfma_f32_16x16x32_bf16 v[192:195], v[172:175], v[88:91], v[192:195]
    s_mul_i32 s48, s89, 512
    s_add_u32 s48, s48, 0
    s_mov_b64 exec, 0xf
    buffer_load_dword v37, v36, s[84:87], s48 offen
    s_mov_b64 exec, -1
    v_mfma_f32_16x16x32_bf16 v[196:199], v[172:175], v[92:95], v[196:199]
    s_waitcnt vmcnt(5)
    s_waitcnt lgkmcnt(0)
    s_barrier
    v_lshlrev_b32 v38, 4, v3
    v_lshl_add_u32 v38, v2, 11, v38
    buffer_load_dwordx4 v[28:31], v38, s[24:27], s78 offen sc1
    buffer_load_dwordx4 v[32:35], v38, s[24:27], s78 offen offset:1024 sc1
    v_mfma_f32_16x16x32_bf16 v[176:179], v[128:131], v[96:99], v[176:179]
    ds_read_b64_tr_b16 v[152:153], v217 offset:0
    ds_read_b64_tr_b16 v[154:155], v217 offset:768
    v_mfma_f32_16x16x32_bf16 v[180:183], v[128:131], v[100:103], v[180:183]
    s_add_u32 s48, s66, 512
    s_mov_b64 exec, 0xff
    buffer_load_dword v37, v215, s[32:35], s48 offen
    s_mov_b64 exec, -1
    ds_read_b64_tr_b16 v[156:157], v218 offset:0
    ds_read_b64_tr_b16 v[158:159], v218 offset:768
    v_mfma_f32_16x16x32_bf16 v[224:227], v[128:131], v[244:247], v[224:227]
    ds_read_b64_tr_b16 v[160:161], v219 offset:0
    ds_read_b64_tr_b16 v[162:163], v219 offset:768
    v_mfma_f32_16x16x32_bf16 v[184:187], v[132:135], v[96:99], v[184:187]
    ds_read_b64_tr_b16 v[164:165], v220 offset:0
    ds_read_b64_tr_b16 v[166:167], v220 offset:768
    v_mfma_f32_16x16x32_bf16 v[188:191], v[132:135], v[100:103], v[188:191]
    s_add_u32 s48, s66, 640
    s_mov_b64 exec, 0xff
    buffer_load_dword v37, v215, s[32:35], s48 offen
    s_mov_b64 exec, -1
    ds_read_b64_tr_b16 v[168:169], v221 offset:0
    ds_read_b64_tr_b16 v[170:171], v221 offset:768
    v_mfma_f32_16x16x32_bf16 v[228:231], v[132:135], v[244:247], v[228:231]
    ds_read_b64_tr_b16 v[172:173], v222 offset:0
    ds_read_b64_tr_b16 v[174:175], v222 offset:768
    v_mfma_f32_16x16x32_bf16 v[192:195], v[136:139], v[96:99], v[192:195]
    v_mfma_f32_16x16x32_bf16 v[196:199], v[136:139], v[100:103], v[196:199]
    s_add_u32 s48, s66, 768
    s_mov_b64 exec, 0xff
    buffer_load_dword v37, v215, s[32:35], s48 offen
    s_mov_b64 exec, -1
    v_mfma_f32_16x16x32_bf16 v[232:235], v[136:139], v[244:247], v[232:235]
    v_mfma_f32_16x16x32_bf16 v[176:179], v[140:143], v[104:107], v[176:179]
    v_mfma_f32_16x16x32_bf16 v[180:183], v[140:143], v[108:111], v[180:183]
    s_add_u32 s48, s66, 896
    s_mov_b64 exec, 0xff
    buffer_load_dword v37, v215, s[32:35], s48 offen
    s_mov_b64 exec, -1
    v_mfma_f32_16x16x32_bf16 v[184:187], v[144:147], v[104:107], v[184:187]
    v_mfma_f32_16x16x32_bf16 v[188:191], v[144:147], v[108:111], v[188:191]
    v_mfma_f32_16x16x32_bf16 v[192:195], v[148:151], v[104:107], v[192:195]
    v_mfma_f32_16x16x32_bf16 v[196:199], v[148:151], v[108:111], v[196:199]
    v_add_u32 v4, 65536, v7
    ds_read_b128 v[48:51], v4 offset:0
    ds_read_b128 v[52:55], v4 offset:160
    ds_read_b128 v[56:59], v4 offset:320
    ds_read_b128 v[60:63], v4 offset:480
    ds_read_b128 v[64:67], v4 offset:640
    v_add_u32 v4, 49152, v7
    ds_read_b128 v[68:71], v4
    ds_read_b128 v[72:75], v4 offset:160
    s_waitcnt lgkmcnt(0)
    v_mul_u32_u24 v7, 1152, v44
    v_lshlrev_b32 v102, 2, v43
    v_sub_u32 v7, v7, v102
    s_lshl_b32 s48, s42, 4
    s_add_u32 s48, s48, 106508
    v_add_u32 v7, s48, v7
    v_lshlrev_b32 v44, 6, v44
    v_add_u32 v44, 160768, v44
    ds_read_b128 v[104:107], v44 offset:0
    ds_read_b128 v[108:111], v44 offset:16
    v_lshlrev_b32 v76, 16, v48
    v_and_b32 v77, 0xffff0000, v48
    v_lshlrev_b32 v78, 16, v52
    v_and_b32 v79, 0xffff0000, v52
    v_lshlrev_b32 v80, 16, v56
    v_and_b32 v81, 0xffff0000, v56
    v_lshlrev_b32 v82, 16, v60
    v_and_b32 v83, 0xffff0000, v60
    v_lshlrev_b32 v84, 16, v64
    v_and_b32 v85, 0xffff0000, v64
    s_waitcnt lgkmcnt(0)
    v_lshlrev_b32 v86, 16, v104
    v_lshlrev_b32 v87, 16, v106
    v_and_b32 v88, 0xffff0000, v104
    v_and_b32 v89, 0xffff0000, v106
    v_lshlrev_b32 v90, 16, v105
    v_lshlrev_b32 v91, 16, v107
    v_and_b32 v92, 0xffff0000, v105
    v_and_b32 v93, 0xffff0000, v107
    v_pk_mul_f32 v[94:95], v[82:83], v[86:87]
    v_pk_mul_f32 v[96:97], v[84:85], v[86:87]
    v_pk_fma_f32 v[94:95], v[80:81], v[88:89], v[94:95]
    v_pk_fma_f32 v[96:97], v[82:83], v[88:89], v[96:97]
    v_pk_fma_f32 v[94:95], v[78:79], v[90:91], v[94:95]
    v_pk_fma_f32 v[96:97], v[80:81], v[90:91], v[96:97]
    v_pk_fma_f32 v[94:95], v[76:77], v[92:93], v[94:95]
    v_pk_fma_f32 v[96:97], v[78:79], v[92:93], v[96:97]
    v_lshlrev_b32 v98, 16, v68
    v_and_b32 v99, 0xffff0000, v68
    v_lshlrev_b32 v100, 16, v72
    v_and_b32 v101, 0xffff0000, v72
    v_pk_mul_f32 v[94:95], v[94:95], v[98:99]
    v_pk_mul_f32 v[96:97], v[96:97], v[100:101]
    v_cvt_pk_bf16_f32 v102, v96, v94
    v_cvt_pk_bf16_f32 v103, v97, v95
    s_mov_b32 exec_hi, 0xff
    ds_write_b32 v7, v102 offset:0
    ds_write_b32 v7, v103 offset:144
    s_mov_b32 exec_hi, -1
    v_lshlrev_b32 v76, 16, v49
    v_and_b32 v77, 0xffff0000, v49
    v_lshlrev_b32 v78, 16, v53
    v_and_b32 v79, 0xffff0000, v53
    v_lshlrev_b32 v80, 16, v57
    v_and_b32 v81, 0xffff0000, v57
    v_lshlrev_b32 v82, 16, v61
    v_and_b32 v83, 0xffff0000, v61
    v_lshlrev_b32 v84, 16, v65
    v_and_b32 v85, 0xffff0000, v65
    v_lshlrev_b32 v86, 16, v108
    v_lshlrev_b32 v87, 16, v110
    v_and_b32 v88, 0xffff0000, v108
    v_and_b32 v89, 0xffff0000, v110
    v_lshlrev_b32 v90, 16, v109
    v_lshlrev_b32 v91, 16, v111
    v_and_b32 v92, 0xffff0000, v109
    v_and_b32 v93, 0xffff0000, v111
    v_pk_mul_f32 v[94:95], v[82:83], v[86:87]
    v_pk_mul_f32 v[96:97], v[84:85], v[86:87]
    v_pk_fma_f32 v[94:95], v[80:81], v[88:89], v[94:95]
    v_pk_fma_f32 v[96:97], v[82:83], v[88:89], v[96:97]
    v_pk_fma_f32 v[94:95], v[78:79], v[90:91], v[94:95]
    v_pk_fma_f32 v[96:97], v[80:81], v[90:91], v[96:97]
    v_pk_fma_f32 v[94:95], v[76:77], v[92:93], v[94:95]
    v_pk_fma_f32 v[96:97], v[78:79], v[92:93], v[96:97]
    v_lshlrev_b32 v98, 16, v69
    v_and_b32 v99, 0xffff0000, v69
    v_lshlrev_b32 v100, 16, v73
    v_and_b32 v101, 0xffff0000, v73
    v_pk_mul_f32 v[94:95], v[94:95], v[98:99]
    v_pk_mul_f32 v[96:97], v[96:97], v[100:101]
    v_cvt_pk_bf16_f32 v102, v96, v94
    v_cvt_pk_bf16_f32 v103, v97, v95
    s_mov_b32 exec_hi, 0xff
    ds_write_b32 v7, v102 offset:288
    ds_write_b32 v7, v103 offset:432
    s_mov_b32 exec_hi, -1
    ds_read_b128 v[104:107], v44 offset:32
    ds_read_b128 v[108:111], v44 offset:48
    v_lshlrev_b32 v76, 16, v50
    v_and_b32 v77, 0xffff0000, v50
    v_lshlrev_b32 v78, 16, v54
    v_and_b32 v79, 0xffff0000, v54
    v_lshlrev_b32 v80, 16, v58
    v_and_b32 v81, 0xffff0000, v58
    v_lshlrev_b32 v82, 16, v62
    v_and_b32 v83, 0xffff0000, v62
    v_lshlrev_b32 v84, 16, v66
    v_and_b32 v85, 0xffff0000, v66
    s_waitcnt lgkmcnt(0)
    v_lshlrev_b32 v86, 16, v104
    v_lshlrev_b32 v87, 16, v106
    v_and_b32 v88, 0xffff0000, v104
    v_and_b32 v89, 0xffff0000, v106
    v_lshlrev_b32 v90, 16, v105
    v_lshlrev_b32 v91, 16, v107
    v_and_b32 v92, 0xffff0000, v105
    v_and_b32 v93, 0xffff0000, v107
    v_pk_mul_f32 v[94:95], v[82:83], v[86:87]
    v_pk_mul_f32 v[96:97], v[84:85], v[86:87]
    v_pk_fma_f32 v[94:95], v[80:81], v[88:89], v[94:95]
    v_pk_fma_f32 v[96:97], v[82:83], v[88:89], v[96:97]
    v_pk_fma_f32 v[94:95], v[78:79], v[90:91], v[94:95]
    v_pk_fma_f32 v[96:97], v[80:81], v[90:91], v[96:97]
    v_pk_fma_f32 v[94:95], v[76:77], v[92:93], v[94:95]
    v_pk_fma_f32 v[96:97], v[78:79], v[92:93], v[96:97]
    v_lshlrev_b32 v98, 16, v70
    v_and_b32 v99, 0xffff0000, v70
    v_lshlrev_b32 v100, 16, v74
    v_and_b32 v101, 0xffff0000, v74
    v_pk_mul_f32 v[94:95], v[94:95], v[98:99]
    v_pk_mul_f32 v[96:97], v[96:97], v[100:101]
    v_cvt_pk_bf16_f32 v102, v96, v94
    v_cvt_pk_bf16_f32 v103, v97, v95
    s_mov_b32 exec_hi, 0xff
    ds_write_b32 v7, v102 offset:576
    ds_write_b32 v7, v103 offset:720
    s_mov_b32 exec_hi, -1
    v_lshlrev_b32 v76, 16, v51
    v_and_b32 v77, 0xffff0000, v51
    v_lshlrev_b32 v78, 16, v55
    v_and_b32 v79, 0xffff0000, v55
    v_lshlrev_b32 v80, 16, v59
    v_and_b32 v81, 0xffff0000, v59
    v_lshlrev_b32 v82, 16, v63
    v_and_b32 v83, 0xffff0000, v63
    v_lshlrev_b32 v84, 16, v67
    v_and_b32 v85, 0xffff0000, v67
    v_lshlrev_b32 v86, 16, v108
    v_lshlrev_b32 v87, 16, v110
    v_and_b32 v88, 0xffff0000, v108
    v_and_b32 v89, 0xffff0000, v110
    v_lshlrev_b32 v90, 16, v109
    v_lshlrev_b32 v91, 16, v111
    v_and_b32 v92, 0xffff0000, v109
    v_and_b32 v93, 0xffff0000, v111
    v_pk_mul_f32 v[94:95], v[82:83], v[86:87]
    v_pk_mul_f32 v[96:97], v[84:85], v[86:87]
    v_pk_fma_f32 v[94:95], v[80:81], v[88:89], v[94:95]
    v_pk_fma_f32 v[96:97], v[82:83], v[88:89], v[96:97]
    v_pk_fma_f32 v[94:95], v[78:79], v[90:91], v[94:95]
    v_pk_fma_f32 v[96:97], v[80:81], v[90:91], v[96:97]
    v_pk_fma_f32 v[94:95], v[76:77], v[92:93], v[94:95]
    v_pk_fma_f32 v[96:97], v[78:79], v[92:93], v[96:97]
    v_lshlrev_b32 v98, 16, v71
    v_and_b32 v99, 0xffff0000, v71
    v_lshlrev_b32 v100, 16, v75
    v_and_b32 v101, 0xffff0000, v75
    v_pk_mul_f32 v[94:95], v[94:95], v[98:99]
    v_pk_mul_f32 v[96:97], v[96:97], v[100:101]
    v_cvt_pk_bf16_f32 v102, v96, v94
    v_cvt_pk_bf16_f32 v103, v97, v95
    s_mov_b32 exec_hi, 0xff
    ds_write_b32 v7, v102 offset:864
    ds_write_b32 v7, v103 offset:1008
    s_mov_b32 exec_hi, -1
    s_lshl_b32 s48, s47, 4
    v_add_u32 v43, s48, v3
    v_mul_u32_u24 v43, 200, v43
    v_lshl_add_u32 v43, v2, 3, v43
    s_mul_i32 s48, s43, 96
    s_add_u32 s48, s48, 0
    v_add_u32 v43, s48, v43
    s_waitcnt vmcnt(4)
    s_mov_b32 s65, 0
k1_poll_5:
    s_add_u32 s65, s65, 1
    s_cmp_gt_u32 s65, 100000
    s_cbranch_scc1 k1_polled_6
    v_cmp_ne_u32 vcc, s100, v30
    v_cmp_ne_u32 s[50:51], s101, v31
    s_nop 0
    s_or_b64 vcc, vcc, s[50:51]
    v_cmp_ne_u32 s[50:51], s100, v34
    s_nop 0
    s_or_b64 vcc, vcc, s[50:51]
    v_cmp_ne_u32 s[50:51], s101, v35
    s_nop 0
    s_or_b64 vcc, vcc, s[50:51]
    s_cmp_eq_u64 vcc, 0
    s_cbranch_scc1 k1_polled_6
    s_sleep 4
    buffer_load_dwordx4 v[28:31], v38, s[24:27], s78 offen sc1
    buffer_load_dwordx4 v[32:35], v38, s[24:27], s78 offen offset:1024 sc1
    s_waitcnt vmcnt(0)
    s_branch k1_poll_5
k1_polled_6:
    s_xor_b32 s48, s42, 1
    s_or_b32 s48, s48, s41
    s_cmp_lg_u32 s48, 0
    s_cbranch_scc1 k1_ep_7
    v_mov_b32 v4, 0
    v_mov_b32 v44, 1
    s_mov_b64 exec, 1
    buffer_atomic_add v44, v4, s[28:31], 0 offen sc0
    s_mov_b64 exec, -1
k1_ep_7:
    v_pk_add_f32 v[8:9], v[28:29], v[32:33]
    v_mov_b32 v10, v8
    v_mov_b32 v11, v9
    s_nop 0
    v_permlane16_swap_b32 v8, v10
    v_permlane16_swap_b32 v9, v11
    v_add_f32 v8, v8, v10
    v_add_f32 v9, v9, v11
    v_mov_b32 v10, v8
    v_mov_b32 v11, v9
    s_nop 0
    v_permlane32_swap_b32 v8, v10
    v_permlane32_swap_b32 v9, v11
    v_add_f32 v8, v8, v10
    v_add_f32 v9, v9, v11
    v_mul_f32 v8, 0x3aaaaaab, v8
    v_mul_f32 v9, 0x3aaaaaab, v9
    v_fma_f32 v9, -v8, v8, v9
    v_max_f32 v9, 0, v9
    v_cvt_pk_bf16_f32 v9, v9, v8
    v_and_b32 v8, 0xffff0000, v9
    v_lshlrev_b32 v9, 16, v9
    v_add_f32 v9, s55, v9
    v_cvt_pk_bf16_f32 v9, v9, v9
    v_and_b32 v9, 0xffff0000, v9
    v_sqrt_f32 v9, v9
    s_nop 0
    v_cvt_pk_bf16_f32 v9, v9, v9
    v_and_b32 v9, 0xffff0000, v9
    v_rcp_f32 v9, v9
    s_nop 0
    v_mov_b32 v10, v9
    v_pk_add_f32 v[200:201], v[200:201], v[8:9] op_sel_hi:[1,0] neg_lo:[0,1] neg_hi:[0,1]
    v_pk_add_f32 v[202:203], v[202:203], v[8:9] op_sel_hi:[1,0] neg_lo:[0,1] neg_hi:[0,1]
    v_pk_add_f32 v[204:205], v[204:205], v[8:9] op_sel_hi:[1,0] neg_lo:[0,1] neg_hi:[0,1]
    v_pk_add_f32 v[206:207], v[206:207], v[8:9] op_sel_hi:[1,0] neg_lo:[0,1] neg_hi:[0,1]
    v_pk_add_f32 v[208:209], v[208:209], v[8:9] op_sel_hi:[1,0] neg_lo:[0,1] neg_hi:[0,1]
    v_pk_add_f32 v[210:211], v[210:211], v[8:9] op_sel_hi:[1,0] neg_lo:[0,1] neg_hi:[0,1]
    v_pk_mul_f32 v[200:201], v[200:201], v[10:11] op_sel_hi:[1,0]
    v_pk_mul_f32 v[202:203], v[202:203], v[10:11] op_sel_hi:[1,0]
    v_pk_mul_f32 v[204:205], v[204:205], v[10:11] op_sel_hi:[1,0]
    v_pk_mul_f32 v[206:207], v[206:207], v[10:11] op_sel_hi:[1,0]
    v_pk_mul_f32 v[208:209], v[208:209], v[10:11] op_sel_hi:[1,0]
    v_pk_mul_f32 v[210:211], v[210:211], v[10:11] op_sel_hi:[1,0]
    v_cvt_pk_bf16_f32 v16, v200, v201
    v_cvt_pk_bf16_f32 v17, v202, v203
    ds_write_b64 v43, v[16:17] offset:0
    v_cvt_pk_bf16_f32 v18, v204, v205
    v_cvt_pk_bf16_f32 v19, v206, v207
    ds_write_b64 v43, v[18:19] offset:32
    v_cvt_pk_bf16_f32 v20, v208, v209
    v_cvt_pk_bf16_f32 v21, v210, v211
    ds_write_b64 v43, v[20:21] offset:64
    v_lshrrev_b32 v212, 1, v2
    v_lshrrev_b32 v5, 2, v3
    v_lshl_add_u32 v212, v212, 3, v5
    v_mul_u32_u24 v212, 200, v212
    v_and_b32 v5, 1, v2
    v_lshl_add_u32 v212, v5, 5, v212
    v_and_b32 v5, 3, v3
    v_lshl_add_u32 v212, v5, 3, v212
    v_lshlrev_b32 v213, 4, v1
    s_waitcnt lgkmcnt(0)
    s_barrier
    v_add_u32 v5, s88, v212
    ds_read_b64_tr_b16 v[8:9], v5
    ds_read_b64_tr_b16 v[10:11], v5 offset:800
    s_waitcnt lgkmcnt(0)
    buffer_store_dwordx4 v[8:11], v213, s[24:27], s64 offen sc1
    s_cmp_ge_u32 s42, 4
    s_cbranch_scc1 k1_fr_8
    v_add_u32 v5, s63, v212
    ds_read_b64_tr_b16 v[12:13], v5
    ds_read_b64_tr_b16 v[14:15], v5 offset:800
    s_waitcnt lgkmcnt(0)
    buffer_store_dwordx4 v[12:15], v213, s[24:27], s67 offen sc1
k1_fr_8:
    s_lshl_b32 s48, s42, 3
    v_lshrrev_b32 v4, 3, v1
    v_add_u32 v4, s48, v4
    v_and_b32 v5, 7, v1
    v_lshlrev_b32 v5, 4, v5
    v_mul_u32_u24 v6, 144, v4
    v_add_u32 v6, v6, v5
    v_add_u32 v6, 106496, v6
    ds_read_b128 v[16:19], v6
    v_lshlrev_b32 v4, 12, v4
    v_add_u32 v4, v4, v5
    s_waitcnt lgkmcnt(0)
    buffer_store_dwordx4 v[16:19], v4, s[24:27], s83 offen sc1
    s_lshl_b32 s48, s42, 3
    s_add_u32 s48, s48, 64
    v_lshrrev_b32 v4, 3, v1
    v_add_u32 v4, s48, v4
    v_and_b32 v5, 7, v1
    v_lshlrev_b32 v5, 4, v5
    v_mul_u32_u24 v6, 144, v4
    v_add_u32 v6, v6, v5
    v_add_u32 v6, 106496, v6
    ds_read_b128 v[20:23], v6
    v_lshlrev_b32 v4, 12, v4
    v_add_u32 v4, v4, v5
    s_waitcnt lgkmcnt(0)
    s_cmp_ge_u32 s42, 2
    s_cbranch_scc1 k1_kvskip_9
    buffer_store_dwordx4 v[20:23], v4, s[24:27], s83 offen sc1
k1_kvskip_9:
    v_mfma_f32_16x16x32_bf16 v[176:179], v[152:155], v[112:115], v[176:179]
    v_mfma_f32_16x16x32_bf16 v[180:183], v[152:155], v[116:119], v[180:183]
    v_mfma_f32_16x16x32_bf16 v[224:227], v[152:155], v[244:247], v[224:227]
    v_mfma_f32_16x16x32_bf16 v[184:187], v[156:159], v[112:115], v[184:187]
    v_mfma_f32_16x16x32_bf16 v[188:191], v[156:159], v[116:119], v[188:191]
    v_mfma_f32_16x16x32_bf16 v[228:231], v[156:159], v[244:247], v[228:231]
    v_mfma_f32_16x16x32_bf16 v[192:195], v[160:163], v[112:115], v[192:195]
    v_mfma_f32_16x16x32_bf16 v[196:199], v[160:163], v[116:119], v[196:199]
    v_mfma_f32_16x16x32_bf16 v[232:235], v[160:163], v[244:247], v[232:235]
    v_mfma_f32_16x16x32_bf16 v[176:179], v[164:167], v[120:123], v[176:179]
    v_mfma_f32_16x16x32_bf16 v[180:183], v[164:167], v[124:127], v[180:183]
    v_mfma_f32_16x16x32_bf16 v[184:187], v[168:171], v[120:123], v[184:187]
    v_mfma_f32_16x16x32_bf16 v[188:191], v[168:171], v[124:127], v[188:191]
    v_mfma_f32_16x16x32_bf16 v[192:195], v[172:175], v[120:123], v[192:195]
    v_mfma_f32_16x16x32_bf16 v[196:199], v[172:175], v[124:127], v[196:199]
    v_lshl_add_u32 v4, v1, 4, s70
    v_lshl_add_u32 v5, v2, 4, s72
    s_nop 1
    ds_write_b128 v4, v[180:183] offset:0
    s_nop 0
    ds_write_b128 v4, v[188:191] offset:1024
    s_nop 0
    ds_write_b128 v4, v[196:199] offset:2048
    s_mov_b32 exec_lo, 0x00010001
    s_mov_b32 exec_hi, 0x00010001
    ds_write_b128 v5, v[224:227] offset:1536
    ds_write_b128 v5, v[228:231] offset:1600
    ds_write_b128 v5, v[232:235] offset:1664
    s_mov_b64 exec, -1
    v_pk_add_f32 v[128:129], v[176:177], 0
    v_pk_add_f32 v[130:131], v[178:179], 0
    v_pk_add_f32 v[132:133], v[184:185], 0
    v_pk_add_f32 v[134:135], v[186:187], 0
    v_pk_add_f32 v[136:137], v[192:193], 0
    v_pk_add_f32 v[138:139], v[194:195], 0
    s_waitcnt vmcnt(0) lgkmcnt(0)
    s_barrier
    s_lshl_b32 s48, s41, 8
    s_lshl_b32 s49, s40, 3
    s_add_u32 s48, s48, s49
    s_add_u32 s48, s48, 14716928
    v_mov_b32 v8, s100
    v_mov_b32 v9, s101
    v_mov_b32 v4, 0
    s_cmp_eq_u32 s42, 0
    s_cselect_b64 exec, 1, 0
    buffer_store_dwordx2 v[8:9], v4, s[24:27], s48 offen sc1
    s_mov_b64 exec, -1
    v_lshl_add_u32 v4, v1, 4, s71
    ds_read_b128 v[48:51], v4 offset:0
    ds_read_b128 v[52:55], v4 offset:1024
    ds_read_b128 v[56:59], v4 offset:2048
    v_lshl_add_u32 v6, v2, 4, s73
    ds_read_b128 v[64:67], v6 offset:1536
    ds_read_b128 v[68:71], v6 offset:1600
    ds_read_b128 v[72:75], v6 offset:1664
    ds_read_b128 v[76:79], v6 offset:1728
    ds_read_b128 v[80:83], v6 offset:1792
    ds_read_b128 v[84:87], v6 offset:1856
    ds_read_b128 v[88:91], v6 offset:1920
    ds_read_b128 v[92:95], v6 offset:1984
    ds_read_b128 v[96:99], v6 offset:2048
    ds_read_b128 v[100:103], v6 offset:2112
    ds_read_b128 v[104:107], v6 offset:2176
    ds_read_b128 v[108:111], v6 offset:2240
    s_waitcnt lgkmcnt(12)
    v_pk_add_f32 v[128:129], v[128:129], v[48:49]
    v_pk_add_f32 v[130:131], v[130:131], v[50:51]
    v_pk_add_f32 v[132:133], v[132:133], v[52:53]
    v_pk_add_f32 v[134:135], v[134:135], v[54:55]
    v_pk_add_f32 v[136:137], v[136:137], v[56:57]
    v_pk_add_f32 v[138:139], v[138:139], v[58:59]
    s_waitcnt lgkmcnt(6)
    v_pk_add_f32 v[64:65], v[64:65], v[76:77]
    v_pk_add_f32 v[66:67], v[66:67], v[78:79]
    v_pk_add_f32 v[68:69], v[68:69], v[80:81]
    v_pk_add_f32 v[70:71], v[70:71], v[82:83]
    v_pk_add_f32 v[72:73], v[72:73], v[84:85]
    v_pk_add_f32 v[74:75], v[74:75], v[86:87]
    s_waitcnt lgkmcnt(0)
    v_pk_add_f32 v[88:89], v[88:89], v[100:101]
    v_pk_add_f32 v[90:91], v[90:91], v[102:103]
    v_pk_add_f32 v[92:93], v[92:93], v[104:105]
    v_pk_add_f32 v[94:95], v[94:95], v[106:107]
    v_pk_add_f32 v[96:97], v[96:97], v[108:109]
    v_pk_add_f32 v[98:99], v[98:99], v[110:111]
    v_pk_add_f32 v[64:65], v[64:65], v[88:89]
    v_pk_add_f32 v[66:67], v[66:67], v[90:91]
    v_pk_add_f32 v[68:69], v[68:69], v[92:93]
    v_pk_add_f32 v[70:71], v[70:71], v[94:95]
    v_pk_add_f32 v[72:73], v[72:73], v[96:97]
    v_pk_add_f32 v[74:75], v[74:75], v[98:99]
    v_pk_fma_f32 v[128:129], v[64:65], v[240:241], v[128:129] op_sel_hi:[1,0,1] neg_lo:[0,1,0] neg_hi:[0,1,0]
    v_pk_fma_f32 v[130:131], v[66:67], v[240:241], v[130:131] op_sel_hi:[1,0,1] neg_lo:[0,1,0] neg_hi:[0,1,0]
    v_pk_fma_f32 v[132:133], v[68:69], v[240:241], v[132:133] op_sel_hi:[1,0,1] neg_lo:[0,1,0] neg_hi:[0,1,0]
    v_pk_fma_f32 v[134:135], v[70:71], v[240:241], v[134:135] op_sel_hi:[1,0,1] neg_lo:[0,1,0] neg_hi:[0,1,0]
    v_pk_fma_f32 v[136:137], v[72:73], v[240:241], v[136:137] op_sel_hi:[1,0,1] neg_lo:[0,1,0] neg_hi:[0,1,0]
    v_pk_fma_f32 v[138:139], v[74:75], v[240:241], v[138:139] op_sel_hi:[1,0,1] neg_lo:[0,1,0] neg_hi:[0,1,0]
    v_pk_mul_f32 v[128:129], v[128:129], v[242:243] op_sel_hi:[1,0]
    v_pk_mul_f32 v[130:131], v[130:131], v[242:243] op_sel_hi:[1,0]
    v_pk_mul_f32 v[132:133], v[132:133], v[242:243] op_sel_hi:[1,0]
    v_pk_mul_f32 v[134:135], v[134:135], v[242:243] op_sel_hi:[1,0]
    v_pk_mul_f32 v[136:137], v[136:137], v[242:243] op_sel_hi:[1,0]
    v_pk_mul_f32 v[138:139], v[138:139], v[242:243] op_sel_hi:[1,0]
    v_pk_mul_f32 v[48:49], v[128:129], v[128:129]
    v_pk_mul_f32 v[50:51], v[130:131], v[130:131]
    v_pk_mul_f32 v[52:53], v[132:133], v[132:133]
    v_pk_mul_f32 v[54:55], v[134:135], v[134:135]
    v_pk_mul_f32 v[56:57], v[136:137], v[136:137]
    v_pk_mul_f32 v[58:59], v[138:139], v[138:139]
    v_pk_fma_f32 v[48:49], v[48:49], s[58:59], v[238:239]
    v_pk_fma_f32 v[50:51], v[50:51], s[58:59], v[238:239]
    v_pk_fma_f32 v[52:53], v[52:53], s[58:59], v[238:239]
    v_pk_fma_f32 v[54:55], v[54:55], s[58:59], v[238:239]
    v_pk_fma_f32 v[56:57], v[56:57], s[58:59], v[238:239]
    v_pk_fma_f32 v[58:59], v[58:59], s[58:59], v[238:239]
    v_pk_mul_f32 v[48:49], v[48:49], v[128:129]
    v_pk_mul_f32 v[50:51], v[50:51], v[130:131]
    v_pk_mul_f32 v[52:53], v[52:53], v[132:133]
    v_pk_mul_f32 v[54:55], v[54:55], v[134:135]
    v_pk_mul_f32 v[56:57], v[56:57], v[136:137]
    v_pk_mul_f32 v[58:59], v[58:59], v[138:139]
    v_exp_f32 v48, v48
    v_exp_f32 v49, v49
    v_exp_f32 v50, v50
    v_exp_f32 v51, v51
    v_exp_f32 v52, v52
    v_exp_f32 v53, v53
    v_exp_f32 v54, v54
    v_exp_f32 v55, v55
    v_exp_f32 v56, v56
    v_exp_f32 v57, v57
    v_exp_f32 v58, v58
    v_exp_f32 v59, v59
    v_pk_add_f32 v[48:49], v[48:49], 1.0 op_sel_hi:[1,0]
    v_pk_add_f32 v[50:51], v[50:51], 1.0 op_sel_hi:[1,0]
    v_pk_add_f32 v[52:53], v[52:53], 1.0 op_sel_hi:[1,0]
    v_pk_add_f32 v[54:55], v[54:55], 1.0 op_sel_hi:[1,0]
    v_pk_add_f32 v[56:57], v[56:57], 1.0 op_sel_hi:[1,0]
    v_pk_add_f32 v[58:59], v[58:59], 1.0 op_sel_hi:[1,0]
    v_rcp_f32 v48, v48
    v_rcp_f32 v49, v49
    v_rcp_f32 v50, v50
    v_rcp_f32 v51, v51
    v_rcp_f32 v52, v52
    v_rcp_f32 v53, v53
    v_rcp_f32 v54, v54
    v_rcp_f32 v55, v55
    v_rcp_f32 v56, v56
    v_rcp_f32 v57, v57
    v_rcp_f32 v58, v58
    v_rcp_f32 v59, v59
    v_pk_mul_f32 v[128:129], v[128:129], v[48:49]
    v_pk_mul_f32 v[130:131], v[130:131], v[50:51]
    v_pk_mul_f32 v[132:133], v[132:133], v[52:53]
    v_pk_mul_f32 v[134:135], v[134:135], v[54:55]
    v_pk_mul_f32 v[136:137], v[136:137], v[56:57]
    v_pk_mul_f32 v[138:139], v[138:139], v[58:59]
    v_lshrrev_b32 v4, 1, v2
    v_mul_u32_u24 v4, 3072, v4
    v_and_b32 v5, 1, v2
    v_lshlrev_b32 v5, 5, v5
    v_add_u32 v5, v5, v3
    v_lshl_add_u32 v4, v5, 4, v4
    v_cvt_pk_bf16_f32 v48, v128, v129
    v_cvt_pk_bf16_f32 v49, v130, v131
    v_add_u32 v5, s80, v4
    ds_write_b64 v5, v[48:49]
    v_cvt_pk_bf16_f32 v50, v132, v133
    v_cvt_pk_bf16_f32 v51, v134, v135
    v_add_u32 v5, s81, v4
    ds_write_b64 v5, v[50:51]
    v_cvt_pk_bf16_f32 v52, v136, v137
    v_cvt_pk_bf16_f32 v53, v138, v139
    v_add_u32 v5, s82, v4
    ds_write_b64 v5, v[52:53]
    s_xor_b32 s48, s42, 1
    s_or_b32 s48, s48, s41
    s_cmp_lg_u32 s48, 0
    s_cbranch_scc1 k1_ep2_10
    s_waitcnt vmcnt(0)
    v_readfirstlane_b32 s48, v44
    s_nop 0
    s_cmp_lg_u32 s48, 31
    s_cbranch_scc1 k1_ep2_10
    v_mov_b32 v8, s100
    v_mov_b32 v9, s101
    v_mov_b32 v4, 14712832
    s_mov_b64 exec, 1
    buffer_store_dwordx2 v[8:9], v4, s[24:27], 0 offen sc1
    s_mov_b64 exec, -1
k1_ep2_10:
    s_waitcnt lgkmcnt(0)
    s_barrier
    s_cmp_ge_u32 s42, 4
    s_cbranch_scc1 recurrent_scan__ssm_conv_h3__mixer_gmlp__prompt_kernel_conv
    s_load_dwordx2 s[4:5], s[0:1], 64
    s_load_dwordx2 s[8:9], s[0:1], 104
    s_load_dwordx2 s[12:13], s[0:1], 72
    v_lshrrev_b32 v2, 6, v0
    v_and_b32 v1, 63, v0
    v_readfirstlane_b32 s34, v2
    s_mov_b32 s6, 8388608
    s_mov_b32 s7, 0x20000
    s_mov_b32 s10, 15990784
    s_mov_b32 s11, 0x20000
    s_mov_b32 s14, 4096
    s_mov_b32 s15, 0x20000
    s_and_b32 s40, s2, 7
    s_lshr_b32 s41, s2, 3
    s_and_b32 s41, s41, 31
    s_lshr_b32 s32, s40, 1
    s_lshl_b32 s32, s32, 3
    s_and_b32 s42, s41, 7
    s_add_u32 s32, s32, s42
    s_and_b32 s33, s40, 1
    s_lshl_b32 s33, s33, 2
    s_lshr_b32 s42, s41, 3
    s_add_u32 s33, s33, s42
    s_lshl_b32 s44, s33, 7
    s_lshl_b32 s40, s34, 5
    s_add_u32 s44, s44, s40
    s_mul_i32 s44, s44, 3072
    s_add_u32 s44, s44, 0
    s_lshl_b32 s45, s32, 18
    s_lshl_b32 s40, s34, 10
    s_add_u32 s45, s45, s40
    s_lshl_b32 s46, s34, 14
    v_lshlrev_b32 v5, 4, v1
    v_lshrrev_b32 v2, 3, v1
    v_lshlrev_b32 v2, 12, v2
    v_and_b32 v3, 7, v1
    v_lshrrev_b32 v4, 4, v1
    v_xor_b32 v3, v3, v4
    v_lshl_add_u32 v6, v3, 4, v2
    v_xor_b32 v7, 64, v6
    s_mov_b32 s50, 0
    s_waitcnt lgkmcnt(0)
    s_add_u32 s54, s50, 0
    s_and_b32 s54, s54, 7
    s_lshl_b32 s54, s54, 7
    s_add_u32 s54, s54, s45
    s_add_u32 s42, s54, 0
    s_add_u32 m0, s46, 0
    s_nop 0
    buffer_load_dwordx4 v6, s[4:7], s42 offen lds
    s_add_u32 s42, s54, 32768
    s_add_u32 m0, s46, 1024
    s_nop 0
    buffer_load_dwordx4 v7, s[4:7], s42 offen lds
    s_add_u32 s42, s54, 65536
    s_add_u32 m0, s46, 2048
    s_nop 0
    buffer_load_dwordx4 v6, s[4:7], s42 offen lds
    s_add_u32 s42, s54, 98304
    s_add_u32 m0, s46, 3072
    s_nop 0
    buffer_load_dwordx4 v7, s[4:7], s42 offen lds
    s_add_u32 s42, s54, 131072
    s_add_u32 m0, s46, 4096
    s_nop 0
    buffer_load_dwordx4 v6, s[4:7], s42 offen lds
    s_add_u32 s42, s54, 163840
    s_add_u32 m0, s46, 5120
    s_nop 0
    buffer_load_dwordx4 v7, s[4:7], s42 offen lds
    s_add_u32 s42, s54, 196608
    s_add_u32 m0, s46, 6144
    s_nop 0
    buffer_load_dwordx4 v6, s[4:7], s42 offen lds
    s_add_u32 s42, s54, 229376
    s_add_u32 m0, s46, 7168
    s_nop 0
    buffer_load_dwordx4 v7, s[4:7], s42 offen lds
    s_lshl_b32 s43, s33, 8
    s_add_u32 s43, s43, 14716928
    v_mbcnt_lo_u32_b32 v2, -1, 0
    v_mbcnt_hi_u32_b32 v2, -1, v2
    v_and_b32 v2, 31, v2
    v_lshlrev_b32 v2, 3, v2
    s_mov_b32 s67, 0
fpoll_11:
    buffer_load_dwordx2 v[104:105], v2, s[8:11], s43 offen sc1
    s_add_u32 s67, s67, 1
    s_waitcnt vmcnt(0)
    v_cmp_ne_u32 vcc, s100, v104
    v_cmp_ne_u32 s[64:65], s101, v105
    s_nop 0
    s_or_b64 vcc, vcc, s[64:65]
    s_cmp_gt_u32 s67, 100000
    s_cbranch_scc1 fpoll_e_12
    s_cmp_eq_u64 vcc, 0
    s_cbranch_scc1 fpoll_e_12
    s_sleep 2
    s_branch fpoll_11
fpoll_e_12:
    s_add_u32 s52, s50, 0
    s_and_b32 s52, s52, 7
    s_mul_i32 s52, s52, 12288
    s_add_u32 s52, s52, s44
    buffer_load_dwordx4 v[104:107], v5, s[8:11], s52 offen offset:0 sc1
    buffer_load_dwordx4 v[108:111], v5, s[8:11], s52 offen offset:1024 sc1
    buffer_load_dwordx4 v[112:115], v5, s[8:11], s52 offen offset:2048 sc1
    s_add_u32 s41, s52, 3072
    buffer_load_dwordx4 v[116:119], v5, s[8:11], s41 offen offset:0 sc1
    s_add_u32 s41, s52, 3072
    buffer_load_dwordx4 v[120:123], v5, s[8:11], s41 offen offset:1024 sc1
    s_add_u32 s41, s52, 3072
    buffer_load_dwordx4 v[124:127], v5, s[8:11], s41 offen offset:2048 sc1
    s_add_u32 s41, s52, 6144
    buffer_load_dwordx4 v[128:131], v5, s[8:11], s41 offen offset:0 sc1
    s_add_u32 s41, s52, 6144
    buffer_load_dwordx4 v[132:135], v5, s[8:11], s41 offen offset:1024 sc1
    s_add_u32 s41, s52, 6144
    buffer_load_dwordx4 v[136:139], v5, s[8:11], s41 offen offset:2048 sc1
    s_add_u32 s41, s52, 9216
    buffer_load_dwordx4 v[140:143], v5, s[8:11], s41 offen offset:0 sc1
    s_add_u32 s41, s52, 9216
    buffer_load_dwordx4 v[144:147], v5, s[8:11], s41 offen offset:1024 sc1
    s_add_u32 s41, s52, 9216
    buffer_load_dwordx4 v[148:151], v5, s[8:11], s41 offen offset:2048 sc1
    v_and_b32 v2, 31, v1
    v_lshrrev_b32 v3, 1, v2
    v_and_b32 v3, 7, v3
    v_lshrrev_b32 v4, 5, v1
    v_xor_b32 v3, v3, v4
    v_lshl_add_u32 v2, v2, 7, s46
    v_xor_b32 v4, 0, v3
    v_lshl_add_u32 v180, v4, 4, v2
    v_xor_b32 v4, 2, v3
    v_lshl_add_u32 v181, v4, 4, v2
    v_xor_b32 v4, 4, v3
    v_lshl_add_u32 v182, v4, 4, v2
    v_xor_b32 v4, 6, v3
    v_lshl_add_u32 v183, v4, 4, v2
    s_waitcnt vmcnt(12)
    s_setprio 2
    ds_read_b128 v[164:167], v180 offset:0
    ds_read_b128 v[168:171], v180 offset:4096
    s_waitcnt vmcnt(9)
    s_waitcnt lgkmcnt(0)
    v_mfma_f32_32x32x16_bf16 v[8:23], v[104:107], v[164:167], 0
    ds_read_b128 v[172:175], v181 offset:0
    ds_read_b128 v[176:179], v181 offset:4096
    v_mfma_f32_32x32x16_bf16 v[24:39], v[104:107], v[168:171], 0
    s_add_u32 s53, s50, 1
    s_and_b32 s53, s53, 7
    s_mul_i32 s53, s53, 12288
    s_add_u32 s53, s53, s44
    buffer_load_dwordx4 v[152:155], v5, s[8:11], s53 offen offset:0 sc1
    v_mfma_f32_32x32x16_bf16 v[40:55], v[108:111], v[164:167], 0
    buffer_load_dwordx4 v[156:159], v5, s[8:11], s53 offen offset:1024 sc1
    v_mfma_f32_32x32x16_bf16 v[56:71], v[108:111], v[168:171], 0
    buffer_load_dwordx4 v[160:163], v5, s[8:11], s53 offen offset:2048 sc1
    v_mfma_f32_32x32x16_bf16 v[72:87], v[112:115], v[164:167], 0
    s_add_u32 s55, s50, 1
    s_and_b32 s55, s55, 7
    s_lshl_b32 s55, s55, 7
    s_add_u32 s55, s55, s45
    s_add_u32 s42, s55, 0
    s_add_u32 m0, s46, 8192
    s_nop 0
    buffer_load_dwordx4 v6, s[4:7], s42 offen lds
    v_mfma_f32_32x32x16_bf16 v[88:103], v[112:115], v[168:171], 0
    s_add_u32 s42, s55, 32768
    s_add_u32 m0, s46, 9216
    s_nop 0
    buffer_load_dwordx4 v7, s[4:7], s42 offen lds
    s_add_u32 s42, s55, 65536
    s_add_u32 m0, s46, 10240
    s_nop 0
    buffer_load_dwordx4 v6, s[4:7], s42 offen lds
    s_add_u32 s42, s55, 98304
    s_add_u32 m0, s46, 11264
    s_nop 0
    buffer_load_dwordx4 v7, s[4:7], s42 offen lds
    s_waitcnt vmcnt(13)
    s_waitcnt lgkmcnt(0)
    v_mfma_f32_32x32x16_bf16 v[8:23], v[116:119], v[172:175], v[8:23]
    ds_read_b128 v[164:167], v182 offset:0
    ds_read_b128 v[168:171], v182 offset:4096
    v_mfma_f32_32x32x16_bf16 v[24:39], v[116:119], v[176:179], v[24:39]
    s_add_u32 s41, s53, 3072
    buffer_load_dwordx4 v[104:107], v5, s[8:11], s41 offen offset:0 sc1
    v_mfma_f32_32x32x16_bf16 v[40:55], v[120:123], v[172:175], v[40:55]
    s_add_u32 s41, s53, 3072
    buffer_load_dwordx4 v[108:111], v5, s[8:11], s41 offen offset:1024 sc1
    v_mfma_f32_32x32x16_bf16 v[56:71], v[120:123], v[176:179], v[56:71]
    s_add_u32 s41, s53, 3072
    buffer_load_dwordx4 v[112:115], v5, s[8:11], s41 offen offset:2048 sc1
    v_mfma_f32_32x32x16_bf16 v[72:87], v[124:127], v[172:175], v[72:87]
    s_add_u32 s42, s55, 131072
    s_add_u32 m0, s46, 12288
    s_nop 0
    buffer_load_dwordx4 v6, s[4:7], s42 offen lds
    v_mfma_f32_32x32x16_bf16 v[88:103], v[124:127], v[176:179], v[88:103]
    s_add_u32 s42, s55, 163840
    s_add_u32 m0, s46, 13312
    s_nop 0
    buffer_load_dwordx4 v7, s[4:7], s42 offen lds
    s_add_u32 s42, s55, 196608
    s_add_u32 m0, s46, 14336
    s_nop 0
    buffer_load_dwordx4 v6, s[4:7], s42 offen lds
    s_add_u32 s42, s55, 229376
    s_add_u32 m0, s46, 15360
    s_nop 0
    buffer_load_dwordx4 v7, s[4:7], s42 offen lds
    s_waitcnt vmcnt(17)
    s_waitcnt lgkmcnt(0)
    v_mfma_f32_32x32x16_bf16 v[8:23], v[128:131], v[164:167], v[8:23]
    ds_read_b128 v[172:175], v183 offset:0
    ds_read_b128 v[176:179], v183 offset:4096
    v_mfma_f32_32x32x16_bf16 v[24:39], v[128:131], v[168:171], v[24:39]
    s_add_u32 s41, s53, 6144
    buffer_load_dwordx4 v[116:119], v5, s[8:11], s41 offen offset:0 sc1
    v_mfma_f32_32x32x16_bf16 v[40:55], v[132:135], v[164:167], v[40:55]
    s_add_u32 s41, s53, 6144
    buffer_load_dwordx4 v[120:123], v5, s[8:11], s41 offen offset:1024 sc1
    v_mfma_f32_32x32x16_bf16 v[56:71], v[132:135], v[168:171], v[56:71]
    s_add_u32 s41, s53, 6144
    buffer_load_dwordx4 v[124:127], v5, s[8:11], s41 offen offset:2048 sc1
    v_mfma_f32_32x32x16_bf16 v[72:87], v[136:139], v[164:167], v[72:87]
    v_mfma_f32_32x32x16_bf16 v[88:103], v[136:139], v[168:171], v[88:103]
    s_waitcnt vmcnt(17)
    s_waitcnt lgkmcnt(0)
    v_mfma_f32_32x32x16_bf16 v[8:23], v[140:143], v[172:175], v[8:23]
    s_waitcnt vmcnt(3)
    ds_read_b128 v[164:167], v180 offset:8192
    ds_read_b128 v[168:171], v180 offset:12288
    v_mfma_f32_32x32x16_bf16 v[24:39], v[140:143], v[176:179], v[24:39]
    s_add_u32 s41, s53, 9216
    buffer_load_dwordx4 v[128:131], v5, s[8:11], s41 offen offset:0 sc1
    v_mfma_f32_32x32x16_bf16 v[40:55], v[144:147], v[172:175], v[40:55]
    s_add_u32 s41, s53, 9216
    buffer_load_dwordx4 v[132:135], v5, s[8:11], s41 offen offset:1024 sc1
    v_mfma_f32_32x32x16_bf16 v[56:71], v[144:147], v[176:179], v[56:71]
    s_add_u32 s41, s53, 9216
    buffer_load_dwordx4 v[136:139], v5, s[8:11], s41 offen offset:2048 sc1
    v_mfma_f32_32x32x16_bf16 v[72:87], v[148:151], v[172:175], v[72:87]
    s_add_u32 s54, s50, 2
    s_and_b32 s54, s54, 7
    s_lshl_b32 s54, s54, 7
    s_add_u32 s54, s54, s45
    s_add_u32 s42, s54, 0
    s_add_u32 m0, s46, 0
    s_nop 0
    buffer_load_dwordx4 v6, s[4:7], s42 offen lds
    v_mfma_f32_32x32x16_bf16 v[88:103], v[148:151], v[176:179], v[88:103]
    s_add_u32 s42, s54, 32768
    s_add_u32 m0, s46, 1024
    s_nop 0
    buffer_load_dwordx4 v7, s[4:7], s42 offen lds
    s_waitcnt vmcnt(19)
    s_waitcnt lgkmcnt(0)
    v_mfma_f32_32x32x16_bf16 v[8:23], v[152:155], v[164:167], v[8:23]
    ds_read_b128 v[172:175], v181 offset:8192
    ds_read_b128 v[176:179], v181 offset:12288
    v_mfma_f32_32x32x16_bf16 v[24:39], v[152:155], v[168:171], v[24:39]
    s_add_u32 s52, s50, 2
    s_and_b32 s52, s52, 7
    s_mul_i32 s52, s52, 12288
    s_add_u32 s52, s52, s44
    buffer_load_dwordx4 v[140:143], v5, s[8:11], s52 offen offset:0 sc1
    v_mfma_f32_32x32x16_bf16 v[40:55], v[156:159], v[164:167], v[40:55]
    buffer_load_dwordx4 v[144:147], v5, s[8:11], s52 offen offset:1024 sc1
    v_mfma_f32_32x32x16_bf16 v[56:71], v[156:159], v[168:171], v[56:71]
    buffer_load_dwordx4 v[148:151], v5, s[8:11], s52 offen offset:2048 sc1
    v_mfma_f32_32x32x16_bf16 v[72:87], v[160:163], v[164:167], v[72:87]
    s_add_u32 s42, s54, 65536
    s_add_u32 m0, s46, 2048
    s_nop 0
    buffer_load_dwordx4 v6, s[4:7], s42 offen lds
    v_mfma_f32_32x32x16_bf16 v[88:103], v[160:163], v[168:171], v[88:103]
    s_add_u32 s42, s54, 98304
    s_add_u32 m0, s46, 3072
    s_nop 0
    buffer_load_dwordx4 v7, s[4:7], s42 offen lds
    s_add_u32 s42, s54, 131072
    s_add_u32 m0, s46, 4096
    s_nop 0
    buffer_load_dwordx4 v6, s[4:7], s42 offen lds
    s_waitcnt vmcnt(18)
    s_waitcnt lgkmcnt(0)
    v_mfma_f32_32x32x16_bf16 v[8:23], v[104:107], v[172:175], v[8:23]
    ds_read_b128 v[164:167], v182 offset:8192
    ds_read_b128 v[168:171], v182 offset:12288
    v_mfma_f32_32x32x16_bf16 v[24:39], v[104:107], v[176:179], v[24:39]
    s_add_u32 s41, s52, 3072
    buffer_load_dwordx4 v[152:155], v5, s[8:11], s41 offen offset:0 sc1
    v_mfma_f32_32x32x16_bf16 v[40:55], v[108:111], v[172:175], v[40:55]
    s_add_u32 s41, s52, 3072
    buffer_load_dwordx4 v[156:159], v5, s[8:11], s41 offen offset:1024 sc1
    v_mfma_f32_32x32x16_bf16 v[56:71], v[108:111], v[176:179], v[56:71]
    s_add_u32 s41, s52, 3072
    buffer_load_dwordx4 v[160:163], v5, s[8:11], s41 offen offset:2048 sc1
    v_mfma_f32_32x32x16_bf16 v[72:87], v[112:115], v[172:175], v[72:87]
    s_add_u32 s42, s54, 163840
    s_add_u32 m0, s46, 5120
    s_nop 0
    buffer_load_dwordx4 v7, s[4:7], s42 offen lds
    v_mfma_f32_32x32x16_bf16 v[88:103], v[112:115], v[176:179], v[88:103]
    s_add_u32 s42, s54, 196608
    s_add_u32 m0, s46, 6144
    s_nop 0
    buffer_load_dwordx4 v6, s[4:7], s42 offen lds
    s_add_u32 s42, s54, 229376
    s_add_u32 m0, s46, 7168
    s_nop 0
    buffer_load_dwordx4 v7, s[4:7], s42 offen lds
    s_waitcnt vmcnt(17)
    s_waitcnt lgkmcnt(0)
    v_mfma_f32_32x32x16_bf16 v[8:23], v[116:119], v[164:167], v[8:23]
    ds_read_b128 v[172:175], v183 offset:8192
    ds_read_b128 v[176:179], v183 offset:12288
    v_mfma_f32_32x32x16_bf16 v[24:39], v[116:119], v[168:171], v[24:39]
    s_add_u32 s41, s52, 6144
    buffer_load_dwordx4 v[104:107], v5, s[8:11], s41 offen offset:0 sc1
    v_mfma_f32_32x32x16_bf16 v[40:55], v[120:123], v[164:167], v[40:55]
    s_add_u32 s41, s52, 6144
    buffer_load_dwordx4 v[108:111], v5, s[8:11], s41 offen offset:1024 sc1
    v_mfma_f32_32x32x16_bf16 v[56:71], v[120:123], v[168:171], v[56:71]
    s_add_u32 s41, s52, 6144
    buffer_load_dwordx4 v[112:115], v5, s[8:11], s41 offen offset:2048 sc1
    v_mfma_f32_32x32x16_bf16 v[72:87], v[124:127], v[164:167], v[72:87]
    v_mfma_f32_32x32x16_bf16 v[88:103], v[124:127], v[168:171], v[88:103]
    s_waitcnt vmcnt(17)
    s_waitcnt lgkmcnt(0)
    v_mfma_f32_32x32x16_bf16 v[8:23], v[128:131], v[172:175], v[8:23]
    s_waitcnt vmcnt(3)
    ds_read_b128 v[164:167], v180 offset:0
    ds_read_b128 v[168:171], v180 offset:4096
    v_mfma_f32_32x32x16_bf16 v[24:39], v[128:131], v[176:179], v[24:39]
    s_add_u32 s41, s52, 9216
    buffer_load_dwordx4 v[116:119], v5, s[8:11], s41 offen offset:0 sc1
    v_mfma_f32_32x32x16_bf16 v[40:55], v[132:135], v[172:175], v[40:55]
    s_add_u32 s41, s52, 9216
    buffer_load_dwordx4 v[120:123], v5, s[8:11], s41 offen offset:1024 sc1
    v_mfma_f32_32x32x16_bf16 v[56:71], v[132:135], v[176:179], v[56:71]
    s_add_u32 s41, s52, 9216
    buffer_load_dwordx4 v[124:127], v5, s[8:11], s41 offen offset:2048 sc1
    v_mfma_f32_32x32x16_bf16 v[72:87], v[136:139], v[172:175], v[72:87]
    s_add_u32 s55, s50, 3
    s_and_b32 s55, s55, 7
    s_lshl_b32 s55, s55, 7
    s_add_u32 s55, s55, s45
    s_add_u32 s42, s55, 0
    s_add_u32 m0, s46, 8192
    s_nop 0
    buffer_load_dwordx4 v6, s[4:7], s42 offen lds
    v_mfma_f32_32x32x16_bf16 v[88:103], v[136:139], v[176:179], v[88:103]
    s_add_u32 s42, s55, 32768
    s_add_u32 m0, s46, 9216
    s_nop 0
    buffer_load_dwordx4 v7, s[4:7], s42 offen lds
    s_waitcnt vmcnt(17)
    s_waitcnt lgkmcnt(0)
    v_mfma_f32_32x32x16_bf16 v[8:23], v[140:143], v[164:167], v[8:23]
    ds_read_b128 v[172:175], v181 offset:0
    ds_read_b128 v[176:179], v181 offset:4096
    v_mfma_f32_32x32x16_bf16 v[24:39], v[140:143], v[168:171], v[24:39]
    s_add_u32 s53, s50, 3
    s_and_b32 s53, s53, 7
    s_mul_i32 s53, s53, 12288
    s_add_u32 s53, s53, s44
    buffer_load_dwordx4 v[128:131], v5, s[8:11], s53 offen offset:0 sc1
    v_mfma_f32_32x32x16_bf16 v[40:55], v[144:147], v[164:167], v[40:55]
    buffer_load_dwordx4 v[132:135], v5, s[8:11], s53 offen offset:1024 sc1
    v_mfma_f32_32x32x16_bf16 v[56:71], v[144:147], v[168:171], v[56:71]
    buffer_load_dwordx4 v[136:139], v5, s[8:11], s53 offen offset:2048 sc1
    v_mfma_f32_32x32x16_bf16 v[72:87], v[148:151], v[164:167], v[72:87]
    s_add_u32 s42, s55, 65536
    s_add_u32 m0, s46, 10240
    s_nop 0
    buffer_load_dwordx4 v6, s[4:7], s42 offen lds
    v_mfma_f32_32x32x16_bf16 v[88:103], v[148:151], v[168:171], v[88:103]
    s_add_u32 s42, s55, 98304
    s_add_u32 m0, s46, 11264
    s_nop 0
    buffer_load_dwordx4 v7, s[4:7], s42 offen lds
    s_add_u32 s42, s55, 131072
    s_add_u32 m0, s46, 12288
    s_nop 0
    buffer_load_dwordx4 v6, s[4:7], s42 offen lds
    s_waitcnt vmcnt(17)
    s_waitcnt lgkmcnt(0)
    v_mfma_f32_32x32x16_bf16 v[8:23], v[152:155], v[172:175], v[8:23]
    ds_read_b128 v[164:167], v182 offset:0
    ds_read_b128 v[168:171], v182 offset:4096
    v_mfma_f32_32x32x16_bf16 v[24:39], v[152:155], v[176:179], v[24:39]
    s_add_u32 s41, s53, 3072
    buffer_load_dwordx4 v[140:143], v5, s[8:11], s41 offen offset:0 sc1
    v_mfma_f32_32x32x16_bf16 v[40:55], v[156:159], v[172:175], v[40:55]
    s_add_u32 s41, s53, 3072
    buffer_load_dwordx4 v[144:147], v5, s[8:11], s41 offen offset:1024 sc1
    v_mfma_f32_32x32x16_bf16 v[56:71], v[156:159], v[176:179], v[56:71]
    s_add_u32 s41, s53, 3072
    buffer_load_dwordx4 v[148:151], v5, s[8:11], s41 offen offset:2048 sc1
    v_mfma_f32_32x32x16_bf16 v[72:87], v[160:163], v[172:175], v[72:87]
    s_add_u32 s42, s55, 163840
    s_add_u32 m0, s46, 13312
    s_nop 0
    buffer_load_dwordx4 v7, s[4:7], s42 offen lds
    v_mfma_f32_32x32x16_bf16 v[88:103], v[160:163], v[176:179], v[88:103]
    s_add_u32 s42, s55, 196608
    s_add_u32 m0, s46, 14336
    s_nop 0
    buffer_load_dwordx4 v6, s[4:7], s42 offen lds
    s_add_u32 s42, s55, 229376
    s_add_u32 m0, s46, 15360
    s_nop 0
    buffer_load_dwordx4 v7, s[4:7], s42 offen lds
    s_waitcnt vmcnt(17)
    s_waitcnt lgkmcnt(0)
    v_mfma_f32_32x32x16_bf16 v[8:23], v[104:107], v[164:167], v[8:23]
    ds_read_b128 v[172:175], v183 offset:0
    ds_read_b128 v[176:179], v183 offset:4096
    v_mfma_f32_32x32x16_bf16 v[24:39], v[104:107], v[168:171], v[24:39]
    s_add_u32 s41, s53, 6144
    buffer_load_dwordx4 v[152:155], v5, s[8:11], s41 offen offset:0 sc1
    v_mfma_f32_32x32x16_bf16 v[40:55], v[108:111], v[164:167], v[40:55]
    s_add_u32 s41, s53, 6144
    buffer_load_dwordx4 v[156:159], v5, s[8:11], s41 offen offset:1024 sc1
    v_mfma_f32_32x32x16_bf16 v[56:71], v[108:111], v[168:171], v[56:71]
    s_add_u32 s41, s53, 6144
    buffer_load_dwordx4 v[160:163], v5, s[8:11], s41 offen offset:2048 sc1
    v_mfma_f32_32x32x16_bf16 v[72:87], v[112:115], v[164:167], v[72:87]
    v_mfma_f32_32x32x16_bf16 v[88:103], v[112:115], v[168:171], v[88:103]
    s_waitcnt vmcnt(17)
    s_waitcnt lgkmcnt(0)
    v_mfma_f32_32x32x16_bf16 v[8:23], v[116:119], v[172:175], v[8:23]
    s_waitcnt vmcnt(3)
    ds_read_b128 v[164:167], v180 offset:8192
    ds_read_b128 v[168:171], v180 offset:12288
    v_mfma_f32_32x32x16_bf16 v[24:39], v[116:119], v[176:179], v[24:39]
    s_add_u32 s41, s53, 9216
    buffer_load_dwordx4 v[104:107], v5, s[8:11], s41 offen offset:0 sc1
    v_mfma_f32_32x32x16_bf16 v[40:55], v[120:123], v[172:175], v[40:55]
    s_add_u32 s41, s53, 9216
    buffer_load_dwordx4 v[108:111], v5, s[8:11], s41 offen offset:1024 sc1
    v_mfma_f32_32x32x16_bf16 v[56:71], v[120:123], v[176:179], v[56:71]
    s_add_u32 s41, s53, 9216
    buffer_load_dwordx4 v[112:115], v5, s[8:11], s41 offen offset:2048 sc1
    v_mfma_f32_32x32x16_bf16 v[72:87], v[124:127], v[172:175], v[72:87]
    s_add_u32 s54, s50, 4
    s_and_b32 s54, s54, 7
    s_lshl_b32 s54, s54, 7
    s_add_u32 s54, s54, s45
    s_add_u32 s42, s54, 0
    s_add_u32 m0, s46, 0
    s_nop 0
    buffer_load_dwordx4 v6, s[4:7], s42 offen lds
    v_mfma_f32_32x32x16_bf16 v[88:103], v[124:127], v[176:179], v[88:103]
    s_add_u32 s42, s54, 32768
    s_add_u32 m0, s46, 1024
    s_nop 0
    buffer_load_dwordx4 v7, s[4:7], s42 offen lds
    s_waitcnt vmcnt(17)
    s_waitcnt lgkmcnt(0)
    v_mfma_f32_32x32x16_bf16 v[8:23], v[128:131], v[164:167], v[8:23]
    ds_read_b128 v[172:175], v181 offset:8192
    ds_read_b128 v[176:179], v181 offset:12288
    v_mfma_f32_32x32x16_bf16 v[24:39], v[128:131], v[168:171], v[24:39]
    s_add_u32 s52, s50, 4
    s_and_b32 s52, s52, 7
    s_mul_i32 s52, s52, 12288
    s_add_u32 s52, s52, s44
    buffer_load_dwordx4 v[116:119], v5, s[8:11], s52 offen offset:0 sc1
    v_mfma_f32_32x32x16_bf16 v[40:55], v[132:135], v[164:167], v[40:55]
    buffer_load_dwordx4 v[120:123], v5, s[8:11], s52 offen offset:1024 sc1
    v_mfma_f32_32x32x16_bf16 v[56:71], v[132:135], v[168:171], v[56:71]
    buffer_load_dwordx4 v[124:127], v5, s[8:11], s52 offen offset:2048 sc1
    v_mfma_f32_32x32x16_bf16 v[72:87], v[136:139], v[164:167], v[72:87]
    s_add_u32 s42, s54, 65536
    s_add_u32 m0, s46, 2048
    s_nop 0
    buffer_load_dwordx4 v6, s[4:7], s42 offen lds
    v_mfma_f32_32x32x16_bf16 v[88:103], v[136:139], v[168:171], v[88:103]
    s_add_u32 s42, s54, 98304
    s_add_u32 m0, s46, 3072
    s_nop 0
    buffer_load_dwordx4 v7, s[4:7], s42 offen lds
    s_add_u32 s42, s54, 131072
    s_add_u32 m0, s46, 4096
    s_nop 0
    buffer_load_dwordx4 v6, s[4:7], s42 offen lds
    s_waitcnt vmcnt(17)
    s_waitcnt lgkmcnt(0)
    v_mfma_f32_32x32x16_bf16 v[8:23], v[140:143], v[172:175], v[8:23]
    ds_read_b128 v[164:167], v182 offset:8192
    ds_read_b128 v[168:171], v182 offset:12288
    v_mfma_f32_32x32x16_bf16 v[24:39], v[140:143], v[176:179], v[24:39]
    s_add_u32 s41, s52, 3072
    buffer_load_dwordx4 v[128:131], v5, s[8:11], s41 offen offset:0 sc1
    v_mfma_f32_32x32x16_bf16 v[40:55], v[144:147], v[172:175], v[40:55]
    s_add_u32 s41, s52, 3072
    buffer_load_dwordx4 v[132:135], v5, s[8:11], s41 offen offset:1024 sc1
    v_mfma_f32_32x32x16_bf16 v[56:71], v[144:147], v[176:179], v[56:71]
    s_add_u32 s41, s52, 3072
    buffer_load_dwordx4 v[136:139], v5, s[8:11], s41 offen offset:2048 sc1
    v_mfma_f32_32x32x16_bf16 v[72:87], v[148:151], v[172:175], v[72:87]
    s_add_u32 s42, s54, 163840
    s_add_u32 m0, s46, 5120
    s_nop 0
    buffer_load_dwordx4 v7, s[4:7], s42 offen lds
    v_mfma_f32_32x32x16_bf16 v[88:103], v[148:151], v[176:179], v[88:103]
    s_add_u32 s42, s54, 196608
    s_add_u32 m0, s46, 6144
    s_nop 0
    buffer_load_dwordx4 v6, s[4:7], s42 offen lds
    s_add_u32 s42, s54, 229376
    s_add_u32 m0, s46, 7168
    s_nop 0
    buffer_load_dwordx4 v7, s[4:7], s42 offen lds
    s_waitcnt vmcnt(17)
    s_waitcnt lgkmcnt(0)
    v_mfma_f32_32x32x16_bf16 v[8:23], v[152:155], v[164:167], v[8:23]
    ds_read_b128 v[172:175], v183 offset:8192
    ds_read_b128 v[176:179], v183 offset:12288
    v_mfma_f32_32x32x16_bf16 v[24:39], v[152:155], v[168:171], v[24:39]
    s_add_u32 s41, s52, 6144
    buffer_load_dwordx4 v[140:143], v5, s[8:11], s41 offen offset:0 sc1
    v_mfma_f32_32x32x16_bf16 v[40:55], v[156:159], v[164:167], v[40:55]
    s_add_u32 s41, s52, 6144
    buffer_load_dwordx4 v[144:147], v5, s[8:11], s41 offen offset:1024 sc1
    v_mfma_f32_32x32x16_bf16 v[56:71], v[156:159], v[168:171], v[56:71]
    s_add_u32 s41, s52, 6144
    buffer_load_dwordx4 v[148:151], v5, s[8:11], s41 offen offset:2048 sc1
    v_mfma_f32_32x32x16_bf16 v[72:87], v[160:163], v[164:167], v[72:87]
    v_mfma_f32_32x32x16_bf16 v[88:103], v[160:163], v[168:171], v[88:103]
    s_waitcnt vmcnt(17)
    s_waitcnt lgkmcnt(0)
    v_mfma_f32_32x32x16_bf16 v[8:23], v[104:107], v[172:175], v[8:23]
    s_waitcnt vmcnt(3)
    ds_read_b128 v[164:167], v180 offset:0
    ds_read_b128 v[168:171], v180 offset:4096
    v_mfma_f32_32x32x16_bf16 v[24:39], v[104:107], v[176:179], v[24:39]
    s_add_u32 s41, s52, 9216
    buffer_load_dwordx4 v[152:155], v5, s[8:11], s41 offen offset:0 sc1
    v_mfma_f32_32x32x16_bf16 v[40:55], v[108:111], v[172:175], v[40:55]
    s_add_u32 s41, s52, 9216
    buffer_load_dwordx4 v[156:159], v5, s[8:11], s41 offen offset:1024 sc1
    v_mfma_f32_32x32x16_bf16 v[56:71], v[108:111], v[176:179], v[56:71]
    s_add_u32 s41, s52, 9216
    buffer_load_dwordx4 v[160:163], v5, s[8:11], s41 offen offset:2048 sc1
    v_mfma_f32_32x32x16_bf16 v[72:87], v[112:115], v[172:175], v[72:87]
    s_add_u32 s55, s50, 5
    s_and_b32 s55, s55, 7
    s_lshl_b32 s55, s55, 7
    s_add_u32 s55, s55, s45
    s_add_u32 s42, s55, 0
    s_add_u32 m0, s46, 8192
    s_nop 0
    buffer_load_dwordx4 v6, s[4:7], s42 offen lds
    v_mfma_f32_32x32x16_bf16 v[88:103], v[112:115], v[176:179], v[88:103]
    s_add_u32 s42, s55, 32768
    s_add_u32 m0, s46, 9216
    s_nop 0
    buffer_load_dwordx4 v7, s[4:7], s42 offen lds
    s_waitcnt vmcnt(17)
    s_waitcnt lgkmcnt(0)
    v_mfma_f32_32x32x16_bf16 v[8:23], v[116:119], v[164:167], v[8:23]
    ds_read_b128 v[172:175], v181 offset:0
    ds_read_b128 v[176:179], v181 offset:4096
    v_mfma_f32_32x32x16_bf16 v[24:39], v[116:119], v[168:171], v[24:39]
    s_add_u32 s53, s50, 5
    s_and_b32 s53, s53, 7
    s_mul_i32 s53, s53, 12288
    s_add_u32 s53, s53, s44
    buffer_load_dwordx4 v[104:107], v5, s[8:11], s53 offen offset:0 sc1
    v_mfma_f32_32x32x16_bf16 v[40:55], v[120:123], v[164:167], v[40:55]
    buffer_load_dwordx4 v[108:111], v5, s[8:11], s53 offen offset:1024 sc1
    v_mfma_f32_32x32x16_bf16 v[56:71], v[120:123], v[168:171], v[56:71]
    buffer_load_dwordx4 v[112:115], v5, s[8:11], s53 offen offset:2048 sc1
    v_mfma_f32_32x32x16_bf16 v[72:87], v[124:127], v[164:167], v[72:87]
    s_add_u32 s42, s55, 65536
    s_add_u32 m0, s46, 10240
    s_nop 0
    buffer_load_dwordx4 v6, s[4:7], s42 offen lds
    v_mfma_f32_32x32x16_bf16 v[88:103], v[124:127], v[168:171], v[88:103]
    s_add_u32 s42, s55, 98304
    s_add_u32 m0, s46, 11264
    s_nop 0
    buffer_load_dwordx4 v7, s[4:7], s42 offen lds
    s_add_u32 s42, s55, 131072
    s_add_u32 m0, s46, 12288
    s_nop 0
    buffer_load_dwordx4 v6, s[4:7], s42 offen lds
    s_waitcnt vmcnt(17)
    s_waitcnt lgkmcnt(0)
    v_mfma_f32_32x32x16_bf16 v[8:23], v[128:131], v[172:175], v[8:23]
    ds_read_b128 v[164:167], v182 offset:0
    ds_read_b128 v[168:171], v182 offset:4096
    v_mfma_f32_32x32x16_bf16 v[24:39], v[128:131], v[176:179], v[24:39]
    s_add_u32 s41, s53, 3072
    buffer_load_dwordx4 v[116:119], v5, s[8:11], s41 offen offset:0 sc1
    v_mfma_f32_32x32x16_bf16 v[40:55], v[132:135], v[172:175], v[40:55]
    s_add_u32 s41, s53, 3072
    buffer_load_dwordx4 v[120:123], v5, s[8:11], s41 offen offset:1024 sc1
    v_mfma_f32_32x32x16_bf16 v[56:71], v[132:135], v[176:179], v[56:71]
    s_add_u32 s41, s53, 3072
    buffer_load_dwordx4 v[124:127], v5, s[8:11], s41 offen offset:2048 sc1
    v_mfma_f32_32x32x16_bf16 v[72:87], v[136:139], v[172:175], v[72:87]
    s_add_u32 s42, s55, 163840
    s_add_u32 m0, s46, 13312
    s_nop 0
    buffer_load_dwordx4 v7, s[4:7], s42 offen lds
    v_mfma_f32_32x32x16_bf16 v[88:103], v[136:139], v[176:179], v[88:103]
    s_add_u32 s42, s55, 196608
    s_add_u32 m0, s46, 14336
    s_nop 0
    buffer_load_dwordx4 v6, s[4:7], s42 offen lds
    s_add_u32 s42, s55, 229376
    s_add_u32 m0, s46, 15360
    s_nop 0
    buffer_load_dwordx4 v7, s[4:7], s42 offen lds
    s_waitcnt vmcnt(17)
    s_waitcnt lgkmcnt(0)
    v_mfma_f32_32x32x16_bf16 v[8:23], v[140:143], v[164:167], v[8:23]
    ds_read_b128 v[172:175], v183 offset:0
    ds_read_b128 v[176:179], v183 offset:4096
    v_mfma_f32_32x32x16_bf16 v[24:39], v[140:143], v[168:171], v[24:39]
    s_add_u32 s41, s53, 6144
    buffer_load_dwordx4 v[128:131], v5, s[8:11], s41 offen offset:0 sc1
    v_mfma_f32_32x32x16_bf16 v[40:55], v[144:147], v[164:167], v[40:55]
    s_add_u32 s41, s53, 6144
    buffer_load_dwordx4 v[132:135], v5, s[8:11], s41 offen offset:1024 sc1
    v_mfma_f32_32x32x16_bf16 v[56:71], v[144:147], v[168:171], v[56:71]
    s_add_u32 s41, s53, 6144
    buffer_load_dwordx4 v[136:139], v5, s[8:11], s41 offen offset:2048 sc1
    v_mfma_f32_32x32x16_bf16 v[72:87], v[148:151], v[164:167], v[72:87]
    v_mfma_f32_32x32x16_bf16 v[88:103], v[148:151], v[168:171], v[88:103]
    s_waitcnt vmcnt(17)
    s_waitcnt lgkmcnt(0)
    v_mfma_f32_32x32x16_bf16 v[8:23], v[152:155], v[172:175], v[8:23]
    s_waitcnt vmcnt(3)
    ds_read_b128 v[164:167], v180 offset:8192
    ds_read_b128 v[168:171], v180 offset:12288
    v_mfma_f32_32x32x16_bf16 v[24:39], v[152:155], v[176:179], v[24:39]
    s_add_u32 s41, s53, 9216
    buffer_load_dwordx4 v[140:143], v5, s[8:11], s41 offen offset:0 sc1
    v_mfma_f32_32x32x16_bf16 v[40:55], v[156:159], v[172:175], v[40:55]
    s_add_u32 s41, s53, 9216
    buffer_load_dwordx4 v[144:147], v5, s[8:11], s41 offen offset:1024 sc1
    v_mfma_f32_32x32x16_bf16 v[56:71], v[156:159], v[176:179], v[56:71]
    s_add_u32 s41, s53, 9216
    buffer_load_dwordx4 v[148:151], v5, s[8:11], s41 offen offset:2048 sc1
    v_mfma_f32_32x32x16_bf16 v[72:87], v[160:163], v[172:175], v[72:87]
    s_add_u32 s54, s50, 6
    s_and_b32 s54, s54, 7
    s_lshl_b32 s54, s54, 7
    s_add_u32 s54, s54, s45
    s_add_u32 s42, s54, 0
    s_add_u32 m0, s46, 0
    s_nop 0
    buffer_load_dwordx4 v6, s[4:7], s42 offen lds
    v_mfma_f32_32x32x16_bf16 v[88:103], v[160:163], v[176:179], v[88:103]
    s_add_u32 s42, s54, 32768
    s_add_u32 m0, s46, 1024
    s_nop 0
    buffer_load_dwordx4 v7, s[4:7], s42 offen lds
    s_waitcnt vmcnt(17)
    s_waitcnt lgkmcnt(0)
    v_mfma_f32_32x32x16_bf16 v[8:23], v[104:107], v[164:167], v[8:23]
    ds_read_b128 v[172:175], v181 offset:8192
    ds_read_b128 v[176:179], v181 offset:12288
    v_mfma_f32_32x32x16_bf16 v[24:39], v[104:107], v[168:171], v[24:39]
    s_add_u32 s52, s50, 6
    s_and_b32 s52, s52, 7
    s_mul_i32 s52, s52, 12288
    s_add_u32 s52, s52, s44
    buffer_load_dwordx4 v[152:155], v5, s[8:11], s52 offen offset:0 sc1
    v_mfma_f32_32x32x16_bf16 v[40:55], v[108:111], v[164:167], v[40:55]
    buffer_load_dwordx4 v[156:159], v5, s[8:11], s52 offen offset:1024 sc1
    v_mfma_f32_32x32x16_bf16 v[56:71], v[108:111], v[168:171], v[56:71]
    buffer_load_dwordx4 v[160:163], v5, s[8:11], s52 offen offset:2048 sc1
    v_mfma_f32_32x32x16_bf16 v[72:87], v[112:115], v[164:167], v[72:87]
    s_add_u32 s42, s54, 65536
    s_add_u32 m0, s46, 2048
    s_nop 0
    buffer_load_dwordx4 v6, s[4:7], s42 offen lds
    v_mfma_f32_32x32x16_bf16 v[88:103], v[112:115], v[168:171], v[88:103]
    s_add_u32 s42, s54, 98304
    s_add_u32 m0, s46, 3072
    s_nop 0
    buffer_load_dwordx4 v7, s[4:7], s42 offen lds
    s_add_u32 s42, s54, 131072
    s_add_u32 m0, s46, 4096
    s_nop 0
    buffer_load_dwordx4 v6, s[4:7], s42 offen lds
    s_waitcnt vmcnt(17)
    s_waitcnt lgkmcnt(0)
    v_mfma_f32_32x32x16_bf16 v[8:23], v[116:119], v[172:175], v[8:23]
    ds_read_b128 v[164:167], v182 offset:8192
    ds_read_b128 v[168:171], v182 offset:12288
    v_mfma_f32_32x32x16_bf16 v[24:39], v[116:119], v[176:179], v[24:39]
    s_add_u32 s41, s52, 3072
    buffer_load_dwordx4 v[104:107], v5, s[8:11], s41 offen offset:0 sc1
    v_mfma_f32_32x32x16_bf16 v[40:55], v[120:123], v[172:175], v[40:55]
    s_add_u32 s41, s52, 3072
    buffer_load_dwordx4 v[108:111], v5, s[8:11], s41 offen offset:1024 sc1
    v_mfma_f32_32x32x16_bf16 v[56:71], v[120:123], v[176:179], v[56:71]
    s_add_u32 s41, s52, 3072
    buffer_load_dwordx4 v[112:115], v5, s[8:11], s41 offen offset:2048 sc1
    v_mfma_f32_32x32x16_bf16 v[72:87], v[124:127], v[172:175], v[72:87]
    s_add_u32 s42, s54, 163840
    s_add_u32 m0, s46, 5120
    s_nop 0
    buffer_load_dwordx4 v7, s[4:7], s42 offen lds
    v_mfma_f32_32x32x16_bf16 v[88:103], v[124:127], v[176:179], v[88:103]
    s_add_u32 s42, s54, 196608
    s_add_u32 m0, s46, 6144
    s_nop 0
    buffer_load_dwordx4 v6, s[4:7], s42 offen lds
    s_add_u32 s42, s54, 229376
    s_add_u32 m0, s46, 7168
    s_nop 0
    buffer_load_dwordx4 v7, s[4:7], s42 offen lds
    s_waitcnt vmcnt(17)
    s_waitcnt lgkmcnt(0)
    v_mfma_f32_32x32x16_bf16 v[8:23], v[128:131], v[164:167], v[8:23]
    ds_read_b128 v[172:175], v183 offset:8192
    ds_read_b128 v[176:179], v183 offset:12288
    v_mfma_f32_32x32x16_bf16 v[24:39], v[128:131], v[168:171], v[24:39]
    s_add_u32 s41, s52, 6144
    buffer_load_dwordx4 v[116:119], v5, s[8:11], s41 offen offset:0 sc1
    v_mfma_f32_32x32x16_bf16 v[40:55], v[132:135], v[164:167], v[40:55]
    s_add_u32 s41, s52, 6144
    buffer_load_dwordx4 v[120:123], v5, s[8:11], s41 offen offset:1024 sc1
    v_mfma_f32_32x32x16_bf16 v[56:71], v[132:135], v[168:171], v[56:71]
    s_add_u32 s41, s52, 6144
    buffer_load_dwordx4 v[124:127], v5, s[8:11], s41 offen offset:2048 sc1
    v_mfma_f32_32x32x16_bf16 v[72:87], v[136:139], v[164:167], v[72:87]
    v_mfma_f32_32x32x16_bf16 v[88:103], v[136:139], v[168:171], v[88:103]
    s_waitcnt vmcnt(17)
    s_waitcnt lgkmcnt(0)
    v_mfma_f32_32x32x16_bf16 v[8:23], v[140:143], v[172:175], v[8:23]
    s_waitcnt vmcnt(3)
    ds_read_b128 v[164:167], v180 offset:0
    ds_read_b128 v[168:171], v180 offset:4096
    v_mfma_f32_32x32x16_bf16 v[24:39], v[140:143], v[176:179], v[24:39]
    s_add_u32 s41, s52, 9216
    buffer_load_dwordx4 v[128:131], v5, s[8:11], s41 offen offset:0 sc1
    v_mfma_f32_32x32x16_bf16 v[40:55], v[144:147], v[172:175], v[40:55]
    s_add_u32 s41, s52, 9216
    buffer_load_dwordx4 v[132:135], v5, s[8:11], s41 offen offset:1024 sc1
    v_mfma_f32_32x32x16_bf16 v[56:71], v[144:147], v[176:179], v[56:71]
    s_add_u32 s41, s52, 9216
    buffer_load_dwordx4 v[136:139], v5, s[8:11], s41 offen offset:2048 sc1
    v_mfma_f32_32x32x16_bf16 v[72:87], v[148:151], v[172:175], v[72:87]
    s_add_u32 s55, s50, 7
    s_and_b32 s55, s55, 7
    s_lshl_b32 s55, s55, 7
    s_add_u32 s55, s55, s45
    s_add_u32 s42, s55, 0
    s_add_u32 m0, s46, 8192
    s_nop 0
    buffer_load_dwordx4 v6, s[4:7], s42 offen lds
    v_mfma_f32_32x32x16_bf16 v[88:103], v[148:151], v[176:179], v[88:103]
    s_add_u32 s42, s55, 32768
    s_add_u32 m0, s46, 9216
    s_nop 0
    buffer_load_dwordx4 v7, s[4:7], s42 offen lds
    s_waitcnt vmcnt(17)
    s_waitcnt lgkmcnt(0)
    v_mfma_f32_32x32x16_bf16 v[8:23], v[152:155], v[164:167], v[8:23]
    ds_read_b128 v[172:175], v181 offset:0
    ds_read_b128 v[176:179], v181 offset:4096
    v_mfma_f32_32x32x16_bf16 v[24:39], v[152:155], v[168:171], v[24:39]
    s_add_u32 s53, s50, 7
    s_and_b32 s53, s53, 7
    s_mul_i32 s53, s53, 12288
    s_add_u32 s53, s53, s44
    buffer_load_dwordx4 v[140:143], v5, s[8:11], s53 offen offset:0 sc1
    v_mfma_f32_32x32x16_bf16 v[40:55], v[156:159], v[164:167], v[40:55]
    buffer_load_dwordx4 v[144:147], v5, s[8:11], s53 offen offset:1024 sc1
    v_mfma_f32_32x32x16_bf16 v[56:71], v[156:159], v[168:171], v[56:71]
    buffer_load_dwordx4 v[148:151], v5, s[8:11], s53 offen offset:2048 sc1
    v_mfma_f32_32x32x16_bf16 v[72:87], v[160:163], v[164:167], v[72:87]
    s_add_u32 s42, s55, 65536
    s_add_u32 m0, s46, 10240
    s_nop 0
    buffer_load_dwordx4 v6, s[4:7], s42 offen lds
    v_mfma_f32_32x32x16_bf16 v[88:103], v[160:163], v[168:171], v[88:103]
    s_add_u32 s42, s55, 98304
    s_add_u32 m0, s46, 11264
    s_nop 0
    buffer_load_dwordx4 v7, s[4:7], s42 offen lds
    s_add_u32 s42, s55, 131072
    s_add_u32 m0, s46, 12288
    s_nop 0
    buffer_load_dwordx4 v6, s[4:7], s42 offen lds
    s_waitcnt vmcnt(17)
    s_waitcnt lgkmcnt(0)
    v_mfma_f32_32x32x16_bf16 v[8:23], v[104:107], v[172:175], v[8:23]
    ds_read_b128 v[164:167], v182 offset:0
    ds_read_b128 v[168:171], v182 offset:4096
    v_mfma_f32_32x32x16_bf16 v[24:39], v[104:107], v[176:179], v[24:39]
    s_add_u32 s41, s53, 3072
    buffer_load_dwordx4 v[152:155], v5, s[8:11], s41 offen offset:0 sc1
    v_mfma_f32_32x32x16_bf16 v[40:55], v[108:111], v[172:175], v[40:55]
    s_add_u32 s41, s53, 3072
    buffer_load_dwordx4 v[156:159], v5, s[8:11], s41 offen offset:1024 sc1
    v_mfma_f32_32x32x16_bf16 v[56:71], v[108:111], v[176:179], v[56:71]
    s_add_u32 s41, s53, 3072
    buffer_load_dwordx4 v[160:163], v5, s[8:11], s41 offen offset:2048 sc1
    v_mfma_f32_32x32x16_bf16 v[72:87], v[112:115], v[172:175], v[72:87]
    s_add_u32 s42, s55, 163840
    s_add_u32 m0, s46, 13312
    s_nop 0
    buffer_load_dwordx4 v7, s[4:7], s42 offen lds
    v_mfma_f32_32x32x16_bf16 v[88:103], v[112:115], v[176:179], v[88:103]
    s_add_u32 s42, s55, 196608
    s_add_u32 m0, s46, 14336
    s_nop 0
    buffer_load_dwordx4 v6, s[4:7], s42 offen lds
    s_add_u32 s42, s55, 229376
    s_add_u32 m0, s46, 15360
    s_nop 0
    buffer_load_dwordx4 v7, s[4:7], s42 offen lds
    s_waitcnt vmcnt(17)
    s_waitcnt lgkmcnt(0)
    v_mfma_f32_32x32x16_bf16 v[8:23], v[116:119], v[164:167], v[8:23]
    ds_read_b128 v[172:175], v183 offset:0
    ds_read_b128 v[176:179], v183 offset:4096
    v_mfma_f32_32x32x16_bf16 v[24:39], v[116:119], v[168:171], v[24:39]
    s_add_u32 s41, s53, 6144
    buffer_load_dwordx4 v[104:107], v5, s[8:11], s41 offen offset:0 sc1
    v_mfma_f32_32x32x16_bf16 v[40:55], v[120:123], v[164:167], v[40:55]
    s_add_u32 s41, s53, 6144
    buffer_load_dwordx4 v[108:111], v5, s[8:11], s41 offen offset:1024 sc1
    v_mfma_f32_32x32x16_bf16 v[56:71], v[120:123], v[168:171], v[56:71]
    s_add_u32 s41, s53, 6144
    buffer_load_dwordx4 v[112:115], v5, s[8:11], s41 offen offset:2048 sc1
    v_mfma_f32_32x32x16_bf16 v[72:87], v[124:127], v[164:167], v[72:87]
    v_mfma_f32_32x32x16_bf16 v[88:103], v[124:127], v[168:171], v[88:103]
    s_waitcnt vmcnt(17)
    s_waitcnt lgkmcnt(0)
    v_mfma_f32_32x32x16_bf16 v[8:23], v[128:131], v[172:175], v[8:23]
    s_waitcnt vmcnt(3)
    ds_read_b128 v[164:167], v180 offset:8192
    ds_read_b128 v[168:171], v180 offset:12288
    v_mfma_f32_32x32x16_bf16 v[24:39], v[128:131], v[176:179], v[24:39]
    s_add_u32 s41, s53, 9216
    buffer_load_dwordx4 v[116:119], v5, s[8:11], s41 offen offset:0 sc1
    v_mfma_f32_32x32x16_bf16 v[40:55], v[132:135], v[172:175], v[40:55]
    s_add_u32 s41, s53, 9216
    buffer_load_dwordx4 v[120:123], v5, s[8:11], s41 offen offset:1024 sc1
    v_mfma_f32_32x32x16_bf16 v[56:71], v[132:135], v[176:179], v[56:71]
    s_add_u32 s41, s53, 9216
    buffer_load_dwordx4 v[124:127], v5, s[8:11], s41 offen offset:2048 sc1
    v_mfma_f32_32x32x16_bf16 v[72:87], v[136:139], v[172:175], v[72:87]
    v_mfma_f32_32x32x16_bf16 v[88:103], v[136:139], v[176:179], v[88:103]
    s_waitcnt vmcnt(15)
    s_waitcnt lgkmcnt(0)
    v_mfma_f32_32x32x16_bf16 v[8:23], v[140:143], v[164:167], v[8:23]
    ds_read_b128 v[172:175], v181 offset:8192
    ds_read_b128 v[176:179], v181 offset:12288
    v_mfma_f32_32x32x16_bf16 v[24:39], v[140:143], v[168:171], v[24:39]
    v_mfma_f32_32x32x16_bf16 v[40:55], v[144:147], v[164:167], v[40:55]
    v_mfma_f32_32x32x16_bf16 v[56:71], v[144:147], v[168:171], v[56:71]
    v_mfma_f32_32x32x16_bf16 v[72:87], v[148:151], v[164:167], v[72:87]
    v_mfma_f32_32x32x16_bf16 v[88:103], v[148:151], v[168:171], v[88:103]
    s_waitcnt vmcnt(9)
    s_waitcnt lgkmcnt(0)
    v_mfma_f32_32x32x16_bf16 v[8:23], v[152:155], v[172:175], v[8:23]
    ds_read_b128 v[164:167], v182 offset:8192
    ds_read_b128 v[168:171], v182 offset:12288
    v_mfma_f32_32x32x16_bf16 v[24:39], v[152:155], v[176:179], v[24:39]
    v_mfma_f32_32x32x16_bf16 v[40:55], v[156:159], v[172:175], v[40:55]
    v_mfma_f32_32x32x16_bf16 v[56:71], v[156:159], v[176:179], v[56:71]
    v_mfma_f32_32x32x16_bf16 v[72:87], v[160:163], v[172:175], v[72:87]
    v_mfma_f32_32x32x16_bf16 v[88:103], v[160:163], v[176:179], v[88:103]
    s_waitcnt vmcnt(3)
    s_waitcnt lgkmcnt(0)
    v_mfma_f32_32x32x16_bf16 v[8:23], v[104:107], v[164:167], v[8:23]
    ds_read_b128 v[172:175], v183 offset:8192
    ds_read_b128 v[176:179], v183 offset:12288
    v_mfma_f32_32x32x16_bf16 v[24:39], v[104:107], v[168:171], v[24:39]
    s_lshl_b32 s40, s32, 3
    s_add_u32 s40, s40, s33
    s_lshl_b32 s40, s40, 2
    s_add_u32 s40, s40, s34
    s_mul_i32 s40, s40, 3072
    s_add_u32 s40, s40, 3145728
    s_mul_i32 s40, s34, 3072
    s_add_u32 s40, s40, 73728
    v_add_u32 v3, s40, v5
    ds_read_b128 v[184:187], v3 offset:0
    v_mfma_f32_32x32x16_bf16 v[40:55], v[108:111], v[164:167], v[40:55]
    ds_read_b128 v[188:191], v3 offset:1024
    v_mfma_f32_32x32x16_bf16 v[56:71], v[108:111], v[168:171], v[56:71]
    ds_read_b128 v[192:195], v3 offset:2048
    v_mfma_f32_32x32x16_bf16 v[72:87], v[112:115], v[164:167], v[72:87]
    v_and_b32 v2, 31, v1
    v_lshlrev_b32 v2, 1, v2
    s_lshr_b32 s40, s34, 1
    s_lshl_b32 s40, s40, 6
    s_lshl_b32 s43, s32, 7
    s_add_u32 s40, s40, s43
    buffer_load_ushort v196, v2, s[12:15], s40 offen
    v_mfma_f32_32x32x16_bf16 v[88:103], v[112:115], v[168:171], v[88:103]
    s_waitcnt vmcnt(1)
    s_waitcnt lgkmcnt(3)
    v_mfma_f32_32x32x16_bf16 v[8:23], v[116:119], v[172:175], v[8:23]
    v_mfma_f32_32x32x16_bf16 v[24:39], v[116:119], v[176:179], v[24:39]
    v_mfma_f32_32x32x16_bf16 v[40:55], v[120:123], v[172:175], v[40:55]
    v_mfma_f32_32x32x16_bf16 v[56:71], v[120:123], v[176:179], v[56:71]
    v_mfma_f32_32x32x16_bf16 v[72:87], v[124:127], v[172:175], v[72:87]
    v_mfma_f32_32x32x16_bf16 v[88:103], v[124:127], v[176:179], v[88:103]
    s_setprio 0
    v_add_u32 v4, 0x10000, v5
    s_nop 15
    s_waitcnt lgkmcnt(0)
    v_mov_b32 v2, 161792
    v_mov_b32 v3, 1
    s_mov_b64 exec, 1
    ds_add_u32 v2, v3
    s_mov_b64 exec, -1
    s_mov_b32 s67, 0
gsync_18:
    ds_read_b32 v3, v2
    s_add_u32 s67, s67, 1
    s_waitcnt lgkmcnt(0)
    v_readfirstlane_b32 s66, v3
    s_cmp_gt_u32 s67, 1000000
    s_cbranch_scc1 gsync_e_19
    s_cmp_lt_u32 s66, 4
    s_cbranch_scc1 gsync_18
gsync_e_19:
    s_cmp_lg_u32 s34, 0
    s_cbranch_scc1 g_epi_14
    ds_write_b128 v5, v[12:15] offset:30720
    ds_write_b128 v5, v[20:23] offset:31744
    ds_write_b128 v5, v[44:47] offset:32768
    ds_write_b128 v5, v[52:55] offset:33792
    ds_write_b128 v5, v[76:79] offset:34816
    ds_write_b128 v5, v[84:87] offset:35840
    ds_write_b128 v5, v[24:27] offset:43008
    ds_write_b128 v5, v[32:35] offset:44032
    ds_write_b128 v5, v[56:59] offset:45056
    ds_write_b128 v5, v[64:67] offset:46080
    ds_write_b128 v5, v[88:91] offset:47104
    ds_write_b128 v5, v[96:99] offset:48128
    ds_write_b128 v5, v[28:31] offset:55296
    ds_write_b128 v5, v[36:39] offset:56320
    ds_write_b128 v5, v[60:63] offset:57344
    ds_write_b128 v5, v[68:71] offset:58368
    ds_write_b128 v5, v[92:95] offset:59392
    ds_write_b128 v5, v[100:103] offset:60416
    v_pk_add_f32 v[104:105], v[8:9], 0
    v_pk_add_f32 v[106:107], v[10:11], 0
    v_pk_add_f32 v[108:109], v[16:17], 0
    v_pk_add_f32 v[110:111], v[18:19], 0
    v_pk_add_f32 v[112:113], v[40:41], 0
    v_pk_add_f32 v[114:115], v[42:43], 0
    v_pk_add_f32 v[116:117], v[48:49], 0
    v_pk_add_f32 v[118:119], v[50:51], 0
    v_pk_add_f32 v[120:121], v[72:73], 0
    v_pk_add_f32 v[122:123], v[74:75], 0
    v_pk_add_f32 v[124:125], v[80:81], 0
    v_pk_add_f32 v[126:127], v[82:83], 0
    s_branch g_epi_end_13
g_epi_14:
    s_cmp_lg_u32 s34, 1
    s_cbranch_scc1 g_epi_15
    ds_write_b128 v5, v[8:11] offset:0
    ds_write_b128 v5, v[16:19] offset:1024
    ds_write_b128 v5, v[40:43] offset:2048
    ds_write_b128 v5, v[48:51] offset:3072
    ds_write_b128 v5, v[72:75] offset:4096
    ds_write_b128 v5, v[80:83] offset:5120
    ds_write_b128 v5, v[24:27] offset:49152
    ds_write_b128 v5, v[32:35] offset:50176
    ds_write_b128 v5, v[56:59] offset:51200
    ds_write_b128 v5, v[64:67] offset:52224
    ds_write_b128 v5, v[88:91] offset:53248
    ds_write_b128 v5, v[96:99] offset:54272
    ds_write_b128 v5, v[28:31] offset:61440
    ds_write_b128 v5, v[36:39] offset:62464
    ds_write_b128 v5, v[60:63] offset:63488
    ds_write_b128 v5, v[68:71] offset:64512
    ds_write_b128 v4, v[92:95] offset:0
    ds_write_b128 v4, v[100:103] offset:1024
    v_pk_add_f32 v[104:105], v[12:13], 0
    v_pk_add_f32 v[106:107], v[14:15], 0
    v_pk_add_f32 v[108:109], v[20:21], 0
    v_pk_add_f32 v[110:111], v[22:23], 0
    v_pk_add_f32 v[112:113], v[44:45], 0
    v_pk_add_f32 v[114:115], v[46:47], 0
    v_pk_add_f32 v[116:117], v[52:53], 0
    v_pk_add_f32 v[118:119], v[54:55], 0
    v_pk_add_f32 v[120:121], v[76:77], 0
    v_pk_add_f32 v[122:123], v[78:79], 0
    v_pk_add_f32 v[124:125], v[84:85], 0
    v_pk_add_f32 v[126:127], v[86:87], 0
    s_branch g_epi_end_13
g_epi_15:
    s_cmp_lg_u32 s34, 2
    s_cbranch_scc1 g_epi_16
    ds_write_b128 v5, v[8:11] offset:6144
    ds_write_b128 v5, v[16:19] offset:7168
    ds_write_b128 v5, v[40:43] offset:8192
    ds_write_b128 v5, v[48:51] offset:9216
    ds_write_b128 v5, v[72:75] offset:10240
    ds_write_b128 v5, v[80:83] offset:11264
    ds_write_b128 v5, v[12:15] offset:18432
    ds_write_b128 v5, v[20:23] offset:19456
    ds_write_b128 v5, v[44:47] offset:20480
    ds_write_b128 v5, v[52:55] offset:21504
    ds_write_b128 v5, v[76:79] offset:22528
    ds_write_b128 v5, v[84:87] offset:23552
    ds_write_b128 v4, v[28:31] offset:2048
    ds_write_b128 v4, v[36:39] offset:3072
    ds_write_b128 v4, v[60:63] offset:4096
    ds_write_b128 v4, v[68:71] offset:5120
    ds_write_b128 v4, v[92:95] offset:6144
    ds_write_b128 v4, v[100:103] offset:7168
    v_pk_add_f32 v[104:105], v[24:25], 0
    v_pk_add_f32 v[106:107], v[26:27], 0
    v_pk_add_f32 v[108:109], v[32:33], 0
    v_pk_add_f32 v[110:111], v[34:35], 0
    v_pk_add_f32 v[112:113], v[56:57], 0
    v_pk_add_f32 v[114:115], v[58:59], 0
    v_pk_add_f32 v[116:117], v[64:65], 0
    v_pk_add_f32 v[118:119], v[66:67], 0
    v_pk_add_f32 v[120:121], v[88:89], 0
    v_pk_add_f32 v[122:123], v[90:91], 0
    v_pk_add_f32 v[124:125], v[96:97], 0
    v_pk_add_f32 v[126:127], v[98:99], 0
    s_branch g_epi_end_13
g_epi_16:
    ds_write_b128 v5, v[8:11] offset:12288
    ds_write_b128 v5, v[16:19] offset:13312
    ds_write_b128 v5, v[40:43] offset:14336
    ds_write_b128 v5, v[48:51] offset:15360
    ds_write_b128 v5, v[72:75] offset:16384
    ds_write_b128 v5, v[80:83] offset:17408
    ds_write_b128 v5, v[12:15] offset:24576
    ds_write_b128 v5, v[20:23] offset:25600
    ds_write_b128 v5, v[44:47] offset:26624
    ds_write_b128 v5, v[52:55] offset:27648
    ds_write_b128 v5, v[76:79] offset:28672
    ds_write_b128 v5, v[84:87] offset:29696
    ds_write_b128 v5, v[24:27] offset:36864
    ds_write_b128 v5, v[32:35] offset:37888
    ds_write_b128 v5, v[56:59] offset:38912
    ds_write_b128 v5, v[64:67] offset:39936
    ds_write_b128 v5, v[88:91] offset:40960
    ds_write_b128 v5, v[96:99] offset:41984
    v_pk_add_f32 v[104:105], v[28:29], 0
    v_pk_add_f32 v[106:107], v[30:31], 0
    v_pk_add_f32 v[108:109], v[36:37], 0
    v_pk_add_f32 v[110:111], v[38:39], 0
    v_pk_add_f32 v[112:113], v[60:61], 0
    v_pk_add_f32 v[114:115], v[62:63], 0
    v_pk_add_f32 v[116:117], v[68:69], 0
    v_pk_add_f32 v[118:119], v[70:71], 0
    v_pk_add_f32 v[120:121], v[92:93], 0
    v_pk_add_f32 v[122:123], v[94:95], 0
    v_pk_add_f32 v[124:125], v[100:101], 0
    v_pk_add_f32 v[126:127], v[102:103], 0
g_epi_end_13:
    s_waitcnt lgkmcnt(0)
    s_waitcnt lgkmcnt(0)
    v_mov_b32 v2, 161792
    v_mov_b32 v3, 1
    s_mov_b64 exec, 1
    ds_add_u32 v2, v3
    s_mov_b64 exec, -1
    s_mov_b32 s67, 0
gsync_20:
    ds_read_b32 v3, v2
    s_add_u32 s67, s67, 1
    s_waitcnt lgkmcnt(0)
    v_readfirstlane_b32 s66, v3
    s_cmp_gt_u32 s67, 1000000
    s_cbranch_scc1 gsync_e_21
    s_cmp_lt_u32 s66, 8
    s_cbranch_scc1 gsync_20
gsync_e_21:
    s_mul_i32 s40, s34, 18432
    v_add_u32 v2, s40, v5
    ds_read_b128 v[8:11], v2 offset:0
    ds_read_b128 v[12:15], v2 offset:1024
    ds_read_b128 v[16:19], v2 offset:2048
    ds_read_b128 v[20:23], v2 offset:3072
    ds_read_b128 v[24:27], v2 offset:4096
    ds_read_b128 v[28:31], v2 offset:5120
    ds_read_b128 v[32:35], v2 offset:6144
    ds_read_b128 v[36:39], v2 offset:7168
    ds_read_b128 v[40:43], v2 offset:8192
    ds_read_b128 v[44:47], v2 offset:9216
    ds_read_b128 v[48:51], v2 offset:10240
    ds_read_b128 v[52:55], v2 offset:11264
    ds_read_b128 v[56:59], v2 offset:12288
    ds_read_b128 v[60:63], v2 offset:13312
    ds_read_b128 v[64:67], v2 offset:14336
    ds_read_b128 v[68:71], v2 offset:15360
    ds_read_b128 v[72:75], v2 offset:16384
    ds_read_b128 v[76:79], v2 offset:17408
    v_lshrrev_b32 v6, 4, v1
    v_and_b32 v6, 1, v6
    v_mul_u32_u24 v6, 24576, v6
    v_and_b32 v3, 15, v1
    v_lshrrev_b32 v4, 5, v1
    v_lshl_add_u32 v3, v4, 4, v3
    v_lshl_add_u32 v6, v3, 4, v6
    s_mul_i32 s40, s32, 98304
    s_lshr_b32 s41, s34, 1
    s_mul_i32 s41, s41, 49152
    s_add_u32 s40, s40, s41
    s_mul_i32 s41, s33, 3072
    s_add_u32 s40, s40, s41
    s_and_b32 s41, s34, 1
    s_lshl_b32 s41, s41, 9
    s_add_u32 s40, s40, s41
    s_add_u32 s40, s40, 11534336
    s_waitcnt vmcnt(0)
    v_lshlrev_b32 v180, 16, v196
    v_lshlrev_b32 v80, 16, v184
    v_and_b32 v81, 0xffff0000, v184
    v_lshlrev_b32 v82, 16, v185
    v_and_b32 v83, 0xffff0000, v185
    v_lshlrev_b32 v84, 16, v186
    v_and_b32 v85, 0xffff0000, v186
    v_lshlrev_b32 v86, 16, v187
    v_and_b32 v87, 0xffff0000, v187
    v_lshlrev_b32 v88, 16, v188
    v_and_b32 v89, 0xffff0000, v188
    v_lshlrev_b32 v90, 16, v189
    v_and_b32 v91, 0xffff0000, v189
    v_lshlrev_b32 v92, 16, v190
    v_and_b32 v93, 0xffff0000, v190
    v_lshlrev_b32 v94, 16, v191
    v_and_b32 v95, 0xffff0000, v191
    v_lshlrev_b32 v96, 16, v192
    v_and_b32 v97, 0xffff0000, v192
    v_lshlrev_b32 v98, 16, v193
    v_and_b32 v99, 0xffff0000, v193
    v_lshlrev_b32 v100, 16, v194
    v_and_b32 v101, 0xffff0000, v194
    v_lshlrev_b32 v102, 16, v195
    v_and_b32 v103, 0xffff0000, v195
    s_waitcnt lgkmcnt(12)
    v_pk_add_f32 v[104:105], v[104:105], v[8:9]
    v_pk_add_f32 v[106:107], v[106:107], v[10:11]
    v_pk_add_f32 v[108:109], v[108:109], v[12:13]
    v_pk_add_f32 v[110:111], v[110:111], v[14:15]
    v_pk_add_f32 v[112:113], v[112:113], v[16:17]
    v_pk_add_f32 v[114:115], v[114:115], v[18:19]
    v_pk_add_f32 v[116:117], v[116:117], v[20:21]
    v_pk_add_f32 v[118:119], v[118:119], v[22:23]
    v_pk_add_f32 v[120:121], v[120:121], v[24:25]
    v_pk_add_f32 v[122:123], v[122:123], v[26:27]
    v_pk_add_f32 v[124:125], v[124:125], v[28:29]
    v_pk_add_f32 v[126:127], v[126:127], v[30:31]
    s_waitcnt lgkmcnt(6)
    v_pk_add_f32 v[104:105], v[104:105], v[32:33]
    v_pk_add_f32 v[106:107], v[106:107], v[34:35]
    v_pk_add_f32 v[108:109], v[108:109], v[36:37]
    v_pk_add_f32 v[110:111], v[110:111], v[38:39]
    v_pk_add_f32 v[112:113], v[112:113], v[40:41]
    v_pk_add_f32 v[114:115], v[114:115], v[42:43]
    v_pk_add_f32 v[116:117], v[116:117], v[44:45]
    v_pk_add_f32 v[118:119], v[118:119], v[46:47]
    v_pk_add_f32 v[120:121], v[120:121], v[48:49]
    v_pk_add_f32 v[122:123], v[122:123], v[50:51]
    v_pk_add_f32 v[124:125], v[124:125], v[52:53]
    v_pk_add_f32 v[126:127], v[126:127], v[54:55]
    s_waitcnt lgkmcnt(0)
    v_pk_add_f32 v[104:105], v[104:105], v[56:57]
    v_pk_add_f32 v[106:107], v[106:107], v[58:59]
    v_pk_add_f32 v[108:109], v[108:109], v[60:61]
    v_pk_add_f32 v[110:111], v[110:111], v[62:63]
    v_pk_add_f32 v[112:113], v[112:113], v[64:65]
    v_pk_add_f32 v[114:115], v[114:115], v[66:67]
    v_pk_add_f32 v[116:117], v[116:117], v[68:69]
    v_pk_add_f32 v[118:119], v[118:119], v[70:71]
    v_pk_add_f32 v[120:121], v[120:121], v[72:73]
    v_pk_add_f32 v[122:123], v[122:123], v[74:75]
    v_pk_add_f32 v[124:125], v[124:125], v[76:77]
    v_pk_add_f32 v[126:127], v[126:127], v[78:79]
    v_pk_add_f32 v[104:105], v[104:105], v[180:181] op_sel_hi:[1,0]
    v_pk_add_f32 v[106:107], v[106:107], v[180:181] op_sel_hi:[1,0]
    v_pk_add_f32 v[108:109], v[108:109], v[180:181] op_sel_hi:[1,0]
    v_pk_add_f32 v[110:111], v[110:111], v[180:181] op_sel_hi:[1,0]
    v_pk_add_f32 v[112:113], v[112:113], v[180:181] op_sel_hi:[1,0]
    v_pk_add_f32 v[114:115], v[114:115], v[180:181] op_sel_hi:[1,0]
    v_pk_add_f32 v[116:117], v[116:117], v[180:181] op_sel_hi:[1,0]
    v_pk_add_f32 v[118:119], v[118:119], v[180:181] op_sel_hi:[1,0]
    v_pk_add_f32 v[120:121], v[120:121], v[180:181] op_sel_hi:[1,0]
    v_pk_add_f32 v[122:123], v[122:123], v[180:181] op_sel_hi:[1,0]
    v_pk_add_f32 v[124:125], v[124:125], v[180:181] op_sel_hi:[1,0]
    v_pk_add_f32 v[126:127], v[126:127], v[180:181] op_sel_hi:[1,0]
    v_pk_mul_f32 v[104:105], v[104:105], v[80:81]
    v_pk_mul_f32 v[106:107], v[106:107], v[82:83]
    v_pk_mul_f32 v[108:109], v[108:109], v[84:85]
    v_pk_mul_f32 v[110:111], v[110:111], v[86:87]
    v_pk_mul_f32 v[112:113], v[112:113], v[88:89]
    v_pk_mul_f32 v[114:115], v[114:115], v[90:91]
    v_pk_mul_f32 v[116:117], v[116:117], v[92:93]
    v_pk_mul_f32 v[118:119], v[118:119], v[94:95]
    v_pk_mul_f32 v[120:121], v[120:121], v[96:97]
    v_pk_mul_f32 v[122:123], v[122:123], v[98:99]
    v_pk_mul_f32 v[124:125], v[124:125], v[100:101]
    v_pk_mul_f32 v[126:127], v[126:127], v[102:103]
    v_cvt_pk_bf16_f32 v8, v104, v105
    v_cvt_pk_bf16_f32 v9, v106, v107
    v_cvt_pk_bf16_f32 v10, v108, v109
    v_cvt_pk_bf16_f32 v11, v110, v111
    buffer_store_dwordx4 v[8:11], v6, s[8:11], s40 offen offset:0 sc1
    v_cvt_pk_bf16_f32 v12, v112, v113
    v_cvt_pk_bf16_f32 v13, v114, v115
    v_cvt_pk_bf16_f32 v14, v116, v117
    v_cvt_pk_bf16_f32 v15, v118, v119
    buffer_store_dwordx4 v[12:15], v6, s[8:11], s40 offen offset:1024 sc1
    v_cvt_pk_bf16_f32 v16, v120, v121
    v_cvt_pk_bf16_f32 v17, v122, v123
    v_cvt_pk_bf16_f32 v18, v124, v125
    v_cvt_pk_bf16_f32 v19, v126, v127
    buffer_store_dwordx4 v[16:19], v6, s[8:11], s40 offen offset:2048 sc1
    s_waitcnt vmcnt(0)
    s_waitcnt lgkmcnt(0)
    v_mov_b32 v1, 161792
    v_mov_b32 v2, 1
    s_mov_b64 exec, 1
    ds_add_u32 v1, v2
    s_mov_b64 exec, -1
    s_mov_b32 s67, 0
gsync_22:
    ds_read_b32 v2, v1
    s_add_u32 s67, s67, 1
    s_waitcnt lgkmcnt(0)
    v_readfirstlane_b32 s66, v2
    s_cmp_gt_u32 s67, 1000000
    s_cbranch_scc1 gsync_e_23
    s_cmp_lt_u32 s66, 12
    s_cbranch_scc1 gsync_22
gsync_e_23:
    s_lshl_b32 s58, s32, 6
    s_lshl_b32 s59, s33, 3
    s_add_u32 s58, s58, s59
    s_add_u32 s58, s58, 14729216
    v_mov_b32 v250, s100
    v_mov_b32 v251, s101
    v_mov_b32 v252, 0
    s_cmp_eq_u32 s34, 0
    s_cselect_b64 exec, 1, 0
    buffer_store_dwordx2 v[250:251], v252, s[8:11], s58 offen sc1
    s_mov_b64 exec, -1
    s_load_dwordx2 s[12:13], s[0:1], 104
    s_load_dwordx2 s[8:9], s[0:1], 0
    s_load_dwordx2 s[16:17], s[0:1], 88
    s_mov_b32 s10, 2621440
    s_mov_b32 s11, 0x20000
    s_mov_b32 s14, 15990784
    s_mov_b32 s15, 0x20000
    s_mov_b32 s18, 2621440
    s_mov_b32 s19, 0x20000
    v_lshrrev_b32 v4, 6, v0
    v_and_b32 v1, 63, v0
    v_readfirstlane_b32 s34, v4
    v_lshlrev_b32 v7, 4, v1
    s_and_b32 s40, s2, 7
    s_lshr_b32 s41, s2, 3
    s_lshr_b32 s32, s40, 1
    s_lshl_b32 s32, s32, 3
    s_and_b32 s42, s41, 7
    s_add_u32 s32, s32, s42
    s_and_b32 s33, s40, 1
    s_lshl_b32 s33, s33, 2
    s_lshr_b32 s42, s41, 3
    s_add_u32 s33, s33, s42
    s_add_u32 s40, s32, s33
    s_mul_i32 s41, s40, 43
    s_lshr_b32 s41, s41, 8
    s_mul_i32 s41, s41, 6
    s_sub_u32 s48, s40, s41
    s_mul_i32 s46, s33, 122880
    s_add_u32 s46, s46, 15007744
    s_mul_i32 s40, s34, 5120
    s_add_u32 s46, s46, s40
    s_mul_i32 s47, s32, 98304
    s_mul_i32 s41, s34, 24576
    s_add_u32 s47, s47, s41
    s_add_u32 s47, s47, 11534336
    s_add_u32 s40, s48, 0
    s_sub_u32 s41, s40, 6
    s_cmp_ge_u32 s40, 6
    s_cselect_b32 s50, s41, s40
    s_add_u32 s40, s48, 1
    s_sub_u32 s41, s40, 6
    s_cmp_ge_u32 s40, 6
    s_cselect_b32 s51, s41, s40
    s_add_u32 s40, s48, 2
    s_sub_u32 s41, s40, 6
    s_cmp_ge_u32 s40, 6
    s_cselect_b32 s52, s41, s40
    s_add_u32 s40, s48, 3
    s_sub_u32 s41, s40, 6
    s_cmp_ge_u32 s40, 6
    s_cselect_b32 s53, s41, s40
    s_add_u32 s40, s48, 4
    s_sub_u32 s41, s40, 6
    s_cmp_ge_u32 s40, 6
    s_cselect_b32 s54, s41, s40
    s_add_u32 s40, s48, 5
    s_sub_u32 s41, s40, 6
    s_cmp_ge_u32 s40, 6
    s_cselect_b32 s55, s41, s40
    s_waitcnt lgkmcnt(0)
    s_mul_i32 s40, s33, 192
    s_add_u32 s40, s40, 14725120
    v_mbcnt_lo_u32_b32 v4, -1, 0
    v_mbcnt_hi_u32_b32 v4, -1, v4
    v_min_u32 v4, 23, v4
    v_lshlrev_b32 v4, 3, v4
    s_mov_b32 s67, 0
fpoll_24:
    buffer_load_dwordx2 v[8:9], v4, s[12:15], s40 offen sc1
    s_add_u32 s67, s67, 1
    s_waitcnt vmcnt(0)
    v_cmp_ne_u32 vcc, s100, v8
    v_cmp_ne_u32 s[64:65], s101, v9
    s_nop 0
    s_or_b64 vcc, vcc, s[64:65]
    s_cmp_gt_u32 s67, 100000
    s_cbranch_scc1 fpoll_e_25
    s_cmp_eq_u64 vcc, 0
    s_cbranch_scc1 fpoll_e_25
    s_sleep 2
    s_branch fpoll_24
fpoll_e_25:
    s_mul_i32 s40, s50, 20480
    s_add_u32 s40, s40, s46
    s_add_u32 s40, s40, 0
    s_mul_i32 s41, s34, 5120
    s_add_u32 m0, s41, 0
    s_nop 0
    buffer_load_dwordx4 v7, s[12:15], s40 offen sc1 lds
    s_mul_i32 s40, s50, 20480
    s_add_u32 s40, s40, s46
    s_add_u32 s40, s40, 1024
    s_mul_i32 s41, s34, 5120
    s_add_u32 m0, s41, 1024
    s_nop 0
    buffer_load_dwordx4 v7, s[12:15], s40 offen sc1 lds
    s_mul_i32 s40, s50, 20480
    s_add_u32 s40, s40, s46
    s_add_u32 s40, s40, 2048
    s_mul_i32 s41, s34, 5120
    s_add_u32 m0, s41, 2048
    s_nop 0
    buffer_load_dwordx4 v7, s[12:15], s40 offen sc1 lds
    s_mul_i32 s40, s50, 20480
    s_add_u32 s40, s40, s46
    s_add_u32 s40, s40, 3072
    s_mul_i32 s41, s34, 5120
    s_add_u32 m0, s41, 3072
    s_nop 0
    buffer_load_dwordx4 v7, s[12:15], s40 offen sc1 lds
    s_mul_i32 s40, s50, 20480
    s_add_u32 s40, s40, s46
    s_add_u32 s40, s40, 4096
    s_mul_i32 s41, s34, 5120
    s_add_u32 m0, s41, 4096
    s_nop 0
    buffer_load_dwordx4 v7, s[12:15], s40 offen sc1 lds
    s_mul_i32 s40, s51, 20480
    s_add_u32 s40, s40, s46
    s_add_u32 s40, s40, 0
    s_mul_i32 s41, s34, 5120
    s_add_u32 m0, s41, 20480
    s_nop 0
    buffer_load_dwordx4 v7, s[12:15], s40 offen sc1 lds
    s_mul_i32 s40, s51, 20480
    s_add_u32 s40, s40, s46
    s_add_u32 s40, s40, 1024
    s_mul_i32 s41, s34, 5120
    s_add_u32 m0, s41, 21504
    s_nop 0
    buffer_load_dwordx4 v7, s[12:15], s40 offen sc1 lds
    s_mul_i32 s40, s51, 20480
    s_add_u32 s40, s40, s46
    s_add_u32 s40, s40, 2048
    s_mul_i32 s41, s34, 5120
    s_add_u32 m0, s41, 22528
    s_nop 0
    buffer_load_dwordx4 v7, s[12:15], s40 offen sc1 lds
    s_mul_i32 s40, s51, 20480
    s_add_u32 s40, s40, s46
    s_add_u32 s40, s40, 3072
    s_mul_i32 s41, s34, 5120
    s_add_u32 m0, s41, 23552
    s_nop 0
    buffer_load_dwordx4 v7, s[12:15], s40 offen sc1 lds
    s_mul_i32 s40, s51, 20480
    s_add_u32 s40, s40, s46
    s_add_u32 s40, s40, 4096
    s_mul_i32 s41, s34, 5120
    s_add_u32 m0, s41, 24576
    s_nop 0
    buffer_load_dwordx4 v7, s[12:15], s40 offen sc1 lds
    s_mul_i32 s40, s52, 20480
    s_add_u32 s40, s40, s46
    s_add_u32 s40, s40, 0
    s_mul_i32 s41, s34, 5120
    s_add_u32 m0, s41, 40960
    s_nop 0
    buffer_load_dwordx4 v7, s[12:15], s40 offen sc1 lds
    s_mul_i32 s40, s52, 20480
    s_add_u32 s40, s40, s46
    s_add_u32 s40, s40, 1024
    s_mul_i32 s41, s34, 5120
    s_add_u32 m0, s41, 41984
    s_nop 0
    buffer_load_dwordx4 v7, s[12:15], s40 offen sc1 lds
    s_mul_i32 s40, s52, 20480
    s_add_u32 s40, s40, s46
    s_add_u32 s40, s40, 2048
    s_mul_i32 s41, s34, 5120
    s_add_u32 m0, s41, 43008
    s_nop 0
    buffer_load_dwordx4 v7, s[12:15], s40 offen sc1 lds
    s_mul_i32 s40, s52, 20480
    s_add_u32 s40, s40, s46
    s_add_u32 s40, s40, 3072
    s_mul_i32 s41, s34, 5120
    s_add_u32 m0, s41, 44032
    s_nop 0
    buffer_load_dwordx4 v7, s[12:15], s40 offen sc1 lds
    s_mul_i32 s40, s52, 20480
    s_add_u32 s40, s40, s46
    s_add_u32 s40, s40, 4096
    s_mul_i32 s41, s34, 5120
    s_add_u32 m0, s41, 45056
    s_nop 0
    buffer_load_dwordx4 v7, s[12:15], s40 offen sc1 lds
    s_mul_i32 s40, s53, 20480
    s_add_u32 s40, s40, s46
    s_add_u32 s40, s40, 0
    s_mul_i32 s41, s34, 5120
    s_add_u32 m0, s41, 61440
    s_nop 0
    buffer_load_dwordx4 v7, s[12:15], s40 offen sc1 lds
    s_mul_i32 s40, s53, 20480
    s_add_u32 s40, s40, s46
    s_add_u32 s40, s40, 1024
    s_mul_i32 s41, s34, 5120
    s_add_u32 m0, s41, 62464
    s_nop 0
    buffer_load_dwordx4 v7, s[12:15], s40 offen sc1 lds
    s_mul_i32 s40, s53, 20480
    s_add_u32 s40, s40, s46
    s_add_u32 s40, s40, 2048
    s_mul_i32 s41, s34, 5120
    s_add_u32 m0, s41, 63488
    s_nop 0
    buffer_load_dwordx4 v7, s[12:15], s40 offen sc1 lds
    s_mul_i32 s40, s53, 20480
    s_add_u32 s40, s40, s46
    s_add_u32 s40, s40, 3072
    s_mul_i32 s41, s34, 5120
    s_add_u32 m0, s41, 64512
    s_nop 0
    buffer_load_dwordx4 v7, s[12:15], s40 offen sc1 lds
    s_mul_i32 s40, s53, 20480
    s_add_u32 s40, s40, s46
    s_add_u32 s40, s40, 4096
    s_mul_i32 s41, s34, 5120
    s_add_u32 m0, s41, 65536
    s_nop 0
    buffer_load_dwordx4 v7, s[12:15], s40 offen sc1 lds
    s_lshl_b32 s40, s32, 6
    s_add_u32 s40, s40, 14729216
    v_mbcnt_lo_u32_b32 v4, -1, 0
    v_mbcnt_hi_u32_b32 v4, -1, v4
    v_min_u32 v4, 7, v4
    v_lshlrev_b32 v4, 3, v4
    s_mov_b32 s67, 0
fpoll_26:
    buffer_load_dwordx2 v[8:9], v4, s[12:15], s40 offen sc1
    s_add_u32 s67, s67, 1
    s_waitcnt vmcnt(0)
    v_cmp_ne_u32 vcc, s100, v8
    v_cmp_ne_u32 s[64:65], s101, v9
    s_nop 0
    s_or_b64 vcc, vcc, s[64:65]
    s_cmp_gt_u32 s67, 100000
    s_cbranch_scc1 fpoll_e_27
    s_cmp_eq_u64 vcc, 0
    s_cbranch_scc1 fpoll_e_27
    s_sleep 2
    s_branch fpoll_26
fpoll_e_27:
    s_lshl_b32 s42, s50, 12
    s_add_u32 s42, s42, s47
    buffer_load_dwordx4 v[8:11], v7, s[12:15], s42 offen offset:0 sc1
    s_lshl_b32 s42, s50, 12
    s_add_u32 s42, s42, s47
    buffer_load_dwordx4 v[12:15], v7, s[12:15], s42 offen offset:1024 sc1
    s_lshl_b32 s42, s50, 12
    s_add_u32 s42, s42, s47
    buffer_load_dwordx4 v[16:19], v7, s[12:15], s42 offen offset:2048 sc1
    s_lshl_b32 s42, s50, 12
    s_add_u32 s42, s42, s47
    buffer_load_dwordx4 v[20:23], v7, s[12:15], s42 offen offset:3072 sc1
    s_lshl_b32 s42, s51, 12
    s_add_u32 s42, s42, s47
    buffer_load_dwordx4 v[24:27], v7, s[12:15], s42 offen offset:0 sc1
    s_lshl_b32 s42, s51, 12
    s_add_u32 s42, s42, s47
    buffer_load_dwordx4 v[28:31], v7, s[12:15], s42 offen offset:1024 sc1
    s_lshl_b32 s42, s51, 12
    s_add_u32 s42, s42, s47
    buffer_load_dwordx4 v[32:35], v7, s[12:15], s42 offen offset:2048 sc1
    s_lshl_b32 s42, s51, 12
    s_add_u32 s42, s42, s47
    buffer_load_dwordx4 v[36:39], v7, s[12:15], s42 offen offset:3072 sc1
    s_waitcnt lgkmcnt(0)
    v_mov_b32 v251, 161792
    v_mov_b32 v252, 1
    s_mov_b64 exec, 1
    ds_add_u32 v251, v252
    s_mov_b64 exec, -1
    s_mov_b32 s67, 0
gsync_28:
    ds_read_b32 v252, v251
    s_add_u32 s67, s67, 1
    s_waitcnt lgkmcnt(0)
    v_readfirstlane_b32 s66, v252
    s_cmp_gt_u32 s67, 1000000
    s_cbranch_scc1 gsync_e_29
    s_cmp_lt_u32 s66, 16
    s_cbranch_scc1 gsync_28
gsync_e_29:
    s_mul_i32 s44, s33, 160
    s_mul_i32 s45, s32, 81920
    s_add_u32 s45, s45, s44
    v_add_u32 v4, 0, v1
    v_mul_u32_u24 v5, 6554, v4
    v_lshrrev_b32 v5, 16, v5
    v_mul_u32_u24 v6, 10, v5
    v_sub_u32 v4, v4, v6
    v_lshlrev_b32 v4, 4, v4
    v_mul_u32_u24 v5, 1280, v5
    v_add_u32 v104, v4, v5
    v_add_u32 v4, 64, v1
    v_mul_u32_u24 v5, 6554, v4
    v_lshrrev_b32 v5, 16, v5
    v_mul_u32_u24 v6, 10, v5
    v_sub_u32 v4, v4, v6
    v_lshlrev_b32 v4, 4, v4
    v_mul_u32_u24 v5, 1280, v5
    v_add_u32 v105, v4, v5
    v_add_u32 v4, 128, v1
    v_mul_u32_u24 v5, 6554, v4
    v_lshrrev_b32 v5, 16, v5
    v_mul_u32_u24 v6, 10, v5
    v_sub_u32 v4, v4, v6
    v_lshlrev_b32 v4, 4, v4
    v_mul_u32_u24 v5, 1280, v5
    v_add_u32 v106, v4, v5
    v_add_u32 v4, 192, v1
    v_mul_u32_u24 v5, 6554, v4
    v_lshrrev_b32 v5, 16, v5
    v_mul_u32_u24 v6, 10, v5
    v_sub_u32 v4, v4, v6
    v_lshlrev_b32 v4, 4, v4
    v_mul_u32_u24 v5, 1280, v5
    v_add_u32 v107, v4, v5
    v_add_u32 v4, 256, v1
    v_mul_u32_u24 v5, 6554, v4
    v_lshrrev_b32 v5, 16, v5
    v_mul_u32_u24 v6, 10, v5
    v_sub_u32 v4, v4, v6
    v_lshlrev_b32 v4, 4, v4
    v_mul_u32_u24 v5, 1280, v5
    v_add_u32 v108, v4, v5
    v_lshrrev_b32 v2, 4, v1
    v_and_b32 v3, 15, v1
    v_mov_b32 v113, v7
    v_add_u32 v114, 61440, v7
    ds_read_b128 v[136:139], v113 offset:0
    ds_read_b128 v[140:143], v113 offset:1024
    ds_read_b128 v[144:147], v113 offset:2048
    ds_read_b128 v[148:151], v113 offset:3072
    ds_read_b128 v[152:155], v113 offset:4096
    ds_read_b128 v[156:159], v113 offset:5120
    ds_read_b128 v[160:163], v113 offset:6144
    ds_read_b128 v[164:167], v113 offset:7168
    ds_read_b128 v[168:171], v113 offset:8192
    ds_read_b128 v[172:175], v113 offset:9216
    s_waitcnt vmcnt(7)
    s_waitcnt lgkmcnt(9)
    v_mfma_f32_16x16x32_bf16 v[116:119], v[136:139], v[8:11], 0
    s_lshl_b32 s42, s52, 12
    s_add_u32 s42, s42, s47
    buffer_load_dwordx4 v[40:43], v7, s[12:15], s42 offen offset:0 sc1
    s_waitcnt lgkmcnt(8)
    v_mfma_f32_16x16x32_bf16 v[120:123], v[140:143], v[8:11], 0
    s_waitcnt lgkmcnt(7)
    v_mfma_f32_16x16x32_bf16 v[124:127], v[144:147], v[8:11], 0
    s_lshl_b32 s42, s52, 12
    s_add_u32 s42, s42, s47
    buffer_load_dwordx4 v[44:47], v7, s[12:15], s42 offen offset:1024 sc1
    s_waitcnt lgkmcnt(6)
    v_mfma_f32_16x16x32_bf16 v[128:131], v[148:151], v[8:11], 0
    s_waitcnt lgkmcnt(5)
    v_mfma_f32_16x16x32_bf16 v[132:135], v[152:155], v[8:11], 0
    s_lshl_b32 s42, s52, 12
    s_add_u32 s42, s42, s47
    buffer_load_dwordx4 v[48:51], v7, s[12:15], s42 offen offset:2048 sc1
    ds_read_b128 v[136:139], v113 offset:10240
    ds_read_b128 v[140:143], v113 offset:11264
    ds_read_b128 v[144:147], v113 offset:12288
    ds_read_b128 v[148:151], v113 offset:13312
    ds_read_b128 v[152:155], v113 offset:14336
    s_waitcnt vmcnt(9)
    s_waitcnt lgkmcnt(9)
    v_mfma_f32_16x16x32_bf16 v[116:119], v[156:159], v[12:15], v[116:119]
    s_lshl_b32 s42, s52, 12
    s_add_u32 s42, s42, s47
    buffer_load_dwordx4 v[52:55], v7, s[12:15], s42 offen offset:3072 sc1
    s_waitcnt lgkmcnt(8)
    v_mfma_f32_16x16x32_bf16 v[120:123], v[160:163], v[12:15], v[120:123]
    s_waitcnt lgkmcnt(7)
    v_mfma_f32_16x16x32_bf16 v[124:127], v[164:167], v[12:15], v[124:127]
    s_waitcnt lgkmcnt(6)
    v_mfma_f32_16x16x32_bf16 v[128:131], v[168:171], v[12:15], v[128:131]
    s_waitcnt lgkmcnt(5)
    v_mfma_f32_16x16x32_bf16 v[132:135], v[172:175], v[12:15], v[132:135]
    ds_read_b128 v[156:159], v113 offset:15360
    ds_read_b128 v[160:163], v113 offset:16384
    ds_read_b128 v[164:167], v113 offset:17408
    ds_read_b128 v[168:171], v113 offset:18432
    ds_read_b128 v[172:175], v113 offset:19456
    s_waitcnt vmcnt(9)
    s_waitcnt lgkmcnt(9)
    v_mfma_f32_16x16x32_bf16 v[116:119], v[136:139], v[16:19], v[116:119]
    s_waitcnt lgkmcnt(8)
    v_mfma_f32_16x16x32_bf16 v[120:123], v[140:143], v[16:19], v[120:123]
    s_waitcnt lgkmcnt(7)
    v_mfma_f32_16x16x32_bf16 v[124:127], v[144:147], v[16:19], v[124:127]
    s_waitcnt lgkmcnt(6)
    v_mfma_f32_16x16x32_bf16 v[128:131], v[148:151], v[16:19], v[128:131]
    s_waitcnt lgkmcnt(5)
    v_mfma_f32_16x16x32_bf16 v[132:135], v[152:155], v[16:19], v[132:135]
    s_waitcnt vmcnt(8)
    s_waitcnt lgkmcnt(4)
    v_mfma_f32_16x16x32_bf16 v[116:119], v[156:159], v[20:23], v[116:119]
    s_waitcnt lgkmcnt(3)
    v_mfma_f32_16x16x32_bf16 v[120:123], v[160:163], v[20:23], v[120:123]
    s_waitcnt lgkmcnt(2)
    v_mfma_f32_16x16x32_bf16 v[124:127], v[164:167], v[20:23], v[124:127]
    s_waitcnt lgkmcnt(1)
    v_mfma_f32_16x16x32_bf16 v[128:131], v[168:171], v[20:23], v[128:131]
    s_waitcnt lgkmcnt(0)
    v_mfma_f32_16x16x32_bf16 v[132:135], v[172:175], v[20:23], v[132:135]
    ds_read_b128 v[136:139], v113 offset:20480
    ds_read_b128 v[140:143], v113 offset:21504
    ds_read_b128 v[144:147], v113 offset:22528
    ds_read_b128 v[148:151], v113 offset:23552
    ds_read_b128 v[152:155], v113 offset:24576
    ds_read_b128 v[156:159], v113 offset:25600
    ds_read_b128 v[160:163], v113 offset:26624
    ds_read_b128 v[164:167], v113 offset:27648
    ds_read_b128 v[168:171], v113 offset:28672
    ds_read_b128 v[172:175], v113 offset:29696
    s_waitcnt vmcnt(7)
    s_waitcnt lgkmcnt(9)
    v_mfma_f32_16x16x32_bf16 v[116:119], v[136:139], v[24:27], v[116:119]
    s_lshl_b32 s42, s53, 12
    s_add_u32 s42, s42, s47
    buffer_load_dwordx4 v[56:59], v7, s[12:15], s42 offen offset:0 sc1
    s_waitcnt lgkmcnt(8)
    v_mfma_f32_16x16x32_bf16 v[120:123], v[140:143], v[24:27], v[120:123]
    s_waitcnt lgkmcnt(7)
    v_mfma_f32_16x16x32_bf16 v[124:127], v[144:147], v[24:27], v[124:127]
    s_lshl_b32 s42, s53, 12
    s_add_u32 s42, s42, s47
    buffer_load_dwordx4 v[60:63], v7, s[12:15], s42 offen offset:1024 sc1
    s_waitcnt lgkmcnt(6)
    v_mfma_f32_16x16x32_bf16 v[128:131], v[148:151], v[24:27], v[128:131]
    s_waitcnt lgkmcnt(5)
    v_mfma_f32_16x16x32_bf16 v[132:135], v[152:155], v[24:27], v[132:135]
    s_lshl_b32 s42, s53, 12
    s_add_u32 s42, s42, s47
    buffer_load_dwordx4 v[64:67], v7, s[12:15], s42 offen offset:2048 sc1
    ds_read_b128 v[136:139], v113 offset:30720
    ds_read_b128 v[140:143], v113 offset:31744
    ds_read_b128 v[144:147], v113 offset:32768
    ds_read_b128 v[148:151], v113 offset:33792
    ds_read_b128 v[152:155], v113 offset:34816
    s_waitcnt vmcnt(9)
    s_waitcnt lgkmcnt(9)
    v_mfma_f32_16x16x32_bf16 v[116:119], v[156:159], v[28:31], v[116:119]
    s_lshl_b32 s42, s53, 12
    s_add_u32 s42, s42, s47
    buffer_load_dwordx4 v[68:71], v7, s[12:15], s42 offen offset:3072 sc1
    s_waitcnt lgkmcnt(8)
    v_mfma_f32_16x16x32_bf16 v[120:123], v[160:163], v[28:31], v[120:123]
    s_waitcnt lgkmcnt(7)
    v_mfma_f32_16x16x32_bf16 v[124:127], v[164:167], v[28:31], v[124:127]
    s_waitcnt lgkmcnt(6)
    v_mfma_f32_16x16x32_bf16 v[128:131], v[168:171], v[28:31], v[128:131]
    s_waitcnt lgkmcnt(5)
    v_mfma_f32_16x16x32_bf16 v[132:135], v[172:175], v[28:31], v[132:135]
    ds_read_b128 v[156:159], v113 offset:35840
    ds_read_b128 v[160:163], v113 offset:36864
    ds_read_b128 v[164:167], v113 offset:37888
    ds_read_b128 v[168:171], v113 offset:38912
    ds_read_b128 v[172:175], v113 offset:39936
    s_waitcnt vmcnt(9)
    s_waitcnt lgkmcnt(9)
    v_mfma_f32_16x16x32_bf16 v[116:119], v[136:139], v[32:35], v[116:119]
    s_waitcnt lgkmcnt(8)
    v_mfma_f32_16x16x32_bf16 v[120:123], v[140:143], v[32:35], v[120:123]
    s_waitcnt lgkmcnt(7)
    v_mfma_f32_16x16x32_bf16 v[124:127], v[144:147], v[32:35], v[124:127]
    s_waitcnt lgkmcnt(6)
    v_mfma_f32_16x16x32_bf16 v[128:131], v[148:151], v[32:35], v[128:131]
    s_waitcnt lgkmcnt(5)
    v_mfma_f32_16x16x32_bf16 v[132:135], v[152:155], v[32:35], v[132:135]
    s_waitcnt vmcnt(8)
    s_waitcnt lgkmcnt(4)
    v_mfma_f32_16x16x32_bf16 v[116:119], v[156:159], v[36:39], v[116:119]
    s_waitcnt lgkmcnt(3)
    v_mfma_f32_16x16x32_bf16 v[120:123], v[160:163], v[36:39], v[120:123]
    s_waitcnt lgkmcnt(2)
    v_mfma_f32_16x16x32_bf16 v[124:127], v[164:167], v[36:39], v[124:127]
    s_waitcnt lgkmcnt(1)
    v_mfma_f32_16x16x32_bf16 v[128:131], v[168:171], v[36:39], v[128:131]
    s_waitcnt lgkmcnt(0)
    v_mfma_f32_16x16x32_bf16 v[132:135], v[172:175], v[36:39], v[132:135]
    ds_read_b128 v[136:139], v113 offset:40960
    ds_read_b128 v[140:143], v113 offset:41984
    ds_read_b128 v[144:147], v113 offset:43008
    ds_read_b128 v[148:151], v113 offset:44032
    ds_read_b128 v[152:155], v113 offset:45056
    ds_read_b128 v[156:159], v113 offset:46080
    ds_read_b128 v[160:163], v113 offset:47104
    ds_read_b128 v[164:167], v113 offset:48128
    ds_read_b128 v[168:171], v113 offset:49152
    ds_read_b128 v[172:175], v113 offset:50176
    s_waitcnt vmcnt(7)
    s_waitcnt lgkmcnt(9)
    v_mfma_f32_16x16x32_bf16 v[116:119], v[136:139], v[40:43], v[116:119]
    s_lshl_b32 s42, s54, 12
    s_add_u32 s42, s42, s47
    buffer_load_dwordx4 v[72:75], v7, s[12:15], s42 offen offset:0 sc1
    s_waitcnt lgkmcnt(8)
    v_mfma_f32_16x16x32_bf16 v[120:123], v[140:143], v[40:43], v[120:123]
    s_waitcnt lgkmcnt(7)
    v_mfma_f32_16x16x32_bf16 v[124:127], v[144:147], v[40:43], v[124:127]
    s_lshl_b32 s42, s54, 12
    s_add_u32 s42, s42, s47
    buffer_load_dwordx4 v[76:79], v7, s[12:15], s42 offen offset:1024 sc1
    s_waitcnt lgkmcnt(6)
    v_mfma_f32_16x16x32_bf16 v[128:131], v[148:151], v[40:43], v[128:131]
    s_waitcnt lgkmcnt(5)
    v_mfma_f32_16x16x32_bf16 v[132:135], v[152:155], v[40:43], v[132:135]
    s_lshl_b32 s42, s54, 12
    s_add_u32 s42, s42, s47
    buffer_load_dwordx4 v[80:83], v7, s[12:15], s42 offen offset:2048 sc1
    ds_read_b128 v[136:139], v113 offset:51200
    ds_read_b128 v[140:143], v113 offset:52224
    ds_read_b128 v[144:147], v113 offset:53248
    ds_read_b128 v[148:151], v113 offset:54272
    ds_read_b128 v[152:155], v113 offset:55296
    s_waitcnt vmcnt(9)
    s_waitcnt lgkmcnt(9)
    v_mfma_f32_16x16x32_bf16 v[116:119], v[156:159], v[44:47], v[116:119]
    s_lshl_b32 s42, s54, 12
    s_add_u32 s42, s42, s47
    buffer_load_dwordx4 v[84:87], v7, s[12:15], s42 offen offset:3072 sc1
    s_waitcnt lgkmcnt(8)
    v_mfma_f32_16x16x32_bf16 v[120:123], v[160:163], v[44:47], v[120:123]
    s_waitcnt lgkmcnt(7)
    v_mfma_f32_16x16x32_bf16 v[124:127], v[164:167], v[44:47], v[124:127]
    s_waitcnt lgkmcnt(6)
    v_mfma_f32_16x16x32_bf16 v[128:131], v[168:171], v[44:47], v[128:131]
    s_waitcnt lgkmcnt(5)
    v_mfma_f32_16x16x32_bf16 v[132:135], v[172:175], v[44:47], v[132:135]
    ds_read_b128 v[156:159], v113 offset:56320
    ds_read_b128 v[160:163], v113 offset:57344
    ds_read_b128 v[164:167], v113 offset:58368
    ds_read_b128 v[168:171], v113 offset:59392
    ds_read_b128 v[172:175], v113 offset:60416
    s_waitcnt vmcnt(9)
    s_waitcnt lgkmcnt(9)
    v_mfma_f32_16x16x32_bf16 v[116:119], v[136:139], v[48:51], v[116:119]
    s_waitcnt lgkmcnt(8)
    v_mfma_f32_16x16x32_bf16 v[120:123], v[140:143], v[48:51], v[120:123]
    s_waitcnt lgkmcnt(7)
    v_mfma_f32_16x16x32_bf16 v[124:127], v[144:147], v[48:51], v[124:127]
    s_waitcnt lgkmcnt(6)
    v_mfma_f32_16x16x32_bf16 v[128:131], v[148:151], v[48:51], v[128:131]
    s_waitcnt lgkmcnt(5)
    v_mfma_f32_16x16x32_bf16 v[132:135], v[152:155], v[48:51], v[132:135]
    s_waitcnt vmcnt(8)
    s_waitcnt lgkmcnt(4)
    v_mfma_f32_16x16x32_bf16 v[116:119], v[156:159], v[52:55], v[116:119]
    s_waitcnt lgkmcnt(3)
    v_mfma_f32_16x16x32_bf16 v[120:123], v[160:163], v[52:55], v[120:123]
    s_waitcnt lgkmcnt(2)
    v_mfma_f32_16x16x32_bf16 v[124:127], v[164:167], v[52:55], v[124:127]
    s_waitcnt lgkmcnt(1)
    v_mfma_f32_16x16x32_bf16 v[128:131], v[168:171], v[52:55], v[128:131]
    s_waitcnt lgkmcnt(0)
    v_mfma_f32_16x16x32_bf16 v[132:135], v[172:175], v[52:55], v[132:135]
    ds_read_b128 v[136:139], v114 offset:0
    ds_read_b128 v[140:143], v114 offset:1024
    ds_read_b128 v[144:147], v114 offset:2048
    ds_read_b128 v[148:151], v114 offset:3072
    ds_read_b128 v[152:155], v114 offset:4096
    ds_read_b128 v[156:159], v114 offset:5120
    ds_read_b128 v[160:163], v114 offset:6144
    ds_read_b128 v[164:167], v114 offset:7168
    ds_read_b128 v[168:171], v114 offset:8192
    ds_read_b128 v[172:175], v114 offset:9216
    s_waitcnt vmcnt(7)
    s_waitcnt lgkmcnt(9)
    v_mfma_f32_16x16x32_bf16 v[116:119], v[136:139], v[56:59], v[116:119]
    s_lshl_b32 s42, s55, 12
    s_add_u32 s42, s42, s47
    buffer_load_dwordx4 v[88:91], v7, s[12:15], s42 offen offset:0 sc1
    s_waitcnt lgkmcnt(8)
    v_mfma_f32_16x16x32_bf16 v[120:123], v[140:143], v[56:59], v[120:123]
    s_waitcnt lgkmcnt(7)
    v_mfma_f32_16x16x32_bf16 v[124:127], v[144:147], v[56:59], v[124:127]
    s_lshl_b32 s42, s55, 12
    s_add_u32 s42, s42, s47
    buffer_load_dwordx4 v[92:95], v7, s[12:15], s42 offen offset:1024 sc1
    s_waitcnt lgkmcnt(6)
    v_mfma_f32_16x16x32_bf16 v[128:131], v[148:151], v[56:59], v[128:131]
    s_waitcnt lgkmcnt(5)
    v_mfma_f32_16x16x32_bf16 v[132:135], v[152:155], v[56:59], v[132:135]
    s_lshl_b32 s42, s55, 12
    s_add_u32 s42, s42, s47
    buffer_load_dwordx4 v[96:99], v7, s[12:15], s42 offen offset:2048 sc1
    ds_read_b128 v[136:139], v114 offset:10240
    ds_read_b128 v[140:143], v114 offset:11264
    ds_read_b128 v[144:147], v114 offset:12288
    ds_read_b128 v[148:151], v114 offset:13312
    ds_read_b128 v[152:155], v114 offset:14336
    s_waitcnt vmcnt(9)
    s_waitcnt lgkmcnt(9)
    v_mfma_f32_16x16x32_bf16 v[116:119], v[156:159], v[60:63], v[116:119]
    s_lshl_b32 s42, s55, 12
    s_add_u32 s42, s42, s47
    buffer_load_dwordx4 v[100:103], v7, s[12:15], s42 offen offset:3072 sc1
    s_waitcnt lgkmcnt(8)
    v_mfma_f32_16x16x32_bf16 v[120:123], v[160:163], v[60:63], v[120:123]
    s_waitcnt lgkmcnt(7)
    v_mfma_f32_16x16x32_bf16 v[124:127], v[164:167], v[60:63], v[124:127]
    s_waitcnt lgkmcnt(6)
    v_mfma_f32_16x16x32_bf16 v[128:131], v[168:171], v[60:63], v[128:131]
    s_waitcnt lgkmcnt(5)
    v_mfma_f32_16x16x32_bf16 v[132:135], v[172:175], v[60:63], v[132:135]
    ds_read_b128 v[156:159], v114 offset:15360
    ds_read_b128 v[160:163], v114 offset:16384
    ds_read_b128 v[164:167], v114 offset:17408
    ds_read_b128 v[168:171], v114 offset:18432
    ds_read_b128 v[172:175], v114 offset:19456
    s_waitcnt vmcnt(9)
    s_waitcnt lgkmcnt(9)
    v_mfma_f32_16x16x32_bf16 v[116:119], v[136:139], v[64:67], v[116:119]
    s_waitcnt lgkmcnt(8)
    v_mfma_f32_16x16x32_bf16 v[120:123], v[140:143], v[64:67], v[120:123]
    s_waitcnt lgkmcnt(7)
    v_mfma_f32_16x16x32_bf16 v[124:127], v[144:147], v[64:67], v[124:127]
    s_waitcnt lgkmcnt(6)
    v_mfma_f32_16x16x32_bf16 v[128:131], v[148:151], v[64:67], v[128:131]
    s_waitcnt lgkmcnt(5)
    v_mfma_f32_16x16x32_bf16 v[132:135], v[152:155], v[64:67], v[132:135]
    s_waitcnt vmcnt(8)
    s_waitcnt lgkmcnt(4)
    v_mfma_f32_16x16x32_bf16 v[116:119], v[156:159], v[68:71], v[116:119]
    s_waitcnt lgkmcnt(3)
    v_mfma_f32_16x16x32_bf16 v[120:123], v[160:163], v[68:71], v[120:123]
    s_waitcnt lgkmcnt(2)
    v_mfma_f32_16x16x32_bf16 v[124:127], v[164:167], v[68:71], v[124:127]
    s_waitcnt lgkmcnt(1)
    v_mfma_f32_16x16x32_bf16 v[128:131], v[168:171], v[68:71], v[128:131]
    s_waitcnt lgkmcnt(0)
    v_mfma_f32_16x16x32_bf16 v[132:135], v[172:175], v[68:71], v[132:135]
    s_barrier
    s_mul_i32 s40, s54, 20480
    s_add_u32 s40, s40, s46
    s_add_u32 s40, s40, 0
    s_mul_i32 s41, s34, 5120
    s_add_u32 m0, s41, 81920
    s_nop 0
    buffer_load_dwordx4 v7, s[12:15], s40 offen sc1 lds
    s_mul_i32 s40, s54, 20480
    s_add_u32 s40, s40, s46
    s_add_u32 s40, s40, 1024
    s_mul_i32 s41, s34, 5120
    s_add_u32 m0, s41, 82944
    s_nop 0
    buffer_load_dwordx4 v7, s[12:15], s40 offen sc1 lds
    s_mul_i32 s40, s54, 20480
    s_add_u32 s40, s40, s46
    s_add_u32 s40, s40, 2048
    s_mul_i32 s41, s34, 5120
    s_add_u32 m0, s41, 83968
    s_nop 0
    buffer_load_dwordx4 v7, s[12:15], s40 offen sc1 lds
    s_mul_i32 s40, s54, 20480
    s_add_u32 s40, s40, s46
    s_add_u32 s40, s40, 3072
    s_mul_i32 s41, s34, 5120
    s_add_u32 m0, s41, 84992
    s_nop 0
    buffer_load_dwordx4 v7, s[12:15], s40 offen sc1 lds
    s_mul_i32 s40, s54, 20480
    s_add_u32 s40, s40, s46
    s_add_u32 s40, s40, 4096
    s_mul_i32 s41, s34, 5120
    s_add_u32 m0, s41, 86016
    s_nop 0
    buffer_load_dwordx4 v7, s[12:15], s40 offen sc1 lds
    s_mul_i32 s40, s55, 20480
    s_add_u32 s40, s40, s46
    s_add_u32 s40, s40, 0
    s_mul_i32 s41, s34, 5120
    s_add_u32 m0, s41, 102400
    s_nop 0
    buffer_load_dwordx4 v7, s[12:15], s40 offen sc1 lds
    s_mul_i32 s40, s55, 20480
    s_add_u32 s40, s40, s46
    s_add_u32 s40, s40, 1024
    s_mul_i32 s41, s34, 5120
    s_add_u32 m0, s41, 103424
    s_nop 0
    buffer_load_dwordx4 v7, s[12:15], s40 offen sc1 lds
    s_mul_i32 s40, s55, 20480
    s_add_u32 s40, s40, s46
    s_add_u32 s40, s40, 2048
    s_mul_i32 s41, s34, 5120
    s_add_u32 m0, s41, 104448
    s_nop 0
    buffer_load_dwordx4 v7, s[12:15], s40 offen sc1 lds
    s_mul_i32 s40, s55, 20480
    s_add_u32 s40, s40, s46
    s_add_u32 s40, s40, 3072
    s_mul_i32 s41, s34, 5120
    s_add_u32 m0, s41, 105472
    s_nop 0
    buffer_load_dwordx4 v7, s[12:15], s40 offen sc1 lds
    s_mul_i32 s40, s55, 20480
    s_add_u32 s40, s40, s46
    s_add_u32 s40, s40, 4096
    s_mul_i32 s41, s34, 5120
    s_add_u32 m0, s41, 106496
    s_nop 0
    buffer_load_dwordx4 v7, s[12:15], s40 offen sc1 lds
    v_mbcnt_lo_u32_b32 v4, -1, 0
    v_mbcnt_hi_u32_b32 v4, -1, v4
    v_lshlrev_b32 v4, 4, v4
    s_mov_b32 s66, 14721024
    s_mov_b32 s67, 0
fpoll_30:
    buffer_load_dwordx4 v[176:179], v4, s[12:15], s66 offen sc1
    buffer_load_dwordx4 v[180:183], v4, s[12:15], s66 offen offset:1024 sc1
    s_add_u32 s67, s67, 1
    s_waitcnt vmcnt(0)
    v_cmp_ne_u32 vcc, s100, v176
    v_cmp_ne_u32 s[64:65], s101, v177
    s_nop 0
    s_or_b64 vcc, vcc, s[64:65]
    v_cmp_ne_u32 s[64:65], s100, v178
    s_nop 0
    s_or_b64 vcc, vcc, s[64:65]
    v_cmp_ne_u32 s[64:65], s101, v179
    s_nop 0
    s_or_b64 vcc, vcc, s[64:65]
    v_cmp_ne_u32 s[64:65], s100, v180
    s_nop 0
    s_or_b64 vcc, vcc, s[64:65]
    v_cmp_ne_u32 s[64:65], s101, v181
    s_nop 0
    s_or_b64 vcc, vcc, s[64:65]
    v_cmp_ne_u32 s[64:65], s100, v182
    s_nop 0
    s_or_b64 vcc, vcc, s[64:65]
    v_cmp_ne_u32 s[64:65], s101, v183
    s_nop 0
    s_or_b64 vcc, vcc, s[64:65]
    s_cmp_gt_u32 s67, 100000
    s_cbranch_scc1 fpoll_e_31
    s_cmp_eq_u64 vcc, 0
    s_cbranch_scc1 fpoll_e_31
    s_sleep 2
    s_branch fpoll_30
fpoll_e_31:
    s_cmp_ge_u32 s34, 2
    s_cbranch_scc1 k3_y_32
    s_mul_i32 s40, s34, 40960
    s_add_u32 s40, s40, s45
    s_mul_i32 s41, s34, 5120
    s_add_u32 m0, s41, 122880
    s_nop 0
    buffer_load_dwordx4 v104, s[8:11], s40 offen lds
    s_add_u32 m0, s41, 123904
    s_nop 0
    buffer_load_dwordx4 v105, s[8:11], s40 offen lds
    s_add_u32 m0, s41, 124928
    s_nop 0
    buffer_load_dwordx4 v106, s[8:11], s40 offen lds
    s_add_u32 m0, s41, 125952
    s_nop 0
    buffer_load_dwordx4 v107, s[8:11], s40 offen lds
    s_add_u32 m0, s41, 126976
    s_nop 0
    buffer_load_dwordx4 v108, s[8:11], s40 offen lds
    s_branch k3_xy_33
k3_y_32:
    v_lshrrev_b32 v4, 3, v1
    v_lshlrev_b32 v4, 12, v4
    v_and_b32 v5, 7, v1
    v_lshl_add_u32 v112, v5, 4, v4
    s_sub_u32 s42, s34, 2
    s_mul_i32 s40, s42, 40
    s_mul_i32 s41, s33, 80
    s_add_u32 s40, s40, s41
    s_lshl_b32 s40, s40, 12
    s_lshl_b32 s41, s32, 7
    s_add_u32 s40, s40, s41
    s_add_u32 s40, s40, 8912896
    s_mul_i32 s41, s42, 5120
    s_add_u32 m0, s41, 133120
    s_nop 0
    buffer_load_dwordx4 v112, s[12:15], s40 offen sc1 lds
    s_add_u32 s40, s40, 32768
    s_add_u32 m0, s41, 134144
    s_nop 0
    buffer_load_dwordx4 v112, s[12:15], s40 offen sc1 lds
    s_add_u32 s40, s40, 32768
    s_add_u32 m0, s41, 135168
    s_nop 0
    buffer_load_dwordx4 v112, s[12:15], s40 offen sc1 lds
    s_add_u32 s40, s40, 32768
    s_add_u32 m0, s41, 136192
    s_nop 0
    buffer_load_dwordx4 v112, s[12:15], s40 offen sc1 lds
    s_add_u32 s40, s40, 32768
    s_add_u32 m0, s41, 137216
    s_nop 0
    buffer_load_dwordx4 v112, s[12:15], s40 offen sc1 lds
    s_add_u32 s40, s40, 32768
k3_xy_33:
    s_lshl_b32 s40, s32, 9
    s_lshl_b32 s41, s34, 7
    s_add_u32 s40, s40, s41
    s_add_u32 s40, s40, 14680064
    v_lshlrev_b32 v4, 3, v3
    buffer_load_dwordx2 v[110:111], v4, s[12:15], s40 offen sc1
    s_barrier
    ds_read_b128 v[136:139], v114 offset:20480
    ds_read_b128 v[140:143], v114 offset:21504
    ds_read_b128 v[144:147], v114 offset:22528
    ds_read_b128 v[148:151], v114 offset:23552
    ds_read_b128 v[152:155], v114 offset:24576
    ds_read_b128 v[156:159], v114 offset:25600
    ds_read_b128 v[160:163], v114 offset:26624
    ds_read_b128 v[164:167], v114 offset:27648
    ds_read_b128 v[168:171], v114 offset:28672
    ds_read_b128 v[172:175], v114 offset:29696
    s_waitcnt vmcnt(23)
    s_waitcnt lgkmcnt(9)
    v_mfma_f32_16x16x32_bf16 v[116:119], v[136:139], v[72:75], v[116:119]
    s_waitcnt lgkmcnt(8)
    v_mfma_f32_16x16x32_bf16 v[120:123], v[140:143], v[72:75], v[120:123]
    s_waitcnt lgkmcnt(7)
    v_mfma_f32_16x16x32_bf16 v[124:127], v[144:147], v[72:75], v[124:127]
    s_waitcnt lgkmcnt(6)
    v_mfma_f32_16x16x32_bf16 v[128:131], v[148:151], v[72:75], v[128:131]
    s_waitcnt lgkmcnt(5)
    v_mfma_f32_16x16x32_bf16 v[132:135], v[152:155], v[72:75], v[132:135]
    ds_read_b128 v[136:139], v114 offset:30720
    ds_read_b128 v[140:143], v114 offset:31744
    ds_read_b128 v[144:147], v114 offset:32768
    ds_read_b128 v[148:151], v114 offset:33792
    ds_read_b128 v[152:155], v114 offset:34816
    s_waitcnt vmcnt(22)
    s_waitcnt lgkmcnt(9)
    v_mfma_f32_16x16x32_bf16 v[116:119], v[156:159], v[76:79], v[116:119]
    s_waitcnt lgkmcnt(8)
    v_mfma_f32_16x16x32_bf16 v[120:123], v[160:163], v[76:79], v[120:123]
    s_waitcnt lgkmcnt(7)
    v_mfma_f32_16x16x32_bf16 v[124:127], v[164:167], v[76:79], v[124:127]
    s_waitcnt lgkmcnt(6)
    v_mfma_f32_16x16x32_bf16 v[128:131], v[168:171], v[76:79], v[128:131]
    s_waitcnt lgkmcnt(5)
    v_mfma_f32_16x16x32_bf16 v[132:135], v[172:175], v[76:79], v[132:135]
    ds_read_b128 v[156:159], v114 offset:35840
    ds_read_b128 v[160:163], v114 offset:36864
    ds_read_b128 v[164:167], v114 offset:37888
    ds_read_b128 v[168:171], v114 offset:38912
    ds_read_b128 v[172:175], v114 offset:39936
    s_waitcnt vmcnt(21)
    s_waitcnt lgkmcnt(9)
    v_mfma_f32_16x16x32_bf16 v[116:119], v[136:139], v[80:83], v[116:119]
    s_waitcnt lgkmcnt(8)
    v_mfma_f32_16x16x32_bf16 v[120:123], v[140:143], v[80:83], v[120:123]
    s_waitcnt lgkmcnt(7)
    v_mfma_f32_16x16x32_bf16 v[124:127], v[144:147], v[80:83], v[124:127]
    s_waitcnt lgkmcnt(6)
    v_mfma_f32_16x16x32_bf16 v[128:131], v[148:151], v[80:83], v[128:131]
    s_waitcnt lgkmcnt(5)
    v_mfma_f32_16x16x32_bf16 v[132:135], v[152:155], v[80:83], v[132:135]
    s_waitcnt vmcnt(20)
    s_waitcnt lgkmcnt(4)
    v_mfma_f32_16x16x32_bf16 v[116:119], v[156:159], v[84:87], v[116:119]
    s_waitcnt lgkmcnt(3)
    v_mfma_f32_16x16x32_bf16 v[120:123], v[160:163], v[84:87], v[120:123]
    s_waitcnt lgkmcnt(2)
    v_mfma_f32_16x16x32_bf16 v[124:127], v[164:167], v[84:87], v[124:127]
    s_waitcnt lgkmcnt(1)
    v_mfma_f32_16x16x32_bf16 v[128:131], v[168:171], v[84:87], v[128:131]
    s_waitcnt lgkmcnt(0)
    v_mfma_f32_16x16x32_bf16 v[132:135], v[172:175], v[84:87], v[132:135]
    ds_read_b128 v[136:139], v114 offset:40960
    ds_read_b128 v[140:143], v114 offset:41984
    ds_read_b128 v[144:147], v114 offset:43008
    ds_read_b128 v[148:151], v114 offset:44032
    ds_read_b128 v[152:155], v114 offset:45056
    ds_read_b128 v[156:159], v114 offset:46080
    ds_read_b128 v[160:163], v114 offset:47104
    ds_read_b128 v[164:167], v114 offset:48128
    ds_read_b128 v[168:171], v114 offset:49152
    ds_read_b128 v[172:175], v114 offset:50176
    s_waitcnt vmcnt(19)
    s_waitcnt lgkmcnt(9)
    v_mfma_f32_16x16x32_bf16 v[116:119], v[136:139], v[88:91], v[116:119]
    s_waitcnt lgkmcnt(8)
    v_mfma_f32_16x16x32_bf16 v[120:123], v[140:143], v[88:91], v[120:123]
    s_waitcnt lgkmcnt(7)
    v_mfma_f32_16x16x32_bf16 v[124:127], v[144:147], v[88:91], v[124:127]
    s_waitcnt lgkmcnt(6)
    v_mfma_f32_16x16x32_bf16 v[128:131], v[148:151], v[88:91], v[128:131]
    s_waitcnt lgkmcnt(5)
    v_mfma_f32_16x16x32_bf16 v[132:135], v[152:155], v[88:91], v[132:135]
    ds_read_b128 v[136:139], v114 offset:51200
    ds_read_b128 v[140:143], v114 offset:52224
    ds_read_b128 v[144:147], v114 offset:53248
    ds_read_b128 v[148:151], v114 offset:54272
    ds_read_b128 v[152:155], v114 offset:55296
    s_waitcnt vmcnt(18)
    s_waitcnt lgkmcnt(9)
    v_mfma_f32_16x16x32_bf16 v[116:119], v[156:159], v[92:95], v[116:119]
    s_waitcnt lgkmcnt(8)
    v_mfma_f32_16x16x32_bf16 v[120:123], v[160:163], v[92:95], v[120:123]
    s_waitcnt lgkmcnt(7)
    v_mfma_f32_16x16x32_bf16 v[124:127], v[164:167], v[92:95], v[124:127]
    s_waitcnt lgkmcnt(6)
    v_mfma_f32_16x16x32_bf16 v[128:131], v[168:171], v[92:95], v[128:131]
    s_waitcnt lgkmcnt(5)
    v_mfma_f32_16x16x32_bf16 v[132:135], v[172:175], v[92:95], v[132:135]
    ds_read_b128 v[156:159], v114 offset:56320
    ds_read_b128 v[160:163], v114 offset:57344
    ds_read_b128 v[164:167], v114 offset:58368
    ds_read_b128 v[168:171], v114 offset:59392
    ds_read_b128 v[172:175], v114 offset:60416
    s_waitcnt vmcnt(17)
    s_waitcnt lgkmcnt(9)
    v_mfma_f32_16x16x32_bf16 v[116:119], v[136:139], v[96:99], v[116:119]
    s_waitcnt lgkmcnt(8)
    v_mfma_f32_16x16x32_bf16 v[120:123], v[140:143], v[96:99], v[120:123]
    s_waitcnt lgkmcnt(7)
    v_mfma_f32_16x16x32_bf16 v[124:127], v[144:147], v[96:99], v[124:127]
    s_waitcnt lgkmcnt(6)
    v_mfma_f32_16x16x32_bf16 v[128:131], v[148:151], v[96:99], v[128:131]
    s_waitcnt lgkmcnt(5)
    v_mfma_f32_16x16x32_bf16 v[132:135], v[152:155], v[96:99], v[132:135]
    s_waitcnt vmcnt(16)
    s_waitcnt lgkmcnt(4)
    v_mfma_f32_16x16x32_bf16 v[116:119], v[156:159], v[100:103], v[116:119]
    s_waitcnt lgkmcnt(3)
    v_mfma_f32_16x16x32_bf16 v[120:123], v[160:163], v[100:103], v[120:123]
    s_waitcnt lgkmcnt(2)
    v_mfma_f32_16x16x32_bf16 v[124:127], v[164:167], v[100:103], v[124:127]
    s_waitcnt lgkmcnt(1)
    v_mfma_f32_16x16x32_bf16 v[128:131], v[168:171], v[100:103], v[128:131]
    s_waitcnt lgkmcnt(0)
    v_mfma_f32_16x16x32_bf16 v[132:135], v[172:175], v[100:103], v[132:135]
    s_lshl_b32 s40, s34, 4
    v_add_u32 v4, s40, v3
    v_mul_u32_u24 v4, 160, v4
    v_lshl_add_u32 v184, v2, 3, v4
    v_add_u32 v185, 122880, v184
    v_lshrrev_b32 v5, 2, v3
    v_lshl_add_u32 v4, v2, 2, v5
    v_lshlrev_b32 v4, 7, v4
    v_and_b32 v5, 3, v3
    v_lshl_add_u32 v4, v5, 3, v4
    s_lshl_b32 s40, s34, 5
    s_add_u32 s40, s40, 133120
    v_add_u32 v186, s40, v4
    s_mov_b32 s46, 0xbfb8aa3b
    s_mov_b32 s47, 0xbfb8aa3b
    v_pk_mul_f32 v[8:9], v[116:117], s[46:47]
    v_pk_mul_f32 v[10:11], v[118:119], s[46:47]
    v_pk_mul_f32 v[12:13], v[120:121], s[46:47]
    v_pk_mul_f32 v[14:15], v[122:123], s[46:47]
    v_pk_mul_f32 v[16:17], v[124:125], s[46:47]
    v_pk_mul_f32 v[18:19], v[126:127], s[46:47]
    v_pk_mul_f32 v[20:21], v[128:129], s[46:47]
    v_pk_mul_f32 v[22:23], v[130:131], s[46:47]
    v_pk_mul_f32 v[24:25], v[132:133], s[46:47]
    v_pk_mul_f32 v[26:27], v[134:135], s[46:47]
    s_waitcnt vmcnt(0)
    s_barrier
    ds_read_b64 v[136:137], v185 offset:0
    ds_read_b64 v[138:139], v185 offset:32
    ds_read_b64 v[140:141], v185 offset:64
    ds_read_b64 v[142:143], v185 offset:96
    ds_read_b64 v[144:145], v185 offset:128
    ds_read_b64_tr_b16 v[146:147], v186 offset:0
    ds_read_b64_tr_b16 v[148:149], v186 offset:2048
    ds_read_b64_tr_b16 v[150:151], v186 offset:4096
    ds_read_b64_tr_b16 v[152:153], v186 offset:6144
    ds_read_b64_tr_b16 v[154:155], v186 offset:8192
    v_exp_f32 v8, v8
    v_exp_f32 v9, v9
    v_exp_f32 v10, v10
    v_exp_f32 v11, v11
    v_exp_f32 v12, v12
    v_exp_f32 v13, v13
    v_exp_f32 v14, v14
    v_exp_f32 v15, v15
    v_exp_f32 v16, v16
    v_exp_f32 v17, v17
    v_exp_f32 v18, v18
    v_exp_f32 v19, v19
    v_exp_f32 v20, v20
    v_exp_f32 v21, v21
    v_exp_f32 v22, v22
    v_exp_f32 v23, v23
    v_exp_f32 v24, v24
    v_exp_f32 v25, v25
    v_exp_f32 v26, v26
    v_exp_f32 v27, v27
    v_pk_add_f32 v[8:9], v[8:9], 1.0 op_sel_hi:[1,0]
    v_pk_add_f32 v[10:11], v[10:11], 1.0 op_sel_hi:[1,0]
    v_pk_add_f32 v[12:13], v[12:13], 1.0 op_sel_hi:[1,0]
    v_pk_add_f32 v[14:15], v[14:15], 1.0 op_sel_hi:[1,0]
    v_pk_add_f32 v[16:17], v[16:17], 1.0 op_sel_hi:[1,0]
    v_pk_add_f32 v[18:19], v[18:19], 1.0 op_sel_hi:[1,0]
    v_pk_add_f32 v[20:21], v[20:21], 1.0 op_sel_hi:[1,0]
    v_pk_add_f32 v[22:23], v[22:23], 1.0 op_sel_hi:[1,0]
    v_pk_add_f32 v[24:25], v[24:25], 1.0 op_sel_hi:[1,0]
    v_pk_add_f32 v[26:27], v[26:27], 1.0 op_sel_hi:[1,0]
    v_rcp_f32 v8, v8
    v_rcp_f32 v9, v9
    v_rcp_f32 v10, v10
    v_rcp_f32 v11, v11
    v_rcp_f32 v12, v12
    v_rcp_f32 v13, v13
    v_rcp_f32 v14, v14
    v_rcp_f32 v15, v15
    v_rcp_f32 v16, v16
    v_rcp_f32 v17, v17
    v_rcp_f32 v18, v18
    v_rcp_f32 v19, v19
    v_rcp_f32 v20, v20
    v_rcp_f32 v21, v21
    v_rcp_f32 v22, v22
    v_rcp_f32 v23, v23
    v_rcp_f32 v24, v24
    v_rcp_f32 v25, v25
    v_rcp_f32 v26, v26
    v_rcp_f32 v27, v27
    v_pk_mul_f32 v[8:9], v[8:9], v[116:117]
    v_pk_mul_f32 v[10:11], v[10:11], v[118:119]
    v_pk_mul_f32 v[12:13], v[12:13], v[120:121]
    v_pk_mul_f32 v[14:15], v[14:15], v[122:123]
    v_pk_mul_f32 v[16:17], v[16:17], v[124:125]
    v_pk_mul_f32 v[18:19], v[18:19], v[126:127]
    v_pk_mul_f32 v[20:21], v[20:21], v[128:129]
    v_pk_mul_f32 v[22:23], v[22:23], v[130:131]
    v_pk_mul_f32 v[24:25], v[24:25], v[132:133]
    v_pk_mul_f32 v[26:27], v[26:27], v[134:135]
    s_waitcnt lgkmcnt(0)
    v_lshlrev_b32 v28, 16, v136
    v_and_b32 v29, 0xffff0000, v136
    v_lshlrev_b32 v48, 16, v146
    v_and_b32 v49, 0xffff0000, v146
    v_lshlrev_b32 v30, 16, v137
    v_and_b32 v31, 0xffff0000, v137
    v_lshlrev_b32 v50, 16, v147
    v_and_b32 v51, 0xffff0000, v147
    v_lshlrev_b32 v32, 16, v138
    v_and_b32 v33, 0xffff0000, v138
    v_lshlrev_b32 v52, 16, v148
    v_and_b32 v53, 0xffff0000, v148
    v_lshlrev_b32 v34, 16, v139
    v_and_b32 v35, 0xffff0000, v139
    v_lshlrev_b32 v54, 16, v149
    v_and_b32 v55, 0xffff0000, v149
    v_lshlrev_b32 v36, 16, v140
    v_and_b32 v37, 0xffff0000, v140
    v_lshlrev_b32 v56, 16, v150
    v_and_b32 v57, 0xffff0000, v150
    v_lshlrev_b32 v38, 16, v141
    v_and_b32 v39, 0xffff0000, v141
    v_lshlrev_b32 v58, 16, v151
    v_and_b32 v59, 0xffff0000, v151
    v_lshlrev_b32 v40, 16, v142
    v_and_b32 v41, 0xffff0000, v142
    v_lshlrev_b32 v60, 16, v152
    v_and_b32 v61, 0xffff0000, v152
    v_lshlrev_b32 v42, 16, v143
    v_and_b32 v43, 0xffff0000, v143
    v_lshlrev_b32 v62, 16, v153
    v_and_b32 v63, 0xffff0000, v153
    v_lshlrev_b32 v44, 16, v144
    v_and_b32 v45, 0xffff0000, v144
    v_lshlrev_b32 v64, 16, v154
    v_and_b32 v65, 0xffff0000, v154
    v_lshlrev_b32 v46, 16, v145
    v_and_b32 v47, 0xffff0000, v145
    v_lshlrev_b32 v66, 16, v155
    v_and_b32 v67, 0xffff0000, v155
    v_mov_b32 v188, v111
    v_pk_add_f32 v[68:69], v[28:29], v[110:111] op_sel_hi:[1,0] neg_lo:[0,1] neg_hi:[0,1]
    v_pk_add_f32 v[70:71], v[30:31], v[110:111] op_sel_hi:[1,0] neg_lo:[0,1] neg_hi:[0,1]
    v_pk_add_f32 v[72:73], v[32:33], v[110:111] op_sel_hi:[1,0] neg_lo:[0,1] neg_hi:[0,1]
    v_pk_add_f32 v[74:75], v[34:35], v[110:111] op_sel_hi:[1,0] neg_lo:[0,1] neg_hi:[0,1]
    v_pk_add_f32 v[76:77], v[36:37], v[110:111] op_sel_hi:[1,0] neg_lo:[0,1] neg_hi:[0,1]
    v_pk_add_f32 v[78:79], v[38:39], v[110:111] op_sel_hi:[1,0] neg_lo:[0,1] neg_hi:[0,1]
    v_pk_add_f32 v[80:81], v[40:41], v[110:111] op_sel_hi:[1,0] neg_lo:[0,1] neg_hi:[0,1]
    v_pk_add_f32 v[82:83], v[42:43], v[110:111] op_sel_hi:[1,0] neg_lo:[0,1] neg_hi:[0,1]
    v_pk_add_f32 v[84:85], v[44:45], v[110:111] op_sel_hi:[1,0] neg_lo:[0,1] neg_hi:[0,1]
    v_pk_add_f32 v[86:87], v[46:47], v[110:111] op_sel_hi:[1,0] neg_lo:[0,1] neg_hi:[0,1]
    v_pk_mul_f32 v[68:69], v[68:69], v[188:189] op_sel_hi:[1,0]
    v_pk_mul_f32 v[70:71], v[70:71], v[188:189] op_sel_hi:[1,0]
    v_pk_mul_f32 v[72:73], v[72:73], v[188:189] op_sel_hi:[1,0]
    v_pk_mul_f32 v[74:75], v[74:75], v[188:189] op_sel_hi:[1,0]
    v_pk_mul_f32 v[76:77], v[76:77], v[188:189] op_sel_hi:[1,0]
    v_pk_mul_f32 v[78:79], v[78:79], v[188:189] op_sel_hi:[1,0]
    v_pk_mul_f32 v[80:81], v[80:81], v[188:189] op_sel_hi:[1,0]
    v_pk_mul_f32 v[82:83], v[82:83], v[188:189] op_sel_hi:[1,0]
    v_pk_mul_f32 v[84:85], v[84:85], v[188:189] op_sel_hi:[1,0]
    v_pk_mul_f32 v[86:87], v[86:87], v[188:189] op_sel_hi:[1,0]
    v_pk_mul_f32 v[68:69], v[68:69], v[48:49]
    v_pk_mul_f32 v[70:71], v[70:71], v[50:51]
    v_pk_mul_f32 v[72:73], v[72:73], v[52:53]
    v_pk_mul_f32 v[74:75], v[74:75], v[54:55]
    v_pk_mul_f32 v[76:77], v[76:77], v[56:57]
    v_pk_mul_f32 v[78:79], v[78:79], v[58:59]
    v_pk_mul_f32 v[80:81], v[80:81], v[60:61]
    v_pk_mul_f32 v[82:83], v[82:83], v[62:63]
    v_pk_mul_f32 v[84:85], v[84:85], v[64:65]
    v_pk_mul_f32 v[86:87], v[86:87], v[66:67]
    v_pk_fma_f32 v[68:69], v[68:69], v[8:9], v[28:29]
    v_pk_fma_f32 v[70:71], v[70:71], v[10:11], v[30:31]
    v_pk_fma_f32 v[72:73], v[72:73], v[12:13], v[32:33]
    v_pk_fma_f32 v[74:75], v[74:75], v[14:15], v[34:35]
    v_pk_fma_f32 v[76:77], v[76:77], v[16:17], v[36:37]
    v_pk_fma_f32 v[78:79], v[78:79], v[18:19], v[38:39]
    v_pk_fma_f32 v[80:81], v[80:81], v[20:21], v[40:41]
    v_pk_fma_f32 v[82:83], v[82:83], v[22:23], v[42:43]
    v_pk_fma_f32 v[84:85], v[84:85], v[24:25], v[44:45]
    v_pk_fma_f32 v[86:87], v[86:87], v[26:27], v[46:47]
    v_cvt_pk_bf16_f32 v136, v68, v69
    v_cvt_pk_bf16_f32 v137, v70, v71
    v_cvt_pk_bf16_f32 v138, v72, v73
    v_cvt_pk_bf16_f32 v139, v74, v75
    v_cvt_pk_bf16_f32 v140, v76, v77
    v_cvt_pk_bf16_f32 v141, v78, v79
    v_cvt_pk_bf16_f32 v142, v80, v81
    v_cvt_pk_bf16_f32 v143, v82, v83
    v_cvt_pk_bf16_f32 v144, v84, v85
    v_cvt_pk_bf16_f32 v145, v86, v87
    v_add_u32 v190, 143360, v184
    ds_write_b64 v190, v[136:137] offset:0
    ds_write_b64 v190, v[138:139] offset:32
    ds_write_b64 v190, v[140:141] offset:64
    ds_write_b64 v190, v[142:143] offset:96
    ds_write_b64 v190, v[144:145] offset:128
    s_mul_i32 s40, s34, 2560
    s_add_u32 s40, s40, 143360
    v_add_u32 v4, s40, v7
    s_waitcnt lgkmcnt(0)
    ds_read_b128 v[8:11], v4 offset:0
    ds_read_b128 v[12:15], v4 offset:1024
    ds_read_b128 v[16:19], v4 offset:2048
    s_mul_i32 s40, s34, 20480
    s_add_u32 s40, s40, s45
    s_waitcnt lgkmcnt(0)
    buffer_store_dwordx4 v[8:11], v104, s[16:19], s40 offen
    buffer_store_dwordx4 v[12:15], v105, s[16:19], s40 offen
    s_mov_b32 exec_hi, 0
    buffer_store_dwordx4 v[16:19], v106, s[16:19], s40 offen
    s_mov_b64 exec, -1
    s_endpgm
recurrent_scan__ssm_conv_h3__mixer_gmlp__prompt_kernel_conv:
    s_load_dwordx2 s[4:5], s[0:1], 32
    s_load_dwordx2 s[8:9], s[0:1], 104
    s_load_dwordx2 s[12:13], s[0:1], 40
    s_load_dwordx2 s[16:17], s[0:1], 64
    s_load_dwordx2 s[20:21], s[0:1], 80
    v_subrev_u32 v0, 256, v0
    s_setprio 0
    v_lshrrev_b32 v3, 6, v0
    v_and_b32 v1, 63, v0
    v_readfirstlane_b32 s34, v3
    s_mov_b32 s6, 2621440
    s_mov_b32 s7, 0x20000
    s_mov_b32 s10, 15990784
    s_mov_b32 s11, 0x20000
    s_mov_b32 s14, 1280
    s_mov_b32 s15, 0x20000
    s_mov_b32 s18, 8388608
    s_mov_b32 s19, 0x20000
    s_mov_b32 s22, 983040
    s_mov_b32 s23, 0x20000
    s_mov_b32 s32, s2
    v_lshlrev_b32 v2, 4, v0
    v_subrev_u32 v47, 16, v2
    s_mov_b32 s56, s2
    s_add_u32 s57, s2, 256
    s_lshr_b32 s58, s2, 1
    s_add_u32 s58, s58, 512
    s_waitcnt lgkmcnt(0)
    s_lshl_b32 s40, s56, 12
    buffer_load_dwordx4 v[12:15], v2, s[4:7], s40 offen
    buffer_load_dwordx4 v[8:11], v47, s[4:7], s40 offen
    s_lshl_b32 s41, s56, 1
    v_mov_b32 v3, 0
    buffer_load_ushort v44, v3, s[12:15], s41 offen
    s_lshr_b32 s47, s2, 3
    s_lshl_b32 s47, s47, 2
    s_add_u32 s47, s47, s34
    s_mul_i32 s40, s47, 12
    v_add_u32 v3, s40, v1
    v_mul_u32_u24 v4, 43691, v3
    v_lshrrev_b32 v4, 22, v4
    v_mul_u32_u24 v5, 96, v4
    v_sub_u32 v3, v3, v5
    v_mul_u32_u24 v4, 98304, v4
    v_lshl_add_u32 v57, v3, 7, v4
    s_and_b32 s40, s2, 7
    s_lshr_b32 s52, s40, 1
    s_lshl_b32 s52, s52, 21
    s_and_b32 s53, s40, 1
    s_mul_i32 s53, s53, 1572864
    s_add_u32 s53, s53, 0
    s_lshl_b32 s40, s47, 4
    v_add_u32 v3, s40, v1
    v_lshrrev_b32 v4, 2, v3
    v_lshlrev_b32 v4, 12, v4
    v_and_b32 v3, 3, v3
    v_lshl_add_u32 v56, v3, 10, v4
    s_cmp_ge_u32 s2, 192
    s_cbranch_scc1 c_wj_34
    s_mul_i32 s40, s2, 2731
    s_lshr_b32 s40, s40, 16
    s_mul_i32 s41, s40, 24
    s_sub_u32 s41, s2, s41
    s_mul_i32 s41, s41, 40960
    s_mul_i32 s40, s40, 160
    s_add_u32 s54, s40, s41
    v_mov_b32 v3, v0
    v_mul_u32_u24 v4, 6554, v3
    v_lshrrev_b32 v4, 16, v4
    v_mul_u32_u24 v5, 10, v4
    v_sub_u32 v3, v3, v5
    v_lshlrev_b32 v3, 4, v3
    v_mul_u32_u24 v4, 1280, v4
    v_add_u32 v3, v3, v4
    s_lshl_b32 s40, s34, 10
    s_add_u32 m0, s40, 156672
    s_nop 0
    buffer_load_dwordx4 v3, s[20:23], s54 offen lds
    s_cmp_lg_u32 s34, 0
    s_cbranch_scc1 c_wj2_35
    v_add_u32 v3, 256, v1
    v_mul_u32_u24 v4, 6554, v3
    v_lshrrev_b32 v4, 16, v4
    v_mul_u32_u24 v5, 10, v4
    v_sub_u32 v3, v3, v5
    v_lshlrev_b32 v3, 4, v3
    v_mul_u32_u24 v4, 1280, v4
    v_add_u32 v3, v3, v4
    s_mov_b32 m0, 160768
    s_nop 0
    buffer_load_dwordx4 v3, s[20:23], s54 offen lds
c_wj2_35:
c_wj_34:
    s_lshl_b32 s40, s57, 12
    buffer_load_dwordx4 v[20:23], v2, s[4:7], s40 offen
    buffer_load_dwordx4 v[16:19], v47, s[4:7], s40 offen
    s_lshl_b32 s41, s57, 1
    v_mov_b32 v3, 0
    buffer_load_ushort v45, v3, s[12:15], s41 offen
    s_lshl_b32 s40, s58, 12
    buffer_load_dwordx4 v[28:31], v2, s[4:7], s40 offen
    buffer_load_dwordx4 v[24:27], v47, s[4:7], s40 offen
    s_lshl_b32 s41, s58, 1
    v_mov_b32 v3, 0
    buffer_load_ushort v46, v3, s[12:15], s41 offen
    v_mov_b32 v60, 0
    v_mov_b32 v61, 0
    v_mov_b32 v62, 0
    v_mov_b32 v63, 0
    v_mul_u32_u24 v3, 4160, v0
    v_add_u32 v3, 86016, v3
    v_cmp_gt_u32 vcc, 64, v0
    s_nop 0
    s_and_saveexec_b64 s[50:51], vcc
    s_cbranch_execz c_z_36
    v_subrev_u32 v4, -118784, v2
    v_cmp_gt_u32 vcc, 8, v0
    s_nop 1
    v_cndmask_b32 v4, v4, v3, vcc
    v_add_u32 v5, -8, v0
    v_cmp_lt_u32 vcc, 23, v5
    s_nop 0
    s_and_b64 exec, exec, vcc
    ds_write_b128 v4, v[60:63]
c_z_36:
    s_mov_b64 exec, s[50:51]
    v_add_u32 v64, 86032, v2
    v_add_u32 v65, 119808, v2
    v_and_b32 v3, 7, v1
    v_mul_u32_u24 v3, 4160, v3
    v_bfe_u32 v4, v1, 3, 1
    v_lshrrev_b32 v5, 4, v1
    v_sub_u32 v4, v4, v5
    v_add_u32 v4, 3, v4
    v_lshl_add_u32 v66, v4, 4, v3
    v_add_u32 v66, 86016, v66
    v_and_b32 v3, 15, v1
    v_lshl_add_u32 v3, v3, 1, v5
    v_lshlrev_b32 v67, 4, v3
    v_add_u32 v67, 119296, v67
    v_and_b32 v3, 15, v1
    v_lshlrev_b32 v4, 3, v5
    v_sub_u32 v4, v4, v3
    v_add_u32 v4, -9, v4
    v_mov_b32 v72, 0xffff
    v_mov_b32 v73, 0xffff0000
    v_cmp_eq_u32 vcc, 0, v4
    s_nop 1
    v_cndmask_b32 v68, 0, v72, vcc
    v_cmp_eq_u32 vcc, 1, v4
    s_nop 1
    v_cndmask_b32 v68, v68, v73, vcc
    v_cmp_eq_u32 vcc, 2, v4
    s_nop 1
    v_cndmask_b32 v69, 0, v72, vcc
    v_cmp_eq_u32 vcc, 3, v4
    s_nop 1
    v_cndmask_b32 v69, v69, v73, vcc
    v_cmp_eq_u32 vcc, 4, v4
    s_nop 1
    v_cndmask_b32 v70, 0, v72, vcc
    v_cmp_eq_u32 vcc, 5, v4
    s_nop 1
    v_cndmask_b32 v70, v70, v73, vcc
    v_cmp_eq_u32 vcc, 6, v4
    s_nop 1
    v_cndmask_b32 v71, 0, v72, vcc
    v_cmp_eq_u32 vcc, 7, v4
    s_nop 1
    v_cndmask_b32 v71, v71, v73, vcc
    v_and_b32 v3, 15, v1
    v_lshlrev_b32 v3, 6, v3
    v_lshl_add_u32 v3, v5, 4, v3
    s_lshl_b32 s40, s34, 13
    s_add_u32 s40, s40, 123904
    v_add_u32 v74, s40, v3
    v_lshlrev_b32 v75, 5, v0
    v_add_u32 v75, 123904, v75
    s_waitcnt vmcnt(6)
    v_cmp_ne_u32 vcc, 0, v0
    s_nop 1
    v_cndmask_b32 v8, 0, v8, vcc
    v_cndmask_b32 v9, 0, v9, vcc
    v_cndmask_b32 v10, 0, v10, vcc
    v_cndmask_b32 v11, 0, v11, vcc
    v_alignbit_b32 v184, v9, v8, 16
    v_alignbit_b32 v185, v10, v9, 16
    v_alignbit_b32 v186, v11, v10, 16
    v_alignbit_b32 v187, v12, v11, 16
    v_alignbit_b32 v188, v13, v12, 16
    v_alignbit_b32 v189, v14, v13, 16
    v_alignbit_b32 v190, v15, v14, 16
    ds_write_b128 v64, v[184:187] offset:0
    v_mov_b32 v192, v9
    v_mov_b32 v193, v10
    v_mov_b32 v194, v11
    v_mov_b32 v195, v12
    ds_write_b128 v64, v[192:195] offset:4160
    s_nop 1
    v_mov_b32 v192, v185
    v_mov_b32 v193, v186
    v_mov_b32 v194, v187
    v_mov_b32 v195, v188
    ds_write_b128 v64, v[192:195] offset:8320
    s_nop 1
    ds_write_b128 v64, v[10:13] offset:12480
    ds_write_b128 v64, v[186:189] offset:16640
    v_mov_b32 v192, v11
    v_mov_b32 v193, v12
    v_mov_b32 v194, v13
    v_mov_b32 v195, v14
    ds_write_b128 v64, v[192:195] offset:20800
    s_nop 1
    v_mov_b32 v192, v187
    v_mov_b32 v193, v188
    v_mov_b32 v194, v189
    v_mov_b32 v195, v190
    ds_write_b128 v64, v[192:195] offset:24960
    s_nop 1
    ds_write_b128 v64, v[12:15] offset:29120
    v_mbcnt_lo_u32_b32 v3, -1, 0
    v_mbcnt_hi_u32_b32 v3, -1, v3
    v_lshlrev_b32 v3, 4, v3
    s_mov_b32 s66, 14716928
    s_mov_b32 s67, 0
fpoll_37:
    buffer_load_dwordx4 v[48:51], v3, s[8:11], s66 offen sc1
    buffer_load_dwordx4 v[52:55], v3, s[8:11], s66 offen offset:1024 sc1
    s_add_u32 s67, s67, 1
    s_waitcnt vmcnt(0)
    v_cmp_ne_u32 vcc, s100, v48
    v_cmp_ne_u32 s[64:65], s101, v49
    s_nop 0
    s_or_b64 vcc, vcc, s[64:65]
    v_cmp_ne_u32 s[64:65], s100, v50
    s_nop 0
    s_or_b64 vcc, vcc, s[64:65]
    v_cmp_ne_u32 s[64:65], s101, v51
    s_nop 0
    s_or_b64 vcc, vcc, s[64:65]
    v_cmp_ne_u32 s[64:65], s100, v52
    s_nop 0
    s_or_b64 vcc, vcc, s[64:65]
    v_cmp_ne_u32 s[64:65], s101, v53
    s_nop 0
    s_or_b64 vcc, vcc, s[64:65]
    v_cmp_ne_u32 s[64:65], s100, v54
    s_nop 0
    s_or_b64 vcc, vcc, s[64:65]
    v_cmp_ne_u32 s[64:65], s101, v55
    s_nop 0
    s_or_b64 vcc, vcc, s[64:65]
    s_cmp_gt_u32 s67, 100000
    s_cbranch_scc1 fpoll_e_38
    s_cmp_eq_u64 vcc, 0
    s_cbranch_scc1 fpoll_e_38
    s_sleep 2
    s_branch fpoll_37
fpoll_e_38:
    s_lshl_b32 s40, s56, 12
    s_add_u32 s40, s40, 6291456
    buffer_load_dwordx4 v[32:35], v2, s[8:11], s40 offen sc1
    s_lshl_b32 s40, s57, 12
    s_add_u32 s40, s40, 6291456
    buffer_load_dwordx4 v[36:39], v2, s[8:11], s40 offen sc1
    s_lshl_b32 s40, s58, 12
    s_add_u32 s40, s40, 6291456
    buffer_load_dwordx4 v[40:43], v2, s[8:11], s40 offen sc1
    s_waitcnt vmcnt(2)
    ds_write_b128 v65, v[32:35]
    v_lshlrev_b32 v3, 16, v44
    v_or_b32 v3, v3, v44
    v_and_b32 v196, v68, v3
    v_and_b32 v197, v69, v3
    v_and_b32 v198, v70, v3
    v_and_b32 v199, v71, v3
    s_waitcnt lgkmcnt(0)
    v_mov_b32 v3, 161796
    v_mov_b32 v4, 1
    s_mov_b64 exec, 1
    ds_add_u32 v3, v4
    s_mov_b64 exec, -1
    s_mov_b32 s67, 0
gsync_39:
    ds_read_b32 v4, v3
    s_add_u32 s67, s67, 1
    s_waitcnt lgkmcnt(0)
    v_readfirstlane_b32 s66, v4
    s_cmp_gt_u32 s67, 1000000
    s_cbranch_scc1 gsync_e_40
    s_cmp_lt_u32 s66, 4
    s_cbranch_scc1 gsync_39
gsync_e_40:
    s_cmp_lg_u32 s34, 0
    s_cbranch_scc1 c_pw_42
    ds_read_b128 v[108:111], v66 offset:0
    ds_read_b128 v[120:123], v67 offset:480
    ds_read_b128 v[124:127], v67 offset:992
    ds_read_b128 v[128:131], v67 offset:1504
    ds_read_b128 v[132:135], v67 offset:2016
    ds_read_b128 v[136:139], v67 offset:2528
    ds_read_b128 v[140:143], v67 offset:3040
    ds_read_b128 v[144:147], v67 offset:3552
    ds_read_b128 v[148:151], v67 offset:4064
    ds_read_b128 v[112:115], v66 offset:512
    ds_read_b128 v[116:119], v66 offset:1024
    s_waitcnt lgkmcnt(2)
    v_mfma_f32_16x16x32_bf16 v[104:107], v[108:111], v[148:151], 0
    v_mfma_f32_16x16x32_bf16 v[100:103], v[108:111], v[144:147], 0
    v_mfma_f32_16x16x32_bf16 v[96:99], v[108:111], v[140:143], 0
    v_mfma_f32_16x16x32_bf16 v[92:95], v[108:111], v[136:139], 0
    v_mfma_f32_16x16x32_bf16 v[88:91], v[108:111], v[132:135], 0
    v_mfma_f32_16x16x32_bf16 v[84:87], v[108:111], v[128:131], 0
    v_mfma_f32_16x16x32_bf16 v[80:83], v[108:111], v[124:127], 0
    v_mfma_f32_16x16x32_bf16 v[76:79], v[108:111], v[120:123], 0
    v_mfma_f32_16x16x32_bf16 v[76:79], v[196:199], v[120:123], v[76:79]
    v_mfma_f32_16x16x32_bf16 v[80:83], v[196:199], v[124:127], v[80:83]
    v_mfma_f32_16x16x32_bf16 v[84:87], v[196:199], v[128:131], v[84:87]
    v_mfma_f32_16x16x32_bf16 v[88:91], v[196:199], v[132:135], v[88:91]
    v_mfma_f32_16x16x32_bf16 v[92:95], v[196:199], v[136:139], v[92:95]
    v_mfma_f32_16x16x32_bf16 v[96:99], v[196:199], v[140:143], v[96:99]
    v_mfma_f32_16x16x32_bf16 v[100:103], v[196:199], v[144:147], v[100:103]
    v_mfma_f32_16x16x32_bf16 v[104:107], v[196:199], v[148:151], v[104:107]
    ds_read_b128 v[108:111], v66 offset:1536
    s_waitcnt lgkmcnt(2)
    v_mfma_f32_16x16x32_bf16 v[104:107], v[112:115], v[144:147], v[104:107]
    v_mfma_f32_16x16x32_bf16 v[100:103], v[112:115], v[140:143], v[100:103]
    v_mfma_f32_16x16x32_bf16 v[96:99], v[112:115], v[136:139], v[96:99]
    v_mfma_f32_16x16x32_bf16 v[92:95], v[112:115], v[132:135], v[92:95]
    v_mfma_f32_16x16x32_bf16 v[88:91], v[112:115], v[128:131], v[88:91]
    v_mfma_f32_16x16x32_bf16 v[84:87], v[112:115], v[124:127], v[84:87]
    v_mfma_f32_16x16x32_bf16 v[80:83], v[112:115], v[120:123], v[80:83]
    ds_read_b128 v[112:115], v66 offset:2048
    ds_read_b128 v[152:155], v67 offset:416
    ds_read_b128 v[156:159], v67 offset:928
    ds_read_b128 v[160:163], v67 offset:1440
    ds_read_b128 v[164:167], v67 offset:1952
    ds_read_b128 v[168:171], v67 offset:2464
    ds_read_b128 v[172:175], v67 offset:2976
    ds_read_b128 v[176:179], v67 offset:3488
    ds_read_b128 v[180:183], v67 offset:4000
    s_waitcnt lgkmcnt(10)
    v_mfma_f32_16x16x32_bf16 v[104:107], v[116:119], v[140:143], v[104:107]
    v_mfma_f32_16x16x32_bf16 v[100:103], v[116:119], v[136:139], v[100:103]
    v_mfma_f32_16x16x32_bf16 v[96:99], v[116:119], v[132:135], v[96:99]
    v_mfma_f32_16x16x32_bf16 v[92:95], v[116:119], v[128:131], v[92:95]
    v_mfma_f32_16x16x32_bf16 v[88:91], v[116:119], v[124:127], v[88:91]
    v_mfma_f32_16x16x32_bf16 v[84:87], v[116:119], v[120:123], v[84:87]
    ds_read_b128 v[116:119], v66 offset:2560
    s_waitcnt lgkmcnt(10)
    v_mfma_f32_16x16x32_bf16 v[104:107], v[108:111], v[136:139], v[104:107]
    v_mfma_f32_16x16x32_bf16 v[100:103], v[108:111], v[132:135], v[100:103]
    v_mfma_f32_16x16x32_bf16 v[96:99], v[108:111], v[128:131], v[96:99]
    v_mfma_f32_16x16x32_bf16 v[92:95], v[108:111], v[124:127], v[92:95]
    v_mfma_f32_16x16x32_bf16 v[88:91], v[108:111], v[120:123], v[88:91]
    ds_read_b128 v[108:111], v66 offset:3072
    s_waitcnt lgkmcnt(10)
    v_mfma_f32_16x16x32_bf16 v[104:107], v[112:115], v[132:135], v[104:107]
    v_mfma_f32_16x16x32_bf16 v[100:103], v[112:115], v[128:131], v[100:103]
    v_mfma_f32_16x16x32_bf16 v[96:99], v[112:115], v[124:127], v[96:99]
    v_mfma_f32_16x16x32_bf16 v[92:95], v[112:115], v[120:123], v[92:95]
    ds_read_b128 v[112:115], v66 offset:3584
    s_waitcnt lgkmcnt(2)
    v_mfma_f32_16x16x32_bf16 v[104:107], v[116:119], v[128:131], v[104:107]
    v_mfma_f32_16x16x32_bf16 v[100:103], v[116:119], v[124:127], v[100:103]
    v_mfma_f32_16x16x32_bf16 v[96:99], v[116:119], v[120:123], v[96:99]
    ds_read_b128 v[116:119], v66 offset:64
    s_waitcnt lgkmcnt(2)
    v_mfma_f32_16x16x32_bf16 v[104:107], v[108:111], v[124:127], v[104:107]
    v_mfma_f32_16x16x32_bf16 v[100:103], v[108:111], v[120:123], v[100:103]
    ds_read_b128 v[108:111], v66 offset:576
    s_waitcnt lgkmcnt(2)
    v_mfma_f32_16x16x32_bf16 v[104:107], v[112:115], v[120:123], v[104:107]
    ds_read_b128 v[112:115], v66 offset:1088
    s_waitcnt lgkmcnt(2)
    v_mfma_f32_16x16x32_bf16 v[104:107], v[116:119], v[180:183], v[104:107]
    v_mfma_f32_16x16x32_bf16 v[100:103], v[116:119], v[176:179], v[100:103]
    v_mfma_f32_16x16x32_bf16 v[96:99], v[116:119], v[172:175], v[96:99]
    v_mfma_f32_16x16x32_bf16 v[92:95], v[116:119], v[168:171], v[92:95]
    v_mfma_f32_16x16x32_bf16 v[88:91], v[116:119], v[164:167], v[88:91]
    v_mfma_f32_16x16x32_bf16 v[84:87], v[116:119], v[160:163], v[84:87]
    v_mfma_f32_16x16x32_bf16 v[80:83], v[116:119], v[156:159], v[80:83]
    v_mfma_f32_16x16x32_bf16 v[76:79], v[116:119], v[152:155], v[76:79]
    ds_read_b128 v[116:119], v66 offset:1600
    s_waitcnt lgkmcnt(2)
    v_mfma_f32_16x16x32_bf16 v[104:107], v[108:111], v[176:179], v[104:107]
    v_mfma_f32_16x16x32_bf16 v[100:103], v[108:111], v[172:175], v[100:103]
    v_mfma_f32_16x16x32_bf16 v[96:99], v[108:111], v[168:171], v[96:99]
    v_mfma_f32_16x16x32_bf16 v[92:95], v[108:111], v[164:167], v[92:95]
    v_mfma_f32_16x16x32_bf16 v[88:91], v[108:111], v[160:163], v[88:91]
    v_mfma_f32_16x16x32_bf16 v[84:87], v[108:111], v[156:159], v[84:87]
    v_mfma_f32_16x16x32_bf16 v[80:83], v[108:111], v[152:155], v[80:83]
    ds_read_b128 v[108:111], v66 offset:2112
    s_waitcnt lgkmcnt(2)
    v_mfma_f32_16x16x32_bf16 v[104:107], v[112:115], v[172:175], v[104:107]
    v_mfma_f32_16x16x32_bf16 v[100:103], v[112:115], v[168:171], v[100:103]
    v_mfma_f32_16x16x32_bf16 v[96:99], v[112:115], v[164:167], v[96:99]
    v_mfma_f32_16x16x32_bf16 v[92:95], v[112:115], v[160:163], v[92:95]
    v_mfma_f32_16x16x32_bf16 v[88:91], v[112:115], v[156:159], v[88:91]
    v_mfma_f32_16x16x32_bf16 v[84:87], v[112:115], v[152:155], v[84:87]
    ds_read_b128 v[112:115], v66 offset:2624
    s_waitcnt lgkmcnt(2)
    v_mfma_f32_16x16x32_bf16 v[104:107], v[116:119], v[168:171], v[104:107]
    v_mfma_f32_16x16x32_bf16 v[100:103], v[116:119], v[164:167], v[100:103]
    v_mfma_f32_16x16x32_bf16 v[96:99], v[116:119], v[160:163], v[96:99]
    v_mfma_f32_16x16x32_bf16 v[92:95], v[116:119], v[156:159], v[92:95]
    v_mfma_f32_16x16x32_bf16 v[88:91], v[116:119], v[152:155], v[88:91]
    ds_read_b128 v[116:119], v66 offset:3136
    s_waitcnt lgkmcnt(2)
    v_mfma_f32_16x16x32_bf16 v[104:107], v[108:111], v[164:167], v[104:107]
    v_mfma_f32_16x16x32_bf16 v[100:103], v[108:111], v[160:163], v[100:103]
    v_mfma_f32_16x16x32_bf16 v[96:99], v[108:111], v[156:159], v[96:99]
    v_mfma_f32_16x16x32_bf16 v[92:95], v[108:111], v[152:155], v[92:95]
    ds_read_b128 v[108:111], v66 offset:3648
    s_waitcnt lgkmcnt(2)
    v_mfma_f32_16x16x32_bf16 v[104:107], v[112:115], v[160:163], v[104:107]
    v_mfma_f32_16x16x32_bf16 v[100:103], v[112:115], v[156:159], v[100:103]
    v_mfma_f32_16x16x32_bf16 v[96:99], v[112:115], v[152:155], v[96:99]
    s_waitcnt lgkmcnt(1)
    v_mfma_f32_16x16x32_bf16 v[104:107], v[116:119], v[156:159], v[104:107]
    v_mfma_f32_16x16x32_bf16 v[100:103], v[116:119], v[152:155], v[100:103]
    s_waitcnt lgkmcnt(0)
    v_mfma_f32_16x16x32_bf16 v[104:107], v[108:111], v[152:155], v[104:107]
    ds_write_b128 v74, v[76:79] offset:0
    ds_write_b128 v74, v[80:83] offset:1024
    ds_write_b128 v74, v[84:87] offset:2048
    ds_write_b128 v74, v[88:91] offset:3072
    ds_write_b128 v74, v[92:95] offset:4096
    ds_write_b128 v74, v[96:99] offset:5120
    ds_write_b128 v74, v[100:103] offset:6144
    s_nop 0
    ds_write_b128 v74, v[104:107] offset:7168
    s_branch c_pw_end_41
c_pw_42:
    s_cmp_lg_u32 s34, 1
    s_cbranch_scc1 c_pw_43
    ds_read_b128 v[108:111], v66 offset:128
    ds_read_b128 v[120:123], v67 offset:352
    ds_read_b128 v[124:127], v67 offset:864
    ds_read_b128 v[128:131], v67 offset:1376
    ds_read_b128 v[132:135], v67 offset:1888
    ds_read_b128 v[136:139], v67 offset:2400
    ds_read_b128 v[140:143], v67 offset:2912
    ds_read_b128 v[144:147], v67 offset:3424
    ds_read_b128 v[148:151], v67 offset:3936
    ds_read_b128 v[112:115], v66 offset:640
    ds_read_b128 v[116:119], v66 offset:1152
    s_waitcnt lgkmcnt(2)
    v_mfma_f32_16x16x32_bf16 v[104:107], v[108:111], v[148:151], 0
    v_mfma_f32_16x16x32_bf16 v[100:103], v[108:111], v[144:147], 0
    v_mfma_f32_16x16x32_bf16 v[96:99], v[108:111], v[140:143], 0
    v_mfma_f32_16x16x32_bf16 v[92:95], v[108:111], v[136:139], 0
    v_mfma_f32_16x16x32_bf16 v[88:91], v[108:111], v[132:135], 0
    v_mfma_f32_16x16x32_bf16 v[84:87], v[108:111], v[128:131], 0
    v_mfma_f32_16x16x32_bf16 v[80:83], v[108:111], v[124:127], 0
    v_mfma_f32_16x16x32_bf16 v[76:79], v[108:111], v[120:123], 0
    ds_read_b128 v[108:111], v66 offset:1664
    s_waitcnt lgkmcnt(2)
    v_mfma_f32_16x16x32_bf16 v[104:107], v[112:115], v[144:147], v[104:107]
    v_mfma_f32_16x16x32_bf16 v[100:103], v[112:115], v[140:143], v[100:103]
    v_mfma_f32_16x16x32_bf16 v[96:99], v[112:115], v[136:139], v[96:99]
    v_mfma_f32_16x16x32_bf16 v[92:95], v[112:115], v[132:135], v[92:95]
    v_mfma_f32_16x16x32_bf16 v[88:91], v[112:115], v[128:131], v[88:91]
    v_mfma_f32_16x16x32_bf16 v[84:87], v[112:115], v[124:127], v[84:87]
    v_mfma_f32_16x16x32_bf16 v[80:83], v[112:115], v[120:123], v[80:83]
    ds_read_b128 v[112:115], v66 offset:2176
    ds_read_b128 v[152:155], v67 offset:288
    ds_read_b128 v[156:159], v67 offset:800
    ds_read_b128 v[160:163], v67 offset:1312
    ds_read_b128 v[164:167], v67 offset:1824
    ds_read_b128 v[168:171], v67 offset:2336
    ds_read_b128 v[172:175], v67 offset:2848
    ds_read_b128 v[176:179], v67 offset:3360
    ds_read_b128 v[180:183], v67 offset:3872
    s_waitcnt lgkmcnt(10)
    v_mfma_f32_16x16x32_bf16 v[104:107], v[116:119], v[140:143], v[104:107]
    v_mfma_f32_16x16x32_bf16 v[100:103], v[116:119], v[136:139], v[100:103]
    v_mfma_f32_16x16x32_bf16 v[96:99], v[116:119], v[132:135], v[96:99]
    v_mfma_f32_16x16x32_bf16 v[92:95], v[116:119], v[128:131], v[92:95]
    v_mfma_f32_16x16x32_bf16 v[88:91], v[116:119], v[124:127], v[88:91]
    v_mfma_f32_16x16x32_bf16 v[84:87], v[116:119], v[120:123], v[84:87]
    ds_read_b128 v[116:119], v66 offset:2688
    s_waitcnt lgkmcnt(10)
    v_mfma_f32_16x16x32_bf16 v[104:107], v[108:111], v[136:139], v[104:107]
    v_mfma_f32_16x16x32_bf16 v[100:103], v[108:111], v[132:135], v[100:103]
    v_mfma_f32_16x16x32_bf16 v[96:99], v[108:111], v[128:131], v[96:99]
    v_mfma_f32_16x16x32_bf16 v[92:95], v[108:111], v[124:127], v[92:95]
    v_mfma_f32_16x16x32_bf16 v[88:91], v[108:111], v[120:123], v[88:91]
    ds_read_b128 v[108:111], v66 offset:3200
    s_waitcnt lgkmcnt(10)
    v_mfma_f32_16x16x32_bf16 v[104:107], v[112:115], v[132:135], v[104:107]
    v_mfma_f32_16x16x32_bf16 v[100:103], v[112:115], v[128:131], v[100:103]
    v_mfma_f32_16x16x32_bf16 v[96:99], v[112:115], v[124:127], v[96:99]
    v_mfma_f32_16x16x32_bf16 v[92:95], v[112:115], v[120:123], v[92:95]
    ds_read_b128 v[112:115], v66 offset:3712
    s_waitcnt lgkmcnt(2)
    v_mfma_f32_16x16x32_bf16 v[104:107], v[116:119], v[128:131], v[104:107]
    v_mfma_f32_16x16x32_bf16 v[100:103], v[116:119], v[124:127], v[100:103]
    v_mfma_f32_16x16x32_bf16 v[96:99], v[116:119], v[120:123], v[96:99]
    ds_read_b128 v[116:119], v66 offset:192
    s_waitcnt lgkmcnt(2)
    v_mfma_f32_16x16x32_bf16 v[104:107], v[108:111], v[124:127], v[104:107]
    v_mfma_f32_16x16x32_bf16 v[100:103], v[108:111], v[120:123], v[100:103]
    ds_read_b128 v[108:111], v66 offset:704
    s_waitcnt lgkmcnt(2)
    v_mfma_f32_16x16x32_bf16 v[104:107], v[112:115], v[120:123], v[104:107]
    ds_read_b128 v[112:115], v66 offset:1216
    s_waitcnt lgkmcnt(2)
    v_mfma_f32_16x16x32_bf16 v[104:107], v[116:119], v[180:183], v[104:107]
    v_mfma_f32_16x16x32_bf16 v[100:103], v[116:119], v[176:179], v[100:103]
    v_mfma_f32_16x16x32_bf16 v[96:99], v[116:119], v[172:175], v[96:99]
    v_mfma_f32_16x16x32_bf16 v[92:95], v[116:119], v[168:171], v[92:95]
    v_mfma_f32_16x16x32_bf16 v[88:91], v[116:119], v[164:167], v[88:91]
    v_mfma_f32_16x16x32_bf16 v[84:87], v[116:119], v[160:163], v[84:87]
    v_mfma_f32_16x16x32_bf16 v[80:83], v[116:119], v[156:159], v[80:83]
    v_mfma_f32_16x16x32_bf16 v[76:79], v[116:119], v[152:155], v[76:79]
    ds_read_b128 v[116:119], v66 offset:1728
    s_waitcnt lgkmcnt(2)
    v_mfma_f32_16x16x32_bf16 v[104:107], v[108:111], v[176:179], v[104:107]
    v_mfma_f32_16x16x32_bf16 v[100:103], v[108:111], v[172:175], v[100:103]
    v_mfma_f32_16x16x32_bf16 v[96:99], v[108:111], v[168:171], v[96:99]
    v_mfma_f32_16x16x32_bf16 v[92:95], v[108:111], v[164:167], v[92:95]
    v_mfma_f32_16x16x32_bf16 v[88:91], v[108:111], v[160:163], v[88:91]
    v_mfma_f32_16x16x32_bf16 v[84:87], v[108:111], v[156:159], v[84:87]
    v_mfma_f32_16x16x32_bf16 v[80:83], v[108:111], v[152:155], v[80:83]
    ds_read_b128 v[108:111], v66 offset:2240
    s_waitcnt lgkmcnt(2)
    v_mfma_f32_16x16x32_bf16 v[104:107], v[112:115], v[172:175], v[104:107]
    v_mfma_f32_16x16x32_bf16 v[100:103], v[112:115], v[168:171], v[100:103]
    v_mfma_f32_16x16x32_bf16 v[96:99], v[112:115], v[164:167], v[96:99]
    v_mfma_f32_16x16x32_bf16 v[92:95], v[112:115], v[160:163], v[92:95]
    v_mfma_f32_16x16x32_bf16 v[88:91], v[112:115], v[156:159], v[88:91]
    v_mfma_f32_16x16x32_bf16 v[84:87], v[112:115], v[152:155], v[84:87]
    ds_read_b128 v[112:115], v66 offset:2752
    s_waitcnt lgkmcnt(2)
    v_mfma_f32_16x16x32_bf16 v[104:107], v[116:119], v[168:171], v[104:107]
    v_mfma_f32_16x16x32_bf16 v[100:103], v[116:119], v[164:167], v[100:103]
    v_mfma_f32_16x16x32_bf16 v[96:99], v[116:119], v[160:163], v[96:99]
    v_mfma_f32_16x16x32_bf16 v[92:95], v[116:119], v[156:159], v[92:95]
    v_mfma_f32_16x16x32_bf16 v[88:91], v[116:119], v[152:155], v[88:91]
    ds_read_b128 v[116:119], v66 offset:3264
    s_waitcnt lgkmcnt(2)
    v_mfma_f32_16x16x32_bf16 v[104:107], v[108:111], v[164:167], v[104:107]
    v_mfma_f32_16x16x32_bf16 v[100:103], v[108:111], v[160:163], v[100:103]
    v_mfma_f32_16x16x32_bf16 v[96:99], v[108:111], v[156:159], v[96:99]
    v_mfma_f32_16x16x32_bf16 v[92:95], v[108:111], v[152:155], v[92:95]
    ds_read_b128 v[108:111], v66 offset:3776
    s_waitcnt lgkmcnt(2)
    v_mfma_f32_16x16x32_bf16 v[104:107], v[112:115], v[160:163], v[104:107]
    v_mfma_f32_16x16x32_bf16 v[100:103], v[112:115], v[156:159], v[100:103]
    v_mfma_f32_16x16x32_bf16 v[96:99], v[112:115], v[152:155], v[96:99]
    s_waitcnt lgkmcnt(1)
    v_mfma_f32_16x16x32_bf16 v[104:107], v[116:119], v[156:159], v[104:107]
    v_mfma_f32_16x16x32_bf16 v[100:103], v[116:119], v[152:155], v[100:103]
    s_waitcnt lgkmcnt(0)
    v_mfma_f32_16x16x32_bf16 v[104:107], v[108:111], v[152:155], v[104:107]
    ds_write_b128 v74, v[76:79] offset:0
    ds_write_b128 v74, v[80:83] offset:1024
    ds_write_b128 v74, v[84:87] offset:2048
    ds_write_b128 v74, v[88:91] offset:3072
    ds_write_b128 v74, v[92:95] offset:4096
    ds_write_b128 v74, v[96:99] offset:5120
    ds_write_b128 v74, v[100:103] offset:6144
    s_nop 0
    ds_write_b128 v74, v[104:107] offset:7168
    s_branch c_pw_end_41
c_pw_43:
    s_cmp_lg_u32 s34, 2
    s_cbranch_scc1 c_pw_44
    ds_read_b128 v[108:111], v66 offset:256
    ds_read_b128 v[120:123], v67 offset:224
    ds_read_b128 v[124:127], v67 offset:736
    ds_read_b128 v[128:131], v67 offset:1248
    ds_read_b128 v[132:135], v67 offset:1760
    ds_read_b128 v[136:139], v67 offset:2272
    ds_read_b128 v[140:143], v67 offset:2784
    ds_read_b128 v[144:147], v67 offset:3296
    ds_read_b128 v[148:151], v67 offset:3808
    ds_read_b128 v[112:115], v66 offset:768
    ds_read_b128 v[116:119], v66 offset:1280
    s_waitcnt lgkmcnt(2)
    v_mfma_f32_16x16x32_bf16 v[104:107], v[108:111], v[148:151], 0
    v_mfma_f32_16x16x32_bf16 v[100:103], v[108:111], v[144:147], 0
    v_mfma_f32_16x16x32_bf16 v[96:99], v[108:111], v[140:143], 0
    v_mfma_f32_16x16x32_bf16 v[92:95], v[108:111], v[136:139], 0
    v_mfma_f32_16x16x32_bf16 v[88:91], v[108:111], v[132:135], 0
    v_mfma_f32_16x16x32_bf16 v[84:87], v[108:111], v[128:131], 0
    v_mfma_f32_16x16x32_bf16 v[80:83], v[108:111], v[124:127], 0
    v_mfma_f32_16x16x32_bf16 v[76:79], v[108:111], v[120:123], 0
    ds_read_b128 v[108:111], v66 offset:1792
    s_waitcnt lgkmcnt(2)
    v_mfma_f32_16x16x32_bf16 v[104:107], v[112:115], v[144:147], v[104:107]
    v_mfma_f32_16x16x32_bf16 v[100:103], v[112:115], v[140:143], v[100:103]
    v_mfma_f32_16x16x32_bf16 v[96:99], v[112:115], v[136:139], v[96:99]
    v_mfma_f32_16x16x32_bf16 v[92:95], v[112:115], v[132:135], v[92:95]
    v_mfma_f32_16x16x32_bf16 v[88:91], v[112:115], v[128:131], v[88:91]
    v_mfma_f32_16x16x32_bf16 v[84:87], v[112:115], v[124:127], v[84:87]
    v_mfma_f32_16x16x32_bf16 v[80:83], v[112:115], v[120:123], v[80:83]
    ds_read_b128 v[112:115], v66 offset:2304
    ds_read_b128 v[152:155], v67 offset:160
    ds_read_b128 v[156:159], v67 offset:672
    ds_read_b128 v[160:163], v67 offset:1184
    ds_read_b128 v[164:167], v67 offset:1696
    ds_read_b128 v[168:171], v67 offset:2208
    ds_read_b128 v[172:175], v67 offset:2720
    ds_read_b128 v[176:179], v67 offset:3232
    ds_read_b128 v[180:183], v67 offset:3744
    s_waitcnt lgkmcnt(10)
    v_mfma_f32_16x16x32_bf16 v[104:107], v[116:119], v[140:143], v[104:107]
    v_mfma_f32_16x16x32_bf16 v[100:103], v[116:119], v[136:139], v[100:103]
    v_mfma_f32_16x16x32_bf16 v[96:99], v[116:119], v[132:135], v[96:99]
    v_mfma_f32_16x16x32_bf16 v[92:95], v[116:119], v[128:131], v[92:95]
    v_mfma_f32_16x16x32_bf16 v[88:91], v[116:119], v[124:127], v[88:91]
    v_mfma_f32_16x16x32_bf16 v[84:87], v[116:119], v[120:123], v[84:87]
    ds_read_b128 v[116:119], v66 offset:2816
    s_waitcnt lgkmcnt(10)
    v_mfma_f32_16x16x32_bf16 v[104:107], v[108:111], v[136:139], v[104:107]
    v_mfma_f32_16x16x32_bf16 v[100:103], v[108:111], v[132:135], v[100:103]
    v_mfma_f32_16x16x32_bf16 v[96:99], v[108:111], v[128:131], v[96:99]
    v_mfma_f32_16x16x32_bf16 v[92:95], v[108:111], v[124:127], v[92:95]
    v_mfma_f32_16x16x32_bf16 v[88:91], v[108:111], v[120:123], v[88:91]
    ds_read_b128 v[108:111], v66 offset:3328
    s_waitcnt lgkmcnt(10)
    v_mfma_f32_16x16x32_bf16 v[104:107], v[112:115], v[132:135], v[104:107]
    v_mfma_f32_16x16x32_bf16 v[100:103], v[112:115], v[128:131], v[100:103]
    v_mfma_f32_16x16x32_bf16 v[96:99], v[112:115], v[124:127], v[96:99]
    v_mfma_f32_16x16x32_bf16 v[92:95], v[112:115], v[120:123], v[92:95]
    ds_read_b128 v[112:115], v66 offset:3840
    s_waitcnt lgkmcnt(2)
    v_mfma_f32_16x16x32_bf16 v[104:107], v[116:119], v[128:131], v[104:107]
    v_mfma_f32_16x16x32_bf16 v[100:103], v[116:119], v[124:127], v[100:103]
    v_mfma_f32_16x16x32_bf16 v[96:99], v[116:119], v[120:123], v[96:99]
    ds_read_b128 v[116:119], v66 offset:320
    s_waitcnt lgkmcnt(2)
    v_mfma_f32_16x16x32_bf16 v[104:107], v[108:111], v[124:127], v[104:107]
    v_mfma_f32_16x16x32_bf16 v[100:103], v[108:111], v[120:123], v[100:103]
    ds_read_b128 v[108:111], v66 offset:832
    s_waitcnt lgkmcnt(2)
    v_mfma_f32_16x16x32_bf16 v[104:107], v[112:115], v[120:123], v[104:107]
    ds_read_b128 v[112:115], v66 offset:1344
    s_waitcnt lgkmcnt(2)
    v_mfma_f32_16x16x32_bf16 v[104:107], v[116:119], v[180:183], v[104:107]
    v_mfma_f32_16x16x32_bf16 v[100:103], v[116:119], v[176:179], v[100:103]
    v_mfma_f32_16x16x32_bf16 v[96:99], v[116:119], v[172:175], v[96:99]
    v_mfma_f32_16x16x32_bf16 v[92:95], v[116:119], v[168:171], v[92:95]
    v_mfma_f32_16x16x32_bf16 v[88:91], v[116:119], v[164:167], v[88:91]
    v_mfma_f32_16x16x32_bf16 v[84:87], v[116:119], v[160:163], v[84:87]
    v_mfma_f32_16x16x32_bf16 v[80:83], v[116:119], v[156:159], v[80:83]
    v_mfma_f32_16x16x32_bf16 v[76:79], v[116:119], v[152:155], v[76:79]
    ds_read_b128 v[116:119], v66 offset:1856
    s_waitcnt lgkmcnt(2)
    v_mfma_f32_16x16x32_bf16 v[104:107], v[108:111], v[176:179], v[104:107]
    v_mfma_f32_16x16x32_bf16 v[100:103], v[108:111], v[172:175], v[100:103]
    v_mfma_f32_16x16x32_bf16 v[96:99], v[108:111], v[168:171], v[96:99]
    v_mfma_f32_16x16x32_bf16 v[92:95], v[108:111], v[164:167], v[92:95]
    v_mfma_f32_16x16x32_bf16 v[88:91], v[108:111], v[160:163], v[88:91]
    v_mfma_f32_16x16x32_bf16 v[84:87], v[108:111], v[156:159], v[84:87]
    v_mfma_f32_16x16x32_bf16 v[80:83], v[108:111], v[152:155], v[80:83]
    ds_read_b128 v[108:111], v66 offset:2368
    s_waitcnt lgkmcnt(2)
    v_mfma_f32_16x16x32_bf16 v[104:107], v[112:115], v[172:175], v[104:107]
    v_mfma_f32_16x16x32_bf16 v[100:103], v[112:115], v[168:171], v[100:103]
    v_mfma_f32_16x16x32_bf16 v[96:99], v[112:115], v[164:167], v[96:99]
    v_mfma_f32_16x16x32_bf16 v[92:95], v[112:115], v[160:163], v[92:95]
    v_mfma_f32_16x16x32_bf16 v[88:91], v[112:115], v[156:159], v[88:91]
    v_mfma_f32_16x16x32_bf16 v[84:87], v[112:115], v[152:155], v[84:87]
    ds_read_b128 v[112:115], v66 offset:2880
    s_waitcnt lgkmcnt(2)
    v_mfma_f32_16x16x32_bf16 v[104:107], v[116:119], v[168:171], v[104:107]
    v_mfma_f32_16x16x32_bf16 v[100:103], v[116:119], v[164:167], v[100:103]
    v_mfma_f32_16x16x32_bf16 v[96:99], v[116:119], v[160:163], v[96:99]
    v_mfma_f32_16x16x32_bf16 v[92:95], v[116:119], v[156:159], v[92:95]
    v_mfma_f32_16x16x32_bf16 v[88:91], v[116:119], v[152:155], v[88:91]
    ds_read_b128 v[116:119], v66 offset:3392
    s_waitcnt lgkmcnt(2)
    v_mfma_f32_16x16x32_bf16 v[104:107], v[108:111], v[164:167], v[104:107]
    v_mfma_f32_16x16x32_bf16 v[100:103], v[108:111], v[160:163], v[100:103]
    v_mfma_f32_16x16x32_bf16 v[96:99], v[108:111], v[156:159], v[96:99]
    v_mfma_f32_16x16x32_bf16 v[92:95], v[108:111], v[152:155], v[92:95]
    ds_read_b128 v[108:111], v66 offset:3904
    s_waitcnt lgkmcnt(2)
    v_mfma_f32_16x16x32_bf16 v[104:107], v[112:115], v[160:163], v[104:107]
    v_mfma_f32_16x16x32_bf16 v[100:103], v[112:115], v[156:159], v[100:103]
    v_mfma_f32_16x16x32_bf16 v[96:99], v[112:115], v[152:155], v[96:99]
    s_waitcnt lgkmcnt(1)
    v_mfma_f32_16x16x32_bf16 v[104:107], v[116:119], v[156:159], v[104:107]
    v_mfma_f32_16x16x32_bf16 v[100:103], v[116:119], v[152:155], v[100:103]
    s_waitcnt lgkmcnt(0)
    v_mfma_f32_16x16x32_bf16 v[104:107], v[108:111], v[152:155], v[104:107]
    ds_write_b128 v74, v[76:79] offset:0
    ds_write_b128 v74, v[80:83] offset:1024
    ds_write_b128 v74, v[84:87] offset:2048
    ds_write_b128 v74, v[88:91] offset:3072
    ds_write_b128 v74, v[92:95] offset:4096
    ds_write_b128 v74, v[96:99] offset:5120
    ds_write_b128 v74, v[100:103] offset:6144
    s_nop 0
    ds_write_b128 v74, v[104:107] offset:7168
    s_branch c_pw_end_41
c_pw_44:
    ds_read_b128 v[108:111], v66 offset:384
    ds_read_b128 v[120:123], v67 offset:96
    ds_read_b128 v[124:127], v67 offset:608
    ds_read_b128 v[128:131], v67 offset:1120
    ds_read_b128 v[132:135], v67 offset:1632
    ds_read_b128 v[136:139], v67 offset:2144
    ds_read_b128 v[140:143], v67 offset:2656
    ds_read_b128 v[144:147], v67 offset:3168
    ds_read_b128 v[148:151], v67 offset:3680
    ds_read_b128 v[112:115], v66 offset:896
    ds_read_b128 v[116:119], v66 offset:1408
    s_waitcnt lgkmcnt(2)
    v_mfma_f32_16x16x32_bf16 v[104:107], v[108:111], v[148:151], 0
    v_mfma_f32_16x16x32_bf16 v[100:103], v[108:111], v[144:147], 0
    v_mfma_f32_16x16x32_bf16 v[96:99], v[108:111], v[140:143], 0
    v_mfma_f32_16x16x32_bf16 v[92:95], v[108:111], v[136:139], 0
    v_mfma_f32_16x16x32_bf16 v[88:91], v[108:111], v[132:135], 0
    v_mfma_f32_16x16x32_bf16 v[84:87], v[108:111], v[128:131], 0
    v_mfma_f32_16x16x32_bf16 v[80:83], v[108:111], v[124:127], 0
    v_mfma_f32_16x16x32_bf16 v[76:79], v[108:111], v[120:123], 0
    ds_read_b128 v[108:111], v66 offset:1920
    s_waitcnt lgkmcnt(2)
    v_mfma_f32_16x16x32_bf16 v[104:107], v[112:115], v[144:147], v[104:107]
    v_mfma_f32_16x16x32_bf16 v[100:103], v[112:115], v[140:143], v[100:103]
    v_mfma_f32_16x16x32_bf16 v[96:99], v[112:115], v[136:139], v[96:99]
    v_mfma_f32_16x16x32_bf16 v[92:95], v[112:115], v[132:135], v[92:95]
    v_mfma_f32_16x16x32_bf16 v[88:91], v[112:115], v[128:131], v[88:91]
    v_mfma_f32_16x16x32_bf16 v[84:87], v[112:115], v[124:127], v[84:87]
    v_mfma_f32_16x16x32_bf16 v[80:83], v[112:115], v[120:123], v[80:83]
    ds_read_b128 v[112:115], v66 offset:2432
    ds_read_b128 v[152:155], v67 offset:32
    ds_read_b128 v[156:159], v67 offset:544
    ds_read_b128 v[160:163], v67 offset:1056
    ds_read_b128 v[164:167], v67 offset:1568
    ds_read_b128 v[168:171], v67 offset:2080
    ds_read_b128 v[172:175], v67 offset:2592
    ds_read_b128 v[176:179], v67 offset:3104
    ds_read_b128 v[180:183], v67 offset:3616
    s_waitcnt lgkmcnt(10)
    v_mfma_f32_16x16x32_bf16 v[104:107], v[116:119], v[140:143], v[104:107]
    v_mfma_f32_16x16x32_bf16 v[100:103], v[116:119], v[136:139], v[100:103]
    v_mfma_f32_16x16x32_bf16 v[96:99], v[116:119], v[132:135], v[96:99]
    v_mfma_f32_16x16x32_bf16 v[92:95], v[116:119], v[128:131], v[92:95]
    v_mfma_f32_16x16x32_bf16 v[88:91], v[116:119], v[124:127], v[88:91]
    v_mfma_f32_16x16x32_bf16 v[84:87], v[116:119], v[120:123], v[84:87]
    ds_read_b128 v[116:119], v66 offset:2944
    s_waitcnt lgkmcnt(10)
    v_mfma_f32_16x16x32_bf16 v[104:107], v[108:111], v[136:139], v[104:107]
    v_mfma_f32_16x16x32_bf16 v[100:103], v[108:111], v[132:135], v[100:103]
    v_mfma_f32_16x16x32_bf16 v[96:99], v[108:111], v[128:131], v[96:99]
    v_mfma_f32_16x16x32_bf16 v[92:95], v[108:111], v[124:127], v[92:95]
    v_mfma_f32_16x16x32_bf16 v[88:91], v[108:111], v[120:123], v[88:91]
    ds_read_b128 v[108:111], v66 offset:3456
    s_waitcnt lgkmcnt(10)
    v_mfma_f32_16x16x32_bf16 v[104:107], v[112:115], v[132:135], v[104:107]
    v_mfma_f32_16x16x32_bf16 v[100:103], v[112:115], v[128:131], v[100:103]
    v_mfma_f32_16x16x32_bf16 v[96:99], v[112:115], v[124:127], v[96:99]
    v_mfma_f32_16x16x32_bf16 v[92:95], v[112:115], v[120:123], v[92:95]
    ds_read_b128 v[112:115], v66 offset:3968
    s_waitcnt lgkmcnt(2)
    v_mfma_f32_16x16x32_bf16 v[104:107], v[116:119], v[128:131], v[104:107]
    v_mfma_f32_16x16x32_bf16 v[100:103], v[116:119], v[124:127], v[100:103]
    v_mfma_f32_16x16x32_bf16 v[96:99], v[116:119], v[120:123], v[96:99]
    ds_read_b128 v[116:119], v66 offset:448
    s_waitcnt lgkmcnt(2)
    v_mfma_f32_16x16x32_bf16 v[104:107], v[108:111], v[124:127], v[104:107]
    v_mfma_f32_16x16x32_bf16 v[100:103], v[108:111], v[120:123], v[100:103]
    ds_read_b128 v[108:111], v66 offset:960
    s_waitcnt lgkmcnt(2)
    v_mfma_f32_16x16x32_bf16 v[104:107], v[112:115], v[120:123], v[104:107]
    ds_read_b128 v[112:115], v66 offset:1472
    s_waitcnt lgkmcnt(2)
    v_mfma_f32_16x16x32_bf16 v[104:107], v[116:119], v[180:183], v[104:107]
    v_mfma_f32_16x16x32_bf16 v[100:103], v[116:119], v[176:179], v[100:103]
    v_mfma_f32_16x16x32_bf16 v[96:99], v[116:119], v[172:175], v[96:99]
    v_mfma_f32_16x16x32_bf16 v[92:95], v[116:119], v[168:171], v[92:95]
    v_mfma_f32_16x16x32_bf16 v[88:91], v[116:119], v[164:167], v[88:91]
    v_mfma_f32_16x16x32_bf16 v[84:87], v[116:119], v[160:163], v[84:87]
    v_mfma_f32_16x16x32_bf16 v[80:83], v[116:119], v[156:159], v[80:83]
    v_mfma_f32_16x16x32_bf16 v[76:79], v[116:119], v[152:155], v[76:79]
    ds_read_b128 v[116:119], v66 offset:1984
    s_waitcnt lgkmcnt(2)
    v_mfma_f32_16x16x32_bf16 v[104:107], v[108:111], v[176:179], v[104:107]
    v_mfma_f32_16x16x32_bf16 v[100:103], v[108:111], v[172:175], v[100:103]
    v_mfma_f32_16x16x32_bf16 v[96:99], v[108:111], v[168:171], v[96:99]
    v_mfma_f32_16x16x32_bf16 v[92:95], v[108:111], v[164:167], v[92:95]
    v_mfma_f32_16x16x32_bf16 v[88:91], v[108:111], v[160:163], v[88:91]
    v_mfma_f32_16x16x32_bf16 v[84:87], v[108:111], v[156:159], v[84:87]
    v_mfma_f32_16x16x32_bf16 v[80:83], v[108:111], v[152:155], v[80:83]
    ds_read_b128 v[108:111], v66 offset:2496
    s_waitcnt lgkmcnt(2)
    v_mfma_f32_16x16x32_bf16 v[104:107], v[112:115], v[172:175], v[104:107]
    v_mfma_f32_16x16x32_bf16 v[100:103], v[112:115], v[168:171], v[100:103]
    v_mfma_f32_16x16x32_bf16 v[96:99], v[112:115], v[164:167], v[96:99]
    v_mfma_f32_16x16x32_bf16 v[92:95], v[112:115], v[160:163], v[92:95]
    v_mfma_f32_16x16x32_bf16 v[88:91], v[112:115], v[156:159], v[88:91]
    v_mfma_f32_16x16x32_bf16 v[84:87], v[112:115], v[152:155], v[84:87]
    ds_read_b128 v[112:115], v66 offset:3008
    s_waitcnt lgkmcnt(2)
    v_mfma_f32_16x16x32_bf16 v[104:107], v[116:119], v[168:171], v[104:107]
    v_mfma_f32_16x16x32_bf16 v[100:103], v[116:119], v[164:167], v[100:103]
    v_mfma_f32_16x16x32_bf16 v[96:99], v[116:119], v[160:163], v[96:99]
    v_mfma_f32_16x16x32_bf16 v[92:95], v[116:119], v[156:159], v[92:95]
    v_mfma_f32_16x16x32_bf16 v[88:91], v[116:119], v[152:155], v[88:91]
    ds_read_b128 v[116:119], v66 offset:3520
    s_waitcnt lgkmcnt(2)
    v_mfma_f32_16x16x32_bf16 v[104:107], v[108:111], v[164:167], v[104:107]
    v_mfma_f32_16x16x32_bf16 v[100:103], v[108:111], v[160:163], v[100:103]
    v_mfma_f32_16x16x32_bf16 v[96:99], v[108:111], v[156:159], v[96:99]
    v_mfma_f32_16x16x32_bf16 v[92:95], v[108:111], v[152:155], v[92:95]
    ds_read_b128 v[108:111], v66 offset:4032
    s_waitcnt lgkmcnt(2)
    v_mfma_f32_16x16x32_bf16 v[104:107], v[112:115], v[160:163], v[104:107]
    v_mfma_f32_16x16x32_bf16 v[100:103], v[112:115], v[156:159], v[100:103]
    v_mfma_f32_16x16x32_bf16 v[96:99], v[112:115], v[152:155], v[96:99]
    s_waitcnt lgkmcnt(1)
    v_mfma_f32_16x16x32_bf16 v[104:107], v[116:119], v[156:159], v[104:107]
    v_mfma_f32_16x16x32_bf16 v[100:103], v[116:119], v[152:155], v[100:103]
    s_waitcnt lgkmcnt(0)
    v_mfma_f32_16x16x32_bf16 v[104:107], v[108:111], v[152:155], v[104:107]
    ds_write_b128 v74, v[76:79] offset:0
    ds_write_b128 v74, v[80:83] offset:1024
    ds_write_b128 v74, v[84:87] offset:2048
    ds_write_b128 v74, v[88:91] offset:3072
    ds_write_b128 v74, v[92:95] offset:4096
    ds_write_b128 v74, v[96:99] offset:5120
    ds_write_b128 v74, v[100:103] offset:6144
    s_nop 0
    ds_write_b128 v74, v[104:107] offset:7168
c_pw_end_41:
    s_waitcnt lgkmcnt(0)
    v_mov_b32 v3, 161796
    v_mov_b32 v4, 1
    s_mov_b64 exec, 1
    ds_add_u32 v3, v4
    s_mov_b64 exec, -1
    s_mov_b32 s67, 0
gsync_46:
    ds_read_b32 v4, v3
    s_add_u32 s67, s67, 1
    s_waitcnt lgkmcnt(0)
    v_readfirstlane_b32 s66, v4
    s_cmp_gt_u32 s67, 1000000
    s_cbranch_scc1 gsync_e_47
    s_cmp_lt_u32 s66, 8
    s_cbranch_scc1 gsync_46
gsync_e_47:
    ds_read_b128 v[120:123], v75 offset:0
    ds_read_b128 v[124:127], v75 offset:16
    ds_read_b128 v[128:131], v75 offset:8192
    ds_read_b128 v[132:135], v75 offset:8208
    ds_read_b128 v[136:139], v75 offset:16384
    ds_read_b128 v[140:143], v75 offset:16400
    ds_read_b128 v[144:147], v75 offset:24576
    ds_read_b128 v[148:151], v75 offset:24592
    s_lshl_b32 s40, s56, 12
    s_add_u32 s40, s40, 8912896
    s_waitcnt lgkmcnt(0)
    v_pk_add_f32 v[120:121], v[120:121], v[128:129]
    v_pk_add_f32 v[136:137], v[136:137], v[144:145]
    v_pk_add_f32 v[122:123], v[122:123], v[130:131]
    v_pk_add_f32 v[138:139], v[138:139], v[146:147]
    v_pk_add_f32 v[124:125], v[124:125], v[132:133]
    v_pk_add_f32 v[140:141], v[140:141], v[148:149]
    v_pk_add_f32 v[126:127], v[126:127], v[134:135]
    v_pk_add_f32 v[142:143], v[142:143], v[150:151]
    v_pk_add_f32 v[120:121], v[120:121], v[136:137]
    v_pk_add_f32 v[122:123], v[122:123], v[138:139]
    v_pk_add_f32 v[124:125], v[124:125], v[140:141]
    v_pk_add_f32 v[126:127], v[126:127], v[142:143]
    v_cvt_pk_bf16_f32 v192, v120, v121
    v_cvt_pk_bf16_f32 v193, v122, v123
    v_cvt_pk_bf16_f32 v194, v124, v125
    v_cvt_pk_bf16_f32 v195, v126, v127
    buffer_store_dwordx4 v[192:195], v2, s[8:11], s40 offen sc1
    s_nop 1
    s_waitcnt vmcnt(1)
    v_cmp_ne_u32 vcc, 0, v0
    s_nop 1
    v_cndmask_b32 v16, 0, v16, vcc
    v_cndmask_b32 v17, 0, v17, vcc
    v_cndmask_b32 v18, 0, v18, vcc
    v_cndmask_b32 v19, 0, v19, vcc
    v_alignbit_b32 v184, v17, v16, 16
    v_alignbit_b32 v185, v18, v17, 16
    v_alignbit_b32 v186, v19, v18, 16
    v_alignbit_b32 v187, v20, v19, 16
    v_alignbit_b32 v188, v21, v20, 16
    v_alignbit_b32 v189, v22, v21, 16
    v_alignbit_b32 v190, v23, v22, 16
    ds_write_b128 v64, v[184:187] offset:0
    v_mov_b32 v192, v17
    v_mov_b32 v193, v18
    v_mov_b32 v194, v19
    v_mov_b32 v195, v20
    ds_write_b128 v64, v[192:195] offset:4160
    s_nop 1
    v_mov_b32 v192, v185
    v_mov_b32 v193, v186
    v_mov_b32 v194, v187
    v_mov_b32 v195, v188
    ds_write_b128 v64, v[192:195] offset:8320
    s_nop 1
    ds_write_b128 v64, v[18:21] offset:12480
    ds_write_b128 v64, v[186:189] offset:16640
    v_mov_b32 v192, v19
    v_mov_b32 v193, v20
    v_mov_b32 v194, v21
    v_mov_b32 v195, v22
    ds_write_b128 v64, v[192:195] offset:20800
    s_nop 1
    v_mov_b32 v192, v187
    v_mov_b32 v193, v188
    v_mov_b32 v194, v189
    v_mov_b32 v195, v190
    ds_write_b128 v64, v[192:195] offset:24960
    s_nop 1
    ds_write_b128 v64, v[20:23] offset:29120
    ds_write_b128 v65, v[36:39]
    v_lshlrev_b32 v3, 16, v45
    v_or_b32 v3, v3, v45
    v_and_b32 v196, v68, v3
    v_and_b32 v197, v69, v3
    v_and_b32 v198, v70, v3
    v_and_b32 v199, v71, v3
    s_waitcnt lgkmcnt(0)
    v_mov_b32 v3, 161796
    v_mov_b32 v4, 1
    s_mov_b64 exec, 1
    ds_add_u32 v3, v4
    s_mov_b64 exec, -1
    s_mov_b32 s67, 0
gsync_48:
    ds_read_b32 v4, v3
    s_add_u32 s67, s67, 1
    s_waitcnt lgkmcnt(0)
    v_readfirstlane_b32 s66, v4
    s_cmp_gt_u32 s67, 1000000
    s_cbranch_scc1 gsync_e_49
    s_cmp_lt_u32 s66, 12
    s_cbranch_scc1 gsync_48
gsync_e_49:
    s_cmp_ge_u32 s2, 192
    s_cbranch_scc1 c_wj3_50
    v_lshrrev_b32 v3, 4, v1
    v_and_b32 v5, 15, v1
    v_lshrrev_b32 v4, 2, v5
    v_lshl_add_u32 v3, v3, 2, v4
    v_mul_u32_u24 v3, 160, v3
    v_and_b32 v4, 3, v5
    v_lshl_add_u32 v3, v4, 3, v3
    v_lshlrev_b32 v5, 4, v1
    s_lshl_b32 s40, s34, 5
    s_add_u32 s41, s40, 156672
    v_add_u32 v4, s41, v3
    ds_read_b64_tr_b16 v[192:193], v4
    ds_read_b64_tr_b16 v[194:195], v4 offset:2560
    s_mul_i32 s41, s2, 5120
    s_lshl_b32 s40, s40, 5
    s_add_u32 s41, s41, s40
    s_add_u32 s41, s41, 15007744
    s_waitcnt lgkmcnt(0)
    buffer_store_dwordx4 v[192:195], v5, s[8:11], s41 offen sc1
    s_nop 1
    s_cmp_lg_u32 s34, 0
    s_cbranch_scc1 c_wj4_51
    s_mov_b32 s40, 128
    s_add_u32 s41, s40, 156672
    v_add_u32 v4, s41, v3
    ds_read_b64_tr_b16 v[192:193], v4
    ds_read_b64_tr_b16 v[194:195], v4 offset:2560
    s_mul_i32 s41, s2, 5120
    s_lshl_b32 s40, s40, 5
    s_add_u32 s41, s41, s40
    s_add_u32 s41, s41, 15007744
    s_waitcnt lgkmcnt(0)
    buffer_store_dwordx4 v[192:195], v5, s[8:11], s41 offen sc1
    s_nop 1
c_wj4_51:
c_wj3_50:
    s_cmp_lg_u32 s34, 0
    s_cbranch_scc1 c_pw_53
    ds_read_b128 v[108:111], v66 offset:0
    ds_read_b128 v[120:123], v67 offset:480
    ds_read_b128 v[124:127], v67 offset:992
    ds_read_b128 v[128:131], v67 offset:1504
    ds_read_b128 v[132:135], v67 offset:2016
    ds_read_b128 v[136:139], v67 offset:2528
    ds_read_b128 v[140:143], v67 offset:3040
    ds_read_b128 v[144:147], v67 offset:3552
    ds_read_b128 v[148:151], v67 offset:4064
    ds_read_b128 v[112:115], v66 offset:512
    ds_read_b128 v[116:119], v66 offset:1024
    s_waitcnt lgkmcnt(2)
    v_mfma_f32_16x16x32_bf16 v[104:107], v[108:111], v[148:151], 0
    v_mfma_f32_16x16x32_bf16 v[100:103], v[108:111], v[144:147], 0
    v_mfma_f32_16x16x32_bf16 v[96:99], v[108:111], v[140:143], 0
    v_mfma_f32_16x16x32_bf16 v[92:95], v[108:111], v[136:139], 0
    v_mfma_f32_16x16x32_bf16 v[88:91], v[108:111], v[132:135], 0
    v_mfma_f32_16x16x32_bf16 v[84:87], v[108:111], v[128:131], 0
    v_mfma_f32_16x16x32_bf16 v[80:83], v[108:111], v[124:127], 0
    v_mfma_f32_16x16x32_bf16 v[76:79], v[108:111], v[120:123], 0
    v_mfma_f32_16x16x32_bf16 v[76:79], v[196:199], v[120:123], v[76:79]
    v_mfma_f32_16x16x32_bf16 v[80:83], v[196:199], v[124:127], v[80:83]
    v_mfma_f32_16x16x32_bf16 v[84:87], v[196:199], v[128:131], v[84:87]
    v_mfma_f32_16x16x32_bf16 v[88:91], v[196:199], v[132:135], v[88:91]
    v_mfma_f32_16x16x32_bf16 v[92:95], v[196:199], v[136:139], v[92:95]
    v_mfma_f32_16x16x32_bf16 v[96:99], v[196:199], v[140:143], v[96:99]
    v_mfma_f32_16x16x32_bf16 v[100:103], v[196:199], v[144:147], v[100:103]
    v_mfma_f32_16x16x32_bf16 v[104:107], v[196:199], v[148:151], v[104:107]
    ds_read_b128 v[108:111], v66 offset:1536
    s_waitcnt lgkmcnt(2)
    v_mfma_f32_16x16x32_bf16 v[104:107], v[112:115], v[144:147], v[104:107]
    v_mfma_f32_16x16x32_bf16 v[100:103], v[112:115], v[140:143], v[100:103]
    v_mfma_f32_16x16x32_bf16 v[96:99], v[112:115], v[136:139], v[96:99]
    v_mfma_f32_16x16x32_bf16 v[92:95], v[112:115], v[132:135], v[92:95]
    v_mfma_f32_16x16x32_bf16 v[88:91], v[112:115], v[128:131], v[88:91]
    v_mfma_f32_16x16x32_bf16 v[84:87], v[112:115], v[124:127], v[84:87]
    v_mfma_f32_16x16x32_bf16 v[80:83], v[112:115], v[120:123], v[80:83]
    ds_read_b128 v[112:115], v66 offset:2048
    ds_read_b128 v[152:155], v67 offset:416
    ds_read_b128 v[156:159], v67 offset:928
    ds_read_b128 v[160:163], v67 offset:1440
    ds_read_b128 v[164:167], v67 offset:1952
    ds_read_b128 v[168:171], v67 offset:2464
    ds_read_b128 v[172:175], v67 offset:2976
    ds_read_b128 v[176:179], v67 offset:3488
    ds_read_b128 v[180:183], v67 offset:4000
    s_waitcnt lgkmcnt(10)
    v_mfma_f32_16x16x32_bf16 v[104:107], v[116:119], v[140:143], v[104:107]
    v_mfma_f32_16x16x32_bf16 v[100:103], v[116:119], v[136:139], v[100:103]
    v_mfma_f32_16x16x32_bf16 v[96:99], v[116:119], v[132:135], v[96:99]
    v_mfma_f32_16x16x32_bf16 v[92:95], v[116:119], v[128:131], v[92:95]
    v_mfma_f32_16x16x32_bf16 v[88:91], v[116:119], v[124:127], v[88:91]
    v_mfma_f32_16x16x32_bf16 v[84:87], v[116:119], v[120:123], v[84:87]
    ds_read_b128 v[116:119], v66 offset:2560
    s_waitcnt lgkmcnt(10)
    v_mfma_f32_16x16x32_bf16 v[104:107], v[108:111], v[136:139], v[104:107]
    v_mfma_f32_16x16x32_bf16 v[100:103], v[108:111], v[132:135], v[100:103]
    v_mfma_f32_16x16x32_bf16 v[96:99], v[108:111], v[128:131], v[96:99]
    v_mfma_f32_16x16x32_bf16 v[92:95], v[108:111], v[124:127], v[92:95]
    v_mfma_f32_16x16x32_bf16 v[88:91], v[108:111], v[120:123], v[88:91]
    ds_read_b128 v[108:111], v66 offset:3072
    s_waitcnt lgkmcnt(10)
    v_mfma_f32_16x16x32_bf16 v[104:107], v[112:115], v[132:135], v[104:107]
    v_mfma_f32_16x16x32_bf16 v[100:103], v[112:115], v[128:131], v[100:103]
    v_mfma_f32_16x16x32_bf16 v[96:99], v[112:115], v[124:127], v[96:99]
    v_mfma_f32_16x16x32_bf16 v[92:95], v[112:115], v[120:123], v[92:95]
    ds_read_b128 v[112:115], v66 offset:3584
    s_waitcnt lgkmcnt(2)
    v_mfma_f32_16x16x32_bf16 v[104:107], v[116:119], v[128:131], v[104:107]
    v_mfma_f32_16x16x32_bf16 v[100:103], v[116:119], v[124:127], v[100:103]
    v_mfma_f32_16x16x32_bf16 v[96:99], v[116:119], v[120:123], v[96:99]
    ds_read_b128 v[116:119], v66 offset:64
    s_waitcnt lgkmcnt(2)
    v_mfma_f32_16x16x32_bf16 v[104:107], v[108:111], v[124:127], v[104:107]
    v_mfma_f32_16x16x32_bf16 v[100:103], v[108:111], v[120:123], v[100:103]
    ds_read_b128 v[108:111], v66 offset:576
    s_waitcnt lgkmcnt(2)
    v_mfma_f32_16x16x32_bf16 v[104:107], v[112:115], v[120:123], v[104:107]
    ds_read_b128 v[112:115], v66 offset:1088
    s_waitcnt lgkmcnt(2)
    v_mfma_f32_16x16x32_bf16 v[104:107], v[116:119], v[180:183], v[104:107]
    v_mfma_f32_16x16x32_bf16 v[100:103], v[116:119], v[176:179], v[100:103]
    v_mfma_f32_16x16x32_bf16 v[96:99], v[116:119], v[172:175], v[96:99]
    v_mfma_f32_16x16x32_bf16 v[92:95], v[116:119], v[168:171], v[92:95]
    v_mfma_f32_16x16x32_bf16 v[88:91], v[116:119], v[164:167], v[88:91]
    v_mfma_f32_16x16x32_bf16 v[84:87], v[116:119], v[160:163], v[84:87]
    v_mfma_f32_16x16x32_bf16 v[80:83], v[116:119], v[156:159], v[80:83]
    v_mfma_f32_16x16x32_bf16 v[76:79], v[116:119], v[152:155], v[76:79]
    ds_read_b128 v[116:119], v66 offset:1600
    s_waitcnt lgkmcnt(2)
    v_mfma_f32_16x16x32_bf16 v[104:107], v[108:111], v[176:179], v[104:107]
    v_mfma_f32_16x16x32_bf16 v[100:103], v[108:111], v[172:175], v[100:103]
    v_mfma_f32_16x16x32_bf16 v[96:99], v[108:111], v[168:171], v[96:99]
    v_mfma_f32_16x16x32_bf16 v[92:95], v[108:111], v[164:167], v[92:95]
    v_mfma_f32_16x16x32_bf16 v[88:91], v[108:111], v[160:163], v[88:91]
    v_mfma_f32_16x16x32_bf16 v[84:87], v[108:111], v[156:159], v[84:87]
    v_mfma_f32_16x16x32_bf16 v[80:83], v[108:111], v[152:155], v[80:83]
    ds_read_b128 v[108:111], v66 offset:2112
    s_waitcnt lgkmcnt(2)
    v_mfma_f32_16x16x32_bf16 v[104:107], v[112:115], v[172:175], v[104:107]
    v_mfma_f32_16x16x32_bf16 v[100:103], v[112:115], v[168:171], v[100:103]
    v_mfma_f32_16x16x32_bf16 v[96:99], v[112:115], v[164:167], v[96:99]
    v_mfma_f32_16x16x32_bf16 v[92:95], v[112:115], v[160:163], v[92:95]
    v_mfma_f32_16x16x32_bf16 v[88:91], v[112:115], v[156:159], v[88:91]
    v_mfma_f32_16x16x32_bf16 v[84:87], v[112:115], v[152:155], v[84:87]
    ds_read_b128 v[112:115], v66 offset:2624
    s_waitcnt lgkmcnt(2)
    v_mfma_f32_16x16x32_bf16 v[104:107], v[116:119], v[168:171], v[104:107]
    v_mfma_f32_16x16x32_bf16 v[100:103], v[116:119], v[164:167], v[100:103]
    v_mfma_f32_16x16x32_bf16 v[96:99], v[116:119], v[160:163], v[96:99]
    v_mfma_f32_16x16x32_bf16 v[92:95], v[116:119], v[156:159], v[92:95]
    v_mfma_f32_16x16x32_bf16 v[88:91], v[116:119], v[152:155], v[88:91]
    ds_read_b128 v[116:119], v66 offset:3136
    s_waitcnt lgkmcnt(2)
    v_mfma_f32_16x16x32_bf16 v[104:107], v[108:111], v[164:167], v[104:107]
    v_mfma_f32_16x16x32_bf16 v[100:103], v[108:111], v[160:163], v[100:103]
    v_mfma_f32_16x16x32_bf16 v[96:99], v[108:111], v[156:159], v[96:99]
    v_mfma_f32_16x16x32_bf16 v[92:95], v[108:111], v[152:155], v[92:95]
    ds_read_b128 v[108:111], v66 offset:3648
    s_waitcnt lgkmcnt(2)
    v_mfma_f32_16x16x32_bf16 v[104:107], v[112:115], v[160:163], v[104:107]
    v_mfma_f32_16x16x32_bf16 v[100:103], v[112:115], v[156:159], v[100:103]
    v_mfma_f32_16x16x32_bf16 v[96:99], v[112:115], v[152:155], v[96:99]
    s_waitcnt lgkmcnt(1)
    v_mfma_f32_16x16x32_bf16 v[104:107], v[116:119], v[156:159], v[104:107]
    v_mfma_f32_16x16x32_bf16 v[100:103], v[116:119], v[152:155], v[100:103]
    s_waitcnt lgkmcnt(0)
    v_mfma_f32_16x16x32_bf16 v[104:107], v[108:111], v[152:155], v[104:107]
    ds_write_b128 v74, v[76:79] offset:0
    ds_write_b128 v74, v[80:83] offset:1024
    ds_write_b128 v74, v[84:87] offset:2048
    ds_write_b128 v74, v[88:91] offset:3072
    ds_write_b128 v74, v[92:95] offset:4096
    ds_write_b128 v74, v[96:99] offset:5120
    ds_write_b128 v74, v[100:103] offset:6144
    s_nop 0
    ds_write_b128 v74, v[104:107] offset:7168
    s_branch c_pw_end_52
c_pw_53:
    s_cmp_lg_u32 s34, 1
    s_cbranch_scc1 c_pw_54
    ds_read_b128 v[108:111], v66 offset:128
    ds_read_b128 v[120:123], v67 offset:352
    ds_read_b128 v[124:127], v67 offset:864
    ds_read_b128 v[128:131], v67 offset:1376
    ds_read_b128 v[132:135], v67 offset:1888
    ds_read_b128 v[136:139], v67 offset:2400
    ds_read_b128 v[140:143], v67 offset:2912
    ds_read_b128 v[144:147], v67 offset:3424
    ds_read_b128 v[148:151], v67 offset:3936
    ds_read_b128 v[112:115], v66 offset:640
    ds_read_b128 v[116:119], v66 offset:1152
    s_waitcnt lgkmcnt(2)
    v_mfma_f32_16x16x32_bf16 v[104:107], v[108:111], v[148:151], 0
    v_mfma_f32_16x16x32_bf16 v[100:103], v[108:111], v[144:147], 0
    v_mfma_f32_16x16x32_bf16 v[96:99], v[108:111], v[140:143], 0
    v_mfma_f32_16x16x32_bf16 v[92:95], v[108:111], v[136:139], 0
    v_mfma_f32_16x16x32_bf16 v[88:91], v[108:111], v[132:135], 0
    v_mfma_f32_16x16x32_bf16 v[84:87], v[108:111], v[128:131], 0
    v_mfma_f32_16x16x32_bf16 v[80:83], v[108:111], v[124:127], 0
    v_mfma_f32_16x16x32_bf16 v[76:79], v[108:111], v[120:123], 0
    ds_read_b128 v[108:111], v66 offset:1664
    s_waitcnt lgkmcnt(2)
    v_mfma_f32_16x16x32_bf16 v[104:107], v[112:115], v[144:147], v[104:107]
    v_mfma_f32_16x16x32_bf16 v[100:103], v[112:115], v[140:143], v[100:103]
    v_mfma_f32_16x16x32_bf16 v[96:99], v[112:115], v[136:139], v[96:99]
    v_mfma_f32_16x16x32_bf16 v[92:95], v[112:115], v[132:135], v[92:95]
    v_mfma_f32_16x16x32_bf16 v[88:91], v[112:115], v[128:131], v[88:91]
    v_mfma_f32_16x16x32_bf16 v[84:87], v[112:115], v[124:127], v[84:87]
    v_mfma_f32_16x16x32_bf16 v[80:83], v[112:115], v[120:123], v[80:83]
    ds_read_b128 v[112:115], v66 offset:2176
    ds_read_b128 v[152:155], v67 offset:288
    ds_read_b128 v[156:159], v67 offset:800
    ds_read_b128 v[160:163], v67 offset:1312
    ds_read_b128 v[164:167], v67 offset:1824
    ds_read_b128 v[168:171], v67 offset:2336
    ds_read_b128 v[172:175], v67 offset:2848
    ds_read_b128 v[176:179], v67 offset:3360
    ds_read_b128 v[180:183], v67 offset:3872
    s_waitcnt lgkmcnt(10)
    v_mfma_f32_16x16x32_bf16 v[104:107], v[116:119], v[140:143], v[104:107]
    v_mfma_f32_16x16x32_bf16 v[100:103], v[116:119], v[136:139], v[100:103]
    v_mfma_f32_16x16x32_bf16 v[96:99], v[116:119], v[132:135], v[96:99]
    v_mfma_f32_16x16x32_bf16 v[92:95], v[116:119], v[128:131], v[92:95]
    v_mfma_f32_16x16x32_bf16 v[88:91], v[116:119], v[124:127], v[88:91]
    v_mfma_f32_16x16x32_bf16 v[84:87], v[116:119], v[120:123], v[84:87]
    ds_read_b128 v[116:119], v66 offset:2688
    s_waitcnt lgkmcnt(10)
    v_mfma_f32_16x16x32_bf16 v[104:107], v[108:111], v[136:139], v[104:107]
    v_mfma_f32_16x16x32_bf16 v[100:103], v[108:111], v[132:135], v[100:103]
    v_mfma_f32_16x16x32_bf16 v[96:99], v[108:111], v[128:131], v[96:99]
    v_mfma_f32_16x16x32_bf16 v[92:95], v[108:111], v[124:127], v[92:95]
    v_mfma_f32_16x16x32_bf16 v[88:91], v[108:111], v[120:123], v[88:91]
    ds_read_b128 v[108:111], v66 offset:3200
    s_waitcnt lgkmcnt(10)
    v_mfma_f32_16x16x32_bf16 v[104:107], v[112:115], v[132:135], v[104:107]
    v_mfma_f32_16x16x32_bf16 v[100:103], v[112:115], v[128:131], v[100:103]
    v_mfma_f32_16x16x32_bf16 v[96:99], v[112:115], v[124:127], v[96:99]
    v_mfma_f32_16x16x32_bf16 v[92:95], v[112:115], v[120:123], v[92:95]
    ds_read_b128 v[112:115], v66 offset:3712
    s_waitcnt lgkmcnt(2)
    v_mfma_f32_16x16x32_bf16 v[104:107], v[116:119], v[128:131], v[104:107]
    v_mfma_f32_16x16x32_bf16 v[100:103], v[116:119], v[124:127], v[100:103]
    v_mfma_f32_16x16x32_bf16 v[96:99], v[116:119], v[120:123], v[96:99]
    ds_read_b128 v[116:119], v66 offset:192
    s_waitcnt lgkmcnt(2)
    v_mfma_f32_16x16x32_bf16 v[104:107], v[108:111], v[124:127], v[104:107]
    v_mfma_f32_16x16x32_bf16 v[100:103], v[108:111], v[120:123], v[100:103]
    ds_read_b128 v[108:111], v66 offset:704
    s_waitcnt lgkmcnt(2)
    v_mfma_f32_16x16x32_bf16 v[104:107], v[112:115], v[120:123], v[104:107]
    ds_read_b128 v[112:115], v66 offset:1216
    s_waitcnt lgkmcnt(2)
    v_mfma_f32_16x16x32_bf16 v[104:107], v[116:119], v[180:183], v[104:107]
    v_mfma_f32_16x16x32_bf16 v[100:103], v[116:119], v[176:179], v[100:103]
    v_mfma_f32_16x16x32_bf16 v[96:99], v[116:119], v[172:175], v[96:99]
    v_mfma_f32_16x16x32_bf16 v[92:95], v[116:119], v[168:171], v[92:95]
    v_mfma_f32_16x16x32_bf16 v[88:91], v[116:119], v[164:167], v[88:91]
    v_mfma_f32_16x16x32_bf16 v[84:87], v[116:119], v[160:163], v[84:87]
    v_mfma_f32_16x16x32_bf16 v[80:83], v[116:119], v[156:159], v[80:83]
    v_mfma_f32_16x16x32_bf16 v[76:79], v[116:119], v[152:155], v[76:79]
    ds_read_b128 v[116:119], v66 offset:1728
    s_waitcnt lgkmcnt(2)
    v_mfma_f32_16x16x32_bf16 v[104:107], v[108:111], v[176:179], v[104:107]
    v_mfma_f32_16x16x32_bf16 v[100:103], v[108:111], v[172:175], v[100:103]
    v_mfma_f32_16x16x32_bf16 v[96:99], v[108:111], v[168:171], v[96:99]
    v_mfma_f32_16x16x32_bf16 v[92:95], v[108:111], v[164:167], v[92:95]
    v_mfma_f32_16x16x32_bf16 v[88:91], v[108:111], v[160:163], v[88:91]
    v_mfma_f32_16x16x32_bf16 v[84:87], v[108:111], v[156:159], v[84:87]
    v_mfma_f32_16x16x32_bf16 v[80:83], v[108:111], v[152:155], v[80:83]
    ds_read_b128 v[108:111], v66 offset:2240
    s_waitcnt lgkmcnt(2)
    v_mfma_f32_16x16x32_bf16 v[104:107], v[112:115], v[172:175], v[104:107]
    v_mfma_f32_16x16x32_bf16 v[100:103], v[112:115], v[168:171], v[100:103]
    v_mfma_f32_16x16x32_bf16 v[96:99], v[112:115], v[164:167], v[96:99]
    v_mfma_f32_16x16x32_bf16 v[92:95], v[112:115], v[160:163], v[92:95]
    v_mfma_f32_16x16x32_bf16 v[88:91], v[112:115], v[156:159], v[88:91]
    v_mfma_f32_16x16x32_bf16 v[84:87], v[112:115], v[152:155], v[84:87]
    ds_read_b128 v[112:115], v66 offset:2752
    s_waitcnt lgkmcnt(2)
    v_mfma_f32_16x16x32_bf16 v[104:107], v[116:119], v[168:171], v[104:107]
    v_mfma_f32_16x16x32_bf16 v[100:103], v[116:119], v[164:167], v[100:103]
    v_mfma_f32_16x16x32_bf16 v[96:99], v[116:119], v[160:163], v[96:99]
    v_mfma_f32_16x16x32_bf16 v[92:95], v[116:119], v[156:159], v[92:95]
    v_mfma_f32_16x16x32_bf16 v[88:91], v[116:119], v[152:155], v[88:91]
    ds_read_b128 v[116:119], v66 offset:3264
    s_waitcnt lgkmcnt(2)
    v_mfma_f32_16x16x32_bf16 v[104:107], v[108:111], v[164:167], v[104:107]
    v_mfma_f32_16x16x32_bf16 v[100:103], v[108:111], v[160:163], v[100:103]
    v_mfma_f32_16x16x32_bf16 v[96:99], v[108:111], v[156:159], v[96:99]
    v_mfma_f32_16x16x32_bf16 v[92:95], v[108:111], v[152:155], v[92:95]
    ds_read_b128 v[108:111], v66 offset:3776
    s_waitcnt lgkmcnt(2)
    v_mfma_f32_16x16x32_bf16 v[104:107], v[112:115], v[160:163], v[104:107]
    v_mfma_f32_16x16x32_bf16 v[100:103], v[112:115], v[156:159], v[100:103]
    v_mfma_f32_16x16x32_bf16 v[96:99], v[112:115], v[152:155], v[96:99]
    s_waitcnt lgkmcnt(1)
    v_mfma_f32_16x16x32_bf16 v[104:107], v[116:119], v[156:159], v[104:107]
    v_mfma_f32_16x16x32_bf16 v[100:103], v[116:119], v[152:155], v[100:103]
    s_waitcnt lgkmcnt(0)
    v_mfma_f32_16x16x32_bf16 v[104:107], v[108:111], v[152:155], v[104:107]
    ds_write_b128 v74, v[76:79] offset:0
    ds_write_b128 v74, v[80:83] offset:1024
    ds_write_b128 v74, v[84:87] offset:2048
    ds_write_b128 v74, v[88:91] offset:3072
    ds_write_b128 v74, v[92:95] offset:4096
    ds_write_b128 v74, v[96:99] offset:5120
    ds_write_b128 v74, v[100:103] offset:6144
    s_nop 0
    ds_write_b128 v74, v[104:107] offset:7168
    s_branch c_pw_end_52
c_pw_54:
    s_cmp_lg_u32 s34, 2
    s_cbranch_scc1 c_pw_55
    ds_read_b128 v[108:111], v66 offset:256
    ds_read_b128 v[120:123], v67 offset:224
    ds_read_b128 v[124:127], v67 offset:736
    ds_read_b128 v[128:131], v67 offset:1248
    ds_read_b128 v[132:135], v67 offset:1760
    ds_read_b128 v[136:139], v67 offset:2272
    ds_read_b128 v[140:143], v67 offset:2784
    ds_read_b128 v[144:147], v67 offset:3296
    ds_read_b128 v[148:151], v67 offset:3808
    ds_read_b128 v[112:115], v66 offset:768
    ds_read_b128 v[116:119], v66 offset:1280
    s_waitcnt lgkmcnt(2)
    v_mfma_f32_16x16x32_bf16 v[104:107], v[108:111], v[148:151], 0
    v_mfma_f32_16x16x32_bf16 v[100:103], v[108:111], v[144:147], 0
    v_mfma_f32_16x16x32_bf16 v[96:99], v[108:111], v[140:143], 0
    v_mfma_f32_16x16x32_bf16 v[92:95], v[108:111], v[136:139], 0
    v_mfma_f32_16x16x32_bf16 v[88:91], v[108:111], v[132:135], 0
    v_mfma_f32_16x16x32_bf16 v[84:87], v[108:111], v[128:131], 0
    v_mfma_f32_16x16x32_bf16 v[80:83], v[108:111], v[124:127], 0
    v_mfma_f32_16x16x32_bf16 v[76:79], v[108:111], v[120:123], 0
    ds_read_b128 v[108:111], v66 offset:1792
    s_waitcnt lgkmcnt(2)
    v_mfma_f32_16x16x32_bf16 v[104:107], v[112:115], v[144:147], v[104:107]
    v_mfma_f32_16x16x32_bf16 v[100:103], v[112:115], v[140:143], v[100:103]
    v_mfma_f32_16x16x32_bf16 v[96:99], v[112:115], v[136:139], v[96:99]
    v_mfma_f32_16x16x32_bf16 v[92:95], v[112:115], v[132:135], v[92:95]
    v_mfma_f32_16x16x32_bf16 v[88:91], v[112:115], v[128:131], v[88:91]
    v_mfma_f32_16x16x32_bf16 v[84:87], v[112:115], v[124:127], v[84:87]
    v_mfma_f32_16x16x32_bf16 v[80:83], v[112:115], v[120:123], v[80:83]
    ds_read_b128 v[112:115], v66 offset:2304
    ds_read_b128 v[152:155], v67 offset:160
    ds_read_b128 v[156:159], v67 offset:672
    ds_read_b128 v[160:163], v67 offset:1184
    ds_read_b128 v[164:167], v67 offset:1696
    ds_read_b128 v[168:171], v67 offset:2208
    ds_read_b128 v[172:175], v67 offset:2720
    ds_read_b128 v[176:179], v67 offset:3232
    ds_read_b128 v[180:183], v67 offset:3744
    s_waitcnt lgkmcnt(10)
    v_mfma_f32_16x16x32_bf16 v[104:107], v[116:119], v[140:143], v[104:107]
    v_mfma_f32_16x16x32_bf16 v[100:103], v[116:119], v[136:139], v[100:103]
    v_mfma_f32_16x16x32_bf16 v[96:99], v[116:119], v[132:135], v[96:99]
    v_mfma_f32_16x16x32_bf16 v[92:95], v[116:119], v[128:131], v[92:95]
    v_mfma_f32_16x16x32_bf16 v[88:91], v[116:119], v[124:127], v[88:91]
    v_mfma_f32_16x16x32_bf16 v[84:87], v[116:119], v[120:123], v[84:87]
    ds_read_b128 v[116:119], v66 offset:2816
    s_waitcnt lgkmcnt(10)
    v_mfma_f32_16x16x32_bf16 v[104:107], v[108:111], v[136:139], v[104:107]
    v_mfma_f32_16x16x32_bf16 v[100:103], v[108:111], v[132:135], v[100:103]
    v_mfma_f32_16x16x32_bf16 v[96:99], v[108:111], v[128:131], v[96:99]
    v_mfma_f32_16x16x32_bf16 v[92:95], v[108:111], v[124:127], v[92:95]
    v_mfma_f32_16x16x32_bf16 v[88:91], v[108:111], v[120:123], v[88:91]
    ds_read_b128 v[108:111], v66 offset:3328
    s_waitcnt lgkmcnt(10)
    v_mfma_f32_16x16x32_bf16 v[104:107], v[112:115], v[132:135], v[104:107]
    v_mfma_f32_16x16x32_bf16 v[100:103], v[112:115], v[128:131], v[100:103]
    v_mfma_f32_16x16x32_bf16 v[96:99], v[112:115], v[124:127], v[96:99]
    v_mfma_f32_16x16x32_bf16 v[92:95], v[112:115], v[120:123], v[92:95]
    ds_read_b128 v[112:115], v66 offset:3840
    s_waitcnt lgkmcnt(2)
    v_mfma_f32_16x16x32_bf16 v[104:107], v[116:119], v[128:131], v[104:107]
    v_mfma_f32_16x16x32_bf16 v[100:103], v[116:119], v[124:127], v[100:103]
    v_mfma_f32_16x16x32_bf16 v[96:99], v[116:119], v[120:123], v[96:99]
    ds_read_b128 v[116:119], v66 offset:320
    s_waitcnt lgkmcnt(2)
    v_mfma_f32_16x16x32_bf16 v[104:107], v[108:111], v[124:127], v[104:107]
    v_mfma_f32_16x16x32_bf16 v[100:103], v[108:111], v[120:123], v[100:103]
    ds_read_b128 v[108:111], v66 offset:832
    s_waitcnt lgkmcnt(2)
    v_mfma_f32_16x16x32_bf16 v[104:107], v[112:115], v[120:123], v[104:107]
    ds_read_b128 v[112:115], v66 offset:1344
    s_waitcnt lgkmcnt(2)
    v_mfma_f32_16x16x32_bf16 v[104:107], v[116:119], v[180:183], v[104:107]
    v_mfma_f32_16x16x32_bf16 v[100:103], v[116:119], v[176:179], v[100:103]
    v_mfma_f32_16x16x32_bf16 v[96:99], v[116:119], v[172:175], v[96:99]
    v_mfma_f32_16x16x32_bf16 v[92:95], v[116:119], v[168:171], v[92:95]
    v_mfma_f32_16x16x32_bf16 v[88:91], v[116:119], v[164:167], v[88:91]
    v_mfma_f32_16x16x32_bf16 v[84:87], v[116:119], v[160:163], v[84:87]
    v_mfma_f32_16x16x32_bf16 v[80:83], v[116:119], v[156:159], v[80:83]
    v_mfma_f32_16x16x32_bf16 v[76:79], v[116:119], v[152:155], v[76:79]
    ds_read_b128 v[116:119], v66 offset:1856
    s_waitcnt lgkmcnt(2)
    v_mfma_f32_16x16x32_bf16 v[104:107], v[108:111], v[176:179], v[104:107]
    v_mfma_f32_16x16x32_bf16 v[100:103], v[108:111], v[172:175], v[100:103]
    v_mfma_f32_16x16x32_bf16 v[96:99], v[108:111], v[168:171], v[96:99]
    v_mfma_f32_16x16x32_bf16 v[92:95], v[108:111], v[164:167], v[92:95]
    v_mfma_f32_16x16x32_bf16 v[88:91], v[108:111], v[160:163], v[88:91]
    v_mfma_f32_16x16x32_bf16 v[84:87], v[108:111], v[156:159], v[84:87]
    v_mfma_f32_16x16x32_bf16 v[80:83], v[108:111], v[152:155], v[80:83]
    ds_read_b128 v[108:111], v66 offset:2368
    s_waitcnt lgkmcnt(2)
    v_mfma_f32_16x16x32_bf16 v[104:107], v[112:115], v[172:175], v[104:107]
    v_mfma_f32_16x16x32_bf16 v[100:103], v[112:115], v[168:171], v[100:103]
    v_mfma_f32_16x16x32_bf16 v[96:99], v[112:115], v[164:167], v[96:99]
    v_mfma_f32_16x16x32_bf16 v[92:95], v[112:115], v[160:163], v[92:95]
    v_mfma_f32_16x16x32_bf16 v[88:91], v[112:115], v[156:159], v[88:91]
    v_mfma_f32_16x16x32_bf16 v[84:87], v[112:115], v[152:155], v[84:87]
    ds_read_b128 v[112:115], v66 offset:2880
    s_waitcnt lgkmcnt(2)
    v_mfma_f32_16x16x32_bf16 v[104:107], v[116:119], v[168:171], v[104:107]
    v_mfma_f32_16x16x32_bf16 v[100:103], v[116:119], v[164:167], v[100:103]
    v_mfma_f32_16x16x32_bf16 v[96:99], v[116:119], v[160:163], v[96:99]
    v_mfma_f32_16x16x32_bf16 v[92:95], v[116:119], v[156:159], v[92:95]
    v_mfma_f32_16x16x32_bf16 v[88:91], v[116:119], v[152:155], v[88:91]
    ds_read_b128 v[116:119], v66 offset:3392
    s_waitcnt lgkmcnt(2)
    v_mfma_f32_16x16x32_bf16 v[104:107], v[108:111], v[164:167], v[104:107]
    v_mfma_f32_16x16x32_bf16 v[100:103], v[108:111], v[160:163], v[100:103]
    v_mfma_f32_16x16x32_bf16 v[96:99], v[108:111], v[156:159], v[96:99]
    v_mfma_f32_16x16x32_bf16 v[92:95], v[108:111], v[152:155], v[92:95]
    ds_read_b128 v[108:111], v66 offset:3904
    s_waitcnt lgkmcnt(2)
    v_mfma_f32_16x16x32_bf16 v[104:107], v[112:115], v[160:163], v[104:107]
    v_mfma_f32_16x16x32_bf16 v[100:103], v[112:115], v[156:159], v[100:103]
    v_mfma_f32_16x16x32_bf16 v[96:99], v[112:115], v[152:155], v[96:99]
    s_waitcnt lgkmcnt(1)
    v_mfma_f32_16x16x32_bf16 v[104:107], v[116:119], v[156:159], v[104:107]
    v_mfma_f32_16x16x32_bf16 v[100:103], v[116:119], v[152:155], v[100:103]
    s_waitcnt lgkmcnt(0)
    v_mfma_f32_16x16x32_bf16 v[104:107], v[108:111], v[152:155], v[104:107]
    ds_write_b128 v74, v[76:79] offset:0
    ds_write_b128 v74, v[80:83] offset:1024
    ds_write_b128 v74, v[84:87] offset:2048
    ds_write_b128 v74, v[88:91] offset:3072
    ds_write_b128 v74, v[92:95] offset:4096
    ds_write_b128 v74, v[96:99] offset:5120
    ds_write_b128 v74, v[100:103] offset:6144
    s_nop 0
    ds_write_b128 v74, v[104:107] offset:7168
    s_branch c_pw_end_52
c_pw_55:
    ds_read_b128 v[108:111], v66 offset:384
    ds_read_b128 v[120:123], v67 offset:96
    ds_read_b128 v[124:127], v67 offset:608
    ds_read_b128 v[128:131], v67 offset:1120
    ds_read_b128 v[132:135], v67 offset:1632
    ds_read_b128 v[136:139], v67 offset:2144
    ds_read_b128 v[140:143], v67 offset:2656
    ds_read_b128 v[144:147], v67 offset:3168
    ds_read_b128 v[148:151], v67 offset:3680
    ds_read_b128 v[112:115], v66 offset:896
    ds_read_b128 v[116:119], v66 offset:1408
    s_waitcnt lgkmcnt(2)
    v_mfma_f32_16x16x32_bf16 v[104:107], v[108:111], v[148:151], 0
    v_mfma_f32_16x16x32_bf16 v[100:103], v[108:111], v[144:147], 0
    v_mfma_f32_16x16x32_bf16 v[96:99], v[108:111], v[140:143], 0
    v_mfma_f32_16x16x32_bf16 v[92:95], v[108:111], v[136:139], 0
    v_mfma_f32_16x16x32_bf16 v[88:91], v[108:111], v[132:135], 0
    v_mfma_f32_16x16x32_bf16 v[84:87], v[108:111], v[128:131], 0
    v_mfma_f32_16x16x32_bf16 v[80:83], v[108:111], v[124:127], 0
    v_mfma_f32_16x16x32_bf16 v[76:79], v[108:111], v[120:123], 0
    ds_read_b128 v[108:111], v66 offset:1920
    s_waitcnt lgkmcnt(2)
    v_mfma_f32_16x16x32_bf16 v[104:107], v[112:115], v[144:147], v[104:107]
    v_mfma_f32_16x16x32_bf16 v[100:103], v[112:115], v[140:143], v[100:103]
    v_mfma_f32_16x16x32_bf16 v[96:99], v[112:115], v[136:139], v[96:99]
    v_mfma_f32_16x16x32_bf16 v[92:95], v[112:115], v[132:135], v[92:95]
    v_mfma_f32_16x16x32_bf16 v[88:91], v[112:115], v[128:131], v[88:91]
    v_mfma_f32_16x16x32_bf16 v[84:87], v[112:115], v[124:127], v[84:87]
    v_mfma_f32_16x16x32_bf16 v[80:83], v[112:115], v[120:123], v[80:83]
    ds_read_b128 v[112:115], v66 offset:2432
    ds_read_b128 v[152:155], v67 offset:32
    ds_read_b128 v[156:159], v67 offset:544
    ds_read_b128 v[160:163], v67 offset:1056
    ds_read_b128 v[164:167], v67 offset:1568
    ds_read_b128 v[168:171], v67 offset:2080
    ds_read_b128 v[172:175], v67 offset:2592
    ds_read_b128 v[176:179], v67 offset:3104
    ds_read_b128 v[180:183], v67 offset:3616
    s_waitcnt lgkmcnt(10)
    v_mfma_f32_16x16x32_bf16 v[104:107], v[116:119], v[140:143], v[104:107]
    v_mfma_f32_16x16x32_bf16 v[100:103], v[116:119], v[136:139], v[100:103]
    v_mfma_f32_16x16x32_bf16 v[96:99], v[116:119], v[132:135], v[96:99]
    v_mfma_f32_16x16x32_bf16 v[92:95], v[116:119], v[128:131], v[92:95]
    v_mfma_f32_16x16x32_bf16 v[88:91], v[116:119], v[124:127], v[88:91]
    v_mfma_f32_16x16x32_bf16 v[84:87], v[116:119], v[120:123], v[84:87]
    ds_read_b128 v[116:119], v66 offset:2944
    s_waitcnt lgkmcnt(10)
    v_mfma_f32_16x16x32_bf16 v[104:107], v[108:111], v[136:139], v[104:107]
    v_mfma_f32_16x16x32_bf16 v[100:103], v[108:111], v[132:135], v[100:103]
    v_mfma_f32_16x16x32_bf16 v[96:99], v[108:111], v[128:131], v[96:99]
    v_mfma_f32_16x16x32_bf16 v[92:95], v[108:111], v[124:127], v[92:95]
    v_mfma_f32_16x16x32_bf16 v[88:91], v[108:111], v[120:123], v[88:91]
    ds_read_b128 v[108:111], v66 offset:3456
    s_waitcnt lgkmcnt(10)
    v_mfma_f32_16x16x32_bf16 v[104:107], v[112:115], v[132:135], v[104:107]
    v_mfma_f32_16x16x32_bf16 v[100:103], v[112:115], v[128:131], v[100:103]
    v_mfma_f32_16x16x32_bf16 v[96:99], v[112:115], v[124:127], v[96:99]
    v_mfma_f32_16x16x32_bf16 v[92:95], v[112:115], v[120:123], v[92:95]
    ds_read_b128 v[112:115], v66 offset:3968
    s_waitcnt lgkmcnt(2)
    v_mfma_f32_16x16x32_bf16 v[104:107], v[116:119], v[128:131], v[104:107]
    v_mfma_f32_16x16x32_bf16 v[100:103], v[116:119], v[124:127], v[100:103]
    v_mfma_f32_16x16x32_bf16 v[96:99], v[116:119], v[120:123], v[96:99]
    ds_read_b128 v[116:119], v66 offset:448
    s_waitcnt lgkmcnt(2)
    v_mfma_f32_16x16x32_bf16 v[104:107], v[108:111], v[124:127], v[104:107]
    v_mfma_f32_16x16x32_bf16 v[100:103], v[108:111], v[120:123], v[100:103]
    ds_read_b128 v[108:111], v66 offset:960
    s_waitcnt lgkmcnt(2)
    v_mfma_f32_16x16x32_bf16 v[104:107], v[112:115], v[120:123], v[104:107]
    ds_read_b128 v[112:115], v66 offset:1472
    s_waitcnt lgkmcnt(2)
    v_mfma_f32_16x16x32_bf16 v[104:107], v[116:119], v[180:183], v[104:107]
    v_mfma_f32_16x16x32_bf16 v[100:103], v[116:119], v[176:179], v[100:103]
    v_mfma_f32_16x16x32_bf16 v[96:99], v[116:119], v[172:175], v[96:99]
    v_mfma_f32_16x16x32_bf16 v[92:95], v[116:119], v[168:171], v[92:95]
    v_mfma_f32_16x16x32_bf16 v[88:91], v[116:119], v[164:167], v[88:91]
    v_mfma_f32_16x16x32_bf16 v[84:87], v[116:119], v[160:163], v[84:87]
    v_mfma_f32_16x16x32_bf16 v[80:83], v[116:119], v[156:159], v[80:83]
    v_mfma_f32_16x16x32_bf16 v[76:79], v[116:119], v[152:155], v[76:79]
    ds_read_b128 v[116:119], v66 offset:1984
    s_waitcnt lgkmcnt(2)
    v_mfma_f32_16x16x32_bf16 v[104:107], v[108:111], v[176:179], v[104:107]
    v_mfma_f32_16x16x32_bf16 v[100:103], v[108:111], v[172:175], v[100:103]
    v_mfma_f32_16x16x32_bf16 v[96:99], v[108:111], v[168:171], v[96:99]
    v_mfma_f32_16x16x32_bf16 v[92:95], v[108:111], v[164:167], v[92:95]
    v_mfma_f32_16x16x32_bf16 v[88:91], v[108:111], v[160:163], v[88:91]
    v_mfma_f32_16x16x32_bf16 v[84:87], v[108:111], v[156:159], v[84:87]
    v_mfma_f32_16x16x32_bf16 v[80:83], v[108:111], v[152:155], v[80:83]
    ds_read_b128 v[108:111], v66 offset:2496
    s_waitcnt lgkmcnt(2)
    v_mfma_f32_16x16x32_bf16 v[104:107], v[112:115], v[172:175], v[104:107]
    v_mfma_f32_16x16x32_bf16 v[100:103], v[112:115], v[168:171], v[100:103]
    v_mfma_f32_16x16x32_bf16 v[96:99], v[112:115], v[164:167], v[96:99]
    v_mfma_f32_16x16x32_bf16 v[92:95], v[112:115], v[160:163], v[92:95]
    v_mfma_f32_16x16x32_bf16 v[88:91], v[112:115], v[156:159], v[88:91]
    v_mfma_f32_16x16x32_bf16 v[84:87], v[112:115], v[152:155], v[84:87]
    ds_read_b128 v[112:115], v66 offset:3008
    s_waitcnt lgkmcnt(2)
    v_mfma_f32_16x16x32_bf16 v[104:107], v[116:119], v[168:171], v[104:107]
    v_mfma_f32_16x16x32_bf16 v[100:103], v[116:119], v[164:167], v[100:103]
    v_mfma_f32_16x16x32_bf16 v[96:99], v[116:119], v[160:163], v[96:99]
    v_mfma_f32_16x16x32_bf16 v[92:95], v[116:119], v[156:159], v[92:95]
    v_mfma_f32_16x16x32_bf16 v[88:91], v[116:119], v[152:155], v[88:91]
    ds_read_b128 v[116:119], v66 offset:3520
    s_waitcnt lgkmcnt(2)
    v_mfma_f32_16x16x32_bf16 v[104:107], v[108:111], v[164:167], v[104:107]
    v_mfma_f32_16x16x32_bf16 v[100:103], v[108:111], v[160:163], v[100:103]
    v_mfma_f32_16x16x32_bf16 v[96:99], v[108:111], v[156:159], v[96:99]
    v_mfma_f32_16x16x32_bf16 v[92:95], v[108:111], v[152:155], v[92:95]
    ds_read_b128 v[108:111], v66 offset:4032
    s_waitcnt lgkmcnt(2)
    v_mfma_f32_16x16x32_bf16 v[104:107], v[112:115], v[160:163], v[104:107]
    v_mfma_f32_16x16x32_bf16 v[100:103], v[112:115], v[156:159], v[100:103]
    v_mfma_f32_16x16x32_bf16 v[96:99], v[112:115], v[152:155], v[96:99]
    s_waitcnt lgkmcnt(1)
    v_mfma_f32_16x16x32_bf16 v[104:107], v[116:119], v[156:159], v[104:107]
    v_mfma_f32_16x16x32_bf16 v[100:103], v[116:119], v[152:155], v[100:103]
    s_waitcnt lgkmcnt(0)
    v_mfma_f32_16x16x32_bf16 v[104:107], v[108:111], v[152:155], v[104:107]
    ds_write_b128 v74, v[76:79] offset:0
    ds_write_b128 v74, v[80:83] offset:1024
    ds_write_b128 v74, v[84:87] offset:2048
    ds_write_b128 v74, v[88:91] offset:3072
    ds_write_b128 v74, v[92:95] offset:4096
    ds_write_b128 v74, v[96:99] offset:5120
    ds_write_b128 v74, v[100:103] offset:6144
    s_nop 0
    ds_write_b128 v74, v[104:107] offset:7168
c_pw_end_52:
    s_waitcnt vmcnt(0)
    s_waitcnt lgkmcnt(0)
    v_mov_b32 v3, 161796
    v_mov_b32 v4, 1
    s_mov_b64 exec, 1
    ds_add_u32 v3, v4
    s_mov_b64 exec, -1
    s_mov_b32 s67, 0
gsync_57:
    ds_read_b32 v4, v3
    s_add_u32 s67, s67, 1
    s_waitcnt lgkmcnt(0)
    v_readfirstlane_b32 s66, v4
    s_cmp_gt_u32 s67, 1000000
    s_cbranch_scc1 gsync_e_58
    s_cmp_lt_u32 s66, 16
    s_cbranch_scc1 gsync_57
gsync_e_58:
    s_lshl_b32 s40, s2, 3
    s_add_u32 s40, s40, 14725120
    v_mov_b32 v48, s100
    v_mov_b32 v49, s101
    v_mov_b32 v3, 0
    s_cmp_eq_u32 s34, 0
    s_cselect_b64 exec, 1, 0
    s_cmp_lt_u32 s2, 192
    s_cselect_b64 exec, exec, 0
    buffer_store_dwordx2 v[48:49], v3, s[8:11], s40 offen sc1
    s_mov_b64 exec, -1
    ds_read_b128 v[120:123], v75 offset:0
    ds_read_b128 v[124:127], v75 offset:16
    ds_read_b128 v[128:131], v75 offset:8192
    ds_read_b128 v[132:135], v75 offset:8208
    ds_read_b128 v[136:139], v75 offset:16384
    ds_read_b128 v[140:143], v75 offset:16400
    ds_read_b128 v[144:147], v75 offset:24576
    ds_read_b128 v[148:151], v75 offset:24592
    s_lshl_b32 s40, s57, 12
    s_add_u32 s40, s40, 8912896
    s_waitcnt lgkmcnt(0)
    v_pk_add_f32 v[120:121], v[120:121], v[128:129]
    v_pk_add_f32 v[136:137], v[136:137], v[144:145]
    v_pk_add_f32 v[122:123], v[122:123], v[130:131]
    v_pk_add_f32 v[138:139], v[138:139], v[146:147]
    v_pk_add_f32 v[124:125], v[124:125], v[132:133]
    v_pk_add_f32 v[140:141], v[140:141], v[148:149]
    v_pk_add_f32 v[126:127], v[126:127], v[134:135]
    v_pk_add_f32 v[142:143], v[142:143], v[150:151]
    v_pk_add_f32 v[120:121], v[120:121], v[136:137]
    v_pk_add_f32 v[122:123], v[122:123], v[138:139]
    v_pk_add_f32 v[124:125], v[124:125], v[140:141]
    v_pk_add_f32 v[126:127], v[126:127], v[142:143]
    v_cvt_pk_bf16_f32 v192, v120, v121
    v_cvt_pk_bf16_f32 v193, v122, v123
    v_cvt_pk_bf16_f32 v194, v124, v125
    v_cvt_pk_bf16_f32 v195, v126, v127
    buffer_store_dwordx4 v[192:195], v2, s[8:11], s40 offen sc1
    s_nop 1
    s_waitcnt vmcnt(0)
    v_cmp_ne_u32 vcc, 0, v0
    s_nop 1
    v_cndmask_b32 v24, 0, v24, vcc
    v_cndmask_b32 v25, 0, v25, vcc
    v_cndmask_b32 v26, 0, v26, vcc
    v_cndmask_b32 v27, 0, v27, vcc
    v_alignbit_b32 v184, v25, v24, 16
    v_alignbit_b32 v185, v26, v25, 16
    v_alignbit_b32 v186, v27, v26, 16
    v_alignbit_b32 v187, v28, v27, 16
    v_alignbit_b32 v188, v29, v28, 16
    v_alignbit_b32 v189, v30, v29, 16
    v_alignbit_b32 v190, v31, v30, 16
    ds_write_b128 v64, v[184:187] offset:0
    v_mov_b32 v192, v25
    v_mov_b32 v193, v26
    v_mov_b32 v194, v27
    v_mov_b32 v195, v28
    ds_write_b128 v64, v[192:195] offset:4160
    s_nop 1
    v_mov_b32 v192, v185
    v_mov_b32 v193, v186
    v_mov_b32 v194, v187
    v_mov_b32 v195, v188
    ds_write_b128 v64, v[192:195] offset:8320
    s_nop 1
    ds_write_b128 v64, v[26:29] offset:12480
    ds_write_b128 v64, v[186:189] offset:16640
    v_mov_b32 v192, v27
    v_mov_b32 v193, v28
    v_mov_b32 v194, v29
    v_mov_b32 v195, v30
    ds_write_b128 v64, v[192:195] offset:20800
    s_nop 1
    v_mov_b32 v192, v187
    v_mov_b32 v193, v188
    v_mov_b32 v194, v189
    v_mov_b32 v195, v190
    ds_write_b128 v64, v[192:195] offset:24960
    s_nop 1
    ds_write_b128 v64, v[28:31] offset:29120
    ds_write_b128 v65, v[40:43]
    v_lshlrev_b32 v3, 16, v46
    v_or_b32 v3, v3, v46
    v_and_b32 v196, v68, v3
    v_and_b32 v197, v69, v3
    v_and_b32 v198, v70, v3
    v_and_b32 v199, v71, v3
    s_waitcnt lgkmcnt(0)
    v_mov_b32 v3, 161796
    v_mov_b32 v4, 1
    s_mov_b64 exec, 1
    ds_add_u32 v3, v4
    s_mov_b64 exec, -1
    s_mov_b32 s67, 0
gsync_59:
    ds_read_b32 v4, v3
    s_add_u32 s67, s67, 1
    s_waitcnt lgkmcnt(0)
    v_readfirstlane_b32 s66, v4
    s_cmp_gt_u32 s67, 1000000
    s_cbranch_scc1 gsync_e_60
    s_cmp_lt_u32 s66, 20
    s_cbranch_scc1 gsync_59
gsync_e_60:
    s_bitcmp1_b32 s2, 0
    s_cbranch_scc1 c_halfB_61
    s_cmp_lg_u32 s34, 0
    s_cbranch_scc1 c_pw_64
    ds_read_b128 v[108:111], v66 offset:0
    ds_read_b128 v[120:123], v67 offset:480
    ds_read_b128 v[124:127], v67 offset:992
    ds_read_b128 v[128:131], v67 offset:1504
    ds_read_b128 v[132:135], v67 offset:2016
    ds_read_b128 v[136:139], v67 offset:2528
    ds_read_b128 v[140:143], v67 offset:3040
    ds_read_b128 v[144:147], v67 offset:3552
    ds_read_b128 v[148:151], v67 offset:4064
    ds_read_b128 v[112:115], v66 offset:512
    ds_read_b128 v[116:119], v66 offset:1024
    s_waitcnt lgkmcnt(2)
    v_mfma_f32_16x16x32_bf16 v[104:107], v[108:111], v[148:151], 0
    v_mfma_f32_16x16x32_bf16 v[100:103], v[108:111], v[144:147], 0
    v_mfma_f32_16x16x32_bf16 v[84:87], v[108:111], v[128:131], 0
    v_mfma_f32_16x16x32_bf16 v[84:87], v[196:199], v[128:131], v[84:87]
    v_mfma_f32_16x16x32_bf16 v[100:103], v[196:199], v[144:147], v[100:103]
    v_mfma_f32_16x16x32_bf16 v[104:107], v[196:199], v[148:151], v[104:107]
    ds_read_b128 v[108:111], v66 offset:1536
    s_waitcnt lgkmcnt(2)
    v_mfma_f32_16x16x32_bf16 v[104:107], v[112:115], v[144:147], v[104:107]
    v_mfma_f32_16x16x32_bf16 v[100:103], v[112:115], v[140:143], v[100:103]
    v_mfma_f32_16x16x32_bf16 v[84:87], v[112:115], v[124:127], v[84:87]
    ds_read_b128 v[112:115], v66 offset:2048
    ds_read_b128 v[152:155], v67 offset:416
    ds_read_b128 v[156:159], v67 offset:928
    ds_read_b128 v[160:163], v67 offset:1440
    ds_read_b128 v[164:167], v67 offset:1952
    ds_read_b128 v[168:171], v67 offset:2464
    ds_read_b128 v[172:175], v67 offset:2976
    ds_read_b128 v[176:179], v67 offset:3488
    ds_read_b128 v[180:183], v67 offset:4000
    s_waitcnt lgkmcnt(10)
    v_mfma_f32_16x16x32_bf16 v[104:107], v[116:119], v[140:143], v[104:107]
    v_mfma_f32_16x16x32_bf16 v[100:103], v[116:119], v[136:139], v[100:103]
    v_mfma_f32_16x16x32_bf16 v[84:87], v[116:119], v[120:123], v[84:87]
    ds_read_b128 v[116:119], v66 offset:2560
    s_waitcnt lgkmcnt(10)
    v_mfma_f32_16x16x32_bf16 v[104:107], v[108:111], v[136:139], v[104:107]
    v_mfma_f32_16x16x32_bf16 v[100:103], v[108:111], v[132:135], v[100:103]
    ds_read_b128 v[108:111], v66 offset:3072
    s_waitcnt lgkmcnt(10)
    v_mfma_f32_16x16x32_bf16 v[104:107], v[112:115], v[132:135], v[104:107]
    v_mfma_f32_16x16x32_bf16 v[100:103], v[112:115], v[128:131], v[100:103]
    ds_read_b128 v[112:115], v66 offset:3584
    s_waitcnt lgkmcnt(2)
    v_mfma_f32_16x16x32_bf16 v[104:107], v[116:119], v[128:131], v[104:107]
    v_mfma_f32_16x16x32_bf16 v[100:103], v[116:119], v[124:127], v[100:103]
    ds_read_b128 v[116:119], v66 offset:64
    s_waitcnt lgkmcnt(2)
    v_mfma_f32_16x16x32_bf16 v[104:107], v[108:111], v[124:127], v[104:107]
    v_mfma_f32_16x16x32_bf16 v[100:103], v[108:111], v[120:123], v[100:103]
    ds_read_b128 v[108:111], v66 offset:576
    s_waitcnt lgkmcnt(2)
    v_mfma_f32_16x16x32_bf16 v[104:107], v[112:115], v[120:123], v[104:107]
    ds_read_b128 v[112:115], v66 offset:1088
    s_waitcnt lgkmcnt(2)
    v_mfma_f32_16x16x32_bf16 v[104:107], v[116:119], v[180:183], v[104:107]
    v_mfma_f32_16x16x32_bf16 v[100:103], v[116:119], v[176:179], v[100:103]
    v_mfma_f32_16x16x32_bf16 v[84:87], v[116:119], v[160:163], v[84:87]
    ds_read_b128 v[116:119], v66 offset:1600
    s_waitcnt lgkmcnt(2)
    v_mfma_f32_16x16x32_bf16 v[104:107], v[108:111], v[176:179], v[104:107]
    v_mfma_f32_16x16x32_bf16 v[100:103], v[108:111], v[172:175], v[100:103]
    v_mfma_f32_16x16x32_bf16 v[84:87], v[108:111], v[156:159], v[84:87]
    ds_read_b128 v[108:111], v66 offset:2112
    s_waitcnt lgkmcnt(2)
    v_mfma_f32_16x16x32_bf16 v[104:107], v[112:115], v[172:175], v[104:107]
    v_mfma_f32_16x16x32_bf16 v[100:103], v[112:115], v[168:171], v[100:103]
    v_mfma_f32_16x16x32_bf16 v[84:87], v[112:115], v[152:155], v[84:87]
    ds_read_b128 v[112:115], v66 offset:2624
    s_waitcnt lgkmcnt(2)
    v_mfma_f32_16x16x32_bf16 v[104:107], v[116:119], v[168:171], v[104:107]
    v_mfma_f32_16x16x32_bf16 v[100:103], v[116:119], v[164:167], v[100:103]
    ds_read_b128 v[116:119], v66 offset:3136
    s_waitcnt lgkmcnt(2)
    v_mfma_f32_16x16x32_bf16 v[104:107], v[108:111], v[164:167], v[104:107]
    v_mfma_f32_16x16x32_bf16 v[100:103], v[108:111], v[160:163], v[100:103]
    ds_read_b128 v[108:111], v66 offset:3648
    s_waitcnt lgkmcnt(2)
    v_mfma_f32_16x16x32_bf16 v[104:107], v[112:115], v[160:163], v[104:107]
    v_mfma_f32_16x16x32_bf16 v[100:103], v[112:115], v[156:159], v[100:103]
    s_waitcnt lgkmcnt(1)
    v_mfma_f32_16x16x32_bf16 v[104:107], v[116:119], v[156:159], v[104:107]
    v_mfma_f32_16x16x32_bf16 v[100:103], v[116:119], v[152:155], v[100:103]
    s_waitcnt lgkmcnt(0)
    v_mfma_f32_16x16x32_bf16 v[104:107], v[108:111], v[152:155], v[104:107]
    ds_write_b128 v74, v[84:87] offset:2048
    s_nop 4
    ds_write_b128 v74, v[100:103] offset:6144
    s_nop 0
    ds_write_b128 v74, v[104:107] offset:7168
    s_branch c_pw_end_63
c_pw_64:
    s_cmp_lg_u32 s34, 1
    s_cbranch_scc1 c_pw_65
    ds_read_b128 v[108:111], v66 offset:128
    ds_read_b128 v[120:123], v67 offset:352
    ds_read_b128 v[124:127], v67 offset:864
    ds_read_b128 v[128:131], v67 offset:1376
    ds_read_b128 v[132:135], v67 offset:1888
    ds_read_b128 v[136:139], v67 offset:2400
    ds_read_b128 v[140:143], v67 offset:2912
    ds_read_b128 v[144:147], v67 offset:3424
    ds_read_b128 v[148:151], v67 offset:3936
    ds_read_b128 v[112:115], v66 offset:640
    ds_read_b128 v[116:119], v66 offset:1152
    s_waitcnt lgkmcnt(2)
    v_mfma_f32_16x16x32_bf16 v[104:107], v[108:111], v[148:151], 0
    v_mfma_f32_16x16x32_bf16 v[100:103], v[108:111], v[144:147], 0
    v_mfma_f32_16x16x32_bf16 v[84:87], v[108:111], v[128:131], 0
    ds_read_b128 v[108:111], v66 offset:1664
    s_waitcnt lgkmcnt(2)
    v_mfma_f32_16x16x32_bf16 v[104:107], v[112:115], v[144:147], v[104:107]
    v_mfma_f32_16x16x32_bf16 v[100:103], v[112:115], v[140:143], v[100:103]
    v_mfma_f32_16x16x32_bf16 v[84:87], v[112:115], v[124:127], v[84:87]
    ds_read_b128 v[112:115], v66 offset:2176
    ds_read_b128 v[152:155], v67 offset:288
    ds_read_b128 v[156:159], v67 offset:800
    ds_read_b128 v[160:163], v67 offset:1312
    ds_read_b128 v[164:167], v67 offset:1824
    ds_read_b128 v[168:171], v67 offset:2336
    ds_read_b128 v[172:175], v67 offset:2848
    ds_read_b128 v[176:179], v67 offset:3360
    ds_read_b128 v[180:183], v67 offset:3872
    s_waitcnt lgkmcnt(10)
    v_mfma_f32_16x16x32_bf16 v[104:107], v[116:119], v[140:143], v[104:107]
    v_mfma_f32_16x16x32_bf16 v[100:103], v[116:119], v[136:139], v[100:103]
    v_mfma_f32_16x16x32_bf16 v[84:87], v[116:119], v[120:123], v[84:87]
    ds_read_b128 v[116:119], v66 offset:2688
    s_waitcnt lgkmcnt(10)
    v_mfma_f32_16x16x32_bf16 v[104:107], v[108:111], v[136:139], v[104:107]
    v_mfma_f32_16x16x32_bf16 v[100:103], v[108:111], v[132:135], v[100:103]
    ds_read_b128 v[108:111], v66 offset:3200
    s_waitcnt lgkmcnt(10)
    v_mfma_f32_16x16x32_bf16 v[104:107], v[112:115], v[132:135], v[104:107]
    v_mfma_f32_16x16x32_bf16 v[100:103], v[112:115], v[128:131], v[100:103]
    ds_read_b128 v[112:115], v66 offset:3712
    s_waitcnt lgkmcnt(2)
    v_mfma_f32_16x16x32_bf16 v[104:107], v[116:119], v[128:131], v[104:107]
    v_mfma_f32_16x16x32_bf16 v[100:103], v[116:119], v[124:127], v[100:103]
    ds_read_b128 v[116:119], v66 offset:192
    s_waitcnt lgkmcnt(2)
    v_mfma_f32_16x16x32_bf16 v[104:107], v[108:111], v[124:127], v[104:107]
    v_mfma_f32_16x16x32_bf16 v[100:103], v[108:111], v[120:123], v[100:103]
    ds_read_b128 v[108:111], v66 offset:704
    s_waitcnt lgkmcnt(2)
    v_mfma_f32_16x16x32_bf16 v[104:107], v[112:115], v[120:123], v[104:107]
    ds_read_b128 v[112:115], v66 offset:1216
    s_waitcnt lgkmcnt(2)
    v_mfma_f32_16x16x32_bf16 v[104:107], v[116:119], v[180:183], v[104:107]
    v_mfma_f32_16x16x32_bf16 v[100:103], v[116:119], v[176:179], v[100:103]
    v_mfma_f32_16x16x32_bf16 v[84:87], v[116:119], v[160:163], v[84:87]
    ds_read_b128 v[116:119], v66 offset:1728
    s_waitcnt lgkmcnt(2)
    v_mfma_f32_16x16x32_bf16 v[104:107], v[108:111], v[176:179], v[104:107]
    v_mfma_f32_16x16x32_bf16 v[100:103], v[108:111], v[172:175], v[100:103]
    v_mfma_f32_16x16x32_bf16 v[84:87], v[108:111], v[156:159], v[84:87]
    ds_read_b128 v[108:111], v66 offset:2240
    s_waitcnt lgkmcnt(2)
    v_mfma_f32_16x16x32_bf16 v[104:107], v[112:115], v[172:175], v[104:107]
    v_mfma_f32_16x16x32_bf16 v[100:103], v[112:115], v[168:171], v[100:103]
    v_mfma_f32_16x16x32_bf16 v[84:87], v[112:115], v[152:155], v[84:87]
    ds_read_b128 v[112:115], v66 offset:2752
    s_waitcnt lgkmcnt(2)
    v_mfma_f32_16x16x32_bf16 v[104:107], v[116:119], v[168:171], v[104:107]
    v_mfma_f32_16x16x32_bf16 v[100:103], v[116:119], v[164:167], v[100:103]
    ds_read_b128 v[116:119], v66 offset:3264
    s_waitcnt lgkmcnt(2)
    v_mfma_f32_16x16x32_bf16 v[104:107], v[108:111], v[164:167], v[104:107]
    v_mfma_f32_16x16x32_bf16 v[100:103], v[108:111], v[160:163], v[100:103]
    ds_read_b128 v[108:111], v66 offset:3776
    s_waitcnt lgkmcnt(2)
    v_mfma_f32_16x16x32_bf16 v[104:107], v[112:115], v[160:163], v[104:107]
    v_mfma_f32_16x16x32_bf16 v[100:103], v[112:115], v[156:159], v[100:103]
    s_waitcnt lgkmcnt(1)
    v_mfma_f32_16x16x32_bf16 v[104:107], v[116:119], v[156:159], v[104:107]
    v_mfma_f32_16x16x32_bf16 v[100:103], v[116:119], v[152:155], v[100:103]
    s_waitcnt lgkmcnt(0)
    v_mfma_f32_16x16x32_bf16 v[104:107], v[108:111], v[152:155], v[104:107]
    ds_write_b128 v74, v[84:87] offset:2048
    s_nop 4
    ds_write_b128 v74, v[100:103] offset:6144
    s_nop 0
    ds_write_b128 v74, v[104:107] offset:7168
    s_branch c_pw_end_63
c_pw_65:
    s_cmp_lg_u32 s34, 2
    s_cbranch_scc1 c_pw_66
    ds_read_b128 v[108:111], v66 offset:256
    ds_read_b128 v[120:123], v67 offset:224
    ds_read_b128 v[124:127], v67 offset:736
    ds_read_b128 v[128:131], v67 offset:1248
    ds_read_b128 v[132:135], v67 offset:1760
    ds_read_b128 v[136:139], v67 offset:2272
    ds_read_b128 v[140:143], v67 offset:2784
    ds_read_b128 v[144:147], v67 offset:3296
    ds_read_b128 v[148:151], v67 offset:3808
    ds_read_b128 v[112:115], v66 offset:768
    ds_read_b128 v[116:119], v66 offset:1280
    s_waitcnt lgkmcnt(2)
    v_mfma_f32_16x16x32_bf16 v[104:107], v[108:111], v[148:151], 0
    v_mfma_f32_16x16x32_bf16 v[100:103], v[108:111], v[144:147], 0
    v_mfma_f32_16x16x32_bf16 v[84:87], v[108:111], v[128:131], 0
    ds_read_b128 v[108:111], v66 offset:1792
    s_waitcnt lgkmcnt(2)
    v_mfma_f32_16x16x32_bf16 v[104:107], v[112:115], v[144:147], v[104:107]
    v_mfma_f32_16x16x32_bf16 v[100:103], v[112:115], v[140:143], v[100:103]
    v_mfma_f32_16x16x32_bf16 v[84:87], v[112:115], v[124:127], v[84:87]
    ds_read_b128 v[112:115], v66 offset:2304
    ds_read_b128 v[152:155], v67 offset:160
    ds_read_b128 v[156:159], v67 offset:672
    ds_read_b128 v[160:163], v67 offset:1184
    ds_read_b128 v[164:167], v67 offset:1696
    ds_read_b128 v[168:171], v67 offset:2208
    ds_read_b128 v[172:175], v67 offset:2720
    ds_read_b128 v[176:179], v67 offset:3232
    ds_read_b128 v[180:183], v67 offset:3744
    s_waitcnt lgkmcnt(10)
    v_mfma_f32_16x16x32_bf16 v[104:107], v[116:119], v[140:143], v[104:107]
    v_mfma_f32_16x16x32_bf16 v[100:103], v[116:119], v[136:139], v[100:103]
    v_mfma_f32_16x16x32_bf16 v[84:87], v[116:119], v[120:123], v[84:87]
    ds_read_b128 v[116:119], v66 offset:2816
    s_waitcnt lgkmcnt(10)
    v_mfma_f32_16x16x32_bf16 v[104:107], v[108:111], v[136:139], v[104:107]
    v_mfma_f32_16x16x32_bf16 v[100:103], v[108:111], v[132:135], v[100:103]
    ds_read_b128 v[108:111], v66 offset:3328
    s_waitcnt lgkmcnt(10)
    v_mfma_f32_16x16x32_bf16 v[104:107], v[112:115], v[132:135], v[104:107]
    v_mfma_f32_16x16x32_bf16 v[100:103], v[112:115], v[128:131], v[100:103]
    ds_read_b128 v[112:115], v66 offset:3840
    s_waitcnt lgkmcnt(2)
    v_mfma_f32_16x16x32_bf16 v[104:107], v[116:119], v[128:131], v[104:107]
    v_mfma_f32_16x16x32_bf16 v[100:103], v[116:119], v[124:127], v[100:103]
    ds_read_b128 v[116:119], v66 offset:320
    s_waitcnt lgkmcnt(2)
    v_mfma_f32_16x16x32_bf16 v[104:107], v[108:111], v[124:127], v[104:107]
    v_mfma_f32_16x16x32_bf16 v[100:103], v[108:111], v[120:123], v[100:103]
    ds_read_b128 v[108:111], v66 offset:832
    s_waitcnt lgkmcnt(2)
    v_mfma_f32_16x16x32_bf16 v[104:107], v[112:115], v[120:123], v[104:107]
    ds_read_b128 v[112:115], v66 offset:1344
    s_waitcnt lgkmcnt(2)
    v_mfma_f32_16x16x32_bf16 v[104:107], v[116:119], v[180:183], v[104:107]
    v_mfma_f32_16x16x32_bf16 v[100:103], v[116:119], v[176:179], v[100:103]
    v_mfma_f32_16x16x32_bf16 v[84:87], v[116:119], v[160:163], v[84:87]
    ds_read_b128 v[116:119], v66 offset:1856
    s_waitcnt lgkmcnt(2)
    v_mfma_f32_16x16x32_bf16 v[104:107], v[108:111], v[176:179], v[104:107]
    v_mfma_f32_16x16x32_bf16 v[100:103], v[108:111], v[172:175], v[100:103]
    v_mfma_f32_16x16x32_bf16 v[84:87], v[108:111], v[156:159], v[84:87]
    ds_read_b128 v[108:111], v66 offset:2368
    s_waitcnt lgkmcnt(2)
    v_mfma_f32_16x16x32_bf16 v[104:107], v[112:115], v[172:175], v[104:107]
    v_mfma_f32_16x16x32_bf16 v[100:103], v[112:115], v[168:171], v[100:103]
    v_mfma_f32_16x16x32_bf16 v[84:87], v[112:115], v[152:155], v[84:87]
    ds_read_b128 v[112:115], v66 offset:2880
    s_waitcnt lgkmcnt(2)
    v_mfma_f32_16x16x32_bf16 v[104:107], v[116:119], v[168:171], v[104:107]
    v_mfma_f32_16x16x32_bf16 v[100:103], v[116:119], v[164:167], v[100:103]
    ds_read_b128 v[116:119], v66 offset:3392
    s_waitcnt lgkmcnt(2)
    v_mfma_f32_16x16x32_bf16 v[104:107], v[108:111], v[164:167], v[104:107]
    v_mfma_f32_16x16x32_bf16 v[100:103], v[108:111], v[160:163], v[100:103]
    ds_read_b128 v[108:111], v66 offset:3904
    s_waitcnt lgkmcnt(2)
    v_mfma_f32_16x16x32_bf16 v[104:107], v[112:115], v[160:163], v[104:107]
    v_mfma_f32_16x16x32_bf16 v[100:103], v[112:115], v[156:159], v[100:103]
    s_waitcnt lgkmcnt(1)
    v_mfma_f32_16x16x32_bf16 v[104:107], v[116:119], v[156:159], v[104:107]
    v_mfma_f32_16x16x32_bf16 v[100:103], v[116:119], v[152:155], v[100:103]
    s_waitcnt lgkmcnt(0)
    v_mfma_f32_16x16x32_bf16 v[104:107], v[108:111], v[152:155], v[104:107]
    ds_write_b128 v74, v[84:87] offset:2048
    s_nop 4
    ds_write_b128 v74, v[100:103] offset:6144
    s_nop 0
    ds_write_b128 v74, v[104:107] offset:7168
    s_branch c_pw_end_63
c_pw_66:
    ds_read_b128 v[108:111], v66 offset:384
    ds_read_b128 v[120:123], v67 offset:96
    ds_read_b128 v[124:127], v67 offset:608
    ds_read_b128 v[128:131], v67 offset:1120
    ds_read_b128 v[132:135], v67 offset:1632
    ds_read_b128 v[136:139], v67 offset:2144
    ds_read_b128 v[140:143], v67 offset:2656
    ds_read_b128 v[144:147], v67 offset:3168
    ds_read_b128 v[148:151], v67 offset:3680
    ds_read_b128 v[112:115], v66 offset:896
    ds_read_b128 v[116:119], v66 offset:1408
    s_waitcnt lgkmcnt(2)
    v_mfma_f32_16x16x32_bf16 v[104:107], v[108:111], v[148:151], 0
    v_mfma_f32_16x16x32_bf16 v[100:103], v[108:111], v[144:147], 0
    v_mfma_f32_16x16x32_bf16 v[84:87], v[108:111], v[128:131], 0
    ds_read_b128 v[108:111], v66 offset:1920
    s_waitcnt lgkmcnt(2)
    v_mfma_f32_16x16x32_bf16 v[104:107], v[112:115], v[144:147], v[104:107]
    v_mfma_f32_16x16x32_bf16 v[100:103], v[112:115], v[140:143], v[100:103]
    v_mfma_f32_16x16x32_bf16 v[84:87], v[112:115], v[124:127], v[84:87]
    ds_read_b128 v[112:115], v66 offset:2432
    ds_read_b128 v[152:155], v67 offset:32
    ds_read_b128 v[156:159], v67 offset:544
    ds_read_b128 v[160:163], v67 offset:1056
    ds_read_b128 v[164:167], v67 offset:1568
    ds_read_b128 v[168:171], v67 offset:2080
    ds_read_b128 v[172:175], v67 offset:2592
    ds_read_b128 v[176:179], v67 offset:3104
    ds_read_b128 v[180:183], v67 offset:3616
    s_waitcnt lgkmcnt(10)
    v_mfma_f32_16x16x32_bf16 v[104:107], v[116:119], v[140:143], v[104:107]
    v_mfma_f32_16x16x32_bf16 v[100:103], v[116:119], v[136:139], v[100:103]
    v_mfma_f32_16x16x32_bf16 v[84:87], v[116:119], v[120:123], v[84:87]
    ds_read_b128 v[116:119], v66 offset:2944
    s_waitcnt lgkmcnt(10)
    v_mfma_f32_16x16x32_bf16 v[104:107], v[108:111], v[136:139], v[104:107]
    v_mfma_f32_16x16x32_bf16 v[100:103], v[108:111], v[132:135], v[100:103]
    ds_read_b128 v[108:111], v66 offset:3456
    s_waitcnt lgkmcnt(10)
    v_mfma_f32_16x16x32_bf16 v[104:107], v[112:115], v[132:135], v[104:107]
    v_mfma_f32_16x16x32_bf16 v[100:103], v[112:115], v[128:131], v[100:103]
    ds_read_b128 v[112:115], v66 offset:3968
    s_waitcnt lgkmcnt(2)
    v_mfma_f32_16x16x32_bf16 v[104:107], v[116:119], v[128:131], v[104:107]
    v_mfma_f32_16x16x32_bf16 v[100:103], v[116:119], v[124:127], v[100:103]
    ds_read_b128 v[116:119], v66 offset:448
    s_waitcnt lgkmcnt(2)
    v_mfma_f32_16x16x32_bf16 v[104:107], v[108:111], v[124:127], v[104:107]
    v_mfma_f32_16x16x32_bf16 v[100:103], v[108:111], v[120:123], v[100:103]
    ds_read_b128 v[108:111], v66 offset:960
    s_waitcnt lgkmcnt(2)
    v_mfma_f32_16x16x32_bf16 v[104:107], v[112:115], v[120:123], v[104:107]
    ds_read_b128 v[112:115], v66 offset:1472
    s_waitcnt lgkmcnt(2)
    v_mfma_f32_16x16x32_bf16 v[104:107], v[116:119], v[180:183], v[104:107]
    v_mfma_f32_16x16x32_bf16 v[100:103], v[116:119], v[176:179], v[100:103]
    v_mfma_f32_16x16x32_bf16 v[84:87], v[116:119], v[160:163], v[84:87]
    ds_read_b128 v[116:119], v66 offset:1984
    s_waitcnt lgkmcnt(2)
    v_mfma_f32_16x16x32_bf16 v[104:107], v[108:111], v[176:179], v[104:107]
    v_mfma_f32_16x16x32_bf16 v[100:103], v[108:111], v[172:175], v[100:103]
    v_mfma_f32_16x16x32_bf16 v[84:87], v[108:111], v[156:159], v[84:87]
    ds_read_b128 v[108:111], v66 offset:2496
    s_waitcnt lgkmcnt(2)
    v_mfma_f32_16x16x32_bf16 v[104:107], v[112:115], v[172:175], v[104:107]
    v_mfma_f32_16x16x32_bf16 v[100:103], v[112:115], v[168:171], v[100:103]
    v_mfma_f32_16x16x32_bf16 v[84:87], v[112:115], v[152:155], v[84:87]
    ds_read_b128 v[112:115], v66 offset:3008
    s_waitcnt lgkmcnt(2)
    v_mfma_f32_16x16x32_bf16 v[104:107], v[116:119], v[168:171], v[104:107]
    v_mfma_f32_16x16x32_bf16 v[100:103], v[116:119], v[164:167], v[100:103]
    ds_read_b128 v[116:119], v66 offset:3520
    s_waitcnt lgkmcnt(2)
    v_mfma_f32_16x16x32_bf16 v[104:107], v[108:111], v[164:167], v[104:107]
    v_mfma_f32_16x16x32_bf16 v[100:103], v[108:111], v[160:163], v[100:103]
    ds_read_b128 v[108:111], v66 offset:4032
    s_waitcnt lgkmcnt(2)
    v_mfma_f32_16x16x32_bf16 v[104:107], v[112:115], v[160:163], v[104:107]
    v_mfma_f32_16x16x32_bf16 v[100:103], v[112:115], v[156:159], v[100:103]
    s_waitcnt lgkmcnt(1)
    v_mfma_f32_16x16x32_bf16 v[104:107], v[116:119], v[156:159], v[104:107]
    v_mfma_f32_16x16x32_bf16 v[100:103], v[116:119], v[152:155], v[100:103]
    s_waitcnt lgkmcnt(0)
    v_mfma_f32_16x16x32_bf16 v[104:107], v[108:111], v[152:155], v[104:107]
    ds_write_b128 v74, v[84:87] offset:2048
    s_nop 4
    ds_write_b128 v74, v[100:103] offset:6144
    s_nop 0
    ds_write_b128 v74, v[104:107] offset:7168
c_pw_end_63:
    s_waitcnt lgkmcnt(0)
    v_mov_b32 v3, 161796
    v_mov_b32 v4, 1
    s_mov_b64 exec, 1
    ds_add_u32 v3, v4
    s_mov_b64 exec, -1
    s_mov_b32 s67, 0
gsync_68:
    ds_read_b32 v4, v3
    s_add_u32 s67, s67, 1
    s_waitcnt lgkmcnt(0)
    v_readfirstlane_b32 s66, v4
    s_cmp_gt_u32 s67, 1000000
    s_cbranch_scc1 gsync_e_69
    s_cmp_lt_u32 s66, 24
    s_cbranch_scc1 gsync_68
gsync_e_69:
    s_mov_b64 exec, 0
    s_cmp_eq_u32 s34, 0
    s_cselect_b32 exec_lo, 0, exec_lo
    s_cselect_b32 exec_hi, 0, exec_hi
    s_cmp_eq_u32 s34, 1
    s_cselect_b32 exec_lo, -1, exec_lo
    s_cselect_b32 exec_hi, 0, exec_hi
    s_cmp_eq_u32 s34, 2
    s_cselect_b32 exec_lo, 0, exec_lo
    s_cselect_b32 exec_hi, 0, exec_hi
    s_cmp_eq_u32 s34, 3
    s_cselect_b32 exec_lo, -1, exec_lo
    s_cselect_b32 exec_hi, -1, exec_hi
    s_cbranch_execz c_fskip_71
    ds_read_b128 v[120:123], v75 offset:0
    ds_read_b128 v[124:127], v75 offset:16
    ds_read_b128 v[128:131], v75 offset:8192
    ds_read_b128 v[132:135], v75 offset:8208
    ds_read_b128 v[136:139], v75 offset:16384
    ds_read_b128 v[140:143], v75 offset:16400
    ds_read_b128 v[144:147], v75 offset:24576
    ds_read_b128 v[148:151], v75 offset:24592
    s_lshl_b32 s40, s58, 12
    s_add_u32 s40, s40, 8912896
    s_waitcnt lgkmcnt(0)
    v_pk_add_f32 v[120:121], v[120:121], v[128:129]
    v_pk_add_f32 v[136:137], v[136:137], v[144:145]
    v_pk_add_f32 v[122:123], v[122:123], v[130:131]
    v_pk_add_f32 v[138:139], v[138:139], v[146:147]
    v_pk_add_f32 v[124:125], v[124:125], v[132:133]
    v_pk_add_f32 v[140:141], v[140:141], v[148:149]
    v_pk_add_f32 v[126:127], v[126:127], v[134:135]
    v_pk_add_f32 v[142:143], v[142:143], v[150:151]
    v_pk_add_f32 v[120:121], v[120:121], v[136:137]
    v_pk_add_f32 v[122:123], v[122:123], v[138:139]
    v_pk_add_f32 v[124:125], v[124:125], v[140:141]
    v_pk_add_f32 v[126:127], v[126:127], v[142:143]
    v_cvt_pk_bf16_f32 v192, v120, v121
    v_cvt_pk_bf16_f32 v193, v122, v123
    v_cvt_pk_bf16_f32 v194, v124, v125
    v_cvt_pk_bf16_f32 v195, v126, v127
    buffer_store_dwordx4 v[192:195], v2, s[8:11], s40 offen sc1
c_fskip_71:
    s_mov_b64 exec, -1
    s_nop 1
    s_branch c_halfE_62
c_halfB_61:
    s_cmp_lg_u32 s34, 0
    s_cbranch_scc1 c_pw_73
    ds_read_b128 v[108:111], v66 offset:0
    ds_read_b128 v[120:123], v67 offset:480
    ds_read_b128 v[124:127], v67 offset:992
    ds_read_b128 v[128:131], v67 offset:1504
    ds_read_b128 v[132:135], v67 offset:2016
    ds_read_b128 v[136:139], v67 offset:2528
    ds_read_b128 v[140:143], v67 offset:3040
    ds_read_b128 v[112:115], v66 offset:512
    ds_read_b128 v[116:119], v66 offset:1024
    s_waitcnt lgkmcnt(2)
    v_mfma_f32_16x16x32_bf16 v[96:99], v[108:111], v[140:143], 0
    v_mfma_f32_16x16x32_bf16 v[92:95], v[108:111], v[136:139], 0
    v_mfma_f32_16x16x32_bf16 v[88:91], v[108:111], v[132:135], 0
    v_mfma_f32_16x16x32_bf16 v[80:83], v[108:111], v[124:127], 0
    v_mfma_f32_16x16x32_bf16 v[76:79], v[108:111], v[120:123], 0
    v_mfma_f32_16x16x32_bf16 v[76:79], v[196:199], v[120:123], v[76:79]
    v_mfma_f32_16x16x32_bf16 v[80:83], v[196:199], v[124:127], v[80:83]
    v_mfma_f32_16x16x32_bf16 v[88:91], v[196:199], v[132:135], v[88:91]
    v_mfma_f32_16x16x32_bf16 v[92:95], v[196:199], v[136:139], v[92:95]
    v_mfma_f32_16x16x32_bf16 v[96:99], v[196:199], v[140:143], v[96:99]
    ds_read_b128 v[108:111], v66 offset:1536
    s_waitcnt lgkmcnt(2)
    v_mfma_f32_16x16x32_bf16 v[96:99], v[112:115], v[136:139], v[96:99]
    v_mfma_f32_16x16x32_bf16 v[92:95], v[112:115], v[132:135], v[92:95]
    v_mfma_f32_16x16x32_bf16 v[88:91], v[112:115], v[128:131], v[88:91]
    v_mfma_f32_16x16x32_bf16 v[80:83], v[112:115], v[120:123], v[80:83]
    ds_read_b128 v[112:115], v66 offset:2048
    ds_read_b128 v[152:155], v67 offset:416
    ds_read_b128 v[156:159], v67 offset:928
    ds_read_b128 v[160:163], v67 offset:1440
    ds_read_b128 v[164:167], v67 offset:1952
    ds_read_b128 v[168:171], v67 offset:2464
    ds_read_b128 v[172:175], v67 offset:2976
    s_waitcnt lgkmcnt(8)
    v_mfma_f32_16x16x32_bf16 v[96:99], v[116:119], v[132:135], v[96:99]
    v_mfma_f32_16x16x32_bf16 v[92:95], v[116:119], v[128:131], v[92:95]
    v_mfma_f32_16x16x32_bf16 v[88:91], v[116:119], v[124:127], v[88:91]
    ds_read_b128 v[116:119], v66 offset:2560
    s_waitcnt lgkmcnt(8)
    v_mfma_f32_16x16x32_bf16 v[96:99], v[108:111], v[128:131], v[96:99]
    v_mfma_f32_16x16x32_bf16 v[92:95], v[108:111], v[124:127], v[92:95]
    v_mfma_f32_16x16x32_bf16 v[88:91], v[108:111], v[120:123], v[88:91]
    ds_read_b128 v[108:111], v66 offset:64
    s_waitcnt lgkmcnt(8)
    v_mfma_f32_16x16x32_bf16 v[96:99], v[112:115], v[124:127], v[96:99]
    v_mfma_f32_16x16x32_bf16 v[92:95], v[112:115], v[120:123], v[92:95]
    ds_read_b128 v[112:115], v66 offset:576
    s_waitcnt lgkmcnt(2)
    v_mfma_f32_16x16x32_bf16 v[96:99], v[116:119], v[120:123], v[96:99]
    ds_read_b128 v[116:119], v66 offset:1088
    s_waitcnt lgkmcnt(2)
    v_mfma_f32_16x16x32_bf16 v[96:99], v[108:111], v[172:175], v[96:99]
    v_mfma_f32_16x16x32_bf16 v[92:95], v[108:111], v[168:171], v[92:95]
    v_mfma_f32_16x16x32_bf16 v[88:91], v[108:111], v[164:167], v[88:91]
    v_mfma_f32_16x16x32_bf16 v[80:83], v[108:111], v[156:159], v[80:83]
    v_mfma_f32_16x16x32_bf16 v[76:79], v[108:111], v[152:155], v[76:79]
    ds_read_b128 v[108:111], v66 offset:1600
    s_waitcnt lgkmcnt(2)
    v_mfma_f32_16x16x32_bf16 v[96:99], v[112:115], v[168:171], v[96:99]
    v_mfma_f32_16x16x32_bf16 v[92:95], v[112:115], v[164:167], v[92:95]
    v_mfma_f32_16x16x32_bf16 v[88:91], v[112:115], v[160:163], v[88:91]
    v_mfma_f32_16x16x32_bf16 v[80:83], v[112:115], v[152:155], v[80:83]
    ds_read_b128 v[112:115], v66 offset:2112
    s_waitcnt lgkmcnt(2)
    v_mfma_f32_16x16x32_bf16 v[96:99], v[116:119], v[164:167], v[96:99]
    v_mfma_f32_16x16x32_bf16 v[92:95], v[116:119], v[160:163], v[92:95]
    v_mfma_f32_16x16x32_bf16 v[88:91], v[116:119], v[156:159], v[88:91]
    ds_read_b128 v[116:119], v66 offset:2624
    s_waitcnt lgkmcnt(2)
    v_mfma_f32_16x16x32_bf16 v[96:99], v[108:111], v[160:163], v[96:99]
    v_mfma_f32_16x16x32_bf16 v[92:95], v[108:111], v[156:159], v[92:95]
    v_mfma_f32_16x16x32_bf16 v[88:91], v[108:111], v[152:155], v[88:91]
    s_waitcnt lgkmcnt(1)
    v_mfma_f32_16x16x32_bf16 v[96:99], v[112:115], v[156:159], v[96:99]
    v_mfma_f32_16x16x32_bf16 v[92:95], v[112:115], v[152:155], v[92:95]
    s_waitcnt lgkmcnt(0)
    v_mfma_f32_16x16x32_bf16 v[96:99], v[116:119], v[152:155], v[96:99]
    ds_write_b128 v74, v[76:79] offset:0
    ds_write_b128 v74, v[80:83] offset:1024
    s_nop 0
    ds_write_b128 v74, v[88:91] offset:3072
    s_nop 1
    ds_write_b128 v74, v[92:95] offset:4096
    s_nop 0
    ds_write_b128 v74, v[96:99] offset:5120
    s_branch c_pw_end_72
c_pw_73:
    s_cmp_lg_u32 s34, 1
    s_cbranch_scc1 c_pw_74
    ds_read_b128 v[108:111], v66 offset:128
    ds_read_b128 v[120:123], v67 offset:352
    ds_read_b128 v[124:127], v67 offset:864
    ds_read_b128 v[128:131], v67 offset:1376
    ds_read_b128 v[132:135], v67 offset:1888
    ds_read_b128 v[136:139], v67 offset:2400
    ds_read_b128 v[140:143], v67 offset:2912
    ds_read_b128 v[112:115], v66 offset:640
    ds_read_b128 v[116:119], v66 offset:1152
    s_waitcnt lgkmcnt(2)
    v_mfma_f32_16x16x32_bf16 v[96:99], v[108:111], v[140:143], 0
    v_mfma_f32_16x16x32_bf16 v[92:95], v[108:111], v[136:139], 0
    v_mfma_f32_16x16x32_bf16 v[88:91], v[108:111], v[132:135], 0
    v_mfma_f32_16x16x32_bf16 v[80:83], v[108:111], v[124:127], 0
    v_mfma_f32_16x16x32_bf16 v[76:79], v[108:111], v[120:123], 0
    ds_read_b128 v[108:111], v66 offset:1664
    s_waitcnt lgkmcnt(2)
    v_mfma_f32_16x16x32_bf16 v[96:99], v[112:115], v[136:139], v[96:99]
    v_mfma_f32_16x16x32_bf16 v[92:95], v[112:115], v[132:135], v[92:95]
    v_mfma_f32_16x16x32_bf16 v[88:91], v[112:115], v[128:131], v[88:91]
    v_mfma_f32_16x16x32_bf16 v[80:83], v[112:115], v[120:123], v[80:83]
    ds_read_b128 v[112:115], v66 offset:2176
    ds_read_b128 v[152:155], v67 offset:288
    ds_read_b128 v[156:159], v67 offset:800
    ds_read_b128 v[160:163], v67 offset:1312
    ds_read_b128 v[164:167], v67 offset:1824
    ds_read_b128 v[168:171], v67 offset:2336
    ds_read_b128 v[172:175], v67 offset:2848
    s_waitcnt lgkmcnt(8)
    v_mfma_f32_16x16x32_bf16 v[96:99], v[116:119], v[132:135], v[96:99]
    v_mfma_f32_16x16x32_bf16 v[92:95], v[116:119], v[128:131], v[92:95]
    v_mfma_f32_16x16x32_bf16 v[88:91], v[116:119], v[124:127], v[88:91]
    ds_read_b128 v[116:119], v66 offset:2688
    s_waitcnt lgkmcnt(8)
    v_mfma_f32_16x16x32_bf16 v[96:99], v[108:111], v[128:131], v[96:99]
    v_mfma_f32_16x16x32_bf16 v[92:95], v[108:111], v[124:127], v[92:95]
    v_mfma_f32_16x16x32_bf16 v[88:91], v[108:111], v[120:123], v[88:91]
    ds_read_b128 v[108:111], v66 offset:192
    s_waitcnt lgkmcnt(8)
    v_mfma_f32_16x16x32_bf16 v[96:99], v[112:115], v[124:127], v[96:99]
    v_mfma_f32_16x16x32_bf16 v[92:95], v[112:115], v[120:123], v[92:95]
    ds_read_b128 v[112:115], v66 offset:704
    s_waitcnt lgkmcnt(2)
    v_mfma_f32_16x16x32_bf16 v[96:99], v[116:119], v[120:123], v[96:99]
    ds_read_b128 v[116:119], v66 offset:1216
    s_waitcnt lgkmcnt(2)
    v_mfma_f32_16x16x32_bf16 v[96:99], v[108:111], v[172:175], v[96:99]
    v_mfma_f32_16x16x32_bf16 v[92:95], v[108:111], v[168:171], v[92:95]
    v_mfma_f32_16x16x32_bf16 v[88:91], v[108:111], v[164:167], v[88:91]
    v_mfma_f32_16x16x32_bf16 v[80:83], v[108:111], v[156:159], v[80:83]
    v_mfma_f32_16x16x32_bf16 v[76:79], v[108:111], v[152:155], v[76:79]
    ds_read_b128 v[108:111], v66 offset:1728
    s_waitcnt lgkmcnt(2)
    v_mfma_f32_16x16x32_bf16 v[96:99], v[112:115], v[168:171], v[96:99]
    v_mfma_f32_16x16x32_bf16 v[92:95], v[112:115], v[164:167], v[92:95]
    v_mfma_f32_16x16x32_bf16 v[88:91], v[112:115], v[160:163], v[88:91]
    v_mfma_f32_16x16x32_bf16 v[80:83], v[112:115], v[152:155], v[80:83]
    ds_read_b128 v[112:115], v66 offset:2240
    s_waitcnt lgkmcnt(2)
    v_mfma_f32_16x16x32_bf16 v[96:99], v[116:119], v[164:167], v[96:99]
    v_mfma_f32_16x16x32_bf16 v[92:95], v[116:119], v[160:163], v[92:95]
    v_mfma_f32_16x16x32_bf16 v[88:91], v[116:119], v[156:159], v[88:91]
    ds_read_b128 v[116:119], v66 offset:2752
    s_waitcnt lgkmcnt(2)
    v_mfma_f32_16x16x32_bf16 v[96:99], v[108:111], v[160:163], v[96:99]
    v_mfma_f32_16x16x32_bf16 v[92:95], v[108:111], v[156:159], v[92:95]
    v_mfma_f32_16x16x32_bf16 v[88:91], v[108:111], v[152:155], v[88:91]
    s_waitcnt lgkmcnt(1)
    v_mfma_f32_16x16x32_bf16 v[96:99], v[112:115], v[156:159], v[96:99]
    v_mfma_f32_16x16x32_bf16 v[92:95], v[112:115], v[152:155], v[92:95]
    s_waitcnt lgkmcnt(0)
    v_mfma_f32_16x16x32_bf16 v[96:99], v[116:119], v[152:155], v[96:99]
    ds_write_b128 v74, v[76:79] offset:0
    ds_write_b128 v74, v[80:83] offset:1024
    s_nop 0
    ds_write_b128 v74, v[88:91] offset:3072
    s_nop 1
    ds_write_b128 v74, v[92:95] offset:4096
    s_nop 0
    ds_write_b128 v74, v[96:99] offset:5120
    s_branch c_pw_end_72
c_pw_74:
    s_cmp_lg_u32 s34, 2
    s_cbranch_scc1 c_pw_75
    ds_read_b128 v[108:111], v66 offset:256
    ds_read_b128 v[120:123], v67 offset:224
    ds_read_b128 v[124:127], v67 offset:736
    ds_read_b128 v[128:131], v67 offset:1248
    ds_read_b128 v[132:135], v67 offset:1760
    ds_read_b128 v[136:139], v67 offset:2272
    ds_read_b128 v[140:143], v67 offset:2784
    ds_read_b128 v[112:115], v66 offset:768
    ds_read_b128 v[116:119], v66 offset:1280
    s_waitcnt lgkmcnt(2)
    v_mfma_f32_16x16x32_bf16 v[96:99], v[108:111], v[140:143], 0
    v_mfma_f32_16x16x32_bf16 v[92:95], v[108:111], v[136:139], 0
    v_mfma_f32_16x16x32_bf16 v[88:91], v[108:111], v[132:135], 0
    v_mfma_f32_16x16x32_bf16 v[80:83], v[108:111], v[124:127], 0
    v_mfma_f32_16x16x32_bf16 v[76:79], v[108:111], v[120:123], 0
    ds_read_b128 v[108:111], v66 offset:1792
    s_waitcnt lgkmcnt(2)
    v_mfma_f32_16x16x32_bf16 v[96:99], v[112:115], v[136:139], v[96:99]
    v_mfma_f32_16x16x32_bf16 v[92:95], v[112:115], v[132:135], v[92:95]
    v_mfma_f32_16x16x32_bf16 v[88:91], v[112:115], v[128:131], v[88:91]
    v_mfma_f32_16x16x32_bf16 v[80:83], v[112:115], v[120:123], v[80:83]
    ds_read_b128 v[112:115], v66 offset:2304
    ds_read_b128 v[152:155], v67 offset:160
    ds_read_b128 v[156:159], v67 offset:672
    ds_read_b128 v[160:163], v67 offset:1184
    ds_read_b128 v[164:167], v67 offset:1696
    ds_read_b128 v[168:171], v67 offset:2208
    ds_read_b128 v[172:175], v67 offset:2720
    s_waitcnt lgkmcnt(8)
    v_mfma_f32_16x16x32_bf16 v[96:99], v[116:119], v[132:135], v[96:99]
    v_mfma_f32_16x16x32_bf16 v[92:95], v[116:119], v[128:131], v[92:95]
    v_mfma_f32_16x16x32_bf16 v[88:91], v[116:119], v[124:127], v[88:91]
    ds_read_b128 v[116:119], v66 offset:2816
    s_waitcnt lgkmcnt(8)
    v_mfma_f32_16x16x32_bf16 v[96:99], v[108:111], v[128:131], v[96:99]
    v_mfma_f32_16x16x32_bf16 v[92:95], v[108:111], v[124:127], v[92:95]
    v_mfma_f32_16x16x32_bf16 v[88:91], v[108:111], v[120:123], v[88:91]
    ds_read_b128 v[108:111], v66 offset:320
    s_waitcnt lgkmcnt(8)
    v_mfma_f32_16x16x32_bf16 v[96:99], v[112:115], v[124:127], v[96:99]
    v_mfma_f32_16x16x32_bf16 v[92:95], v[112:115], v[120:123], v[92:95]
    ds_read_b128 v[112:115], v66 offset:832
    s_waitcnt lgkmcnt(2)
    v_mfma_f32_16x16x32_bf16 v[96:99], v[116:119], v[120:123], v[96:99]
    ds_read_b128 v[116:119], v66 offset:1344
    s_waitcnt lgkmcnt(2)
    v_mfma_f32_16x16x32_bf16 v[96:99], v[108:111], v[172:175], v[96:99]
    v_mfma_f32_16x16x32_bf16 v[92:95], v[108:111], v[168:171], v[92:95]
    v_mfma_f32_16x16x32_bf16 v[88:91], v[108:111], v[164:167], v[88:91]
    v_mfma_f32_16x16x32_bf16 v[80:83], v[108:111], v[156:159], v[80:83]
    v_mfma_f32_16x16x32_bf16 v[76:79], v[108:111], v[152:155], v[76:79]
    ds_read_b128 v[108:111], v66 offset:1856
    s_waitcnt lgkmcnt(2)
    v_mfma_f32_16x16x32_bf16 v[96:99], v[112:115], v[168:171], v[96:99]
    v_mfma_f32_16x16x32_bf16 v[92:95], v[112:115], v[164:167], v[92:95]
    v_mfma_f32_16x16x32_bf16 v[88:91], v[112:115], v[160:163], v[88:91]
    v_mfma_f32_16x16x32_bf16 v[80:83], v[112:115], v[152:155], v[80:83]
    ds_read_b128 v[112:115], v66 offset:2368
    s_waitcnt lgkmcnt(2)
    v_mfma_f32_16x16x32_bf16 v[96:99], v[116:119], v[164:167], v[96:99]
    v_mfma_f32_16x16x32_bf16 v[92:95], v[116:119], v[160:163], v[92:95]
    v_mfma_f32_16x16x32_bf16 v[88:91], v[116:119], v[156:159], v[88:91]
    ds_read_b128 v[116:119], v66 offset:2880
    s_waitcnt lgkmcnt(2)
    v_mfma_f32_16x16x32_bf16 v[96:99], v[108:111], v[160:163], v[96:99]
    v_mfma_f32_16x16x32_bf16 v[92:95], v[108:111], v[156:159], v[92:95]
    v_mfma_f32_16x16x32_bf16 v[88:91], v[108:111], v[152:155], v[88:91]
    s_waitcnt lgkmcnt(1)
    v_mfma_f32_16x16x32_bf16 v[96:99], v[112:115], v[156:159], v[96:99]
    v_mfma_f32_16x16x32_bf16 v[92:95], v[112:115], v[152:155], v[92:95]
    s_waitcnt lgkmcnt(0)
    v_mfma_f32_16x16x32_bf16 v[96:99], v[116:119], v[152:155], v[96:99]
    ds_write_b128 v74, v[76:79] offset:0
    ds_write_b128 v74, v[80:83] offset:1024
    s_nop 0
    ds_write_b128 v74, v[88:91] offset:3072
    s_nop 1
    ds_write_b128 v74, v[92:95] offset:4096
    s_nop 0
    ds_write_b128 v74, v[96:99] offset:5120
    s_branch c_pw_end_72
c_pw_75:
    ds_read_b128 v[108:111], v66 offset:384
    ds_read_b128 v[120:123], v67 offset:96
    ds_read_b128 v[124:127], v67 offset:608
    ds_read_b128 v[128:131], v67 offset:1120
    ds_read_b128 v[132:135], v67 offset:1632
    ds_read_b128 v[136:139], v67 offset:2144
    ds_read_b128 v[140:143], v67 offset:2656
    ds_read_b128 v[112:115], v66 offset:896
    ds_read_b128 v[116:119], v66 offset:1408
    s_waitcnt lgkmcnt(2)
    v_mfma_f32_16x16x32_bf16 v[96:99], v[108:111], v[140:143], 0
    v_mfma_f32_16x16x32_bf16 v[92:95], v[108:111], v[136:139], 0
    v_mfma_f32_16x16x32_bf16 v[88:91], v[108:111], v[132:135], 0
    v_mfma_f32_16x16x32_bf16 v[80:83], v[108:111], v[124:127], 0
    v_mfma_f32_16x16x32_bf16 v[76:79], v[108:111], v[120:123], 0
    ds_read_b128 v[108:111], v66 offset:1920
    s_waitcnt lgkmcnt(2)
    v_mfma_f32_16x16x32_bf16 v[96:99], v[112:115], v[136:139], v[96:99]
    v_mfma_f32_16x16x32_bf16 v[92:95], v[112:115], v[132:135], v[92:95]
    v_mfma_f32_16x16x32_bf16 v[88:91], v[112:115], v[128:131], v[88:91]
    v_mfma_f32_16x16x32_bf16 v[80:83], v[112:115], v[120:123], v[80:83]
    ds_read_b128 v[112:115], v66 offset:2432
    ds_read_b128 v[152:155], v67 offset:32
    ds_read_b128 v[156:159], v67 offset:544
    ds_read_b128 v[160:163], v67 offset:1056
    ds_read_b128 v[164:167], v67 offset:1568
    ds_read_b128 v[168:171], v67 offset:2080
    ds_read_b128 v[172:175], v67 offset:2592
    s_waitcnt lgkmcnt(8)
    v_mfma_f32_16x16x32_bf16 v[96:99], v[116:119], v[132:135], v[96:99]
    v_mfma_f32_16x16x32_bf16 v[92:95], v[116:119], v[128:131], v[92:95]
    v_mfma_f32_16x16x32_bf16 v[88:91], v[116:119], v[124:127], v[88:91]
    ds_read_b128 v[116:119], v66 offset:2944
    s_waitcnt lgkmcnt(8)
    v_mfma_f32_16x16x32_bf16 v[96:99], v[108:111], v[128:131], v[96:99]
    v_mfma_f32_16x16x32_bf16 v[92:95], v[108:111], v[124:127], v[92:95]
    v_mfma_f32_16x16x32_bf16 v[88:91], v[108:111], v[120:123], v[88:91]
    ds_read_b128 v[108:111], v66 offset:448
    s_waitcnt lgkmcnt(8)
    v_mfma_f32_16x16x32_bf16 v[96:99], v[112:115], v[124:127], v[96:99]
    v_mfma_f32_16x16x32_bf16 v[92:95], v[112:115], v[120:123], v[92:95]
    ds_read_b128 v[112:115], v66 offset:960
    s_waitcnt lgkmcnt(2)
    v_mfma_f32_16x16x32_bf16 v[96:99], v[116:119], v[120:123], v[96:99]
    ds_read_b128 v[116:119], v66 offset:1472
    s_waitcnt lgkmcnt(2)
    v_mfma_f32_16x16x32_bf16 v[96:99], v[108:111], v[172:175], v[96:99]
    v_mfma_f32_16x16x32_bf16 v[92:95], v[108:111], v[168:171], v[92:95]
    v_mfma_f32_16x16x32_bf16 v[88:91], v[108:111], v[164:167], v[88:91]
    v_mfma_f32_16x16x32_bf16 v[80:83], v[108:111], v[156:159], v[80:83]
    v_mfma_f32_16x16x32_bf16 v[76:79], v[108:111], v[152:155], v[76:79]
    ds_read_b128 v[108:111], v66 offset:1984
    s_waitcnt lgkmcnt(2)
    v_mfma_f32_16x16x32_bf16 v[96:99], v[112:115], v[168:171], v[96:99]
    v_mfma_f32_16x16x32_bf16 v[92:95], v[112:115], v[164:167], v[92:95]
    v_mfma_f32_16x16x32_bf16 v[88:91], v[112:115], v[160:163], v[88:91]
    v_mfma_f32_16x16x32_bf16 v[80:83], v[112:115], v[152:155], v[80:83]
    ds_read_b128 v[112:115], v66 offset:2496
    s_waitcnt lgkmcnt(2)
    v_mfma_f32_16x16x32_bf16 v[96:99], v[116:119], v[164:167], v[96:99]
    v_mfma_f32_16x16x32_bf16 v[92:95], v[116:119], v[160:163], v[92:95]
    v_mfma_f32_16x16x32_bf16 v[88:91], v[116:119], v[156:159], v[88:91]
    ds_read_b128 v[116:119], v66 offset:3008
    s_waitcnt lgkmcnt(2)
    v_mfma_f32_16x16x32_bf16 v[96:99], v[108:111], v[160:163], v[96:99]
    v_mfma_f32_16x16x32_bf16 v[92:95], v[108:111], v[156:159], v[92:95]
    v_mfma_f32_16x16x32_bf16 v[88:91], v[108:111], v[152:155], v[88:91]
    s_waitcnt lgkmcnt(1)
    v_mfma_f32_16x16x32_bf16 v[96:99], v[112:115], v[156:159], v[96:99]
    v_mfma_f32_16x16x32_bf16 v[92:95], v[112:115], v[152:155], v[92:95]
    s_waitcnt lgkmcnt(0)
    v_mfma_f32_16x16x32_bf16 v[96:99], v[116:119], v[152:155], v[96:99]
    ds_write_b128 v74, v[76:79] offset:0
    ds_write_b128 v74, v[80:83] offset:1024
    s_nop 0
    ds_write_b128 v74, v[88:91] offset:3072
    s_nop 1
    ds_write_b128 v74, v[92:95] offset:4096
    s_nop 0
    ds_write_b128 v74, v[96:99] offset:5120
c_pw_end_72:
    s_waitcnt lgkmcnt(0)
    v_mov_b32 v3, 161796
    v_mov_b32 v4, 1
    s_mov_b64 exec, 1
    ds_add_u32 v3, v4
    s_mov_b64 exec, -1
    s_mov_b32 s67, 0
gsync_77:
    ds_read_b32 v4, v3
    s_add_u32 s67, s67, 1
    s_waitcnt lgkmcnt(0)
    v_readfirstlane_b32 s66, v4
    s_cmp_gt_u32 s67, 1000000
    s_cbranch_scc1 gsync_e_78
    s_cmp_lt_u32 s66, 24
    s_cbranch_scc1 gsync_77
gsync_e_78:
    s_mov_b64 exec, 0
    s_cmp_eq_u32 s34, 0
    s_cselect_b32 exec_lo, -1, exec_lo
    s_cselect_b32 exec_hi, -1, exec_hi
    s_cmp_eq_u32 s34, 1
    s_cselect_b32 exec_lo, 0, exec_lo
    s_cselect_b32 exec_hi, -1, exec_hi
    s_cmp_eq_u32 s34, 2
    s_cselect_b32 exec_lo, -1, exec_lo
    s_cselect_b32 exec_hi, -1, exec_hi
    s_cmp_eq_u32 s34, 3
    s_cselect_b32 exec_lo, 0, exec_lo
    s_cselect_b32 exec_hi, 0, exec_hi
    s_cbranch_execz c_fskip_80
    ds_read_b128 v[120:123], v75 offset:0
    ds_read_b128 v[124:127], v75 offset:16
    ds_read_b128 v[128:131], v75 offset:8192
    ds_read_b128 v[132:135], v75 offset:8208
    ds_read_b128 v[136:139], v75 offset:16384
    ds_read_b128 v[140:143], v75 offset:16400
    ds_read_b128 v[144:147], v75 offset:24576
    ds_read_b128 v[148:151], v75 offset:24592
    s_lshl_b32 s40, s58, 12
    s_add_u32 s40, s40, 8912896
    s_waitcnt lgkmcnt(0)
    v_pk_add_f32 v[120:121], v[120:121], v[128:129]
    v_pk_add_f32 v[136:137], v[136:137], v[144:145]
    v_pk_add_f32 v[122:123], v[122:123], v[130:131]
    v_pk_add_f32 v[138:139], v[138:139], v[146:147]
    v_pk_add_f32 v[124:125], v[124:125], v[132:133]
    v_pk_add_f32 v[140:141], v[140:141], v[148:149]
    v_pk_add_f32 v[126:127], v[126:127], v[134:135]
    v_pk_add_f32 v[142:143], v[142:143], v[150:151]
    v_pk_add_f32 v[120:121], v[120:121], v[136:137]
    v_pk_add_f32 v[122:123], v[122:123], v[138:139]
    v_pk_add_f32 v[124:125], v[124:125], v[140:141]
    v_pk_add_f32 v[126:127], v[126:127], v[142:143]
    v_cvt_pk_bf16_f32 v192, v120, v121
    v_cvt_pk_bf16_f32 v193, v122, v123
    v_cvt_pk_bf16_f32 v194, v124, v125
    v_cvt_pk_bf16_f32 v195, v126, v127
    buffer_store_dwordx4 v[192:195], v2, s[8:11], s40 offen sc1
c_fskip_80:
    s_mov_b64 exec, -1
    s_nop 1
c_halfE_62:
    s_waitcnt vmcnt(0) lgkmcnt(0)
    s_waitcnt lgkmcnt(0)
    v_mov_b32 v251, 161796
    v_mov_b32 v252, 1
    s_mov_b64 exec, 1
    ds_add_u32 v251, v252
    s_mov_b64 exec, -1
    s_mov_b32 s67, 0
gsync_81:
    ds_read_b32 v252, v251
    s_add_u32 s67, s67, 1
    s_waitcnt lgkmcnt(0)
    v_readfirstlane_b32 s66, v252
    s_cmp_gt_u32 s67, 1000000
    s_cbranch_scc1 gsync_e_82
    s_cmp_lt_u32 s66, 28
    s_cbranch_scc1 gsync_81
gsync_e_82:
    s_lshl_b32 s58, s2, 3
    s_add_u32 s58, s58, 14721024
    v_mov_b32 v250, s100
    v_mov_b32 v251, s101
    v_mov_b32 v252, 0
    s_cmp_eq_u32 s34, 0
    s_cselect_b64 exec, 1, 0
    buffer_store_dwordx2 v[250:251], v252, s[8:11], s58 offen sc1
    s_mov_b64 exec, -1
    s_barrier
recurrent_scan__ssm_conv_h3__mixer_gmlp__prompt_kernel_end:
    s_endpgm
.section .rodata,"a"
.p2align 6
.amdhsa_kernel recurrent_scan__ssm_conv_h3__mixer_gmlp__prompt_kernel
  .amdhsa_next_free_vgpr 254
  .amdhsa_next_free_sgpr 102
  .amdhsa_accum_offset 256
  .amdhsa_group_segment_fixed_size 0
  .amdhsa_kernarg_size 112
  .amdhsa_user_sgpr_count 2
  .amdhsa_user_sgpr_kernarg_segment_ptr 1
  .amdhsa_system_sgpr_workgroup_id_x 1
.end_amdhsa_kernel
```

```asm
; @launch grid=(256,1,1) block=(512,1,1) lds=163840
.amdgcn_target "amdgcn-amd-amdhsa--gfx950"
.text
.globl recurrent_scan__ssm_conv_h3__mixer_gmlp__prompt_kernel
.p2align 8
.type recurrent_scan__ssm_conv_h3__mixer_gmlp__prompt_kernel,@function
recurrent_scan__ssm_conv_h3__mixer_gmlp__prompt_kernel:
    s_cmp_ge_u32 s2, 256
    s_cbranch_scc1 recurrent_scan__ssm_conv_h3__mixer_gmlp__prompt_kernel_end
    s_load_dwordx2 s[4:5], s[0:1], 0
    s_load_dwordx2 s[8:9], s[0:1], 56
    s_load_dwordx2 s[12:13], s[0:1], 8
    s_load_dwordx2 s[16:17], s[0:1], 16
    s_load_dwordx2 s[20:21], s[0:1], 24
    s_load_dwordx2 s[24:25], s[0:1], 104
    s_load_dwordx2 s[28:29], s[0:1], 96
    s_load_dwordx2 s[32:33], s[0:1], 64
    s_load_dwordx2 s[36:37], s[0:1], 32
    s_load_dwordx2 s[84:85], s[0:1], 80
    v_lshrrev_b32 v2, 6, v0
    v_and_b32 v1, 63, v0
    v_readfirstlane_b32 s42, v2
    v_lshrrev_b32 v2, 4, v1
    v_and_b32 v3, 15, v1
    s_and_b32 s48, s2, 7
    s_lshr_b32 s49, s2, 3
    s_lshr_b32 s66, s48, 1
    s_and_b32 s67, s48, 1
    s_lshl_b32 s40, s66, 3
    s_and_b32 s48, s49, 7
    s_add_u32 s40, s40, s48
    s_lshl_b32 s41, s67, 2
    s_lshr_b32 s48, s49, 3
    s_add_u32 s41, s41, s48
    s_mul_i32 s52, s40, 81920
    s_mul_i32 s54, s41, 192
    s_add_u32 s53, s54, 1536
    s_lshl_b32 s60, s42, 11
    s_mul_i32 s61, s42, 3072
    s_mov_b32 s6, 2621440
    s_mov_b32 s7, 0x20000
    s_mov_b32 s10, 1966080
    s_mov_b32 s11, 0x20000
    s_lshl_b32 s48, s42, 3
    v_add_u32 v4, s48, v2
    v_and_b32 v5, 15, v4
    v_xor_b32 v5, v5, v3
    v_mul_u32_u24 v4, 1280, v4
    v_lshl_add_u32 v38, v5, 4, v4
    v_add_u32 v4, s48, v2
    v_add_u32 v4, 4, v4
    v_and_b32 v5, 15, v4
    v_xor_b32 v5, v5, v3
    v_mul_u32_u24 v4, 1280, v4
    v_lshl_add_u32 v39, v5, 4, v4
    s_mul_i32 s48, s42, 192
    v_add_u32 v4, s48, v1
    v_mul_u32_u24 v5, 43691, v4
    v_lshrrev_b32 v5, 19, v5
    v_mul_u32_u24 v6, 12, v5
    v_sub_u32 v4, v4, v6
    v_lshrrev_b32 v6, 2, v5
    v_and_b32 v6, 2, v6
    v_xor_b32 v4, v4, v6
    v_mul_u32_u24 v5, 3072, v5
    v_lshl_add_u32 v40, v4, 4, v5
    v_add_u32 v4, s48, v1
    v_add_u32 v4, 64, v4
    v_mul_u32_u24 v5, 43691, v4
    v_lshrrev_b32 v5, 19, v5
    v_mul_u32_u24 v6, 12, v5
    v_sub_u32 v4, v4, v6
    v_lshrrev_b32 v6, 2, v5
    v_and_b32 v6, 2, v6
    v_xor_b32 v4, v4, v6
    v_mul_u32_u24 v5, 3072, v5
    v_lshl_add_u32 v41, v4, 4, v5
    v_add_u32 v4, s48, v1
    v_add_u32 v4, 128, v4
    v_mul_u32_u24 v5, 43691, v4
    v_lshrrev_b32 v5, 19, v5
    v_mul_u32_u24 v6, 12, v5
    v_sub_u32 v4, v4, v6
    v_lshrrev_b32 v6, 2, v5
    v_and_b32 v6, 2, v6
    v_xor_b32 v4, v4, v6
    v_mul_u32_u24 v5, 3072, v5
    v_lshl_add_u32 v42, v4, 4, v5
    s_add_u32 s48, s40, s41
    s_mul_i32 s49, s48, 52
    s_lshr_b32 s49, s49, 8
    s_mul_i32 s49, s49, 5
    s_sub_u32 s51, s48, s49
    s_add_u32 s49, s51, 0
    s_sub_u32 s50, s49, 5
    s_cmp_ge_u32 s49, 5
    s_cselect_b32 s49, s50, s49
    s_lshl_b32 s90, s49, 8
    s_mul_i32 s95, s49, 393216
    s_add_u32 s49, s51, 1
    s_sub_u32 s50, s49, 5
    s_cmp_ge_u32 s49, 5
    s_cselect_b32 s49, s50, s49
    s_lshl_b32 s91, s49, 8
    s_mul_i32 s96, s49, 393216
    s_waitcnt lgkmcnt(0)
    s_add_u32 s65, s52, s90
    s_add_u32 m0, s60, 0
    s_nop 0
    buffer_load_dwordx4 v38, s[4:7], s65 offen lds
    s_add_u32 s65, s52, s90
    s_add_u32 m0, s60, 1024
    s_nop 0
    buffer_load_dwordx4 v39, s[4:7], s65 offen lds
    s_add_u32 s65, s53, s95
    s_add_u32 m0, s61, 81920
    s_nop 0
    buffer_load_dwordx4 v40, s[8:11], s65 offen lds
    s_add_u32 s65, s53, s95
    s_add_u32 m0, s61, 82944
    s_nop 0
    buffer_load_dwordx4 v41, s[8:11], s65 offen lds
    s_add_u32 s65, s53, s95
    s_add_u32 m0, s61, 83968
    s_nop 0
    buffer_load_dwordx4 v42, s[8:11], s65 offen lds
    s_mov_b32 s48, 14712832
    s_load_dwordx2 s[100:101], s[24:25], s48
    s_add_u32 s49, s51, 2
    s_sub_u32 s50, s49, 5
    s_cmp_ge_u32 s49, 5
    s_cselect_b32 s49, s50, s49
    s_lshl_b32 s92, s49, 8
    s_mul_i32 s97, s49, 393216
    s_add_u32 s49, s51, 3
    s_sub_u32 s50, s49, 5
    s_cmp_ge_u32 s49, 5
    s_cselect_b32 s49, s50, s49
    s_lshl_b32 s93, s49, 8
    s_mul_i32 s98, s49, 393216
    s_add_u32 s49, s51, 4
    s_sub_u32 s50, s49, 5
    s_cmp_ge_u32 s49, 5
    s_cselect_b32 s49, s50, s49
    s_lshl_b32 s94, s49, 8
    s_mul_i32 s99, s49, 393216
    s_mov_b32 s14, 2621440
    s_mov_b32 s15, 0x20000
    s_mov_b32 s18, 2621440
    s_mov_b32 s19, 0x20000
    s_mov_b32 s22, 5120
    s_mov_b32 s23, 0x20000
    s_mov_b32 s26, 15990784
    s_mov_b32 s27, 0x20000
    s_mov_b32 s30, 256
    s_mov_b32 s31, 0x20000
    s_mov_b32 s34, 8388608
    s_mov_b32 s35, 0x20000
    s_mov_b32 s38, 2621440
    s_mov_b32 s39, 0x20000
    s_mov_b32 s86, 983040
    s_mov_b32 s87, 0x20000
    v_lshlrev_b32 v36, 7, v1
    v_mov_b32 v4, 161792
    v_mov_b32 v8, 0
    v_mov_b32 v9, 0
    ds_write_b64 v4, v[8:9]
    s_barrier
    s_add_u32 s65, s52, s91
    s_add_u32 m0, s60, 16384
    s_nop 0
    buffer_load_dwordx4 v38, s[4:7], s65 offen lds
    s_add_u32 s65, s52, s91
    s_add_u32 m0, s60, 17408
    s_nop 0
    buffer_load_dwordx4 v39, s[4:7], s65 offen lds
    s_add_u32 s65, s53, s96
    s_add_u32 m0, s61, 106496
    s_nop 0
    buffer_load_dwordx4 v40, s[8:11], s65 offen lds
    s_add_u32 s65, s53, s96
    s_add_u32 m0, s61, 107520
    s_nop 0
    buffer_load_dwordx4 v41, s[8:11], s65 offen lds
    s_add_u32 s65, s53, s96
    s_add_u32 m0, s61, 108544
    s_nop 0
    buffer_load_dwordx4 v42, s[8:11], s65 offen lds
    s_cmp_lg_u32 s42, 7
    s_cbranch_scc1 k1_shk_1
    v_lshlrev_b32 v4, 4, v1
    s_mul_i32 s48, s41, 640
    s_mov_b32 m0, 160768
    s_mov_b32 exec_lo, -1
    s_mov_b32 exec_hi, 0xff
    buffer_load_dwordx4 v4, s[20:23], s48 offen lds
    s_mov_b64 exec, -1
k1_shk_1:
    s_and_b32 s43, s42, 1
    s_lshr_b32 s44, s42, 1
    s_and_b32 s44, s44, 1
    s_lshr_b32 s45, s42, 2
    s_xor_b32 s46, s43, s45
    s_lshl_b32 s47, s44, 1
    s_add_u32 s47, s47, s46
    s_mov_b32 s55, 0x3727c5ac
    s_mov_b32 s56, 0x3f803f80
    s_mov_b32 s58, 0xbdd2d3e8
    s_mov_b32 s59, 0xbdd2d3e8
    s_lshl_b32 s48, s45, 1
    s_add_u32 s63, s48, s44
    s_xor_b32 s64, s63, 1
    v_xor_b32 v4, v2, v3
    v_lshlrev_b32 v6, 8, v3
    s_lshl_b32 s48, s44, 13
    s_lshl_b32 s49, s46, 12
    s_add_u32 s50, s48, s49
    s_xor_b32 s49, s49, 4096
    s_add_u32 s51, s48, s49
    s_lshl_b32 s48, s63, 2
    v_xor_b32 v5, s48, v4
    v_lshl_add_u32 v5, v5, 4, v6
    v_add_u32 v45, s50, v5
    v_add_u32 v46, s51, v5
    s_lshl_b32 s48, s64, 2
    v_xor_b32 v5, s48, v4
    v_lshl_add_u32 v5, v5, 4, v6
    v_add_u32 v47, s50, v5
    v_add_u32 v216, s51, v5
    v_lshrrev_b32 v5, 2, v3
    v_lshl_add_u32 v4, v2, 3, v5
    v_mul_u32_u24 v4, 192, v4
    v_and_b32 v5, 3, v3
    v_lshl_add_u32 v4, v5, 3, v4
    v_and_b32 v5, 1, v2
    s_mul_i32 s51, s43, 3
    s_mul_i32 s49, s63, 6144
    s_add_u32 s49, s49, 81920
    s_mul_i32 s50, s64, 6144
    s_add_u32 s50, s50, 81920
    s_add_u32 s48, s51, 0
    v_xor_b32 v6, s48, v5
    v_lshl_add_u32 v6, v6, 5, v4
    v_add_u32 v217, s49, v6
    v_add_u32 v220, s50, v6
    s_add_u32 s48, s51, 1
    v_xor_b32 v6, s48, v5
    v_lshl_add_u32 v6, v6, 5, v4
    v_add_u32 v218, s49, v6
    v_add_u32 v221, s50, v6
    s_add_u32 s48, s51, 2
    v_xor_b32 v6, s48, v5
    v_lshl_add_u32 v6, v6, 5, v4
    v_add_u32 v219, s49, v6
    v_add_u32 v222, s50, v6
    v_mov_b32 v244, s56
    v_mov_b32 v245, s56
    v_mov_b32 v246, s56
    v_mov_b32 v247, s56
    v_mul_u32_u24 v43, 205, v1
    v_lshrrev_b32 v43, 11, v43
    v_mul_u32_u24 v4, 10, v43
    v_sub_u32 v44, v1, v4
    s_lshl_b32 s48, s42, 3
    v_lshl_add_u32 v4, v43, 1, s48
    v_min_u32 v4, 62, v4
    v_mul_u32_u24 v4, 160, v4
    v_lshl_add_u32 v7, v44, 4, v4
    v_lshlrev_b32 v215, 10, v1
    s_lshl_b32 s89, s2, 3
    s_add_u32 s89, s89, s42
    s_mul_i32 s70, s42, 3072
    s_add_u32 s70, s70, 16384
    s_xor_b32 s48, s42, 4
    s_mul_i32 s71, s48, 3072
    s_add_u32 s71, s71, 16384
    s_lshl_b32 s48, s43, 2
    s_lshl_b32 s49, s44, 1
    s_add_u32 s48, s48, s49
    s_add_u32 s48, s48, s45
    s_mul_i32 s72, s48, 192
    s_add_u32 s72, s72, 155648
    s_mul_i32 s73, s43, 768
    s_add_u32 s73, s73, 155648
    s_lshl_b32 s48, s47, 1
    s_add_u32 s48, s48, s45
    s_lshl_b32 s48, s48, 7
    s_add_u32 s74, s48, 158720
    s_lshl_b32 s48, s47, 8
    s_add_u32 s75, s48, 158720
    s_lshl_b32 s48, s47, 7
    s_lshl_b32 s49, s43, 9
    s_add_u32 s48, s48, s49
    s_add_u32 s76, s48, 159744
    s_lshl_b32 s48, s40, 3
    s_add_u32 s48, s48, s41
    s_lshl_b32 s49, s48, 10
    s_add_u32 s77, s49, 14745600
    s_mov_b32 s48, 0
    s_lshr_b32 s49, s47, 1
    s_mul_i32 s49, s49, 6144
    s_add_u32 s48, s48, s49
    s_and_b32 s49, s47, 1
    s_lshl_b32 s49, s49, 8
    s_add_u32 s48, s48, s49
    s_add_u32 s48, s48, 73728
    s_mul_i32 s49, s43, 3
    s_add_u32 s49, s49, 0
    s_lshr_b32 s50, s49, 1
    s_lshl_b32 s50, s50, 10
    s_and_b32 s49, s49, 1
    s_lshl_b32 s49, s49, 3
    s_add_u32 s80, s48, s49
    s_add_u32 s80, s80, s50
    s_mul_i32 s49, s43, 3
    s_add_u32 s49, s49, 1
    s_lshr_b32 s50, s49, 1
    s_lshl_b32 s50, s50, 10
    s_and_b32 s49, s49, 1
    s_lshl_b32 s49, s49, 3
    s_add_u32 s81, s48, s49
    s_add_u32 s81, s81, s50
    s_mul_i32 s49, s43, 3
    s_add_u32 s49, s49, 2
    s_lshr_b32 s50, s49, 1
    s_lshl_b32 s50, s50, 10
    s_and_b32 s49, s49, 1
    s_lshl_b32 s49, s49, 3
    s_add_u32 s82, s48, s49
    s_add_u32 s82, s82, s50
    s_lshl_b32 s48, s40, 13
    s_lshl_b32 s49, s47, 8
    s_add_u32 s48, s48, s49
    s_add_u32 s78, s48, 14745600
    s_lshl_b32 s48, s40, 9
    s_lshl_b32 s49, s47, 7
    s_add_u32 s48, s48, s49
    s_add_u32 s79, s48, 14680064
    s_mul_i32 s48, s41, 327680
    s_lshl_b32 s49, s40, 7
    s_add_u32 s48, s48, s49
    s_add_u32 s83, s48, 6291456
    s_lshr_b32 s48, s2, 3
    s_lshl_b32 s48, s48, 3
    s_add_u32 s48, s48, s42
    s_lshl_b32 s48, s48, 13
    s_lshl_b32 s49, s66, 21
    s_add_u32 s66, s48, s49
    s_add_u32 s51, s42, 0
    s_mul_i32 s48, s51, 43
    s_lshr_b32 s48, s48, 7
    s_mul_i32 s49, s48, 3
    s_sub_u32 s49, s51, s49
    s_mul_i32 s48, s48, 3200
    s_lshl_b32 s49, s49, 6
    s_add_u32 s48, s48, s49
    s_add_u32 s88, s48, 0
    s_lshl_b32 s48, s41, 7
    s_lshl_b32 s49, s40, 2
    s_add_u32 s48, s48, s49
    s_mul_i32 s48, s48, 3
    s_add_u32 s48, s48, s51
    s_lshl_b32 s48, s48, 10
    s_add_u32 s64, s48, 0
    s_add_u32 s51, s42, 8
    s_mul_i32 s48, s51, 43
    s_lshr_b32 s48, s48, 7
    s_mul_i32 s49, s48, 3
    s_sub_u32 s49, s51, s49
    s_mul_i32 s48, s48, 3200
    s_lshl_b32 s49, s49, 6
    s_add_u32 s48, s48, s49
    s_add_u32 s63, s48, 0
    s_lshl_b32 s48, s41, 7
    s_lshl_b32 s49, s40, 2
    s_add_u32 s48, s48, s49
    s_mul_i32 s48, s48, 3
    s_add_u32 s48, s48, s51
    s_lshl_b32 s48, s48, 10
    s_add_u32 s67, s48, 0
    s_waitcnt vmcnt(5)
    s_waitcnt lgkmcnt(0)
    s_add_u32 s100, s100, 1
    s_addc_u32 s101, s101, 0
    s_barrier
    ds_read_b64_tr_b16 v[128:129], v217 offset:0
    ds_read_b64_tr_b16 v[130:131], v217 offset:768
    ds_read_b64_tr_b16 v[132:133], v218 offset:0
    ds_read_b64_tr_b16 v[134:135], v218 offset:768
    ds_read_b64_tr_b16 v[136:137], v219 offset:0
    ds_read_b64_tr_b16 v[138:139], v219 offset:768
    ds_read_b64_tr_b16 v[140:141], v220 offset:0
    ds_read_b64_tr_b16 v[142:143], v220 offset:768
    ds_read_b64_tr_b16 v[144:145], v221 offset:0
    ds_read_b64_tr_b16 v[146:147], v221 offset:768
    ds_read_b64_tr_b16 v[148:149], v222 offset:0
    ds_read_b64_tr_b16 v[150:151], v222 offset:768
    ds_read_b128 v[48:51], v45 offset:0
    ds_read_b128 v[52:55], v46 offset:0
    ds_read_b128 v[56:59], v47 offset:0
    ds_read_b128 v[60:63], v216 offset:0
    s_add_u32 s65, s52, s92
    s_add_u32 m0, s60, 32768
    s_nop 0
    buffer_load_dwordx4 v38, s[4:7], s65 offen lds
    s_add_u32 s65, s52, s92
    s_add_u32 m0, s60, 33792
    s_nop 0
    buffer_load_dwordx4 v39, s[4:7], s65 offen lds
    s_add_u32 s65, s53, s97
    s_add_u32 m0, s61, 131072
    s_nop 0
    buffer_load_dwordx4 v40, s[8:11], s65 offen lds
    s_add_u32 s65, s53, s97
    s_add_u32 m0, s61, 132096
    s_nop 0
    buffer_load_dwordx4 v41, s[8:11], s65 offen lds
    s_add_u32 s65, s53, s97
    s_add_u32 m0, s61, 133120
    s_nop 0
    buffer_load_dwordx4 v42, s[8:11], s65 offen lds
    s_waitcnt vmcnt(5)
    s_waitcnt lgkmcnt(0)
    s_barrier
    v_mfma_f32_16x16x32_bf16 v[176:179], v[128:131], v[48:51], 0
    ds_read_b64_tr_b16 v[152:153], v217 offset:24576
    ds_read_b64_tr_b16 v[154:155], v217 offset:25344
    v_mfma_f32_16x16x32_bf16 v[180:183], v[128:131], v[52:55], 0
    s_add_u32 s65, s52, s93
    s_add_u32 m0, s60, 49152
    s_nop 0
    buffer_load_dwordx4 v38, s[4:7], s65 offen lds
    ds_read_b64_tr_b16 v[156:157], v218 offset:24576
    ds_read_b64_tr_b16 v[158:159], v218 offset:25344
    v_mfma_f32_16x16x32_bf16 v[224:227], v[128:131], v[244:247], 0
    ds_read_b64_tr_b16 v[160:161], v219 offset:24576
    ds_read_b64_tr_b16 v[162:163], v219 offset:25344
    v_mfma_f32_16x16x32_bf16 v[184:187], v[132:135], v[48:51], 0
    ds_read_b64_tr_b16 v[164:165], v220 offset:24576
    ds_read_b64_tr_b16 v[166:167], v220 offset:25344
    v_mfma_f32_16x16x32_bf16 v[188:191], v[132:135], v[52:55], 0
    s_add_u32 s65, s52, s93
    s_add_u32 m0, s60, 50176
    s_nop 0
    buffer_load_dwordx4 v39, s[4:7], s65 offen lds
    ds_read_b64_tr_b16 v[168:169], v221 offset:24576
    ds_read_b64_tr_b16 v[170:171], v221 offset:25344
    v_mfma_f32_16x16x32_bf16 v[228:231], v[132:135], v[244:247], 0
    ds_read_b64_tr_b16 v[172:173], v222 offset:24576
    ds_read_b64_tr_b16 v[174:175], v222 offset:25344
    v_mfma_f32_16x16x32_bf16 v[192:195], v[136:139], v[48:51], 0
    ds_read_b128 v[64:67], v45 offset:16384
    ds_read_b128 v[68:71], v46 offset:16384
    v_mfma_f32_16x16x32_bf16 v[196:199], v[136:139], v[52:55], 0
    s_add_u32 s65, s53, s98
    s_add_u32 m0, s61, 81920
    s_nop 0
    buffer_load_dwordx4 v40, s[8:11], s65 offen lds
    ds_read_b128 v[72:75], v47 offset:16384
    ds_read_b128 v[76:79], v216 offset:16384
    v_mfma_f32_16x16x32_bf16 v[232:235], v[136:139], v[244:247], 0
    v_mfma_f32_16x16x32_bf16 v[236:239], v[244:247], v[48:51], 0
    v_mfma_f32_16x16x32_bf16 v[240:243], v[48:51], v[48:51], 0
    s_add_u32 s65, s53, s98
    s_add_u32 m0, s61, 82944
    s_nop 0
    buffer_load_dwordx4 v41, s[8:11], s65 offen lds
    v_mfma_f32_16x16x32_bf16 v[176:179], v[140:143], v[56:59], v[176:179]
    v_mfma_f32_16x16x32_bf16 v[180:183], v[140:143], v[60:63], v[180:183]
    v_mfma_f32_16x16x32_bf16 v[184:187], v[144:147], v[56:59], v[184:187]
    s_add_u32 s65, s53, s98
    s_add_u32 m0, s61, 83968
    s_nop 0
    buffer_load_dwordx4 v42, s[8:11], s65 offen lds
    v_mfma_f32_16x16x32_bf16 v[188:191], v[144:147], v[60:63], v[188:191]
    v_mfma_f32_16x16x32_bf16 v[192:195], v[148:151], v[56:59], v[192:195]
    v_mfma_f32_16x16x32_bf16 v[196:199], v[148:151], v[60:63], v[196:199]
    v_mfma_f32_16x16x32_bf16 v[236:239], v[244:247], v[56:59], v[236:239]
    v_mfma_f32_16x16x32_bf16 v[240:243], v[56:59], v[56:59], v[240:243]
    s_waitcnt vmcnt(5)
    s_waitcnt lgkmcnt(0)
    s_barrier
    v_mfma_f32_16x16x32_bf16 v[176:179], v[152:155], v[64:67], v[176:179]
    ds_read_b64_tr_b16 v[128:129], v217 offset:49152
    ds_read_b64_tr_b16 v[130:131], v217 offset:49920
    v_mfma_f32_16x16x32_bf16 v[180:183], v[152:155], v[68:71], v[180:183]
    s_add_u32 s65, s52, s94
    s_add_u32 m0, s60, 65536
    s_nop 0
    buffer_load_dwordx4 v38, s[4:7], s65 offen lds
    ds_read_b64_tr_b16 v[132:133], v218 offset:49152
    ds_read_b64_tr_b16 v[134:135], v218 offset:49920
    v_mfma_f32_16x16x32_bf16 v[224:227], v[152:155], v[244:247], v[224:227]
    ds_read_b64_tr_b16 v[136:137], v219 offset:49152
    ds_read_b64_tr_b16 v[138:139], v219 offset:49920
    v_mfma_f32_16x16x32_bf16 v[184:187], v[156:159], v[64:67], v[184:187]
    ds_read_b64_tr_b16 v[140:141], v220 offset:49152
    ds_read_b64_tr_b16 v[142:143], v220 offset:49920
    v_mfma_f32_16x16x32_bf16 v[188:191], v[156:159], v[68:71], v[188:191]
    s_add_u32 s65, s52, s94
    s_add_u32 m0, s60, 66560
    s_nop 0
    buffer_load_dwordx4 v39, s[4:7], s65 offen lds
    ds_read_b64_tr_b16 v[144:145], v221 offset:49152
    ds_read_b64_tr_b16 v[146:147], v221 offset:49920
    v_mfma_f32_16x16x32_bf16 v[228:231], v[156:159], v[244:247], v[228:231]
    ds_read_b64_tr_b16 v[148:149], v222 offset:49152
    ds_read_b64_tr_b16 v[150:151], v222 offset:49920
    v_mfma_f32_16x16x32_bf16 v[192:195], v[160:163], v[64:67], v[192:195]
    ds_read_b128 v[80:83], v45 offset:32768
    ds_read_b128 v[84:87], v46 offset:32768
    v_mfma_f32_16x16x32_bf16 v[196:199], v[160:163], v[68:71], v[196:199]
    s_add_u32 s65, s53, s99
    s_add_u32 m0, s61, 106496
    s_nop 0
    buffer_load_dwordx4 v40, s[8:11], s65 offen lds
    ds_read_b128 v[88:91], v47 offset:32768
    ds_read_b128 v[92:95], v216 offset:32768
    v_mfma_f32_16x16x32_bf16 v[232:235], v[160:163], v[244:247], v[232:235]
    v_mfma_f32_16x16x32_bf16 v[236:239], v[244:247], v[64:67], v[236:239]
    v_mfma_f32_16x16x32_bf16 v[240:243], v[64:67], v[64:67], v[240:243]
    s_add_u32 s65, s53, s99
    s_add_u32 m0, s61, 107520
    s_nop 0
    buffer_load_dwordx4 v41, s[8:11], s65 offen lds
    v_mfma_f32_16x16x32_bf16 v[176:179], v[164:167], v[72:75], v[176:179]
    v_mfma_f32_16x16x32_bf16 v[180:183], v[164:167], v[76:79], v[180:183]
    v_mfma_f32_16x16x32_bf16 v[184:187], v[168:171], v[72:75], v[184:187]
    s_add_u32 s65, s53, s99
    s_add_u32 m0, s61, 108544
    s_nop 0
    buffer_load_dwordx4 v42, s[8:11], s65 offen lds
    v_mfma_f32_16x16x32_bf16 v[188:191], v[168:171], v[76:79], v[188:191]
    v_mfma_f32_16x16x32_bf16 v[192:195], v[172:175], v[72:75], v[192:195]
    v_mfma_f32_16x16x32_bf16 v[196:199], v[172:175], v[76:79], v[196:199]
    v_mfma_f32_16x16x32_bf16 v[236:239], v[244:247], v[72:75], v[236:239]
    v_mfma_f32_16x16x32_bf16 v[240:243], v[72:75], v[72:75], v[240:243]
    s_waitcnt vmcnt(5)
    s_waitcnt lgkmcnt(0)
    s_barrier
    v_mfma_f32_16x16x32_bf16 v[176:179], v[128:131], v[80:83], v[176:179]
    ds_read_b64_tr_b16 v[152:153], v217 offset:0
    ds_read_b64_tr_b16 v[154:155], v217 offset:768
    v_mfma_f32_16x16x32_bf16 v[180:183], v[128:131], v[84:87], v[180:183]
    s_add_u32 s65, s54, s95
    s_add_u32 m0, s61, 131072
    s_nop 0
    buffer_load_dwordx4 v40, s[8:11], s65 offen lds
    ds_read_b64_tr_b16 v[156:157], v218 offset:0
    ds_read_b64_tr_b16 v[158:159], v218 offset:768
    v_mfma_f32_16x16x32_bf16 v[224:227], v[128:131], v[244:247], v[224:227]
    ds_read_b64_tr_b16 v[160:161], v219 offset:0
    ds_read_b64_tr_b16 v[162:163], v219 offset:768
    v_mfma_f32_16x16x32_bf16 v[184:187], v[132:135], v[80:83], v[184:187]
    ds_read_b64_tr_b16 v[164:165], v220 offset:0
    ds_read_b64_tr_b16 v[166:167], v220 offset:768
    v_mfma_f32_16x16x32_bf16 v[188:191], v[132:135], v[84:87], v[188:191]
    s_add_u32 s65, s54, s95
    s_add_u32 m0, s61, 132096
    s_nop 0
    buffer_load_dwordx4 v41, s[8:11], s65 offen lds
    ds_read_b64_tr_b16 v[168:169], v221 offset:0
    ds_read_b64_tr_b16 v[170:171], v221 offset:768
    v_mfma_f32_16x16x32_bf16 v[228:231], v[132:135], v[244:247], v[228:231]
    ds_read_b64_tr_b16 v[172:173], v222 offset:0
    ds_read_b64_tr_b16 v[174:175], v222 offset:768
    v_mfma_f32_16x16x32_bf16 v[192:195], v[136:139], v[80:83], v[192:195]
    ds_read_b128 v[96:99], v45 offset:49152
    ds_read_b128 v[100:103], v46 offset:49152
    v_mfma_f32_16x16x32_bf16 v[196:199], v[136:139], v[84:87], v[196:199]
    s_add_u32 s65, s54, s95
    s_add_u32 m0, s61, 133120
    s_nop 0
    buffer_load_dwordx4 v42, s[8:11], s65 offen lds
    ds_read_b128 v[104:107], v47 offset:49152
    ds_read_b128 v[108:111], v216 offset:49152
    v_mfma_f32_16x16x32_bf16 v[232:235], v[136:139], v[244:247], v[232:235]
    v_mfma_f32_16x16x32_bf16 v[236:239], v[244:247], v[80:83], v[236:239]
    v_mfma_f32_16x16x32_bf16 v[240:243], v[80:83], v[80:83], v[240:243]
    s_mul_i32 s48, s89, 1280
    s_add_u32 s48, s48, 0
    s_mov_b64 exec, 0x1f
    buffer_load_dword v37, v36, s[36:39], s48 offen
    s_mov_b64 exec, -1
    v_mfma_f32_16x16x32_bf16 v[176:179], v[140:143], v[88:91], v[176:179]
    v_mfma_f32_16x16x32_bf16 v[180:183], v[140:143], v[92:95], v[180:183]
    v_mfma_f32_16x16x32_bf16 v[184:187], v[144:147], v[88:91], v[184:187]
    v_mfma_f32_16x16x32_bf16 v[188:191], v[144:147], v[92:95], v[188:191]
    v_mfma_f32_16x16x32_bf16 v[192:195], v[148:151], v[88:91], v[192:195]
    v_mfma_f32_16x16x32_bf16 v[196:199], v[148:151], v[92:95], v[196:199]
    v_mfma_f32_16x16x32_bf16 v[236:239], v[244:247], v[88:91], v[236:239]
    v_mfma_f32_16x16x32_bf16 v[240:243], v[88:91], v[88:91], v[240:243]
    s_waitcnt vmcnt(4)
    s_waitcnt lgkmcnt(0)
    s_barrier
    v_mfma_f32_16x16x32_bf16 v[176:179], v[152:155], v[96:99], v[176:179]
    ds_read_b64_tr_b16 v[128:129], v217 offset:24576
    ds_read_b64_tr_b16 v[130:131], v217 offset:25344
    v_mfma_f32_16x16x32_bf16 v[180:183], v[152:155], v[100:103], v[180:183]
    s_add_u32 s65, s54, s96
    s_add_u32 m0, s61, 81920
    s_nop 0
    buffer_load_dwordx4 v40, s[8:11], s65 offen lds
    ds_read_b64_tr_b16 v[132:133], v218 offset:24576
    ds_read_b64_tr_b16 v[134:135], v218 offset:25344
    v_mfma_f32_16x16x32_bf16 v[224:227], v[152:155], v[244:247], v[224:227]
    ds_read_b64_tr_b16 v[136:137], v219 offset:24576
    ds_read_b64_tr_b16 v[138:139], v219 offset:25344
    v_mfma_f32_16x16x32_bf16 v[184:187], v[156:159], v[96:99], v[184:187]
    ds_read_b64_tr_b16 v[140:141], v220 offset:24576
    ds_read_b64_tr_b16 v[142:143], v220 offset:25344
    v_mfma_f32_16x16x32_bf16 v[188:191], v[156:159], v[100:103], v[188:191]
    s_add_u32 s65, s54, s96
    s_add_u32 m0, s61, 82944
    s_nop 0
    buffer_load_dwordx4 v41, s[8:11], s65 offen lds
    ds_read_b64_tr_b16 v[144:145], v221 offset:24576
    ds_read_b64_tr_b16 v[146:147], v221 offset:25344
    v_mfma_f32_16x16x32_bf16 v[228:231], v[156:159], v[244:247], v[228:231]
    ds_read_b64_tr_b16 v[148:149], v222 offset:24576
    ds_read_b64_tr_b16 v[150:151], v222 offset:25344
    v_mfma_f32_16x16x32_bf16 v[192:195], v[160:163], v[96:99], v[192:195]
    v_add_u32 v45, 0x10000, v45
    v_add_u32 v46, 0x10000, v46
    v_add_u32 v47, 0x10000, v47
    v_add_u32 v216, 0x10000, v216
    ds_read_b128 v[112:115], v45 offset:0
    ds_read_b128 v[116:119], v46 offset:0
    v_mfma_f32_16x16x32_bf16 v[196:199], v[160:163], v[100:103], v[196:199]
    s_add_u32 s65, s54, s96
    s_add_u32 m0, s61, 83968
    s_nop 0
    buffer_load_dwordx4 v42, s[8:11], s65 offen lds
    ds_read_b128 v[120:123], v47 offset:0
    ds_read_b128 v[124:127], v216 offset:0
    v_mfma_f32_16x16x32_bf16 v[232:235], v[160:163], v[244:247], v[232:235]
    v_mfma_f32_16x16x32_bf16 v[236:239], v[244:247], v[96:99], v[236:239]
    v_mfma_f32_16x16x32_bf16 v[240:243], v[96:99], v[96:99], v[240:243]
    v_mfma_f32_16x16x32_bf16 v[176:179], v[164:167], v[104:107], v[176:179]
    v_mfma_f32_16x16x32_bf16 v[180:183], v[164:167], v[108:111], v[180:183]
    v_mfma_f32_16x16x32_bf16 v[184:187], v[168:171], v[104:107], v[184:187]
    v_mfma_f32_16x16x32_bf16 v[188:191], v[168:171], v[108:111], v[188:191]
    v_mfma_f32_16x16x32_bf16 v[192:195], v[172:175], v[104:107], v[192:195]
    v_mfma_f32_16x16x32_bf16 v[196:199], v[172:175], v[108:111], v[196:199]
    v_mfma_f32_16x16x32_bf16 v[236:239], v[244:247], v[104:107], v[236:239]
    v_mfma_f32_16x16x32_bf16 v[240:243], v[104:107], v[104:107], v[240:243]
    s_waitcnt vmcnt(4)
    s_waitcnt lgkmcnt(0)
    s_barrier
    v_mfma_f32_16x16x32_bf16 v[176:179], v[128:131], v[112:115], v[176:179]
    ds_read_b64_tr_b16 v[152:153], v217 offset:49152
    ds_read_b64_tr_b16 v[154:155], v217 offset:49920
    v_mfma_f32_16x16x32_bf16 v[180:183], v[128:131], v[116:119], v[180:183]
    s_add_u32 s65, s54, s97
    s_add_u32 m0, s61, 106496
    s_nop 0
    buffer_load_dwordx4 v40, s[8:11], s65 offen lds
    ds_read_b64_tr_b16 v[156:157], v218 offset:49152
    ds_read_b64_tr_b16 v[158:159], v218 offset:49920
    v_mfma_f32_16x16x32_bf16 v[224:227], v[128:131], v[244:247], v[224:227]
    ds_read_b64_tr_b16 v[160:161], v219 offset:49152
    ds_read_b64_tr_b16 v[162:163], v219 offset:49920
    v_mfma_f32_16x16x32_bf16 v[184:187], v[132:135], v[112:115], v[184:187]
    ds_read_b64_tr_b16 v[164:165], v220 offset:49152
    ds_read_b64_tr_b16 v[166:167], v220 offset:49920
    v_mfma_f32_16x16x32_bf16 v[188:191], v[132:135], v[116:119], v[188:191]
    s_add_u32 s65, s54, s97
    s_add_u32 m0, s61, 107520
    s_nop 0
    buffer_load_dwordx4 v41, s[8:11], s65 offen lds
    ds_read_b64_tr_b16 v[168:169], v221 offset:49152
    ds_read_b64_tr_b16 v[170:171], v221 offset:49920
    v_mfma_f32_16x16x32_bf16 v[228:231], v[132:135], v[244:247], v[228:231]
    ds_read_b64_tr_b16 v[172:173], v222 offset:49152
    ds_read_b64_tr_b16 v[174:175], v222 offset:49920
    v_mfma_f32_16x16x32_bf16 v[192:195], v[136:139], v[112:115], v[192:195]
    v_mfma_f32_16x16x32_bf16 v[196:199], v[136:139], v[116:119], v[196:199]
    s_add_u32 s65, s54, s97
    s_add_u32 m0, s61, 108544
    s_nop 0
    buffer_load_dwordx4 v42, s[8:11], s65 offen lds
    v_mfma_f32_16x16x32_bf16 v[232:235], v[136:139], v[244:247], v[232:235]
    v_mfma_f32_16x16x32_bf16 v[236:239], v[244:247], v[112:115], v[236:239]
    v_mfma_f32_16x16x32_bf16 v[240:243], v[112:115], v[112:115], v[240:243]
    v_mfma_f32_16x16x32_bf16 v[176:179], v[140:143], v[120:123], v[176:179]
    v_mfma_f32_16x16x32_bf16 v[180:183], v[140:143], v[124:127], v[180:183]
    v_mfma_f32_16x16x32_bf16 v[184:187], v[144:147], v[120:123], v[184:187]
    v_mfma_f32_16x16x32_bf16 v[188:191], v[144:147], v[124:127], v[188:191]
    v_mfma_f32_16x16x32_bf16 v[192:195], v[148:151], v[120:123], v[192:195]
    v_mfma_f32_16x16x32_bf16 v[196:199], v[148:151], v[124:127], v[196:199]
    v_mfma_f32_16x16x32_bf16 v[236:239], v[244:247], v[120:123], v[236:239]
    v_mfma_f32_16x16x32_bf16 v[240:243], v[120:123], v[120:123], v[240:243]
    v_lshl_add_u32 v4, v1, 4, s70
    v_lshl_add_u32 v5, v2, 4, s72
    ds_write_b128 v4, v[180:183] offset:0
    s_nop 0
    ds_write_b128 v4, v[188:191] offset:1024
    s_nop 0
    ds_write_b128 v4, v[196:199] offset:2048
    s_mov_b32 exec_lo, 0x00010001
    s_mov_b32 exec_hi, 0x00010001
    ds_write_b128 v5, v[224:227] offset:0
    ds_write_b128 v5, v[228:231] offset:64
    ds_write_b128 v5, v[232:235] offset:128
    s_mov_b64 exec, -1
    v_and_b32 v8, 3, v3
    v_cmp_eq_u32 vcc, 1, v8
    s_nop 1
    v_cndmask_b32 v237, v240, v241, vcc
    v_cmp_eq_u32 vcc, 2, v8
    s_nop 1
    v_cndmask_b32 v237, v237, v242, vcc
    v_cmp_eq_u32 vcc, 3, v8
    s_nop 1
    v_cndmask_b32 v237, v237, v243, vcc
    v_lshl_add_u32 v6, v3, 3, s74
    s_mov_b32 exec_lo, 0x00F0000F
    s_mov_b32 exec_hi, 0xF0000F00
    ds_write_b64 v6, v[236:237]
    s_mov_b64 exec, -1
    v_pk_add_f32 v[200:201], v[176:177], 0
    v_pk_add_f32 v[202:203], v[178:179], 0
    v_pk_add_f32 v[204:205], v[184:185], 0
    v_pk_add_f32 v[206:207], v[186:187], 0
    v_pk_add_f32 v[208:209], v[192:193], 0
    v_pk_add_f32 v[210:211], v[194:195], 0
    v_mov_b32 v238, 0xc0135761
    v_mov_b32 v239, 0xc0135761
    s_waitcnt vmcnt(3)
    s_waitcnt lgkmcnt(0)
    s_barrier
    v_lshl_add_u32 v4, v1, 4, s71
    v_lshl_add_u32 v5, v3, 3, s75
    ds_read_b64 v[20:21], v5
    ds_read_b64 v[22:23], v5 offset:128
    ds_read_b128 v[8:11], v4 offset:0
    ds_read_b128 v[12:15], v4 offset:1024
    ds_read_b128 v[16:19], v4 offset:2048
    v_lshl_add_u32 v6, v2, 4, s73
    ds_read_b128 v[24:27], v6 offset:0
    ds_read_b128 v[28:31], v6 offset:64
    ds_read_b128 v[32:35], v6 offset:128
    ds_read_b128 v[176:179], v6 offset:192
    ds_read_b128 v[180:183], v6 offset:256
    ds_read_b128 v[184:187], v6 offset:320
    ds_read_b128 v[188:191], v6 offset:384
    ds_read_b128 v[192:195], v6 offset:448
    ds_read_b128 v[196:199], v6 offset:512
    ds_read_b128 v[224:227], v6 offset:576
    ds_read_b128 v[228:231], v6 offset:640
    ds_read_b128 v[232:235], v6 offset:704
    s_waitcnt lgkmcnt(15)
    v_pk_add_f32 v[240:241], v[20:21], v[22:23]
    v_mul_f32 v240, 0x3acccccd, v240
    v_mul_f32 v241, 0x3acccccd, v241
    v_fma_f32 v241, -v240, v240, v241
    v_max_f32 v241, 0, v241
    v_cvt_pk_bf16_f32 v241, v241, v240
    v_and_b32 v240, 0xffff0000, v241
    v_lshlrev_b32 v241, 16, v241
    v_add_f32 v241, s55, v241
    v_cvt_pk_bf16_f32 v241, v241, v241
    v_and_b32 v241, 0xffff0000, v241
    v_sqrt_f32 v241, v241
    s_nop 0
    v_cvt_pk_bf16_f32 v241, v241, v241
    v_and_b32 v241, 0xffff0000, v241
    v_rcp_f32 v241, v241
    s_nop 0
    v_mov_b32 v242, v241
    s_waitcnt lgkmcnt(12)
    v_pk_add_f32 v[200:201], v[200:201], v[8:9]
    v_pk_add_f32 v[202:203], v[202:203], v[10:11]
    v_pk_add_f32 v[204:205], v[204:205], v[12:13]
    v_pk_add_f32 v[206:207], v[206:207], v[14:15]
    v_pk_add_f32 v[208:209], v[208:209], v[16:17]
    v_pk_add_f32 v[210:211], v[210:211], v[18:19]
    s_waitcnt lgkmcnt(6)
    v_pk_add_f32 v[24:25], v[24:25], v[176:177]
    v_pk_add_f32 v[26:27], v[26:27], v[178:179]
    v_pk_add_f32 v[28:29], v[28:29], v[180:181]
    v_pk_add_f32 v[30:31], v[30:31], v[182:183]
    v_pk_add_f32 v[32:33], v[32:33], v[184:185]
    v_pk_add_f32 v[34:35], v[34:35], v[186:187]
    s_waitcnt lgkmcnt(0)
    v_pk_add_f32 v[188:189], v[188:189], v[224:225]
    v_pk_add_f32 v[190:191], v[190:191], v[226:227]
    v_pk_add_f32 v[192:193], v[192:193], v[228:229]
    v_pk_add_f32 v[194:195], v[194:195], v[230:231]
    v_pk_add_f32 v[196:197], v[196:197], v[232:233]
    v_pk_add_f32 v[198:199], v[198:199], v[234:235]
    v_pk_add_f32 v[24:25], v[24:25], v[188:189]
    v_pk_add_f32 v[26:27], v[26:27], v[190:191]
    v_pk_add_f32 v[28:29], v[28:29], v[192:193]
    v_pk_add_f32 v[30:31], v[30:31], v[194:195]
    v_pk_add_f32 v[32:33], v[32:33], v[196:197]
    v_pk_add_f32 v[34:35], v[34:35], v[198:199]
    v_pk_fma_f32 v[200:201], v[24:25], v[240:241], v[200:201] op_sel_hi:[1,0,1] neg_lo:[0,1,0] neg_hi:[0,1,0]
    v_pk_fma_f32 v[202:203], v[26:27], v[240:241], v[202:203] op_sel_hi:[1,0,1] neg_lo:[0,1,0] neg_hi:[0,1,0]
    v_pk_fma_f32 v[204:205], v[28:29], v[240:241], v[204:205] op_sel_hi:[1,0,1] neg_lo:[0,1,0] neg_hi:[0,1,0]
    v_pk_fma_f32 v[206:207], v[30:31], v[240:241], v[206:207] op_sel_hi:[1,0,1] neg_lo:[0,1,0] neg_hi:[0,1,0]
    v_pk_fma_f32 v[208:209], v[32:33], v[240:241], v[208:209] op_sel_hi:[1,0,1] neg_lo:[0,1,0] neg_hi:[0,1,0]
    v_pk_fma_f32 v[210:211], v[34:35], v[240:241], v[210:211] op_sel_hi:[1,0,1] neg_lo:[0,1,0] neg_hi:[0,1,0]
    v_pk_mul_f32 v[200:201], v[200:201], v[242:243] op_sel_hi:[1,0]
    v_pk_mul_f32 v[202:203], v[202:203], v[242:243] op_sel_hi:[1,0]
    v_pk_mul_f32 v[204:205], v[204:205], v[242:243] op_sel_hi:[1,0]
    v_pk_mul_f32 v[206:207], v[206:207], v[242:243] op_sel_hi:[1,0]
    v_pk_mul_f32 v[208:209], v[208:209], v[242:243] op_sel_hi:[1,0]
    v_pk_mul_f32 v[210:211], v[210:211], v[242:243] op_sel_hi:[1,0]
    v_pk_mul_f32 v[8:9], v[200:201], v[200:201]
    v_pk_mul_f32 v[10:11], v[202:203], v[202:203]
    v_pk_mul_f32 v[12:13], v[204:205], v[204:205]
    v_pk_mul_f32 v[14:15], v[206:207], v[206:207]
    v_pk_mul_f32 v[16:17], v[208:209], v[208:209]
    v_pk_mul_f32 v[18:19], v[210:211], v[210:211]
    v_pk_fma_f32 v[8:9], v[8:9], s[58:59], v[238:239]
    v_pk_fma_f32 v[10:11], v[10:11], s[58:59], v[238:239]
    v_pk_fma_f32 v[12:13], v[12:13], s[58:59], v[238:239]
    v_pk_fma_f32 v[14:15], v[14:15], s[58:59], v[238:239]
    v_pk_fma_f32 v[16:17], v[16:17], s[58:59], v[238:239]
    v_pk_fma_f32 v[18:19], v[18:19], s[58:59], v[238:239]
    v_pk_mul_f32 v[8:9], v[8:9], v[200:201]
    v_pk_mul_f32 v[10:11], v[10:11], v[202:203]
    v_pk_mul_f32 v[12:13], v[12:13], v[204:205]
    v_pk_mul_f32 v[14:15], v[14:15], v[206:207]
    v_pk_mul_f32 v[16:17], v[16:17], v[208:209]
    v_pk_mul_f32 v[18:19], v[18:19], v[210:211]
    v_exp_f32 v8, v8
    v_exp_f32 v9, v9
    v_exp_f32 v10, v10
    v_exp_f32 v11, v11
    v_exp_f32 v12, v12
    v_exp_f32 v13, v13
    v_exp_f32 v14, v14
    v_exp_f32 v15, v15
    v_exp_f32 v16, v16
    v_exp_f32 v17, v17
    v_exp_f32 v18, v18
    v_exp_f32 v19, v19
    v_pk_add_f32 v[8:9], v[8:9], 1.0 op_sel_hi:[1,0]
    v_pk_add_f32 v[10:11], v[10:11], 1.0 op_sel_hi:[1,0]
    v_pk_add_f32 v[12:13], v[12:13], 1.0 op_sel_hi:[1,0]
    v_pk_add_f32 v[14:15], v[14:15], 1.0 op_sel_hi:[1,0]
    v_pk_add_f32 v[16:17], v[16:17], 1.0 op_sel_hi:[1,0]
    v_pk_add_f32 v[18:19], v[18:19], 1.0 op_sel_hi:[1,0]
    v_rcp_f32 v8, v8
    v_rcp_f32 v9, v9
    v_rcp_f32 v10, v10
    v_rcp_f32 v11, v11
    v_rcp_f32 v12, v12
    v_rcp_f32 v13, v13
    v_rcp_f32 v14, v14
    v_rcp_f32 v15, v15
    v_rcp_f32 v16, v16
    v_rcp_f32 v17, v17
    v_rcp_f32 v18, v18
    v_rcp_f32 v19, v19
    v_pk_mul_f32 v[200:201], v[200:201], v[8:9]
    v_pk_mul_f32 v[202:203], v[202:203], v[10:11]
    v_pk_mul_f32 v[204:205], v[204:205], v[12:13]
    v_pk_mul_f32 v[206:207], v[206:207], v[14:15]
    v_pk_mul_f32 v[208:209], v[208:209], v[16:17]
    v_pk_mul_f32 v[210:211], v[210:211], v[18:19]
    v_pk_add_f32 v[14:15], v[200:201], v[202:203]
    v_pk_mul_f32 v[16:17], v[200:201], v[200:201]
    v_pk_add_f32 v[18:19], v[204:205], v[206:207]
    v_pk_fma_f32 v[16:17], v[202:203], v[202:203], v[16:17]
    v_pk_add_f32 v[20:21], v[208:209], v[210:211]
    v_pk_fma_f32 v[16:17], v[204:205], v[204:205], v[16:17]
    v_pk_add_f32 v[14:15], v[14:15], v[18:19]
    v_pk_fma_f32 v[16:17], v[206:207], v[206:207], v[16:17]
    v_pk_add_f32 v[14:15], v[14:15], v[20:21]
    v_pk_fma_f32 v[16:17], v[208:209], v[208:209], v[16:17]
    v_pk_fma_f32 v[16:17], v[210:211], v[210:211], v[16:17]
    v_add_f32 v8, v14, v15
    v_add_f32 v9, v16, v17
    v_lshl_add_u32 v4, v3, 3, s76
    v_mov_b32 v12, v8
    v_mov_b32 v13, v9
    s_nop 0
    v_permlane16_swap_b32 v8, v12
    v_permlane16_swap_b32 v9, v13
    v_add_f32 v8, v8, v12
    v_add_f32 v9, v9, v13
    v_mov_b32 v12, v8
    v_mov_b32 v13, v9
    s_nop 0
    v_permlane32_swap_b32 v8, v12
    v_permlane32_swap_b32 v9, v13
    v_add_f32 v8, v8, v12
    v_add_f32 v9, v9, v13
    s_mov_b64 exec, 0xffff
    ds_write_b64 v4, v[8:9]
    s_mov_b64 exec, -1
    s_or_b32 s48, s41, s43
    s_cmp_eq_u32 s48, 0
    v_lshlrev_b32 v4, 3, v3
    s_cselect_b64 exec, 0xffff, 0
    buffer_store_dwordx2 v[240:241], v4, s[24:27], s79 offen sc1
    s_mov_b64 exec, -1
    v_mfma_f32_16x16x32_bf16 v[176:179], v[152:155], v[48:51], 0
    ds_read_b64_tr_b16 v[128:129], v217 offset:0
    ds_read_b64_tr_b16 v[130:131], v217 offset:768
    v_mfma_f32_16x16x32_bf16 v[180:183], v[152:155], v[52:55], 0
    s_add_u32 s65, s54, s98
    s_add_u32 m0, s61, 131072
    s_nop 0
    buffer_load_dwordx4 v40, s[8:11], s65 offen lds
    ds_read_b64_tr_b16 v[132:133], v218 offset:0
    ds_read_b64_tr_b16 v[134:135], v218 offset:768
    v_mfma_f32_16x16x32_bf16 v[224:227], v[152:155], v[244:247], 0
    ds_read_b64_tr_b16 v[136:137], v219 offset:0
    ds_read_b64_tr_b16 v[138:139], v219 offset:768
    v_mfma_f32_16x16x32_bf16 v[184:187], v[156:159], v[48:51], 0
    ds_read_b64_tr_b16 v[140:141], v220 offset:0
    ds_read_b64_tr_b16 v[142:143], v220 offset:768
    v_mfma_f32_16x16x32_bf16 v[188:191], v[156:159], v[52:55], 0
    s_add_u32 s65, s54, s98
    s_add_u32 m0, s61, 132096
    s_nop 0
    buffer_load_dwordx4 v41, s[8:11], s65 offen lds
    ds_read_b64_tr_b16 v[144:145], v221 offset:0
    ds_read_b64_tr_b16 v[146:147], v221 offset:768
    v_mfma_f32_16x16x32_bf16 v[228:231], v[156:159], v[244:247], 0
    ds_read_b64_tr_b16 v[148:149], v222 offset:0
    ds_read_b64_tr_b16 v[150:151], v222 offset:768
    v_mfma_f32_16x16x32_bf16 v[192:195], v[160:163], v[48:51], 0
    v_mfma_f32_16x16x32_bf16 v[196:199], v[160:163], v[52:55], 0
    s_add_u32 s65, s54, s98
    s_add_u32 m0, s61, 133120
    s_nop 0
    buffer_load_dwordx4 v42, s[8:11], s65 offen lds
    v_mfma_f32_16x16x32_bf16 v[232:235], v[160:163], v[244:247], 0
    v_mfma_f32_16x16x32_bf16 v[176:179], v[164:167], v[56:59], v[176:179]
    v_mfma_f32_16x16x32_bf16 v[180:183], v[164:167], v[60:63], v[180:183]
    v_mul_u32_u24 v4, 1280, v43
    v_lshl_add_u32 v4, v44, 4, v4
    s_mul_i32 s51, s41, 160
    s_add_u32 s51, s51, s52
    s_mul_i32 s48, s42, 7680
    s_add_u32 s48, s48, s51
    s_sub_i32 s48, s48, 3840
    s_cmp_lt_i32 s48, 0
    s_cselect_b32 s49, 3840, 0
    s_add_u32 s48, s48, s49
    v_subrev_u32 v5, s49, v4
    s_mul_i32 s50, s42, 960
    s_add_u32 m0, s50, 65536
    s_mov_b32 exec_lo, -1
    s_mov_b32 exec_hi, 0xfffffff
    buffer_load_dwordx4 v5, s[12:15], s48 offen lds
    s_mov_b64 exec, -1
    v_mfma_f32_16x16x32_bf16 v[184:187], v[168:171], v[56:59], v[184:187]
    v_mfma_f32_16x16x32_bf16 v[188:191], v[168:171], v[60:63], v[188:191]
    v_mfma_f32_16x16x32_bf16 v[192:195], v[172:175], v[56:59], v[192:195]
    s_cmp_ge_u32 s42, 4
    s_mov_b32 exec_lo, -1
    s_mov_b32 exec_hi, 0xfffffff
    s_cbranch_scc1 k1_kvv_2
    s_mul_i32 s48, s42, 7680
    s_add_u32 s48, s48, s51
    s_add_u32 s48, s48, 57600
    s_mul_i32 s50, s42, 960
    s_add_u32 m0, s50, 73216
    s_nop 0
    buffer_load_dwordx4 v4, s[12:15], s48 offen lds
    s_branch k1_kve_3
k1_kvv_2:
    s_sub_u32 s49, s42, 4
    s_mul_i32 s48, s49, 7680
    s_add_u32 s48, s48, s51
    s_mul_i32 s50, s49, 960
    s_add_u32 m0, s50, 49152
    s_nop 0
    buffer_load_dwordx4 v4, s[16:19], s48 offen lds
k1_kve_3:
    s_mov_b64 exec, -1
    v_mfma_f32_16x16x32_bf16 v[196:199], v[172:175], v[60:63], v[196:199]
    s_add_u32 s49, s42, 4
    s_mul_i32 s48, s49, 7680
    s_add_u32 s48, s48, s51
    s_mul_i32 s50, s49, 960
    s_add_u32 m0, s50, 49152
    s_mov_b32 exec_lo, -1
    s_mov_b32 exec_hi, 0xfffffff
    buffer_load_dwordx4 v4, s[16:19], s48 offen lds
    s_mov_b64 exec, -1
    s_mul_i32 s48, s89, 1280
    s_add_u32 s48, s48, 640
    s_mov_b64 exec, 0x1f
    buffer_load_dword v37, v36, s[36:39], s48 offen
    s_mov_b64 exec, -1
    s_waitcnt vmcnt(8)
    s_waitcnt lgkmcnt(0)
    s_barrier
    s_cmp_lg_u32 s42, 0
    s_cbranch_scc1 k1_pub_4
    v_lshlrev_b32 v4, 3, v1
    v_add_u32 v5, 159744, v4
    ds_read_b64 v[8:9], v5
    ds_read_b64 v[12:13], v5 offset:512
    v_lshlrev_b32 v4, 4, v1
    v_mov_b32 v10, s100
    v_mov_b32 v11, s101
    s_waitcnt lgkmcnt(0)
    v_pk_add_f32 v[8:9], v[8:9], v[12:13]
k1_pub_4:
    s_cmp_eq_u32 s42, 0
    s_cselect_b64 exec, -1, 0
    buffer_store_dwordx4 v[8:11], v4, s[24:27], s77 offen sc1
    s_mov_b64 exec, -1
    v_mfma_f32_16x16x32_bf16 v[176:179], v[128:131], v[64:67], v[176:179]
    ds_read_b64_tr_b16 v[152:153], v217 offset:24576
    ds_read_b64_tr_b16 v[154:155], v217 offset:25344
    v_mfma_f32_16x16x32_bf16 v[180:183], v[128:131], v[68:71], v[180:183]
    s_add_u32 s65, s54, s99
    s_add_u32 m0, s61, 81920
    s_nop 0
    buffer_load_dwordx4 v40, s[8:11], s65 offen lds
    ds_read_b64_tr_b16 v[156:157], v218 offset:24576
    ds_read_b64_tr_b16 v[158:159], v218 offset:25344
    v_mfma_f32_16x16x32_bf16 v[224:227], v[128:131], v[244:247], v[224:227]
    ds_read_b64_tr_b16 v[160:161], v219 offset:24576
    ds_read_b64_tr_b16 v[162:163], v219 offset:25344
    v_mfma_f32_16x16x32_bf16 v[184:187], v[132:135], v[64:67], v[184:187]
    ds_read_b64_tr_b16 v[164:165], v220 offset:24576
    ds_read_b64_tr_b16 v[166:167], v220 offset:25344
    v_mfma_f32_16x16x32_bf16 v[188:191], v[132:135], v[68:71], v[188:191]
    s_add_u32 s65, s54, s99
    s_add_u32 m0, s61, 82944
    s_nop 0
    buffer_load_dwordx4 v41, s[8:11], s65 offen lds
    ds_read_b64_tr_b16 v[168:169], v221 offset:24576
    ds_read_b64_tr_b16 v[170:171], v221 offset:25344
    v_mfma_f32_16x16x32_bf16 v[228:231], v[132:135], v[244:247], v[228:231]
    ds_read_b64_tr_b16 v[172:173], v222 offset:24576
    ds_read_b64_tr_b16 v[174:175], v222 offset:25344
    v_mfma_f32_16x16x32_bf16 v[192:195], v[136:139], v[64:67], v[192:195]
    v_mfma_f32_16x16x32_bf16 v[196:199], v[136:139], v[68:71], v[196:199]
    s_add_u32 s65, s54, s99
    s_add_u32 m0, s61, 83968
    s_nop 0
    buffer_load_dwordx4 v42, s[8:11], s65 offen lds
    v_mfma_f32_16x16x32_bf16 v[232:235], v[136:139], v[244:247], v[232:235]
    v_mfma_f32_16x16x32_bf16 v[176:179], v[140:143], v[72:75], v[176:179]
    v_mfma_f32_16x16x32_bf16 v[180:183], v[140:143], v[76:79], v[180:183]
    v_mfma_f32_16x16x32_bf16 v[184:187], v[144:147], v[72:75], v[184:187]
    v_mfma_f32_16x16x32_bf16 v[188:191], v[144:147], v[76:79], v[188:191]
    v_mfma_f32_16x16x32_bf16 v[192:195], v[148:151], v[72:75], v[192:195]
    v_mfma_f32_16x16x32_bf16 v[196:199], v[148:151], v[76:79], v[196:199]
    s_waitcnt vmcnt(8)
    s_waitcnt lgkmcnt(0)
    s_barrier
    v_mfma_f32_16x16x32_bf16 v[176:179], v[152:155], v[80:83], v[176:179]
    ds_read_b64_tr_b16 v[128:129], v217 offset:49152
    ds_read_b64_tr_b16 v[130:131], v217 offset:49920
    v_mfma_f32_16x16x32_bf16 v[180:183], v[152:155], v[84:87], v[180:183]
    s_add_u32 s48, s66, 0
    s_mov_b64 exec, 0xff
    buffer_load_dword v37, v215, s[32:35], s48 offen
    s_mov_b64 exec, -1
    ds_read_b64_tr_b16 v[132:133], v218 offset:49152
    ds_read_b64_tr_b16 v[134:135], v218 offset:49920
    v_mfma_f32_16x16x32_bf16 v[224:227], v[152:155], v[244:247], v[224:227]
    ds_read_b64_tr_b16 v[136:137], v219 offset:49152
    ds_read_b64_tr_b16 v[138:139], v219 offset:49920
    v_mfma_f32_16x16x32_bf16 v[184:187], v[156:159], v[80:83], v[184:187]
    ds_read_b64_tr_b16 v[140:141], v220 offset:49152
    ds_read_b64_tr_b16 v[142:143], v220 offset:49920
    v_mfma_f32_16x16x32_bf16 v[188:191], v[156:159], v[84:87], v[188:191]
    s_add_u32 s48, s66, 128
    s_mov_b64 exec, 0xff
    buffer_load_dword v37, v215, s[32:35], s48 offen
    s_mov_b64 exec, -1
    ds_read_b64_tr_b16 v[144:145], v221 offset:49152
    ds_read_b64_tr_b16 v[146:147], v221 offset:49920
    v_mfma_f32_16x16x32_bf16 v[228:231], v[156:159], v[244:247], v[228:231]
    ds_read_b64_tr_b16 v[148:149], v222 offset:49152
    ds_read_b64_tr_b16 v[150:151], v222 offset:49920
    v_mfma_f32_16x16x32_bf16 v[192:195], v[160:163], v[80:83], v[192:195]
    v_mfma_f32_16x16x32_bf16 v[196:199], v[160:163], v[84:87], v[196:199]
    s_add_u32 s48, s66, 256
    s_mov_b64 exec, 0xff
    buffer_load_dword v37, v215, s[32:35], s48 offen
    s_mov_b64 exec, -1
    v_mfma_f32_16x16x32_bf16 v[232:235], v[160:163], v[244:247], v[232:235]
    v_mfma_f32_16x16x32_bf16 v[176:179], v[164:167], v[88:91], v[176:179]
    v_mfma_f32_16x16x32_bf16 v[180:183], v[164:167], v[92:95], v[180:183]
    s_add_u32 s48, s66, 384
    s_mov_b64 exec, 0xff
    buffer_load_dword v37, v215, s[32:35], s48 offen
    s_mov_b64 exec, -1
    v_mfma_f32_16x16x32_bf16 v[184:187], v[168:171], v[88:91], v[184:187]
    v_mfma_f32_16x16x32_bf16 v[188:191], v[168:171], v[92:95], v[188:191]
    v_mfma_f32_16x16x32_bf16 v[192:195], v[172:175], v[88:91], v[192:195]
    s_mul_i32 s48, s89, 512
    s_add_u32 s48, s48, 0
    s_mov_b64 exec, 0xf
    buffer_load_dword v37, v36, s[84:87], s48 offen
    s_mov_b64 exec, -1
    v_mfma_f32_16x16x32_bf16 v[196:199], v[172:175], v[92:95], v[196:199]
    s_waitcnt vmcnt(5)
    s_waitcnt lgkmcnt(0)
    s_barrier
    v_lshlrev_b32 v38, 4, v3
    v_lshl_add_u32 v38, v2, 11, v38
    buffer_load_dwordx4 v[28:31], v38, s[24:27], s78 offen sc1
    buffer_load_dwordx4 v[32:35], v38, s[24:27], s78 offen offset:1024 sc1
    v_mfma_f32_16x16x32_bf16 v[176:179], v[128:131], v[96:99], v[176:179]
    ds_read_b64_tr_b16 v[152:153], v217 offset:0
    ds_read_b64_tr_b16 v[154:155], v217 offset:768
    v_mfma_f32_16x16x32_bf16 v[180:183], v[128:131], v[100:103], v[180:183]
    s_add_u32 s48, s66, 512
    s_mov_b64 exec, 0xff
    buffer_load_dword v37, v215, s[32:35], s48 offen
    s_mov_b64 exec, -1
    ds_read_b64_tr_b16 v[156:157], v218 offset:0
    ds_read_b64_tr_b16 v[158:159], v218 offset:768
    v_mfma_f32_16x16x32_bf16 v[224:227], v[128:131], v[244:247], v[224:227]
    ds_read_b64_tr_b16 v[160:161], v219 offset:0
    ds_read_b64_tr_b16 v[162:163], v219 offset:768
    v_mfma_f32_16x16x32_bf16 v[184:187], v[132:135], v[96:99], v[184:187]
    ds_read_b64_tr_b16 v[164:165], v220 offset:0
    ds_read_b64_tr_b16 v[166:167], v220 offset:768
    v_mfma_f32_16x16x32_bf16 v[188:191], v[132:135], v[100:103], v[188:191]
    s_add_u32 s48, s66, 640
    s_mov_b64 exec, 0xff
    buffer_load_dword v37, v215, s[32:35], s48 offen
    s_mov_b64 exec, -1
    ds_read_b64_tr_b16 v[168:169], v221 offset:0
    ds_read_b64_tr_b16 v[170:171], v221 offset:768
    v_mfma_f32_16x16x32_bf16 v[228:231], v[132:135], v[244:247], v[228:231]
    ds_read_b64_tr_b16 v[172:173], v222 offset:0
    ds_read_b64_tr_b16 v[174:175], v222 offset:768
    v_mfma_f32_16x16x32_bf16 v[192:195], v[136:139], v[96:99], v[192:195]
    v_mfma_f32_16x16x32_bf16 v[196:199], v[136:139], v[100:103], v[196:199]
    s_add_u32 s48, s66, 768
    s_mov_b64 exec, 0xff
    buffer_load_dword v37, v215, s[32:35], s48 offen
    s_mov_b64 exec, -1
    v_mfma_f32_16x16x32_bf16 v[232:235], v[136:139], v[244:247], v[232:235]
    v_mfma_f32_16x16x32_bf16 v[176:179], v[140:143], v[104:107], v[176:179]
    v_mfma_f32_16x16x32_bf16 v[180:183], v[140:143], v[108:111], v[180:183]
    s_add_u32 s48, s66, 896
    s_mov_b64 exec, 0xff
    buffer_load_dword v37, v215, s[32:35], s48 offen
    s_mov_b64 exec, -1
    v_mfma_f32_16x16x32_bf16 v[184:187], v[144:147], v[104:107], v[184:187]
    v_mfma_f32_16x16x32_bf16 v[188:191], v[144:147], v[108:111], v[188:191]
    v_mfma_f32_16x16x32_bf16 v[192:195], v[148:151], v[104:107], v[192:195]
    v_mfma_f32_16x16x32_bf16 v[196:199], v[148:151], v[108:111], v[196:199]
    v_add_u32 v4, 65536, v7
    ds_read_b128 v[48:51], v4 offset:0
    ds_read_b128 v[52:55], v4 offset:160
    ds_read_b128 v[56:59], v4 offset:320
    ds_read_b128 v[60:63], v4 offset:480
    ds_read_b128 v[64:67], v4 offset:640
    v_add_u32 v4, 49152, v7
    ds_read_b128 v[68:71], v4
    ds_read_b128 v[72:75], v4 offset:160
    s_waitcnt lgkmcnt(0)
    v_mul_u32_u24 v7, 1152, v44
    v_lshlrev_b32 v102, 2, v43
    v_sub_u32 v7, v7, v102
    s_lshl_b32 s48, s42, 4
    s_add_u32 s48, s48, 106508
    v_add_u32 v7, s48, v7
    v_lshlrev_b32 v44, 6, v44
    v_add_u32 v44, 160768, v44
    ds_read_b128 v[104:107], v44 offset:0
    ds_read_b128 v[108:111], v44 offset:16
    v_lshlrev_b32 v76, 16, v48
    v_and_b32 v77, 0xffff0000, v48
    v_lshlrev_b32 v78, 16, v52
    v_and_b32 v79, 0xffff0000, v52
    v_lshlrev_b32 v80, 16, v56
    v_and_b32 v81, 0xffff0000, v56
    v_lshlrev_b32 v82, 16, v60
    v_and_b32 v83, 0xffff0000, v60
    v_lshlrev_b32 v84, 16, v64
    v_and_b32 v85, 0xffff0000, v64
    s_waitcnt lgkmcnt(0)
    v_lshlrev_b32 v86, 16, v104
    v_lshlrev_b32 v87, 16, v106
    v_and_b32 v88, 0xffff0000, v104
    v_and_b32 v89, 0xffff0000, v106
    v_lshlrev_b32 v90, 16, v105
    v_lshlrev_b32 v91, 16, v107
    v_and_b32 v92, 0xffff0000, v105
    v_and_b32 v93, 0xffff0000, v107
    v_pk_mul_f32 v[94:95], v[82:83], v[86:87]
    v_pk_mul_f32 v[96:97], v[84:85], v[86:87]
    v_pk_fma_f32 v[94:95], v[80:81], v[88:89], v[94:95]
    v_pk_fma_f32 v[96:97], v[82:83], v[88:89], v[96:97]
    v_pk_fma_f32 v[94:95], v[78:79], v[90:91], v[94:95]
    v_pk_fma_f32 v[96:97], v[80:81], v[90:91], v[96:97]
    v_pk_fma_f32 v[94:95], v[76:77], v[92:93], v[94:95]
    v_pk_fma_f32 v[96:97], v[78:79], v[92:93], v[96:97]
    v_lshlrev_b32 v98, 16, v68
    v_and_b32 v99, 0xffff0000, v68
    v_lshlrev_b32 v100, 16, v72
    v_and_b32 v101, 0xffff0000, v72
    v_pk_mul_f32 v[94:95], v[94:95], v[98:99]
    v_pk_mul_f32 v[96:97], v[96:97], v[100:101]
    v_cvt_pk_bf16_f32 v102, v96, v94
    v_cvt_pk_bf16_f32 v103, v97, v95
    s_mov_b32 exec_hi, 0xff
    ds_write_b32 v7, v102 offset:0
    ds_write_b32 v7, v103 offset:144
    s_mov_b32 exec_hi, -1
    v_lshlrev_b32 v76, 16, v49
    v_and_b32 v77, 0xffff0000, v49
    v_lshlrev_b32 v78, 16, v53
    v_and_b32 v79, 0xffff0000, v53
    v_lshlrev_b32 v80, 16, v57
    v_and_b32 v81, 0xffff0000, v57
    v_lshlrev_b32 v82, 16, v61
    v_and_b32 v83, 0xffff0000, v61
    v_lshlrev_b32 v84, 16, v65
    v_and_b32 v85, 0xffff0000, v65
    v_lshlrev_b32 v86, 16, v108
    v_lshlrev_b32 v87, 16, v110
    v_and_b32 v88, 0xffff0000, v108
    v_and_b32 v89, 0xffff0000, v110
    v_lshlrev_b32 v90, 16, v109
    v_lshlrev_b32 v91, 16, v111
    v_and_b32 v92, 0xffff0000, v109
    v_and_b32 v93, 0xffff0000, v111
    v_pk_mul_f32 v[94:95], v[82:83], v[86:87]
    v_pk_mul_f32 v[96:97], v[84:85], v[86:87]
    v_pk_fma_f32 v[94:95], v[80:81], v[88:89], v[94:95]
    v_pk_fma_f32 v[96:97], v[82:83], v[88:89], v[96:97]
    v_pk_fma_f32 v[94:95], v[78:79], v[90:91], v[94:95]
    v_pk_fma_f32 v[96:97], v[80:81], v[90:91], v[96:97]
    v_pk_fma_f32 v[94:95], v[76:77], v[92:93], v[94:95]
    v_pk_fma_f32 v[96:97], v[78:79], v[92:93], v[96:97]
    v_lshlrev_b32 v98, 16, v69
    v_and_b32 v99, 0xffff0000, v69
    v_lshlrev_b32 v100, 16, v73
    v_and_b32 v101, 0xffff0000, v73
    v_pk_mul_f32 v[94:95], v[94:95], v[98:99]
    v_pk_mul_f32 v[96:97], v[96:97], v[100:101]
    v_cvt_pk_bf16_f32 v102, v96, v94
    v_cvt_pk_bf16_f32 v103, v97, v95
    s_mov_b32 exec_hi, 0xff
    ds_write_b32 v7, v102 offset:288
    ds_write_b32 v7, v103 offset:432
    s_mov_b32 exec_hi, -1
    ds_read_b128 v[104:107], v44 offset:32
    ds_read_b128 v[108:111], v44 offset:48
    v_lshlrev_b32 v76, 16, v50
    v_and_b32 v77, 0xffff0000, v50
    v_lshlrev_b32 v78, 16, v54
    v_and_b32 v79, 0xffff0000, v54
    v_lshlrev_b32 v80, 16, v58
    v_and_b32 v81, 0xffff0000, v58
    v_lshlrev_b32 v82, 16, v62
    v_and_b32 v83, 0xffff0000, v62
    v_lshlrev_b32 v84, 16, v66
    v_and_b32 v85, 0xffff0000, v66
    s_waitcnt lgkmcnt(0)
    v_lshlrev_b32 v86, 16, v104
    v_lshlrev_b32 v87, 16, v106
    v_and_b32 v88, 0xffff0000, v104
    v_and_b32 v89, 0xffff0000, v106
    v_lshlrev_b32 v90, 16, v105
    v_lshlrev_b32 v91, 16, v107
    v_and_b32 v92, 0xffff0000, v105
    v_and_b32 v93, 0xffff0000, v107
    v_pk_mul_f32 v[94:95], v[82:83], v[86:87]
    v_pk_mul_f32 v[96:97], v[84:85], v[86:87]
    v_pk_fma_f32 v[94:95], v[80:81], v[88:89], v[94:95]
    v_pk_fma_f32 v[96:97], v[82:83], v[88:89], v[96:97]
    v_pk_fma_f32 v[94:95], v[78:79], v[90:91], v[94:95]
    v_pk_fma_f32 v[96:97], v[80:81], v[90:91], v[96:97]
    v_pk_fma_f32 v[94:95], v[76:77], v[92:93], v[94:95]
    v_pk_fma_f32 v[96:97], v[78:79], v[92:93], v[96:97]
    v_lshlrev_b32 v98, 16, v70
    v_and_b32 v99, 0xffff0000, v70
    v_lshlrev_b32 v100, 16, v74
    v_and_b32 v101, 0xffff0000, v74
    v_pk_mul_f32 v[94:95], v[94:95], v[98:99]
    v_pk_mul_f32 v[96:97], v[96:97], v[100:101]
    v_cvt_pk_bf16_f32 v102, v96, v94
    v_cvt_pk_bf16_f32 v103, v97, v95
    s_mov_b32 exec_hi, 0xff
    ds_write_b32 v7, v102 offset:576
    ds_write_b32 v7, v103 offset:720
    s_mov_b32 exec_hi, -1
    v_lshlrev_b32 v76, 16, v51
    v_and_b32 v77, 0xffff0000, v51
    v_lshlrev_b32 v78, 16, v55
    v_and_b32 v79, 0xffff0000, v55
    v_lshlrev_b32 v80, 16, v59
    v_and_b32 v81, 0xffff0000, v59
    v_lshlrev_b32 v82, 16, v63
    v_and_b32 v83, 0xffff0000, v63
    v_lshlrev_b32 v84, 16, v67
    v_and_b32 v85, 0xffff0000, v67
    v_lshlrev_b32 v86, 16, v108
    v_lshlrev_b32 v87, 16, v110
    v_and_b32 v88, 0xffff0000, v108
    v_and_b32 v89, 0xffff0000, v110
    v_lshlrev_b32 v90, 16, v109
    v_lshlrev_b32 v91, 16, v111
    v_and_b32 v92, 0xffff0000, v109
    v_and_b32 v93, 0xffff0000, v111
    v_pk_mul_f32 v[94:95], v[82:83], v[86:87]
    v_pk_mul_f32 v[96:97], v[84:85], v[86:87]
    v_pk_fma_f32 v[94:95], v[80:81], v[88:89], v[94:95]
    v_pk_fma_f32 v[96:97], v[82:83], v[88:89], v[96:97]
    v_pk_fma_f32 v[94:95], v[78:79], v[90:91], v[94:95]
    v_pk_fma_f32 v[96:97], v[80:81], v[90:91], v[96:97]
    v_pk_fma_f32 v[94:95], v[76:77], v[92:93], v[94:95]
    v_pk_fma_f32 v[96:97], v[78:79], v[92:93], v[96:97]
    v_lshlrev_b32 v98, 16, v71
    v_and_b32 v99, 0xffff0000, v71
    v_lshlrev_b32 v100, 16, v75
    v_and_b32 v101, 0xffff0000, v75
    v_pk_mul_f32 v[94:95], v[94:95], v[98:99]
    v_pk_mul_f32 v[96:97], v[96:97], v[100:101]
    v_cvt_pk_bf16_f32 v102, v96, v94
    v_cvt_pk_bf16_f32 v103, v97, v95
    s_mov_b32 exec_hi, 0xff
    ds_write_b32 v7, v102 offset:864
    ds_write_b32 v7, v103 offset:1008
    s_mov_b32 exec_hi, -1
    s_lshl_b32 s48, s47, 4
    v_add_u32 v43, s48, v3
    v_mul_u32_u24 v43, 200, v43
    v_lshl_add_u32 v43, v2, 3, v43
    s_mul_i32 s48, s43, 96
    s_add_u32 s48, s48, 0
    v_add_u32 v43, s48, v43
    s_waitcnt vmcnt(4)
    s_mov_b32 s65, 0
k1_poll_5:
    s_add_u32 s65, s65, 1
    s_cmp_gt_u32 s65, 100000
    s_cbranch_scc1 k1_polled_6
    v_cmp_ne_u32 vcc, s100, v30
    v_cmp_ne_u32 s[50:51], s101, v31
    s_nop 0
    s_or_b64 vcc, vcc, s[50:51]
    v_cmp_ne_u32 s[50:51], s100, v34
    s_nop 0
    s_or_b64 vcc, vcc, s[50:51]
    v_cmp_ne_u32 s[50:51], s101, v35
    s_nop 0
    s_or_b64 vcc, vcc, s[50:51]
    s_cmp_eq_u64 vcc, 0
    s_cbranch_scc1 k1_polled_6
    s_sleep 4
    buffer_load_dwordx4 v[28:31], v38, s[24:27], s78 offen sc1
    buffer_load_dwordx4 v[32:35], v38, s[24:27], s78 offen offset:1024 sc1
    s_waitcnt vmcnt(0)
    s_branch k1_poll_5
k1_polled_6:
    s_xor_b32 s48, s42, 1
    s_or_b32 s48, s48, s41
    s_cmp_lg_u32 s48, 0
    s_cbranch_scc1 k1_ep_7
    v_mov_b32 v4, 0
    v_mov_b32 v44, 1
    s_mov_b64 exec, 1
    buffer_atomic_add v44, v4, s[28:31], 0 offen sc0
    s_mov_b64 exec, -1
k1_ep_7:
    v_pk_add_f32 v[8:9], v[28:29], v[32:33]
    v_mov_b32 v10, v8
    v_mov_b32 v11, v9
    s_nop 0
    v_permlane16_swap_b32 v8, v10
    v_permlane16_swap_b32 v9, v11
    v_add_f32 v8, v8, v10
    v_add_f32 v9, v9, v11
    v_mov_b32 v10, v8
    v_mov_b32 v11, v9
    s_nop 0
    v_permlane32_swap_b32 v8, v10
    v_permlane32_swap_b32 v9, v11
    v_add_f32 v8, v8, v10
    v_add_f32 v9, v9, v11
    v_mul_f32 v8, 0x3aaaaaab, v8
    v_mul_f32 v9, 0x3aaaaaab, v9
    v_fma_f32 v9, -v8, v8, v9
    v_max_f32 v9, 0, v9
    v_cvt_pk_bf16_f32 v9, v9, v8
    v_and_b32 v8, 0xffff0000, v9
    v_lshlrev_b32 v9, 16, v9
    v_add_f32 v9, s55, v9
    v_cvt_pk_bf16_f32 v9, v9, v9
    v_and_b32 v9, 0xffff0000, v9
    v_sqrt_f32 v9, v9
    s_nop 0
    v_cvt_pk_bf16_f32 v9, v9, v9
    v_and_b32 v9, 0xffff0000, v9
    v_rcp_f32 v9, v9
    s_nop 0
    v_mov_b32 v10, v9
    v_pk_add_f32 v[200:201], v[200:201], v[8:9] op_sel_hi:[1,0] neg_lo:[0,1] neg_hi:[0,1]
    v_pk_add_f32 v[202:203], v[202:203], v[8:9] op_sel_hi:[1,0] neg_lo:[0,1] neg_hi:[0,1]
    v_pk_add_f32 v[204:205], v[204:205], v[8:9] op_sel_hi:[1,0] neg_lo:[0,1] neg_hi:[0,1]
    v_pk_add_f32 v[206:207], v[206:207], v[8:9] op_sel_hi:[1,0] neg_lo:[0,1] neg_hi:[0,1]
    v_pk_add_f32 v[208:209], v[208:209], v[8:9] op_sel_hi:[1,0] neg_lo:[0,1] neg_hi:[0,1]
    v_pk_add_f32 v[210:211], v[210:211], v[8:9] op_sel_hi:[1,0] neg_lo:[0,1] neg_hi:[0,1]
    v_pk_mul_f32 v[200:201], v[200:201], v[10:11] op_sel_hi:[1,0]
    v_pk_mul_f32 v[202:203], v[202:203], v[10:11] op_sel_hi:[1,0]
    v_pk_mul_f32 v[204:205], v[204:205], v[10:11] op_sel_hi:[1,0]
    v_pk_mul_f32 v[206:207], v[206:207], v[10:11] op_sel_hi:[1,0]
    v_pk_mul_f32 v[208:209], v[208:209], v[10:11] op_sel_hi:[1,0]
    v_pk_mul_f32 v[210:211], v[210:211], v[10:11] op_sel_hi:[1,0]
    v_cvt_pk_bf16_f32 v16, v200, v201
    v_cvt_pk_bf16_f32 v17, v202, v203
    ds_write_b64 v43, v[16:17] offset:0
    v_cvt_pk_bf16_f32 v18, v204, v205
    v_cvt_pk_bf16_f32 v19, v206, v207
    ds_write_b64 v43, v[18:19] offset:32
    v_cvt_pk_bf16_f32 v20, v208, v209
    v_cvt_pk_bf16_f32 v21, v210, v211
    ds_write_b64 v43, v[20:21] offset:64
    v_lshrrev_b32 v212, 1, v2
    v_lshrrev_b32 v5, 2, v3
    v_lshl_add_u32 v212, v212, 3, v5
    v_mul_u32_u24 v212, 200, v212
    v_and_b32 v5, 1, v2
    v_lshl_add_u32 v212, v5, 5, v212
    v_and_b32 v5, 3, v3
    v_lshl_add_u32 v212, v5, 3, v212
    v_lshlrev_b32 v213, 4, v1
    s_waitcnt lgkmcnt(0)
    s_barrier
    v_add_u32 v5, s88, v212
    ds_read_b64_tr_b16 v[8:9], v5
    ds_read_b64_tr_b16 v[10:11], v5 offset:800
    s_waitcnt lgkmcnt(0)
    buffer_store_dwordx4 v[8:11], v213, s[24:27], s64 offen sc1
    s_cmp_ge_u32 s42, 4
    s_cbranch_scc1 k1_fr_8
    v_add_u32 v5, s63, v212
    ds_read_b64_tr_b16 v[12:13], v5
    ds_read_b64_tr_b16 v[14:15], v5 offset:800
    s_waitcnt lgkmcnt(0)
    buffer_store_dwordx4 v[12:15], v213, s[24:27], s67 offen sc1
k1_fr_8:
    s_lshl_b32 s48, s42, 3
    v_lshrrev_b32 v4, 3, v1
    v_add_u32 v4, s48, v4
    v_and_b32 v5, 7, v1
    v_lshlrev_b32 v5, 4, v5
    v_mul_u32_u24 v6, 144, v4
    v_add_u32 v6, v6, v5
    v_add_u32 v6, 106496, v6
    ds_read_b128 v[16:19], v6
    v_lshlrev_b32 v4, 12, v4
    v_add_u32 v4, v4, v5
    s_waitcnt lgkmcnt(0)
    buffer_store_dwordx4 v[16:19], v4, s[24:27], s83 offen sc1
    s_lshl_b32 s48, s42, 3
    s_add_u32 s48, s48, 64
    v_lshrrev_b32 v4, 3, v1
    v_add_u32 v4, s48, v4
    v_and_b32 v5, 7, v1
    v_lshlrev_b32 v5, 4, v5
    v_mul_u32_u24 v6, 144, v4
    v_add_u32 v6, v6, v5
    v_add_u32 v6, 106496, v6
    ds_read_b128 v[20:23], v6
    v_lshlrev_b32 v4, 12, v4
    v_add_u32 v4, v4, v5
    s_waitcnt lgkmcnt(0)
    s_cmp_ge_u32 s42, 2
    s_cbranch_scc1 k1_kvskip_9
    buffer_store_dwordx4 v[20:23], v4, s[24:27], s83 offen sc1
k1_kvskip_9:
    v_mfma_f32_16x16x32_bf16 v[176:179], v[152:155], v[112:115], v[176:179]
    v_mfma_f32_16x16x32_bf16 v[180:183], v[152:155], v[116:119], v[180:183]
    v_mfma_f32_16x16x32_bf16 v[224:227], v[152:155], v[244:247], v[224:227]
    v_mfma_f32_16x16x32_bf16 v[184:187], v[156:159], v[112:115], v[184:187]
    v_mfma_f32_16x16x32_bf16 v[188:191], v[156:159], v[116:119], v[188:191]
    v_mfma_f32_16x16x32_bf16 v[228:231], v[156:159], v[244:247], v[228:231]
    v_mfma_f32_16x16x32_bf16 v[192:195], v[160:163], v[112:115], v[192:195]
    v_mfma_f32_16x16x32_bf16 v[196:199], v[160:163], v[116:119], v[196:199]
    v_mfma_f32_16x16x32_bf16 v[232:235], v[160:163], v[244:247], v[232:235]
    v_mfma_f32_16x16x32_bf16 v[176:179], v[164:167], v[120:123], v[176:179]
    v_mfma_f32_16x16x32_bf16 v[180:183], v[164:167], v[124:127], v[180:183]
    v_mfma_f32_16x16x32_bf16 v[184:187], v[168:171], v[120:123], v[184:187]
    v_mfma_f32_16x16x32_bf16 v[188:191], v[168:171], v[124:127], v[188:191]
    v_mfma_f32_16x16x32_bf16 v[192:195], v[172:175], v[120:123], v[192:195]
    v_mfma_f32_16x16x32_bf16 v[196:199], v[172:175], v[124:127], v[196:199]
    v_lshl_add_u32 v4, v1, 4, s70
    v_lshl_add_u32 v5, v2, 4, s72
    s_nop 1
    ds_write_b128 v4, v[180:183] offset:0
    s_nop 0
    ds_write_b128 v4, v[188:191] offset:1024
    s_nop 0
    ds_write_b128 v4, v[196:199] offset:2048
    s_mov_b32 exec_lo, 0x00010001
    s_mov_b32 exec_hi, 0x00010001
    ds_write_b128 v5, v[224:227] offset:1536
    ds_write_b128 v5, v[228:231] offset:1600
    ds_write_b128 v5, v[232:235] offset:1664
    s_mov_b64 exec, -1
    v_pk_add_f32 v[128:129], v[176:177], 0
    v_pk_add_f32 v[130:131], v[178:179], 0
    v_pk_add_f32 v[132:133], v[184:185], 0
    v_pk_add_f32 v[134:135], v[186:187], 0
    v_pk_add_f32 v[136:137], v[192:193], 0
    v_pk_add_f32 v[138:139], v[194:195], 0
    s_waitcnt vmcnt(0) lgkmcnt(0)
    s_barrier
    s_lshl_b32 s48, s41, 8
    s_lshl_b32 s49, s40, 3
    s_add_u32 s48, s48, s49
    s_add_u32 s48, s48, 14716928
    v_mov_b32 v8, s100
    v_mov_b32 v9, s101
    v_mov_b32 v4, 0
    s_cmp_eq_u32 s42, 0
    s_cselect_b64 exec, 1, 0
    buffer_store_dwordx2 v[8:9], v4, s[24:27], s48 offen sc1
    s_mov_b64 exec, -1
    v_lshl_add_u32 v4, v1, 4, s71
    ds_read_b128 v[48:51], v4 offset:0
    ds_read_b128 v[52:55], v4 offset:1024
    ds_read_b128 v[56:59], v4 offset:2048
    v_lshl_add_u32 v6, v2, 4, s73
    ds_read_b128 v[64:67], v6 offset:1536
    ds_read_b128 v[68:71], v6 offset:1600
    ds_read_b128 v[72:75], v6 offset:1664
    ds_read_b128 v[76:79], v6 offset:1728
    ds_read_b128 v[80:83], v6 offset:1792
    ds_read_b128 v[84:87], v6 offset:1856
    ds_read_b128 v[88:91], v6 offset:1920
    ds_read_b128 v[92:95], v6 offset:1984
    ds_read_b128 v[96:99], v6 offset:2048
    ds_read_b128 v[100:103], v6 offset:2112
    ds_read_b128 v[104:107], v6 offset:2176
    ds_read_b128 v[108:111], v6 offset:2240
    s_waitcnt lgkmcnt(12)
    v_pk_add_f32 v[128:129], v[128:129], v[48:49]
    v_pk_add_f32 v[130:131], v[130:131], v[50:51]
    v_pk_add_f32 v[132:133], v[132:133], v[52:53]
    v_pk_add_f32 v[134:135], v[134:135], v[54:55]
    v_pk_add_f32 v[136:137], v[136:137], v[56:57]
    v_pk_add_f32 v[138:139], v[138:139], v[58:59]
    s_waitcnt lgkmcnt(6)
    v_pk_add_f32 v[64:65], v[64:65], v[76:77]
    v_pk_add_f32 v[66:67], v[66:67], v[78:79]
    v_pk_add_f32 v[68:69], v[68:69], v[80:81]
    v_pk_add_f32 v[70:71], v[70:71], v[82:83]
    v_pk_add_f32 v[72:73], v[72:73], v[84:85]
    v_pk_add_f32 v[74:75], v[74:75], v[86:87]
    s_waitcnt lgkmcnt(0)
    v_pk_add_f32 v[88:89], v[88:89], v[100:101]
    v_pk_add_f32 v[90:91], v[90:91], v[102:103]
    v_pk_add_f32 v[92:93], v[92:93], v[104:105]
    v_pk_add_f32 v[94:95], v[94:95], v[106:107]
    v_pk_add_f32 v[96:97], v[96:97], v[108:109]
    v_pk_add_f32 v[98:99], v[98:99], v[110:111]
    v_pk_add_f32 v[64:65], v[64:65], v[88:89]
    v_pk_add_f32 v[66:67], v[66:67], v[90:91]
    v_pk_add_f32 v[68:69], v[68:69], v[92:93]
    v_pk_add_f32 v[70:71], v[70:71], v[94:95]
    v_pk_add_f32 v[72:73], v[72:73], v[96:97]
    v_pk_add_f32 v[74:75], v[74:75], v[98:99]
    v_pk_fma_f32 v[128:129], v[64:65], v[240:241], v[128:129] op_sel_hi:[1,0,1] neg_lo:[0,1,0] neg_hi:[0,1,0]
    v_pk_fma_f32 v[130:131], v[66:67], v[240:241], v[130:131] op_sel_hi:[1,0,1] neg_lo:[0,1,0] neg_hi:[0,1,0]
    v_pk_fma_f32 v[132:133], v[68:69], v[240:241], v[132:133] op_sel_hi:[1,0,1] neg_lo:[0,1,0] neg_hi:[0,1,0]
    v_pk_fma_f32 v[134:135], v[70:71], v[240:241], v[134:135] op_sel_hi:[1,0,1] neg_lo:[0,1,0] neg_hi:[0,1,0]
    v_pk_fma_f32 v[136:137], v[72:73], v[240:241], v[136:137] op_sel_hi:[1,0,1] neg_lo:[0,1,0] neg_hi:[0,1,0]
    v_pk_fma_f32 v[138:139], v[74:75], v[240:241], v[138:139] op_sel_hi:[1,0,1] neg_lo:[0,1,0] neg_hi:[0,1,0]
    v_pk_mul_f32 v[128:129], v[128:129], v[242:243] op_sel_hi:[1,0]
    v_pk_mul_f32 v[130:131], v[130:131], v[242:243] op_sel_hi:[1,0]
    v_pk_mul_f32 v[132:133], v[132:133], v[242:243] op_sel_hi:[1,0]
    v_pk_mul_f32 v[134:135], v[134:135], v[242:243] op_sel_hi:[1,0]
    v_pk_mul_f32 v[136:137], v[136:137], v[242:243] op_sel_hi:[1,0]
    v_pk_mul_f32 v[138:139], v[138:139], v[242:243] op_sel_hi:[1,0]
    v_pk_mul_f32 v[48:49], v[128:129], v[128:129]
    v_pk_mul_f32 v[50:51], v[130:131], v[130:131]
    v_pk_mul_f32 v[52:53], v[132:133], v[132:133]
    v_pk_mul_f32 v[54:55], v[134:135], v[134:135]
    v_pk_mul_f32 v[56:57], v[136:137], v[136:137]
    v_pk_mul_f32 v[58:59], v[138:139], v[138:139]
    v_pk_fma_f32 v[48:49], v[48:49], s[58:59], v[238:239]
    v_pk_fma_f32 v[50:51], v[50:51], s[58:59], v[238:239]
    v_pk_fma_f32 v[52:53], v[52:53], s[58:59], v[238:239]
    v_pk_fma_f32 v[54:55], v[54:55], s[58:59], v[238:239]
    v_pk_fma_f32 v[56:57], v[56:57], s[58:59], v[238:239]
    v_pk_fma_f32 v[58:59], v[58:59], s[58:59], v[238:239]
    v_pk_mul_f32 v[48:49], v[48:49], v[128:129]
    v_pk_mul_f32 v[50:51], v[50:51], v[130:131]
    v_pk_mul_f32 v[52:53], v[52:53], v[132:133]
    v_pk_mul_f32 v[54:55], v[54:55], v[134:135]
    v_pk_mul_f32 v[56:57], v[56:57], v[136:137]
    v_pk_mul_f32 v[58:59], v[58:59], v[138:139]
    v_exp_f32 v48, v48
    v_exp_f32 v49, v49
    v_exp_f32 v50, v50
    v_exp_f32 v51, v51
    v_exp_f32 v52, v52
    v_exp_f32 v53, v53
    v_exp_f32 v54, v54
    v_exp_f32 v55, v55
    v_exp_f32 v56, v56
    v_exp_f32 v57, v57
    v_exp_f32 v58, v58
    v_exp_f32 v59, v59
    v_pk_add_f32 v[48:49], v[48:49], 1.0 op_sel_hi:[1,0]
    v_pk_add_f32 v[50:51], v[50:51], 1.0 op_sel_hi:[1,0]
    v_pk_add_f32 v[52:53], v[52:53], 1.0 op_sel_hi:[1,0]
    v_pk_add_f32 v[54:55], v[54:55], 1.0 op_sel_hi:[1,0]
    v_pk_add_f32 v[56:57], v[56:57], 1.0 op_sel_hi:[1,0]
    v_pk_add_f32 v[58:59], v[58:59], 1.0 op_sel_hi:[1,0]
    v_rcp_f32 v48, v48
    v_rcp_f32 v49, v49
    v_rcp_f32 v50, v50
    v_rcp_f32 v51, v51
    v_rcp_f32 v52, v52
    v_rcp_f32 v53, v53
    v_rcp_f32 v54, v54
    v_rcp_f32 v55, v55
    v_rcp_f32 v56, v56
    v_rcp_f32 v57, v57
    v_rcp_f32 v58, v58
    v_rcp_f32 v59, v59
    v_pk_mul_f32 v[128:129], v[128:129], v[48:49]
    v_pk_mul_f32 v[130:131], v[130:131], v[50:51]
    v_pk_mul_f32 v[132:133], v[132:133], v[52:53]
    v_pk_mul_f32 v[134:135], v[134:135], v[54:55]
    v_pk_mul_f32 v[136:137], v[136:137], v[56:57]
    v_pk_mul_f32 v[138:139], v[138:139], v[58:59]
    v_lshrrev_b32 v4, 1, v2
    v_mul_u32_u24 v4, 3072, v4
    v_and_b32 v5, 1, v2
    v_lshlrev_b32 v5, 5, v5
    v_add_u32 v5, v5, v3
    v_lshl_add_u32 v4, v5, 4, v4
    v_cvt_pk_bf16_f32 v48, v128, v129
    v_cvt_pk_bf16_f32 v49, v130, v131
    v_add_u32 v5, s80, v4
    ds_write_b64 v5, v[48:49]
    v_cvt_pk_bf16_f32 v50, v132, v133
    v_cvt_pk_bf16_f32 v51, v134, v135
    v_add_u32 v5, s81, v4
    ds_write_b64 v5, v[50:51]
    v_cvt_pk_bf16_f32 v52, v136, v137
    v_cvt_pk_bf16_f32 v53, v138, v139
    v_add_u32 v5, s82, v4
    ds_write_b64 v5, v[52:53]
    s_xor_b32 s48, s42, 1
    s_or_b32 s48, s48, s41
    s_cmp_lg_u32 s48, 0
    s_cbranch_scc1 k1_ep2_10
    s_waitcnt vmcnt(0)
    v_readfirstlane_b32 s48, v44
    s_nop 0
    s_cmp_lg_u32 s48, 31
    s_cbranch_scc1 k1_ep2_10
    v_mov_b32 v8, s100
    v_mov_b32 v9, s101
    v_mov_b32 v4, 14712832
    s_mov_b64 exec, 1
    buffer_store_dwordx2 v[8:9], v4, s[24:27], 0 offen sc1
    s_mov_b64 exec, -1
k1_ep2_10:
    s_waitcnt lgkmcnt(0)
    s_barrier
    s_cmp_ge_u32 s42, 4
    s_cbranch_scc1 recurrent_scan__ssm_conv_h3__mixer_gmlp__prompt_kernel_conv
    s_load_dwordx2 s[4:5], s[0:1], 64
    s_load_dwordx2 s[8:9], s[0:1], 104
    s_load_dwordx2 s[12:13], s[0:1], 72
    v_lshrrev_b32 v2, 6, v0
    v_and_b32 v1, 63, v0
    v_readfirstlane_b32 s34, v2
    s_mov_b32 s6, 8388608
    s_mov_b32 s7, 0x20000
    s_mov_b32 s10, 15990784
    s_mov_b32 s11, 0x20000
    s_mov_b32 s14, 4096
    s_mov_b32 s15, 0x20000
    s_and_b32 s40, s2, 7
    s_lshr_b32 s41, s2, 3
    s_and_b32 s41, s41, 31
    s_lshr_b32 s32, s40, 1
    s_lshl_b32 s32, s32, 3
    s_and_b32 s42, s41, 7
    s_add_u32 s32, s32, s42
    s_and_b32 s33, s40, 1
    s_lshl_b32 s33, s33, 2
    s_lshr_b32 s42, s41, 3
    s_add_u32 s33, s33, s42
    s_lshl_b32 s44, s33, 7
    s_lshl_b32 s40, s34, 5
    s_add_u32 s44, s44, s40
    s_mul_i32 s44, s44, 3072
    s_add_u32 s44, s44, 0
    s_lshl_b32 s45, s32, 18
    s_lshl_b32 s40, s34, 10
    s_add_u32 s45, s45, s40
    s_lshl_b32 s46, s34, 14
    v_lshlrev_b32 v5, 4, v1
    v_lshrrev_b32 v2, 3, v1
    v_lshlrev_b32 v2, 12, v2
    v_and_b32 v3, 7, v1
    v_lshrrev_b32 v4, 4, v1
    v_xor_b32 v3, v3, v4
    v_lshl_add_u32 v6, v3, 4, v2
    v_xor_b32 v7, 64, v6
    s_mov_b32 s50, 0
    s_waitcnt lgkmcnt(0)
    s_add_u32 s54, s50, 0
    s_and_b32 s54, s54, 7
    s_lshl_b32 s54, s54, 7
    s_add_u32 s54, s54, s45
    s_add_u32 s42, s54, 0
    s_add_u32 m0, s46, 0
    s_nop 0
    buffer_load_dwordx4 v6, s[4:7], s42 offen lds
    s_add_u32 s42, s54, 32768
    s_add_u32 m0, s46, 1024
    s_nop 0
    buffer_load_dwordx4 v7, s[4:7], s42 offen lds
    s_add_u32 s42, s54, 65536
    s_add_u32 m0, s46, 2048
    s_nop 0
    buffer_load_dwordx4 v6, s[4:7], s42 offen lds
    s_add_u32 s42, s54, 98304
    s_add_u32 m0, s46, 3072
    s_nop 0
    buffer_load_dwordx4 v7, s[4:7], s42 offen lds
    s_add_u32 s42, s54, 131072
    s_add_u32 m0, s46, 4096
    s_nop 0
    buffer_load_dwordx4 v6, s[4:7], s42 offen lds
    s_add_u32 s42, s54, 163840
    s_add_u32 m0, s46, 5120
    s_nop 0
    buffer_load_dwordx4 v7, s[4:7], s42 offen lds
    s_add_u32 s42, s54, 196608
    s_add_u32 m0, s46, 6144
    s_nop 0
    buffer_load_dwordx4 v6, s[4:7], s42 offen lds
    s_add_u32 s42, s54, 229376
    s_add_u32 m0, s46, 7168
    s_nop 0
    buffer_load_dwordx4 v7, s[4:7], s42 offen lds
    s_lshl_b32 s43, s33, 8
    s_add_u32 s43, s43, 14716928
    v_mbcnt_lo_u32_b32 v2, -1, 0
    v_mbcnt_hi_u32_b32 v2, -1, v2
    v_and_b32 v2, 31, v2
    v_lshlrev_b32 v2, 3, v2
    s_mov_b32 s67, 0
fpoll_11:
    buffer_load_dwordx2 v[104:105], v2, s[8:11], s43 offen sc1
    s_add_u32 s67, s67, 1
    s_waitcnt vmcnt(0)
    v_cmp_ne_u32 vcc, s100, v104
    v_cmp_ne_u32 s[64:65], s101, v105
    s_nop 0
    s_or_b64 vcc, vcc, s[64:65]
    s_cmp_gt_u32 s67, 100000
    s_cbranch_scc1 fpoll_e_12
    s_cmp_eq_u64 vcc, 0
    s_cbranch_scc1 fpoll_e_12
    s_sleep 2
    s_branch fpoll_11
fpoll_e_12:
    s_add_u32 s52, s50, 0
    s_and_b32 s52, s52, 7
    s_mul_i32 s52, s52, 12288
    s_add_u32 s52, s52, s44
    buffer_load_dwordx4 v[104:107], v5, s[8:11], s52 offen offset:0 sc1
    buffer_load_dwordx4 v[108:111], v5, s[8:11], s52 offen offset:1024 sc1
    buffer_load_dwordx4 v[112:115], v5, s[8:11], s52 offen offset:2048 sc1
    s_add_u32 s41, s52, 3072
    buffer_load_dwordx4 v[116:119], v5, s[8:11], s41 offen offset:0 sc1
    s_add_u32 s41, s52, 3072
    buffer_load_dwordx4 v[120:123], v5, s[8:11], s41 offen offset:1024 sc1
    s_add_u32 s41, s52, 3072
    buffer_load_dwordx4 v[124:127], v5, s[8:11], s41 offen offset:2048 sc1
    s_add_u32 s41, s52, 6144
    buffer_load_dwordx4 v[128:131], v5, s[8:11], s41 offen offset:0 sc1
    s_add_u32 s41, s52, 6144
    buffer_load_dwordx4 v[132:135], v5, s[8:11], s41 offen offset:1024 sc1
    s_add_u32 s41, s52, 6144
    buffer_load_dwordx4 v[136:139], v5, s[8:11], s41 offen offset:2048 sc1
    s_add_u32 s41, s52, 9216
    buffer_load_dwordx4 v[140:143], v5, s[8:11], s41 offen offset:0 sc1
    s_add_u32 s41, s52, 9216
    buffer_load_dwordx4 v[144:147], v5, s[8:11], s41 offen offset:1024 sc1
    s_add_u32 s41, s52, 9216
    buffer_load_dwordx4 v[148:151], v5, s[8:11], s41 offen offset:2048 sc1
    v_and_b32 v2, 31, v1
    v_lshrrev_b32 v3, 1, v2
    v_and_b32 v3, 7, v3
    v_lshrrev_b32 v4, 5, v1
    v_xor_b32 v3, v3, v4
    v_lshl_add_u32 v2, v2, 7, s46
    v_xor_b32 v4, 0, v3
    v_lshl_add_u32 v180, v4, 4, v2
    v_xor_b32 v4, 2, v3
    v_lshl_add_u32 v181, v4, 4, v2
    v_xor_b32 v4, 4, v3
    v_lshl_add_u32 v182, v4, 4, v2
    v_xor_b32 v4, 6, v3
    v_lshl_add_u32 v183, v4, 4, v2
    s_waitcnt vmcnt(12)
    s_setprio 2
    ds_read_b128 v[164:167], v180 offset:0
    ds_read_b128 v[168:171], v180 offset:4096
    s_waitcnt vmcnt(9)
    s_waitcnt lgkmcnt(0)
    v_mfma_f32_32x32x16_bf16 v[8:23], v[104:107], v[164:167], 0
    ds_read_b128 v[172:175], v181 offset:0
    ds_read_b128 v[176:179], v181 offset:4096
    v_mfma_f32_32x32x16_bf16 v[24:39], v[104:107], v[168:171], 0
    s_add_u32 s53, s50, 1
    s_and_b32 s53, s53, 7
    s_mul_i32 s53, s53, 12288
    s_add_u32 s53, s53, s44
    buffer_load_dwordx4 v[152:155], v5, s[8:11], s53 offen offset:0 sc1
    v_mfma_f32_32x32x16_bf16 v[40:55], v[108:111], v[164:167], 0
    buffer_load_dwordx4 v[156:159], v5, s[8:11], s53 offen offset:1024 sc1
    v_mfma_f32_32x32x16_bf16 v[56:71], v[108:111], v[168:171], 0
    buffer_load_dwordx4 v[160:163], v5, s[8:11], s53 offen offset:2048 sc1
    v_mfma_f32_32x32x16_bf16 v[72:87], v[112:115], v[164:167], 0
    s_add_u32 s55, s50, 1
    s_and_b32 s55, s55, 7
    s_lshl_b32 s55, s55, 7
    s_add_u32 s55, s55, s45
    s_add_u32 s42, s55, 0
    s_add_u32 m0, s46, 8192
    s_nop 0
    buffer_load_dwordx4 v6, s[4:7], s42 offen lds
    v_mfma_f32_32x32x16_bf16 v[88:103], v[112:115], v[168:171], 0
    s_add_u32 s42, s55, 32768
    s_add_u32 m0, s46, 9216
    s_nop 0
    buffer_load_dwordx4 v7, s[4:7], s42 offen lds
    s_add_u32 s42, s55, 65536
    s_add_u32 m0, s46, 10240
    s_nop 0
    buffer_load_dwordx4 v6, s[4:7], s42 offen lds
    s_add_u32 s42, s55, 98304
    s_add_u32 m0, s46, 11264
    s_nop 0
    buffer_load_dwordx4 v7, s[4:7], s42 offen lds
    s_waitcnt vmcnt(13)
    s_waitcnt lgkmcnt(0)
    v_mfma_f32_32x32x16_bf16 v[8:23], v[116:119], v[172:175], v[8:23]
    ds_read_b128 v[164:167], v182 offset:0
    ds_read_b128 v[168:171], v182 offset:4096
    v_mfma_f32_32x32x16_bf16 v[24:39], v[116:119], v[176:179], v[24:39]
    s_add_u32 s41, s53, 3072
    buffer_load_dwordx4 v[104:107], v5, s[8:11], s41 offen offset:0 sc1
    v_mfma_f32_32x32x16_bf16 v[40:55], v[120:123], v[172:175], v[40:55]
    s_add_u32 s41, s53, 3072
    buffer_load_dwordx4 v[108:111], v5, s[8:11], s41 offen offset:1024 sc1
    v_mfma_f32_32x32x16_bf16 v[56:71], v[120:123], v[176:179], v[56:71]
    s_add_u32 s41, s53, 3072
    buffer_load_dwordx4 v[112:115], v5, s[8:11], s41 offen offset:2048 sc1
    v_mfma_f32_32x32x16_bf16 v[72:87], v[124:127], v[172:175], v[72:87]
    s_add_u32 s42, s55, 131072
    s_add_u32 m0, s46, 12288
    s_nop 0
    buffer_load_dwordx4 v6, s[4:7], s42 offen lds
    v_mfma_f32_32x32x16_bf16 v[88:103], v[124:127], v[176:179], v[88:103]
    s_add_u32 s42, s55, 163840
    s_add_u32 m0, s46, 13312
    s_nop 0
    buffer_load_dwordx4 v7, s[4:7], s42 offen lds
    s_add_u32 s42, s55, 196608
    s_add_u32 m0, s46, 14336
    s_nop 0
    buffer_load_dwordx4 v6, s[4:7], s42 offen lds
    s_add_u32 s42, s55, 229376
    s_add_u32 m0, s46, 15360
    s_nop 0
    buffer_load_dwordx4 v7, s[4:7], s42 offen lds
    s_waitcnt vmcnt(17)
    s_waitcnt lgkmcnt(0)
    v_mfma_f32_32x32x16_bf16 v[8:23], v[128:131], v[164:167], v[8:23]
    ds_read_b128 v[172:175], v183 offset:0
    ds_read_b128 v[176:179], v183 offset:4096
    v_mfma_f32_32x32x16_bf16 v[24:39], v[128:131], v[168:171], v[24:39]
    s_add_u32 s41, s53, 6144
    buffer_load_dwordx4 v[116:119], v5, s[8:11], s41 offen offset:0 sc1
    v_mfma_f32_32x32x16_bf16 v[40:55], v[132:135], v[164:167], v[40:55]
    s_add_u32 s41, s53, 6144
    buffer_load_dwordx4 v[120:123], v5, s[8:11], s41 offen offset:1024 sc1
    v_mfma_f32_32x32x16_bf16 v[56:71], v[132:135], v[168:171], v[56:71]
    s_add_u32 s41, s53, 6144
    buffer_load_dwordx4 v[124:127], v5, s[8:11], s41 offen offset:2048 sc1
    v_mfma_f32_32x32x16_bf16 v[72:87], v[136:139], v[164:167], v[72:87]
    v_mfma_f32_32x32x16_bf16 v[88:103], v[136:139], v[168:171], v[88:103]
    s_waitcnt vmcnt(17)
    s_waitcnt lgkmcnt(0)
    v_mfma_f32_32x32x16_bf16 v[8:23], v[140:143], v[172:175], v[8:23]
    s_waitcnt vmcnt(3)
    ds_read_b128 v[164:167], v180 offset:8192
    ds_read_b128 v[168:171], v180 offset:12288
    v_mfma_f32_32x32x16_bf16 v[24:39], v[140:143], v[176:179], v[24:39]
    s_add_u32 s41, s53, 9216
    buffer_load_dwordx4 v[128:131], v5, s[8:11], s41 offen offset:0 sc1
    v_mfma_f32_32x32x16_bf16 v[40:55], v[144:147], v[172:175], v[40:55]
    s_add_u32 s41, s53, 9216
    buffer_load_dwordx4 v[132:135], v5, s[8:11], s41 offen offset:1024 sc1
    v_mfma_f32_32x32x16_bf16 v[56:71], v[144:147], v[176:179], v[56:71]
    s_add_u32 s41, s53, 9216
    buffer_load_dwordx4 v[136:139], v5, s[8:11], s41 offen offset:2048 sc1
    v_mfma_f32_32x32x16_bf16 v[72:87], v[148:151], v[172:175], v[72:87]
    s_add_u32 s54, s50, 2
    s_and_b32 s54, s54, 7
    s_lshl_b32 s54, s54, 7
    s_add_u32 s54, s54, s45
    s_add_u32 s42, s54, 0
    s_add_u32 m0, s46, 0
    s_nop 0
    buffer_load_dwordx4 v6, s[4:7], s42 offen lds
    v_mfma_f32_32x32x16_bf16 v[88:103], v[148:151], v[176:179], v[88:103]
    s_add_u32 s42, s54, 32768
    s_add_u32 m0, s46, 1024
    s_nop 0
    buffer_load_dwordx4 v7, s[4:7], s42 offen lds
    s_waitcnt vmcnt(19)
    s_waitcnt lgkmcnt(0)
    v_mfma_f32_32x32x16_bf16 v[8:23], v[152:155], v[164:167], v[8:23]
    ds_read_b128 v[172:175], v181 offset:8192
    ds_read_b128 v[176:179], v181 offset:12288
    v_mfma_f32_32x32x16_bf16 v[24:39], v[152:155], v[168:171], v[24:39]
    s_add_u32 s52, s50, 2
    s_and_b32 s52, s52, 7
    s_mul_i32 s52, s52, 12288
    s_add_u32 s52, s52, s44
    buffer_load_dwordx4 v[140:143], v5, s[8:11], s52 offen offset:0 sc1
    v_mfma_f32_32x32x16_bf16 v[40:55], v[156:159], v[164:167], v[40:55]
    buffer_load_dwordx4 v[144:147], v5, s[8:11], s52 offen offset:1024 sc1
    v_mfma_f32_32x32x16_bf16 v[56:71], v[156:159], v[168:171], v[56:71]
    buffer_load_dwordx4 v[148:151], v5, s[8:11], s52 offen offset:2048 sc1
    v_mfma_f32_32x32x16_bf16 v[72:87], v[160:163], v[164:167], v[72:87]
    s_add_u32 s42, s54, 65536
    s_add_u32 m0, s46, 2048
    s_nop 0
    buffer_load_dwordx4 v6, s[4:7], s42 offen lds
    v_mfma_f32_32x32x16_bf16 v[88:103], v[160:163], v[168:171], v[88:103]
    s_add_u32 s42, s54, 98304
    s_add_u32 m0, s46, 3072
    s_nop 0
    buffer_load_dwordx4 v7, s[4:7], s42 offen lds
    s_add_u32 s42, s54, 131072
    s_add_u32 m0, s46, 4096
    s_nop 0
    buffer_load_dwordx4 v6, s[4:7], s42 offen lds
    s_waitcnt vmcnt(18)
    s_waitcnt lgkmcnt(0)
    v_mfma_f32_32x32x16_bf16 v[8:23], v[104:107], v[172:175], v[8:23]
    ds_read_b128 v[164:167], v182 offset:8192
    ds_read_b128 v[168:171], v182 offset:12288
    v_mfma_f32_32x32x16_bf16 v[24:39], v[104:107], v[176:179], v[24:39]
    s_add_u32 s41, s52, 3072
    buffer_load_dwordx4 v[152:155], v5, s[8:11], s41 offen offset:0 sc1
    v_mfma_f32_32x32x16_bf16 v[40:55], v[108:111], v[172:175], v[40:55]
    s_add_u32 s41, s52, 3072
    buffer_load_dwordx4 v[156:159], v5, s[8:11], s41 offen offset:1024 sc1
    v_mfma_f32_32x32x16_bf16 v[56:71], v[108:111], v[176:179], v[56:71]
    s_add_u32 s41, s52, 3072
    buffer_load_dwordx4 v[160:163], v5, s[8:11], s41 offen offset:2048 sc1
    v_mfma_f32_32x32x16_bf16 v[72:87], v[112:115], v[172:175], v[72:87]
    s_add_u32 s42, s54, 163840
    s_add_u32 m0, s46, 5120
    s_nop 0
    buffer_load_dwordx4 v7, s[4:7], s42 offen lds
    v_mfma_f32_32x32x16_bf16 v[88:103], v[112:115], v[176:179], v[88:103]
    s_add_u32 s42, s54, 196608
    s_add_u32 m0, s46, 6144
    s_nop 0
    buffer_load_dwordx4 v6, s[4:7], s42 offen lds
    s_add_u32 s42, s54, 229376
    s_add_u32 m0, s46, 7168
    s_nop 0
    buffer_load_dwordx4 v7, s[4:7], s42 offen lds
    s_waitcnt vmcnt(17)
    s_waitcnt lgkmcnt(0)
    v_mfma_f32_32x32x16_bf16 v[8:23], v[116:119], v[164:167], v[8:23]
    ds_read_b128 v[172:175], v183 offset:8192
    ds_read_b128 v[176:179], v183 offset:12288
    v_mfma_f32_32x32x16_bf16 v[24:39], v[116:119], v[168:171], v[24:39]
    s_add_u32 s41, s52, 6144
    buffer_load_dwordx4 v[104:107], v5, s[8:11], s41 offen offset:0 sc1
    v_mfma_f32_32x32x16_bf16 v[40:55], v[120:123], v[164:167], v[40:55]
    s_add_u32 s41, s52, 6144
    buffer_load_dwordx4 v[108:111], v5, s[8:11], s41 offen offset:1024 sc1
    v_mfma_f32_32x32x16_bf16 v[56:71], v[120:123], v[168:171], v[56:71]
    s_add_u32 s41, s52, 6144
    buffer_load_dwordx4 v[112:115], v5, s[8:11], s41 offen offset:2048 sc1
    v_mfma_f32_32x32x16_bf16 v[72:87], v[124:127], v[164:167], v[72:87]
    v_mfma_f32_32x32x16_bf16 v[88:103], v[124:127], v[168:171], v[88:103]
    s_waitcnt vmcnt(17)
    s_waitcnt lgkmcnt(0)
    v_mfma_f32_32x32x16_bf16 v[8:23], v[128:131], v[172:175], v[8:23]
    s_waitcnt vmcnt(3)
    ds_read_b128 v[164:167], v180 offset:0
    ds_read_b128 v[168:171], v180 offset:4096
    v_mfma_f32_32x32x16_bf16 v[24:39], v[128:131], v[176:179], v[24:39]
    s_add_u32 s41, s52, 9216
    buffer_load_dwordx4 v[116:119], v5, s[8:11], s41 offen offset:0 sc1
    v_mfma_f32_32x32x16_bf16 v[40:55], v[132:135], v[172:175], v[40:55]
    s_add_u32 s41, s52, 9216
    buffer_load_dwordx4 v[120:123], v5, s[8:11], s41 offen offset:1024 sc1
    v_mfma_f32_32x32x16_bf16 v[56:71], v[132:135], v[176:179], v[56:71]
    s_add_u32 s41, s52, 9216
    buffer_load_dwordx4 v[124:127], v5, s[8:11], s41 offen offset:2048 sc1
    v_mfma_f32_32x32x16_bf16 v[72:87], v[136:139], v[172:175], v[72:87]
    s_add_u32 s55, s50, 3
    s_and_b32 s55, s55, 7
    s_lshl_b32 s55, s55, 7
    s_add_u32 s55, s55, s45
    s_add_u32 s42, s55, 0
    s_add_u32 m0, s46, 8192
    s_nop 0
    buffer_load_dwordx4 v6, s[4:7], s42 offen lds
    v_mfma_f32_32x32x16_bf16 v[88:103], v[136:139], v[176:179], v[88:103]
    s_add_u32 s42, s55, 32768
    s_add_u32 m0, s46, 9216
    s_nop 0
    buffer_load_dwordx4 v7, s[4:7], s42 offen lds
    s_waitcnt vmcnt(17)
    s_waitcnt lgkmcnt(0)
    v_mfma_f32_32x32x16_bf16 v[8:23], v[140:143], v[164:167], v[8:23]
    ds_read_b128 v[172:175], v181 offset:0
    ds_read_b128 v[176:179], v181 offset:4096
    v_mfma_f32_32x32x16_bf16 v[24:39], v[140:143], v[168:171], v[24:39]
    s_add_u32 s53, s50, 3
    s_and_b32 s53, s53, 7
    s_mul_i32 s53, s53, 12288
    s_add_u32 s53, s53, s44
    buffer_load_dwordx4 v[128:131], v5, s[8:11], s53 offen offset:0 sc1
    v_mfma_f32_32x32x16_bf16 v[40:55], v[144:147], v[164:167], v[40:55]
    buffer_load_dwordx4 v[132:135], v5, s[8:11], s53 offen offset:1024 sc1
    v_mfma_f32_32x32x16_bf16 v[56:71], v[144:147], v[168:171], v[56:71]
    buffer_load_dwordx4 v[136:139], v5, s[8:11], s53 offen offset:2048 sc1
    v_mfma_f32_32x32x16_bf16 v[72:87], v[148:151], v[164:167], v[72:87]
    s_add_u32 s42, s55, 65536
    s_add_u32 m0, s46, 10240
    s_nop 0
    buffer_load_dwordx4 v6, s[4:7], s42 offen lds
    v_mfma_f32_32x32x16_bf16 v[88:103], v[148:151], v[168:171], v[88:103]
    s_add_u32 s42, s55, 98304
    s_add_u32 m0, s46, 11264
    s_nop 0
    buffer_load_dwordx4 v7, s[4:7], s42 offen lds
    s_add_u32 s42, s55, 131072
    s_add_u32 m0, s46, 12288
    s_nop 0
    buffer_load_dwordx4 v6, s[4:7], s42 offen lds
    s_waitcnt vmcnt(17)
    s_waitcnt lgkmcnt(0)
    v_mfma_f32_32x32x16_bf16 v[8:23], v[152:155], v[172:175], v[8:23]
    ds_read_b128 v[164:167], v182 offset:0
    ds_read_b128 v[168:171], v182 offset:4096
    v_mfma_f32_32x32x16_bf16 v[24:39], v[152:155], v[176:179], v[24:39]
    s_add_u32 s41, s53, 3072
    buffer_load_dwordx4 v[140:143], v5, s[8:11], s41 offen offset:0 sc1
    v_mfma_f32_32x32x16_bf16 v[40:55], v[156:159], v[172:175], v[40:55]
    s_add_u32 s41, s53, 3072
    buffer_load_dwordx4 v[144:147], v5, s[8:11], s41 offen offset:1024 sc1
    v_mfma_f32_32x32x16_bf16 v[56:71], v[156:159], v[176:179], v[56:71]
    s_add_u32 s41, s53, 3072
    buffer_load_dwordx4 v[148:151], v5, s[8:11], s41 offen offset:2048 sc1
    v_mfma_f32_32x32x16_bf16 v[72:87], v[160:163], v[172:175], v[72:87]
    s_add_u32 s42, s55, 163840
    s_add_u32 m0, s46, 13312
    s_nop 0
    buffer_load_dwordx4 v7, s[4:7], s42 offen lds
    v_mfma_f32_32x32x16_bf16 v[88:103], v[160:163], v[176:179], v[88:103]
    s_add_u32 s42, s55, 196608
    s_add_u32 m0, s46, 14336
    s_nop 0
    buffer_load_dwordx4 v6, s[4:7], s42 offen lds
    s_add_u32 s42, s55, 229376
    s_add_u32 m0, s46, 15360
    s_nop 0
    buffer_load_dwordx4 v7, s[4:7], s42 offen lds
    s_waitcnt vmcnt(17)
    s_waitcnt lgkmcnt(0)
    v_mfma_f32_32x32x16_bf16 v[8:23], v[104:107], v[164:167], v[8:23]
    ds_read_b128 v[172:175], v183 offset:0
    ds_read_b128 v[176:179], v183 offset:4096
    v_mfma_f32_32x32x16_bf16 v[24:39], v[104:107], v[168:171], v[24:39]
    s_add_u32 s41, s53, 6144
    buffer_load_dwordx4 v[152:155], v5, s[8:11], s41 offen offset:0 sc1
    v_mfma_f32_32x32x16_bf16 v[40:55], v[108:111], v[164:167], v[40:55]
    s_add_u32 s41, s53, 6144
    buffer_load_dwordx4 v[156:159], v5, s[8:11], s41 offen offset:1024 sc1
    v_mfma_f32_32x32x16_bf16 v[56:71], v[108:111], v[168:171], v[56:71]
    s_add_u32 s41, s53, 6144
    buffer_load_dwordx4 v[160:163], v5, s[8:11], s41 offen offset:2048 sc1
    v_mfma_f32_32x32x16_bf16 v[72:87], v[112:115], v[164:167], v[72:87]
    v_mfma_f32_32x32x16_bf16 v[88:103], v[112:115], v[168:171], v[88:103]
    s_waitcnt vmcnt(17)
    s_waitcnt lgkmcnt(0)
    v_mfma_f32_32x32x16_bf16 v[8:23], v[116:119], v[172:175], v[8:23]
    s_waitcnt vmcnt(3)
    ds_read_b128 v[164:167], v180 offset:8192
    ds_read_b128 v[168:171], v180 offset:12288
    v_mfma_f32_32x32x16_bf16 v[24:39], v[116:119], v[176:179], v[24:39]
    s_add_u32 s41, s53, 9216
    buffer_load_dwordx4 v[104:107], v5, s[8:11], s41 offen offset:0 sc1
    v_mfma_f32_32x32x16_bf16 v[40:55], v[120:123], v[172:175], v[40:55]
    s_add_u32 s41, s53, 9216
    buffer_load_dwordx4 v[108:111], v5, s[8:11], s41 offen offset:1024 sc1
    v_mfma_f32_32x32x16_bf16 v[56:71], v[120:123], v[176:179], v[56:71]
    s_add_u32 s41, s53, 9216
    buffer_load_dwordx4 v[112:115], v5, s[8:11], s41 offen offset:2048 sc1
    v_mfma_f32_32x32x16_bf16 v[72:87], v[124:127], v[172:175], v[72:87]
    s_add_u32 s54, s50, 4
    s_and_b32 s54, s54, 7
    s_lshl_b32 s54, s54, 7
    s_add_u32 s54, s54, s45
    s_add_u32 s42, s54, 0
    s_add_u32 m0, s46, 0
    s_nop 0
    buffer_load_dwordx4 v6, s[4:7], s42 offen lds
    v_mfma_f32_32x32x16_bf16 v[88:103], v[124:127], v[176:179], v[88:103]
    s_add_u32 s42, s54, 32768
    s_add_u32 m0, s46, 1024
    s_nop 0
    buffer_load_dwordx4 v7, s[4:7], s42 offen lds
    s_waitcnt vmcnt(17)
    s_waitcnt lgkmcnt(0)
    v_mfma_f32_32x32x16_bf16 v[8:23], v[128:131], v[164:167], v[8:23]
    ds_read_b128 v[172:175], v181 offset:8192
    ds_read_b128 v[176:179], v181 offset:12288
    v_mfma_f32_32x32x16_bf16 v[24:39], v[128:131], v[168:171], v[24:39]
    s_add_u32 s52, s50, 4
    s_and_b32 s52, s52, 7
    s_mul_i32 s52, s52, 12288
    s_add_u32 s52, s52, s44
    buffer_load_dwordx4 v[116:119], v5, s[8:11], s52 offen offset:0 sc1
    v_mfma_f32_32x32x16_bf16 v[40:55], v[132:135], v[164:167], v[40:55]
    buffer_load_dwordx4 v[120:123], v5, s[8:11], s52 offen offset:1024 sc1
    v_mfma_f32_32x32x16_bf16 v[56:71], v[132:135], v[168:171], v[56:71]
    buffer_load_dwordx4 v[124:127], v5, s[8:11], s52 offen offset:2048 sc1
    v_mfma_f32_32x32x16_bf16 v[72:87], v[136:139], v[164:167], v[72:87]
    s_add_u32 s42, s54, 65536
    s_add_u32 m0, s46, 2048
    s_nop 0
    buffer_load_dwordx4 v6, s[4:7], s42 offen lds
    v_mfma_f32_32x32x16_bf16 v[88:103], v[136:139], v[168:171], v[88:103]
    s_add_u32 s42, s54, 98304
    s_add_u32 m0, s46, 3072
    s_nop 0
    buffer_load_dwordx4 v7, s[4:7], s42 offen lds
    s_add_u32 s42, s54, 131072
    s_add_u32 m0, s46, 4096
    s_nop 0
    buffer_load_dwordx4 v6, s[4:7], s42 offen lds
    s_waitcnt vmcnt(17)
    s_waitcnt lgkmcnt(0)
    v_mfma_f32_32x32x16_bf16 v[8:23], v[140:143], v[172:175], v[8:23]
    ds_read_b128 v[164:167], v182 offset:8192
    ds_read_b128 v[168:171], v182 offset:12288
    v_mfma_f32_32x32x16_bf16 v[24:39], v[140:143], v[176:179], v[24:39]
    s_add_u32 s41, s52, 3072
    buffer_load_dwordx4 v[128:131], v5, s[8:11], s41 offen offset:0 sc1
    v_mfma_f32_32x32x16_bf16 v[40:55], v[144:147], v[172:175], v[40:55]
    s_add_u32 s41, s52, 3072
    buffer_load_dwordx4 v[132:135], v5, s[8:11], s41 offen offset:1024 sc1
    v_mfma_f32_32x32x16_bf16 v[56:71], v[144:147], v[176:179], v[56:71]
    s_add_u32 s41, s52, 3072
    buffer_load_dwordx4 v[136:139], v5, s[8:11], s41 offen offset:2048 sc1
    v_mfma_f32_32x32x16_bf16 v[72:87], v[148:151], v[172:175], v[72:87]
    s_add_u32 s42, s54, 163840
    s_add_u32 m0, s46, 5120
    s_nop 0
    buffer_load_dwordx4 v7, s[4:7], s42 offen lds
    v_mfma_f32_32x32x16_bf16 v[88:103], v[148:151], v[176:179], v[88:103]
    s_add_u32 s42, s54, 196608
    s_add_u32 m0, s46, 6144
    s_nop 0
    buffer_load_dwordx4 v6, s[4:7], s42 offen lds
    s_add_u32 s42, s54, 229376
    s_add_u32 m0, s46, 7168
    s_nop 0
    buffer_load_dwordx4 v7, s[4:7], s42 offen lds
    s_waitcnt vmcnt(17)
    s_waitcnt lgkmcnt(0)
    v_mfma_f32_32x32x16_bf16 v[8:23], v[152:155], v[164:167], v[8:23]
    ds_read_b128 v[172:175], v183 offset:8192
    ds_read_b128 v[176:179], v183 offset:12288
    v_mfma_f32_32x32x16_bf16 v[24:39], v[152:155], v[168:171], v[24:39]
    s_add_u32 s41, s52, 6144
    buffer_load_dwordx4 v[140:143], v5, s[8:11], s41 offen offset:0 sc1
    v_mfma_f32_32x32x16_bf16 v[40:55], v[156:159], v[164:167], v[40:55]
    s_add_u32 s41, s52, 6144
    buffer_load_dwordx4 v[144:147], v5, s[8:11], s41 offen offset:1024 sc1
    v_mfma_f32_32x32x16_bf16 v[56:71], v[156:159], v[168:171], v[56:71]
    s_add_u32 s41, s52, 6144
    buffer_load_dwordx4 v[148:151], v5, s[8:11], s41 offen offset:2048 sc1
    v_mfma_f32_32x32x16_bf16 v[72:87], v[160:163], v[164:167], v[72:87]
    v_mfma_f32_32x32x16_bf16 v[88:103], v[160:163], v[168:171], v[88:103]
    s_waitcnt vmcnt(17)
    s_waitcnt lgkmcnt(0)
    v_mfma_f32_32x32x16_bf16 v[8:23], v[104:107], v[172:175], v[8:23]
    s_waitcnt vmcnt(3)
    ds_read_b128 v[164:167], v180 offset:0
    ds_read_b128 v[168:171], v180 offset:4096
    v_mfma_f32_32x32x16_bf16 v[24:39], v[104:107], v[176:179], v[24:39]
    s_add_u32 s41, s52, 9216
    buffer_load_dwordx4 v[152:155], v5, s[8:11], s41 offen offset:0 sc1
    v_mfma_f32_32x32x16_bf16 v[40:55], v[108:111], v[172:175], v[40:55]
    s_add_u32 s41, s52, 9216
    buffer_load_dwordx4 v[156:159], v5, s[8:11], s41 offen offset:1024 sc1
    v_mfma_f32_32x32x16_bf16 v[56:71], v[108:111], v[176:179], v[56:71]
    s_add_u32 s41, s52, 9216
    buffer_load_dwordx4 v[160:163], v5, s[8:11], s41 offen offset:2048 sc1
    v_mfma_f32_32x32x16_bf16 v[72:87], v[112:115], v[172:175], v[72:87]
    s_add_u32 s55, s50, 5
    s_and_b32 s55, s55, 7
    s_lshl_b32 s55, s55, 7
    s_add_u32 s55, s55, s45
    s_add_u32 s42, s55, 0
    s_add_u32 m0, s46, 8192
    s_nop 0
    buffer_load_dwordx4 v6, s[4:7], s42 offen lds
    v_mfma_f32_32x32x16_bf16 v[88:103], v[112:115], v[176:179], v[88:103]
    s_add_u32 s42, s55, 32768
    s_add_u32 m0, s46, 9216
    s_nop 0
    buffer_load_dwordx4 v7, s[4:7], s42 offen lds
    s_waitcnt vmcnt(17)
    s_waitcnt lgkmcnt(0)
    v_mfma_f32_32x32x16_bf16 v[8:23], v[116:119], v[164:167], v[8:23]
    ds_read_b128 v[172:175], v181 offset:0
    ds_read_b128 v[176:179], v181 offset:4096
    v_mfma_f32_32x32x16_bf16 v[24:39], v[116:119], v[168:171], v[24:39]
    s_add_u32 s53, s50, 5
    s_and_b32 s53, s53, 7
    s_mul_i32 s53, s53, 12288
    s_add_u32 s53, s53, s44
    buffer_load_dwordx4 v[104:107], v5, s[8:11], s53 offen offset:0 sc1
    v_mfma_f32_32x32x16_bf16 v[40:55], v[120:123], v[164:167], v[40:55]
    buffer_load_dwordx4 v[108:111], v5, s[8:11], s53 offen offset:1024 sc1
    v_mfma_f32_32x32x16_bf16 v[56:71], v[120:123], v[168:171], v[56:71]
    buffer_load_dwordx4 v[112:115], v5, s[8:11], s53 offen offset:2048 sc1
    v_mfma_f32_32x32x16_bf16 v[72:87], v[124:127], v[164:167], v[72:87]
    s_add_u32 s42, s55, 65536
    s_add_u32 m0, s46, 10240
    s_nop 0
    buffer_load_dwordx4 v6, s[4:7], s42 offen lds
    v_mfma_f32_32x32x16_bf16 v[88:103], v[124:127], v[168:171], v[88:103]
    s_add_u32 s42, s55, 98304
    s_add_u32 m0, s46, 11264
    s_nop 0
    buffer_load_dwordx4 v7, s[4:7], s42 offen lds
    s_add_u32 s42, s55, 131072
    s_add_u32 m0, s46, 12288
    s_nop 0
    buffer_load_dwordx4 v6, s[4:7], s42 offen lds
    s_waitcnt vmcnt(17)
    s_waitcnt lgkmcnt(0)
    v_mfma_f32_32x32x16_bf16 v[8:23], v[128:131], v[172:175], v[8:23]
    ds_read_b128 v[164:167], v182 offset:0
    ds_read_b128 v[168:171], v182 offset:4096
    v_mfma_f32_32x32x16_bf16 v[24:39], v[128:131], v[176:179], v[24:39]
    s_add_u32 s41, s53, 3072
    buffer_load_dwordx4 v[116:119], v5, s[8:11], s41 offen offset:0 sc1
    v_mfma_f32_32x32x16_bf16 v[40:55], v[132:135], v[172:175], v[40:55]
    s_add_u32 s41, s53, 3072
    buffer_load_dwordx4 v[120:123], v5, s[8:11], s41 offen offset:1024 sc1
    v_mfma_f32_32x32x16_bf16 v[56:71], v[132:135], v[176:179], v[56:71]
    s_add_u32 s41, s53, 3072
    buffer_load_dwordx4 v[124:127], v5, s[8:11], s41 offen offset:2048 sc1
    v_mfma_f32_32x32x16_bf16 v[72:87], v[136:139], v[172:175], v[72:87]
    s_add_u32 s42, s55, 163840
    s_add_u32 m0, s46, 13312
    s_nop 0
    buffer_load_dwordx4 v7, s[4:7], s42 offen lds
    v_mfma_f32_32x32x16_bf16 v[88:103], v[136:139], v[176:179], v[88:103]
    s_add_u32 s42, s55, 196608
    s_add_u32 m0, s46, 14336
    s_nop 0
    buffer_load_dwordx4 v6, s[4:7], s42 offen lds
    s_add_u32 s42, s55, 229376
    s_add_u32 m0, s46, 15360
    s_nop 0
    buffer_load_dwordx4 v7, s[4:7], s42 offen lds
    s_waitcnt vmcnt(17)
    s_waitcnt lgkmcnt(0)
    v_mfma_f32_32x32x16_bf16 v[8:23], v[140:143], v[164:167], v[8:23]
    ds_read_b128 v[172:175], v183 offset:0
    ds_read_b128 v[176:179], v183 offset:4096
    v_mfma_f32_32x32x16_bf16 v[24:39], v[140:143], v[168:171], v[24:39]
    s_add_u32 s41, s53, 6144
    buffer_load_dwordx4 v[128:131], v5, s[8:11], s41 offen offset:0 sc1
    v_mfma_f32_32x32x16_bf16 v[40:55], v[144:147], v[164:167], v[40:55]
    s_add_u32 s41, s53, 6144
    buffer_load_dwordx4 v[132:135], v5, s[8:11], s41 offen offset:1024 sc1
    v_mfma_f32_32x32x16_bf16 v[56:71], v[144:147], v[168:171], v[56:71]
    s_add_u32 s41, s53, 6144
    buffer_load_dwordx4 v[136:139], v5, s[8:11], s41 offen offset:2048 sc1
    v_mfma_f32_32x32x16_bf16 v[72:87], v[148:151], v[164:167], v[72:87]
    v_mfma_f32_32x32x16_bf16 v[88:103], v[148:151], v[168:171], v[88:103]
    s_waitcnt vmcnt(17)
    s_waitcnt lgkmcnt(0)
    v_mfma_f32_32x32x16_bf16 v[8:23], v[152:155], v[172:175], v[8:23]
    s_waitcnt vmcnt(3)
    ds_read_b128 v[164:167], v180 offset:8192
    ds_read_b128 v[168:171], v180 offset:12288
    v_mfma_f32_32x32x16_bf16 v[24:39], v[152:155], v[176:179], v[24:39]
    s_add_u32 s41, s53, 9216
    buffer_load_dwordx4 v[140:143], v5, s[8:11], s41 offen offset:0 sc1
    v_mfma_f32_32x32x16_bf16 v[40:55], v[156:159], v[172:175], v[40:55]
    s_add_u32 s41, s53, 9216
    buffer_load_dwordx4 v[144:147], v5, s[8:11], s41 offen offset:1024 sc1
    v_mfma_f32_32x32x16_bf16 v[56:71], v[156:159], v[176:179], v[56:71]
    s_add_u32 s41, s53, 9216
    buffer_load_dwordx4 v[148:151], v5, s[8:11], s41 offen offset:2048 sc1
    v_mfma_f32_32x32x16_bf16 v[72:87], v[160:163], v[172:175], v[72:87]
    s_add_u32 s54, s50, 6
    s_and_b32 s54, s54, 7
    s_lshl_b32 s54, s54, 7
    s_add_u32 s54, s54, s45
    s_add_u32 s42, s54, 0
    s_add_u32 m0, s46, 0
    s_nop 0
    buffer_load_dwordx4 v6, s[4:7], s42 offen lds
    v_mfma_f32_32x32x16_bf16 v[88:103], v[160:163], v[176:179], v[88:103]
    s_add_u32 s42, s54, 32768
    s_add_u32 m0, s46, 1024
    s_nop 0
    buffer_load_dwordx4 v7, s[4:7], s42 offen lds
    s_waitcnt vmcnt(17)
    s_waitcnt lgkmcnt(0)
    v_mfma_f32_32x32x16_bf16 v[8:23], v[104:107], v[164:167], v[8:23]
    ds_read_b128 v[172:175], v181 offset:8192
    ds_read_b128 v[176:179], v181 offset:12288
    v_mfma_f32_32x32x16_bf16 v[24:39], v[104:107], v[168:171], v[24:39]
    s_add_u32 s52, s50, 6
    s_and_b32 s52, s52, 7
    s_mul_i32 s52, s52, 12288
    s_add_u32 s52, s52, s44
    buffer_load_dwordx4 v[152:155], v5, s[8:11], s52 offen offset:0 sc1
    v_mfma_f32_32x32x16_bf16 v[40:55], v[108:111], v[164:167], v[40:55]
    buffer_load_dwordx4 v[156:159], v5, s[8:11], s52 offen offset:1024 sc1
    v_mfma_f32_32x32x16_bf16 v[56:71], v[108:111], v[168:171], v[56:71]
    buffer_load_dwordx4 v[160:163], v5, s[8:11], s52 offen offset:2048 sc1
    v_mfma_f32_32x32x16_bf16 v[72:87], v[112:115], v[164:167], v[72:87]
    s_add_u32 s42, s54, 65536
    s_add_u32 m0, s46, 2048
    s_nop 0
    buffer_load_dwordx4 v6, s[4:7], s42 offen lds
    v_mfma_f32_32x32x16_bf16 v[88:103], v[112:115], v[168:171], v[88:103]
    s_add_u32 s42, s54, 98304
    s_add_u32 m0, s46, 3072
    s_nop 0
    buffer_load_dwordx4 v7, s[4:7], s42 offen lds
    s_add_u32 s42, s54, 131072
    s_add_u32 m0, s46, 4096
    s_nop 0
    buffer_load_dwordx4 v6, s[4:7], s42 offen lds
    s_waitcnt vmcnt(17)
    s_waitcnt lgkmcnt(0)
    v_mfma_f32_32x32x16_bf16 v[8:23], v[116:119], v[172:175], v[8:23]
    ds_read_b128 v[164:167], v182 offset:8192
    ds_read_b128 v[168:171], v182 offset:12288
    v_mfma_f32_32x32x16_bf16 v[24:39], v[116:119], v[176:179], v[24:39]
    s_add_u32 s41, s52, 3072
    buffer_load_dwordx4 v[104:107], v5, s[8:11], s41 offen offset:0 sc1
    v_mfma_f32_32x32x16_bf16 v[40:55], v[120:123], v[172:175], v[40:55]
    s_add_u32 s41, s52, 3072
    buffer_load_dwordx4 v[108:111], v5, s[8:11], s41 offen offset:1024 sc1
    v_mfma_f32_32x32x16_bf16 v[56:71], v[120:123], v[176:179], v[56:71]
    s_add_u32 s41, s52, 3072
    buffer_load_dwordx4 v[112:115], v5, s[8:11], s41 offen offset:2048 sc1
    v_mfma_f32_32x32x16_bf16 v[72:87], v[124:127], v[172:175], v[72:87]
    s_add_u32 s42, s54, 163840
    s_add_u32 m0, s46, 5120
    s_nop 0
    buffer_load_dwordx4 v7, s[4:7], s42 offen lds
    v_mfma_f32_32x32x16_bf16 v[88:103], v[124:127], v[176:179], v[88:103]
    s_add_u32 s42, s54, 196608
    s_add_u32 m0, s46, 6144
    s_nop 0
    buffer_load_dwordx4 v6, s[4:7], s42 offen lds
    s_add_u32 s42, s54, 229376
    s_add_u32 m0, s46, 7168
    s_nop 0
    buffer_load_dwordx4 v7, s[4:7], s42 offen lds
    s_waitcnt vmcnt(17)
    s_waitcnt lgkmcnt(0)
    v_mfma_f32_32x32x16_bf16 v[8:23], v[128:131], v[164:167], v[8:23]
    ds_read_b128 v[172:175], v183 offset:8192
    ds_read_b128 v[176:179], v183 offset:12288
    v_mfma_f32_32x32x16_bf16 v[24:39], v[128:131], v[168:171], v[24:39]
    s_add_u32 s41, s52, 6144
    buffer_load_dwordx4 v[116:119], v5, s[8:11], s41 offen offset:0 sc1
    v_mfma_f32_32x32x16_bf16 v[40:55], v[132:135], v[164:167], v[40:55]
    s_add_u32 s41, s52, 6144
    buffer_load_dwordx4 v[120:123], v5, s[8:11], s41 offen offset:1024 sc1
    v_mfma_f32_32x32x16_bf16 v[56:71], v[132:135], v[168:171], v[56:71]
    s_add_u32 s41, s52, 6144
    buffer_load_dwordx4 v[124:127], v5, s[8:11], s41 offen offset:2048 sc1
    v_mfma_f32_32x32x16_bf16 v[72:87], v[136:139], v[164:167], v[72:87]
    v_mfma_f32_32x32x16_bf16 v[88:103], v[136:139], v[168:171], v[88:103]
    s_waitcnt vmcnt(17)
    s_waitcnt lgkmcnt(0)
    v_mfma_f32_32x32x16_bf16 v[8:23], v[140:143], v[172:175], v[8:23]
    s_waitcnt vmcnt(3)
    ds_read_b128 v[164:167], v180 offset:0
    ds_read_b128 v[168:171], v180 offset:4096
    v_mfma_f32_32x32x16_bf16 v[24:39], v[140:143], v[176:179], v[24:39]
    s_add_u32 s41, s52, 9216
    buffer_load_dwordx4 v[128:131], v5, s[8:11], s41 offen offset:0 sc1
    v_mfma_f32_32x32x16_bf16 v[40:55], v[144:147], v[172:175], v[40:55]
    s_add_u32 s41, s52, 9216
    buffer_load_dwordx4 v[132:135], v5, s[8:11], s41 offen offset:1024 sc1
    v_mfma_f32_32x32x16_bf16 v[56:71], v[144:147], v[176:179], v[56:71]
    s_add_u32 s41, s52, 9216
    buffer_load_dwordx4 v[136:139], v5, s[8:11], s41 offen offset:2048 sc1
    v_mfma_f32_32x32x16_bf16 v[72:87], v[148:151], v[172:175], v[72:87]
    s_add_u32 s55, s50, 7
    s_and_b32 s55, s55, 7
    s_lshl_b32 s55, s55, 7
    s_add_u32 s55, s55, s45
    s_add_u32 s42, s55, 0
    s_add_u32 m0, s46, 8192
    s_nop 0
    buffer_load_dwordx4 v6, s[4:7], s42 offen lds
    v_mfma_f32_32x32x16_bf16 v[88:103], v[148:151], v[176:179], v[88:103]
    s_add_u32 s42, s55, 32768
    s_add_u32 m0, s46, 9216
    s_nop 0
    buffer_load_dwordx4 v7, s[4:7], s42 offen lds
    s_waitcnt vmcnt(17)
    s_waitcnt lgkmcnt(0)
    v_mfma_f32_32x32x16_bf16 v[8:23], v[152:155], v[164:167], v[8:23]
    ds_read_b128 v[172:175], v181 offset:0
    ds_read_b128 v[176:179], v181 offset:4096
    v_mfma_f32_32x32x16_bf16 v[24:39], v[152:155], v[168:171], v[24:39]
    s_add_u32 s53, s50, 7
    s_and_b32 s53, s53, 7
    s_mul_i32 s53, s53, 12288
    s_add_u32 s53, s53, s44
    buffer_load_dwordx4 v[140:143], v5, s[8:11], s53 offen offset:0 sc1
    v_mfma_f32_32x32x16_bf16 v[40:55], v[156:159], v[164:167], v[40:55]
    buffer_load_dwordx4 v[144:147], v5, s[8:11], s53 offen offset:1024 sc1
    v_mfma_f32_32x32x16_bf16 v[56:71], v[156:159], v[168:171], v[56:71]
    buffer_load_dwordx4 v[148:151], v5, s[8:11], s53 offen offset:2048 sc1
    v_mfma_f32_32x32x16_bf16 v[72:87], v[160:163], v[164:167], v[72:87]
    s_add_u32 s42, s55, 65536
    s_add_u32 m0, s46, 10240
    s_nop 0
    buffer_load_dwordx4 v6, s[4:7], s42 offen lds
    v_mfma_f32_32x32x16_bf16 v[88:103], v[160:163], v[168:171], v[88:103]
    s_add_u32 s42, s55, 98304
    s_add_u32 m0, s46, 11264
    s_nop 0
    buffer_load_dwordx4 v7, s[4:7], s42 offen lds
    s_add_u32 s42, s55, 131072
    s_add_u32 m0, s46, 12288
    s_nop 0
    buffer_load_dwordx4 v6, s[4:7], s42 offen lds
    s_waitcnt vmcnt(17)
    s_waitcnt lgkmcnt(0)
    v_mfma_f32_32x32x16_bf16 v[8:23], v[104:107], v[172:175], v[8:23]
    ds_read_b128 v[164:167], v182 offset:0
    ds_read_b128 v[168:171], v182 offset:4096
    v_mfma_f32_32x32x16_bf16 v[24:39], v[104:107], v[176:179], v[24:39]
    s_add_u32 s41, s53, 3072
    buffer_load_dwordx4 v[152:155], v5, s[8:11], s41 offen offset:0 sc1
    v_mfma_f32_32x32x16_bf16 v[40:55], v[108:111], v[172:175], v[40:55]
    s_add_u32 s41, s53, 3072
    buffer_load_dwordx4 v[156:159], v5, s[8:11], s41 offen offset:1024 sc1
    v_mfma_f32_32x32x16_bf16 v[56:71], v[108:111], v[176:179], v[56:71]
    s_add_u32 s41, s53, 3072
    buffer_load_dwordx4 v[160:163], v5, s[8:11], s41 offen offset:2048 sc1
    v_mfma_f32_32x32x16_bf16 v[72:87], v[112:115], v[172:175], v[72:87]
    s_add_u32 s42, s55, 163840
    s_add_u32 m0, s46, 13312
    s_nop 0
    buffer_load_dwordx4 v7, s[4:7], s42 offen lds
    v_mfma_f32_32x32x16_bf16 v[88:103], v[112:115], v[176:179], v[88:103]
    s_add_u32 s42, s55, 196608
    s_add_u32 m0, s46, 14336
    s_nop 0
    buffer_load_dwordx4 v6, s[4:7], s42 offen lds
    s_add_u32 s42, s55, 229376
    s_add_u32 m0, s46, 15360
    s_nop 0
    buffer_load_dwordx4 v7, s[4:7], s42 offen lds
    s_waitcnt vmcnt(17)
    s_waitcnt lgkmcnt(0)
    v_mfma_f32_32x32x16_bf16 v[8:23], v[116:119], v[164:167], v[8:23]
    ds_read_b128 v[172:175], v183 offset:0
    ds_read_b128 v[176:179], v183 offset:4096
    v_mfma_f32_32x32x16_bf16 v[24:39], v[116:119], v[168:171], v[24:39]
    s_add_u32 s41, s53, 6144
    buffer_load_dwordx4 v[104:107], v5, s[8:11], s41 offen offset:0 sc1
    v_mfma_f32_32x32x16_bf16 v[40:55], v[120:123], v[164:167], v[40:55]
    s_add_u32 s41, s53, 6144
    buffer_load_dwordx4 v[108:111], v5, s[8:11], s41 offen offset:1024 sc1
    v_mfma_f32_32x32x16_bf16 v[56:71], v[120:123], v[168:171], v[56:71]
    s_add_u32 s41, s53, 6144
    buffer_load_dwordx4 v[112:115], v5, s[8:11], s41 offen offset:2048 sc1
    v_mfma_f32_32x32x16_bf16 v[72:87], v[124:127], v[164:167], v[72:87]
    v_mfma_f32_32x32x16_bf16 v[88:103], v[124:127], v[168:171], v[88:103]
    s_waitcnt vmcnt(17)
    s_waitcnt lgkmcnt(0)
    v_mfma_f32_32x32x16_bf16 v[8:23], v[128:131], v[172:175], v[8:23]
    s_waitcnt vmcnt(3)
    ds_read_b128 v[164:167], v180 offset:8192
    ds_read_b128 v[168:171], v180 offset:12288
    v_mfma_f32_32x32x16_bf16 v[24:39], v[128:131], v[176:179], v[24:39]
    s_add_u32 s41, s53, 9216
    buffer_load_dwordx4 v[116:119], v5, s[8:11], s41 offen offset:0 sc1
    v_mfma_f32_32x32x16_bf16 v[40:55], v[132:135], v[172:175], v[40:55]
    s_add_u32 s41, s53, 9216
    buffer_load_dwordx4 v[120:123], v5, s[8:11], s41 offen offset:1024 sc1
    v_mfma_f32_32x32x16_bf16 v[56:71], v[132:135], v[176:179], v[56:71]
    s_add_u32 s41, s53, 9216
    buffer_load_dwordx4 v[124:127], v5, s[8:11], s41 offen offset:2048 sc1
    v_mfma_f32_32x32x16_bf16 v[72:87], v[136:139], v[172:175], v[72:87]
    v_mfma_f32_32x32x16_bf16 v[88:103], v[136:139], v[176:179], v[88:103]
    s_waitcnt vmcnt(15)
    s_waitcnt lgkmcnt(0)
    v_mfma_f32_32x32x16_bf16 v[8:23], v[140:143], v[164:167], v[8:23]
    ds_read_b128 v[172:175], v181 offset:8192
    ds_read_b128 v[176:179], v181 offset:12288
    v_mfma_f32_32x32x16_bf16 v[24:39], v[140:143], v[168:171], v[24:39]
    v_mfma_f32_32x32x16_bf16 v[40:55], v[144:147], v[164:167], v[40:55]
    v_mfma_f32_32x32x16_bf16 v[56:71], v[144:147], v[168:171], v[56:71]
    v_mfma_f32_32x32x16_bf16 v[72:87], v[148:151], v[164:167], v[72:87]
    v_mfma_f32_32x32x16_bf16 v[88:103], v[148:151], v[168:171], v[88:103]
    s_waitcnt vmcnt(9)
    s_waitcnt lgkmcnt(0)
    v_mfma_f32_32x32x16_bf16 v[8:23], v[152:155], v[172:175], v[8:23]
    ds_read_b128 v[164:167], v182 offset:8192
    ds_read_b128 v[168:171], v182 offset:12288
    v_mfma_f32_32x32x16_bf16 v[24:39], v[152:155], v[176:179], v[24:39]
    v_mfma_f32_32x32x16_bf16 v[40:55], v[156:159], v[172:175], v[40:55]
    v_mfma_f32_32x32x16_bf16 v[56:71], v[156:159], v[176:179], v[56:71]
    v_mfma_f32_32x32x16_bf16 v[72:87], v[160:163], v[172:175], v[72:87]
    v_mfma_f32_32x32x16_bf16 v[88:103], v[160:163], v[176:179], v[88:103]
    s_waitcnt vmcnt(3)
    s_waitcnt lgkmcnt(0)
    v_mfma_f32_32x32x16_bf16 v[8:23], v[104:107], v[164:167], v[8:23]
    ds_read_b128 v[172:175], v183 offset:8192
    ds_read_b128 v[176:179], v183 offset:12288
    v_mfma_f32_32x32x16_bf16 v[24:39], v[104:107], v[168:171], v[24:39]
    s_lshl_b32 s40, s32, 3
    s_add_u32 s40, s40, s33
    s_lshl_b32 s40, s40, 2
    s_add_u32 s40, s40, s34
    s_mul_i32 s40, s40, 3072
    s_add_u32 s40, s40, 3145728
    s_mul_i32 s40, s34, 3072
    s_add_u32 s40, s40, 73728
    v_add_u32 v3, s40, v5
    ds_read_b128 v[184:187], v3 offset:0
    v_mfma_f32_32x32x16_bf16 v[40:55], v[108:111], v[164:167], v[40:55]
    ds_read_b128 v[188:191], v3 offset:1024
    v_mfma_f32_32x32x16_bf16 v[56:71], v[108:111], v[168:171], v[56:71]
    ds_read_b128 v[192:195], v3 offset:2048
    v_mfma_f32_32x32x16_bf16 v[72:87], v[112:115], v[164:167], v[72:87]
    v_and_b32 v2, 31, v1
    v_lshlrev_b32 v2, 1, v2
    s_lshr_b32 s40, s34, 1
    s_lshl_b32 s40, s40, 6
    s_lshl_b32 s43, s32, 7
    s_add_u32 s40, s40, s43
    buffer_load_ushort v196, v2, s[12:15], s40 offen
    v_mfma_f32_32x32x16_bf16 v[88:103], v[112:115], v[168:171], v[88:103]
    s_waitcnt vmcnt(1)
    s_waitcnt lgkmcnt(3)
    v_mfma_f32_32x32x16_bf16 v[8:23], v[116:119], v[172:175], v[8:23]
    v_mfma_f32_32x32x16_bf16 v[24:39], v[116:119], v[176:179], v[24:39]
    v_mfma_f32_32x32x16_bf16 v[40:55], v[120:123], v[172:175], v[40:55]
    v_mfma_f32_32x32x16_bf16 v[56:71], v[120:123], v[176:179], v[56:71]
    v_mfma_f32_32x32x16_bf16 v[72:87], v[124:127], v[172:175], v[72:87]
    v_mfma_f32_32x32x16_bf16 v[88:103], v[124:127], v[176:179], v[88:103]
    s_setprio 0
    v_add_u32 v4, 0x10000, v5
    s_nop 15
    s_waitcnt lgkmcnt(0)
    v_mov_b32 v2, 161792
    v_mov_b32 v3, 1
    s_mov_b64 exec, 1
    ds_add_u32 v2, v3
    s_mov_b64 exec, -1
    s_mov_b32 s67, 0
gsync_18:
    ds_read_b32 v3, v2
    s_add_u32 s67, s67, 1
    s_waitcnt lgkmcnt(0)
    v_readfirstlane_b32 s66, v3
    s_cmp_gt_u32 s67, 1000000
    s_cbranch_scc1 gsync_e_19
    s_cmp_lt_u32 s66, 4
    s_cbranch_scc1 gsync_18
gsync_e_19:
    s_cmp_lg_u32 s34, 0
    s_cbranch_scc1 g_epi_14
    ds_write_b128 v5, v[12:15] offset:30720
    ds_write_b128 v5, v[20:23] offset:31744
    ds_write_b128 v5, v[44:47] offset:32768
    ds_write_b128 v5, v[52:55] offset:33792
    ds_write_b128 v5, v[76:79] offset:34816
    ds_write_b128 v5, v[84:87] offset:35840
    ds_write_b128 v5, v[24:27] offset:43008
    ds_write_b128 v5, v[32:35] offset:44032
    ds_write_b128 v5, v[56:59] offset:45056
    ds_write_b128 v5, v[64:67] offset:46080
    ds_write_b128 v5, v[88:91] offset:47104
    ds_write_b128 v5, v[96:99] offset:48128
    ds_write_b128 v5, v[28:31] offset:55296
    ds_write_b128 v5, v[36:39] offset:56320
    ds_write_b128 v5, v[60:63] offset:57344
    ds_write_b128 v5, v[68:71] offset:58368
    ds_write_b128 v5, v[92:95] offset:59392
    ds_write_b128 v5, v[100:103] offset:60416
    v_pk_add_f32 v[104:105], v[8:9], 0
    v_pk_add_f32 v[106:107], v[10:11], 0
    v_pk_add_f32 v[108:109], v[16:17], 0
    v_pk_add_f32 v[110:111], v[18:19], 0
    v_pk_add_f32 v[112:113], v[40:41], 0
    v_pk_add_f32 v[114:115], v[42:43], 0
    v_pk_add_f32 v[116:117], v[48:49], 0
    v_pk_add_f32 v[118:119], v[50:51], 0
    v_pk_add_f32 v[120:121], v[72:73], 0
    v_pk_add_f32 v[122:123], v[74:75], 0
    v_pk_add_f32 v[124:125], v[80:81], 0
    v_pk_add_f32 v[126:127], v[82:83], 0
    s_branch g_epi_end_13
g_epi_14:
    s_cmp_lg_u32 s34, 1
    s_cbranch_scc1 g_epi_15
    ds_write_b128 v5, v[8:11] offset:0
    ds_write_b128 v5, v[16:19] offset:1024
    ds_write_b128 v5, v[40:43] offset:2048
    ds_write_b128 v5, v[48:51] offset:3072
    ds_write_b128 v5, v[72:75] offset:4096
    ds_write_b128 v5, v[80:83] offset:5120
    ds_write_b128 v5, v[24:27] offset:49152
    ds_write_b128 v5, v[32:35] offset:50176
    ds_write_b128 v5, v[56:59] offset:51200
    ds_write_b128 v5, v[64:67] offset:52224
    ds_write_b128 v5, v[88:91] offset:53248
    ds_write_b128 v5, v[96:99] offset:54272
    ds_write_b128 v5, v[28:31] offset:61440
    ds_write_b128 v5, v[36:39] offset:62464
    ds_write_b128 v5, v[60:63] offset:63488
    ds_write_b128 v5, v[68:71] offset:64512
    ds_write_b128 v4, v[92:95] offset:0
    ds_write_b128 v4, v[100:103] offset:1024
    v_pk_add_f32 v[104:105], v[12:13], 0
    v_pk_add_f32 v[106:107], v[14:15], 0
    v_pk_add_f32 v[108:109], v[20:21], 0
    v_pk_add_f32 v[110:111], v[22:23], 0
    v_pk_add_f32 v[112:113], v[44:45], 0
    v_pk_add_f32 v[114:115], v[46:47], 0
    v_pk_add_f32 v[116:117], v[52:53], 0
    v_pk_add_f32 v[118:119], v[54:55], 0
    v_pk_add_f32 v[120:121], v[76:77], 0
    v_pk_add_f32 v[122:123], v[78:79], 0
    v_pk_add_f32 v[124:125], v[84:85], 0
    v_pk_add_f32 v[126:127], v[86:87], 0
    s_branch g_epi_end_13
g_epi_15:
    s_cmp_lg_u32 s34, 2
    s_cbranch_scc1 g_epi_16
    ds_write_b128 v5, v[8:11] offset:6144
    ds_write_b128 v5, v[16:19] offset:7168
    ds_write_b128 v5, v[40:43] offset:8192
    ds_write_b128 v5, v[48:51] offset:9216
    ds_write_b128 v5, v[72:75] offset:10240
    ds_write_b128 v5, v[80:83] offset:11264
    ds_write_b128 v5, v[12:15] offset:18432
    ds_write_b128 v5, v[20:23] offset:19456
    ds_write_b128 v5, v[44:47] offset:20480
    ds_write_b128 v5, v[52:55] offset:21504
    ds_write_b128 v5, v[76:79] offset:22528
    ds_write_b128 v5, v[84:87] offset:23552
    ds_write_b128 v4, v[28:31] offset:2048
    ds_write_b128 v4, v[36:39] offset:3072
    ds_write_b128 v4, v[60:63] offset:4096
    ds_write_b128 v4, v[68:71] offset:5120
    ds_write_b128 v4, v[92:95] offset:6144
    ds_write_b128 v4, v[100:103] offset:7168
    v_pk_add_f32 v[104:105], v[24:25], 0
    v_pk_add_f32 v[106:107], v[26:27], 0
    v_pk_add_f32 v[108:109], v[32:33], 0
    v_pk_add_f32 v[110:111], v[34:35], 0
    v_pk_add_f32 v[112:113], v[56:57], 0
    v_pk_add_f32 v[114:115], v[58:59], 0
    v_pk_add_f32 v[116:117], v[64:65], 0
    v_pk_add_f32 v[118:119], v[66:67], 0
    v_pk_add_f32 v[120:121], v[88:89], 0
    v_pk_add_f32 v[122:123], v[90:91], 0
    v_pk_add_f32 v[124:125], v[96:97], 0
    v_pk_add_f32 v[126:127], v[98:99], 0
    s_branch g_epi_end_13
g_epi_16:
    ds_write_b128 v5, v[8:11] offset:12288
    ds_write_b128 v5, v[16:19] offset:13312
    ds_write_b128 v5, v[40:43] offset:14336
    ds_write_b128 v5, v[48:51] offset:15360
    ds_write_b128 v5, v[72:75] offset:16384
    ds_write_b128 v5, v[80:83] offset:17408
    ds_write_b128 v5, v[12:15] offset:24576
    ds_write_b128 v5, v[20:23] offset:25600
    ds_write_b128 v5, v[44:47] offset:26624
    ds_write_b128 v5, v[52:55] offset:27648
    ds_write_b128 v5, v[76:79] offset:28672
    ds_write_b128 v5, v[84:87] offset:29696
    ds_write_b128 v5, v[24:27] offset:36864
    ds_write_b128 v5, v[32:35] offset:37888
    ds_write_b128 v5, v[56:59] offset:38912
    ds_write_b128 v5, v[64:67] offset:39936
    ds_write_b128 v5, v[88:91] offset:40960
    ds_write_b128 v5, v[96:99] offset:41984
    v_pk_add_f32 v[104:105], v[28:29], 0
    v_pk_add_f32 v[106:107], v[30:31], 0
    v_pk_add_f32 v[108:109], v[36:37], 0
    v_pk_add_f32 v[110:111], v[38:39], 0
    v_pk_add_f32 v[112:113], v[60:61], 0
    v_pk_add_f32 v[114:115], v[62:63], 0
    v_pk_add_f32 v[116:117], v[68:69], 0
    v_pk_add_f32 v[118:119], v[70:71], 0
    v_pk_add_f32 v[120:121], v[92:93], 0
    v_pk_add_f32 v[122:123], v[94:95], 0
    v_pk_add_f32 v[124:125], v[100:101], 0
    v_pk_add_f32 v[126:127], v[102:103], 0
g_epi_end_13:
    s_waitcnt lgkmcnt(0)
    s_waitcnt lgkmcnt(0)
    v_mov_b32 v2, 161792
    v_mov_b32 v3, 1
    s_mov_b64 exec, 1
    ds_add_u32 v2, v3
    s_mov_b64 exec, -1
    s_mov_b32 s67, 0
gsync_20:
    ds_read_b32 v3, v2
    s_add_u32 s67, s67, 1
    s_waitcnt lgkmcnt(0)
    v_readfirstlane_b32 s66, v3
    s_cmp_gt_u32 s67, 1000000
    s_cbranch_scc1 gsync_e_21
    s_cmp_lt_u32 s66, 8
    s_cbranch_scc1 gsync_20
gsync_e_21:
    s_mul_i32 s40, s34, 18432
    v_add_u32 v2, s40, v5
    ds_read_b128 v[8:11], v2 offset:0
    ds_read_b128 v[12:15], v2 offset:1024
    ds_read_b128 v[16:19], v2 offset:2048
    ds_read_b128 v[20:23], v2 offset:3072
    ds_read_b128 v[24:27], v2 offset:4096
    ds_read_b128 v[28:31], v2 offset:5120
    ds_read_b128 v[32:35], v2 offset:6144
    ds_read_b128 v[36:39], v2 offset:7168
    ds_read_b128 v[40:43], v2 offset:8192
    ds_read_b128 v[44:47], v2 offset:9216
    ds_read_b128 v[48:51], v2 offset:10240
    ds_read_b128 v[52:55], v2 offset:11264
    ds_read_b128 v[56:59], v2 offset:12288
    ds_read_b128 v[60:63], v2 offset:13312
    ds_read_b128 v[64:67], v2 offset:14336
    ds_read_b128 v[68:71], v2 offset:15360
    ds_read_b128 v[72:75], v2 offset:16384
    ds_read_b128 v[76:79], v2 offset:17408
    v_lshrrev_b32 v6, 4, v1
    v_and_b32 v6, 1, v6
    v_mul_u32_u24 v6, 24576, v6
    v_and_b32 v3, 15, v1
    v_lshrrev_b32 v4, 5, v1
    v_lshl_add_u32 v3, v4, 4, v3
    v_lshl_add_u32 v6, v3, 4, v6
    s_mul_i32 s40, s32, 98304
    s_lshr_b32 s41, s34, 1
    s_mul_i32 s41, s41, 49152
    s_add_u32 s40, s40, s41
    s_mul_i32 s41, s33, 3072
    s_add_u32 s40, s40, s41
    s_and_b32 s41, s34, 1
    s_lshl_b32 s41, s41, 9
    s_add_u32 s40, s40, s41
    s_add_u32 s40, s40, 11534336
    s_waitcnt vmcnt(0)
    v_lshlrev_b32 v180, 16, v196
    v_lshlrev_b32 v80, 16, v184
    v_and_b32 v81, 0xffff0000, v184
    v_lshlrev_b32 v82, 16, v185
    v_and_b32 v83, 0xffff0000, v185
    v_lshlrev_b32 v84, 16, v186
    v_and_b32 v85, 0xffff0000, v186
    v_lshlrev_b32 v86, 16, v187
    v_and_b32 v87, 0xffff0000, v187
    v_lshlrev_b32 v88, 16, v188
    v_and_b32 v89, 0xffff0000, v188
    v_lshlrev_b32 v90, 16, v189
    v_and_b32 v91, 0xffff0000, v189
    v_lshlrev_b32 v92, 16, v190
    v_and_b32 v93, 0xffff0000, v190
    v_lshlrev_b32 v94, 16, v191
    v_and_b32 v95, 0xffff0000, v191
    v_lshlrev_b32 v96, 16, v192
    v_and_b32 v97, 0xffff0000, v192
    v_lshlrev_b32 v98, 16, v193
    v_and_b32 v99, 0xffff0000, v193
    v_lshlrev_b32 v100, 16, v194
    v_and_b32 v101, 0xffff0000, v194
    v_lshlrev_b32 v102, 16, v195
    v_and_b32 v103, 0xffff0000, v195
    s_waitcnt lgkmcnt(12)
    v_pk_add_f32 v[104:105], v[104:105], v[8:9]
    v_pk_add_f32 v[106:107], v[106:107], v[10:11]
    v_pk_add_f32 v[108:109], v[108:109], v[12:13]
    v_pk_add_f32 v[110:111], v[110:111], v[14:15]
    v_pk_add_f32 v[112:113], v[112:113], v[16:17]
    v_pk_add_f32 v[114:115], v[114:115], v[18:19]
    v_pk_add_f32 v[116:117], v[116:117], v[20:21]
    v_pk_add_f32 v[118:119], v[118:119], v[22:23]
    v_pk_add_f32 v[120:121], v[120:121], v[24:25]
    v_pk_add_f32 v[122:123], v[122:123], v[26:27]
    v_pk_add_f32 v[124:125], v[124:125], v[28:29]
    v_pk_add_f32 v[126:127], v[126:127], v[30:31]
    s_waitcnt lgkmcnt(6)
    v_pk_add_f32 v[104:105], v[104:105], v[32:33]
    v_pk_add_f32 v[106:107], v[106:107], v[34:35]
    v_pk_add_f32 v[108:109], v[108:109], v[36:37]
    v_pk_add_f32 v[110:111], v[110:111], v[38:39]
    v_pk_add_f32 v[112:113], v[112:113], v[40:41]
    v_pk_add_f32 v[114:115], v[114:115], v[42:43]
    v_pk_add_f32 v[116:117], v[116:117], v[44:45]
    v_pk_add_f32 v[118:119], v[118:119], v[46:47]
    v_pk_add_f32 v[120:121], v[120:121], v[48:49]
    v_pk_add_f32 v[122:123], v[122:123], v[50:51]
    v_pk_add_f32 v[124:125], v[124:125], v[52:53]
    v_pk_add_f32 v[126:127], v[126:127], v[54:55]
    s_waitcnt lgkmcnt(0)
    v_pk_add_f32 v[104:105], v[104:105], v[56:57]
    v_pk_add_f32 v[106:107], v[106:107], v[58:59]
    v_pk_add_f32 v[108:109], v[108:109], v[60:61]
    v_pk_add_f32 v[110:111], v[110:111], v[62:63]
    v_pk_add_f32 v[112:113], v[112:113], v[64:65]
    v_pk_add_f32 v[114:115], v[114:115], v[66:67]
    v_pk_add_f32 v[116:117], v[116:117], v[68:69]
    v_pk_add_f32 v[118:119], v[118:119], v[70:71]
    v_pk_add_f32 v[120:121], v[120:121], v[72:73]
    v_pk_add_f32 v[122:123], v[122:123], v[74:75]
    v_pk_add_f32 v[124:125], v[124:125], v[76:77]
    v_pk_add_f32 v[126:127], v[126:127], v[78:79]
    v_pk_add_f32 v[104:105], v[104:105], v[180:181] op_sel_hi:[1,0]
    v_pk_add_f32 v[106:107], v[106:107], v[180:181] op_sel_hi:[1,0]
    v_pk_add_f32 v[108:109], v[108:109], v[180:181] op_sel_hi:[1,0]
    v_pk_add_f32 v[110:111], v[110:111], v[180:181] op_sel_hi:[1,0]
    v_pk_add_f32 v[112:113], v[112:113], v[180:181] op_sel_hi:[1,0]
    v_pk_add_f32 v[114:115], v[114:115], v[180:181] op_sel_hi:[1,0]
    v_pk_add_f32 v[116:117], v[116:117], v[180:181] op_sel_hi:[1,0]
    v_pk_add_f32 v[118:119], v[118:119], v[180:181] op_sel_hi:[1,0]
    v_pk_add_f32 v[120:121], v[120:121], v[180:181] op_sel_hi:[1,0]
    v_pk_add_f32 v[122:123], v[122:123], v[180:181] op_sel_hi:[1,0]
    v_pk_add_f32 v[124:125], v[124:125], v[180:181] op_sel_hi:[1,0]
    v_pk_add_f32 v[126:127], v[126:127], v[180:181] op_sel_hi:[1,0]
    v_pk_mul_f32 v[104:105], v[104:105], v[80:81]
    v_pk_mul_f32 v[106:107], v[106:107], v[82:83]
    v_pk_mul_f32 v[108:109], v[108:109], v[84:85]
    v_pk_mul_f32 v[110:111], v[110:111], v[86:87]
    v_pk_mul_f32 v[112:113], v[112:113], v[88:89]
    v_pk_mul_f32 v[114:115], v[114:115], v[90:91]
    v_pk_mul_f32 v[116:117], v[116:117], v[92:93]
    v_pk_mul_f32 v[118:119], v[118:119], v[94:95]
    v_pk_mul_f32 v[120:121], v[120:121], v[96:97]
    v_pk_mul_f32 v[122:123], v[122:123], v[98:99]
    v_pk_mul_f32 v[124:125], v[124:125], v[100:101]
    v_pk_mul_f32 v[126:127], v[126:127], v[102:103]
    v_cvt_pk_bf16_f32 v8, v104, v105
    v_cvt_pk_bf16_f32 v9, v106, v107
    v_cvt_pk_bf16_f32 v10, v108, v109
    v_cvt_pk_bf16_f32 v11, v110, v111
    buffer_store_dwordx4 v[8:11], v6, s[8:11], s40 offen offset:0 sc1
    v_cvt_pk_bf16_f32 v12, v112, v113
    v_cvt_pk_bf16_f32 v13, v114, v115
    v_cvt_pk_bf16_f32 v14, v116, v117
    v_cvt_pk_bf16_f32 v15, v118, v119
    buffer_store_dwordx4 v[12:15], v6, s[8:11], s40 offen offset:1024 sc1
    v_cvt_pk_bf16_f32 v16, v120, v121
    v_cvt_pk_bf16_f32 v17, v122, v123
    v_cvt_pk_bf16_f32 v18, v124, v125
    v_cvt_pk_bf16_f32 v19, v126, v127
    buffer_store_dwordx4 v[16:19], v6, s[8:11], s40 offen offset:2048 sc1
    s_waitcnt vmcnt(0)
    s_waitcnt lgkmcnt(0)
    v_mov_b32 v1, 161792
    v_mov_b32 v2, 1
    s_mov_b64 exec, 1
    ds_add_u32 v1, v2
    s_mov_b64 exec, -1
    s_mov_b32 s67, 0
gsync_22:
    ds_read_b32 v2, v1
    s_add_u32 s67, s67, 1
    s_waitcnt lgkmcnt(0)
    v_readfirstlane_b32 s66, v2
    s_cmp_gt_u32 s67, 1000000
    s_cbranch_scc1 gsync_e_23
    s_cmp_lt_u32 s66, 12
    s_cbranch_scc1 gsync_22
gsync_e_23:
    s_lshl_b32 s58, s32, 6
    s_lshl_b32 s59, s33, 3
    s_add_u32 s58, s58, s59
    s_add_u32 s58, s58, 14729216
    v_mov_b32 v250, s100
    v_mov_b32 v251, s101
    v_mov_b32 v252, 0
    s_cmp_eq_u32 s34, 0
    s_cselect_b64 exec, 1, 0
    buffer_store_dwordx2 v[250:251], v252, s[8:11], s58 offen sc1
    s_mov_b64 exec, -1
    s_load_dwordx2 s[12:13], s[0:1], 104
    s_load_dwordx2 s[8:9], s[0:1], 0
    s_load_dwordx2 s[16:17], s[0:1], 88
    s_mov_b32 s10, 2621440
    s_mov_b32 s11, 0x20000
    s_mov_b32 s14, 15990784
    s_mov_b32 s15, 0x20000
    s_mov_b32 s18, 2621440
    s_mov_b32 s19, 0x20000
    v_lshrrev_b32 v4, 6, v0
    v_and_b32 v1, 63, v0
    v_readfirstlane_b32 s34, v4
    v_lshlrev_b32 v7, 4, v1
    s_and_b32 s40, s2, 7
    s_lshr_b32 s41, s2, 3
    s_lshr_b32 s32, s40, 1
    s_lshl_b32 s32, s32, 3
    s_and_b32 s42, s41, 7
    s_add_u32 s32, s32, s42
    s_and_b32 s33, s40, 1
    s_lshl_b32 s33, s33, 2
    s_lshr_b32 s42, s41, 3
    s_add_u32 s33, s33, s42
    s_add_u32 s40, s32, s33
    s_mul_i32 s41, s40, 43
    s_lshr_b32 s41, s41, 8
    s_mul_i32 s41, s41, 6
    s_sub_u32 s48, s40, s41
    s_mul_i32 s46, s33, 122880
    s_add_u32 s46, s46, 15007744
    s_mul_i32 s40, s34, 5120
    s_add_u32 s46, s46, s40
    s_mul_i32 s47, s32, 98304
    s_mul_i32 s41, s34, 24576
    s_add_u32 s47, s47, s41
    s_add_u32 s47, s47, 11534336
    s_add_u32 s40, s48, 0
    s_sub_u32 s41, s40, 6
    s_cmp_ge_u32 s40, 6
    s_cselect_b32 s50, s41, s40
    s_add_u32 s40, s48, 1
    s_sub_u32 s41, s40, 6
    s_cmp_ge_u32 s40, 6
    s_cselect_b32 s51, s41, s40
    s_add_u32 s40, s48, 2
    s_sub_u32 s41, s40, 6
    s_cmp_ge_u32 s40, 6
    s_cselect_b32 s52, s41, s40
    s_add_u32 s40, s48, 3
    s_sub_u32 s41, s40, 6
    s_cmp_ge_u32 s40, 6
    s_cselect_b32 s53, s41, s40
    s_add_u32 s40, s48, 4
    s_sub_u32 s41, s40, 6
    s_cmp_ge_u32 s40, 6
    s_cselect_b32 s54, s41, s40
    s_add_u32 s40, s48, 5
    s_sub_u32 s41, s40, 6
    s_cmp_ge_u32 s40, 6
    s_cselect_b32 s55, s41, s40
    s_waitcnt lgkmcnt(0)
    s_mul_i32 s40, s33, 192
    s_add_u32 s40, s40, 14725120
    v_mbcnt_lo_u32_b32 v4, -1, 0
    v_mbcnt_hi_u32_b32 v4, -1, v4
    v_min_u32 v4, 23, v4
    v_lshlrev_b32 v4, 3, v4
    s_mov_b32 s67, 0
fpoll_24:
    buffer_load_dwordx2 v[8:9], v4, s[12:15], s40 offen sc1
    s_add_u32 s67, s67, 1
    s_waitcnt vmcnt(0)
    v_cmp_ne_u32 vcc, s100, v8
    v_cmp_ne_u32 s[64:65], s101, v9
    s_nop 0
    s_or_b64 vcc, vcc, s[64:65]
    s_cmp_gt_u32 s67, 100000
    s_cbranch_scc1 fpoll_e_25
    s_cmp_eq_u64 vcc, 0
    s_cbranch_scc1 fpoll_e_25
    s_sleep 2
    s_branch fpoll_24
fpoll_e_25:
    s_mul_i32 s40, s50, 20480
    s_add_u32 s40, s40, s46
    s_add_u32 s40, s40, 0
    s_mul_i32 s41, s34, 5120
    s_add_u32 m0, s41, 0
    s_nop 0
    buffer_load_dwordx4 v7, s[12:15], s40 offen sc1 lds
    s_mul_i32 s40, s50, 20480
    s_add_u32 s40, s40, s46
    s_add_u32 s40, s40, 1024
    s_mul_i32 s41, s34, 5120
    s_add_u32 m0, s41, 1024
    s_nop 0
    buffer_load_dwordx4 v7, s[12:15], s40 offen sc1 lds
    s_mul_i32 s40, s50, 20480
    s_add_u32 s40, s40, s46
    s_add_u32 s40, s40, 2048
    s_mul_i32 s41, s34, 5120
    s_add_u32 m0, s41, 2048
    s_nop 0
    buffer_load_dwordx4 v7, s[12:15], s40 offen sc1 lds
    s_mul_i32 s40, s50, 20480
    s_add_u32 s40, s40, s46
    s_add_u32 s40, s40, 3072
    s_mul_i32 s41, s34, 5120
    s_add_u32 m0, s41, 3072
    s_nop 0
    buffer_load_dwordx4 v7, s[12:15], s40 offen sc1 lds
    s_mul_i32 s40, s50, 20480
    s_add_u32 s40, s40, s46
    s_add_u32 s40, s40, 4096
    s_mul_i32 s41, s34, 5120
    s_add_u32 m0, s41, 4096
    s_nop 0
    buffer_load_dwordx4 v7, s[12:15], s40 offen sc1 lds
    s_mul_i32 s40, s51, 20480
    s_add_u32 s40, s40, s46
    s_add_u32 s40, s40, 0
    s_mul_i32 s41, s34, 5120
    s_add_u32 m0, s41, 20480
    s_nop 0
    buffer_load_dwordx4 v7, s[12:15], s40 offen sc1 lds
    s_mul_i32 s40, s51, 20480
    s_add_u32 s40, s40, s46
    s_add_u32 s40, s40, 1024
    s_mul_i32 s41, s34, 5120
    s_add_u32 m0, s41, 21504
    s_nop 0
    buffer_load_dwordx4 v7, s[12:15], s40 offen sc1 lds
    s_mul_i32 s40, s51, 20480
    s_add_u32 s40, s40, s46
    s_add_u32 s40, s40, 2048
    s_mul_i32 s41, s34, 5120
    s_add_u32 m0, s41, 22528
    s_nop 0
    buffer_load_dwordx4 v7, s[12:15], s40 offen sc1 lds
    s_mul_i32 s40, s51, 20480
    s_add_u32 s40, s40, s46
    s_add_u32 s40, s40, 3072
    s_mul_i32 s41, s34, 5120
    s_add_u32 m0, s41, 23552
    s_nop 0
    buffer_load_dwordx4 v7, s[12:15], s40 offen sc1 lds
    s_mul_i32 s40, s51, 20480
    s_add_u32 s40, s40, s46
    s_add_u32 s40, s40, 4096
    s_mul_i32 s41, s34, 5120
    s_add_u32 m0, s41, 24576
    s_nop 0
    buffer_load_dwordx4 v7, s[12:15], s40 offen sc1 lds
    s_mul_i32 s40, s52, 20480
    s_add_u32 s40, s40, s46
    s_add_u32 s40, s40, 0
    s_mul_i32 s41, s34, 5120
    s_add_u32 m0, s41, 40960
    s_nop 0
    buffer_load_dwordx4 v7, s[12:15], s40 offen sc1 lds
    s_mul_i32 s40, s52, 20480
    s_add_u32 s40, s40, s46
    s_add_u32 s40, s40, 1024
    s_mul_i32 s41, s34, 5120
    s_add_u32 m0, s41, 41984
    s_nop 0
    buffer_load_dwordx4 v7, s[12:15], s40 offen sc1 lds
    s_mul_i32 s40, s52, 20480
    s_add_u32 s40, s40, s46
    s_add_u32 s40, s40, 2048
    s_mul_i32 s41, s34, 5120
    s_add_u32 m0, s41, 43008
    s_nop 0
    buffer_load_dwordx4 v7, s[12:15], s40 offen sc1 lds
    s_mul_i32 s40, s52, 20480
    s_add_u32 s40, s40, s46
    s_add_u32 s40, s40, 3072
    s_mul_i32 s41, s34, 5120
    s_add_u32 m0, s41, 44032
    s_nop 0
    buffer_load_dwordx4 v7, s[12:15], s40 offen sc1 lds
    s_mul_i32 s40, s52, 20480
    s_add_u32 s40, s40, s46
    s_add_u32 s40, s40, 4096
    s_mul_i32 s41, s34, 5120
    s_add_u32 m0, s41, 45056
    s_nop 0
    buffer_load_dwordx4 v7, s[12:15], s40 offen sc1 lds
    s_mul_i32 s40, s53, 20480
    s_add_u32 s40, s40, s46
    s_add_u32 s40, s40, 0
    s_mul_i32 s41, s34, 5120
    s_add_u32 m0, s41, 61440
    s_nop 0
    buffer_load_dwordx4 v7, s[12:15], s40 offen sc1 lds
    s_mul_i32 s40, s53, 20480
    s_add_u32 s40, s40, s46
    s_add_u32 s40, s40, 1024
    s_mul_i32 s41, s34, 5120
    s_add_u32 m0, s41, 62464
    s_nop 0
    buffer_load_dwordx4 v7, s[12:15], s40 offen sc1 lds
    s_mul_i32 s40, s53, 20480
    s_add_u32 s40, s40, s46
    s_add_u32 s40, s40, 2048
    s_mul_i32 s41, s34, 5120
    s_add_u32 m0, s41, 63488
    s_nop 0
    buffer_load_dwordx4 v7, s[12:15], s40 offen sc1 lds
    s_mul_i32 s40, s53, 20480
    s_add_u32 s40, s40, s46
    s_add_u32 s40, s40, 3072
    s_mul_i32 s41, s34, 5120
    s_add_u32 m0, s41, 64512
    s_nop 0
    buffer_load_dwordx4 v7, s[12:15], s40 offen sc1 lds
    s_mul_i32 s40, s53, 20480
    s_add_u32 s40, s40, s46
    s_add_u32 s40, s40, 4096
    s_mul_i32 s41, s34, 5120
    s_add_u32 m0, s41, 65536
    s_nop 0
    buffer_load_dwordx4 v7, s[12:15], s40 offen sc1 lds
    s_lshl_b32 s40, s32, 6
    s_add_u32 s40, s40, 14729216
    v_mbcnt_lo_u32_b32 v4, -1, 0
    v_mbcnt_hi_u32_b32 v4, -1, v4
    v_min_u32 v4, 7, v4
    v_lshlrev_b32 v4, 3, v4
    s_mov_b32 s67, 0
fpoll_26:
    buffer_load_dwordx2 v[8:9], v4, s[12:15], s40 offen sc1
    s_add_u32 s67, s67, 1
    s_waitcnt vmcnt(0)
    v_cmp_ne_u32 vcc, s100, v8
    v_cmp_ne_u32 s[64:65], s101, v9
    s_nop 0
    s_or_b64 vcc, vcc, s[64:65]
    s_cmp_gt_u32 s67, 100000
    s_cbranch_scc1 fpoll_e_27
    s_cmp_eq_u64 vcc, 0
    s_cbranch_scc1 fpoll_e_27
    s_sleep 2
    s_branch fpoll_26
fpoll_e_27:
    s_lshl_b32 s42, s50, 12
    s_add_u32 s42, s42, s47
    buffer_load_dwordx4 v[8:11], v7, s[12:15], s42 offen offset:0 sc1
    s_lshl_b32 s42, s50, 12
    s_add_u32 s42, s42, s47
    buffer_load_dwordx4 v[12:15], v7, s[12:15], s42 offen offset:1024 sc1
    s_lshl_b32 s42, s50, 12
    s_add_u32 s42, s42, s47
    buffer_load_dwordx4 v[16:19], v7, s[12:15], s42 offen offset:2048 sc1
    s_lshl_b32 s42, s50, 12
    s_add_u32 s42, s42, s47
    buffer_load_dwordx4 v[20:23], v7, s[12:15], s42 offen offset:3072 sc1
    s_lshl_b32 s42, s51, 12
    s_add_u32 s42, s42, s47
    buffer_load_dwordx4 v[24:27], v7, s[12:15], s42 offen offset:0 sc1
    s_lshl_b32 s42, s51, 12
    s_add_u32 s42, s42, s47
    buffer_load_dwordx4 v[28:31], v7, s[12:15], s42 offen offset:1024 sc1
    s_lshl_b32 s42, s51, 12
    s_add_u32 s42, s42, s47
    buffer_load_dwordx4 v[32:35], v7, s[12:15], s42 offen offset:2048 sc1
    s_lshl_b32 s42, s51, 12
    s_add_u32 s42, s42, s47
    buffer_load_dwordx4 v[36:39], v7, s[12:15], s42 offen offset:3072 sc1
    s_waitcnt lgkmcnt(0)
    v_mov_b32 v251, 161792
    v_mov_b32 v252, 1
    s_mov_b64 exec, 1
    ds_add_u32 v251, v252
    s_mov_b64 exec, -1
    s_mov_b32 s67, 0
gsync_28:
    ds_read_b32 v252, v251
    s_add_u32 s67, s67, 1
    s_waitcnt lgkmcnt(0)
    v_readfirstlane_b32 s66, v252
    s_cmp_gt_u32 s67, 1000000
    s_cbranch_scc1 gsync_e_29
    s_cmp_lt_u32 s66, 16
    s_cbranch_scc1 gsync_28
gsync_e_29:
    s_mul_i32 s44, s33, 160
    s_mul_i32 s45, s32, 81920
    s_add_u32 s45, s45, s44
    v_add_u32 v4, 0, v1
    v_mul_u32_u24 v5, 6554, v4
    v_lshrrev_b32 v5, 16, v5
    v_mul_u32_u24 v6, 10, v5
    v_sub_u32 v4, v4, v6
    v_lshlrev_b32 v4, 4, v4
    v_mul_u32_u24 v5, 1280, v5
    v_add_u32 v104, v4, v5
    v_add_u32 v4, 64, v1
    v_mul_u32_u24 v5, 6554, v4
    v_lshrrev_b32 v5, 16, v5
    v_mul_u32_u24 v6, 10, v5
    v_sub_u32 v4, v4, v6
    v_lshlrev_b32 v4, 4, v4
    v_mul_u32_u24 v5, 1280, v5
    v_add_u32 v105, v4, v5
    v_add_u32 v4, 128, v1
    v_mul_u32_u24 v5, 6554, v4
    v_lshrrev_b32 v5, 16, v5
    v_mul_u32_u24 v6, 10, v5
    v_sub_u32 v4, v4, v6
    v_lshlrev_b32 v4, 4, v4
    v_mul_u32_u24 v5, 1280, v5
    v_add_u32 v106, v4, v5
    v_add_u32 v4, 192, v1
    v_mul_u32_u24 v5, 6554, v4
    v_lshrrev_b32 v5, 16, v5
    v_mul_u32_u24 v6, 10, v5
    v_sub_u32 v4, v4, v6
    v_lshlrev_b32 v4, 4, v4
    v_mul_u32_u24 v5, 1280, v5
    v_add_u32 v107, v4, v5
    v_add_u32 v4, 256, v1
    v_mul_u32_u24 v5, 6554, v4
    v_lshrrev_b32 v5, 16, v5
    v_mul_u32_u24 v6, 10, v5
    v_sub_u32 v4, v4, v6
    v_lshlrev_b32 v4, 4, v4
    v_mul_u32_u24 v5, 1280, v5
    v_add_u32 v108, v4, v5
    v_lshrrev_b32 v2, 4, v1
    v_and_b32 v3, 15, v1
    v_mov_b32 v113, v7
    v_add_u32 v114, 61440, v7
    ds_read_b128 v[136:139], v113 offset:0
    ds_read_b128 v[140:143], v113 offset:1024
    ds_read_b128 v[144:147], v113 offset:2048
    ds_read_b128 v[148:151], v113 offset:3072
    ds_read_b128 v[152:155], v113 offset:4096
    ds_read_b128 v[156:159], v113 offset:5120
    ds_read_b128 v[160:163], v113 offset:6144
    ds_read_b128 v[164:167], v113 offset:7168
    ds_read_b128 v[168:171], v113 offset:8192
    ds_read_b128 v[172:175], v113 offset:9216
    s_waitcnt vmcnt(7)
    s_waitcnt lgkmcnt(9)
    v_mfma_f32_16x16x32_bf16 v[116:119], v[136:139], v[8:11], 0
    s_lshl_b32 s42, s52, 12
    s_add_u32 s42, s42, s47
    buffer_load_dwordx4 v[40:43], v7, s[12:15], s42 offen offset:0 sc1
    s_waitcnt lgkmcnt(8)
    v_mfma_f32_16x16x32_bf16 v[120:123], v[140:143], v[8:11], 0
    s_waitcnt lgkmcnt(7)
    v_mfma_f32_16x16x32_bf16 v[124:127], v[144:147], v[8:11], 0
    s_lshl_b32 s42, s52, 12
    s_add_u32 s42, s42, s47
    buffer_load_dwordx4 v[44:47], v7, s[12:15], s42 offen offset:1024 sc1
    s_waitcnt lgkmcnt(6)
    v_mfma_f32_16x16x32_bf16 v[128:131], v[148:151], v[8:11], 0
    s_waitcnt lgkmcnt(5)
    v_mfma_f32_16x16x32_bf16 v[132:135], v[152:155], v[8:11], 0
    s_lshl_b32 s42, s52, 12
    s_add_u32 s42, s42, s47
    buffer_load_dwordx4 v[48:51], v7, s[12:15], s42 offen offset:2048 sc1
    ds_read_b128 v[136:139], v113 offset:10240
    ds_read_b128 v[140:143], v113 offset:11264
    ds_read_b128 v[144:147], v113 offset:12288
    ds_read_b128 v[148:151], v113 offset:13312
    ds_read_b128 v[152:155], v113 offset:14336
    s_waitcnt vmcnt(9)
    s_waitcnt lgkmcnt(9)
    v_mfma_f32_16x16x32_bf16 v[116:119], v[156:159], v[12:15], v[116:119]
    s_lshl_b32 s42, s52, 12
    s_add_u32 s42, s42, s47
    buffer_load_dwordx4 v[52:55], v7, s[12:15], s42 offen offset:3072 sc1
    s_waitcnt lgkmcnt(8)
    v_mfma_f32_16x16x32_bf16 v[120:123], v[160:163], v[12:15], v[120:123]
    s_waitcnt lgkmcnt(7)
    v_mfma_f32_16x16x32_bf16 v[124:127], v[164:167], v[12:15], v[124:127]
    s_waitcnt lgkmcnt(6)
    v_mfma_f32_16x16x32_bf16 v[128:131], v[168:171], v[12:15], v[128:131]
    s_waitcnt lgkmcnt(5)
    v_mfma_f32_16x16x32_bf16 v[132:135], v[172:175], v[12:15], v[132:135]
    ds_read_b128 v[156:159], v113 offset:15360
    ds_read_b128 v[160:163], v113 offset:16384
    ds_read_b128 v[164:167], v113 offset:17408
    ds_read_b128 v[168:171], v113 offset:18432
    ds_read_b128 v[172:175], v113 offset:19456
    s_waitcnt vmcnt(9)
    s_waitcnt lgkmcnt(9)
    v_mfma_f32_16x16x32_bf16 v[116:119], v[136:139], v[16:19], v[116:119]
    s_waitcnt lgkmcnt(8)
    v_mfma_f32_16x16x32_bf16 v[120:123], v[140:143], v[16:19], v[120:123]
    s_waitcnt lgkmcnt(7)
    v_mfma_f32_16x16x32_bf16 v[124:127], v[144:147], v[16:19], v[124:127]
    s_waitcnt lgkmcnt(6)
    v_mfma_f32_16x16x32_bf16 v[128:131], v[148:151], v[16:19], v[128:131]
    s_waitcnt lgkmcnt(5)
    v_mfma_f32_16x16x32_bf16 v[132:135], v[152:155], v[16:19], v[132:135]
    s_waitcnt vmcnt(8)
    s_waitcnt lgkmcnt(4)
    v_mfma_f32_16x16x32_bf16 v[116:119], v[156:159], v[20:23], v[116:119]
    s_waitcnt lgkmcnt(3)
    v_mfma_f32_16x16x32_bf16 v[120:123], v[160:163], v[20:23], v[120:123]
    s_waitcnt lgkmcnt(2)
    v_mfma_f32_16x16x32_bf16 v[124:127], v[164:167], v[20:23], v[124:127]
    s_waitcnt lgkmcnt(1)
    v_mfma_f32_16x16x32_bf16 v[128:131], v[168:171], v[20:23], v[128:131]
    s_waitcnt lgkmcnt(0)
    v_mfma_f32_16x16x32_bf16 v[132:135], v[172:175], v[20:23], v[132:135]
    ds_read_b128 v[136:139], v113 offset:20480
    ds_read_b128 v[140:143], v113 offset:21504
    ds_read_b128 v[144:147], v113 offset:22528
    ds_read_b128 v[148:151], v113 offset:23552
    ds_read_b128 v[152:155], v113 offset:24576
    ds_read_b128 v[156:159], v113 offset:25600
    ds_read_b128 v[160:163], v113 offset:26624
    ds_read_b128 v[164:167], v113 offset:27648
    ds_read_b128 v[168:171], v113 offset:28672
    ds_read_b128 v[172:175], v113 offset:29696
    s_waitcnt vmcnt(7)
    s_waitcnt lgkmcnt(9)
    v_mfma_f32_16x16x32_bf16 v[116:119], v[136:139], v[24:27], v[116:119]
    s_lshl_b32 s42, s53, 12
    s_add_u32 s42, s42, s47
    buffer_load_dwordx4 v[56:59], v7, s[12:15], s42 offen offset:0 sc1
    s_waitcnt lgkmcnt(8)
    v_mfma_f32_16x16x32_bf16 v[120:123], v[140:143], v[24:27], v[120:123]
    s_waitcnt lgkmcnt(7)
    v_mfma_f32_16x16x32_bf16 v[124:127], v[144:147], v[24:27], v[124:127]
    s_lshl_b32 s42, s53, 12
    s_add_u32 s42, s42, s47
    buffer_load_dwordx4 v[60:63], v7, s[12:15], s42 offen offset:1024 sc1
    s_waitcnt lgkmcnt(6)
    v_mfma_f32_16x16x32_bf16 v[128:131], v[148:151], v[24:27], v[128:131]
    s_waitcnt lgkmcnt(5)
    v_mfma_f32_16x16x32_bf16 v[132:135], v[152:155], v[24:27], v[132:135]
    s_lshl_b32 s42, s53, 12
    s_add_u32 s42, s42, s47
    buffer_load_dwordx4 v[64:67], v7, s[12:15], s42 offen offset:2048 sc1
    ds_read_b128 v[136:139], v113 offset:30720
    ds_read_b128 v[140:143], v113 offset:31744
    ds_read_b128 v[144:147], v113 offset:32768
    ds_read_b128 v[148:151], v113 offset:33792
    ds_read_b128 v[152:155], v113 offset:34816
    s_waitcnt vmcnt(9)
    s_waitcnt lgkmcnt(9)
    v_mfma_f32_16x16x32_bf16 v[116:119], v[156:159], v[28:31], v[116:119]
    s_lshl_b32 s42, s53, 12
    s_add_u32 s42, s42, s47
    buffer_load_dwordx4 v[68:71], v7, s[12:15], s42 offen offset:3072 sc1
    s_waitcnt lgkmcnt(8)
    v_mfma_f32_16x16x32_bf16 v[120:123], v[160:163], v[28:31], v[120:123]
    s_waitcnt lgkmcnt(7)
    v_mfma_f32_16x16x32_bf16 v[124:127], v[164:167], v[28:31], v[124:127]
    s_waitcnt lgkmcnt(6)
    v_mfma_f32_16x16x32_bf16 v[128:131], v[168:171], v[28:31], v[128:131]
    s_waitcnt lgkmcnt(5)
    v_mfma_f32_16x16x32_bf16 v[132:135], v[172:175], v[28:31], v[132:135]
    ds_read_b128 v[156:159], v113 offset:35840
    ds_read_b128 v[160:163], v113 offset:36864
    ds_read_b128 v[164:167], v113 offset:37888
    ds_read_b128 v[168:171], v113 offset:38912
    ds_read_b128 v[172:175], v113 offset:39936
    s_waitcnt vmcnt(9)
    s_waitcnt lgkmcnt(9)
    v_mfma_f32_16x16x32_bf16 v[116:119], v[136:139], v[32:35], v[116:119]
    s_waitcnt lgkmcnt(8)
    v_mfma_f32_16x16x32_bf16 v[120:123], v[140:143], v[32:35], v[120:123]
    s_waitcnt lgkmcnt(7)
    v_mfma_f32_16x16x32_bf16 v[124:127], v[144:147], v[32:35], v[124:127]
    s_waitcnt lgkmcnt(6)
    v_mfma_f32_16x16x32_bf16 v[128:131], v[148:151], v[32:35], v[128:131]
    s_waitcnt lgkmcnt(5)
    v_mfma_f32_16x16x32_bf16 v[132:135], v[152:155], v[32:35], v[132:135]
    s_waitcnt vmcnt(8)
    s_waitcnt lgkmcnt(4)
    v_mfma_f32_16x16x32_bf16 v[116:119], v[156:159], v[36:39], v[116:119]
    s_waitcnt lgkmcnt(3)
    v_mfma_f32_16x16x32_bf16 v[120:123], v[160:163], v[36:39], v[120:123]
    s_waitcnt lgkmcnt(2)
    v_mfma_f32_16x16x32_bf16 v[124:127], v[164:167], v[36:39], v[124:127]
    s_waitcnt lgkmcnt(1)
    v_mfma_f32_16x16x32_bf16 v[128:131], v[168:171], v[36:39], v[128:131]
    s_waitcnt lgkmcnt(0)
    v_mfma_f32_16x16x32_bf16 v[132:135], v[172:175], v[36:39], v[132:135]
    s_waitcnt lgkmcnt(0)
    v_mov_b32 v251, 161792
    v_mov_b32 v252, 1
    s_mov_b64 exec, 1
    ds_add_u32 v251, v252
    s_mov_b64 exec, -1
    s_mov_b32 s67, 0
gsync_30:
    ds_read_b32 v252, v251
    s_add_u32 s67, s67, 1
    s_waitcnt lgkmcnt(0)
    v_readfirstlane_b32 s66, v252
    s_cmp_gt_u32 s67, 1000000
    s_cbranch_scc1 gsync_e_31
    s_cmp_lt_u32 s66, 20
    s_cbranch_scc1 gsync_30
gsync_e_31:
    s_mul_i32 s40, s54, 20480
    s_add_u32 s40, s40, s46
    s_add_u32 s40, s40, 0
    s_mul_i32 s41, s34, 5120
    s_add_u32 m0, s41, 0
    s_nop 0
    buffer_load_dwordx4 v7, s[12:15], s40 offen sc1 lds
    s_mul_i32 s40, s54, 20480
    s_add_u32 s40, s40, s46
    s_add_u32 s40, s40, 1024
    s_mul_i32 s41, s34, 5120
    s_add_u32 m0, s41, 1024
    s_nop 0
    buffer_load_dwordx4 v7, s[12:15], s40 offen sc1 lds
    s_mul_i32 s40, s54, 20480
    s_add_u32 s40, s40, s46
    s_add_u32 s40, s40, 2048
    s_mul_i32 s41, s34, 5120
    s_add_u32 m0, s41, 2048
    s_nop 0
    buffer_load_dwordx4 v7, s[12:15], s40 offen sc1 lds
    s_mul_i32 s40, s54, 20480
    s_add_u32 s40, s40, s46
    s_add_u32 s40, s40, 3072
    s_mul_i32 s41, s34, 5120
    s_add_u32 m0, s41, 3072
    s_nop 0
    buffer_load_dwordx4 v7, s[12:15], s40 offen sc1 lds
    s_mul_i32 s40, s54, 20480
    s_add_u32 s40, s40, s46
    s_add_u32 s40, s40, 4096
    s_mul_i32 s41, s34, 5120
    s_add_u32 m0, s41, 4096
    s_nop 0
    buffer_load_dwordx4 v7, s[12:15], s40 offen sc1 lds
    s_mul_i32 s40, s55, 20480
    s_add_u32 s40, s40, s46
    s_add_u32 s40, s40, 0
    s_mul_i32 s41, s34, 5120
    s_add_u32 m0, s41, 20480
    s_nop 0
    buffer_load_dwordx4 v7, s[12:15], s40 offen sc1 lds
    s_mul_i32 s40, s55, 20480
    s_add_u32 s40, s40, s46
    s_add_u32 s40, s40, 1024
    s_mul_i32 s41, s34, 5120
    s_add_u32 m0, s41, 21504
    s_nop 0
    buffer_load_dwordx4 v7, s[12:15], s40 offen sc1 lds
    s_mul_i32 s40, s55, 20480
    s_add_u32 s40, s40, s46
    s_add_u32 s40, s40, 2048
    s_mul_i32 s41, s34, 5120
    s_add_u32 m0, s41, 22528
    s_nop 0
    buffer_load_dwordx4 v7, s[12:15], s40 offen sc1 lds
    s_mul_i32 s40, s55, 20480
    s_add_u32 s40, s40, s46
    s_add_u32 s40, s40, 3072
    s_mul_i32 s41, s34, 5120
    s_add_u32 m0, s41, 23552
    s_nop 0
    buffer_load_dwordx4 v7, s[12:15], s40 offen sc1 lds
    s_mul_i32 s40, s55, 20480
    s_add_u32 s40, s40, s46
    s_add_u32 s40, s40, 4096
    s_mul_i32 s41, s34, 5120
    s_add_u32 m0, s41, 24576
    s_nop 0
    buffer_load_dwordx4 v7, s[12:15], s40 offen sc1 lds
    ds_read_b128 v[136:139], v113 offset:40960
    ds_read_b128 v[140:143], v113 offset:41984
    ds_read_b128 v[144:147], v113 offset:43008
    ds_read_b128 v[148:151], v113 offset:44032
    ds_read_b128 v[152:155], v113 offset:45056
    ds_read_b128 v[156:159], v113 offset:46080
    ds_read_b128 v[160:163], v113 offset:47104
    ds_read_b128 v[164:167], v113 offset:48128
    ds_read_b128 v[168:171], v113 offset:49152
    ds_read_b128 v[172:175], v113 offset:50176
    s_waitcnt vmcnt(17)
    s_waitcnt lgkmcnt(9)
    v_mfma_f32_16x16x32_bf16 v[116:119], v[136:139], v[40:43], v[116:119]
    s_lshl_b32 s42, s54, 12
    s_add_u32 s42, s42, s47
    buffer_load_dwordx4 v[72:75], v7, s[12:15], s42 offen offset:0 sc1
    s_waitcnt lgkmcnt(8)
    v_mfma_f32_16x16x32_bf16 v[120:123], v[140:143], v[40:43], v[120:123]
    s_waitcnt lgkmcnt(7)
    v_mfma_f32_16x16x32_bf16 v[124:127], v[144:147], v[40:43], v[124:127]
    s_lshl_b32 s42, s54, 12
    s_add_u32 s42, s42, s47
    buffer_load_dwordx4 v[76:79], v7, s[12:15], s42 offen offset:1024 sc1
    s_waitcnt lgkmcnt(6)
    v_mfma_f32_16x16x32_bf16 v[128:131], v[148:151], v[40:43], v[128:131]
    s_waitcnt lgkmcnt(5)
    v_mfma_f32_16x16x32_bf16 v[132:135], v[152:155], v[40:43], v[132:135]
    s_lshl_b32 s42, s54, 12
    s_add_u32 s42, s42, s47
    buffer_load_dwordx4 v[80:83], v7, s[12:15], s42 offen offset:2048 sc1
    ds_read_b128 v[136:139], v113 offset:51200
    ds_read_b128 v[140:143], v113 offset:52224
    ds_read_b128 v[144:147], v113 offset:53248
    ds_read_b128 v[148:151], v113 offset:54272
    ds_read_b128 v[152:155], v113 offset:55296
    s_waitcnt vmcnt(19)
    s_waitcnt lgkmcnt(9)
    v_mfma_f32_16x16x32_bf16 v[116:119], v[156:159], v[44:47], v[116:119]
    s_lshl_b32 s42, s54, 12
    s_add_u32 s42, s42, s47
    buffer_load_dwordx4 v[84:87], v7, s[12:15], s42 offen offset:3072 sc1
    s_waitcnt lgkmcnt(8)
    v_mfma_f32_16x16x32_bf16 v[120:123], v[160:163], v[44:47], v[120:123]
    s_waitcnt lgkmcnt(7)
    v_mfma_f32_16x16x32_bf16 v[124:127], v[164:167], v[44:47], v[124:127]
    s_waitcnt lgkmcnt(6)
    v_mfma_f32_16x16x32_bf16 v[128:131], v[168:171], v[44:47], v[128:131]
    s_waitcnt lgkmcnt(5)
    v_mfma_f32_16x16x32_bf16 v[132:135], v[172:175], v[44:47], v[132:135]
    ds_read_b128 v[156:159], v113 offset:56320
    ds_read_b128 v[160:163], v113 offset:57344
    ds_read_b128 v[164:167], v113 offset:58368
    ds_read_b128 v[168:171], v113 offset:59392
    ds_read_b128 v[172:175], v113 offset:60416
    s_waitcnt vmcnt(19)
    s_waitcnt lgkmcnt(9)
    v_mfma_f32_16x16x32_bf16 v[116:119], v[136:139], v[48:51], v[116:119]
    s_waitcnt lgkmcnt(8)
    v_mfma_f32_16x16x32_bf16 v[120:123], v[140:143], v[48:51], v[120:123]
    s_waitcnt lgkmcnt(7)
    v_mfma_f32_16x16x32_bf16 v[124:127], v[144:147], v[48:51], v[124:127]
    s_waitcnt lgkmcnt(6)
    v_mfma_f32_16x16x32_bf16 v[128:131], v[148:151], v[48:51], v[128:131]
    s_waitcnt lgkmcnt(5)
    v_mfma_f32_16x16x32_bf16 v[132:135], v[152:155], v[48:51], v[132:135]
    s_waitcnt vmcnt(18)
    s_waitcnt lgkmcnt(4)
    v_mfma_f32_16x16x32_bf16 v[116:119], v[156:159], v[52:55], v[116:119]
    s_waitcnt lgkmcnt(3)
    v_mfma_f32_16x16x32_bf16 v[120:123], v[160:163], v[52:55], v[120:123]
    s_waitcnt lgkmcnt(2)
    v_mfma_f32_16x16x32_bf16 v[124:127], v[164:167], v[52:55], v[124:127]
    s_waitcnt lgkmcnt(1)
    v_mfma_f32_16x16x32_bf16 v[128:131], v[168:171], v[52:55], v[128:131]
    s_waitcnt lgkmcnt(0)
    v_mfma_f32_16x16x32_bf16 v[132:135], v[172:175], v[52:55], v[132:135]
    ds_read_b128 v[136:139], v114 offset:0
    ds_read_b128 v[140:143], v114 offset:1024
    ds_read_b128 v[144:147], v114 offset:2048
    ds_read_b128 v[148:151], v114 offset:3072
    ds_read_b128 v[152:155], v114 offset:4096
    ds_read_b128 v[156:159], v114 offset:5120
    ds_read_b128 v[160:163], v114 offset:6144
    ds_read_b128 v[164:167], v114 offset:7168
    ds_read_b128 v[168:171], v114 offset:8192
    ds_read_b128 v[172:175], v114 offset:9216
    s_waitcnt vmcnt(17)
    s_waitcnt lgkmcnt(9)
    v_mfma_f32_16x16x32_bf16 v[116:119], v[136:139], v[56:59], v[116:119]
    s_lshl_b32 s42, s55, 12
    s_add_u32 s42, s42, s47
    buffer_load_dwordx4 v[88:91], v7, s[12:15], s42 offen offset:0 sc1
    s_waitcnt lgkmcnt(8)
    v_mfma_f32_16x16x32_bf16 v[120:123], v[140:143], v[56:59], v[120:123]
    s_waitcnt lgkmcnt(7)
    v_mfma_f32_16x16x32_bf16 v[124:127], v[144:147], v[56:59], v[124:127]
    s_lshl_b32 s42, s55, 12
    s_add_u32 s42, s42, s47
    buffer_load_dwordx4 v[92:95], v7, s[12:15], s42 offen offset:1024 sc1
    s_waitcnt lgkmcnt(6)
    v_mfma_f32_16x16x32_bf16 v[128:131], v[148:151], v[56:59], v[128:131]
    s_waitcnt lgkmcnt(5)
    v_mfma_f32_16x16x32_bf16 v[132:135], v[152:155], v[56:59], v[132:135]
    s_lshl_b32 s42, s55, 12
    s_add_u32 s42, s42, s47
    buffer_load_dwordx4 v[96:99], v7, s[12:15], s42 offen offset:2048 sc1
    ds_read_b128 v[136:139], v114 offset:10240
    ds_read_b128 v[140:143], v114 offset:11264
    ds_read_b128 v[144:147], v114 offset:12288
    ds_read_b128 v[148:151], v114 offset:13312
    ds_read_b128 v[152:155], v114 offset:14336
    s_waitcnt vmcnt(19)
    s_waitcnt lgkmcnt(9)
    v_mfma_f32_16x16x32_bf16 v[116:119], v[156:159], v[60:63], v[116:119]
    s_lshl_b32 s42, s55, 12
    s_add_u32 s42, s42, s47
    buffer_load_dwordx4 v[100:103], v7, s[12:15], s42 offen offset:3072 sc1
    s_waitcnt lgkmcnt(8)
    v_mfma_f32_16x16x32_bf16 v[120:123], v[160:163], v[60:63], v[120:123]
    s_waitcnt lgkmcnt(7)
    v_mfma_f32_16x16x32_bf16 v[124:127], v[164:167], v[60:63], v[124:127]
    s_waitcnt lgkmcnt(6)
    v_mfma_f32_16x16x32_bf16 v[128:131], v[168:171], v[60:63], v[128:131]
    s_waitcnt lgkmcnt(5)
    v_mfma_f32_16x16x32_bf16 v[132:135], v[172:175], v[60:63], v[132:135]
    ds_read_b128 v[156:159], v114 offset:15360
    ds_read_b128 v[160:163], v114 offset:16384
    ds_read_b128 v[164:167], v114 offset:17408
    ds_read_b128 v[168:171], v114 offset:18432
    ds_read_b128 v[172:175], v114 offset:19456
    s_waitcnt vmcnt(19)
    s_waitcnt lgkmcnt(9)
    v_mfma_f32_16x16x32_bf16 v[116:119], v[136:139], v[64:67], v[116:119]
    s_waitcnt lgkmcnt(8)
    v_mfma_f32_16x16x32_bf16 v[120:123], v[140:143], v[64:67], v[120:123]
    s_waitcnt lgkmcnt(7)
    v_mfma_f32_16x16x32_bf16 v[124:127], v[144:147], v[64:67], v[124:127]
    s_waitcnt lgkmcnt(6)
    v_mfma_f32_16x16x32_bf16 v[128:131], v[148:151], v[64:67], v[128:131]
    s_waitcnt lgkmcnt(5)
    v_mfma_f32_16x16x32_bf16 v[132:135], v[152:155], v[64:67], v[132:135]
    s_waitcnt vmcnt(18)
    s_waitcnt lgkmcnt(4)
    v_mfma_f32_16x16x32_bf16 v[116:119], v[156:159], v[68:71], v[116:119]
    s_waitcnt lgkmcnt(3)
    v_mfma_f32_16x16x32_bf16 v[120:123], v[160:163], v[68:71], v[120:123]
    s_waitcnt lgkmcnt(2)
    v_mfma_f32_16x16x32_bf16 v[124:127], v[164:167], v[68:71], v[124:127]
    s_waitcnt lgkmcnt(1)
    v_mfma_f32_16x16x32_bf16 v[128:131], v[168:171], v[68:71], v[128:131]
    s_waitcnt lgkmcnt(0)
    v_mfma_f32_16x16x32_bf16 v[132:135], v[172:175], v[68:71], v[132:135]
    s_waitcnt vmcnt(8)
    s_waitcnt lgkmcnt(0)
    v_mov_b32 v251, 161792
    v_mov_b32 v252, 1
    s_mov_b64 exec, 1
    ds_add_u32 v251, v252
    s_mov_b64 exec, -1
    s_mov_b32 s67, 0
gsync_32:
    ds_read_b32 v252, v251
    s_add_u32 s67, s67, 1
    s_waitcnt lgkmcnt(0)
    v_readfirstlane_b32 s66, v252
    s_cmp_gt_u32 s67, 1000000
    s_cbranch_scc1 gsync_e_33
    s_cmp_lt_u32 s66, 24
    s_cbranch_scc1 gsync_32
gsync_e_33:
    s_cmp_ge_u32 s34, 2
    s_cbranch_scc1 k3_x2_34
    s_mul_i32 s40, s34, 40960
    s_add_u32 s40, s40, s45
    s_mul_i32 s41, s34, 5120
    s_add_u32 m0, s41, 40960
    s_nop 0
    buffer_load_dwordx4 v104, s[8:11], s40 offen lds
    s_add_u32 m0, s41, 41984
    s_nop 0
    buffer_load_dwordx4 v105, s[8:11], s40 offen lds
    s_add_u32 m0, s41, 43008
    s_nop 0
    buffer_load_dwordx4 v106, s[8:11], s40 offen lds
    s_add_u32 m0, s41, 44032
    s_nop 0
    buffer_load_dwordx4 v107, s[8:11], s40 offen lds
    s_add_u32 m0, s41, 45056
    s_nop 0
    buffer_load_dwordx4 v108, s[8:11], s40 offen lds
k3_x2_34:
    s_lshl_b32 s40, s32, 9
    s_lshl_b32 s41, s34, 7
    s_add_u32 s40, s40, s41
    s_add_u32 s40, s40, 14680064
    v_lshlrev_b32 v4, 3, v3
    buffer_load_dwordx2 v[110:111], v4, s[12:15], s40 offen sc1
    ds_read_b128 v[136:139], v113 offset:0
    ds_read_b128 v[140:143], v113 offset:1024
    ds_read_b128 v[144:147], v113 offset:2048
    ds_read_b128 v[148:151], v113 offset:3072
    ds_read_b128 v[152:155], v113 offset:4096
    ds_read_b128 v[156:159], v113 offset:5120
    ds_read_b128 v[160:163], v113 offset:6144
    ds_read_b128 v[164:167], v113 offset:7168
    ds_read_b128 v[168:171], v113 offset:8192
    ds_read_b128 v[172:175], v113 offset:9216
    s_waitcnt vmcnt(8)
    s_waitcnt lgkmcnt(9)
    v_mfma_f32_16x16x32_bf16 v[116:119], v[136:139], v[72:75], v[116:119]
    s_waitcnt lgkmcnt(8)
    v_mfma_f32_16x16x32_bf16 v[120:123], v[140:143], v[72:75], v[120:123]
    s_waitcnt lgkmcnt(7)
    v_mfma_f32_16x16x32_bf16 v[124:127], v[144:147], v[72:75], v[124:127]
    s_waitcnt lgkmcnt(6)
    v_mfma_f32_16x16x32_bf16 v[128:131], v[148:151], v[72:75], v[128:131]
    s_waitcnt lgkmcnt(5)
    v_mfma_f32_16x16x32_bf16 v[132:135], v[152:155], v[72:75], v[132:135]
    ds_read_b128 v[136:139], v113 offset:10240
    ds_read_b128 v[140:143], v113 offset:11264
    ds_read_b128 v[144:147], v113 offset:12288
    ds_read_b128 v[148:151], v113 offset:13312
    ds_read_b128 v[152:155], v113 offset:14336
    s_waitcnt vmcnt(7)
    s_waitcnt lgkmcnt(9)
    v_mfma_f32_16x16x32_bf16 v[116:119], v[156:159], v[76:79], v[116:119]
    s_waitcnt lgkmcnt(8)
    v_mfma_f32_16x16x32_bf16 v[120:123], v[160:163], v[76:79], v[120:123]
    s_waitcnt lgkmcnt(7)
    v_mfma_f32_16x16x32_bf16 v[124:127], v[164:167], v[76:79], v[124:127]
    s_waitcnt lgkmcnt(6)
    v_mfma_f32_16x16x32_bf16 v[128:131], v[168:171], v[76:79], v[128:131]
    s_waitcnt lgkmcnt(5)
    v_mfma_f32_16x16x32_bf16 v[132:135], v[172:175], v[76:79], v[132:135]
    ds_read_b128 v[156:159], v113 offset:15360
    ds_read_b128 v[160:163], v113 offset:16384
    ds_read_b128 v[164:167], v113 offset:17408
    ds_read_b128 v[168:171], v113 offset:18432
    ds_read_b128 v[172:175], v113 offset:19456
    s_waitcnt vmcnt(6)
    s_waitcnt lgkmcnt(9)
    v_mfma_f32_16x16x32_bf16 v[116:119], v[136:139], v[80:83], v[116:119]
    s_waitcnt lgkmcnt(8)
    v_mfma_f32_16x16x32_bf16 v[120:123], v[140:143], v[80:83], v[120:123]
    s_waitcnt lgkmcnt(7)
    v_mfma_f32_16x16x32_bf16 v[124:127], v[144:147], v[80:83], v[124:127]
    s_waitcnt lgkmcnt(6)
    v_mfma_f32_16x16x32_bf16 v[128:131], v[148:151], v[80:83], v[128:131]
    s_waitcnt lgkmcnt(5)
    v_mfma_f32_16x16x32_bf16 v[132:135], v[152:155], v[80:83], v[132:135]
    s_waitcnt vmcnt(5)
    s_waitcnt lgkmcnt(4)
    v_mfma_f32_16x16x32_bf16 v[116:119], v[156:159], v[84:87], v[116:119]
    s_waitcnt lgkmcnt(3)
    v_mfma_f32_16x16x32_bf16 v[120:123], v[160:163], v[84:87], v[120:123]
    s_waitcnt lgkmcnt(2)
    v_mfma_f32_16x16x32_bf16 v[124:127], v[164:167], v[84:87], v[124:127]
    s_waitcnt lgkmcnt(1)
    v_mfma_f32_16x16x32_bf16 v[128:131], v[168:171], v[84:87], v[128:131]
    s_waitcnt lgkmcnt(0)
    v_mfma_f32_16x16x32_bf16 v[132:135], v[172:175], v[84:87], v[132:135]
    ds_read_b128 v[136:139], v113 offset:20480
    ds_read_b128 v[140:143], v113 offset:21504
    ds_read_b128 v[144:147], v113 offset:22528
    ds_read_b128 v[148:151], v113 offset:23552
    ds_read_b128 v[152:155], v113 offset:24576
    ds_read_b128 v[156:159], v113 offset:25600
    ds_read_b128 v[160:163], v113 offset:26624
    ds_read_b128 v[164:167], v113 offset:27648
    ds_read_b128 v[168:171], v113 offset:28672
    ds_read_b128 v[172:175], v113 offset:29696
    s_waitcnt vmcnt(4)
    s_waitcnt lgkmcnt(9)
    v_mfma_f32_16x16x32_bf16 v[116:119], v[136:139], v[88:91], v[116:119]
    s_waitcnt lgkmcnt(8)
    v_mfma_f32_16x16x32_bf16 v[120:123], v[140:143], v[88:91], v[120:123]
    s_waitcnt lgkmcnt(7)
    v_mfma_f32_16x16x32_bf16 v[124:127], v[144:147], v[88:91], v[124:127]
    s_waitcnt lgkmcnt(6)
    v_mfma_f32_16x16x32_bf16 v[128:131], v[148:151], v[88:91], v[128:131]
    s_waitcnt lgkmcnt(5)
    v_mfma_f32_16x16x32_bf16 v[132:135], v[152:155], v[88:91], v[132:135]
    ds_read_b128 v[136:139], v113 offset:30720
    ds_read_b128 v[140:143], v113 offset:31744
    ds_read_b128 v[144:147], v113 offset:32768
    ds_read_b128 v[148:151], v113 offset:33792
    ds_read_b128 v[152:155], v113 offset:34816
    s_waitcnt vmcnt(3)
    s_waitcnt lgkmcnt(9)
    v_mfma_f32_16x16x32_bf16 v[116:119], v[156:159], v[92:95], v[116:119]
    s_waitcnt lgkmcnt(8)
    v_mfma_f32_16x16x32_bf16 v[120:123], v[160:163], v[92:95], v[120:123]
    s_waitcnt lgkmcnt(7)
    v_mfma_f32_16x16x32_bf16 v[124:127], v[164:167], v[92:95], v[124:127]
    s_waitcnt lgkmcnt(6)
    v_mfma_f32_16x16x32_bf16 v[128:131], v[168:171], v[92:95], v[128:131]
    s_waitcnt lgkmcnt(5)
    v_mfma_f32_16x16x32_bf16 v[132:135], v[172:175], v[92:95], v[132:135]
    ds_read_b128 v[156:159], v113 offset:35840
    ds_read_b128 v[160:163], v113 offset:36864
    ds_read_b128 v[164:167], v113 offset:37888
    ds_read_b128 v[168:171], v113 offset:38912
    ds_read_b128 v[172:175], v113 offset:39936
    s_waitcnt vmcnt(2)
    s_waitcnt lgkmcnt(9)
    v_mfma_f32_16x16x32_bf16 v[116:119], v[136:139], v[96:99], v[116:119]
    s_waitcnt lgkmcnt(8)
    v_mfma_f32_16x16x32_bf16 v[120:123], v[140:143], v[96:99], v[120:123]
    s_waitcnt lgkmcnt(7)
    v_mfma_f32_16x16x32_bf16 v[124:127], v[144:147], v[96:99], v[124:127]
    s_waitcnt lgkmcnt(6)
    v_mfma_f32_16x16x32_bf16 v[128:131], v[148:151], v[96:99], v[128:131]
    s_waitcnt lgkmcnt(5)
    v_mfma_f32_16x16x32_bf16 v[132:135], v[152:155], v[96:99], v[132:135]
    s_waitcnt vmcnt(1)
    s_waitcnt lgkmcnt(4)
    v_mfma_f32_16x16x32_bf16 v[116:119], v[156:159], v[100:103], v[116:119]
    s_waitcnt lgkmcnt(3)
    v_mfma_f32_16x16x32_bf16 v[120:123], v[160:163], v[100:103], v[120:123]
    s_waitcnt lgkmcnt(2)
    v_mfma_f32_16x16x32_bf16 v[124:127], v[164:167], v[100:103], v[124:127]
    s_waitcnt lgkmcnt(1)
    v_mfma_f32_16x16x32_bf16 v[128:131], v[168:171], v[100:103], v[128:131]
    s_waitcnt lgkmcnt(0)
    v_mfma_f32_16x16x32_bf16 v[132:135], v[172:175], v[100:103], v[132:135]
    v_mbcnt_lo_u32_b32 v4, -1, 0
    v_mbcnt_hi_u32_b32 v4, -1, v4
    v_lshlrev_b32 v4, 4, v4
    s_mov_b32 s66, 14721024
    s_mov_b32 s67, 0
fpoll_35:
    buffer_load_dwordx4 v[176:179], v4, s[12:15], s66 offen sc1
    buffer_load_dwordx4 v[180:183], v4, s[12:15], s66 offen offset:1024 sc1
    s_add_u32 s67, s67, 1
    s_waitcnt vmcnt(0)
    v_cmp_ne_u32 vcc, s100, v176
    v_cmp_ne_u32 s[64:65], s101, v177
    s_nop 0
    s_or_b64 vcc, vcc, s[64:65]
    v_cmp_ne_u32 s[64:65], s100, v178
    s_nop 0
    s_or_b64 vcc, vcc, s[64:65]
    v_cmp_ne_u32 s[64:65], s101, v179
    s_nop 0
    s_or_b64 vcc, vcc, s[64:65]
    v_cmp_ne_u32 s[64:65], s100, v180
    s_nop 0
    s_or_b64 vcc, vcc, s[64:65]
    v_cmp_ne_u32 s[64:65], s101, v181
    s_nop 0
    s_or_b64 vcc, vcc, s[64:65]
    v_cmp_ne_u32 s[64:65], s100, v182
    s_nop 0
    s_or_b64 vcc, vcc, s[64:65]
    v_cmp_ne_u32 s[64:65], s101, v183
    s_nop 0
    s_or_b64 vcc, vcc, s[64:65]
    s_cmp_gt_u32 s67, 100000
    s_cbranch_scc1 fpoll_e_36
    s_cmp_eq_u64 vcc, 0
    s_cbranch_scc1 fpoll_e_36
    s_sleep 2
    s_branch fpoll_35
fpoll_e_36:
    v_lshrrev_b32 v4, 3, v1
    v_lshlrev_b32 v4, 12, v4
    v_and_b32 v5, 7, v1
    v_lshl_add_u32 v112, v5, 4, v4
    s_add_u32 s42, s34, 0
    s_lshl_b32 s40, s42, 3
    s_mul_i32 s41, s33, 80
    s_add_u32 s40, s40, s41
    s_lshl_b32 s40, s40, 12
    s_lshl_b32 s41, s32, 7
    s_add_u32 s40, s40, s41
    s_add_u32 s40, s40, 8912896
    s_lshl_b32 s41, s42, 10
    s_add_u32 m0, s41, 51200
    s_cmp_lt_u32 s42, 10
    s_cselect_b64 exec, -1, 0
    buffer_load_dwordx4 v112, s[12:15], s40 offen sc1 lds
    s_mov_b64 exec, -1
    s_add_u32 s42, s34, 4
    s_lshl_b32 s40, s42, 3
    s_mul_i32 s41, s33, 80
    s_add_u32 s40, s40, s41
    s_lshl_b32 s40, s40, 12
    s_lshl_b32 s41, s32, 7
    s_add_u32 s40, s40, s41
    s_add_u32 s40, s40, 8912896
    s_lshl_b32 s41, s42, 10
    s_add_u32 m0, s41, 51200
    s_cmp_lt_u32 s42, 10
    s_cselect_b64 exec, -1, 0
    buffer_load_dwordx4 v112, s[12:15], s40 offen sc1 lds
    s_mov_b64 exec, -1
    s_add_u32 s42, s34, 8
    s_lshl_b32 s40, s42, 3
    s_mul_i32 s41, s33, 80
    s_add_u32 s40, s40, s41
    s_lshl_b32 s40, s40, 12
    s_lshl_b32 s41, s32, 7
    s_add_u32 s40, s40, s41
    s_add_u32 s40, s40, 8912896
    s_lshl_b32 s41, s42, 10
    s_add_u32 m0, s41, 51200
    s_cmp_lt_u32 s42, 10
    s_cselect_b64 exec, -1, 0
    buffer_load_dwordx4 v112, s[12:15], s40 offen sc1 lds
    s_mov_b64 exec, -1
    s_lshl_b32 s40, s34, 4
    v_add_u32 v4, s40, v3
    v_mul_u32_u24 v4, 160, v4
    v_lshl_add_u32 v184, v2, 3, v4
    v_add_u32 v185, 40960, v184
    v_lshrrev_b32 v5, 2, v3
    v_lshl_add_u32 v4, v2, 2, v5
    v_lshlrev_b32 v4, 7, v4
    v_and_b32 v5, 3, v3
    v_lshl_add_u32 v4, v5, 3, v4
    s_lshl_b32 s40, s34, 5
    s_add_u32 s40, s40, 51200
    v_add_u32 v186, s40, v4
    s_mov_b32 s46, 0xbfb8aa3b
    s_mov_b32 s47, 0xbfb8aa3b
    v_pk_mul_f32 v[8:9], v[116:117], s[46:47]
    v_pk_mul_f32 v[10:11], v[118:119], s[46:47]
    v_pk_mul_f32 v[12:13], v[120:121], s[46:47]
    v_pk_mul_f32 v[14:15], v[122:123], s[46:47]
    v_pk_mul_f32 v[16:17], v[124:125], s[46:47]
    v_pk_mul_f32 v[18:19], v[126:127], s[46:47]
    v_pk_mul_f32 v[20:21], v[128:129], s[46:47]
    v_pk_mul_f32 v[22:23], v[130:131], s[46:47]
    v_pk_mul_f32 v[24:25], v[132:133], s[46:47]
    v_pk_mul_f32 v[26:27], v[134:135], s[46:47]
    v_exp_f32 v8, v8
    v_exp_f32 v9, v9
    v_exp_f32 v10, v10
    v_exp_f32 v11, v11
    v_exp_f32 v12, v12
    v_exp_f32 v13, v13
    v_exp_f32 v14, v14
    v_exp_f32 v15, v15
    v_exp_f32 v16, v16
    v_exp_f32 v17, v17
    v_exp_f32 v18, v18
    v_exp_f32 v19, v19
    v_exp_f32 v20, v20
    v_exp_f32 v21, v21
    v_exp_f32 v22, v22
    v_exp_f32 v23, v23
    v_exp_f32 v24, v24
    v_exp_f32 v25, v25
    v_exp_f32 v26, v26
    v_exp_f32 v27, v27
    s_waitcnt vmcnt(0)
    s_waitcnt lgkmcnt(0)
    v_mov_b32 v251, 161792
    v_mov_b32 v252, 1
    s_mov_b64 exec, 1
    ds_add_u32 v251, v252
    s_mov_b64 exec, -1
    s_mov_b32 s67, 0
gsync_37:
    ds_read_b32 v252, v251
    s_add_u32 s67, s67, 1
    s_waitcnt lgkmcnt(0)
    v_readfirstlane_b32 s66, v252
    s_cmp_gt_u32 s67, 1000000
    s_cbranch_scc1 gsync_e_38
    s_cmp_lt_u32 s66, 28
    s_cbranch_scc1 gsync_37
gsync_e_38:
    ds_read_b64 v[136:137], v185 offset:0
    ds_read_b64 v[138:139], v185 offset:32
    ds_read_b64 v[140:141], v185 offset:64
    ds_read_b64 v[142:143], v185 offset:96
    ds_read_b64 v[144:145], v185 offset:128
    ds_read_b64_tr_b16 v[146:147], v186 offset:0
    ds_read_b64_tr_b16 v[148:149], v186 offset:2048
    ds_read_b64_tr_b16 v[150:151], v186 offset:4096
    ds_read_b64_tr_b16 v[152:153], v186 offset:6144
    ds_read_b64_tr_b16 v[154:155], v186 offset:8192
    v_pk_add_f32 v[8:9], v[8:9], 1.0 op_sel_hi:[1,0]
    v_pk_add_f32 v[10:11], v[10:11], 1.0 op_sel_hi:[1,0]
    v_pk_add_f32 v[12:13], v[12:13], 1.0 op_sel_hi:[1,0]
    v_pk_add_f32 v[14:15], v[14:15], 1.0 op_sel_hi:[1,0]
    v_pk_add_f32 v[16:17], v[16:17], 1.0 op_sel_hi:[1,0]
    v_pk_add_f32 v[18:19], v[18:19], 1.0 op_sel_hi:[1,0]
    v_pk_add_f32 v[20:21], v[20:21], 1.0 op_sel_hi:[1,0]
    v_pk_add_f32 v[22:23], v[22:23], 1.0 op_sel_hi:[1,0]
    v_pk_add_f32 v[24:25], v[24:25], 1.0 op_sel_hi:[1,0]
    v_pk_add_f32 v[26:27], v[26:27], 1.0 op_sel_hi:[1,0]
    v_rcp_f32 v8, v8
    v_rcp_f32 v9, v9
    v_rcp_f32 v10, v10
    v_rcp_f32 v11, v11
    v_rcp_f32 v12, v12
    v_rcp_f32 v13, v13
    v_rcp_f32 v14, v14
    v_rcp_f32 v15, v15
    v_rcp_f32 v16, v16
    v_rcp_f32 v17, v17
    v_rcp_f32 v18, v18
    v_rcp_f32 v19, v19
    v_rcp_f32 v20, v20
    v_rcp_f32 v21, v21
    v_rcp_f32 v22, v22
    v_rcp_f32 v23, v23
    v_rcp_f32 v24, v24
    v_rcp_f32 v25, v25
    v_rcp_f32 v26, v26
    v_rcp_f32 v27, v27
    v_pk_mul_f32 v[8:9], v[8:9], v[116:117]
    v_pk_mul_f32 v[10:11], v[10:11], v[118:119]
    v_pk_mul_f32 v[12:13], v[12:13], v[120:121]
    v_pk_mul_f32 v[14:15], v[14:15], v[122:123]
    v_pk_mul_f32 v[16:17], v[16:17], v[124:125]
    v_pk_mul_f32 v[18:19], v[18:19], v[126:127]
    v_pk_mul_f32 v[20:21], v[20:21], v[128:129]
    v_pk_mul_f32 v[22:23], v[22:23], v[130:131]
    v_pk_mul_f32 v[24:25], v[24:25], v[132:133]
    v_pk_mul_f32 v[26:27], v[26:27], v[134:135]
    s_waitcnt lgkmcnt(0)
    v_lshlrev_b32 v28, 16, v136
    v_and_b32 v29, 0xffff0000, v136
    v_lshlrev_b32 v48, 16, v146
    v_and_b32 v49, 0xffff0000, v146
    v_lshlrev_b32 v30, 16, v137
    v_and_b32 v31, 0xffff0000, v137
    v_lshlrev_b32 v50, 16, v147
    v_and_b32 v51, 0xffff0000, v147
    v_lshlrev_b32 v32, 16, v138
    v_and_b32 v33, 0xffff0000, v138
    v_lshlrev_b32 v52, 16, v148
    v_and_b32 v53, 0xffff0000, v148
    v_lshlrev_b32 v34, 16, v139
    v_and_b32 v35, 0xffff0000, v139
    v_lshlrev_b32 v54, 16, v149
    v_and_b32 v55, 0xffff0000, v149
    v_lshlrev_b32 v36, 16, v140
    v_and_b32 v37, 0xffff0000, v140
    v_lshlrev_b32 v56, 16, v150
    v_and_b32 v57, 0xffff0000, v150
    v_lshlrev_b32 v38, 16, v141
    v_and_b32 v39, 0xffff0000, v141
    v_lshlrev_b32 v58, 16, v151
    v_and_b32 v59, 0xffff0000, v151
    v_lshlrev_b32 v40, 16, v142
    v_and_b32 v41, 0xffff0000, v142
    v_lshlrev_b32 v60, 16, v152
    v_and_b32 v61, 0xffff0000, v152
    v_lshlrev_b32 v42, 16, v143
    v_and_b32 v43, 0xffff0000, v143
    v_lshlrev_b32 v62, 16, v153
    v_and_b32 v63, 0xffff0000, v153
    v_lshlrev_b32 v44, 16, v144
    v_and_b32 v45, 0xffff0000, v144
    v_lshlrev_b32 v64, 16, v154
    v_and_b32 v65, 0xffff0000, v154
    v_lshlrev_b32 v46, 16, v145
    v_and_b32 v47, 0xffff0000, v145
    v_lshlrev_b32 v66, 16, v155
    v_and_b32 v67, 0xffff0000, v155
    v_mov_b32 v188, v111
    v_pk_add_f32 v[68:69], v[28:29], v[110:111] op_sel_hi:[1,0] neg_lo:[0,1] neg_hi:[0,1]
    v_pk_add_f32 v[70:71], v[30:31], v[110:111] op_sel_hi:[1,0] neg_lo:[0,1] neg_hi:[0,1]
    v_pk_add_f32 v[72:73], v[32:33], v[110:111] op_sel_hi:[1,0] neg_lo:[0,1] neg_hi:[0,1]
    v_pk_add_f32 v[74:75], v[34:35], v[110:111] op_sel_hi:[1,0] neg_lo:[0,1] neg_hi:[0,1]
    v_pk_add_f32 v[76:77], v[36:37], v[110:111] op_sel_hi:[1,0] neg_lo:[0,1] neg_hi:[0,1]
    v_pk_add_f32 v[78:79], v[38:39], v[110:111] op_sel_hi:[1,0] neg_lo:[0,1] neg_hi:[0,1]
    v_pk_add_f32 v[80:81], v[40:41], v[110:111] op_sel_hi:[1,0] neg_lo:[0,1] neg_hi:[0,1]
    v_pk_add_f32 v[82:83], v[42:43], v[110:111] op_sel_hi:[1,0] neg_lo:[0,1] neg_hi:[0,1]
    v_pk_add_f32 v[84:85], v[44:45], v[110:111] op_sel_hi:[1,0] neg_lo:[0,1] neg_hi:[0,1]
    v_pk_add_f32 v[86:87], v[46:47], v[110:111] op_sel_hi:[1,0] neg_lo:[0,1] neg_hi:[0,1]
    v_pk_mul_f32 v[68:69], v[68:69], v[188:189] op_sel_hi:[1,0]
    v_pk_mul_f32 v[70:71], v[70:71], v[188:189] op_sel_hi:[1,0]
    v_pk_mul_f32 v[72:73], v[72:73], v[188:189] op_sel_hi:[1,0]
    v_pk_mul_f32 v[74:75], v[74:75], v[188:189] op_sel_hi:[1,0]
    v_pk_mul_f32 v[76:77], v[76:77], v[188:189] op_sel_hi:[1,0]
    v_pk_mul_f32 v[78:79], v[78:79], v[188:189] op_sel_hi:[1,0]
    v_pk_mul_f32 v[80:81], v[80:81], v[188:189] op_sel_hi:[1,0]
    v_pk_mul_f32 v[82:83], v[82:83], v[188:189] op_sel_hi:[1,0]
    v_pk_mul_f32 v[84:85], v[84:85], v[188:189] op_sel_hi:[1,0]
    v_pk_mul_f32 v[86:87], v[86:87], v[188:189] op_sel_hi:[1,0]
    v_pk_mul_f32 v[68:69], v[68:69], v[48:49]
    v_pk_mul_f32 v[70:71], v[70:71], v[50:51]
    v_pk_mul_f32 v[72:73], v[72:73], v[52:53]
    v_pk_mul_f32 v[74:75], v[74:75], v[54:55]
    v_pk_mul_f32 v[76:77], v[76:77], v[56:57]
    v_pk_mul_f32 v[78:79], v[78:79], v[58:59]
    v_pk_mul_f32 v[80:81], v[80:81], v[60:61]
    v_pk_mul_f32 v[82:83], v[82:83], v[62:63]
    v_pk_mul_f32 v[84:85], v[84:85], v[64:65]
    v_pk_mul_f32 v[86:87], v[86:87], v[66:67]
    v_pk_fma_f32 v[68:69], v[68:69], v[8:9], v[28:29]
    v_pk_fma_f32 v[70:71], v[70:71], v[10:11], v[30:31]
    v_pk_fma_f32 v[72:73], v[72:73], v[12:13], v[32:33]
    v_pk_fma_f32 v[74:75], v[74:75], v[14:15], v[34:35]
    v_pk_fma_f32 v[76:77], v[76:77], v[16:17], v[36:37]
    v_pk_fma_f32 v[78:79], v[78:79], v[18:19], v[38:39]
    v_pk_fma_f32 v[80:81], v[80:81], v[20:21], v[40:41]
    v_pk_fma_f32 v[82:83], v[82:83], v[22:23], v[42:43]
    v_pk_fma_f32 v[84:85], v[84:85], v[24:25], v[44:45]
    v_pk_fma_f32 v[86:87], v[86:87], v[26:27], v[46:47]
    v_cvt_pk_bf16_f32 v136, v68, v69
    v_cvt_pk_bf16_f32 v137, v70, v71
    v_cvt_pk_bf16_f32 v138, v72, v73
    v_cvt_pk_bf16_f32 v139, v74, v75
    v_cvt_pk_bf16_f32 v140, v76, v77
    v_cvt_pk_bf16_f32 v141, v78, v79
    v_cvt_pk_bf16_f32 v142, v80, v81
    v_cvt_pk_bf16_f32 v143, v82, v83
    v_cvt_pk_bf16_f32 v144, v84, v85
    v_cvt_pk_bf16_f32 v145, v86, v87
    v_add_u32 v190, 61440, v184
    ds_write_b64 v190, v[136:137] offset:0
    ds_write_b64 v190, v[138:139] offset:32
    ds_write_b64 v190, v[140:141] offset:64
    ds_write_b64 v190, v[142:143] offset:96
    ds_write_b64 v190, v[144:145] offset:128
    s_mul_i32 s40, s34, 2560
    s_add_u32 s40, s40, 61440
    v_add_u32 v4, s40, v7
    s_waitcnt lgkmcnt(0)
    ds_read_b128 v[8:11], v4 offset:0
    ds_read_b128 v[12:15], v4 offset:1024
    ds_read_b128 v[16:19], v4 offset:2048
    s_mul_i32 s40, s34, 20480
    s_add_u32 s40, s40, s45
    s_waitcnt lgkmcnt(0)
    buffer_store_dwordx4 v[8:11], v104, s[16:19], s40 offen
    buffer_store_dwordx4 v[12:15], v105, s[16:19], s40 offen
    s_mov_b32 exec_hi, 0
    buffer_store_dwordx4 v[16:19], v106, s[16:19], s40 offen
    s_mov_b64 exec, -1
    s_endpgm
recurrent_scan__ssm_conv_h3__mixer_gmlp__prompt_kernel_conv:
    s_load_dwordx2 s[4:5], s[0:1], 32
    s_load_dwordx2 s[8:9], s[0:1], 104
    s_load_dwordx2 s[12:13], s[0:1], 40
    s_load_dwordx2 s[16:17], s[0:1], 64
    s_load_dwordx2 s[20:21], s[0:1], 80
    v_subrev_u32 v0, 256, v0
    s_setprio 0
    v_lshrrev_b32 v3, 6, v0
    v_and_b32 v1, 63, v0
    v_readfirstlane_b32 s34, v3
    s_mov_b32 s6, 2621440
    s_mov_b32 s7, 0x20000
    s_mov_b32 s10, 15990784
    s_mov_b32 s11, 0x20000
    s_mov_b32 s14, 1280
    s_mov_b32 s15, 0x20000
    s_mov_b32 s18, 8388608
    s_mov_b32 s19, 0x20000
    s_mov_b32 s22, 983040
    s_mov_b32 s23, 0x20000
    s_mov_b32 s32, s2
    v_lshlrev_b32 v2, 4, v0
    v_subrev_u32 v47, 16, v2
    s_mov_b32 s56, s2
    s_add_u32 s57, s2, 256
    s_lshr_b32 s58, s2, 1
    s_add_u32 s58, s58, 512
    s_waitcnt lgkmcnt(0)
    s_lshl_b32 s40, s56, 12
    buffer_load_dwordx4 v[12:15], v2, s[4:7], s40 offen
    buffer_load_dwordx4 v[8:11], v47, s[4:7], s40 offen
    s_lshl_b32 s41, s56, 1
    v_mov_b32 v3, 0
    buffer_load_ushort v44, v3, s[12:15], s41 offen
    s_lshr_b32 s47, s2, 3
    s_lshl_b32 s47, s47, 2
    s_add_u32 s47, s47, s34
    s_mul_i32 s40, s47, 12
    v_add_u32 v3, s40, v1
    v_mul_u32_u24 v4, 43691, v3
    v_lshrrev_b32 v4, 22, v4
    v_mul_u32_u24 v5, 96, v4
    v_sub_u32 v3, v3, v5
    v_mul_u32_u24 v4, 98304, v4
    v_lshl_add_u32 v57, v3, 7, v4
    s_and_b32 s40, s2, 7
    s_lshr_b32 s52, s40, 1
    s_lshl_b32 s52, s52, 21
    s_and_b32 s53, s40, 1
    s_mul_i32 s53, s53, 1572864
    s_add_u32 s53, s53, 0
    s_lshl_b32 s40, s47, 4
    v_add_u32 v3, s40, v1
    v_lshrrev_b32 v4, 2, v3
    v_lshlrev_b32 v4, 12, v4
    v_and_b32 v3, 3, v3
    v_lshl_add_u32 v56, v3, 10, v4
    s_cmp_ge_u32 s2, 192
    s_cbranch_scc1 c_wj_39
    s_mul_i32 s40, s2, 2731
    s_lshr_b32 s40, s40, 16
    s_mul_i32 s41, s40, 24
    s_sub_u32 s41, s2, s41
    s_mul_i32 s41, s41, 40960
    s_mul_i32 s40, s40, 160
    s_add_u32 s54, s40, s41
    v_mov_b32 v3, v0
    v_mul_u32_u24 v4, 6554, v3
    v_lshrrev_b32 v4, 16, v4
    v_mul_u32_u24 v5, 10, v4
    v_sub_u32 v3, v3, v5
    v_lshlrev_b32 v3, 4, v3
    v_mul_u32_u24 v4, 1280, v4
    v_add_u32 v3, v3, v4
    s_lshl_b32 s40, s34, 10
    s_add_u32 m0, s40, 156672
    s_nop 0
    buffer_load_dwordx4 v3, s[20:23], s54 offen lds
    s_cmp_lg_u32 s34, 0
    s_cbranch_scc1 c_wj2_40
    v_add_u32 v3, 256, v1
    v_mul_u32_u24 v4, 6554, v3
    v_lshrrev_b32 v4, 16, v4
    v_mul_u32_u24 v5, 10, v4
    v_sub_u32 v3, v3, v5
    v_lshlrev_b32 v3, 4, v3
    v_mul_u32_u24 v4, 1280, v4
    v_add_u32 v3, v3, v4
    s_mov_b32 m0, 160768
    s_nop 0
    buffer_load_dwordx4 v3, s[20:23], s54 offen lds
c_wj2_40:
c_wj_39:
    s_lshl_b32 s40, s57, 12
    buffer_load_dwordx4 v[20:23], v2, s[4:7], s40 offen
    buffer_load_dwordx4 v[16:19], v47, s[4:7], s40 offen
    s_lshl_b32 s41, s57, 1
    v_mov_b32 v3, 0
    buffer_load_ushort v45, v3, s[12:15], s41 offen
    s_lshl_b32 s40, s58, 12
    buffer_load_dwordx4 v[28:31], v2, s[4:7], s40 offen
    buffer_load_dwordx4 v[24:27], v47, s[4:7], s40 offen
    s_lshl_b32 s41, s58, 1
    v_mov_b32 v3, 0
    buffer_load_ushort v46, v3, s[12:15], s41 offen
    v_mov_b32 v60, 0
    v_mov_b32 v61, 0
    v_mov_b32 v62, 0
    v_mov_b32 v63, 0
    v_mul_u32_u24 v3, 4160, v0
    v_add_u32 v3, 86016, v3
    v_cmp_gt_u32 vcc, 64, v0
    s_nop 0
    s_and_saveexec_b64 s[50:51], vcc
    s_cbranch_execz c_z_41
    v_subrev_u32 v4, -118784, v2
    v_cmp_gt_u32 vcc, 8, v0
    s_nop 1
    v_cndmask_b32 v4, v4, v3, vcc
    v_add_u32 v5, -8, v0
    v_cmp_lt_u32 vcc, 23, v5
    s_nop 0
    s_and_b64 exec, exec, vcc
    ds_write_b128 v4, v[60:63]
c_z_41:
    s_mov_b64 exec, s[50:51]
    v_add_u32 v64, 86032, v2
    v_add_u32 v65, 119808, v2
    v_and_b32 v3, 7, v1
    v_mul_u32_u24 v3, 4160, v3
    v_bfe_u32 v4, v1, 3, 1
    v_lshrrev_b32 v5, 4, v1
    v_sub_u32 v4, v4, v5
    v_add_u32 v4, 3, v4
    v_lshl_add_u32 v66, v4, 4, v3
    v_add_u32 v66, 86016, v66
    v_and_b32 v3, 15, v1
    v_lshl_add_u32 v3, v3, 1, v5
    v_lshlrev_b32 v67, 4, v3
    v_add_u32 v67, 119296, v67
    v_and_b32 v3, 15, v1
    v_lshlrev_b32 v4, 3, v5
    v_sub_u32 v4, v4, v3
    v_add_u32 v4, -9, v4
    v_mov_b32 v72, 0xffff
    v_mov_b32 v73, 0xffff0000
    v_cmp_eq_u32 vcc, 0, v4
    s_nop 1
    v_cndmask_b32 v68, 0, v72, vcc
    v_cmp_eq_u32 vcc, 1, v4
    s_nop 1
    v_cndmask_b32 v68, v68, v73, vcc
    v_cmp_eq_u32 vcc, 2, v4
    s_nop 1
    v_cndmask_b32 v69, 0, v72, vcc
    v_cmp_eq_u32 vcc, 3, v4
    s_nop 1
    v_cndmask_b32 v69, v69, v73, vcc
    v_cmp_eq_u32 vcc, 4, v4
    s_nop 1
    v_cndmask_b32 v70, 0, v72, vcc
    v_cmp_eq_u32 vcc, 5, v4
    s_nop 1
    v_cndmask_b32 v70, v70, v73, vcc
    v_cmp_eq_u32 vcc, 6, v4
    s_nop 1
    v_cndmask_b32 v71, 0, v72, vcc
    v_cmp_eq_u32 vcc, 7, v4
    s_nop 1
    v_cndmask_b32 v71, v71, v73, vcc
    v_and_b32 v3, 15, v1
    v_lshlrev_b32 v3, 6, v3
    v_lshl_add_u32 v3, v5, 4, v3
    s_lshl_b32 s40, s34, 13
    s_add_u32 s40, s40, 123904
    v_add_u32 v74, s40, v3
    v_lshlrev_b32 v75, 5, v0
    v_add_u32 v75, 123904, v75
    s_waitcnt vmcnt(6)
    v_cmp_ne_u32 vcc, 0, v0
    s_nop 1
    v_cndmask_b32 v8, 0, v8, vcc
    v_cndmask_b32 v9, 0, v9, vcc
    v_cndmask_b32 v10, 0, v10, vcc
    v_cndmask_b32 v11, 0, v11, vcc
    v_alignbit_b32 v184, v9, v8, 16
    v_alignbit_b32 v185, v10, v9, 16
    v_alignbit_b32 v186, v11, v10, 16
    v_alignbit_b32 v187, v12, v11, 16
    v_alignbit_b32 v188, v13, v12, 16
    v_alignbit_b32 v189, v14, v13, 16
    v_alignbit_b32 v190, v15, v14, 16
    ds_write_b128 v64, v[184:187] offset:0
    v_mov_b32 v192, v9
    v_mov_b32 v193, v10
    v_mov_b32 v194, v11
    v_mov_b32 v195, v12
    ds_write_b128 v64, v[192:195] offset:4160
    s_nop 1
    v_mov_b32 v192, v185
    v_mov_b32 v193, v186
    v_mov_b32 v194, v187
    v_mov_b32 v195, v188
    ds_write_b128 v64, v[192:195] offset:8320
    s_nop 1
    ds_write_b128 v64, v[10:13] offset:12480
    ds_write_b128 v64, v[186:189] offset:16640
    v_mov_b32 v192, v11
    v_mov_b32 v193, v12
    v_mov_b32 v194, v13
    v_mov_b32 v195, v14
    ds_write_b128 v64, v[192:195] offset:20800
    s_nop 1
    v_mov_b32 v192, v187
    v_mov_b32 v193, v188
    v_mov_b32 v194, v189
    v_mov_b32 v195, v190
    ds_write_b128 v64, v[192:195] offset:24960
    s_nop 1
    ds_write_b128 v64, v[12:15] offset:29120
    v_mbcnt_lo_u32_b32 v3, -1, 0
    v_mbcnt_hi_u32_b32 v3, -1, v3
    v_lshlrev_b32 v3, 4, v3
    s_mov_b32 s66, 14716928
    s_mov_b32 s67, 0
fpoll_42:
    buffer_load_dwordx4 v[48:51], v3, s[8:11], s66 offen sc1
    buffer_load_dwordx4 v[52:55], v3, s[8:11], s66 offen offset:1024 sc1
    s_add_u32 s67, s67, 1
    s_waitcnt vmcnt(0)
    v_cmp_ne_u32 vcc, s100, v48
    v_cmp_ne_u32 s[64:65], s101, v49
    s_nop 0
    s_or_b64 vcc, vcc, s[64:65]
    v_cmp_ne_u32 s[64:65], s100, v50
    s_nop 0
    s_or_b64 vcc, vcc, s[64:65]
    v_cmp_ne_u32 s[64:65], s101, v51
    s_nop 0
    s_or_b64 vcc, vcc, s[64:65]
    v_cmp_ne_u32 s[64:65], s100, v52
    s_nop 0
    s_or_b64 vcc, vcc, s[64:65]
    v_cmp_ne_u32 s[64:65], s101, v53
    s_nop 0
    s_or_b64 vcc, vcc, s[64:65]
    v_cmp_ne_u32 s[64:65], s100, v54
    s_nop 0
    s_or_b64 vcc, vcc, s[64:65]
    v_cmp_ne_u32 s[64:65], s101, v55
    s_nop 0
    s_or_b64 vcc, vcc, s[64:65]
    s_cmp_gt_u32 s67, 100000
    s_cbranch_scc1 fpoll_e_43
    s_cmp_eq_u64 vcc, 0
    s_cbranch_scc1 fpoll_e_43
    s_sleep 2
    s_branch fpoll_42
fpoll_e_43:
    s_lshl_b32 s40, s56, 12
    s_add_u32 s40, s40, 6291456
    buffer_load_dwordx4 v[32:35], v2, s[8:11], s40 offen sc1
    s_lshl_b32 s40, s57, 12
    s_add_u32 s40, s40, 6291456
    buffer_load_dwordx4 v[36:39], v2, s[8:11], s40 offen sc1
    s_lshl_b32 s40, s58, 12
    s_add_u32 s40, s40, 6291456
    buffer_load_dwordx4 v[40:43], v2, s[8:11], s40 offen sc1
    s_waitcnt vmcnt(2)
    ds_write_b128 v65, v[32:35]
    v_lshlrev_b32 v3, 16, v44
    v_or_b32 v3, v3, v44
    v_and_b32 v196, v68, v3
    v_and_b32 v197, v69, v3
    v_and_b32 v198, v70, v3
    v_and_b32 v199, v71, v3
    s_waitcnt lgkmcnt(0)
    v_mov_b32 v3, 161796
    v_mov_b32 v4, 1
    s_mov_b64 exec, 1
    ds_add_u32 v3, v4
    s_mov_b64 exec, -1
    s_mov_b32 s67, 0
gsync_44:
    ds_read_b32 v4, v3
    s_add_u32 s67, s67, 1
    s_waitcnt lgkmcnt(0)
    v_readfirstlane_b32 s66, v4
    s_cmp_gt_u32 s67, 1000000
    s_cbranch_scc1 gsync_e_45
    s_cmp_lt_u32 s66, 4
    s_cbranch_scc1 gsync_44
gsync_e_45:
    s_cmp_lg_u32 s34, 0
    s_cbranch_scc1 c_pw_47
    ds_read_b128 v[108:111], v66 offset:0
    ds_read_b128 v[120:123], v67 offset:480
    ds_read_b128 v[124:127], v67 offset:992
    ds_read_b128 v[128:131], v67 offset:1504
    ds_read_b128 v[132:135], v67 offset:2016
    ds_read_b128 v[136:139], v67 offset:2528
    ds_read_b128 v[140:143], v67 offset:3040
    ds_read_b128 v[144:147], v67 offset:3552
    ds_read_b128 v[148:151], v67 offset:4064
    ds_read_b128 v[112:115], v66 offset:512
    ds_read_b128 v[116:119], v66 offset:1024
    s_waitcnt lgkmcnt(2)
    v_mfma_f32_16x16x32_bf16 v[104:107], v[108:111], v[148:151], 0
    v_mfma_f32_16x16x32_bf16 v[100:103], v[108:111], v[144:147], 0
    v_mfma_f32_16x16x32_bf16 v[96:99], v[108:111], v[140:143], 0
    v_mfma_f32_16x16x32_bf16 v[92:95], v[108:111], v[136:139], 0
    v_mfma_f32_16x16x32_bf16 v[88:91], v[108:111], v[132:135], 0
    v_mfma_f32_16x16x32_bf16 v[84:87], v[108:111], v[128:131], 0
    v_mfma_f32_16x16x32_bf16 v[80:83], v[108:111], v[124:127], 0
    v_mfma_f32_16x16x32_bf16 v[76:79], v[108:111], v[120:123], 0
    v_mfma_f32_16x16x32_bf16 v[76:79], v[196:199], v[120:123], v[76:79]
    v_mfma_f32_16x16x32_bf16 v[80:83], v[196:199], v[124:127], v[80:83]
    v_mfma_f32_16x16x32_bf16 v[84:87], v[196:199], v[128:131], v[84:87]
    v_mfma_f32_16x16x32_bf16 v[88:91], v[196:199], v[132:135], v[88:91]
    v_mfma_f32_16x16x32_bf16 v[92:95], v[196:199], v[136:139], v[92:95]
    v_mfma_f32_16x16x32_bf16 v[96:99], v[196:199], v[140:143], v[96:99]
    v_mfma_f32_16x16x32_bf16 v[100:103], v[196:199], v[144:147], v[100:103]
    v_mfma_f32_16x16x32_bf16 v[104:107], v[196:199], v[148:151], v[104:107]
    ds_read_b128 v[108:111], v66 offset:1536
    s_waitcnt lgkmcnt(2)
    v_mfma_f32_16x16x32_bf16 v[104:107], v[112:115], v[144:147], v[104:107]
    v_mfma_f32_16x16x32_bf16 v[100:103], v[112:115], v[140:143], v[100:103]
    v_mfma_f32_16x16x32_bf16 v[96:99], v[112:115], v[136:139], v[96:99]
    v_mfma_f32_16x16x32_bf16 v[92:95], v[112:115], v[132:135], v[92:95]
    v_mfma_f32_16x16x32_bf16 v[88:91], v[112:115], v[128:131], v[88:91]
    v_mfma_f32_16x16x32_bf16 v[84:87], v[112:115], v[124:127], v[84:87]
    v_mfma_f32_16x16x32_bf16 v[80:83], v[112:115], v[120:123], v[80:83]
    ds_read_b128 v[112:115], v66 offset:2048
    ds_read_b128 v[152:155], v67 offset:416
    ds_read_b128 v[156:159], v67 offset:928
    ds_read_b128 v[160:163], v67 offset:1440
    ds_read_b128 v[164:167], v67 offset:1952
    ds_read_b128 v[168:171], v67 offset:2464
    ds_read_b128 v[172:175], v67 offset:2976
    ds_read_b128 v[176:179], v67 offset:3488
    ds_read_b128 v[180:183], v67 offset:4000
    s_waitcnt lgkmcnt(10)
    v_mfma_f32_16x16x32_bf16 v[104:107], v[116:119], v[140:143], v[104:107]
    v_mfma_f32_16x16x32_bf16 v[100:103], v[116:119], v[136:139], v[100:103]
    v_mfma_f32_16x16x32_bf16 v[96:99], v[116:119], v[132:135], v[96:99]
    v_mfma_f32_16x16x32_bf16 v[92:95], v[116:119], v[128:131], v[92:95]
    v_mfma_f32_16x16x32_bf16 v[88:91], v[116:119], v[124:127], v[88:91]
    v_mfma_f32_16x16x32_bf16 v[84:87], v[116:119], v[120:123], v[84:87]
    ds_read_b128 v[116:119], v66 offset:2560
    s_waitcnt lgkmcnt(10)
    v_mfma_f32_16x16x32_bf16 v[104:107], v[108:111], v[136:139], v[104:107]
    v_mfma_f32_16x16x32_bf16 v[100:103], v[108:111], v[132:135], v[100:103]
    v_mfma_f32_16x16x32_bf16 v[96:99], v[108:111], v[128:131], v[96:99]
    v_mfma_f32_16x16x32_bf16 v[92:95], v[108:111], v[124:127], v[92:95]
    v_mfma_f32_16x16x32_bf16 v[88:91], v[108:111], v[120:123], v[88:91]
    ds_read_b128 v[108:111], v66 offset:3072
    s_waitcnt lgkmcnt(10)
    v_mfma_f32_16x16x32_bf16 v[104:107], v[112:115], v[132:135], v[104:107]
    v_mfma_f32_16x16x32_bf16 v[100:103], v[112:115], v[128:131], v[100:103]
    v_mfma_f32_16x16x32_bf16 v[96:99], v[112:115], v[124:127], v[96:99]
    v_mfma_f32_16x16x32_bf16 v[92:95], v[112:115], v[120:123], v[92:95]
    ds_read_b128 v[112:115], v66 offset:3584
    s_waitcnt lgkmcnt(2)
    v_mfma_f32_16x16x32_bf16 v[104:107], v[116:119], v[128:131], v[104:107]
    v_mfma_f32_16x16x32_bf16 v[100:103], v[116:119], v[124:127], v[100:103]
    v_mfma_f32_16x16x32_bf16 v[96:99], v[116:119], v[120:123], v[96:99]
    ds_read_b128 v[116:119], v66 offset:64
    s_waitcnt lgkmcnt(2)
    v_mfma_f32_16x16x32_bf16 v[104:107], v[108:111], v[124:127], v[104:107]
    v_mfma_f32_16x16x32_bf16 v[100:103], v[108:111], v[120:123], v[100:103]
    ds_read_b128 v[108:111], v66 offset:576
    s_waitcnt lgkmcnt(2)
    v_mfma_f32_16x16x32_bf16 v[104:107], v[112:115], v[120:123], v[104:107]
    ds_read_b128 v[112:115], v66 offset:1088
    s_waitcnt lgkmcnt(2)
    v_mfma_f32_16x16x32_bf16 v[104:107], v[116:119], v[180:183], v[104:107]
    v_mfma_f32_16x16x32_bf16 v[100:103], v[116:119], v[176:179], v[100:103]
    v_mfma_f32_16x16x32_bf16 v[96:99], v[116:119], v[172:175], v[96:99]
    v_mfma_f32_16x16x32_bf16 v[92:95], v[116:119], v[168:171], v[92:95]
    v_mfma_f32_16x16x32_bf16 v[88:91], v[116:119], v[164:167], v[88:91]
    v_mfma_f32_16x16x32_bf16 v[84:87], v[116:119], v[160:163], v[84:87]
    v_mfma_f32_16x16x32_bf16 v[80:83], v[116:119], v[156:159], v[80:83]
    v_mfma_f32_16x16x32_bf16 v[76:79], v[116:119], v[152:155], v[76:79]
    ds_read_b128 v[116:119], v66 offset:1600
    s_waitcnt lgkmcnt(2)
    v_mfma_f32_16x16x32_bf16 v[104:107], v[108:111], v[176:179], v[104:107]
    v_mfma_f32_16x16x32_bf16 v[100:103], v[108:111], v[172:175], v[100:103]
    v_mfma_f32_16x16x32_bf16 v[96:99], v[108:111], v[168:171], v[96:99]
    v_mfma_f32_16x16x32_bf16 v[92:95], v[108:111], v[164:167], v[92:95]
    v_mfma_f32_16x16x32_bf16 v[88:91], v[108:111], v[160:163], v[88:91]
    v_mfma_f32_16x16x32_bf16 v[84:87], v[108:111], v[156:159], v[84:87]
    v_mfma_f32_16x16x32_bf16 v[80:83], v[108:111], v[152:155], v[80:83]
    ds_read_b128 v[108:111], v66 offset:2112
    s_waitcnt lgkmcnt(2)
    v_mfma_f32_16x16x32_bf16 v[104:107], v[112:115], v[172:175], v[104:107]
    v_mfma_f32_16x16x32_bf16 v[100:103], v[112:115], v[168:171], v[100:103]
    v_mfma_f32_16x16x32_bf16 v[96:99], v[112:115], v[164:167], v[96:99]
    v_mfma_f32_16x16x32_bf16 v[92:95], v[112:115], v[160:163], v[92:95]
    v_mfma_f32_16x16x32_bf16 v[88:91], v[112:115], v[156:159], v[88:91]
    v_mfma_f32_16x16x32_bf16 v[84:87], v[112:115], v[152:155], v[84:87]
    ds_read_b128 v[112:115], v66 offset:2624
    s_waitcnt lgkmcnt(2)
    v_mfma_f32_16x16x32_bf16 v[104:107], v[116:119], v[168:171], v[104:107]
    v_mfma_f32_16x16x32_bf16 v[100:103], v[116:119], v[164:167], v[100:103]
    v_mfma_f32_16x16x32_bf16 v[96:99], v[116:119], v[160:163], v[96:99]
    v_mfma_f32_16x16x32_bf16 v[92:95], v[116:119], v[156:159], v[92:95]
    v_mfma_f32_16x16x32_bf16 v[88:91], v[116:119], v[152:155], v[88:91]
    ds_read_b128 v[116:119], v66 offset:3136
    s_waitcnt lgkmcnt(2)
    v_mfma_f32_16x16x32_bf16 v[104:107], v[108:111], v[164:167], v[104:107]
    v_mfma_f32_16x16x32_bf16 v[100:103], v[108:111], v[160:163], v[100:103]
    v_mfma_f32_16x16x32_bf16 v[96:99], v[108:111], v[156:159], v[96:99]
    v_mfma_f32_16x16x32_bf16 v[92:95], v[108:111], v[152:155], v[92:95]
    ds_read_b128 v[108:111], v66 offset:3648
    s_waitcnt lgkmcnt(2)
    v_mfma_f32_16x16x32_bf16 v[104:107], v[112:115], v[160:163], v[104:107]
    v_mfma_f32_16x16x32_bf16 v[100:103], v[112:115], v[156:159], v[100:103]
    v_mfma_f32_16x16x32_bf16 v[96:99], v[112:115], v[152:155], v[96:99]
    s_waitcnt lgkmcnt(1)
    v_mfma_f32_16x16x32_bf16 v[104:107], v[116:119], v[156:159], v[104:107]
    v_mfma_f32_16x16x32_bf16 v[100:103], v[116:119], v[152:155], v[100:103]
    s_waitcnt lgkmcnt(0)
    v_mfma_f32_16x16x32_bf16 v[104:107], v[108:111], v[152:155], v[104:107]
    ds_write_b128 v74, v[76:79] offset:0
    ds_write_b128 v74, v[80:83] offset:1024
    ds_write_b128 v74, v[84:87] offset:2048
    ds_write_b128 v74, v[88:91] offset:3072
    ds_write_b128 v74, v[92:95] offset:4096
    ds_write_b128 v74, v[96:99] offset:5120
    ds_write_b128 v74, v[100:103] offset:6144
    s_nop 0
    ds_write_b128 v74, v[104:107] offset:7168
    s_branch c_pw_end_46
c_pw_47:
    s_cmp_lg_u32 s34, 1
    s_cbranch_scc1 c_pw_48
    ds_read_b128 v[108:111], v66 offset:128
    ds_read_b128 v[120:123], v67 offset:352
    ds_read_b128 v[124:127], v67 offset:864
    ds_read_b128 v[128:131], v67 offset:1376
    ds_read_b128 v[132:135], v67 offset:1888
    ds_read_b128 v[136:139], v67 offset:2400
    ds_read_b128 v[140:143], v67 offset:2912
    ds_read_b128 v[144:147], v67 offset:3424
    ds_read_b128 v[148:151], v67 offset:3936
    ds_read_b128 v[112:115], v66 offset:640
    ds_read_b128 v[116:119], v66 offset:1152
    s_waitcnt lgkmcnt(2)
    v_mfma_f32_16x16x32_bf16 v[104:107], v[108:111], v[148:151], 0
    v_mfma_f32_16x16x32_bf16 v[100:103], v[108:111], v[144:147], 0
    v_mfma_f32_16x16x32_bf16 v[96:99], v[108:111], v[140:143], 0
    v_mfma_f32_16x16x32_bf16 v[92:95], v[108:111], v[136:139], 0
    v_mfma_f32_16x16x32_bf16 v[88:91], v[108:111], v[132:135], 0
    v_mfma_f32_16x16x32_bf16 v[84:87], v[108:111], v[128:131], 0
    v_mfma_f32_16x16x32_bf16 v[80:83], v[108:111], v[124:127], 0
    v_mfma_f32_16x16x32_bf16 v[76:79], v[108:111], v[120:123], 0
    ds_read_b128 v[108:111], v66 offset:1664
    s_waitcnt lgkmcnt(2)
    v_mfma_f32_16x16x32_bf16 v[104:107], v[112:115], v[144:147], v[104:107]
    v_mfma_f32_16x16x32_bf16 v[100:103], v[112:115], v[140:143], v[100:103]
    v_mfma_f32_16x16x32_bf16 v[96:99], v[112:115], v[136:139], v[96:99]
    v_mfma_f32_16x16x32_bf16 v[92:95], v[112:115], v[132:135], v[92:95]
    v_mfma_f32_16x16x32_bf16 v[88:91], v[112:115], v[128:131], v[88:91]
    v_mfma_f32_16x16x32_bf16 v[84:87], v[112:115], v[124:127], v[84:87]
    v_mfma_f32_16x16x32_bf16 v[80:83], v[112:115], v[120:123], v[80:83]
    ds_read_b128 v[112:115], v66 offset:2176
    ds_read_b128 v[152:155], v67 offset:288
    ds_read_b128 v[156:159], v67 offset:800
    ds_read_b128 v[160:163], v67 offset:1312
    ds_read_b128 v[164:167], v67 offset:1824
    ds_read_b128 v[168:171], v67 offset:2336
    ds_read_b128 v[172:175], v67 offset:2848
    ds_read_b128 v[176:179], v67 offset:3360
    ds_read_b128 v[180:183], v67 offset:3872
    s_waitcnt lgkmcnt(10)
    v_mfma_f32_16x16x32_bf16 v[104:107], v[116:119], v[140:143], v[104:107]
    v_mfma_f32_16x16x32_bf16 v[100:103], v[116:119], v[136:139], v[100:103]
    v_mfma_f32_16x16x32_bf16 v[96:99], v[116:119], v[132:135], v[96:99]
    v_mfma_f32_16x16x32_bf16 v[92:95], v[116:119], v[128:131], v[92:95]
    v_mfma_f32_16x16x32_bf16 v[88:91], v[116:119], v[124:127], v[88:91]
    v_mfma_f32_16x16x32_bf16 v[84:87], v[116:119], v[120:123], v[84:87]
    ds_read_b128 v[116:119], v66 offset:2688
    s_waitcnt lgkmcnt(10)
    v_mfma_f32_16x16x32_bf16 v[104:107], v[108:111], v[136:139], v[104:107]
    v_mfma_f32_16x16x32_bf16 v[100:103], v[108:111], v[132:135], v[100:103]
    v_mfma_f32_16x16x32_bf16 v[96:99], v[108:111], v[128:131], v[96:99]
    v_mfma_f32_16x16x32_bf16 v[92:95], v[108:111], v[124:127], v[92:95]
    v_mfma_f32_16x16x32_bf16 v[88:91], v[108:111], v[120:123], v[88:91]
    ds_read_b128 v[108:111], v66 offset:3200
    s_waitcnt lgkmcnt(10)
    v_mfma_f32_16x16x32_bf16 v[104:107], v[112:115], v[132:135], v[104:107]
    v_mfma_f32_16x16x32_bf16 v[100:103], v[112:115], v[128:131], v[100:103]
    v_mfma_f32_16x16x32_bf16 v[96:99], v[112:115], v[124:127], v[96:99]
    v_mfma_f32_16x16x32_bf16 v[92:95], v[112:115], v[120:123], v[92:95]
    ds_read_b128 v[112:115], v66 offset:3712
    s_waitcnt lgkmcnt(2)
    v_mfma_f32_16x16x32_bf16 v[104:107], v[116:119], v[128:131], v[104:107]
    v_mfma_f32_16x16x32_bf16 v[100:103], v[116:119], v[124:127], v[100:103]
    v_mfma_f32_16x16x32_bf16 v[96:99], v[116:119], v[120:123], v[96:99]
    ds_read_b128 v[116:119], v66 offset:192
    s_waitcnt lgkmcnt(2)
    v_mfma_f32_16x16x32_bf16 v[104:107], v[108:111], v[124:127], v[104:107]
    v_mfma_f32_16x16x32_bf16 v[100:103], v[108:111], v[120:123], v[100:103]
    ds_read_b128 v[108:111], v66 offset:704
    s_waitcnt lgkmcnt(2)
    v_mfma_f32_16x16x32_bf16 v[104:107], v[112:115], v[120:123], v[104:107]
    ds_read_b128 v[112:115], v66 offset:1216
    s_waitcnt lgkmcnt(2)
    v_mfma_f32_16x16x32_bf16 v[104:107], v[116:119], v[180:183], v[104:107]
    v_mfma_f32_16x16x32_bf16 v[100:103], v[116:119], v[176:179], v[100:103]
    v_mfma_f32_16x16x32_bf16 v[96:99], v[116:119], v[172:175], v[96:99]
    v_mfma_f32_16x16x32_bf16 v[92:95], v[116:119], v[168:171], v[92:95]
    v_mfma_f32_16x16x32_bf16 v[88:91], v[116:119], v[164:167], v[88:91]
    v_mfma_f32_16x16x32_bf16 v[84:87], v[116:119], v[160:163], v[84:87]
    v_mfma_f32_16x16x32_bf16 v[80:83], v[116:119], v[156:159], v[80:83]
    v_mfma_f32_16x16x32_bf16 v[76:79], v[116:119], v[152:155], v[76:79]
    ds_read_b128 v[116:119], v66 offset:1728
    s_waitcnt lgkmcnt(2)
    v_mfma_f32_16x16x32_bf16 v[104:107], v[108:111], v[176:179], v[104:107]
    v_mfma_f32_16x16x32_bf16 v[100:103], v[108:111], v[172:175], v[100:103]
    v_mfma_f32_16x16x32_bf16 v[96:99], v[108:111], v[168:171], v[96:99]
    v_mfma_f32_16x16x32_bf16 v[92:95], v[108:111], v[164:167], v[92:95]
    v_mfma_f32_16x16x32_bf16 v[88:91], v[108:111], v[160:163], v[88:91]
    v_mfma_f32_16x16x32_bf16 v[84:87], v[108:111], v[156:159], v[84:87]
    v_mfma_f32_16x16x32_bf16 v[80:83], v[108:111], v[152:155], v[80:83]
    ds_read_b128 v[108:111], v66 offset:2240
    s_waitcnt lgkmcnt(2)
    v_mfma_f32_16x16x32_bf16 v[104:107], v[112:115], v[172:175], v[104:107]
    v_mfma_f32_16x16x32_bf16 v[100:103], v[112:115], v[168:171], v[100:103]
    v_mfma_f32_16x16x32_bf16 v[96:99], v[112:115], v[164:167], v[96:99]
    v_mfma_f32_16x16x32_bf16 v[92:95], v[112:115], v[160:163], v[92:95]
    v_mfma_f32_16x16x32_bf16 v[88:91], v[112:115], v[156:159], v[88:91]
    v_mfma_f32_16x16x32_bf16 v[84:87], v[112:115], v[152:155], v[84:87]
    ds_read_b128 v[112:115], v66 offset:2752
    s_waitcnt lgkmcnt(2)
    v_mfma_f32_16x16x32_bf16 v[104:107], v[116:119], v[168:171], v[104:107]
    v_mfma_f32_16x16x32_bf16 v[100:103], v[116:119], v[164:167], v[100:103]
    v_mfma_f32_16x16x32_bf16 v[96:99], v[116:119], v[160:163], v[96:99]
    v_mfma_f32_16x16x32_bf16 v[92:95], v[116:119], v[156:159], v[92:95]
    v_mfma_f32_16x16x32_bf16 v[88:91], v[116:119], v[152:155], v[88:91]
    ds_read_b128 v[116:119], v66 offset:3264
    s_waitcnt lgkmcnt(2)
    v_mfma_f32_16x16x32_bf16 v[104:107], v[108:111], v[164:167], v[104:107]
    v_mfma_f32_16x16x32_bf16 v[100:103], v[108:111], v[160:163], v[100:103]
    v_mfma_f32_16x16x32_bf16 v[96:99], v[108:111], v[156:159], v[96:99]
    v_mfma_f32_16x16x32_bf16 v[92:95], v[108:111], v[152:155], v[92:95]
    ds_read_b128 v[108:111], v66 offset:3776
    s_waitcnt lgkmcnt(2)
    v_mfma_f32_16x16x32_bf16 v[104:107], v[112:115], v[160:163], v[104:107]
    v_mfma_f32_16x16x32_bf16 v[100:103], v[112:115], v[156:159], v[100:103]
    v_mfma_f32_16x16x32_bf16 v[96:99], v[112:115], v[152:155], v[96:99]
    s_waitcnt lgkmcnt(1)
    v_mfma_f32_16x16x32_bf16 v[104:107], v[116:119], v[156:159], v[104:107]
    v_mfma_f32_16x16x32_bf16 v[100:103], v[116:119], v[152:155], v[100:103]
    s_waitcnt lgkmcnt(0)
    v_mfma_f32_16x16x32_bf16 v[104:107], v[108:111], v[152:155], v[104:107]
    ds_write_b128 v74, v[76:79] offset:0
    ds_write_b128 v74, v[80:83] offset:1024
    ds_write_b128 v74, v[84:87] offset:2048
    ds_write_b128 v74, v[88:91] offset:3072
    ds_write_b128 v74, v[92:95] offset:4096
    ds_write_b128 v74, v[96:99] offset:5120
    ds_write_b128 v74, v[100:103] offset:6144
    s_nop 0
    ds_write_b128 v74, v[104:107] offset:7168
    s_branch c_pw_end_46
c_pw_48:
    s_cmp_lg_u32 s34, 2
    s_cbranch_scc1 c_pw_49
    ds_read_b128 v[108:111], v66 offset:256
    ds_read_b128 v[120:123], v67 offset:224
    ds_read_b128 v[124:127], v67 offset:736
    ds_read_b128 v[128:131], v67 offset:1248
    ds_read_b128 v[132:135], v67 offset:1760
    ds_read_b128 v[136:139], v67 offset:2272
    ds_read_b128 v[140:143], v67 offset:2784
    ds_read_b128 v[144:147], v67 offset:3296
    ds_read_b128 v[148:151], v67 offset:3808
    ds_read_b128 v[112:115], v66 offset:768
    ds_read_b128 v[116:119], v66 offset:1280
    s_waitcnt lgkmcnt(2)
    v_mfma_f32_16x16x32_bf16 v[104:107], v[108:111], v[148:151], 0
    v_mfma_f32_16x16x32_bf16 v[100:103], v[108:111], v[144:147], 0
    v_mfma_f32_16x16x32_bf16 v[96:99], v[108:111], v[140:143], 0
    v_mfma_f32_16x16x32_bf16 v[92:95], v[108:111], v[136:139], 0
    v_mfma_f32_16x16x32_bf16 v[88:91], v[108:111], v[132:135], 0
    v_mfma_f32_16x16x32_bf16 v[84:87], v[108:111], v[128:131], 0
    v_mfma_f32_16x16x32_bf16 v[80:83], v[108:111], v[124:127], 0
    v_mfma_f32_16x16x32_bf16 v[76:79], v[108:111], v[120:123], 0
    ds_read_b128 v[108:111], v66 offset:1792
    s_waitcnt lgkmcnt(2)
    v_mfma_f32_16x16x32_bf16 v[104:107], v[112:115], v[144:147], v[104:107]
    v_mfma_f32_16x16x32_bf16 v[100:103], v[112:115], v[140:143], v[100:103]
    v_mfma_f32_16x16x32_bf16 v[96:99], v[112:115], v[136:139], v[96:99]
    v_mfma_f32_16x16x32_bf16 v[92:95], v[112:115], v[132:135], v[92:95]
    v_mfma_f32_16x16x32_bf16 v[88:91], v[112:115], v[128:131], v[88:91]
    v_mfma_f32_16x16x32_bf16 v[84:87], v[112:115], v[124:127], v[84:87]
    v_mfma_f32_16x16x32_bf16 v[80:83], v[112:115], v[120:123], v[80:83]
    ds_read_b128 v[112:115], v66 offset:2304
    ds_read_b128 v[152:155], v67 offset:160
    ds_read_b128 v[156:159], v67 offset:672
    ds_read_b128 v[160:163], v67 offset:1184
    ds_read_b128 v[164:167], v67 offset:1696
    ds_read_b128 v[168:171], v67 offset:2208
    ds_read_b128 v[172:175], v67 offset:2720
    ds_read_b128 v[176:179], v67 offset:3232
    ds_read_b128 v[180:183], v67 offset:3744
    s_waitcnt lgkmcnt(10)
    v_mfma_f32_16x16x32_bf16 v[104:107], v[116:119], v[140:143], v[104:107]
    v_mfma_f32_16x16x32_bf16 v[100:103], v[116:119], v[136:139], v[100:103]
    v_mfma_f32_16x16x32_bf16 v[96:99], v[116:119], v[132:135], v[96:99]
    v_mfma_f32_16x16x32_bf16 v[92:95], v[116:119], v[128:131], v[92:95]
    v_mfma_f32_16x16x32_bf16 v[88:91], v[116:119], v[124:127], v[88:91]
    v_mfma_f32_16x16x32_bf16 v[84:87], v[116:119], v[120:123], v[84:87]
    ds_read_b128 v[116:119], v66 offset:2816
    s_waitcnt lgkmcnt(10)
    v_mfma_f32_16x16x32_bf16 v[104:107], v[108:111], v[136:139], v[104:107]
    v_mfma_f32_16x16x32_bf16 v[100:103], v[108:111], v[132:135], v[100:103]
    v_mfma_f32_16x16x32_bf16 v[96:99], v[108:111], v[128:131], v[96:99]
    v_mfma_f32_16x16x32_bf16 v[92:95], v[108:111], v[124:127], v[92:95]
    v_mfma_f32_16x16x32_bf16 v[88:91], v[108:111], v[120:123], v[88:91]
    ds_read_b128 v[108:111], v66 offset:3328
    s_waitcnt lgkmcnt(10)
    v_mfma_f32_16x16x32_bf16 v[104:107], v[112:115], v[132:135], v[104:107]
    v_mfma_f32_16x16x32_bf16 v[100:103], v[112:115], v[128:131], v[100:103]
    v_mfma_f32_16x16x32_bf16 v[96:99], v[112:115], v[124:127], v[96:99]
    v_mfma_f32_16x16x32_bf16 v[92:95], v[112:115], v[120:123], v[92:95]
    ds_read_b128 v[112:115], v66 offset:3840
    s_waitcnt lgkmcnt(2)
    v_mfma_f32_16x16x32_bf16 v[104:107], v[116:119], v[128:131], v[104:107]
    v_mfma_f32_16x16x32_bf16 v[100:103], v[116:119], v[124:127], v[100:103]
    v_mfma_f32_16x16x32_bf16 v[96:99], v[116:119], v[120:123], v[96:99]
    ds_read_b128 v[116:119], v66 offset:320
    s_waitcnt lgkmcnt(2)
    v_mfma_f32_16x16x32_bf16 v[104:107], v[108:111], v[124:127], v[104:107]
    v_mfma_f32_16x16x32_bf16 v[100:103], v[108:111], v[120:123], v[100:103]
    ds_read_b128 v[108:111], v66 offset:832
    s_waitcnt lgkmcnt(2)
    v_mfma_f32_16x16x32_bf16 v[104:107], v[112:115], v[120:123], v[104:107]
    ds_read_b128 v[112:115], v66 offset:1344
    s_waitcnt lgkmcnt(2)
    v_mfma_f32_16x16x32_bf16 v[104:107], v[116:119], v[180:183], v[104:107]
    v_mfma_f32_16x16x32_bf16 v[100:103], v[116:119], v[176:179], v[100:103]
    v_mfma_f32_16x16x32_bf16 v[96:99], v[116:119], v[172:175], v[96:99]
    v_mfma_f32_16x16x32_bf16 v[92:95], v[116:119], v[168:171], v[92:95]
    v_mfma_f32_16x16x32_bf16 v[88:91], v[116:119], v[164:167], v[88:91]
    v_mfma_f32_16x16x32_bf16 v[84:87], v[116:119], v[160:163], v[84:87]
    v_mfma_f32_16x16x32_bf16 v[80:83], v[116:119], v[156:159], v[80:83]
    v_mfma_f32_16x16x32_bf16 v[76:79], v[116:119], v[152:155], v[76:79]
    ds_read_b128 v[116:119], v66 offset:1856
    s_waitcnt lgkmcnt(2)
    v_mfma_f32_16x16x32_bf16 v[104:107], v[108:111], v[176:179], v[104:107]
    v_mfma_f32_16x16x32_bf16 v[100:103], v[108:111], v[172:175], v[100:103]
    v_mfma_f32_16x16x32_bf16 v[96:99], v[108:111], v[168:171], v[96:99]
    v_mfma_f32_16x16x32_bf16 v[92:95], v[108:111], v[164:167], v[92:95]
    v_mfma_f32_16x16x32_bf16 v[88:91], v[108:111], v[160:163], v[88:91]
    v_mfma_f32_16x16x32_bf16 v[84:87], v[108:111], v[156:159], v[84:87]
    v_mfma_f32_16x16x32_bf16 v[80:83], v[108:111], v[152:155], v[80:83]
    ds_read_b128 v[108:111], v66 offset:2368
    s_waitcnt lgkmcnt(2)
    v_mfma_f32_16x16x32_bf16 v[104:107], v[112:115], v[172:175], v[104:107]
    v_mfma_f32_16x16x32_bf16 v[100:103], v[112:115], v[168:171], v[100:103]
    v_mfma_f32_16x16x32_bf16 v[96:99], v[112:115], v[164:167], v[96:99]
    v_mfma_f32_16x16x32_bf16 v[92:95], v[112:115], v[160:163], v[92:95]
    v_mfma_f32_16x16x32_bf16 v[88:91], v[112:115], v[156:159], v[88:91]
    v_mfma_f32_16x16x32_bf16 v[84:87], v[112:115], v[152:155], v[84:87]
    ds_read_b128 v[112:115], v66 offset:2880
    s_waitcnt lgkmcnt(2)
    v_mfma_f32_16x16x32_bf16 v[104:107], v[116:119], v[168:171], v[104:107]
    v_mfma_f32_16x16x32_bf16 v[100:103], v[116:119], v[164:167], v[100:103]
    v_mfma_f32_16x16x32_bf16 v[96:99], v[116:119], v[160:163], v[96:99]
    v_mfma_f32_16x16x32_bf16 v[92:95], v[116:119], v[156:159], v[92:95]
    v_mfma_f32_16x16x32_bf16 v[88:91], v[116:119], v[152:155], v[88:91]
    ds_read_b128 v[116:119], v66 offset:3392
    s_waitcnt lgkmcnt(2)
    v_mfma_f32_16x16x32_bf16 v[104:107], v[108:111], v[164:167], v[104:107]
    v_mfma_f32_16x16x32_bf16 v[100:103], v[108:111], v[160:163], v[100:103]
    v_mfma_f32_16x16x32_bf16 v[96:99], v[108:111], v[156:159], v[96:99]
    v_mfma_f32_16x16x32_bf16 v[92:95], v[108:111], v[152:155], v[92:95]
    ds_read_b128 v[108:111], v66 offset:3904
    s_waitcnt lgkmcnt(2)
    v_mfma_f32_16x16x32_bf16 v[104:107], v[112:115], v[160:163], v[104:107]
    v_mfma_f32_16x16x32_bf16 v[100:103], v[112:115], v[156:159], v[100:103]
    v_mfma_f32_16x16x32_bf16 v[96:99], v[112:115], v[152:155], v[96:99]
    s_waitcnt lgkmcnt(1)
    v_mfma_f32_16x16x32_bf16 v[104:107], v[116:119], v[156:159], v[104:107]
    v_mfma_f32_16x16x32_bf16 v[100:103], v[116:119], v[152:155], v[100:103]
    s_waitcnt lgkmcnt(0)
    v_mfma_f32_16x16x32_bf16 v[104:107], v[108:111], v[152:155], v[104:107]
    ds_write_b128 v74, v[76:79] offset:0
    ds_write_b128 v74, v[80:83] offset:1024
    ds_write_b128 v74, v[84:87] offset:2048
    ds_write_b128 v74, v[88:91] offset:3072
    ds_write_b128 v74, v[92:95] offset:4096
    ds_write_b128 v74, v[96:99] offset:5120
    ds_write_b128 v74, v[100:103] offset:6144
    s_nop 0
    ds_write_b128 v74, v[104:107] offset:7168
    s_branch c_pw_end_46
c_pw_49:
    ds_read_b128 v[108:111], v66 offset:384
    ds_read_b128 v[120:123], v67 offset:96
    ds_read_b128 v[124:127], v67 offset:608
    ds_read_b128 v[128:131], v67 offset:1120
    ds_read_b128 v[132:135], v67 offset:1632
    ds_read_b128 v[136:139], v67 offset:2144
    ds_read_b128 v[140:143], v67 offset:2656
    ds_read_b128 v[144:147], v67 offset:3168
    ds_read_b128 v[148:151], v67 offset:3680
    ds_read_b128 v[112:115], v66 offset:896
    ds_read_b128 v[116:119], v66 offset:1408
    s_waitcnt lgkmcnt(2)
    v_mfma_f32_16x16x32_bf16 v[104:107], v[108:111], v[148:151], 0
    v_mfma_f32_16x16x32_bf16 v[100:103], v[108:111], v[144:147], 0
    v_mfma_f32_16x16x32_bf16 v[96:99], v[108:111], v[140:143], 0
    v_mfma_f32_16x16x32_bf16 v[92:95], v[108:111], v[136:139], 0
    v_mfma_f32_16x16x32_bf16 v[88:91], v[108:111], v[132:135], 0
    v_mfma_f32_16x16x32_bf16 v[84:87], v[108:111], v[128:131], 0
    v_mfma_f32_16x16x32_bf16 v[80:83], v[108:111], v[124:127], 0
    v_mfma_f32_16x16x32_bf16 v[76:79], v[108:111], v[120:123], 0
    ds_read_b128 v[108:111], v66 offset:1920
    s_waitcnt lgkmcnt(2)
    v_mfma_f32_16x16x32_bf16 v[104:107], v[112:115], v[144:147], v[104:107]
    v_mfma_f32_16x16x32_bf16 v[100:103], v[112:115], v[140:143], v[100:103]
    v_mfma_f32_16x16x32_bf16 v[96:99], v[112:115], v[136:139], v[96:99]
    v_mfma_f32_16x16x32_bf16 v[92:95], v[112:115], v[132:135], v[92:95]
    v_mfma_f32_16x16x32_bf16 v[88:91], v[112:115], v[128:131], v[88:91]
    v_mfma_f32_16x16x32_bf16 v[84:87], v[112:115], v[124:127], v[84:87]
    v_mfma_f32_16x16x32_bf16 v[80:83], v[112:115], v[120:123], v[80:83]
    ds_read_b128 v[112:115], v66 offset:2432
    ds_read_b128 v[152:155], v67 offset:32
    ds_read_b128 v[156:159], v67 offset:544
    ds_read_b128 v[160:163], v67 offset:1056
    ds_read_b128 v[164:167], v67 offset:1568
    ds_read_b128 v[168:171], v67 offset:2080
    ds_read_b128 v[172:175], v67 offset:2592
    ds_read_b128 v[176:179], v67 offset:3104
    ds_read_b128 v[180:183], v67 offset:3616
    s_waitcnt lgkmcnt(10)
    v_mfma_f32_16x16x32_bf16 v[104:107], v[116:119], v[140:143], v[104:107]
    v_mfma_f32_16x16x32_bf16 v[100:103], v[116:119], v[136:139], v[100:103]
    v_mfma_f32_16x16x32_bf16 v[96:99], v[116:119], v[132:135], v[96:99]
    v_mfma_f32_16x16x32_bf16 v[92:95], v[116:119], v[128:131], v[92:95]
    v_mfma_f32_16x16x32_bf16 v[88:91], v[116:119], v[124:127], v[88:91]
    v_mfma_f32_16x16x32_bf16 v[84:87], v[116:119], v[120:123], v[84:87]
    ds_read_b128 v[116:119], v66 offset:2944
    s_waitcnt lgkmcnt(10)
    v_mfma_f32_16x16x32_bf16 v[104:107], v[108:111], v[136:139], v[104:107]
    v_mfma_f32_16x16x32_bf16 v[100:103], v[108:111], v[132:135], v[100:103]
    v_mfma_f32_16x16x32_bf16 v[96:99], v[108:111], v[128:131], v[96:99]
    v_mfma_f32_16x16x32_bf16 v[92:95], v[108:111], v[124:127], v[92:95]
    v_mfma_f32_16x16x32_bf16 v[88:91], v[108:111], v[120:123], v[88:91]
    ds_read_b128 v[108:111], v66 offset:3456
    s_waitcnt lgkmcnt(10)
    v_mfma_f32_16x16x32_bf16 v[104:107], v[112:115], v[132:135], v[104:107]
    v_mfma_f32_16x16x32_bf16 v[100:103], v[112:115], v[128:131], v[100:103]
    v_mfma_f32_16x16x32_bf16 v[96:99], v[112:115], v[124:127], v[96:99]
    v_mfma_f32_16x16x32_bf16 v[92:95], v[112:115], v[120:123], v[92:95]
    ds_read_b128 v[112:115], v66 offset:3968
    s_waitcnt lgkmcnt(2)
    v_mfma_f32_16x16x32_bf16 v[104:107], v[116:119], v[128:131], v[104:107]
    v_mfma_f32_16x16x32_bf16 v[100:103], v[116:119], v[124:127], v[100:103]
    v_mfma_f32_16x16x32_bf16 v[96:99], v[116:119], v[120:123], v[96:99]
    ds_read_b128 v[116:119], v66 offset:448
    s_waitcnt lgkmcnt(2)
    v_mfma_f32_16x16x32_bf16 v[104:107], v[108:111], v[124:127], v[104:107]
    v_mfma_f32_16x16x32_bf16 v[100:103], v[108:111], v[120:123], v[100:103]
    ds_read_b128 v[108:111], v66 offset:960
    s_waitcnt lgkmcnt(2)
    v_mfma_f32_16x16x32_bf16 v[104:107], v[112:115], v[120:123], v[104:107]
    ds_read_b128 v[112:115], v66 offset:1472
    s_waitcnt lgkmcnt(2)
    v_mfma_f32_16x16x32_bf16 v[104:107], v[116:119], v[180:183], v[104:107]
    v_mfma_f32_16x16x32_bf16 v[100:103], v[116:119], v[176:179], v[100:103]
    v_mfma_f32_16x16x32_bf16 v[96:99], v[116:119], v[172:175], v[96:99]
    v_mfma_f32_16x16x32_bf16 v[92:95], v[116:119], v[168:171], v[92:95]
    v_mfma_f32_16x16x32_bf16 v[88:91], v[116:119], v[164:167], v[88:91]
    v_mfma_f32_16x16x32_bf16 v[84:87], v[116:119], v[160:163], v[84:87]
    v_mfma_f32_16x16x32_bf16 v[80:83], v[116:119], v[156:159], v[80:83]
    v_mfma_f32_16x16x32_bf16 v[76:79], v[116:119], v[152:155], v[76:79]
    ds_read_b128 v[116:119], v66 offset:1984
    s_waitcnt lgkmcnt(2)
    v_mfma_f32_16x16x32_bf16 v[104:107], v[108:111], v[176:179], v[104:107]
    v_mfma_f32_16x16x32_bf16 v[100:103], v[108:111], v[172:175], v[100:103]
    v_mfma_f32_16x16x32_bf16 v[96:99], v[108:111], v[168:171], v[96:99]
    v_mfma_f32_16x16x32_bf16 v[92:95], v[108:111], v[164:167], v[92:95]
    v_mfma_f32_16x16x32_bf16 v[88:91], v[108:111], v[160:163], v[88:91]
    v_mfma_f32_16x16x32_bf16 v[84:87], v[108:111], v[156:159], v[84:87]
    v_mfma_f32_16x16x32_bf16 v[80:83], v[108:111], v[152:155], v[80:83]
    ds_read_b128 v[108:111], v66 offset:2496
    s_waitcnt lgkmcnt(2)
    v_mfma_f32_16x16x32_bf16 v[104:107], v[112:115], v[172:175], v[104:107]
    v_mfma_f32_16x16x32_bf16 v[100:103], v[112:115], v[168:171], v[100:103]
    v_mfma_f32_16x16x32_bf16 v[96:99], v[112:115], v[164:167], v[96:99]
    v_mfma_f32_16x16x32_bf16 v[92:95], v[112:115], v[160:163], v[92:95]
    v_mfma_f32_16x16x32_bf16 v[88:91], v[112:115], v[156:159], v[88:91]
    v_mfma_f32_16x16x32_bf16 v[84:87], v[112:115], v[152:155], v[84:87]
    ds_read_b128 v[112:115], v66 offset:3008
    s_waitcnt lgkmcnt(2)
    v_mfma_f32_16x16x32_bf16 v[104:107], v[116:119], v[168:171], v[104:107]
    v_mfma_f32_16x16x32_bf16 v[100:103], v[116:119], v[164:167], v[100:103]
    v_mfma_f32_16x16x32_bf16 v[96:99], v[116:119], v[160:163], v[96:99]
    v_mfma_f32_16x16x32_bf16 v[92:95], v[116:119], v[156:159], v[92:95]
    v_mfma_f32_16x16x32_bf16 v[88:91], v[116:119], v[152:155], v[88:91]
    ds_read_b128 v[116:119], v66 offset:3520
    s_waitcnt lgkmcnt(2)
    v_mfma_f32_16x16x32_bf16 v[104:107], v[108:111], v[164:167], v[104:107]
    v_mfma_f32_16x16x32_bf16 v[100:103], v[108:111], v[160:163], v[100:103]
    v_mfma_f32_16x16x32_bf16 v[96:99], v[108:111], v[156:159], v[96:99]
    v_mfma_f32_16x16x32_bf16 v[92:95], v[108:111], v[152:155], v[92:95]
    ds_read_b128 v[108:111], v66 offset:4032
    s_waitcnt lgkmcnt(2)
    v_mfma_f32_16x16x32_bf16 v[104:107], v[112:115], v[160:163], v[104:107]
    v_mfma_f32_16x16x32_bf16 v[100:103], v[112:115], v[156:159], v[100:103]
    v_mfma_f32_16x16x32_bf16 v[96:99], v[112:115], v[152:155], v[96:99]
    s_waitcnt lgkmcnt(1)
    v_mfma_f32_16x16x32_bf16 v[104:107], v[116:119], v[156:159], v[104:107]
    v_mfma_f32_16x16x32_bf16 v[100:103], v[116:119], v[152:155], v[100:103]
    s_waitcnt lgkmcnt(0)
    v_mfma_f32_16x16x32_bf16 v[104:107], v[108:111], v[152:155], v[104:107]
    ds_write_b128 v74, v[76:79] offset:0
    ds_write_b128 v74, v[80:83] offset:1024
    ds_write_b128 v74, v[84:87] offset:2048
    ds_write_b128 v74, v[88:91] offset:3072
    ds_write_b128 v74, v[92:95] offset:4096
    ds_write_b128 v74, v[96:99] offset:5120
    ds_write_b128 v74, v[100:103] offset:6144
    s_nop 0
    ds_write_b128 v74, v[104:107] offset:7168
c_pw_end_46:
    s_waitcnt lgkmcnt(0)
    v_mov_b32 v3, 161796
    v_mov_b32 v4, 1
    s_mov_b64 exec, 1
    ds_add_u32 v3, v4
    s_mov_b64 exec, -1
    s_mov_b32 s67, 0
gsync_51:
    ds_read_b32 v4, v3
    s_add_u32 s67, s67, 1
    s_waitcnt lgkmcnt(0)
    v_readfirstlane_b32 s66, v4
    s_cmp_gt_u32 s67, 1000000
    s_cbranch_scc1 gsync_e_52
    s_cmp_lt_u32 s66, 8
    s_cbranch_scc1 gsync_51
gsync_e_52:
    ds_read_b128 v[120:123], v75 offset:0
    ds_read_b128 v[124:127], v75 offset:16
    ds_read_b128 v[128:131], v75 offset:8192
    ds_read_b128 v[132:135], v75 offset:8208
    ds_read_b128 v[136:139], v75 offset:16384
    ds_read_b128 v[140:143], v75 offset:16400
    ds_read_b128 v[144:147], v75 offset:24576
    ds_read_b128 v[148:151], v75 offset:24592
    s_lshl_b32 s40, s56, 12
    s_add_u32 s40, s40, 8912896
    s_waitcnt lgkmcnt(0)
    v_pk_add_f32 v[120:121], v[120:121], v[128:129]
    v_pk_add_f32 v[136:137], v[136:137], v[144:145]
    v_pk_add_f32 v[122:123], v[122:123], v[130:131]
    v_pk_add_f32 v[138:139], v[138:139], v[146:147]
    v_pk_add_f32 v[124:125], v[124:125], v[132:133]
    v_pk_add_f32 v[140:141], v[140:141], v[148:149]
    v_pk_add_f32 v[126:127], v[126:127], v[134:135]
    v_pk_add_f32 v[142:143], v[142:143], v[150:151]
    v_pk_add_f32 v[120:121], v[120:121], v[136:137]
    v_pk_add_f32 v[122:123], v[122:123], v[138:139]
    v_pk_add_f32 v[124:125], v[124:125], v[140:141]
    v_pk_add_f32 v[126:127], v[126:127], v[142:143]
    v_cvt_pk_bf16_f32 v192, v120, v121
    v_cvt_pk_bf16_f32 v193, v122, v123
    v_cvt_pk_bf16_f32 v194, v124, v125
    v_cvt_pk_bf16_f32 v195, v126, v127
    buffer_store_dwordx4 v[192:195], v2, s[8:11], s40 offen sc1
    s_nop 1
    s_waitcnt vmcnt(1)
    v_cmp_ne_u32 vcc, 0, v0
    s_nop 1
    v_cndmask_b32 v16, 0, v16, vcc
    v_cndmask_b32 v17, 0, v17, vcc
    v_cndmask_b32 v18, 0, v18, vcc
    v_cndmask_b32 v19, 0, v19, vcc
    v_alignbit_b32 v184, v17, v16, 16
    v_alignbit_b32 v185, v18, v17, 16
    v_alignbit_b32 v186, v19, v18, 16
    v_alignbit_b32 v187, v20, v19, 16
    v_alignbit_b32 v188, v21, v20, 16
    v_alignbit_b32 v189, v22, v21, 16
    v_alignbit_b32 v190, v23, v22, 16
    ds_write_b128 v64, v[184:187] offset:0
    v_mov_b32 v192, v17
    v_mov_b32 v193, v18
    v_mov_b32 v194, v19
    v_mov_b32 v195, v20
    ds_write_b128 v64, v[192:195] offset:4160
    s_nop 1
    v_mov_b32 v192, v185
    v_mov_b32 v193, v186
    v_mov_b32 v194, v187
    v_mov_b32 v195, v188
    ds_write_b128 v64, v[192:195] offset:8320
    s_nop 1
    ds_write_b128 v64, v[18:21] offset:12480
    ds_write_b128 v64, v[186:189] offset:16640
    v_mov_b32 v192, v19
    v_mov_b32 v193, v20
    v_mov_b32 v194, v21
    v_mov_b32 v195, v22
    ds_write_b128 v64, v[192:195] offset:20800
    s_nop 1
    v_mov_b32 v192, v187
    v_mov_b32 v193, v188
    v_mov_b32 v194, v189
    v_mov_b32 v195, v190
    ds_write_b128 v64, v[192:195] offset:24960
    s_nop 1
    ds_write_b128 v64, v[20:23] offset:29120
    ds_write_b128 v65, v[36:39]
    v_lshlrev_b32 v3, 16, v45
    v_or_b32 v3, v3, v45
    v_and_b32 v196, v68, v3
    v_and_b32 v197, v69, v3
    v_and_b32 v198, v70, v3
    v_and_b32 v199, v71, v3
    s_waitcnt lgkmcnt(0)
    v_mov_b32 v3, 161796
    v_mov_b32 v4, 1
    s_mov_b64 exec, 1
    ds_add_u32 v3, v4
    s_mov_b64 exec, -1
    s_mov_b32 s67, 0
gsync_53:
    ds_read_b32 v4, v3
    s_add_u32 s67, s67, 1
    s_waitcnt lgkmcnt(0)
    v_readfirstlane_b32 s66, v4
    s_cmp_gt_u32 s67, 1000000
    s_cbranch_scc1 gsync_e_54
    s_cmp_lt_u32 s66, 12
    s_cbranch_scc1 gsync_53
gsync_e_54:
    s_cmp_ge_u32 s2, 192
    s_cbranch_scc1 c_wj3_55
    v_lshrrev_b32 v3, 4, v1
    v_and_b32 v5, 15, v1
    v_lshrrev_b32 v4, 2, v5
    v_lshl_add_u32 v3, v3, 2, v4
    v_mul_u32_u24 v3, 160, v3
    v_and_b32 v4, 3, v5
    v_lshl_add_u32 v3, v4, 3, v3
    v_lshlrev_b32 v5, 4, v1
    s_lshl_b32 s40, s34, 5
    s_add_u32 s41, s40, 156672
    v_add_u32 v4, s41, v3
    ds_read_b64_tr_b16 v[192:193], v4
    ds_read_b64_tr_b16 v[194:195], v4 offset:2560
    s_mul_i32 s41, s2, 5120
    s_lshl_b32 s40, s40, 5
    s_add_u32 s41, s41, s40
    s_add_u32 s41, s41, 15007744
    s_waitcnt lgkmcnt(0)
    buffer_store_dwordx4 v[192:195], v5, s[8:11], s41 offen sc1
    s_nop 1
    s_cmp_lg_u32 s34, 0
    s_cbranch_scc1 c_wj4_56
    s_mov_b32 s40, 128
    s_add_u32 s41, s40, 156672
    v_add_u32 v4, s41, v3
    ds_read_b64_tr_b16 v[192:193], v4
    ds_read_b64_tr_b16 v[194:195], v4 offset:2560
    s_mul_i32 s41, s2, 5120
    s_lshl_b32 s40, s40, 5
    s_add_u32 s41, s41, s40
    s_add_u32 s41, s41, 15007744
    s_waitcnt lgkmcnt(0)
    buffer_store_dwordx4 v[192:195], v5, s[8:11], s41 offen sc1
    s_nop 1
c_wj4_56:
c_wj3_55:
    s_cmp_lg_u32 s34, 0
    s_cbranch_scc1 c_pw_58
    ds_read_b128 v[108:111], v66 offset:0
    ds_read_b128 v[120:123], v67 offset:480
    ds_read_b128 v[124:127], v67 offset:992
    ds_read_b128 v[128:131], v67 offset:1504
    ds_read_b128 v[132:135], v67 offset:2016
    ds_read_b128 v[136:139], v67 offset:2528
    ds_read_b128 v[140:143], v67 offset:3040
    ds_read_b128 v[144:147], v67 offset:3552
    ds_read_b128 v[148:151], v67 offset:4064
    ds_read_b128 v[112:115], v66 offset:512
    ds_read_b128 v[116:119], v66 offset:1024
    s_waitcnt lgkmcnt(2)
    v_mfma_f32_16x16x32_bf16 v[104:107], v[108:111], v[148:151], 0
    v_mfma_f32_16x16x32_bf16 v[100:103], v[108:111], v[144:147], 0
    v_mfma_f32_16x16x32_bf16 v[96:99], v[108:111], v[140:143], 0
    v_mfma_f32_16x16x32_bf16 v[92:95], v[108:111], v[136:139], 0
    v_mfma_f32_16x16x32_bf16 v[88:91], v[108:111], v[132:135], 0
    v_mfma_f32_16x16x32_bf16 v[84:87], v[108:111], v[128:131], 0
    v_mfma_f32_16x16x32_bf16 v[80:83], v[108:111], v[124:127], 0
    v_mfma_f32_16x16x32_bf16 v[76:79], v[108:111], v[120:123], 0
    v_mfma_f32_16x16x32_bf16 v[76:79], v[196:199], v[120:123], v[76:79]
    v_mfma_f32_16x16x32_bf16 v[80:83], v[196:199], v[124:127], v[80:83]
    v_mfma_f32_16x16x32_bf16 v[84:87], v[196:199], v[128:131], v[84:87]
    v_mfma_f32_16x16x32_bf16 v[88:91], v[196:199], v[132:135], v[88:91]
    v_mfma_f32_16x16x32_bf16 v[92:95], v[196:199], v[136:139], v[92:95]
    v_mfma_f32_16x16x32_bf16 v[96:99], v[196:199], v[140:143], v[96:99]
    v_mfma_f32_16x16x32_bf16 v[100:103], v[196:199], v[144:147], v[100:103]
    v_mfma_f32_16x16x32_bf16 v[104:107], v[196:199], v[148:151], v[104:107]
    ds_read_b128 v[108:111], v66 offset:1536
    s_waitcnt lgkmcnt(2)
    v_mfma_f32_16x16x32_bf16 v[104:107], v[112:115], v[144:147], v[104:107]
    v_mfma_f32_16x16x32_bf16 v[100:103], v[112:115], v[140:143], v[100:103]
    v_mfma_f32_16x16x32_bf16 v[96:99], v[112:115], v[136:139], v[96:99]
    v_mfma_f32_16x16x32_bf16 v[92:95], v[112:115], v[132:135], v[92:95]
    v_mfma_f32_16x16x32_bf16 v[88:91], v[112:115], v[128:131], v[88:91]
    v_mfma_f32_16x16x32_bf16 v[84:87], v[112:115], v[124:127], v[84:87]
    v_mfma_f32_16x16x32_bf16 v[80:83], v[112:115], v[120:123], v[80:83]
    ds_read_b128 v[112:115], v66 offset:2048
    ds_read_b128 v[152:155], v67 offset:416
    ds_read_b128 v[156:159], v67 offset:928
    ds_read_b128 v[160:163], v67 offset:1440
    ds_read_b128 v[164:167], v67 offset:1952
    ds_read_b128 v[168:171], v67 offset:2464
    ds_read_b128 v[172:175], v67 offset:2976
    ds_read_b128 v[176:179], v67 offset:3488
    ds_read_b128 v[180:183], v67 offset:4000
    s_waitcnt lgkmcnt(10)
    v_mfma_f32_16x16x32_bf16 v[104:107], v[116:119], v[140:143], v[104:107]
    v_mfma_f32_16x16x32_bf16 v[100:103], v[116:119], v[136:139], v[100:103]
    v_mfma_f32_16x16x32_bf16 v[96:99], v[116:119], v[132:135], v[96:99]
    v_mfma_f32_16x16x32_bf16 v[92:95], v[116:119], v[128:131], v[92:95]
    v_mfma_f32_16x16x32_bf16 v[88:91], v[116:119], v[124:127], v[88:91]
    v_mfma_f32_16x16x32_bf16 v[84:87], v[116:119], v[120:123], v[84:87]
    ds_read_b128 v[116:119], v66 offset:2560
    s_waitcnt lgkmcnt(10)
    v_mfma_f32_16x16x32_bf16 v[104:107], v[108:111], v[136:139], v[104:107]
    v_mfma_f32_16x16x32_bf16 v[100:103], v[108:111], v[132:135], v[100:103]
    v_mfma_f32_16x16x32_bf16 v[96:99], v[108:111], v[128:131], v[96:99]
    v_mfma_f32_16x16x32_bf16 v[92:95], v[108:111], v[124:127], v[92:95]
    v_mfma_f32_16x16x32_bf16 v[88:91], v[108:111], v[120:123], v[88:91]
    ds_read_b128 v[108:111], v66 offset:3072
    s_waitcnt lgkmcnt(10)
    v_mfma_f32_16x16x32_bf16 v[104:107], v[112:115], v[132:135], v[104:107]
    v_mfma_f32_16x16x32_bf16 v[100:103], v[112:115], v[128:131], v[100:103]
    v_mfma_f32_16x16x32_bf16 v[96:99], v[112:115], v[124:127], v[96:99]
    v_mfma_f32_16x16x32_bf16 v[92:95], v[112:115], v[120:123], v[92:95]
    ds_read_b128 v[112:115], v66 offset:3584
    s_waitcnt lgkmcnt(2)
    v_mfma_f32_16x16x32_bf16 v[104:107], v[116:119], v[128:131], v[104:107]
    v_mfma_f32_16x16x32_bf16 v[100:103], v[116:119], v[124:127], v[100:103]
    v_mfma_f32_16x16x32_bf16 v[96:99], v[116:119], v[120:123], v[96:99]
    ds_read_b128 v[116:119], v66 offset:64
    s_waitcnt lgkmcnt(2)
    v_mfma_f32_16x16x32_bf16 v[104:107], v[108:111], v[124:127], v[104:107]
    v_mfma_f32_16x16x32_bf16 v[100:103], v[108:111], v[120:123], v[100:103]
    ds_read_b128 v[108:111], v66 offset:576
    s_waitcnt lgkmcnt(2)
    v_mfma_f32_16x16x32_bf16 v[104:107], v[112:115], v[120:123], v[104:107]
    ds_read_b128 v[112:115], v66 offset:1088
    s_waitcnt lgkmcnt(2)
    v_mfma_f32_16x16x32_bf16 v[104:107], v[116:119], v[180:183], v[104:107]
    v_mfma_f32_16x16x32_bf16 v[100:103], v[116:119], v[176:179], v[100:103]
    v_mfma_f32_16x16x32_bf16 v[96:99], v[116:119], v[172:175], v[96:99]
    v_mfma_f32_16x16x32_bf16 v[92:95], v[116:119], v[168:171], v[92:95]
    v_mfma_f32_16x16x32_bf16 v[88:91], v[116:119], v[164:167], v[88:91]
    v_mfma_f32_16x16x32_bf16 v[84:87], v[116:119], v[160:163], v[84:87]
    v_mfma_f32_16x16x32_bf16 v[80:83], v[116:119], v[156:159], v[80:83]
    v_mfma_f32_16x16x32_bf16 v[76:79], v[116:119], v[152:155], v[76:79]
    ds_read_b128 v[116:119], v66 offset:1600
    s_waitcnt lgkmcnt(2)
    v_mfma_f32_16x16x32_bf16 v[104:107], v[108:111], v[176:179], v[104:107]
    v_mfma_f32_16x16x32_bf16 v[100:103], v[108:111], v[172:175], v[100:103]
    v_mfma_f32_16x16x32_bf16 v[96:99], v[108:111], v[168:171], v[96:99]
    v_mfma_f32_16x16x32_bf16 v[92:95], v[108:111], v[164:167], v[92:95]
    v_mfma_f32_16x16x32_bf16 v[88:91], v[108:111], v[160:163], v[88:91]
    v_mfma_f32_16x16x32_bf16 v[84:87], v[108:111], v[156:159], v[84:87]
    v_mfma_f32_16x16x32_bf16 v[80:83], v[108:111], v[152:155], v[80:83]
    ds_read_b128 v[108:111], v66 offset:2112
    s_waitcnt lgkmcnt(2)
    v_mfma_f32_16x16x32_bf16 v[104:107], v[112:115], v[172:175], v[104:107]
    v_mfma_f32_16x16x32_bf16 v[100:103], v[112:115], v[168:171], v[100:103]
    v_mfma_f32_16x16x32_bf16 v[96:99], v[112:115], v[164:167], v[96:99]
    v_mfma_f32_16x16x32_bf16 v[92:95], v[112:115], v[160:163], v[92:95]
    v_mfma_f32_16x16x32_bf16 v[88:91], v[112:115], v[156:159], v[88:91]
    v_mfma_f32_16x16x32_bf16 v[84:87], v[112:115], v[152:155], v[84:87]
    ds_read_b128 v[112:115], v66 offset:2624
    s_waitcnt lgkmcnt(2)
    v_mfma_f32_16x16x32_bf16 v[104:107], v[116:119], v[168:171], v[104:107]
    v_mfma_f32_16x16x32_bf16 v[100:103], v[116:119], v[164:167], v[100:103]
    v_mfma_f32_16x16x32_bf16 v[96:99], v[116:119], v[160:163], v[96:99]
    v_mfma_f32_16x16x32_bf16 v[92:95], v[116:119], v[156:159], v[92:95]
    v_mfma_f32_16x16x32_bf16 v[88:91], v[116:119], v[152:155], v[88:91]
    ds_read_b128 v[116:119], v66 offset:3136
    s_waitcnt lgkmcnt(2)
    v_mfma_f32_16x16x32_bf16 v[104:107], v[108:111], v[164:167], v[104:107]
    v_mfma_f32_16x16x32_bf16 v[100:103], v[108:111], v[160:163], v[100:103]
    v_mfma_f32_16x16x32_bf16 v[96:99], v[108:111], v[156:159], v[96:99]
    v_mfma_f32_16x16x32_bf16 v[92:95], v[108:111], v[152:155], v[92:95]
    ds_read_b128 v[108:111], v66 offset:3648
    s_waitcnt lgkmcnt(2)
    v_mfma_f32_16x16x32_bf16 v[104:107], v[112:115], v[160:163], v[104:107]
    v_mfma_f32_16x16x32_bf16 v[100:103], v[112:115], v[156:159], v[100:103]
    v_mfma_f32_16x16x32_bf16 v[96:99], v[112:115], v[152:155], v[96:99]
    s_waitcnt lgkmcnt(1)
    v_mfma_f32_16x16x32_bf16 v[104:107], v[116:119], v[156:159], v[104:107]
    v_mfma_f32_16x16x32_bf16 v[100:103], v[116:119], v[152:155], v[100:103]
    s_waitcnt lgkmcnt(0)
    v_mfma_f32_16x16x32_bf16 v[104:107], v[108:111], v[152:155], v[104:107]
    ds_write_b128 v74, v[76:79] offset:0
    ds_write_b128 v74, v[80:83] offset:1024
    ds_write_b128 v74, v[84:87] offset:2048
    ds_write_b128 v74, v[88:91] offset:3072
    ds_write_b128 v74, v[92:95] offset:4096
    ds_write_b128 v74, v[96:99] offset:5120
    ds_write_b128 v74, v[100:103] offset:6144
    s_nop 0
    ds_write_b128 v74, v[104:107] offset:7168
    s_branch c_pw_end_57
c_pw_58:
    s_cmp_lg_u32 s34, 1
    s_cbranch_scc1 c_pw_59
    ds_read_b128 v[108:111], v66 offset:128
    ds_read_b128 v[120:123], v67 offset:352
    ds_read_b128 v[124:127], v67 offset:864
    ds_read_b128 v[128:131], v67 offset:1376
    ds_read_b128 v[132:135], v67 offset:1888
    ds_read_b128 v[136:139], v67 offset:2400
    ds_read_b128 v[140:143], v67 offset:2912
    ds_read_b128 v[144:147], v67 offset:3424
    ds_read_b128 v[148:151], v67 offset:3936
    ds_read_b128 v[112:115], v66 offset:640
    ds_read_b128 v[116:119], v66 offset:1152
    s_waitcnt lgkmcnt(2)
    v_mfma_f32_16x16x32_bf16 v[104:107], v[108:111], v[148:151], 0
    v_mfma_f32_16x16x32_bf16 v[100:103], v[108:111], v[144:147], 0
    v_mfma_f32_16x16x32_bf16 v[96:99], v[108:111], v[140:143], 0
    v_mfma_f32_16x16x32_bf16 v[92:95], v[108:111], v[136:139], 0
    v_mfma_f32_16x16x32_bf16 v[88:91], v[108:111], v[132:135], 0
    v_mfma_f32_16x16x32_bf16 v[84:87], v[108:111], v[128:131], 0
    v_mfma_f32_16x16x32_bf16 v[80:83], v[108:111], v[124:127], 0
    v_mfma_f32_16x16x32_bf16 v[76:79], v[108:111], v[120:123], 0
    ds_read_b128 v[108:111], v66 offset:1664
    s_waitcnt lgkmcnt(2)
    v_mfma_f32_16x16x32_bf16 v[104:107], v[112:115], v[144:147], v[104:107]
    v_mfma_f32_16x16x32_bf16 v[100:103], v[112:115], v[140:143], v[100:103]
    v_mfma_f32_16x16x32_bf16 v[96:99], v[112:115], v[136:139], v[96:99]
    v_mfma_f32_16x16x32_bf16 v[92:95], v[112:115], v[132:135], v[92:95]
    v_mfma_f32_16x16x32_bf16 v[88:91], v[112:115], v[128:131], v[88:91]
    v_mfma_f32_16x16x32_bf16 v[84:87], v[112:115], v[124:127], v[84:87]
    v_mfma_f32_16x16x32_bf16 v[80:83], v[112:115], v[120:123], v[80:83]
    ds_read_b128 v[112:115], v66 offset:2176
    ds_read_b128 v[152:155], v67 offset:288
    ds_read_b128 v[156:159], v67 offset:800
    ds_read_b128 v[160:163], v67 offset:1312
    ds_read_b128 v[164:167], v67 offset:1824
    ds_read_b128 v[168:171], v67 offset:2336
    ds_read_b128 v[172:175], v67 offset:2848
    ds_read_b128 v[176:179], v67 offset:3360
    ds_read_b128 v[180:183], v67 offset:3872
    s_waitcnt lgkmcnt(10)
    v_mfma_f32_16x16x32_bf16 v[104:107], v[116:119], v[140:143], v[104:107]
    v_mfma_f32_16x16x32_bf16 v[100:103], v[116:119], v[136:139], v[100:103]
    v_mfma_f32_16x16x32_bf16 v[96:99], v[116:119], v[132:135], v[96:99]
    v_mfma_f32_16x16x32_bf16 v[92:95], v[116:119], v[128:131], v[92:95]
    v_mfma_f32_16x16x32_bf16 v[88:91], v[116:119], v[124:127], v[88:91]
    v_mfma_f32_16x16x32_bf16 v[84:87], v[116:119], v[120:123], v[84:87]
    ds_read_b128 v[116:119], v66 offset:2688
    s_waitcnt lgkmcnt(10)
    v_mfma_f32_16x16x32_bf16 v[104:107], v[108:111], v[136:139], v[104:107]
    v_mfma_f32_16x16x32_bf16 v[100:103], v[108:111], v[132:135], v[100:103]
    v_mfma_f32_16x16x32_bf16 v[96:99], v[108:111], v[128:131], v[96:99]
    v_mfma_f32_16x16x32_bf16 v[92:95], v[108:111], v[124:127], v[92:95]
    v_mfma_f32_16x16x32_bf16 v[88:91], v[108:111], v[120:123], v[88:91]
    ds_read_b128 v[108:111], v66 offset:3200
    s_waitcnt lgkmcnt(10)
    v_mfma_f32_16x16x32_bf16 v[104:107], v[112:115], v[132:135], v[104:107]
    v_mfma_f32_16x16x32_bf16 v[100:103], v[112:115], v[128:131], v[100:103]
    v_mfma_f32_16x16x32_bf16 v[96:99], v[112:115], v[124:127], v[96:99]
    v_mfma_f32_16x16x32_bf16 v[92:95], v[112:115], v[120:123], v[92:95]
    ds_read_b128 v[112:115], v66 offset:3712
    s_waitcnt lgkmcnt(2)
    v_mfma_f32_16x16x32_bf16 v[104:107], v[116:119], v[128:131], v[104:107]
    v_mfma_f32_16x16x32_bf16 v[100:103], v[116:119], v[124:127], v[100:103]
    v_mfma_f32_16x16x32_bf16 v[96:99], v[116:119], v[120:123], v[96:99]
    ds_read_b128 v[116:119], v66 offset:192
    s_waitcnt lgkmcnt(2)
    v_mfma_f32_16x16x32_bf16 v[104:107], v[108:111], v[124:127], v[104:107]
    v_mfma_f32_16x16x32_bf16 v[100:103], v[108:111], v[120:123], v[100:103]
    ds_read_b128 v[108:111], v66 offset:704
    s_waitcnt lgkmcnt(2)
    v_mfma_f32_16x16x32_bf16 v[104:107], v[112:115], v[120:123], v[104:107]
    ds_read_b128 v[112:115], v66 offset:1216
    s_waitcnt lgkmcnt(2)
    v_mfma_f32_16x16x32_bf16 v[104:107], v[116:119], v[180:183], v[104:107]
    v_mfma_f32_16x16x32_bf16 v[100:103], v[116:119], v[176:179], v[100:103]
    v_mfma_f32_16x16x32_bf16 v[96:99], v[116:119], v[172:175], v[96:99]
    v_mfma_f32_16x16x32_bf16 v[92:95], v[116:119], v[168:171], v[92:95]
    v_mfma_f32_16x16x32_bf16 v[88:91], v[116:119], v[164:167], v[88:91]
    v_mfma_f32_16x16x32_bf16 v[84:87], v[116:119], v[160:163], v[84:87]
    v_mfma_f32_16x16x32_bf16 v[80:83], v[116:119], v[156:159], v[80:83]
    v_mfma_f32_16x16x32_bf16 v[76:79], v[116:119], v[152:155], v[76:79]
    ds_read_b128 v[116:119], v66 offset:1728
    s_waitcnt lgkmcnt(2)
    v_mfma_f32_16x16x32_bf16 v[104:107], v[108:111], v[176:179], v[104:107]
    v_mfma_f32_16x16x32_bf16 v[100:103], v[108:111], v[172:175], v[100:103]
    v_mfma_f32_16x16x32_bf16 v[96:99], v[108:111], v[168:171], v[96:99]
    v_mfma_f32_16x16x32_bf16 v[92:95], v[108:111], v[164:167], v[92:95]
    v_mfma_f32_16x16x32_bf16 v[88:91], v[108:111], v[160:163], v[88:91]
    v_mfma_f32_16x16x32_bf16 v[84:87], v[108:111], v[156:159], v[84:87]
    v_mfma_f32_16x16x32_bf16 v[80:83], v[108:111], v[152:155], v[80:83]
    ds_read_b128 v[108:111], v66 offset:2240
    s_waitcnt lgkmcnt(2)
    v_mfma_f32_16x16x32_bf16 v[104:107], v[112:115], v[172:175], v[104:107]
    v_mfma_f32_16x16x32_bf16 v[100:103], v[112:115], v[168:171], v[100:103]
    v_mfma_f32_16x16x32_bf16 v[96:99], v[112:115], v[164:167], v[96:99]
    v_mfma_f32_16x16x32_bf16 v[92:95], v[112:115], v[160:163], v[92:95]
    v_mfma_f32_16x16x32_bf16 v[88:91], v[112:115], v[156:159], v[88:91]
    v_mfma_f32_16x16x32_bf16 v[84:87], v[112:115], v[152:155], v[84:87]
    ds_read_b128 v[112:115], v66 offset:2752
    s_waitcnt lgkmcnt(2)
    v_mfma_f32_16x16x32_bf16 v[104:107], v[116:119], v[168:171], v[104:107]
    v_mfma_f32_16x16x32_bf16 v[100:103], v[116:119], v[164:167], v[100:103]
    v_mfma_f32_16x16x32_bf16 v[96:99], v[116:119], v[160:163], v[96:99]
    v_mfma_f32_16x16x32_bf16 v[92:95], v[116:119], v[156:159], v[92:95]
    v_mfma_f32_16x16x32_bf16 v[88:91], v[116:119], v[152:155], v[88:91]
    ds_read_b128 v[116:119], v66 offset:3264
    s_waitcnt lgkmcnt(2)
    v_mfma_f32_16x16x32_bf16 v[104:107], v[108:111], v[164:167], v[104:107]
    v_mfma_f32_16x16x32_bf16 v[100:103], v[108:111], v[160:163], v[100:103]
    v_mfma_f32_16x16x32_bf16 v[96:99], v[108:111], v[156:159], v[96:99]
    v_mfma_f32_16x16x32_bf16 v[92:95], v[108:111], v[152:155], v[92:95]
    ds_read_b128 v[108:111], v66 offset:3776
    s_waitcnt lgkmcnt(2)
    v_mfma_f32_16x16x32_bf16 v[104:107], v[112:115], v[160:163], v[104:107]
    v_mfma_f32_16x16x32_bf16 v[100:103], v[112:115], v[156:159], v[100:103]
    v_mfma_f32_16x16x32_bf16 v[96:99], v[112:115], v[152:155], v[96:99]
    s_waitcnt lgkmcnt(1)
    v_mfma_f32_16x16x32_bf16 v[104:107], v[116:119], v[156:159], v[104:107]
    v_mfma_f32_16x16x32_bf16 v[100:103], v[116:119], v[152:155], v[100:103]
    s_waitcnt lgkmcnt(0)
    v_mfma_f32_16x16x32_bf16 v[104:107], v[108:111], v[152:155], v[104:107]
    ds_write_b128 v74, v[76:79] offset:0
    ds_write_b128 v74, v[80:83] offset:1024
    ds_write_b128 v74, v[84:87] offset:2048
    ds_write_b128 v74, v[88:91] offset:3072
    ds_write_b128 v74, v[92:95] offset:4096
    ds_write_b128 v74, v[96:99] offset:5120
    ds_write_b128 v74, v[100:103] offset:6144
    s_nop 0
    ds_write_b128 v74, v[104:107] offset:7168
    s_branch c_pw_end_57
c_pw_59:
    s_cmp_lg_u32 s34, 2
    s_cbranch_scc1 c_pw_60
    ds_read_b128 v[108:111], v66 offset:256
    ds_read_b128 v[120:123], v67 offset:224
    ds_read_b128 v[124:127], v67 offset:736
    ds_read_b128 v[128:131], v67 offset:1248
    ds_read_b128 v[132:135], v67 offset:1760
    ds_read_b128 v[136:139], v67 offset:2272
    ds_read_b128 v[140:143], v67 offset:2784
    ds_read_b128 v[144:147], v67 offset:3296
    ds_read_b128 v[148:151], v67 offset:3808
    ds_read_b128 v[112:115], v66 offset:768
    ds_read_b128 v[116:119], v66 offset:1280
    s_waitcnt lgkmcnt(2)
    v_mfma_f32_16x16x32_bf16 v[104:107], v[108:111], v[148:151], 0
    v_mfma_f32_16x16x32_bf16 v[100:103], v[108:111], v[144:147], 0
    v_mfma_f32_16x16x32_bf16 v[96:99], v[108:111], v[140:143], 0
    v_mfma_f32_16x16x32_bf16 v[92:95], v[108:111], v[136:139], 0
    v_mfma_f32_16x16x32_bf16 v[88:91], v[108:111], v[132:135], 0
    v_mfma_f32_16x16x32_bf16 v[84:87], v[108:111], v[128:131], 0
    v_mfma_f32_16x16x32_bf16 v[80:83], v[108:111], v[124:127], 0
    v_mfma_f32_16x16x32_bf16 v[76:79], v[108:111], v[120:123], 0
    ds_read_b128 v[108:111], v66 offset:1792
    s_waitcnt lgkmcnt(2)
    v_mfma_f32_16x16x32_bf16 v[104:107], v[112:115], v[144:147], v[104:107]
    v_mfma_f32_16x16x32_bf16 v[100:103], v[112:115], v[140:143], v[100:103]
    v_mfma_f32_16x16x32_bf16 v[96:99], v[112:115], v[136:139], v[96:99]
    v_mfma_f32_16x16x32_bf16 v[92:95], v[112:115], v[132:135], v[92:95]
    v_mfma_f32_16x16x32_bf16 v[88:91], v[112:115], v[128:131], v[88:91]
    v_mfma_f32_16x16x32_bf16 v[84:87], v[112:115], v[124:127], v[84:87]
    v_mfma_f32_16x16x32_bf16 v[80:83], v[112:115], v[120:123], v[80:83]
    ds_read_b128 v[112:115], v66 offset:2304
    ds_read_b128 v[152:155], v67 offset:160
    ds_read_b128 v[156:159], v67 offset:672
    ds_read_b128 v[160:163], v67 offset:1184
    ds_read_b128 v[164:167], v67 offset:1696
    ds_read_b128 v[168:171], v67 offset:2208
    ds_read_b128 v[172:175], v67 offset:2720
    ds_read_b128 v[176:179], v67 offset:3232
    ds_read_b128 v[180:183], v67 offset:3744
    s_waitcnt lgkmcnt(10)
    v_mfma_f32_16x16x32_bf16 v[104:107], v[116:119], v[140:143], v[104:107]
    v_mfma_f32_16x16x32_bf16 v[100:103], v[116:119], v[136:139], v[100:103]
    v_mfma_f32_16x16x32_bf16 v[96:99], v[116:119], v[132:135], v[96:99]
    v_mfma_f32_16x16x32_bf16 v[92:95], v[116:119], v[128:131], v[92:95]
    v_mfma_f32_16x16x32_bf16 v[88:91], v[116:119], v[124:127], v[88:91]
    v_mfma_f32_16x16x32_bf16 v[84:87], v[116:119], v[120:123], v[84:87]
    ds_read_b128 v[116:119], v66 offset:2816
    s_waitcnt lgkmcnt(10)
    v_mfma_f32_16x16x32_bf16 v[104:107], v[108:111], v[136:139], v[104:107]
    v_mfma_f32_16x16x32_bf16 v[100:103], v[108:111], v[132:135], v[100:103]
    v_mfma_f32_16x16x32_bf16 v[96:99], v[108:111], v[128:131], v[96:99]
    v_mfma_f32_16x16x32_bf16 v[92:95], v[108:111], v[124:127], v[92:95]
    v_mfma_f32_16x16x32_bf16 v[88:91], v[108:111], v[120:123], v[88:91]
    ds_read_b128 v[108:111], v66 offset:3328
    s_waitcnt lgkmcnt(10)
    v_mfma_f32_16x16x32_bf16 v[104:107], v[112:115], v[132:135], v[104:107]
    v_mfma_f32_16x16x32_bf16 v[100:103], v[112:115], v[128:131], v[100:103]
    v_mfma_f32_16x16x32_bf16 v[96:99], v[112:115], v[124:127], v[96:99]
    v_mfma_f32_16x16x32_bf16 v[92:95], v[112:115], v[120:123], v[92:95]
    ds_read_b128 v[112:115], v66 offset:3840
    s_waitcnt lgkmcnt(2)
    v_mfma_f32_16x16x32_bf16 v[104:107], v[116:119], v[128:131], v[104:107]
    v_mfma_f32_16x16x32_bf16 v[100:103], v[116:119], v[124:127], v[100:103]
    v_mfma_f32_16x16x32_bf16 v[96:99], v[116:119], v[120:123], v[96:99]
    ds_read_b128 v[116:119], v66 offset:320
    s_waitcnt lgkmcnt(2)
    v_mfma_f32_16x16x32_bf16 v[104:107], v[108:111], v[124:127], v[104:107]
    v_mfma_f32_16x16x32_bf16 v[100:103], v[108:111], v[120:123], v[100:103]
    ds_read_b128 v[108:111], v66 offset:832
    s_waitcnt lgkmcnt(2)
    v_mfma_f32_16x16x32_bf16 v[104:107], v[112:115], v[120:123], v[104:107]
    ds_read_b128 v[112:115], v66 offset:1344
    s_waitcnt lgkmcnt(2)
    v_mfma_f32_16x16x32_bf16 v[104:107], v[116:119], v[180:183], v[104:107]
    v_mfma_f32_16x16x32_bf16 v[100:103], v[116:119], v[176:179], v[100:103]
    v_mfma_f32_16x16x32_bf16 v[96:99], v[116:119], v[172:175], v[96:99]
    v_mfma_f32_16x16x32_bf16 v[92:95], v[116:119], v[168:171], v[92:95]
    v_mfma_f32_16x16x32_bf16 v[88:91], v[116:119], v[164:167], v[88:91]
    v_mfma_f32_16x16x32_bf16 v[84:87], v[116:119], v[160:163], v[84:87]
    v_mfma_f32_16x16x32_bf16 v[80:83], v[116:119], v[156:159], v[80:83]
    v_mfma_f32_16x16x32_bf16 v[76:79], v[116:119], v[152:155], v[76:79]
    ds_read_b128 v[116:119], v66 offset:1856
    s_waitcnt lgkmcnt(2)
    v_mfma_f32_16x16x32_bf16 v[104:107], v[108:111], v[176:179], v[104:107]
    v_mfma_f32_16x16x32_bf16 v[100:103], v[108:111], v[172:175], v[100:103]
    v_mfma_f32_16x16x32_bf16 v[96:99], v[108:111], v[168:171], v[96:99]
    v_mfma_f32_16x16x32_bf16 v[92:95], v[108:111], v[164:167], v[92:95]
    v_mfma_f32_16x16x32_bf16 v[88:91], v[108:111], v[160:163], v[88:91]
    v_mfma_f32_16x16x32_bf16 v[84:87], v[108:111], v[156:159], v[84:87]
    v_mfma_f32_16x16x32_bf16 v[80:83], v[108:111], v[152:155], v[80:83]
    ds_read_b128 v[108:111], v66 offset:2368
    s_waitcnt lgkmcnt(2)
    v_mfma_f32_16x16x32_bf16 v[104:107], v[112:115], v[172:175], v[104:107]
    v_mfma_f32_16x16x32_bf16 v[100:103], v[112:115], v[168:171], v[100:103]
    v_mfma_f32_16x16x32_bf16 v[96:99], v[112:115], v[164:167], v[96:99]
    v_mfma_f32_16x16x32_bf16 v[92:95], v[112:115], v[160:163], v[92:95]
    v_mfma_f32_16x16x32_bf16 v[88:91], v[112:115], v[156:159], v[88:91]
    v_mfma_f32_16x16x32_bf16 v[84:87], v[112:115], v[152:155], v[84:87]
    ds_read_b128 v[112:115], v66 offset:2880
    s_waitcnt lgkmcnt(2)
    v_mfma_f32_16x16x32_bf16 v[104:107], v[116:119], v[168:171], v[104:107]
    v_mfma_f32_16x16x32_bf16 v[100:103], v[116:119], v[164:167], v[100:103]
    v_mfma_f32_16x16x32_bf16 v[96:99], v[116:119], v[160:163], v[96:99]
    v_mfma_f32_16x16x32_bf16 v[92:95], v[116:119], v[156:159], v[92:95]
    v_mfma_f32_16x16x32_bf16 v[88:91], v[116:119], v[152:155], v[88:91]
    ds_read_b128 v[116:119], v66 offset:3392
    s_waitcnt lgkmcnt(2)
    v_mfma_f32_16x16x32_bf16 v[104:107], v[108:111], v[164:167], v[104:107]
    v_mfma_f32_16x16x32_bf16 v[100:103], v[108:111], v[160:163], v[100:103]
    v_mfma_f32_16x16x32_bf16 v[96:99], v[108:111], v[156:159], v[96:99]
    v_mfma_f32_16x16x32_bf16 v[92:95], v[108:111], v[152:155], v[92:95]
    ds_read_b128 v[108:111], v66 offset:3904
    s_waitcnt lgkmcnt(2)
    v_mfma_f32_16x16x32_bf16 v[104:107], v[112:115], v[160:163], v[104:107]
    v_mfma_f32_16x16x32_bf16 v[100:103], v[112:115], v[156:159], v[100:103]
    v_mfma_f32_16x16x32_bf16 v[96:99], v[112:115], v[152:155], v[96:99]
    s_waitcnt lgkmcnt(1)
    v_mfma_f32_16x16x32_bf16 v[104:107], v[116:119], v[156:159], v[104:107]
    v_mfma_f32_16x16x32_bf16 v[100:103], v[116:119], v[152:155], v[100:103]
    s_waitcnt lgkmcnt(0)
    v_mfma_f32_16x16x32_bf16 v[104:107], v[108:111], v[152:155], v[104:107]
    ds_write_b128 v74, v[76:79] offset:0
    ds_write_b128 v74, v[80:83] offset:1024
    ds_write_b128 v74, v[84:87] offset:2048
    ds_write_b128 v74, v[88:91] offset:3072
    ds_write_b128 v74, v[92:95] offset:4096
    ds_write_b128 v74, v[96:99] offset:5120
    ds_write_b128 v74, v[100:103] offset:6144
    s_nop 0
    ds_write_b128 v74, v[104:107] offset:7168
    s_branch c_pw_end_57
c_pw_60:
    ds_read_b128 v[108:111], v66 offset:384
    ds_read_b128 v[120:123], v67 offset:96
    ds_read_b128 v[124:127], v67 offset:608
    ds_read_b128 v[128:131], v67 offset:1120
    ds_read_b128 v[132:135], v67 offset:1632
    ds_read_b128 v[136:139], v67 offset:2144
    ds_read_b128 v[140:143], v67 offset:2656
    ds_read_b128 v[144:147], v67 offset:3168
    ds_read_b128 v[148:151], v67 offset:3680
    ds_read_b128 v[112:115], v66 offset:896
    ds_read_b128 v[116:119], v66 offset:1408
    s_waitcnt lgkmcnt(2)
    v_mfma_f32_16x16x32_bf16 v[104:107], v[108:111], v[148:151], 0
    v_mfma_f32_16x16x32_bf16 v[100:103], v[108:111], v[144:147], 0
    v_mfma_f32_16x16x32_bf16 v[96:99], v[108:111], v[140:143], 0
    v_mfma_f32_16x16x32_bf16 v[92:95], v[108:111], v[136:139], 0
    v_mfma_f32_16x16x32_bf16 v[88:91], v[108:111], v[132:135], 0
    v_mfma_f32_16x16x32_bf16 v[84:87], v[108:111], v[128:131], 0
    v_mfma_f32_16x16x32_bf16 v[80:83], v[108:111], v[124:127], 0
    v_mfma_f32_16x16x32_bf16 v[76:79], v[108:111], v[120:123], 0
    ds_read_b128 v[108:111], v66 offset:1920
    s_waitcnt lgkmcnt(2)
    v_mfma_f32_16x16x32_bf16 v[104:107], v[112:115], v[144:147], v[104:107]
    v_mfma_f32_16x16x32_bf16 v[100:103], v[112:115], v[140:143], v[100:103]
    v_mfma_f32_16x16x32_bf16 v[96:99], v[112:115], v[136:139], v[96:99]
    v_mfma_f32_16x16x32_bf16 v[92:95], v[112:115], v[132:135], v[92:95]
    v_mfma_f32_16x16x32_bf16 v[88:91], v[112:115], v[128:131], v[88:91]
    v_mfma_f32_16x16x32_bf16 v[84:87], v[112:115], v[124:127], v[84:87]
    v_mfma_f32_16x16x32_bf16 v[80:83], v[112:115], v[120:123], v[80:83]
    ds_read_b128 v[112:115], v66 offset:2432
    ds_read_b128 v[152:155], v67 offset:32
    ds_read_b128 v[156:159], v67 offset:544
    ds_read_b128 v[160:163], v67 offset:1056
    ds_read_b128 v[164:167], v67 offset:1568
    ds_read_b128 v[168:171], v67 offset:2080
    ds_read_b128 v[172:175], v67 offset:2592
    ds_read_b128 v[176:179], v67 offset:3104
    ds_read_b128 v[180:183], v67 offset:3616
    s_waitcnt lgkmcnt(10)
    v_mfma_f32_16x16x32_bf16 v[104:107], v[116:119], v[140:143], v[104:107]
    v_mfma_f32_16x16x32_bf16 v[100:103], v[116:119], v[136:139], v[100:103]
    v_mfma_f32_16x16x32_bf16 v[96:99], v[116:119], v[132:135], v[96:99]
    v_mfma_f32_16x16x32_bf16 v[92:95], v[116:119], v[128:131], v[92:95]
    v_mfma_f32_16x16x32_bf16 v[88:91], v[116:119], v[124:127], v[88:91]
    v_mfma_f32_16x16x32_bf16 v[84:87], v[116:119], v[120:123], v[84:87]
    ds_read_b128 v[116:119], v66 offset:2944
    s_waitcnt lgkmcnt(10)
    v_mfma_f32_16x16x32_bf16 v[104:107], v[108:111], v[136:139], v[104:107]
    v_mfma_f32_16x16x32_bf16 v[100:103], v[108:111], v[132:135], v[100:103]
    v_mfma_f32_16x16x32_bf16 v[96:99], v[108:111], v[128:131], v[96:99]
    v_mfma_f32_16x16x32_bf16 v[92:95], v[108:111], v[124:127], v[92:95]
    v_mfma_f32_16x16x32_bf16 v[88:91], v[108:111], v[120:123], v[88:91]
    ds_read_b128 v[108:111], v66 offset:3456
    s_waitcnt lgkmcnt(10)
    v_mfma_f32_16x16x32_bf16 v[104:107], v[112:115], v[132:135], v[104:107]
    v_mfma_f32_16x16x32_bf16 v[100:103], v[112:115], v[128:131], v[100:103]
    v_mfma_f32_16x16x32_bf16 v[96:99], v[112:115], v[124:127], v[96:99]
    v_mfma_f32_16x16x32_bf16 v[92:95], v[112:115], v[120:123], v[92:95]
    ds_read_b128 v[112:115], v66 offset:3968
    s_waitcnt lgkmcnt(2)
    v_mfma_f32_16x16x32_bf16 v[104:107], v[116:119], v[128:131], v[104:107]
    v_mfma_f32_16x16x32_bf16 v[100:103], v[116:119], v[124:127], v[100:103]
    v_mfma_f32_16x16x32_bf16 v[96:99], v[116:119], v[120:123], v[96:99]
    ds_read_b128 v[116:119], v66 offset:448
    s_waitcnt lgkmcnt(2)
    v_mfma_f32_16x16x32_bf16 v[104:107], v[108:111], v[124:127], v[104:107]
    v_mfma_f32_16x16x32_bf16 v[100:103], v[108:111], v[120:123], v[100:103]
    ds_read_b128 v[108:111], v66 offset:960
    s_waitcnt lgkmcnt(2)
    v_mfma_f32_16x16x32_bf16 v[104:107], v[112:115], v[120:123], v[104:107]
    ds_read_b128 v[112:115], v66 offset:1472
    s_waitcnt lgkmcnt(2)
    v_mfma_f32_16x16x32_bf16 v[104:107], v[116:119], v[180:183], v[104:107]
    v_mfma_f32_16x16x32_bf16 v[100:103], v[116:119], v[176:179], v[100:103]
    v_mfma_f32_16x16x32_bf16 v[96:99], v[116:119], v[172:175], v[96:99]
    v_mfma_f32_16x16x32_bf16 v[92:95], v[116:119], v[168:171], v[92:95]
    v_mfma_f32_16x16x32_bf16 v[88:91], v[116:119], v[164:167], v[88:91]
    v_mfma_f32_16x16x32_bf16 v[84:87], v[116:119], v[160:163], v[84:87]
    v_mfma_f32_16x16x32_bf16 v[80:83], v[116:119], v[156:159], v[80:83]
    v_mfma_f32_16x16x32_bf16 v[76:79], v[116:119], v[152:155], v[76:79]
    ds_read_b128 v[116:119], v66 offset:1984
    s_waitcnt lgkmcnt(2)
    v_mfma_f32_16x16x32_bf16 v[104:107], v[108:111], v[176:179], v[104:107]
    v_mfma_f32_16x16x32_bf16 v[100:103], v[108:111], v[172:175], v[100:103]
    v_mfma_f32_16x16x32_bf16 v[96:99], v[108:111], v[168:171], v[96:99]
    v_mfma_f32_16x16x32_bf16 v[92:95], v[108:111], v[164:167], v[92:95]
    v_mfma_f32_16x16x32_bf16 v[88:91], v[108:111], v[160:163], v[88:91]
    v_mfma_f32_16x16x32_bf16 v[84:87], v[108:111], v[156:159], v[84:87]
    v_mfma_f32_16x16x32_bf16 v[80:83], v[108:111], v[152:155], v[80:83]
    ds_read_b128 v[108:111], v66 offset:2496
    s_waitcnt lgkmcnt(2)
    v_mfma_f32_16x16x32_bf16 v[104:107], v[112:115], v[172:175], v[104:107]
    v_mfma_f32_16x16x32_bf16 v[100:103], v[112:115], v[168:171], v[100:103]
    v_mfma_f32_16x16x32_bf16 v[96:99], v[112:115], v[164:167], v[96:99]
    v_mfma_f32_16x16x32_bf16 v[92:95], v[112:115], v[160:163], v[92:95]
    v_mfma_f32_16x16x32_bf16 v[88:91], v[112:115], v[156:159], v[88:91]
    v_mfma_f32_16x16x32_bf16 v[84:87], v[112:115], v[152:155], v[84:87]
    ds_read_b128 v[112:115], v66 offset:3008
    s_waitcnt lgkmcnt(2)
    v_mfma_f32_16x16x32_bf16 v[104:107], v[116:119], v[168:171], v[104:107]
    v_mfma_f32_16x16x32_bf16 v[100:103], v[116:119], v[164:167], v[100:103]
    v_mfma_f32_16x16x32_bf16 v[96:99], v[116:119], v[160:163], v[96:99]
    v_mfma_f32_16x16x32_bf16 v[92:95], v[116:119], v[156:159], v[92:95]
    v_mfma_f32_16x16x32_bf16 v[88:91], v[116:119], v[152:155], v[88:91]
    ds_read_b128 v[116:119], v66 offset:3520
    s_waitcnt lgkmcnt(2)
    v_mfma_f32_16x16x32_bf16 v[104:107], v[108:111], v[164:167], v[104:107]
    v_mfma_f32_16x16x32_bf16 v[100:103], v[108:111], v[160:163], v[100:103]
    v_mfma_f32_16x16x32_bf16 v[96:99], v[108:111], v[156:159], v[96:99]
    v_mfma_f32_16x16x32_bf16 v[92:95], v[108:111], v[152:155], v[92:95]
    ds_read_b128 v[108:111], v66 offset:4032
    s_waitcnt lgkmcnt(2)
    v_mfma_f32_16x16x32_bf16 v[104:107], v[112:115], v[160:163], v[104:107]
    v_mfma_f32_16x16x32_bf16 v[100:103], v[112:115], v[156:159], v[100:103]
    v_mfma_f32_16x16x32_bf16 v[96:99], v[112:115], v[152:155], v[96:99]
    s_waitcnt lgkmcnt(1)
    v_mfma_f32_16x16x32_bf16 v[104:107], v[116:119], v[156:159], v[104:107]
    v_mfma_f32_16x16x32_bf16 v[100:103], v[116:119], v[152:155], v[100:103]
    s_waitcnt lgkmcnt(0)
    v_mfma_f32_16x16x32_bf16 v[104:107], v[108:111], v[152:155], v[104:107]
    ds_write_b128 v74, v[76:79] offset:0
    ds_write_b128 v74, v[80:83] offset:1024
    ds_write_b128 v74, v[84:87] offset:2048
    ds_write_b128 v74, v[88:91] offset:3072
    ds_write_b128 v74, v[92:95] offset:4096
    ds_write_b128 v74, v[96:99] offset:5120
    ds_write_b128 v74, v[100:103] offset:6144
    s_nop 0
    ds_write_b128 v74, v[104:107] offset:7168
c_pw_end_57:
    s_waitcnt vmcnt(0)
    s_waitcnt lgkmcnt(0)
    v_mov_b32 v3, 161796
    v_mov_b32 v4, 1
    s_mov_b64 exec, 1
    ds_add_u32 v3, v4
    s_mov_b64 exec, -1
    s_mov_b32 s67, 0
gsync_62:
    ds_read_b32 v4, v3
    s_add_u32 s67, s67, 1
    s_waitcnt lgkmcnt(0)
    v_readfirstlane_b32 s66, v4
    s_cmp_gt_u32 s67, 1000000
    s_cbranch_scc1 gsync_e_63
    s_cmp_lt_u32 s66, 16
    s_cbranch_scc1 gsync_62
gsync_e_63:
    s_lshl_b32 s40, s2, 3
    s_add_u32 s40, s40, 14725120
    v_mov_b32 v48, s100
    v_mov_b32 v49, s101
    v_mov_b32 v3, 0
    s_cmp_eq_u32 s34, 0
    s_cselect_b64 exec, 1, 0
    s_cmp_lt_u32 s2, 192
    s_cselect_b64 exec, exec, 0
    buffer_store_dwordx2 v[48:49], v3, s[8:11], s40 offen sc1
    s_mov_b64 exec, -1
    ds_read_b128 v[120:123], v75 offset:0
    ds_read_b128 v[124:127], v75 offset:16
    ds_read_b128 v[128:131], v75 offset:8192
    ds_read_b128 v[132:135], v75 offset:8208
    ds_read_b128 v[136:139], v75 offset:16384
    ds_read_b128 v[140:143], v75 offset:16400
    ds_read_b128 v[144:147], v75 offset:24576
    ds_read_b128 v[148:151], v75 offset:24592
    s_lshl_b32 s40, s57, 12
    s_add_u32 s40, s40, 8912896
    s_waitcnt lgkmcnt(0)
    v_pk_add_f32 v[120:121], v[120:121], v[128:129]
    v_pk_add_f32 v[136:137], v[136:137], v[144:145]
    v_pk_add_f32 v[122:123], v[122:123], v[130:131]
    v_pk_add_f32 v[138:139], v[138:139], v[146:147]
    v_pk_add_f32 v[124:125], v[124:125], v[132:133]
    v_pk_add_f32 v[140:141], v[140:141], v[148:149]
    v_pk_add_f32 v[126:127], v[126:127], v[134:135]
    v_pk_add_f32 v[142:143], v[142:143], v[150:151]
    v_pk_add_f32 v[120:121], v[120:121], v[136:137]
    v_pk_add_f32 v[122:123], v[122:123], v[138:139]
    v_pk_add_f32 v[124:125], v[124:125], v[140:141]
    v_pk_add_f32 v[126:127], v[126:127], v[142:143]
    v_cvt_pk_bf16_f32 v192, v120, v121
    v_cvt_pk_bf16_f32 v193, v122, v123
    v_cvt_pk_bf16_f32 v194, v124, v125
    v_cvt_pk_bf16_f32 v195, v126, v127
    buffer_store_dwordx4 v[192:195], v2, s[8:11], s40 offen sc1
    s_nop 1
    s_waitcnt vmcnt(0)
    v_cmp_ne_u32 vcc, 0, v0
    s_nop 1
    v_cndmask_b32 v24, 0, v24, vcc
    v_cndmask_b32 v25, 0, v25, vcc
    v_cndmask_b32 v26, 0, v26, vcc
    v_cndmask_b32 v27, 0, v27, vcc
    v_alignbit_b32 v184, v25, v24, 16
    v_alignbit_b32 v185, v26, v25, 16
    v_alignbit_b32 v186, v27, v26, 16
    v_alignbit_b32 v187, v28, v27, 16
    v_alignbit_b32 v188, v29, v28, 16
    v_alignbit_b32 v189, v30, v29, 16
    v_alignbit_b32 v190, v31, v30, 16
    ds_write_b128 v64, v[184:187] offset:0
    v_mov_b32 v192, v25
    v_mov_b32 v193, v26
    v_mov_b32 v194, v27
    v_mov_b32 v195, v28
    ds_write_b128 v64, v[192:195] offset:4160
    s_nop 1
    v_mov_b32 v192, v185
    v_mov_b32 v193, v186
    v_mov_b32 v194, v187
    v_mov_b32 v195, v188
    ds_write_b128 v64, v[192:195] offset:8320
    s_nop 1
    ds_write_b128 v64, v[26:29] offset:12480
    ds_write_b128 v64, v[186:189] offset:16640
    v_mov_b32 v192, v27
    v_mov_b32 v193, v28
    v_mov_b32 v194, v29
    v_mov_b32 v195, v30
    ds_write_b128 v64, v[192:195] offset:20800
    s_nop 1
    v_mov_b32 v192, v187
    v_mov_b32 v193, v188
    v_mov_b32 v194, v189
    v_mov_b32 v195, v190
    ds_write_b128 v64, v[192:195] offset:24960
    s_nop 1
    ds_write_b128 v64, v[28:31] offset:29120
    ds_write_b128 v65, v[40:43]
    v_lshlrev_b32 v3, 16, v46
    v_or_b32 v3, v3, v46
    v_and_b32 v196, v68, v3
    v_and_b32 v197, v69, v3
    v_and_b32 v198, v70, v3
    v_and_b32 v199, v71, v3
    s_waitcnt lgkmcnt(0)
    v_mov_b32 v3, 161796
    v_mov_b32 v4, 1
    s_mov_b64 exec, 1
    ds_add_u32 v3, v4
    s_mov_b64 exec, -1
    s_mov_b32 s67, 0
gsync_64:
    ds_read_b32 v4, v3
    s_add_u32 s67, s67, 1
    s_waitcnt lgkmcnt(0)
    v_readfirstlane_b32 s66, v4
    s_cmp_gt_u32 s67, 1000000
    s_cbranch_scc1 gsync_e_65
    s_cmp_lt_u32 s66, 20
    s_cbranch_scc1 gsync_64
gsync_e_65:
    s_bitcmp1_b32 s2, 0
    s_cbranch_scc1 c_halfB_66
    s_cmp_lg_u32 s34, 0
    s_cbranch_scc1 c_pw_69
    ds_read_b128 v[108:111], v66 offset:0
    ds_read_b128 v[120:123], v67 offset:480
    ds_read_b128 v[124:127], v67 offset:992
    ds_read_b128 v[128:131], v67 offset:1504
    ds_read_b128 v[132:135], v67 offset:2016
    ds_read_b128 v[136:139], v67 offset:2528
    ds_read_b128 v[140:143], v67 offset:3040
    ds_read_b128 v[144:147], v67 offset:3552
    ds_read_b128 v[148:151], v67 offset:4064
    ds_read_b128 v[112:115], v66 offset:512
    ds_read_b128 v[116:119], v66 offset:1024
    s_waitcnt lgkmcnt(2)
    v_mfma_f32_16x16x32_bf16 v[104:107], v[108:111], v[148:151], 0
    v_mfma_f32_16x16x32_bf16 v[100:103], v[108:111], v[144:147], 0
    v_mfma_f32_16x16x32_bf16 v[84:87], v[108:111], v[128:131], 0
    v_mfma_f32_16x16x32_bf16 v[84:87], v[196:199], v[128:131], v[84:87]
    v_mfma_f32_16x16x32_bf16 v[100:103], v[196:199], v[144:147], v[100:103]
    v_mfma_f32_16x16x32_bf16 v[104:107], v[196:199], v[148:151], v[104:107]
    ds_read_b128 v[108:111], v66 offset:1536
    s_waitcnt lgkmcnt(2)
    v_mfma_f32_16x16x32_bf16 v[104:107], v[112:115], v[144:147], v[104:107]
    v_mfma_f32_16x16x32_bf16 v[100:103], v[112:115], v[140:143], v[100:103]
    v_mfma_f32_16x16x32_bf16 v[84:87], v[112:115], v[124:127], v[84:87]
    ds_read_b128 v[112:115], v66 offset:2048
    ds_read_b128 v[152:155], v67 offset:416
    ds_read_b128 v[156:159], v67 offset:928
    ds_read_b128 v[160:163], v67 offset:1440
    ds_read_b128 v[164:167], v67 offset:1952
    ds_read_b128 v[168:171], v67 offset:2464
    ds_read_b128 v[172:175], v67 offset:2976
    ds_read_b128 v[176:179], v67 offset:3488
    ds_read_b128 v[180:183], v67 offset:4000
    s_waitcnt lgkmcnt(10)
    v_mfma_f32_16x16x32_bf16 v[104:107], v[116:119], v[140:143], v[104:107]
    v_mfma_f32_16x16x32_bf16 v[100:103], v[116:119], v[136:139], v[100:103]
    v_mfma_f32_16x16x32_bf16 v[84:87], v[116:119], v[120:123], v[84:87]
    ds_read_b128 v[116:119], v66 offset:2560
    s_waitcnt lgkmcnt(10)
    v_mfma_f32_16x16x32_bf16 v[104:107], v[108:111], v[136:139], v[104:107]
    v_mfma_f32_16x16x32_bf16 v[100:103], v[108:111], v[132:135], v[100:103]
    ds_read_b128 v[108:111], v66 offset:3072
    s_waitcnt lgkmcnt(10)
    v_mfma_f32_16x16x32_bf16 v[104:107], v[112:115], v[132:135], v[104:107]
    v_mfma_f32_16x16x32_bf16 v[100:103], v[112:115], v[128:131], v[100:103]
    ds_read_b128 v[112:115], v66 offset:3584
    s_waitcnt lgkmcnt(2)
    v_mfma_f32_16x16x32_bf16 v[104:107], v[116:119], v[128:131], v[104:107]
    v_mfma_f32_16x16x32_bf16 v[100:103], v[116:119], v[124:127], v[100:103]
    ds_read_b128 v[116:119], v66 offset:64
    s_waitcnt lgkmcnt(2)
    v_mfma_f32_16x16x32_bf16 v[104:107], v[108:111], v[124:127], v[104:107]
    v_mfma_f32_16x16x32_bf16 v[100:103], v[108:111], v[120:123], v[100:103]
    ds_read_b128 v[108:111], v66 offset:576
    s_waitcnt lgkmcnt(2)
    v_mfma_f32_16x16x32_bf16 v[104:107], v[112:115], v[120:123], v[104:107]
    ds_read_b128 v[112:115], v66 offset:1088
    s_waitcnt lgkmcnt(2)
    v_mfma_f32_16x16x32_bf16 v[104:107], v[116:119], v[180:183], v[104:107]
    v_mfma_f32_16x16x32_bf16 v[100:103], v[116:119], v[176:179], v[100:103]
    v_mfma_f32_16x16x32_bf16 v[84:87], v[116:119], v[160:163], v[84:87]
    ds_read_b128 v[116:119], v66 offset:1600
    s_waitcnt lgkmcnt(2)
    v_mfma_f32_16x16x32_bf16 v[104:107], v[108:111], v[176:179], v[104:107]
    v_mfma_f32_16x16x32_bf16 v[100:103], v[108:111], v[172:175], v[100:103]
    v_mfma_f32_16x16x32_bf16 v[84:87], v[108:111], v[156:159], v[84:87]
    ds_read_b128 v[108:111], v66 offset:2112
    s_waitcnt lgkmcnt(2)
    v_mfma_f32_16x16x32_bf16 v[104:107], v[112:115], v[172:175], v[104:107]
    v_mfma_f32_16x16x32_bf16 v[100:103], v[112:115], v[168:171], v[100:103]
    v_mfma_f32_16x16x32_bf16 v[84:87], v[112:115], v[152:155], v[84:87]
    ds_read_b128 v[112:115], v66 offset:2624
    s_waitcnt lgkmcnt(2)
    v_mfma_f32_16x16x32_bf16 v[104:107], v[116:119], v[168:171], v[104:107]
    v_mfma_f32_16x16x32_bf16 v[100:103], v[116:119], v[164:167], v[100:103]
    ds_read_b128 v[116:119], v66 offset:3136
    s_waitcnt lgkmcnt(2)
    v_mfma_f32_16x16x32_bf16 v[104:107], v[108:111], v[164:167], v[104:107]
    v_mfma_f32_16x16x32_bf16 v[100:103], v[108:111], v[160:163], v[100:103]
    ds_read_b128 v[108:111], v66 offset:3648
    s_waitcnt lgkmcnt(2)
    v_mfma_f32_16x16x32_bf16 v[104:107], v[112:115], v[160:163], v[104:107]
    v_mfma_f32_16x16x32_bf16 v[100:103], v[112:115], v[156:159], v[100:103]
    s_waitcnt lgkmcnt(1)
    v_mfma_f32_16x16x32_bf16 v[104:107], v[116:119], v[156:159], v[104:107]
    v_mfma_f32_16x16x32_bf16 v[100:103], v[116:119], v[152:155], v[100:103]
    s_waitcnt lgkmcnt(0)
    v_mfma_f32_16x16x32_bf16 v[104:107], v[108:111], v[152:155], v[104:107]
    ds_write_b128 v74, v[84:87] offset:2048
    s_nop 4
    ds_write_b128 v74, v[100:103] offset:6144
    s_nop 0
    ds_write_b128 v74, v[104:107] offset:7168
    s_branch c_pw_end_68
c_pw_69:
    s_cmp_lg_u32 s34, 1
    s_cbranch_scc1 c_pw_70
    ds_read_b128 v[108:111], v66 offset:128
    ds_read_b128 v[120:123], v67 offset:352
    ds_read_b128 v[124:127], v67 offset:864
    ds_read_b128 v[128:131], v67 offset:1376
    ds_read_b128 v[132:135], v67 offset:1888
    ds_read_b128 v[136:139], v67 offset:2400
    ds_read_b128 v[140:143], v67 offset:2912
    ds_read_b128 v[144:147], v67 offset:3424
    ds_read_b128 v[148:151], v67 offset:3936
    ds_read_b128 v[112:115], v66 offset:640
    ds_read_b128 v[116:119], v66 offset:1152
    s_waitcnt lgkmcnt(2)
    v_mfma_f32_16x16x32_bf16 v[104:107], v[108:111], v[148:151], 0
    v_mfma_f32_16x16x32_bf16 v[100:103], v[108:111], v[144:147], 0
    v_mfma_f32_16x16x32_bf16 v[84:87], v[108:111], v[128:131], 0
    ds_read_b128 v[108:111], v66 offset:1664
    s_waitcnt lgkmcnt(2)
    v_mfma_f32_16x16x32_bf16 v[104:107], v[112:115], v[144:147], v[104:107]
    v_mfma_f32_16x16x32_bf16 v[100:103], v[112:115], v[140:143], v[100:103]
    v_mfma_f32_16x16x32_bf16 v[84:87], v[112:115], v[124:127], v[84:87]
    ds_read_b128 v[112:115], v66 offset:2176
    ds_read_b128 v[152:155], v67 offset:288
    ds_read_b128 v[156:159], v67 offset:800
    ds_read_b128 v[160:163], v67 offset:1312
    ds_read_b128 v[164:167], v67 offset:1824
    ds_read_b128 v[168:171], v67 offset:2336
    ds_read_b128 v[172:175], v67 offset:2848
    ds_read_b128 v[176:179], v67 offset:3360
    ds_read_b128 v[180:183], v67 offset:3872
    s_waitcnt lgkmcnt(10)
    v_mfma_f32_16x16x32_bf16 v[104:107], v[116:119], v[140:143], v[104:107]
    v_mfma_f32_16x16x32_bf16 v[100:103], v[116:119], v[136:139], v[100:103]
    v_mfma_f32_16x16x32_bf16 v[84:87], v[116:119], v[120:123], v[84:87]
    ds_read_b128 v[116:119], v66 offset:2688
    s_waitcnt lgkmcnt(10)
    v_mfma_f32_16x16x32_bf16 v[104:107], v[108:111], v[136:139], v[104:107]
    v_mfma_f32_16x16x32_bf16 v[100:103], v[108:111], v[132:135], v[100:103]
    ds_read_b128 v[108:111], v66 offset:3200
    s_waitcnt lgkmcnt(10)
    v_mfma_f32_16x16x32_bf16 v[104:107], v[112:115], v[132:135], v[104:107]
    v_mfma_f32_16x16x32_bf16 v[100:103], v[112:115], v[128:131], v[100:103]
    ds_read_b128 v[112:115], v66 offset:3712
    s_waitcnt lgkmcnt(2)
    v_mfma_f32_16x16x32_bf16 v[104:107], v[116:119], v[128:131], v[104:107]
    v_mfma_f32_16x16x32_bf16 v[100:103], v[116:119], v[124:127], v[100:103]
    ds_read_b128 v[116:119], v66 offset:192
    s_waitcnt lgkmcnt(2)
    v_mfma_f32_16x16x32_bf16 v[104:107], v[108:111], v[124:127], v[104:107]
    v_mfma_f32_16x16x32_bf16 v[100:103], v[108:111], v[120:123], v[100:103]
    ds_read_b128 v[108:111], v66 offset:704
    s_waitcnt lgkmcnt(2)
    v_mfma_f32_16x16x32_bf16 v[104:107], v[112:115], v[120:123], v[104:107]
    ds_read_b128 v[112:115], v66 offset:1216
    s_waitcnt lgkmcnt(2)
    v_mfma_f32_16x16x32_bf16 v[104:107], v[116:119], v[180:183], v[104:107]
    v_mfma_f32_16x16x32_bf16 v[100:103], v[116:119], v[176:179], v[100:103]
    v_mfma_f32_16x16x32_bf16 v[84:87], v[116:119], v[160:163], v[84:87]
    ds_read_b128 v[116:119], v66 offset:1728
    s_waitcnt lgkmcnt(2)
    v_mfma_f32_16x16x32_bf16 v[104:107], v[108:111], v[176:179], v[104:107]
    v_mfma_f32_16x16x32_bf16 v[100:103], v[108:111], v[172:175], v[100:103]
    v_mfma_f32_16x16x32_bf16 v[84:87], v[108:111], v[156:159], v[84:87]
    ds_read_b128 v[108:111], v66 offset:2240
    s_waitcnt lgkmcnt(2)
    v_mfma_f32_16x16x32_bf16 v[104:107], v[112:115], v[172:175], v[104:107]
    v_mfma_f32_16x16x32_bf16 v[100:103], v[112:115], v[168:171], v[100:103]
    v_mfma_f32_16x16x32_bf16 v[84:87], v[112:115], v[152:155], v[84:87]
    ds_read_b128 v[112:115], v66 offset:2752
    s_waitcnt lgkmcnt(2)
    v_mfma_f32_16x16x32_bf16 v[104:107], v[116:119], v[168:171], v[104:107]
    v_mfma_f32_16x16x32_bf16 v[100:103], v[116:119], v[164:167], v[100:103]
    ds_read_b128 v[116:119], v66 offset:3264
    s_waitcnt lgkmcnt(2)
    v_mfma_f32_16x16x32_bf16 v[104:107], v[108:111], v[164:167], v[104:107]
    v_mfma_f32_16x16x32_bf16 v[100:103], v[108:111], v[160:163], v[100:103]
    ds_read_b128 v[108:111], v66 offset:3776
    s_waitcnt lgkmcnt(2)
    v_mfma_f32_16x16x32_bf16 v[104:107], v[112:115], v[160:163], v[104:107]
    v_mfma_f32_16x16x32_bf16 v[100:103], v[112:115], v[156:159], v[100:103]
    s_waitcnt lgkmcnt(1)
    v_mfma_f32_16x16x32_bf16 v[104:107], v[116:119], v[156:159], v[104:107]
    v_mfma_f32_16x16x32_bf16 v[100:103], v[116:119], v[152:155], v[100:103]
    s_waitcnt lgkmcnt(0)
    v_mfma_f32_16x16x32_bf16 v[104:107], v[108:111], v[152:155], v[104:107]
    ds_write_b128 v74, v[84:87] offset:2048
    s_nop 4
    ds_write_b128 v74, v[100:103] offset:6144
    s_nop 0
    ds_write_b128 v74, v[104:107] offset:7168
    s_branch c_pw_end_68
c_pw_70:
    s_cmp_lg_u32 s34, 2
    s_cbranch_scc1 c_pw_71
    ds_read_b128 v[108:111], v66 offset:256
    ds_read_b128 v[120:123], v67 offset:224
    ds_read_b128 v[124:127], v67 offset:736
    ds_read_b128 v[128:131], v67 offset:1248
    ds_read_b128 v[132:135], v67 offset:1760
    ds_read_b128 v[136:139], v67 offset:2272
    ds_read_b128 v[140:143], v67 offset:2784
    ds_read_b128 v[144:147], v67 offset:3296
    ds_read_b128 v[148:151], v67 offset:3808
    ds_read_b128 v[112:115], v66 offset:768
    ds_read_b128 v[116:119], v66 offset:1280
    s_waitcnt lgkmcnt(2)
    v_mfma_f32_16x16x32_bf16 v[104:107], v[108:111], v[148:151], 0
    v_mfma_f32_16x16x32_bf16 v[100:103], v[108:111], v[144:147], 0
    v_mfma_f32_16x16x32_bf16 v[84:87], v[108:111], v[128:131], 0
    ds_read_b128 v[108:111], v66 offset:1792
    s_waitcnt lgkmcnt(2)
    v_mfma_f32_16x16x32_bf16 v[104:107], v[112:115], v[144:147], v[104:107]
    v_mfma_f32_16x16x32_bf16 v[100:103], v[112:115], v[140:143], v[100:103]
    v_mfma_f32_16x16x32_bf16 v[84:87], v[112:115], v[124:127], v[84:87]
    ds_read_b128 v[112:115], v66 offset:2304
    ds_read_b128 v[152:155], v67 offset:160
    ds_read_b128 v[156:159], v67 offset:672
    ds_read_b128 v[160:163], v67 offset:1184
    ds_read_b128 v[164:167], v67 offset:1696
    ds_read_b128 v[168:171], v67 offset:2208
    ds_read_b128 v[172:175], v67 offset:2720
    ds_read_b128 v[176:179], v67 offset:3232
    ds_read_b128 v[180:183], v67 offset:3744
    s_waitcnt lgkmcnt(10)
    v_mfma_f32_16x16x32_bf16 v[104:107], v[116:119], v[140:143], v[104:107]
    v_mfma_f32_16x16x32_bf16 v[100:103], v[116:119], v[136:139], v[100:103]
    v_mfma_f32_16x16x32_bf16 v[84:87], v[116:119], v[120:123], v[84:87]
    ds_read_b128 v[116:119], v66 offset:2816
    s_waitcnt lgkmcnt(10)
    v_mfma_f32_16x16x32_bf16 v[104:107], v[108:111], v[136:139], v[104:107]
    v_mfma_f32_16x16x32_bf16 v[100:103], v[108:111], v[132:135], v[100:103]
    ds_read_b128 v[108:111], v66 offset:3328
    s_waitcnt lgkmcnt(10)
    v_mfma_f32_16x16x32_bf16 v[104:107], v[112:115], v[132:135], v[104:107]
    v_mfma_f32_16x16x32_bf16 v[100:103], v[112:115], v[128:131], v[100:103]
    ds_read_b128 v[112:115], v66 offset:3840
    s_waitcnt lgkmcnt(2)
    v_mfma_f32_16x16x32_bf16 v[104:107], v[116:119], v[128:131], v[104:107]
    v_mfma_f32_16x16x32_bf16 v[100:103], v[116:119], v[124:127], v[100:103]
    ds_read_b128 v[116:119], v66 offset:320
    s_waitcnt lgkmcnt(2)
    v_mfma_f32_16x16x32_bf16 v[104:107], v[108:111], v[124:127], v[104:107]
    v_mfma_f32_16x16x32_bf16 v[100:103], v[108:111], v[120:123], v[100:103]
    ds_read_b128 v[108:111], v66 offset:832
    s_waitcnt lgkmcnt(2)
    v_mfma_f32_16x16x32_bf16 v[104:107], v[112:115], v[120:123], v[104:107]
    ds_read_b128 v[112:115], v66 offset:1344
    s_waitcnt lgkmcnt(2)
    v_mfma_f32_16x16x32_bf16 v[104:107], v[116:119], v[180:183], v[104:107]
    v_mfma_f32_16x16x32_bf16 v[100:103], v[116:119], v[176:179], v[100:103]
    v_mfma_f32_16x16x32_bf16 v[84:87], v[116:119], v[160:163], v[84:87]
    ds_read_b128 v[116:119], v66 offset:1856
    s_waitcnt lgkmcnt(2)
    v_mfma_f32_16x16x32_bf16 v[104:107], v[108:111], v[176:179], v[104:107]
    v_mfma_f32_16x16x32_bf16 v[100:103], v[108:111], v[172:175], v[100:103]
    v_mfma_f32_16x16x32_bf16 v[84:87], v[108:111], v[156:159], v[84:87]
    ds_read_b128 v[108:111], v66 offset:2368
    s_waitcnt lgkmcnt(2)
    v_mfma_f32_16x16x32_bf16 v[104:107], v[112:115], v[172:175], v[104:107]
    v_mfma_f32_16x16x32_bf16 v[100:103], v[112:115], v[168:171], v[100:103]
    v_mfma_f32_16x16x32_bf16 v[84:87], v[112:115], v[152:155], v[84:87]
    ds_read_b128 v[112:115], v66 offset:2880
    s_waitcnt lgkmcnt(2)
    v_mfma_f32_16x16x32_bf16 v[104:107], v[116:119], v[168:171], v[104:107]
    v_mfma_f32_16x16x32_bf16 v[100:103], v[116:119], v[164:167], v[100:103]
    ds_read_b128 v[116:119], v66 offset:3392
    s_waitcnt lgkmcnt(2)
    v_mfma_f32_16x16x32_bf16 v[104:107], v[108:111], v[164:167], v[104:107]
    v_mfma_f32_16x16x32_bf16 v[100:103], v[108:111], v[160:163], v[100:103]
    ds_read_b128 v[108:111], v66 offset:3904
    s_waitcnt lgkmcnt(2)
    v_mfma_f32_16x16x32_bf16 v[104:107], v[112:115], v[160:163], v[104:107]
    v_mfma_f32_16x16x32_bf16 v[100:103], v[112:115], v[156:159], v[100:103]
    s_waitcnt lgkmcnt(1)
    v_mfma_f32_16x16x32_bf16 v[104:107], v[116:119], v[156:159], v[104:107]
    v_mfma_f32_16x16x32_bf16 v[100:103], v[116:119], v[152:155], v[100:103]
    s_waitcnt lgkmcnt(0)
    v_mfma_f32_16x16x32_bf16 v[104:107], v[108:111], v[152:155], v[104:107]
    ds_write_b128 v74, v[84:87] offset:2048
    s_nop 4
    ds_write_b128 v74, v[100:103] offset:6144
    s_nop 0
    ds_write_b128 v74, v[104:107] offset:7168
    s_branch c_pw_end_68
c_pw_71:
    ds_read_b128 v[108:111], v66 offset:384
    ds_read_b128 v[120:123], v67 offset:96
    ds_read_b128 v[124:127], v67 offset:608
    ds_read_b128 v[128:131], v67 offset:1120
    ds_read_b128 v[132:135], v67 offset:1632
    ds_read_b128 v[136:139], v67 offset:2144
    ds_read_b128 v[140:143], v67 offset:2656
    ds_read_b128 v[144:147], v67 offset:3168
    ds_read_b128 v[148:151], v67 offset:3680
    ds_read_b128 v[112:115], v66 offset:896
    ds_read_b128 v[116:119], v66 offset:1408
    s_waitcnt lgkmcnt(2)
    v_mfma_f32_16x16x32_bf16 v[104:107], v[108:111], v[148:151], 0
    v_mfma_f32_16x16x32_bf16 v[100:103], v[108:111], v[144:147], 0
    v_mfma_f32_16x16x32_bf16 v[84:87], v[108:111], v[128:131], 0
    ds_read_b128 v[108:111], v66 offset:1920
    s_waitcnt lgkmcnt(2)
    v_mfma_f32_16x16x32_bf16 v[104:107], v[112:115], v[144:147], v[104:107]
    v_mfma_f32_16x16x32_bf16 v[100:103], v[112:115], v[140:143], v[100:103]
    v_mfma_f32_16x16x32_bf16 v[84:87], v[112:115], v[124:127], v[84:87]
    ds_read_b128 v[112:115], v66 offset:2432
    ds_read_b128 v[152:155], v67 offset:32
    ds_read_b128 v[156:159], v67 offset:544
    ds_read_b128 v[160:163], v67 offset:1056
    ds_read_b128 v[164:167], v67 offset:1568
    ds_read_b128 v[168:171], v67 offset:2080
    ds_read_b128 v[172:175], v67 offset:2592
    ds_read_b128 v[176:179], v67 offset:3104
    ds_read_b128 v[180:183], v67 offset:3616
    s_waitcnt lgkmcnt(10)
    v_mfma_f32_16x16x32_bf16 v[104:107], v[116:119], v[140:143], v[104:107]
    v_mfma_f32_16x16x32_bf16 v[100:103], v[116:119], v[136:139], v[100:103]
    v_mfma_f32_16x16x32_bf16 v[84:87], v[116:119], v[120:123], v[84:87]
    ds_read_b128 v[116:119], v66 offset:2944
    s_waitcnt lgkmcnt(10)
    v_mfma_f32_16x16x32_bf16 v[104:107], v[108:111], v[136:139], v[104:107]
    v_mfma_f32_16x16x32_bf16 v[100:103], v[108:111], v[132:135], v[100:103]
    ds_read_b128 v[108:111], v66 offset:3456
    s_waitcnt lgkmcnt(10)
    v_mfma_f32_16x16x32_bf16 v[104:107], v[112:115], v[132:135], v[104:107]
    v_mfma_f32_16x16x32_bf16 v[100:103], v[112:115], v[128:131], v[100:103]
    ds_read_b128 v[112:115], v66 offset:3968
    s_waitcnt lgkmcnt(2)
    v_mfma_f32_16x16x32_bf16 v[104:107], v[116:119], v[128:131], v[104:107]
    v_mfma_f32_16x16x32_bf16 v[100:103], v[116:119], v[124:127], v[100:103]
    ds_read_b128 v[116:119], v66 offset:448
    s_waitcnt lgkmcnt(2)
    v_mfma_f32_16x16x32_bf16 v[104:107], v[108:111], v[124:127], v[104:107]
    v_mfma_f32_16x16x32_bf16 v[100:103], v[108:111], v[120:123], v[100:103]
    ds_read_b128 v[108:111], v66 offset:960
    s_waitcnt lgkmcnt(2)
    v_mfma_f32_16x16x32_bf16 v[104:107], v[112:115], v[120:123], v[104:107]
    ds_read_b128 v[112:115], v66 offset:1472
    s_waitcnt lgkmcnt(2)
    v_mfma_f32_16x16x32_bf16 v[104:107], v[116:119], v[180:183], v[104:107]
    v_mfma_f32_16x16x32_bf16 v[100:103], v[116:119], v[176:179], v[100:103]
    v_mfma_f32_16x16x32_bf16 v[84:87], v[116:119], v[160:163], v[84:87]
    ds_read_b128 v[116:119], v66 offset:1984
    s_waitcnt lgkmcnt(2)
    v_mfma_f32_16x16x32_bf16 v[104:107], v[108:111], v[176:179], v[104:107]
    v_mfma_f32_16x16x32_bf16 v[100:103], v[108:111], v[172:175], v[100:103]
    v_mfma_f32_16x16x32_bf16 v[84:87], v[108:111], v[156:159], v[84:87]
    ds_read_b128 v[108:111], v66 offset:2496
    s_waitcnt lgkmcnt(2)
    v_mfma_f32_16x16x32_bf16 v[104:107], v[112:115], v[172:175], v[104:107]
    v_mfma_f32_16x16x32_bf16 v[100:103], v[112:115], v[168:171], v[100:103]
    v_mfma_f32_16x16x32_bf16 v[84:87], v[112:115], v[152:155], v[84:87]
    ds_read_b128 v[112:115], v66 offset:3008
    s_waitcnt lgkmcnt(2)
    v_mfma_f32_16x16x32_bf16 v[104:107], v[116:119], v[168:171], v[104:107]
    v_mfma_f32_16x16x32_bf16 v[100:103], v[116:119], v[164:167], v[100:103]
    ds_read_b128 v[116:119], v66 offset:3520
    s_waitcnt lgkmcnt(2)
    v_mfma_f32_16x16x32_bf16 v[104:107], v[108:111], v[164:167], v[104:107]
    v_mfma_f32_16x16x32_bf16 v[100:103], v[108:111], v[160:163], v[100:103]
    ds_read_b128 v[108:111], v66 offset:4032
    s_waitcnt lgkmcnt(2)
    v_mfma_f32_16x16x32_bf16 v[104:107], v[112:115], v[160:163], v[104:107]
    v_mfma_f32_16x16x32_bf16 v[100:103], v[112:115], v[156:159], v[100:103]
    s_waitcnt lgkmcnt(1)
    v_mfma_f32_16x16x32_bf16 v[104:107], v[116:119], v[156:159], v[104:107]
    v_mfma_f32_16x16x32_bf16 v[100:103], v[116:119], v[152:155], v[100:103]
    s_waitcnt lgkmcnt(0)
    v_mfma_f32_16x16x32_bf16 v[104:107], v[108:111], v[152:155], v[104:107]
    ds_write_b128 v74, v[84:87] offset:2048
    s_nop 4
    ds_write_b128 v74, v[100:103] offset:6144
    s_nop 0
    ds_write_b128 v74, v[104:107] offset:7168
c_pw_end_68:
    s_waitcnt lgkmcnt(0)
    v_mov_b32 v3, 161796
    v_mov_b32 v4, 1
    s_mov_b64 exec, 1
    ds_add_u32 v3, v4
    s_mov_b64 exec, -1
    s_mov_b32 s67, 0
gsync_73:
    ds_read_b32 v4, v3
    s_add_u32 s67, s67, 1
    s_waitcnt lgkmcnt(0)
    v_readfirstlane_b32 s66, v4
    s_cmp_gt_u32 s67, 1000000
    s_cbranch_scc1 gsync_e_74
    s_cmp_lt_u32 s66, 24
    s_cbranch_scc1 gsync_73
gsync_e_74:
    s_mov_b64 exec, 0
    s_cmp_eq_u32 s34, 0
    s_cselect_b32 exec_lo, 0, exec_lo
    s_cselect_b32 exec_hi, 0, exec_hi
    s_cmp_eq_u32 s34, 1
    s_cselect_b32 exec_lo, -1, exec_lo
    s_cselect_b32 exec_hi, 0, exec_hi
    s_cmp_eq_u32 s34, 2
    s_cselect_b32 exec_lo, 0, exec_lo
    s_cselect_b32 exec_hi, 0, exec_hi
    s_cmp_eq_u32 s34, 3
    s_cselect_b32 exec_lo, -1, exec_lo
    s_cselect_b32 exec_hi, -1, exec_hi
    s_cbranch_execz c_fskip_76
    ds_read_b128 v[120:123], v75 offset:0
    ds_read_b128 v[124:127], v75 offset:16
    ds_read_b128 v[128:131], v75 offset:8192
    ds_read_b128 v[132:135], v75 offset:8208
    ds_read_b128 v[136:139], v75 offset:16384
    ds_read_b128 v[140:143], v75 offset:16400
    ds_read_b128 v[144:147], v75 offset:24576
    ds_read_b128 v[148:151], v75 offset:24592
    s_lshl_b32 s40, s58, 12
    s_add_u32 s40, s40, 8912896
    s_waitcnt lgkmcnt(0)
    v_pk_add_f32 v[120:121], v[120:121], v[128:129]
    v_pk_add_f32 v[136:137], v[136:137], v[144:145]
    v_pk_add_f32 v[122:123], v[122:123], v[130:131]
    v_pk_add_f32 v[138:139], v[138:139], v[146:147]
    v_pk_add_f32 v[124:125], v[124:125], v[132:133]
    v_pk_add_f32 v[140:141], v[140:141], v[148:149]
    v_pk_add_f32 v[126:127], v[126:127], v[134:135]
    v_pk_add_f32 v[142:143], v[142:143], v[150:151]
    v_pk_add_f32 v[120:121], v[120:121], v[136:137]
    v_pk_add_f32 v[122:123], v[122:123], v[138:139]
    v_pk_add_f32 v[124:125], v[124:125], v[140:141]
    v_pk_add_f32 v[126:127], v[126:127], v[142:143]
    v_cvt_pk_bf16_f32 v192, v120, v121
    v_cvt_pk_bf16_f32 v193, v122, v123
    v_cvt_pk_bf16_f32 v194, v124, v125
    v_cvt_pk_bf16_f32 v195, v126, v127
    buffer_store_dwordx4 v[192:195], v2, s[8:11], s40 offen sc1
c_fskip_76:
    s_mov_b64 exec, -1
    s_nop 1
    s_branch c_halfE_67
c_halfB_66:
    s_cmp_lg_u32 s34, 0
    s_cbranch_scc1 c_pw_78
    ds_read_b128 v[108:111], v66 offset:0
    ds_read_b128 v[120:123], v67 offset:480
    ds_read_b128 v[124:127], v67 offset:992
    ds_read_b128 v[128:131], v67 offset:1504
    ds_read_b128 v[132:135], v67 offset:2016
    ds_read_b128 v[136:139], v67 offset:2528
    ds_read_b128 v[140:143], v67 offset:3040
    ds_read_b128 v[112:115], v66 offset:512
    ds_read_b128 v[116:119], v66 offset:1024
    s_waitcnt lgkmcnt(2)
    v_mfma_f32_16x16x32_bf16 v[96:99], v[108:111], v[140:143], 0
    v_mfma_f32_16x16x32_bf16 v[92:95], v[108:111], v[136:139], 0
    v_mfma_f32_16x16x32_bf16 v[88:91], v[108:111], v[132:135], 0
    v_mfma_f32_16x16x32_bf16 v[80:83], v[108:111], v[124:127], 0
    v_mfma_f32_16x16x32_bf16 v[76:79], v[108:111], v[120:123], 0
    v_mfma_f32_16x16x32_bf16 v[76:79], v[196:199], v[120:123], v[76:79]
    v_mfma_f32_16x16x32_bf16 v[80:83], v[196:199], v[124:127], v[80:83]
    v_mfma_f32_16x16x32_bf16 v[88:91], v[196:199], v[132:135], v[88:91]
    v_mfma_f32_16x16x32_bf16 v[92:95], v[196:199], v[136:139], v[92:95]
    v_mfma_f32_16x16x32_bf16 v[96:99], v[196:199], v[140:143], v[96:99]
    ds_read_b128 v[108:111], v66 offset:1536
    s_waitcnt lgkmcnt(2)
    v_mfma_f32_16x16x32_bf16 v[96:99], v[112:115], v[136:139], v[96:99]
    v_mfma_f32_16x16x32_bf16 v[92:95], v[112:115], v[132:135], v[92:95]
    v_mfma_f32_16x16x32_bf16 v[88:91], v[112:115], v[128:131], v[88:91]
    v_mfma_f32_16x16x32_bf16 v[80:83], v[112:115], v[120:123], v[80:83]
    ds_read_b128 v[112:115], v66 offset:2048
    ds_read_b128 v[152:155], v67 offset:416
    ds_read_b128 v[156:159], v67 offset:928
    ds_read_b128 v[160:163], v67 offset:1440
    ds_read_b128 v[164:167], v67 offset:1952
    ds_read_b128 v[168:171], v67 offset:2464
    ds_read_b128 v[172:175], v67 offset:2976
    s_waitcnt lgkmcnt(8)
    v_mfma_f32_16x16x32_bf16 v[96:99], v[116:119], v[132:135], v[96:99]
    v_mfma_f32_16x16x32_bf16 v[92:95], v[116:119], v[128:131], v[92:95]
    v_mfma_f32_16x16x32_bf16 v[88:91], v[116:119], v[124:127], v[88:91]
    ds_read_b128 v[116:119], v66 offset:2560
    s_waitcnt lgkmcnt(8)
    v_mfma_f32_16x16x32_bf16 v[96:99], v[108:111], v[128:131], v[96:99]
    v_mfma_f32_16x16x32_bf16 v[92:95], v[108:111], v[124:127], v[92:95]
    v_mfma_f32_16x16x32_bf16 v[88:91], v[108:111], v[120:123], v[88:91]
    ds_read_b128 v[108:111], v66 offset:64
    s_waitcnt lgkmcnt(8)
    v_mfma_f32_16x16x32_bf16 v[96:99], v[112:115], v[124:127], v[96:99]
    v_mfma_f32_16x16x32_bf16 v[92:95], v[112:115], v[120:123], v[92:95]
    ds_read_b128 v[112:115], v66 offset:576
    s_waitcnt lgkmcnt(2)
    v_mfma_f32_16x16x32_bf16 v[96:99], v[116:119], v[120:123], v[96:99]
    ds_read_b128 v[116:119], v66 offset:1088
    s_waitcnt lgkmcnt(2)
    v_mfma_f32_16x16x32_bf16 v[96:99], v[108:111], v[172:175], v[96:99]
    v_mfma_f32_16x16x32_bf16 v[92:95], v[108:111], v[168:171], v[92:95]
    v_mfma_f32_16x16x32_bf16 v[88:91], v[108:111], v[164:167], v[88:91]
    v_mfma_f32_16x16x32_bf16 v[80:83], v[108:111], v[156:159], v[80:83]
    v_mfma_f32_16x16x32_bf16 v[76:79], v[108:111], v[152:155], v[76:79]
    ds_read_b128 v[108:111], v66 offset:1600
    s_waitcnt lgkmcnt(2)
    v_mfma_f32_16x16x32_bf16 v[96:99], v[112:115], v[168:171], v[96:99]
    v_mfma_f32_16x16x32_bf16 v[92:95], v[112:115], v[164:167], v[92:95]
    v_mfma_f32_16x16x32_bf16 v[88:91], v[112:115], v[160:163], v[88:91]
    v_mfma_f32_16x16x32_bf16 v[80:83], v[112:115], v[152:155], v[80:83]
    ds_read_b128 v[112:115], v66 offset:2112
    s_waitcnt lgkmcnt(2)
    v_mfma_f32_16x16x32_bf16 v[96:99], v[116:119], v[164:167], v[96:99]
    v_mfma_f32_16x16x32_bf16 v[92:95], v[116:119], v[160:163], v[92:95]
    v_mfma_f32_16x16x32_bf16 v[88:91], v[116:119], v[156:159], v[88:91]
    ds_read_b128 v[116:119], v66 offset:2624
    s_waitcnt lgkmcnt(2)
    v_mfma_f32_16x16x32_bf16 v[96:99], v[108:111], v[160:163], v[96:99]
    v_mfma_f32_16x16x32_bf16 v[92:95], v[108:111], v[156:159], v[92:95]
    v_mfma_f32_16x16x32_bf16 v[88:91], v[108:111], v[152:155], v[88:91]
    s_waitcnt lgkmcnt(1)
    v_mfma_f32_16x16x32_bf16 v[96:99], v[112:115], v[156:159], v[96:99]
    v_mfma_f32_16x16x32_bf16 v[92:95], v[112:115], v[152:155], v[92:95]
    s_waitcnt lgkmcnt(0)
    v_mfma_f32_16x16x32_bf16 v[96:99], v[116:119], v[152:155], v[96:99]
    ds_write_b128 v74, v[76:79] offset:0
    ds_write_b128 v74, v[80:83] offset:1024
    s_nop 0
    ds_write_b128 v74, v[88:91] offset:3072
    s_nop 1
    ds_write_b128 v74, v[92:95] offset:4096
    s_nop 0
    ds_write_b128 v74, v[96:99] offset:5120
    s_branch c_pw_end_77
c_pw_78:
    s_cmp_lg_u32 s34, 1
    s_cbranch_scc1 c_pw_79
    ds_read_b128 v[108:111], v66 offset:128
    ds_read_b128 v[120:123], v67 offset:352
    ds_read_b128 v[124:127], v67 offset:864
    ds_read_b128 v[128:131], v67 offset:1376
    ds_read_b128 v[132:135], v67 offset:1888
    ds_read_b128 v[136:139], v67 offset:2400
    ds_read_b128 v[140:143], v67 offset:2912
    ds_read_b128 v[112:115], v66 offset:640
    ds_read_b128 v[116:119], v66 offset:1152
    s_waitcnt lgkmcnt(2)
    v_mfma_f32_16x16x32_bf16 v[96:99], v[108:111], v[140:143], 0
    v_mfma_f32_16x16x32_bf16 v[92:95], v[108:111], v[136:139], 0
    v_mfma_f32_16x16x32_bf16 v[88:91], v[108:111], v[132:135], 0
    v_mfma_f32_16x16x32_bf16 v[80:83], v[108:111], v[124:127], 0
    v_mfma_f32_16x16x32_bf16 v[76:79], v[108:111], v[120:123], 0
    ds_read_b128 v[108:111], v66 offset:1664
    s_waitcnt lgkmcnt(2)
    v_mfma_f32_16x16x32_bf16 v[96:99], v[112:115], v[136:139], v[96:99]
    v_mfma_f32_16x16x32_bf16 v[92:95], v[112:115], v[132:135], v[92:95]
    v_mfma_f32_16x16x32_bf16 v[88:91], v[112:115], v[128:131], v[88:91]
    v_mfma_f32_16x16x32_bf16 v[80:83], v[112:115], v[120:123], v[80:83]
    ds_read_b128 v[112:115], v66 offset:2176
    ds_read_b128 v[152:155], v67 offset:288
    ds_read_b128 v[156:159], v67 offset:800
    ds_read_b128 v[160:163], v67 offset:1312
    ds_read_b128 v[164:167], v67 offset:1824
    ds_read_b128 v[168:171], v67 offset:2336
    ds_read_b128 v[172:175], v67 offset:2848
    s_waitcnt lgkmcnt(8)
    v_mfma_f32_16x16x32_bf16 v[96:99], v[116:119], v[132:135], v[96:99]
    v_mfma_f32_16x16x32_bf16 v[92:95], v[116:119], v[128:131], v[92:95]
    v_mfma_f32_16x16x32_bf16 v[88:91], v[116:119], v[124:127], v[88:91]
    ds_read_b128 v[116:119], v66 offset:2688
    s_waitcnt lgkmcnt(8)
    v_mfma_f32_16x16x32_bf16 v[96:99], v[108:111], v[128:131], v[96:99]
    v_mfma_f32_16x16x32_bf16 v[92:95], v[108:111], v[124:127], v[92:95]
    v_mfma_f32_16x16x32_bf16 v[88:91], v[108:111], v[120:123], v[88:91]
    ds_read_b128 v[108:111], v66 offset:192
    s_waitcnt lgkmcnt(8)
    v_mfma_f32_16x16x32_bf16 v[96:99], v[112:115], v[124:127], v[96:99]
    v_mfma_f32_16x16x32_bf16 v[92:95], v[112:115], v[120:123], v[92:95]
    ds_read_b128 v[112:115], v66 offset:704
    s_waitcnt lgkmcnt(2)
    v_mfma_f32_16x16x32_bf16 v[96:99], v[116:119], v[120:123], v[96:99]
    ds_read_b128 v[116:119], v66 offset:1216
    s_waitcnt lgkmcnt(2)
    v_mfma_f32_16x16x32_bf16 v[96:99], v[108:111], v[172:175], v[96:99]
    v_mfma_f32_16x16x32_bf16 v[92:95], v[108:111], v[168:171], v[92:95]
    v_mfma_f32_16x16x32_bf16 v[88:91], v[108:111], v[164:167], v[88:91]
    v_mfma_f32_16x16x32_bf16 v[80:83], v[108:111], v[156:159], v[80:83]
    v_mfma_f32_16x16x32_bf16 v[76:79], v[108:111], v[152:155], v[76:79]
    ds_read_b128 v[108:111], v66 offset:1728
    s_waitcnt lgkmcnt(2)
    v_mfma_f32_16x16x32_bf16 v[96:99], v[112:115], v[168:171], v[96:99]
    v_mfma_f32_16x16x32_bf16 v[92:95], v[112:115], v[164:167], v[92:95]
    v_mfma_f32_16x16x32_bf16 v[88:91], v[112:115], v[160:163], v[88:91]
    v_mfma_f32_16x16x32_bf16 v[80:83], v[112:115], v[152:155], v[80:83]
    ds_read_b128 v[112:115], v66 offset:2240
    s_waitcnt lgkmcnt(2)
    v_mfma_f32_16x16x32_bf16 v[96:99], v[116:119], v[164:167], v[96:99]
    v_mfma_f32_16x16x32_bf16 v[92:95], v[116:119], v[160:163], v[92:95]
    v_mfma_f32_16x16x32_bf16 v[88:91], v[116:119], v[156:159], v[88:91]
    ds_read_b128 v[116:119], v66 offset:2752
    s_waitcnt lgkmcnt(2)
    v_mfma_f32_16x16x32_bf16 v[96:99], v[108:111], v[160:163], v[96:99]
    v_mfma_f32_16x16x32_bf16 v[92:95], v[108:111], v[156:159], v[92:95]
    v_mfma_f32_16x16x32_bf16 v[88:91], v[108:111], v[152:155], v[88:91]
    s_waitcnt lgkmcnt(1)
    v_mfma_f32_16x16x32_bf16 v[96:99], v[112:115], v[156:159], v[96:99]
    v_mfma_f32_16x16x32_bf16 v[92:95], v[112:115], v[152:155], v[92:95]
    s_waitcnt lgkmcnt(0)
    v_mfma_f32_16x16x32_bf16 v[96:99], v[116:119], v[152:155], v[96:99]
    ds_write_b128 v74, v[76:79] offset:0
    ds_write_b128 v74, v[80:83] offset:1024
    s_nop 0
    ds_write_b128 v74, v[88:91] offset:3072
    s_nop 1
    ds_write_b128 v74, v[92:95] offset:4096
    s_nop 0
    ds_write_b128 v74, v[96:99] offset:5120
    s_branch c_pw_end_77
c_pw_79:
    s_cmp_lg_u32 s34, 2
    s_cbranch_scc1 c_pw_80
    ds_read_b128 v[108:111], v66 offset:256
    ds_read_b128 v[120:123], v67 offset:224
    ds_read_b128 v[124:127], v67 offset:736
    ds_read_b128 v[128:131], v67 offset:1248
    ds_read_b128 v[132:135], v67 offset:1760
    ds_read_b128 v[136:139], v67 offset:2272
    ds_read_b128 v[140:143], v67 offset:2784
    ds_read_b128 v[112:115], v66 offset:768
    ds_read_b128 v[116:119], v66 offset:1280
    s_waitcnt lgkmcnt(2)
    v_mfma_f32_16x16x32_bf16 v[96:99], v[108:111], v[140:143], 0
    v_mfma_f32_16x16x32_bf16 v[92:95], v[108:111], v[136:139], 0
    v_mfma_f32_16x16x32_bf16 v[88:91], v[108:111], v[132:135], 0
    v_mfma_f32_16x16x32_bf16 v[80:83], v[108:111], v[124:127], 0
    v_mfma_f32_16x16x32_bf16 v[76:79], v[108:111], v[120:123], 0
    ds_read_b128 v[108:111], v66 offset:1792
    s_waitcnt lgkmcnt(2)
    v_mfma_f32_16x16x32_bf16 v[96:99], v[112:115], v[136:139], v[96:99]
    v_mfma_f32_16x16x32_bf16 v[92:95], v[112:115], v[132:135], v[92:95]
    v_mfma_f32_16x16x32_bf16 v[88:91], v[112:115], v[128:131], v[88:91]
    v_mfma_f32_16x16x32_bf16 v[80:83], v[112:115], v[120:123], v[80:83]
    ds_read_b128 v[112:115], v66 offset:2304
    ds_read_b128 v[152:155], v67 offset:160
    ds_read_b128 v[156:159], v67 offset:672
    ds_read_b128 v[160:163], v67 offset:1184
    ds_read_b128 v[164:167], v67 offset:1696
    ds_read_b128 v[168:171], v67 offset:2208
    ds_read_b128 v[172:175], v67 offset:2720
    s_waitcnt lgkmcnt(8)
    v_mfma_f32_16x16x32_bf16 v[96:99], v[116:119], v[132:135], v[96:99]
    v_mfma_f32_16x16x32_bf16 v[92:95], v[116:119], v[128:131], v[92:95]
    v_mfma_f32_16x16x32_bf16 v[88:91], v[116:119], v[124:127], v[88:91]
    ds_read_b128 v[116:119], v66 offset:2816
    s_waitcnt lgkmcnt(8)
    v_mfma_f32_16x16x32_bf16 v[96:99], v[108:111], v[128:131], v[96:99]
    v_mfma_f32_16x16x32_bf16 v[92:95], v[108:111], v[124:127], v[92:95]
    v_mfma_f32_16x16x32_bf16 v[88:91], v[108:111], v[120:123], v[88:91]
    ds_read_b128 v[108:111], v66 offset:320
    s_waitcnt lgkmcnt(8)
    v_mfma_f32_16x16x32_bf16 v[96:99], v[112:115], v[124:127], v[96:99]
    v_mfma_f32_16x16x32_bf16 v[92:95], v[112:115], v[120:123], v[92:95]
    ds_read_b128 v[112:115], v66 offset:832
    s_waitcnt lgkmcnt(2)
    v_mfma_f32_16x16x32_bf16 v[96:99], v[116:119], v[120:123], v[96:99]
    ds_read_b128 v[116:119], v66 offset:1344
    s_waitcnt lgkmcnt(2)
    v_mfma_f32_16x16x32_bf16 v[96:99], v[108:111], v[172:175], v[96:99]
    v_mfma_f32_16x16x32_bf16 v[92:95], v[108:111], v[168:171], v[92:95]
    v_mfma_f32_16x16x32_bf16 v[88:91], v[108:111], v[164:167], v[88:91]
    v_mfma_f32_16x16x32_bf16 v[80:83], v[108:111], v[156:159], v[80:83]
    v_mfma_f32_16x16x32_bf16 v[76:79], v[108:111], v[152:155], v[76:79]
    ds_read_b128 v[108:111], v66 offset:1856
    s_waitcnt lgkmcnt(2)
    v_mfma_f32_16x16x32_bf16 v[96:99], v[112:115], v[168:171], v[96:99]
    v_mfma_f32_16x16x32_bf16 v[92:95], v[112:115], v[164:167], v[92:95]
    v_mfma_f32_16x16x32_bf16 v[88:91], v[112:115], v[160:163], v[88:91]
    v_mfma_f32_16x16x32_bf16 v[80:83], v[112:115], v[152:155], v[80:83]
    ds_read_b128 v[112:115], v66 offset:2368
    s_waitcnt lgkmcnt(2)
    v_mfma_f32_16x16x32_bf16 v[96:99], v[116:119], v[164:167], v[96:99]
    v_mfma_f32_16x16x32_bf16 v[92:95], v[116:119], v[160:163], v[92:95]
    v_mfma_f32_16x16x32_bf16 v[88:91], v[116:119], v[156:159], v[88:91]
    ds_read_b128 v[116:119], v66 offset:2880
    s_waitcnt lgkmcnt(2)
    v_mfma_f32_16x16x32_bf16 v[96:99], v[108:111], v[160:163], v[96:99]
    v_mfma_f32_16x16x32_bf16 v[92:95], v[108:111], v[156:159], v[92:95]
    v_mfma_f32_16x16x32_bf16 v[88:91], v[108:111], v[152:155], v[88:91]
    s_waitcnt lgkmcnt(1)
    v_mfma_f32_16x16x32_bf16 v[96:99], v[112:115], v[156:159], v[96:99]
    v_mfma_f32_16x16x32_bf16 v[92:95], v[112:115], v[152:155], v[92:95]
    s_waitcnt lgkmcnt(0)
    v_mfma_f32_16x16x32_bf16 v[96:99], v[116:119], v[152:155], v[96:99]
    ds_write_b128 v74, v[76:79] offset:0
    ds_write_b128 v74, v[80:83] offset:1024
    s_nop 0
    ds_write_b128 v74, v[88:91] offset:3072
    s_nop 1
    ds_write_b128 v74, v[92:95] offset:4096
    s_nop 0
    ds_write_b128 v74, v[96:99] offset:5120
    s_branch c_pw_end_77
c_pw_80:
    ds_read_b128 v[108:111], v66 offset:384
    ds_read_b128 v[120:123], v67 offset:96
    ds_read_b128 v[124:127], v67 offset:608
    ds_read_b128 v[128:131], v67 offset:1120
    ds_read_b128 v[132:135], v67 offset:1632
    ds_read_b128 v[136:139], v67 offset:2144
    ds_read_b128 v[140:143], v67 offset:2656
    ds_read_b128 v[112:115], v66 offset:896
    ds_read_b128 v[116:119], v66 offset:1408
    s_waitcnt lgkmcnt(2)
    v_mfma_f32_16x16x32_bf16 v[96:99], v[108:111], v[140:143], 0
    v_mfma_f32_16x16x32_bf16 v[92:95], v[108:111], v[136:139], 0
    v_mfma_f32_16x16x32_bf16 v[88:91], v[108:111], v[132:135], 0
    v_mfma_f32_16x16x32_bf16 v[80:83], v[108:111], v[124:127], 0
    v_mfma_f32_16x16x32_bf16 v[76:79], v[108:111], v[120:123], 0
    ds_read_b128 v[108:111], v66 offset:1920
    s_waitcnt lgkmcnt(2)
    v_mfma_f32_16x16x32_bf16 v[96:99], v[112:115], v[136:139], v[96:99]
    v_mfma_f32_16x16x32_bf16 v[92:95], v[112:115], v[132:135], v[92:95]
    v_mfma_f32_16x16x32_bf16 v[88:91], v[112:115], v[128:131], v[88:91]
    v_mfma_f32_16x16x32_bf16 v[80:83], v[112:115], v[120:123], v[80:83]
    ds_read_b128 v[112:115], v66 offset:2432
    ds_read_b128 v[152:155], v67 offset:32
    ds_read_b128 v[156:159], v67 offset:544
    ds_read_b128 v[160:163], v67 offset:1056
    ds_read_b128 v[164:167], v67 offset:1568
    ds_read_b128 v[168:171], v67 offset:2080
    ds_read_b128 v[172:175], v67 offset:2592
    s_waitcnt lgkmcnt(8)
    v_mfma_f32_16x16x32_bf16 v[96:99], v[116:119], v[132:135], v[96:99]
    v_mfma_f32_16x16x32_bf16 v[92:95], v[116:119], v[128:131], v[92:95]
    v_mfma_f32_16x16x32_bf16 v[88:91], v[116:119], v[124:127], v[88:91]
    ds_read_b128 v[116:119], v66 offset:2944
    s_waitcnt lgkmcnt(8)
    v_mfma_f32_16x16x32_bf16 v[96:99], v[108:111], v[128:131], v[96:99]
    v_mfma_f32_16x16x32_bf16 v[92:95], v[108:111], v[124:127], v[92:95]
    v_mfma_f32_16x16x32_bf16 v[88:91], v[108:111], v[120:123], v[88:91]
    ds_read_b128 v[108:111], v66 offset:448
    s_waitcnt lgkmcnt(8)
    v_mfma_f32_16x16x32_bf16 v[96:99], v[112:115], v[124:127], v[96:99]
    v_mfma_f32_16x16x32_bf16 v[92:95], v[112:115], v[120:123], v[92:95]
    ds_read_b128 v[112:115], v66 offset:960
    s_waitcnt lgkmcnt(2)
    v_mfma_f32_16x16x32_bf16 v[96:99], v[116:119], v[120:123], v[96:99]
    ds_read_b128 v[116:119], v66 offset:1472
    s_waitcnt lgkmcnt(2)
    v_mfma_f32_16x16x32_bf16 v[96:99], v[108:111], v[172:175], v[96:99]
    v_mfma_f32_16x16x32_bf16 v[92:95], v[108:111], v[168:171], v[92:95]
    v_mfma_f32_16x16x32_bf16 v[88:91], v[108:111], v[164:167], v[88:91]
    v_mfma_f32_16x16x32_bf16 v[80:83], v[108:111], v[156:159], v[80:83]
    v_mfma_f32_16x16x32_bf16 v[76:79], v[108:111], v[152:155], v[76:79]
    ds_read_b128 v[108:111], v66 offset:1984
    s_waitcnt lgkmcnt(2)
    v_mfma_f32_16x16x32_bf16 v[96:99], v[112:115], v[168:171], v[96:99]
    v_mfma_f32_16x16x32_bf16 v[92:95], v[112:115], v[164:167], v[92:95]
    v_mfma_f32_16x16x32_bf16 v[88:91], v[112:115], v[160:163], v[88:91]
    v_mfma_f32_16x16x32_bf16 v[80:83], v[112:115], v[152:155], v[80:83]
    ds_read_b128 v[112:115], v66 offset:2496
    s_waitcnt lgkmcnt(2)
    v_mfma_f32_16x16x32_bf16 v[96:99], v[116:119], v[164:167], v[96:99]
    v_mfma_f32_16x16x32_bf16 v[92:95], v[116:119], v[160:163], v[92:95]
    v_mfma_f32_16x16x32_bf16 v[88:91], v[116:119], v[156:159], v[88:91]
    ds_read_b128 v[116:119], v66 offset:3008
    s_waitcnt lgkmcnt(2)
    v_mfma_f32_16x16x32_bf16 v[96:99], v[108:111], v[160:163], v[96:99]
    v_mfma_f32_16x16x32_bf16 v[92:95], v[108:111], v[156:159], v[92:95]
    v_mfma_f32_16x16x32_bf16 v[88:91], v[108:111], v[152:155], v[88:91]
    s_waitcnt lgkmcnt(1)
    v_mfma_f32_16x16x32_bf16 v[96:99], v[112:115], v[156:159], v[96:99]
    v_mfma_f32_16x16x32_bf16 v[92:95], v[112:115], v[152:155], v[92:95]
    s_waitcnt lgkmcnt(0)
    v_mfma_f32_16x16x32_bf16 v[96:99], v[116:119], v[152:155], v[96:99]
    ds_write_b128 v74, v[76:79] offset:0
    ds_write_b128 v74, v[80:83] offset:1024
    s_nop 0
    ds_write_b128 v74, v[88:91] offset:3072
    s_nop 1
    ds_write_b128 v74, v[92:95] offset:4096
    s_nop 0
    ds_write_b128 v74, v[96:99] offset:5120
c_pw_end_77:
    s_waitcnt lgkmcnt(0)
    v_mov_b32 v3, 161796
    v_mov_b32 v4, 1
    s_mov_b64 exec, 1
    ds_add_u32 v3, v4
    s_mov_b64 exec, -1
    s_mov_b32 s67, 0
gsync_82:
    ds_read_b32 v4, v3
    s_add_u32 s67, s67, 1
    s_waitcnt lgkmcnt(0)
    v_readfirstlane_b32 s66, v4
    s_cmp_gt_u32 s67, 1000000
    s_cbranch_scc1 gsync_e_83
    s_cmp_lt_u32 s66, 24
    s_cbranch_scc1 gsync_82
gsync_e_83:
    s_mov_b64 exec, 0
    s_cmp_eq_u32 s34, 0
    s_cselect_b32 exec_lo, -1, exec_lo
    s_cselect_b32 exec_hi, -1, exec_hi
    s_cmp_eq_u32 s34, 1
    s_cselect_b32 exec_lo, 0, exec_lo
    s_cselect_b32 exec_hi, -1, exec_hi
    s_cmp_eq_u32 s34, 2
    s_cselect_b32 exec_lo, -1, exec_lo
    s_cselect_b32 exec_hi, -1, exec_hi
    s_cmp_eq_u32 s34, 3
    s_cselect_b32 exec_lo, 0, exec_lo
    s_cselect_b32 exec_hi, 0, exec_hi
    s_cbranch_execz c_fskip_85
    ds_read_b128 v[120:123], v75 offset:0
    ds_read_b128 v[124:127], v75 offset:16
    ds_read_b128 v[128:131], v75 offset:8192
    ds_read_b128 v[132:135], v75 offset:8208
    ds_read_b128 v[136:139], v75 offset:16384
    ds_read_b128 v[140:143], v75 offset:16400
    ds_read_b128 v[144:147], v75 offset:24576
    ds_read_b128 v[148:151], v75 offset:24592
    s_lshl_b32 s40, s58, 12
    s_add_u32 s40, s40, 8912896
    s_waitcnt lgkmcnt(0)
    v_pk_add_f32 v[120:121], v[120:121], v[128:129]
    v_pk_add_f32 v[136:137], v[136:137], v[144:145]
    v_pk_add_f32 v[122:123], v[122:123], v[130:131]
    v_pk_add_f32 v[138:139], v[138:139], v[146:147]
    v_pk_add_f32 v[124:125], v[124:125], v[132:133]
    v_pk_add_f32 v[140:141], v[140:141], v[148:149]
    v_pk_add_f32 v[126:127], v[126:127], v[134:135]
    v_pk_add_f32 v[142:143], v[142:143], v[150:151]
    v_pk_add_f32 v[120:121], v[120:121], v[136:137]
    v_pk_add_f32 v[122:123], v[122:123], v[138:139]
    v_pk_add_f32 v[124:125], v[124:125], v[140:141]
    v_pk_add_f32 v[126:127], v[126:127], v[142:143]
    v_cvt_pk_bf16_f32 v192, v120, v121
    v_cvt_pk_bf16_f32 v193, v122, v123
    v_cvt_pk_bf16_f32 v194, v124, v125
    v_cvt_pk_bf16_f32 v195, v126, v127
    buffer_store_dwordx4 v[192:195], v2, s[8:11], s40 offen sc1
c_fskip_85:
    s_mov_b64 exec, -1
    s_nop 1
c_halfE_67:
    s_waitcnt vmcnt(0) lgkmcnt(0)
    s_waitcnt lgkmcnt(0)
    v_mov_b32 v251, 161796
    v_mov_b32 v252, 1
    s_mov_b64 exec, 1
    ds_add_u32 v251, v252
    s_mov_b64 exec, -1
    s_mov_b32 s67, 0
gsync_86:
    ds_read_b32 v252, v251
    s_add_u32 s67, s67, 1
    s_waitcnt lgkmcnt(0)
    v_readfirstlane_b32 s66, v252
    s_cmp_gt_u32 s67, 1000000
    s_cbranch_scc1 gsync_e_87
    s_cmp_lt_u32 s66, 28
    s_cbranch_scc1 gsync_86
gsync_e_87:
    s_lshl_b32 s58, s2, 3
    s_add_u32 s58, s58, 14721024
    v_mov_b32 v250, s100
    v_mov_b32 v251, s101
    v_mov_b32 v252, 0
    s_cmp_eq_u32 s34, 0
    s_cselect_b64 exec, 1, 0
    buffer_store_dwordx2 v[250:251], v252, s[8:11], s58 offen sc1
    s_mov_b64 exec, -1
recurrent_scan__ssm_conv_h3__mixer_gmlp__prompt_kernel_end:
    s_endpgm
.section .rodata,"a"
.p2align 6
.amdhsa_kernel recurrent_scan__ssm_conv_h3__mixer_gmlp__prompt_kernel
  .amdhsa_next_free_vgpr 254
  .amdhsa_next_free_sgpr 102
  .amdhsa_accum_offset 256
  .amdhsa_group_segment_fixed_size 0
  .amdhsa_kernarg_size 112
  .amdhsa_user_sgpr_count 2
  .amdhsa_user_sgpr_kernarg_segment_ptr 1
  .amdhsa_system_sgpr_workgroup_id_x 1
.end_amdhsa_kernel
```
